```python
import torch

def _softmax(x, axis=-1):
    return torch.softmax(x, dim=axis)
def _gelu(x):
    return torch.nn.functional.gelu(x, approximate="tanh")
def _silu(x):
    return torch.nn.functional.silu(x)
def _sigmoid(x):
    return torch.sigmoid(x)
def _layernorm(x, axis=-1, eps=1e-5):
    m = x.mean(dim=axis, keepdim=True)
    v = x.var(dim=axis, keepdim=True, unbiased=False)
    return (x - m) / torch.sqrt(v + eps)
def _scatter_add(tgt, idx, src, axis=0):
    return tgt.clone().index_add_(axis, idx, src)
def _segment_sum(src, seg, n):
    out = torch.zeros((n,) + src.shape[1:], dtype=src.dtype)
    return out.index_add_(0, seg, src)
def _pad(x, pw):
    flat = tuple(v for pair in reversed(pw) for v in pair)
    return torch.nn.functional.pad(x, flat)

kernel_name = 'interleave_layers__sliding_local_dilated__glu_gated_geglu__prompt'

def setup_inputs():

    _w = (lambda a: (lambda t: t.to(torch.bfloat16) if t.is_floating_point() else t)(torch.as_tensor(a)))
    def _A_setup():
        B, S, D = 1, 2048, 576
        return {
            "x": _w((lambda *s: torch.randn(*s, dtype=torch.bfloat16) * 0.05)(B, S, D)),
            "wqkv": _w((lambda *s: torch.randn(*s, dtype=torch.bfloat16) * 0.05)(D, 3 * D)),
            "wo": _w((lambda *s: torch.randn(*s, dtype=torch.bfloat16) * 0.05)(D, D)),
        }
    _A_in = _A_setup()

    def _B_setup():
        B, S, Dm, Df = 1, 2048, 576, 4608
        return {
            "x": _w((lambda *s: torch.randn(*s, dtype=torch.bfloat16) * 0.05)(B, S, Dm)),
            "w_gate": _w((lambda *s: torch.randn(*s, dtype=torch.bfloat16) * 0.8)(Dm, Df) * (Dm ** -0.5)),
            "w_up": _w((lambda *s: torch.randn(*s, dtype=torch.bfloat16) * 0.8)(Dm, Df) * (Dm ** -0.5)),
            "w_down": _w((lambda *s: torch.randn(*s, dtype=torch.bfloat16) * 0.8)(Df, Dm) * (Df ** -0.5)),
        }
    _B_in = _B_setup()

    return {
        "A_x": _A_in["x"],
        "A_wqkv": _A_in["wqkv"],
        "A_wo": _A_in["wo"],
        "B_x": _B_in["x"],
        "B_w_gate": _B_in["w_gate"],
        "B_w_up": _B_in["w_up"],
        "B_w_down": _B_in["w_down"],
    }

def reference(A_x, A_wqkv, A_wo, B_x, B_w_gate, B_w_up, B_w_down):
    def _A_ref(x, wqkv, wo):
        B, S, D = x.shape
        H = 32; Dh = D // H
        W, dil = 8, 2
        qkv = (lambda x, *d: x.permute(*d))((x @ wqkv).reshape(B, S, 3, H, Dh), 2, 0, 3, 1, 4)
        q, k, v = qkv[0], qkv[1], qkv[2]
        scale = Dh ** -0.5
        pos = torch.arange(S)
        off = torch.arange(W) * dil
        idx = pos[:, None] - off[None, :]
        mask = idx >= 0
        idx_c = torch.where(mask, idx, 0).reshape(-1)
        kg = k[:, :, idx_c, :].reshape(B, H, S, W, Dh)
        vg = v[:, :, idx_c, :].reshape(B, H, S, W, Dh)
        logits = torch.einsum("bhsd,bhswd->bhsw", q, kg) * scale
        logits = torch.where(mask[None, None, :, :], logits, -1e9)
        attn = _softmax(logits, axis=-1)
        o = torch.einsum("bhsw,bhswd->bhsd", attn, vg)
        return (lambda x, *d: x.permute(*d))(o, 0, 2, 1, 3).reshape(B, S, D) @ wo

    def _B_ref(x, w_gate, w_up, w_down):
        g = torch.einsum("bsd,df->bsf", x, w_gate)
        u = torch.einsum("bsd,df->bsf", x, w_up)
        h = _gelu(g) * u
        return torch.einsum("bsf,fd->bsd", h, w_down)

    x = A_x
    x = x + _A_ref(_layernorm(x, axis=-1), A_wqkv, A_wo)
    x = x + _B_ref(_layernorm(x, axis=-1), B_w_gate, B_w_up, B_w_down)
    x = x + _A_ref(_layernorm(x, axis=-1), A_wqkv, A_wo)
    x = x + _B_ref(_layernorm(x, axis=-1), B_w_gate, B_w_up, B_w_down)
    return x
```

```asm
; @launch kernel=prep_kernel grid=(988,1,1) block=(256,1,1) lds=32768
; @launch kernel=qkv_kernel grid=(256,1,1) block=(256,1,1) lds=98304
; @launch kernel=wo_kernel grid=(256,1,1) block=(256,1,1) lds=38912
; @launch kernel=ffn_kernel grid=(256,1,1) block=(256,1,1) lds=147456
; @launch kernel=red1_kernel grid=(256,1,1) block=(256,1,1) lds=1024
; @launch kernel=qkv_kernel grid=(256,1,1) block=(256,1,1) lds=98304
; @launch kernel=wo_kernel grid=(256,1,1) block=(256,1,1) lds=38912
; @launch kernel=ffn_kernel grid=(256,1,1) block=(256,1,1) lds=147456
; @launch kernel=red2_kernel grid=(256,1,1) block=(256,1,1) lds=1024
.amdgcn_target "amdgcn-amd-amdhsa--gfx950"
.text
.globl prep_kernel
.p2align 8
.type prep_kernel,@function
prep_kernel:
    s_cmp_ge_u32 s2, 988
    s_cbranch_scc1 L_prep_end
    s_load_dwordx2 s[4:5], s[0:1], 72
    v_lshrrev_b32 v1, 6, v0
    v_and_b32 v0, 63, v0
    v_readfirstlane_b32 s3, v1
    s_waitcnt lgkmcnt(0)
    s_mov_b32 s8, s4
    s_and_b32 s9, s5, 0xffff
    s_mov_b32 s10, 268435456
    s_mov_b32 s11, 0x20000
    s_cmp_ge_u32 s2, 486
    s_cbranch_scc1 L_prep_q
    s_load_dwordx4 s[24:27], s[0:1], 32
    s_load_dwordx2 s[28:29], s[0:1], 48
    s_waitcnt lgkmcnt(0)
    s_mul_i32 s20, s2, 6473
    s_lshr_b32 s20, s20, 20
    s_mul_i32 s21, s20, 162
    s_sub_u32 s21, s2, s21
    s_cmp_eq_u32 s20, 1
    s_cselect_b32 s12, s26, s24
    s_cselect_b32 s13, s27, s25
    s_cmp_eq_u32 s20, 2
    s_cselect_b32 s12, s28, s12
    s_cselect_b32 s13, s29, s13
    s_and_b32 s13, s13, 0xffff
    s_mov_b32 s14, 5308416
    s_mov_b32 s15, 0x20000
    s_cmp_eq_u32 s20, 2
    s_mov_b32 s22, 9216
    s_cmov_b32 s22, 1152
    s_mov_b32 s23, 14564
    s_cmov_b32 s23, 116509
    s_cselect_b32 s30, 9, 72
    s_cselect_b32 s31, 2, 3
    s_mov_b32 s32, 512
    s_cmov_b32 s32, 2048
    s_lshl_b32 s21, s21, 2
    s_add_u32 s21, s21, s3
    s_mul_i32 s21, s21, 2
    v_lshrrev_b32 v2, 3, v0
    v_mul_lo_u32 v2, v2, s22
    v_and_b32 v3, 7, v0
    v_lshl_add_u32 v2, v3, 4, v2
    s_mul_i32 s33, s3, 8192
    s_lshl_b32 s34, s22, 3
    s_add_u32 s7, s21, 0
    s_mul_i32 s36, s7, s23
    s_lshr_b32 s36, s36, 20
    s_mul_i32 s37, s36, s30
    s_sub_u32 s37, s7, s37
    s_mul_i32 s7, s36, s34
    s_lshl_b32 s7, s7, 2
    s_lshl_b32 s35, s37, 7
    s_add_u32 s7, s7, s35
    s_add_u32 m0, s33, 0
    s_nop 0
    buffer_load_dwordx4 v2, s[12:15], s7 offen lds
    s_add_u32 m0, s33, 1024
    s_add_u32 s7, s7, s34
    buffer_load_dwordx4 v2, s[12:15], s7 offen lds
    s_add_u32 m0, s33, 2048
    s_add_u32 s7, s7, s34
    buffer_load_dwordx4 v2, s[12:15], s7 offen lds
    s_add_u32 m0, s33, 3072
    s_add_u32 s7, s7, s34
    buffer_load_dwordx4 v2, s[12:15], s7 offen lds
    s_add_u32 s7, s21, 1
    s_mul_i32 s38, s7, s23
    s_lshr_b32 s38, s38, 20
    s_mul_i32 s39, s38, s30
    s_sub_u32 s39, s7, s39
    s_mul_i32 s7, s38, s34
    s_lshl_b32 s7, s7, 2
    s_lshl_b32 s35, s39, 7
    s_add_u32 s7, s7, s35
    s_add_u32 m0, s33, 4096
    s_nop 0
    buffer_load_dwordx4 v2, s[12:15], s7 offen lds
    s_add_u32 m0, s33, 5120
    s_add_u32 s7, s7, s34
    buffer_load_dwordx4 v2, s[12:15], s7 offen lds
    s_add_u32 m0, s33, 6144
    s_add_u32 s7, s7, s34
    buffer_load_dwordx4 v2, s[12:15], s7 offen lds
    s_add_u32 m0, s33, 7168
    s_add_u32 s7, s7, s34
    buffer_load_dwordx4 v2, s[12:15], s7 offen lds
    v_lshrrev_b32 v3, 4, v0
    v_lshlrev_b32 v3, s31, v3
    v_bfe_u32 v4, v0, 2, 2
    v_add_u32 v3, v3, v4
    v_and_b32 v4, 3, v0
    v_lshlrev_b32 v4, 3, v4
    v_lshl_add_u32 v3, v3, 7, v4
    v_add_u32 v3, s33, v3
    v_add_u32 v4, s32, v3
    v_lshlrev_b32 v5, 4, v0
    s_cmp_eq_u32 s20, 2
    s_cbranch_scc1 L_swz_down_1
    s_mul_i32 s6, s37, 116509
    s_lshr_b32 s6, s6, 20
    s_mul_i32 s7, s6, 9
    s_sub_u32 s7, s37, s7
    s_mul_i32 s6, s6, 1990656
    s_mul_i32 s7, s7, 36
    s_mul_i32 s34, s36, 349526
    s_lshr_b32 s34, s34, 20
    s_mul_i32 s35, s34, 3
    s_sub_u32 s35, s36, s35
    s_mul_i32 s34, s34, 6
    s_add_u32 s7, s7, s34
    s_add_u32 s7, s7, s35
    s_mul_i32 s34, s20, 3
    s_add_u32 s7, s7, s34
    s_lshl_b32 s7, s7, 10
    s_add_u32 s6, s6, s7
    s_add_u32 s44, s6, 3145728
    s_add_u32 s45, s6, 3643392
    s_add_u32 s46, s6, 4141056
    s_add_u32 s47, s6, 4638720
    s_mul_i32 s6, s39, 116509
    s_lshr_b32 s6, s6, 20
    s_mul_i32 s7, s6, 9
    s_sub_u32 s7, s39, s7
    s_mul_i32 s6, s6, 1990656
    s_mul_i32 s7, s7, 36
    s_mul_i32 s34, s38, 349526
    s_lshr_b32 s34, s34, 20
    s_mul_i32 s35, s34, 3
    s_sub_u32 s35, s38, s35
    s_mul_i32 s34, s34, 6
    s_add_u32 s7, s7, s34
    s_add_u32 s7, s7, s35
    s_mul_i32 s34, s20, 3
    s_add_u32 s7, s7, s34
    s_lshl_b32 s7, s7, 10
    s_add_u32 s6, s6, s7
    s_add_u32 s48, s6, 3145728
    s_add_u32 s49, s6, 3643392
    s_add_u32 s50, s6, 4141056
    s_add_u32 s51, s6, 4638720
    s_branch L_swz_dest_2
L_swz_down_1:
    s_mul_i32 s6, s36, 58255
    s_lshr_b32 s6, s6, 20
    s_mul_i32 s7, s6, 18
    s_sub_u32 s7, s36, s7
    s_mul_i32 s6, s6, 1990656
    s_lshl_b32 s7, s7, 10
    s_add_u32 s6, s6, s7
    s_add_u32 s6, s6, 3477504
    s_lshl_b32 s7, s37, 2
    s_add_u32 s7, s7, 0
    s_mul_i32 s34, s7, 116509
    s_lshr_b32 s34, s34, 20
    s_mul_i32 s35, s34, 9
    s_sub_u32 s35, s7, s35
    s_mul_i32 s34, s34, 497664
    s_mul_i32 s35, s35, 18432
    s_add_u32 s34, s34, s35
    s_add_u32 s44, s6, s34
    s_lshl_b32 s7, s37, 2
    s_add_u32 s7, s7, 1
    s_mul_i32 s34, s7, 116509
    s_lshr_b32 s34, s34, 20
    s_mul_i32 s35, s34, 9
    s_sub_u32 s35, s7, s35
    s_mul_i32 s34, s34, 497664
    s_mul_i32 s35, s35, 18432
    s_add_u32 s34, s34, s35
    s_add_u32 s45, s6, s34
    s_lshl_b32 s7, s37, 2
    s_add_u32 s7, s7, 2
    s_mul_i32 s34, s7, 116509
    s_lshr_b32 s34, s34, 20
    s_mul_i32 s35, s34, 9
    s_sub_u32 s35, s7, s35
    s_mul_i32 s34, s34, 497664
    s_mul_i32 s35, s35, 18432
    s_add_u32 s34, s34, s35
    s_add_u32 s46, s6, s34
    s_lshl_b32 s7, s37, 2
    s_add_u32 s7, s7, 3
    s_mul_i32 s34, s7, 116509
    s_lshr_b32 s34, s34, 20
    s_mul_i32 s35, s34, 9
    s_sub_u32 s35, s7, s35
    s_mul_i32 s34, s34, 497664
    s_mul_i32 s35, s35, 18432
    s_add_u32 s34, s34, s35
    s_add_u32 s47, s6, s34
    s_mul_i32 s6, s38, 58255
    s_lshr_b32 s6, s6, 20
    s_mul_i32 s7, s6, 18
    s_sub_u32 s7, s38, s7
    s_mul_i32 s6, s6, 1990656
    s_lshl_b32 s7, s7, 10
    s_add_u32 s6, s6, s7
    s_add_u32 s6, s6, 3477504
    s_lshl_b32 s7, s39, 2
    s_add_u32 s7, s7, 0
    s_mul_i32 s34, s7, 116509
    s_lshr_b32 s34, s34, 20
    s_mul_i32 s35, s34, 9
    s_sub_u32 s35, s7, s35
    s_mul_i32 s34, s34, 497664
    s_mul_i32 s35, s35, 18432
    s_add_u32 s34, s34, s35
    s_add_u32 s48, s6, s34
    s_lshl_b32 s7, s39, 2
    s_add_u32 s7, s7, 1
    s_mul_i32 s34, s7, 116509
    s_lshr_b32 s34, s34, 20
    s_mul_i32 s35, s34, 9
    s_sub_u32 s35, s7, s35
    s_mul_i32 s34, s34, 497664
    s_mul_i32 s35, s35, 18432
    s_add_u32 s34, s34, s35
    s_add_u32 s49, s6, s34
    s_lshl_b32 s7, s39, 2
    s_add_u32 s7, s7, 2
    s_mul_i32 s34, s7, 116509
    s_lshr_b32 s34, s34, 20
    s_mul_i32 s35, s34, 9
    s_sub_u32 s35, s7, s35
    s_mul_i32 s34, s34, 497664
    s_mul_i32 s35, s35, 18432
    s_add_u32 s34, s34, s35
    s_add_u32 s50, s6, s34
    s_lshl_b32 s7, s39, 2
    s_add_u32 s7, s7, 3
    s_mul_i32 s34, s7, 116509
    s_lshr_b32 s34, s34, 20
    s_mul_i32 s35, s34, 9
    s_sub_u32 s35, s7, s35
    s_mul_i32 s34, s34, 497664
    s_mul_i32 s35, s35, 18432
    s_add_u32 s34, s34, s35
    s_add_u32 s51, s6, s34
L_swz_dest_2:
    s_waitcnt vmcnt(4)
    ds_read_b64_tr_b16 v[8:9], v3 offset:0
    ds_read_b64_tr_b16 v[10:11], v4 offset:0
    ds_read_b64_tr_b16 v[12:13], v3 offset:32
    ds_read_b64_tr_b16 v[14:15], v4 offset:32
    ds_read_b64_tr_b16 v[16:17], v3 offset:64
    ds_read_b64_tr_b16 v[18:19], v4 offset:64
    ds_read_b64_tr_b16 v[20:21], v3 offset:96
    ds_read_b64_tr_b16 v[22:23], v4 offset:96
    s_waitcnt lgkmcnt(6)
    buffer_store_dwordx4 v[8:11], v5, s[8:11], s44 offen
    s_waitcnt lgkmcnt(4)
    buffer_store_dwordx4 v[12:15], v5, s[8:11], s45 offen
    s_waitcnt lgkmcnt(2)
    buffer_store_dwordx4 v[16:19], v5, s[8:11], s46 offen
    s_waitcnt lgkmcnt(0)
    buffer_store_dwordx4 v[20:23], v5, s[8:11], s47 offen
    s_waitcnt vmcnt(4)
    ds_read_b64_tr_b16 v[24:25], v3 offset:4096
    ds_read_b64_tr_b16 v[26:27], v4 offset:4096
    ds_read_b64_tr_b16 v[28:29], v3 offset:4128
    ds_read_b64_tr_b16 v[30:31], v4 offset:4128
    ds_read_b64_tr_b16 v[32:33], v3 offset:4160
    ds_read_b64_tr_b16 v[34:35], v4 offset:4160
    ds_read_b64_tr_b16 v[36:37], v3 offset:4192
    ds_read_b64_tr_b16 v[38:39], v4 offset:4192
    s_waitcnt lgkmcnt(6)
    buffer_store_dwordx4 v[24:27], v5, s[8:11], s48 offen
    s_waitcnt lgkmcnt(4)
    buffer_store_dwordx4 v[28:31], v5, s[8:11], s49 offen
    s_waitcnt lgkmcnt(2)
    buffer_store_dwordx4 v[32:35], v5, s[8:11], s50 offen
    s_waitcnt lgkmcnt(0)
    buffer_store_dwordx4 v[36:39], v5, s[8:11], s51 offen
    s_branch L_prep_fin
L_prep_q:
    s_cmp_ge_u32 s2, 732
    s_cbranch_scc1 L_prep_ln
    s_load_dwordx2 s[24:25], s[0:1], 8
    s_load_dwordx2 s[26:27], s[0:1], 16
    s_waitcnt lgkmcnt(0)
    s_cmp_ge_u32 s2, 678
    s_cbranch_scc1 L_prep_o
    s_mov_b32 s12, s24
    s_and_b32 s13, s25, 0xffff
    s_mov_b32 s14, 1990656
    s_mov_b32 s15, 0x20000
    s_sub_u32 s20, s2, 486
    s_lshl_b32 s20, s20, 2
    s_add_u32 s20, s20, s3
    s_mul_i32 s20, s20, 3
    s_mul_i32 s21, s20, 14564
    s_lshr_b32 s21, s21, 20
    s_mul_i32 s22, s21, 72
    s_sub_u32 s22, s20, s22
    s_mul_i32 s21, s21, 36
    v_and_b32 v2, 15, v0
    v_lshrrev_b32 v3, 4, v0
    v_mul_u32_u24 v3, 27648, v3
    v_add_u32 v3, s21, v3
    v_lshlrev_b32 v5, 4, v0
    v_mov_b32 v9, 1073741824
    s_mov_b32 s31, 3456
    s_mov_b32 s32, 6912
    s_mov_b32 s33, 10368
    s_mov_b32 s34, 13824
    s_mov_b32 s35, 17280
    s_mov_b32 s36, 20736
    s_mov_b32 s37, 24192
    s_add_u32 s7, s22, 0
    s_and_b32 s6, s7, 3
    s_lshl_b32 s6, s6, 4
    v_add_u32 v4, s6, v2
    s_lshr_b32 s7, s7, 2
    s_mul_i32 s7, s7, 110592
    v_lshl_add_u32 v6, v4, 1, v3
    v_add_u32 v6, s7, v6
    v_add_u32 v7, 1112, v6
    v_add_u32 v8, 2228, v6
    v_cmp_gt_u32 s[40:41], 18, v4
    v_cmp_gt_u32 s[42:43], 20, v4
    v_cmp_gt_u32 s[44:45], 38, v4
    v_cmp_gt_u32 s[46:47], 56, v4
    s_nop 1
    v_cndmask_b32 v8, v9, v8, s[46:47]
    v_cndmask_b32 v8, v8, v7, s[44:45]
    v_cndmask_b32 v8, v8, v9, s[42:43]
    v_cndmask_b32 v10, v8, v6, s[40:41]
    buffer_load_ushort v16, v10, s[12:15], 0 offen
    buffer_load_ushort v17, v10, s[12:15], s31 offen
    buffer_load_ushort v18, v10, s[12:15], s32 offen
    buffer_load_ushort v19, v10, s[12:15], s33 offen
    buffer_load_ushort v20, v10, s[12:15], s34 offen
    buffer_load_ushort v21, v10, s[12:15], s35 offen
    buffer_load_ushort v22, v10, s[12:15], s36 offen
    buffer_load_ushort v23, v10, s[12:15], s37 offen
    s_add_u32 s7, s22, 1
    s_and_b32 s6, s7, 3
    s_lshl_b32 s6, s6, 4
    v_add_u32 v4, s6, v2
    s_lshr_b32 s7, s7, 2
    s_mul_i32 s7, s7, 110592
    v_lshl_add_u32 v6, v4, 1, v3
    v_add_u32 v6, s7, v6
    v_add_u32 v7, 1112, v6
    v_add_u32 v8, 2228, v6
    v_cmp_gt_u32 s[40:41], 18, v4
    v_cmp_gt_u32 s[42:43], 20, v4
    v_cmp_gt_u32 s[44:45], 38, v4
    v_cmp_gt_u32 s[46:47], 56, v4
    s_nop 1
    v_cndmask_b32 v8, v9, v8, s[46:47]
    v_cndmask_b32 v8, v8, v7, s[44:45]
    v_cndmask_b32 v8, v8, v9, s[42:43]
    v_cndmask_b32 v11, v8, v6, s[40:41]
    buffer_load_ushort v24, v11, s[12:15], 0 offen
    buffer_load_ushort v25, v11, s[12:15], s31 offen
    buffer_load_ushort v26, v11, s[12:15], s32 offen
    buffer_load_ushort v27, v11, s[12:15], s33 offen
    buffer_load_ushort v28, v11, s[12:15], s34 offen
    buffer_load_ushort v29, v11, s[12:15], s35 offen
    buffer_load_ushort v30, v11, s[12:15], s36 offen
    buffer_load_ushort v31, v11, s[12:15], s37 offen
    s_add_u32 s7, s22, 2
    s_and_b32 s6, s7, 3
    s_lshl_b32 s6, s6, 4
    v_add_u32 v4, s6, v2
    s_lshr_b32 s7, s7, 2
    s_mul_i32 s7, s7, 110592
    v_lshl_add_u32 v6, v4, 1, v3
    v_add_u32 v6, s7, v6
    v_add_u32 v7, 1112, v6
    v_add_u32 v8, 2228, v6
    v_cmp_gt_u32 s[40:41], 18, v4
    v_cmp_gt_u32 s[42:43], 20, v4
    v_cmp_gt_u32 s[44:45], 38, v4
    v_cmp_gt_u32 s[46:47], 56, v4
    s_nop 1
    v_cndmask_b32 v8, v9, v8, s[46:47]
    v_cndmask_b32 v8, v8, v7, s[44:45]
    v_cndmask_b32 v8, v8, v9, s[42:43]
    v_cndmask_b32 v12, v8, v6, s[40:41]
    buffer_load_ushort v32, v12, s[12:15], 0 offen
    buffer_load_ushort v33, v12, s[12:15], s31 offen
    buffer_load_ushort v34, v12, s[12:15], s32 offen
    buffer_load_ushort v35, v12, s[12:15], s33 offen
    buffer_load_ushort v36, v12, s[12:15], s34 offen
    buffer_load_ushort v37, v12, s[12:15], s35 offen
    buffer_load_ushort v38, v12, s[12:15], s36 offen
    buffer_load_ushort v39, v12, s[12:15], s37 offen
    s_lshl_b32 s20, s20, 10
    s_add_u32 s20, s20, 0
    s_waitcnt vmcnt(16)
    v_lshl_or_b32 v44, v17, 16, v16
    v_lshl_or_b32 v45, v19, 16, v18
    v_lshl_or_b32 v46, v21, 16, v20
    v_lshl_or_b32 v47, v23, 16, v22
    buffer_store_dwordx4 v[44:47], v5, s[8:11], s20 offen offset:0
    s_waitcnt vmcnt(9)
    v_lshl_or_b32 v48, v25, 16, v24
    v_lshl_or_b32 v49, v27, 16, v26
    v_lshl_or_b32 v50, v29, 16, v28
    v_lshl_or_b32 v51, v31, 16, v30
    buffer_store_dwordx4 v[48:51], v5, s[8:11], s20 offen offset:1024
    s_waitcnt vmcnt(2)
    v_lshl_or_b32 v52, v33, 16, v32
    v_lshl_or_b32 v53, v35, 16, v34
    v_lshl_or_b32 v54, v37, 16, v36
    v_lshl_or_b32 v55, v39, 16, v38
    buffer_store_dwordx4 v[52:55], v5, s[8:11], s20 offen offset:2048
    s_branch L_prep_fin
L_prep_o:
    s_mov_b32 s12, s26
    s_and_b32 s13, s27, 0xffff
    s_mov_b32 s14, 663552
    s_mov_b32 s15, 0x20000
    s_sub_u32 s20, s2, 678
    s_lshl_b32 s20, s20, 2
    s_add_u32 s20, s20, s3
    s_mul_i32 s20, s20, 3
    s_mul_i32 s21, s20, 58255
    s_lshr_b32 s21, s21, 20
    s_mul_i32 s22, s21, 18
    s_sub_u32 s22, s20, s22
    s_lshl_b32 s21, s21, 5
    v_and_b32 v2, 15, v0
    v_lshl_add_u32 v2, v2, 1, s21
    v_lshrrev_b32 v3, 4, v0
    v_lshlrev_b32 v5, 4, v0
    s_movk_i32 s23, 1152
    s_add_u32 s7, s22, 0
    s_lshl_b32 s7, s7, 2
    v_add_u32 v4, s7, v3
    v_mul_u32_u24 v6, 7282, v4
    v_lshrrev_b32 v6, 16, v6
    v_mul_u32_u24 v7, 9, v6
    v_sub_u32 v7, v4, v7
    v_mul_u32_u24 v6, 72, v6
    v_cmp_eq_u32 vcc, 8, v7
    v_lshrrev_b32 v8, 1, v7
    v_mad_u32_u24 v8, v8, 18, v6
    v_and_b32 v7, 1, v7
    v_lshl_add_u32 v8, v7, 3, v8
    v_mad_u32_u24 v8, v8, s23, v2
    v_add_u32 v6, 16, v6
    v_mad_u32_u24 v6, v6, s23, v2
    v_add_u32 v9, 0, v8
    v_add_u32 v10, 0, v6
    v_cndmask_b32 v9, v9, v10, vcc
    buffer_load_ushort v16, v9, s[12:15], 0 offen
    v_add_u32 v9, 1152, v8
    v_add_u32 v10, 1152, v6
    v_cndmask_b32 v9, v9, v10, vcc
    buffer_load_ushort v17, v9, s[12:15], 0 offen
    v_add_u32 v9, 2304, v8
    v_add_u32 v10, 20736, v6
    v_cndmask_b32 v9, v9, v10, vcc
    buffer_load_ushort v18, v9, s[12:15], 0 offen
    v_add_u32 v9, 3456, v8
    v_add_u32 v10, 21888, v6
    v_cndmask_b32 v9, v9, v10, vcc
    buffer_load_ushort v19, v9, s[12:15], 0 offen
    v_add_u32 v9, 4608, v8
    v_add_u32 v10, 41472, v6
    v_cndmask_b32 v9, v9, v10, vcc
    buffer_load_ushort v20, v9, s[12:15], 0 offen
    v_add_u32 v9, 5760, v8
    v_add_u32 v10, 42624, v6
    v_cndmask_b32 v9, v9, v10, vcc
    buffer_load_ushort v21, v9, s[12:15], 0 offen
    v_add_u32 v9, 6912, v8
    v_add_u32 v10, 62208, v6
    v_cndmask_b32 v9, v9, v10, vcc
    buffer_load_ushort v22, v9, s[12:15], 0 offen
    v_add_u32 v9, 8064, v8
    v_add_u32 v10, 63360, v6
    v_cndmask_b32 v9, v9, v10, vcc
    buffer_load_ushort v23, v9, s[12:15], 0 offen
    s_add_u32 s7, s22, 1
    s_lshl_b32 s7, s7, 2
    v_add_u32 v4, s7, v3
    v_mul_u32_u24 v6, 7282, v4
    v_lshrrev_b32 v6, 16, v6
    v_mul_u32_u24 v7, 9, v6
    v_sub_u32 v7, v4, v7
    v_mul_u32_u24 v6, 72, v6
    v_cmp_eq_u32 vcc, 8, v7
    v_lshrrev_b32 v8, 1, v7
    v_mad_u32_u24 v8, v8, 18, v6
    v_and_b32 v7, 1, v7
    v_lshl_add_u32 v8, v7, 3, v8
    v_mad_u32_u24 v8, v8, s23, v2
    v_add_u32 v6, 16, v6
    v_mad_u32_u24 v6, v6, s23, v2
    v_add_u32 v9, 0, v8
    v_add_u32 v10, 0, v6
    v_cndmask_b32 v9, v9, v10, vcc
    buffer_load_ushort v24, v9, s[12:15], 0 offen
    v_add_u32 v9, 1152, v8
    v_add_u32 v10, 1152, v6
    v_cndmask_b32 v9, v9, v10, vcc
    buffer_load_ushort v25, v9, s[12:15], 0 offen
    v_add_u32 v9, 2304, v8
    v_add_u32 v10, 20736, v6
    v_cndmask_b32 v9, v9, v10, vcc
    buffer_load_ushort v26, v9, s[12:15], 0 offen
    v_add_u32 v9, 3456, v8
    v_add_u32 v10, 21888, v6
    v_cndmask_b32 v9, v9, v10, vcc
    buffer_load_ushort v27, v9, s[12:15], 0 offen
    v_add_u32 v9, 4608, v8
    v_add_u32 v10, 41472, v6
    v_cndmask_b32 v9, v9, v10, vcc
    buffer_load_ushort v28, v9, s[12:15], 0 offen
    v_add_u32 v9, 5760, v8
    v_add_u32 v10, 42624, v6
    v_cndmask_b32 v9, v9, v10, vcc
    buffer_load_ushort v29, v9, s[12:15], 0 offen
    v_add_u32 v9, 6912, v8
    v_add_u32 v10, 62208, v6
    v_cndmask_b32 v9, v9, v10, vcc
    buffer_load_ushort v30, v9, s[12:15], 0 offen
    v_add_u32 v9, 8064, v8
    v_add_u32 v10, 63360, v6
    v_cndmask_b32 v9, v9, v10, vcc
    buffer_load_ushort v31, v9, s[12:15], 0 offen
    s_add_u32 s7, s22, 2
    s_lshl_b32 s7, s7, 2
    v_add_u32 v4, s7, v3
    v_mul_u32_u24 v6, 7282, v4
    v_lshrrev_b32 v6, 16, v6
    v_mul_u32_u24 v7, 9, v6
    v_sub_u32 v7, v4, v7
    v_mul_u32_u24 v6, 72, v6
    v_cmp_eq_u32 vcc, 8, v7
    v_lshrrev_b32 v8, 1, v7
    v_mad_u32_u24 v8, v8, 18, v6
    v_and_b32 v7, 1, v7
    v_lshl_add_u32 v8, v7, 3, v8
    v_mad_u32_u24 v8, v8, s23, v2
    v_add_u32 v6, 16, v6
    v_mad_u32_u24 v6, v6, s23, v2
    v_add_u32 v9, 0, v8
    v_add_u32 v10, 0, v6
    v_cndmask_b32 v9, v9, v10, vcc
    buffer_load_ushort v32, v9, s[12:15], 0 offen
    v_add_u32 v9, 1152, v8
    v_add_u32 v10, 1152, v6
    v_cndmask_b32 v9, v9, v10, vcc
    buffer_load_ushort v33, v9, s[12:15], 0 offen
    v_add_u32 v9, 2304, v8
    v_add_u32 v10, 20736, v6
    v_cndmask_b32 v9, v9, v10, vcc
    buffer_load_ushort v34, v9, s[12:15], 0 offen
    v_add_u32 v9, 3456, v8
    v_add_u32 v10, 21888, v6
    v_cndmask_b32 v9, v9, v10, vcc
    buffer_load_ushort v35, v9, s[12:15], 0 offen
    v_add_u32 v9, 4608, v8
    v_add_u32 v10, 41472, v6
    v_cndmask_b32 v9, v9, v10, vcc
    buffer_load_ushort v36, v9, s[12:15], 0 offen
    v_add_u32 v9, 5760, v8
    v_add_u32 v10, 42624, v6
    v_cndmask_b32 v9, v9, v10, vcc
    buffer_load_ushort v37, v9, s[12:15], 0 offen
    v_add_u32 v9, 6912, v8
    v_add_u32 v10, 62208, v6
    v_cndmask_b32 v9, v9, v10, vcc
    buffer_load_ushort v38, v9, s[12:15], 0 offen
    v_add_u32 v9, 8064, v8
    v_add_u32 v10, 63360, v6
    v_cndmask_b32 v9, v9, v10, vcc
    buffer_load_ushort v39, v9, s[12:15], 0 offen
    s_lshl_b32 s20, s20, 10
    s_add_u32 s20, s20, 2359296
    s_waitcnt vmcnt(16)
    v_lshl_or_b32 v44, v17, 16, v16
    v_lshl_or_b32 v45, v19, 16, v18
    v_lshl_or_b32 v46, v21, 16, v20
    v_lshl_or_b32 v47, v23, 16, v22
    buffer_store_dwordx4 v[44:47], v5, s[8:11], s20 offen offset:0
    s_waitcnt vmcnt(9)
    v_lshl_or_b32 v48, v25, 16, v24
    v_lshl_or_b32 v49, v27, 16, v26
    v_lshl_or_b32 v50, v29, 16, v28
    v_lshl_or_b32 v51, v31, 16, v30
    buffer_store_dwordx4 v[48:51], v5, s[8:11], s20 offen offset:1024
    s_waitcnt vmcnt(2)
    v_lshl_or_b32 v52, v33, 16, v32
    v_lshl_or_b32 v53, v35, 16, v34
    v_lshl_or_b32 v54, v37, 16, v36
    v_lshl_or_b32 v55, v39, 16, v38
    buffer_store_dwordx4 v[52:55], v5, s[8:11], s20 offen offset:2048
    s_branch L_prep_fin
L_prep_ln:
    s_load_dwordx2 s[6:7], s[0:1], 0
    s_waitcnt lgkmcnt(0)
    s_mov_b32 s12, s6
    s_and_b32 s13, s7, 0xffff
    s_mov_b32 s14, 2359296
    s_mov_b32 s15, 0x20000
    s_sub_u32 s21, s2, 732
    s_mov_b32 s16, 0xffff0000
    s_lshl_b32 s7, s3, 10
    v_lshl_add_u32 v2, v0, 4, s7
    v_add_u32 v3, 4096, v2
    s_cmp_eq_u32 s3, 0
    s_mov_b32 s17, 1073741824
    s_cmov_b32 s17, 8192
    v_add_u32 v4, s17, v2
    v_and_b32 v8, 7, v0
    v_mul_u32_u24 v8, 1152, v8
    v_lshrrev_b32 v9, 3, v0
    v_lshl_add_u32 v8, v9, 4, v8
    s_lshl_b32 s7, s3, 7
    v_add_u32 v5, s7, v8
    v_add_u32 v6, 512, v5
    s_cmp_eq_u32 s3, 0
    s_mov_b32 s17, 1073741824
    s_cmov_b32 s17, 1024
    v_add_u32 v7, s17, v5
    s_mul_i32 s18, s21, 9216
    buffer_load_dwordx4 v[16:19], v5, s[12:15], s18 offen
    buffer_load_dwordx4 v[20:23], v6, s[12:15], s18 offen
    buffer_load_dwordx4 v[24:27], v7, s[12:15], s18 offen
    s_waitcnt vmcnt(0)
    s_add_u32 s19, s18, 27000832
    buffer_store_dwordx4 v[16:19], v2, s[8:11], s19 offen
    buffer_store_dwordx4 v[20:23], v3, s[8:11], s19 offen
    buffer_store_dwordx4 v[24:27], v4, s[8:11], s19 offen
    s_mov_b32 s17, 0x3f803f80
    v_mov_b32 v8, 0
    v_mov_b32 v9, 0
    v_mov_b32 v10, 0
    v_mov_b32 v11, 0
    v_dot2c_f32_bf16 v8, s17, v16
    v_dot2c_f32_bf16 v9, v16, v16
    v_dot2c_f32_bf16 v10, s17, v17
    v_dot2c_f32_bf16 v11, v17, v17
    v_dot2c_f32_bf16 v8, s17, v18
    v_dot2c_f32_bf16 v9, v18, v18
    v_dot2c_f32_bf16 v10, s17, v19
    v_dot2c_f32_bf16 v11, v19, v19
    v_dot2c_f32_bf16 v8, s17, v20
    v_dot2c_f32_bf16 v9, v20, v20
    v_dot2c_f32_bf16 v10, s17, v21
    v_dot2c_f32_bf16 v11, v21, v21
    v_dot2c_f32_bf16 v8, s17, v22
    v_dot2c_f32_bf16 v9, v22, v22
    v_dot2c_f32_bf16 v10, s17, v23
    v_dot2c_f32_bf16 v11, v23, v23
    v_dot2c_f32_bf16 v8, s17, v24
    v_dot2c_f32_bf16 v9, v24, v24
    v_dot2c_f32_bf16 v10, s17, v25
    v_dot2c_f32_bf16 v11, v25, v25
    v_dot2c_f32_bf16 v8, s17, v26
    v_dot2c_f32_bf16 v9, v26, v26
    v_dot2c_f32_bf16 v10, s17, v27
    v_dot2c_f32_bf16 v11, v27, v27
    s_nop 2
    v_add_f32 v8, v8, v10
    v_add_f32 v9, v9, v11
    s_nop 1
    v_add_f32_dpp v8, v8, v8 row_ror:8 row_mask:0xf bank_mask:0xf
    v_add_f32_dpp v9, v9, v9 row_ror:8 row_mask:0xf bank_mask:0xf
    v_mov_b32 v10, v8
    v_mov_b32 v11, v9
    s_nop 1
    v_permlane32_swap_b32 v10, v8
    v_permlane32_swap_b32 v11, v9
    v_add_f32 v8, v8, v10
    v_add_f32 v9, v9, v11
    v_mov_b32 v10, v8
    v_mov_b32 v11, v9
    s_nop 1
    v_permlane16_swap_b32 v10, v8
    v_permlane16_swap_b32 v11, v9
    v_add_f32 v8, v8, v10
    v_add_f32 v9, v9, v11
    v_and_b32 v12, 7, v0
    v_lshlrev_b32 v12, 3, v12
    s_lshl_b32 s7, s3, 6
    v_add_u32 v13, s7, v12
    ds_write_b64 v13, v[8:9]
    s_waitcnt lgkmcnt(0)
    s_barrier
    ds_read_b64 v[40:41], v12 offset:0
    ds_read_b64 v[42:43], v12 offset:64
    ds_read_b64 v[44:45], v12 offset:128
    ds_read_b64 v[46:47], v12 offset:192
    s_waitcnt lgkmcnt(0)
    v_pk_add_f32 v[40:41], v[40:41], v[42:43]
    v_pk_add_f32 v[44:45], v[44:45], v[46:47]
    v_pk_add_f32 v[8:9], v[40:41], v[44:45]
    v_mul_f32 v8, 0x3ae38e39, v8
    v_mul_f32 v9, 0x3ae38e39, v9
    v_fma_f32 v9, -v8, v8, v9
    v_max_f32 v9, 0, v9
    v_add_f32 v9, 0x3727c5ac, v9
    v_rsq_f32 v10, v9
    s_nop 0
    v_mul_f32 v12, v8, v10
    v_mov_b32 v11, v10
    v_sub_f32 v12, 0, v12
    v_mov_b32 v13, v12
    v_lshlrev_b32 v40, 16, v16
    v_and_b32 v41, s16, v16
    v_lshlrev_b32 v42, 16, v17
    v_and_b32 v43, s16, v17
    v_lshlrev_b32 v44, 16, v18
    v_and_b32 v45, s16, v18
    v_lshlrev_b32 v46, 16, v19
    v_and_b32 v47, s16, v19
    v_pk_fma_f32 v[40:41], v[40:41], v[10:11], v[12:13]
    v_pk_fma_f32 v[42:43], v[42:43], v[10:11], v[12:13]
    v_pk_fma_f32 v[44:45], v[44:45], v[10:11], v[12:13]
    v_pk_fma_f32 v[46:47], v[46:47], v[10:11], v[12:13]
    v_cvt_pk_bf16_f32 v48, v40, v41
    v_cvt_pk_bf16_f32 v49, v42, v43
    v_cvt_pk_bf16_f32 v50, v44, v45
    v_cvt_pk_bf16_f32 v51, v46, v47
    v_lshlrev_b32 v40, 16, v20
    v_and_b32 v41, s16, v20
    v_lshlrev_b32 v42, 16, v21
    v_and_b32 v43, s16, v21
    v_lshlrev_b32 v44, 16, v22
    v_and_b32 v45, s16, v22
    v_lshlrev_b32 v46, 16, v23
    v_and_b32 v47, s16, v23
    v_pk_fma_f32 v[40:41], v[40:41], v[10:11], v[12:13]
    v_pk_fma_f32 v[42:43], v[42:43], v[10:11], v[12:13]
    v_pk_fma_f32 v[44:45], v[44:45], v[10:11], v[12:13]
    v_pk_fma_f32 v[46:47], v[46:47], v[10:11], v[12:13]
    v_cvt_pk_bf16_f32 v52, v40, v41
    v_cvt_pk_bf16_f32 v53, v42, v43
    v_cvt_pk_bf16_f32 v54, v44, v45
    v_cvt_pk_bf16_f32 v55, v46, v47
    v_lshlrev_b32 v40, 16, v24
    v_and_b32 v41, s16, v24
    v_lshlrev_b32 v42, 16, v25
    v_and_b32 v43, s16, v25
    v_lshlrev_b32 v44, 16, v26
    v_and_b32 v45, s16, v26
    v_lshlrev_b32 v46, 16, v27
    v_and_b32 v47, s16, v27
    v_pk_fma_f32 v[40:41], v[40:41], v[10:11], v[12:13]
    v_pk_fma_f32 v[42:43], v[42:43], v[10:11], v[12:13]
    v_pk_fma_f32 v[44:45], v[44:45], v[10:11], v[12:13]
    v_pk_fma_f32 v[46:47], v[46:47], v[10:11], v[12:13]
    v_cvt_pk_bf16_f32 v56, v40, v41
    v_cvt_pk_bf16_f32 v57, v42, v43
    v_cvt_pk_bf16_f32 v58, v44, v45
    v_cvt_pk_bf16_f32 v59, v46, v47
    s_add_u32 s19, s18, 19922944
    buffer_store_dwordx4 v[48:51], v2, s[8:11], s19 offen
    buffer_store_dwordx4 v[52:55], v3, s[8:11], s19 offen
    buffer_store_dwordx4 v[56:59], v4, s[8:11], s19 offen
    s_cmp_ge_u32 s21, 2
    s_cbranch_scc1 L_nopad_3
    v_mov_b32 v60, 0
    v_mov_b32 v61, 0
    v_mov_b32 v62, 0
    v_mov_b32 v63, 0
    s_add_u32 s19, s18, 19904512
    buffer_store_dwordx4 v[60:63], v2, s[8:11], s19 offen
    buffer_store_dwordx4 v[60:63], v3, s[8:11], s19 offen
    buffer_store_dwordx4 v[60:63], v4, s[8:11], s19 offen
L_nopad_3:
L_prep_fin:
L_prep_end:
    s_endpgm
.text
.globl qkv_kernel
.p2align 8
.type qkv_kernel,@function
qkv_kernel:
    s_cmp_ge_u32 s2, 256
    s_cbranch_scc1 L_qkv_end
    s_load_dwordx2 s[4:5], s[0:1], 72
    v_lshrrev_b32 v1, 6, v0
    v_and_b32 v0, 63, v0
    v_readfirstlane_b32 s3, v1
    s_waitcnt lgkmcnt(0)
    s_mov_b32 s8, s4
    s_and_b32 s9, s5, 0xffff
    s_mov_b32 s10, 268435456
    s_mov_b32 s11, 0x20000
    s_lshr_b32 s20, s2, 3
    s_and_b32 s21, s2, 7
    v_bfe_u32 v3, v0, 3, 1
    v_mul_u32_u24 v2, 9216, v3
    v_lshrrev_b32 v3, 4, v0
    v_lshl_add_u32 v2, v3, 7, v2
    v_and_b32 v3, 7, v0
    v_lshl_add_u32 v2, v3, 4, v2
    s_mul_i32 s22, s20, 73728
    s_add_u32 s23, s22, 19904512
    s_mul_i32 s7, s3, 18432
    s_add_u32 s24, s23, s7
    s_add_u32 s24, s24, 18432
    s_lshl_b32 s25, s3, 10
    s_add_u32 m0, s25, 1024
    s_mov_b32 s26, 0
L_qkv_dma_4:
    s_add_u32 s26, s26, 1
    buffer_load_dwordx4 v2, s[8:11], s24 offen lds
    s_add_u32 s24, s24, 512
    s_add_u32 m0, m0, 5120
    s_cmp_lt_u32 s26, 18
    s_cbranch_scc1 L_qkv_dma_4
    s_add_u32 s7, s3, 0
    s_mul_i32 m0, s7, 5120
    s_lshl_b32 s7, s7, 9
    s_add_u32 s7, s7, s23
    buffer_load_dwordx4 v2, s[8:11], s7 offen lds
    s_add_u32 s7, s3, 4
    s_mul_i32 m0, s7, 5120
    s_lshl_b32 s7, s7, 9
    s_add_u32 s7, s7, s23
    buffer_load_dwordx4 v2, s[8:11], s7 offen lds
    s_add_u32 s7, s3, 8
    s_mul_i32 m0, s7, 5120
    s_lshl_b32 s7, s7, 9
    s_add_u32 s7, s7, s23
    buffer_load_dwordx4 v2, s[8:11], s7 offen lds
    s_add_u32 s7, s3, 12
    s_mul_i32 m0, s7, 5120
    s_lshl_b32 s7, s7, 9
    s_add_u32 s7, s7, s23
    buffer_load_dwordx4 v2, s[8:11], s7 offen lds
    s_add_u32 s7, s3, 16
    s_min_u32 s7, s7, 17
    s_mul_i32 m0, s7, 5120
    s_lshl_b32 s7, s7, 9
    s_add_u32 s7, s7, s23
    buffer_load_dwordx4 v2, s[8:11], s7 offen lds
    s_lshl_b32 s27, s21, 2
    s_add_u32 s27, s27, s3
    s_mul_i32 s28, s27, 73728
    v_lshlrev_b32 v4, 4, v0
    v_mov_b32 v5, v4
    buffer_load_dwordx4 a[0:3], v5, s[8:11], s28 offen offset:0
    buffer_load_dwordx4 a[4:7], v5, s[8:11], s28 offen offset:1024
    buffer_load_dwordx4 a[8:11], v5, s[8:11], s28 offen offset:2048
    buffer_load_dwordx4 a[12:15], v5, s[8:11], s28 offen offset:3072
    s_add_u32 s28, s28, 4096
    buffer_load_dwordx4 a[16:19], v5, s[8:11], s28 offen offset:0
    buffer_load_dwordx4 a[20:23], v5, s[8:11], s28 offen offset:1024
    buffer_load_dwordx4 a[24:27], v5, s[8:11], s28 offen offset:2048
    buffer_load_dwordx4 a[28:31], v5, s[8:11], s28 offen offset:3072
    s_add_u32 s28, s28, 4096
    buffer_load_dwordx4 a[32:35], v5, s[8:11], s28 offen offset:0
    buffer_load_dwordx4 a[36:39], v5, s[8:11], s28 offen offset:1024
    buffer_load_dwordx4 a[40:43], v5, s[8:11], s28 offen offset:2048
    buffer_load_dwordx4 a[44:47], v5, s[8:11], s28 offen offset:3072
    s_add_u32 s28, s28, 4096
    buffer_load_dwordx4 a[48:51], v5, s[8:11], s28 offen offset:0
    buffer_load_dwordx4 a[52:55], v5, s[8:11], s28 offen offset:1024
    buffer_load_dwordx4 a[56:59], v5, s[8:11], s28 offen offset:2048
    buffer_load_dwordx4 a[60:63], v5, s[8:11], s28 offen offset:3072
    s_add_u32 s28, s28, 4096
    buffer_load_dwordx4 a[64:67], v5, s[8:11], s28 offen offset:0
    buffer_load_dwordx4 a[68:71], v5, s[8:11], s28 offen offset:1024
    buffer_load_dwordx4 a[72:75], v5, s[8:11], s28 offen offset:2048
    buffer_load_dwordx4 a[76:79], v5, s[8:11], s28 offen offset:3072
    s_add_u32 s28, s28, 4096
    v_accvgpr_write_b32 a96, 0
    v_accvgpr_write_b32 a97, 0
    v_accvgpr_write_b32 a98, 0
    v_accvgpr_write_b32 a99, 0
    v_accvgpr_write_b32 a100, 0
    v_accvgpr_write_b32 a101, 0
    v_accvgpr_write_b32 a102, 0
    v_accvgpr_write_b32 a103, 0
    v_accvgpr_write_b32 a104, 0
    v_accvgpr_write_b32 a105, 0
    v_accvgpr_write_b32 a106, 0
    v_accvgpr_write_b32 a107, 0
    v_accvgpr_write_b32 a108, 0
    v_accvgpr_write_b32 a109, 0
    v_accvgpr_write_b32 a110, 0
    v_accvgpr_write_b32 a111, 0
    v_accvgpr_write_b32 a112, 0
    v_accvgpr_write_b32 a113, 0
    v_accvgpr_write_b32 a114, 0
    v_accvgpr_write_b32 a115, 0
    v_accvgpr_write_b32 a116, 0
    v_accvgpr_write_b32 a117, 0
    v_accvgpr_write_b32 a118, 0
    v_accvgpr_write_b32 a119, 0
    v_accvgpr_write_b32 a120, 0
    v_accvgpr_write_b32 a121, 0
    v_accvgpr_write_b32 a122, 0
    v_accvgpr_write_b32 a123, 0
    v_accvgpr_write_b32 a124, 0
    v_accvgpr_write_b32 a125, 0
    v_accvgpr_write_b32 a126, 0
    v_accvgpr_write_b32 a127, 0
    v_accvgpr_write_b32 a128, 0
    v_accvgpr_write_b32 a129, 0
    v_accvgpr_write_b32 a130, 0
    v_accvgpr_write_b32 a131, 0
    v_accvgpr_write_b32 a132, 0
    v_accvgpr_write_b32 a133, 0
    v_accvgpr_write_b32 a134, 0
    v_accvgpr_write_b32 a135, 0
    v_accvgpr_write_b32 a136, 0
    v_accvgpr_write_b32 a137, 0
    v_accvgpr_write_b32 a138, 0
    v_accvgpr_write_b32 a139, 0
    v_accvgpr_write_b32 a140, 0
    v_accvgpr_write_b32 a141, 0
    v_accvgpr_write_b32 a142, 0
    v_accvgpr_write_b32 a143, 0
    v_accvgpr_write_b32 a144, 0
    v_accvgpr_write_b32 a145, 0
    v_accvgpr_write_b32 a146, 0
    v_accvgpr_write_b32 a147, 0
    v_accvgpr_write_b32 a148, 0
    v_accvgpr_write_b32 a149, 0
    v_accvgpr_write_b32 a150, 0
    v_accvgpr_write_b32 a151, 0
    v_accvgpr_write_b32 a152, 0
    v_accvgpr_write_b32 a153, 0
    v_accvgpr_write_b32 a154, 0
    v_accvgpr_write_b32 a155, 0
    v_accvgpr_write_b32 a156, 0
    v_accvgpr_write_b32 a157, 0
    v_accvgpr_write_b32 a158, 0
    v_accvgpr_write_b32 a159, 0
    v_accvgpr_write_b32 a160, 0
    v_accvgpr_write_b32 a161, 0
    v_accvgpr_write_b32 a162, 0
    v_accvgpr_write_b32 a163, 0
    v_accvgpr_write_b32 a164, 0
    v_accvgpr_write_b32 a165, 0
    v_accvgpr_write_b32 a166, 0
    v_accvgpr_write_b32 a167, 0
    v_accvgpr_write_b32 a168, 0
    v_accvgpr_write_b32 a169, 0
    v_accvgpr_write_b32 a170, 0
    v_accvgpr_write_b32 a171, 0
    s_waitcnt vmcnt(20)
    s_barrier
    v_mov_b32 v6, v4
    ds_read_b128 v[16:19], v6 offset:0
    ds_read_b128 v[20:23], v6 offset:1024
    ds_read_b128 v[24:27], v6 offset:2048
    ds_read_b128 v[28:31], v6 offset:3072
    ds_read_b128 v[32:35], v6 offset:4096
    s_mov_b32 s26, 0
L_qkv_k_5:
    s_waitcnt vmcnt(16) lgkmcnt(0)
    v_mfma_f32_16x16x32_bf16 a[96:99], a[0:3], v[20:23], a[96:99]
    ds_read_b128 v[36:39], v6 offset:5120
    v_mfma_f32_16x16x32_bf16 a[100:103], a[0:3], v[24:27], a[100:103]
    ds_read_b128 v[40:43], v6 offset:6144
    v_mfma_f32_16x16x32_bf16 a[104:107], a[0:3], v[28:31], a[104:107]
    ds_read_b128 v[44:47], v6 offset:7168
    v_mfma_f32_16x16x32_bf16 a[108:111], a[0:3], v[32:35], a[108:111]
    ds_read_b128 v[48:51], v6 offset:8192
    v_mfma_f32_16x16x32_bf16 a[112:115], a[4:7], v[16:19], a[112:115]
    ds_read_b128 v[52:55], v6 offset:9216
    v_mfma_f32_16x16x32_bf16 a[116:119], a[4:7], v[20:23], a[116:119]
    v_mfma_f32_16x16x32_bf16 a[120:123], a[4:7], v[24:27], a[120:123]
    buffer_load_dwordx4 a[80:83], v5, s[8:11], s28 offen offset:0
    v_mfma_f32_16x16x32_bf16 a[124:127], a[4:7], v[28:31], a[124:127]
    v_mfma_f32_16x16x32_bf16 a[128:131], a[4:7], v[32:35], a[128:131]
    v_mfma_f32_16x16x32_bf16 a[132:135], a[8:11], v[16:19], a[132:135]
    buffer_load_dwordx4 a[84:87], v5, s[8:11], s28 offen offset:1024
    v_mfma_f32_16x16x32_bf16 a[136:139], a[8:11], v[20:23], a[136:139]
    v_mfma_f32_16x16x32_bf16 a[140:143], a[8:11], v[24:27], a[140:143]
    v_mfma_f32_16x16x32_bf16 a[144:147], a[8:11], v[28:31], a[144:147]
    buffer_load_dwordx4 a[88:91], v5, s[8:11], s28 offen offset:2048
    v_mfma_f32_16x16x32_bf16 a[148:151], a[8:11], v[32:35], a[148:151]
    v_mfma_f32_16x16x32_bf16 a[152:155], a[12:15], v[16:19], a[152:155]
    v_mfma_f32_16x16x32_bf16 a[156:159], a[12:15], v[20:23], a[156:159]
    buffer_load_dwordx4 a[92:95], v5, s[8:11], s28 offen offset:3072
    v_mfma_f32_16x16x32_bf16 a[160:163], a[12:15], v[24:27], a[160:163]
    s_add_u32 s28, s28, 4096
    v_mfma_f32_16x16x32_bf16 a[164:167], a[12:15], v[28:31], a[164:167]
    s_cmp_eq_u32 s26, 2
    s_cselect_b32 s7, 1073741824, 0
    v_add_u32 v5, s7, v4
    v_mfma_f32_16x16x32_bf16 a[168:171], a[12:15], v[32:35], a[168:171]
    s_waitcnt vmcnt(16) lgkmcnt(0)
    v_mfma_f32_16x16x32_bf16 a[96:99], a[16:19], v[40:43], a[96:99]
    ds_read_b128 v[16:19], v6 offset:10240
    v_mfma_f32_16x16x32_bf16 a[100:103], a[16:19], v[44:47], a[100:103]
    ds_read_b128 v[20:23], v6 offset:11264
    v_mfma_f32_16x16x32_bf16 a[104:107], a[16:19], v[48:51], a[104:107]
    ds_read_b128 v[24:27], v6 offset:12288
    v_mfma_f32_16x16x32_bf16 a[108:111], a[16:19], v[52:55], a[108:111]
    ds_read_b128 v[28:31], v6 offset:13312
    v_mfma_f32_16x16x32_bf16 a[112:115], a[20:23], v[36:39], a[112:115]
    ds_read_b128 v[32:35], v6 offset:14336
    v_mfma_f32_16x16x32_bf16 a[116:119], a[20:23], v[40:43], a[116:119]
    v_mfma_f32_16x16x32_bf16 a[120:123], a[20:23], v[44:47], a[120:123]
    buffer_load_dwordx4 a[0:3], v5, s[8:11], s28 offen offset:0
    v_mfma_f32_16x16x32_bf16 a[124:127], a[20:23], v[48:51], a[124:127]
    v_mfma_f32_16x16x32_bf16 a[128:131], a[20:23], v[52:55], a[128:131]
    v_mfma_f32_16x16x32_bf16 a[132:135], a[24:27], v[36:39], a[132:135]
    buffer_load_dwordx4 a[4:7], v5, s[8:11], s28 offen offset:1024
    v_mfma_f32_16x16x32_bf16 a[136:139], a[24:27], v[40:43], a[136:139]
    v_mfma_f32_16x16x32_bf16 a[140:143], a[24:27], v[44:47], a[140:143]
    v_mfma_f32_16x16x32_bf16 a[144:147], a[24:27], v[48:51], a[144:147]
    buffer_load_dwordx4 a[8:11], v5, s[8:11], s28 offen offset:2048
    v_mfma_f32_16x16x32_bf16 a[148:151], a[24:27], v[52:55], a[148:151]
    v_mfma_f32_16x16x32_bf16 a[152:155], a[28:31], v[36:39], a[152:155]
    v_mfma_f32_16x16x32_bf16 a[156:159], a[28:31], v[40:43], a[156:159]
    buffer_load_dwordx4 a[12:15], v5, s[8:11], s28 offen offset:3072
    v_mfma_f32_16x16x32_bf16 a[160:163], a[28:31], v[44:47], a[160:163]
    s_add_u32 s28, s28, 4096
    v_mfma_f32_16x16x32_bf16 a[164:167], a[28:31], v[48:51], a[164:167]
    v_mfma_f32_16x16x32_bf16 a[168:171], a[28:31], v[52:55], a[168:171]
    s_waitcnt vmcnt(16) lgkmcnt(0)
    v_mfma_f32_16x16x32_bf16 a[96:99], a[32:35], v[20:23], a[96:99]
    ds_read_b128 v[36:39], v6 offset:15360
    v_mfma_f32_16x16x32_bf16 a[100:103], a[32:35], v[24:27], a[100:103]
    ds_read_b128 v[40:43], v6 offset:16384
    v_mfma_f32_16x16x32_bf16 a[104:107], a[32:35], v[28:31], a[104:107]
    ds_read_b128 v[44:47], v6 offset:17408
    v_mfma_f32_16x16x32_bf16 a[108:111], a[32:35], v[32:35], a[108:111]
    ds_read_b128 v[48:51], v6 offset:18432
    v_mfma_f32_16x16x32_bf16 a[112:115], a[36:39], v[16:19], a[112:115]
    ds_read_b128 v[52:55], v6 offset:19456
    v_mfma_f32_16x16x32_bf16 a[116:119], a[36:39], v[20:23], a[116:119]
    v_mfma_f32_16x16x32_bf16 a[120:123], a[36:39], v[24:27], a[120:123]
    buffer_load_dwordx4 a[16:19], v5, s[8:11], s28 offen offset:0
    v_mfma_f32_16x16x32_bf16 a[124:127], a[36:39], v[28:31], a[124:127]
    v_mfma_f32_16x16x32_bf16 a[128:131], a[36:39], v[32:35], a[128:131]
    v_mfma_f32_16x16x32_bf16 a[132:135], a[40:43], v[16:19], a[132:135]
    buffer_load_dwordx4 a[20:23], v5, s[8:11], s28 offen offset:1024
    v_mfma_f32_16x16x32_bf16 a[136:139], a[40:43], v[20:23], a[136:139]
    v_mfma_f32_16x16x32_bf16 a[140:143], a[40:43], v[24:27], a[140:143]
    v_mfma_f32_16x16x32_bf16 a[144:147], a[40:43], v[28:31], a[144:147]
    buffer_load_dwordx4 a[24:27], v5, s[8:11], s28 offen offset:2048
    v_mfma_f32_16x16x32_bf16 a[148:151], a[40:43], v[32:35], a[148:151]
    v_mfma_f32_16x16x32_bf16 a[152:155], a[44:47], v[16:19], a[152:155]
    v_mfma_f32_16x16x32_bf16 a[156:159], a[44:47], v[20:23], a[156:159]
    buffer_load_dwordx4 a[28:31], v5, s[8:11], s28 offen offset:3072
    v_mfma_f32_16x16x32_bf16 a[160:163], a[44:47], v[24:27], a[160:163]
    s_add_u32 s28, s28, 4096
    v_mfma_f32_16x16x32_bf16 a[164:167], a[44:47], v[28:31], a[164:167]
    v_mfma_f32_16x16x32_bf16 a[168:171], a[44:47], v[32:35], a[168:171]
    s_waitcnt vmcnt(16) lgkmcnt(0)
    v_mfma_f32_16x16x32_bf16 a[96:99], a[48:51], v[40:43], a[96:99]
    ds_read_b128 v[16:19], v6 offset:20480
    v_mfma_f32_16x16x32_bf16 a[100:103], a[48:51], v[44:47], a[100:103]
    ds_read_b128 v[20:23], v6 offset:21504
    v_mfma_f32_16x16x32_bf16 a[104:107], a[48:51], v[48:51], a[104:107]
    ds_read_b128 v[24:27], v6 offset:22528
    v_mfma_f32_16x16x32_bf16 a[108:111], a[48:51], v[52:55], a[108:111]
    ds_read_b128 v[28:31], v6 offset:23552
    v_mfma_f32_16x16x32_bf16 a[112:115], a[52:55], v[36:39], a[112:115]
    ds_read_b128 v[32:35], v6 offset:24576
    v_mfma_f32_16x16x32_bf16 a[116:119], a[52:55], v[40:43], a[116:119]
    v_mfma_f32_16x16x32_bf16 a[120:123], a[52:55], v[44:47], a[120:123]
    buffer_load_dwordx4 a[32:35], v5, s[8:11], s28 offen offset:0
    v_mfma_f32_16x16x32_bf16 a[124:127], a[52:55], v[48:51], a[124:127]
    v_mfma_f32_16x16x32_bf16 a[128:131], a[52:55], v[52:55], a[128:131]
    v_mfma_f32_16x16x32_bf16 a[132:135], a[56:59], v[36:39], a[132:135]
    buffer_load_dwordx4 a[36:39], v5, s[8:11], s28 offen offset:1024
    v_mfma_f32_16x16x32_bf16 a[136:139], a[56:59], v[40:43], a[136:139]
    v_mfma_f32_16x16x32_bf16 a[140:143], a[56:59], v[44:47], a[140:143]
    v_mfma_f32_16x16x32_bf16 a[144:147], a[56:59], v[48:51], a[144:147]
    buffer_load_dwordx4 a[40:43], v5, s[8:11], s28 offen offset:2048
    v_mfma_f32_16x16x32_bf16 a[148:151], a[56:59], v[52:55], a[148:151]
    v_mfma_f32_16x16x32_bf16 a[152:155], a[60:63], v[36:39], a[152:155]
    v_mfma_f32_16x16x32_bf16 a[156:159], a[60:63], v[40:43], a[156:159]
    buffer_load_dwordx4 a[44:47], v5, s[8:11], s28 offen offset:3072
    v_mfma_f32_16x16x32_bf16 a[160:163], a[60:63], v[44:47], a[160:163]
    s_add_u32 s28, s28, 4096
    v_mfma_f32_16x16x32_bf16 a[164:167], a[60:63], v[48:51], a[164:167]
    v_mfma_f32_16x16x32_bf16 a[168:171], a[60:63], v[52:55], a[168:171]
    s_waitcnt vmcnt(16) lgkmcnt(0)
    v_mfma_f32_16x16x32_bf16 a[96:99], a[64:67], v[20:23], a[96:99]
    ds_read_b128 v[36:39], v6 offset:25600
    v_mfma_f32_16x16x32_bf16 a[100:103], a[64:67], v[24:27], a[100:103]
    ds_read_b128 v[40:43], v6 offset:26624
    v_mfma_f32_16x16x32_bf16 a[104:107], a[64:67], v[28:31], a[104:107]
    ds_read_b128 v[44:47], v6 offset:27648
    v_mfma_f32_16x16x32_bf16 a[108:111], a[64:67], v[32:35], a[108:111]
    ds_read_b128 v[48:51], v6 offset:28672
    v_mfma_f32_16x16x32_bf16 a[112:115], a[68:71], v[16:19], a[112:115]
    ds_read_b128 v[52:55], v6 offset:29696
    v_mfma_f32_16x16x32_bf16 a[116:119], a[68:71], v[20:23], a[116:119]
    v_mfma_f32_16x16x32_bf16 a[120:123], a[68:71], v[24:27], a[120:123]
    buffer_load_dwordx4 a[48:51], v5, s[8:11], s28 offen offset:0
    v_mfma_f32_16x16x32_bf16 a[124:127], a[68:71], v[28:31], a[124:127]
    v_mfma_f32_16x16x32_bf16 a[128:131], a[68:71], v[32:35], a[128:131]
    v_mfma_f32_16x16x32_bf16 a[132:135], a[72:75], v[16:19], a[132:135]
    buffer_load_dwordx4 a[52:55], v5, s[8:11], s28 offen offset:1024
    v_mfma_f32_16x16x32_bf16 a[136:139], a[72:75], v[20:23], a[136:139]
    v_mfma_f32_16x16x32_bf16 a[140:143], a[72:75], v[24:27], a[140:143]
    v_mfma_f32_16x16x32_bf16 a[144:147], a[72:75], v[28:31], a[144:147]
    buffer_load_dwordx4 a[56:59], v5, s[8:11], s28 offen offset:2048
    v_mfma_f32_16x16x32_bf16 a[148:151], a[72:75], v[32:35], a[148:151]
    v_mfma_f32_16x16x32_bf16 a[152:155], a[76:79], v[16:19], a[152:155]
    v_mfma_f32_16x16x32_bf16 a[156:159], a[76:79], v[20:23], a[156:159]
    buffer_load_dwordx4 a[60:63], v5, s[8:11], s28 offen offset:3072
    v_mfma_f32_16x16x32_bf16 a[160:163], a[76:79], v[24:27], a[160:163]
    s_add_u32 s28, s28, 4096
    v_mfma_f32_16x16x32_bf16 a[164:167], a[76:79], v[28:31], a[164:167]
    v_mfma_f32_16x16x32_bf16 a[168:171], a[76:79], v[32:35], a[168:171]
    s_waitcnt vmcnt(16) lgkmcnt(0)
    v_mfma_f32_16x16x32_bf16 a[96:99], a[80:83], v[40:43], a[96:99]
    ds_read_b128 v[16:19], v6 offset:30720
    v_mfma_f32_16x16x32_bf16 a[100:103], a[80:83], v[44:47], a[100:103]
    ds_read_b128 v[20:23], v6 offset:31744
    v_mfma_f32_16x16x32_bf16 a[104:107], a[80:83], v[48:51], a[104:107]
    ds_read_b128 v[24:27], v6 offset:32768
    v_mfma_f32_16x16x32_bf16 a[108:111], a[80:83], v[52:55], a[108:111]
    ds_read_b128 v[28:31], v6 offset:33792
    v_mfma_f32_16x16x32_bf16 a[112:115], a[84:87], v[36:39], a[112:115]
    ds_read_b128 v[32:35], v6 offset:34816
    v_mfma_f32_16x16x32_bf16 a[116:119], a[84:87], v[40:43], a[116:119]
    v_mfma_f32_16x16x32_bf16 a[120:123], a[84:87], v[44:47], a[120:123]
    buffer_load_dwordx4 a[64:67], v5, s[8:11], s28 offen offset:0
    v_mfma_f32_16x16x32_bf16 a[124:127], a[84:87], v[48:51], a[124:127]
    v_mfma_f32_16x16x32_bf16 a[128:131], a[84:87], v[52:55], a[128:131]
    v_mfma_f32_16x16x32_bf16 a[132:135], a[88:91], v[36:39], a[132:135]
    buffer_load_dwordx4 a[68:71], v5, s[8:11], s28 offen offset:1024
    v_mfma_f32_16x16x32_bf16 a[136:139], a[88:91], v[40:43], a[136:139]
    v_mfma_f32_16x16x32_bf16 a[140:143], a[88:91], v[44:47], a[140:143]
    v_mfma_f32_16x16x32_bf16 a[144:147], a[88:91], v[48:51], a[144:147]
    buffer_load_dwordx4 a[72:75], v5, s[8:11], s28 offen offset:2048
    v_mfma_f32_16x16x32_bf16 a[148:151], a[88:91], v[52:55], a[148:151]
    v_mfma_f32_16x16x32_bf16 a[152:155], a[92:95], v[36:39], a[152:155]
    v_mfma_f32_16x16x32_bf16 a[156:159], a[92:95], v[40:43], a[156:159]
    buffer_load_dwordx4 a[76:79], v5, s[8:11], s28 offen offset:3072
    v_mfma_f32_16x16x32_bf16 a[160:163], a[92:95], v[44:47], a[160:163]
    s_add_u32 s28, s28, 4096
    v_mfma_f32_16x16x32_bf16 a[164:167], a[92:95], v[48:51], a[164:167]
    v_mfma_f32_16x16x32_bf16 a[168:171], a[92:95], v[52:55], a[168:171]
    v_add_u32 v6, 30720, v6
    s_add_u32 s26, s26, 1
    s_cmp_lt_u32 s26, 3
    s_cbranch_scc1 L_qkv_k_5
    s_mul_i32 s24, s3, 21760
    v_and_b32 v7, 15, v0
    v_mul_u32_u24 v7, 272, v7
    v_lshrrev_b32 v8, 4, v0
    v_lshl_add_u32 v7, v8, 4, v7
    v_add_u32 v7, s24, v7
    v_mul_u32_u24 v8, 272, v0
    v_add_u32 v8, 544, v8
    v_add_u32 v8, s24, v8
    s_waitcnt lgkmcnt(0)
    s_barrier
    ds_write_b128 v7, a[96:99] offset:4352
    ds_write_b128 v7, a[100:103] offset:8704
    ds_write_b128 v7, a[104:107] offset:13056
    ds_write_b128 v7, a[108:111] offset:17408
    ds_write_b128 v7, a[112:115] offset:64
    ds_write_b128 v7, a[116:119] offset:4416
    ds_write_b128 v7, a[120:123] offset:8768
    ds_write_b128 v7, a[124:127] offset:13120
    ds_write_b128 v7, a[128:131] offset:17472
    ds_write_b128 v7, a[132:135] offset:128
    ds_write_b128 v7, a[136:139] offset:4480
    ds_write_b128 v7, a[140:143] offset:8832
    ds_write_b128 v7, a[144:147] offset:13184
    ds_write_b128 v7, a[148:151] offset:17536
    ds_write_b128 v7, a[152:155] offset:192
    ds_write_b128 v7, a[156:159] offset:4544
    ds_write_b128 v7, a[160:163] offset:8896
    ds_write_b128 v7, a[164:167] offset:13248
    ds_write_b128 v7, a[168:171] offset:17600
    s_waitcnt lgkmcnt(0)
    ds_read_b128 v[16:19], v8 offset:3808
    ds_read_b128 v[20:23], v8 offset:3824
    ds_read_b128 v[24:27], v8 offset:3840
    ds_read_b128 v[28:31], v8 offset:3856
    ds_read_b64 v[32:33], v8 offset:3872
    ds_read_b128 v[36:39], v8 offset:3888
    ds_read_b128 v[40:43], v8 offset:3904
    ds_read_b128 v[44:47], v8 offset:3920
    ds_read_b128 v[48:51], v8 offset:3936
    ds_read_b128 v[52:55], v8 offset:3952
    ds_read_b128 v[56:59], v8 offset:3344
    ds_read_b128 v[60:63], v8 offset:3360
    ds_read_b128 v[64:67], v8 offset:3376
    ds_read_b128 v[68:71], v8 offset:3392
    ds_read_b128 v[72:75], v8 offset:3408
    s_waitcnt lgkmcnt(0)
    ds_read_b128 v[76:79], v8 offset:2800
    ds_read_b128 v[80:83], v8 offset:2816
    ds_read_b128 v[84:87], v8 offset:2832
    ds_read_b128 v[88:91], v8 offset:2848
    ds_read_b128 v[92:95], v8 offset:2864
    ds_read_b128 v[96:99], v8 offset:2256
    ds_read_b128 v[100:103], v8 offset:2272
    ds_read_b128 v[104:107], v8 offset:2288
    ds_read_b128 v[108:111], v8 offset:2304
    ds_read_b128 v[112:115], v8 offset:2320
    v_pk_mul_f32 v[204:205], v[16:17], v[36:37]
    v_pk_mul_f32 v[206:207], v[16:17], v[56:57]
    v_pk_fma_f32 v[204:205], v[18:19], v[38:39], v[204:205]
    v_pk_fma_f32 v[206:207], v[18:19], v[58:59], v[206:207]
    v_pk_fma_f32 v[204:205], v[20:21], v[40:41], v[204:205]
    v_pk_fma_f32 v[206:207], v[20:21], v[60:61], v[206:207]
    v_pk_fma_f32 v[204:205], v[22:23], v[42:43], v[204:205]
    v_pk_fma_f32 v[206:207], v[22:23], v[62:63], v[206:207]
    v_pk_fma_f32 v[204:205], v[24:25], v[44:45], v[204:205]
    v_pk_fma_f32 v[206:207], v[24:25], v[64:65], v[206:207]
    v_pk_fma_f32 v[204:205], v[26:27], v[46:47], v[204:205]
    v_pk_fma_f32 v[206:207], v[26:27], v[66:67], v[206:207]
    v_pk_fma_f32 v[204:205], v[28:29], v[48:49], v[204:205]
    v_pk_fma_f32 v[206:207], v[28:29], v[68:69], v[206:207]
    v_pk_fma_f32 v[204:205], v[30:31], v[50:51], v[204:205]
    v_pk_fma_f32 v[206:207], v[30:31], v[70:71], v[206:207]
    v_pk_fma_f32 v[204:205], v[32:33], v[52:53], v[204:205]
    v_pk_fma_f32 v[206:207], v[32:33], v[72:73], v[206:207]
    v_add_f32 v196, v204, v205
    v_add_f32 v197, v206, v207
    s_waitcnt lgkmcnt(0)
    ds_read_b128 v[116:119], v8 offset:1712
    ds_read_b128 v[120:123], v8 offset:1728
    ds_read_b128 v[124:127], v8 offset:1744
    ds_read_b128 v[128:131], v8 offset:1760
    ds_read_b128 v[132:135], v8 offset:1776
    ds_read_b128 v[136:139], v8 offset:1168
    ds_read_b128 v[140:143], v8 offset:1184
    ds_read_b128 v[144:147], v8 offset:1200
    ds_read_b128 v[148:151], v8 offset:1216
    ds_read_b128 v[152:155], v8 offset:1232
    v_pk_mul_f32 v[204:205], v[16:17], v[76:77]
    v_pk_mul_f32 v[206:207], v[16:17], v[96:97]
    v_pk_fma_f32 v[204:205], v[18:19], v[78:79], v[204:205]
    v_pk_fma_f32 v[206:207], v[18:19], v[98:99], v[206:207]
    v_pk_fma_f32 v[204:205], v[20:21], v[80:81], v[204:205]
    v_pk_fma_f32 v[206:207], v[20:21], v[100:101], v[206:207]
    v_pk_fma_f32 v[204:205], v[22:23], v[82:83], v[204:205]
    v_pk_fma_f32 v[206:207], v[22:23], v[102:103], v[206:207]
    v_pk_fma_f32 v[204:205], v[24:25], v[84:85], v[204:205]
    v_pk_fma_f32 v[206:207], v[24:25], v[104:105], v[206:207]
    v_pk_fma_f32 v[204:205], v[26:27], v[86:87], v[204:205]
    v_pk_fma_f32 v[206:207], v[26:27], v[106:107], v[206:207]
    v_pk_fma_f32 v[204:205], v[28:29], v[88:89], v[204:205]
    v_pk_fma_f32 v[206:207], v[28:29], v[108:109], v[206:207]
    v_pk_fma_f32 v[204:205], v[30:31], v[90:91], v[204:205]
    v_pk_fma_f32 v[206:207], v[30:31], v[110:111], v[206:207]
    v_pk_fma_f32 v[204:205], v[32:33], v[92:93], v[204:205]
    v_pk_fma_f32 v[206:207], v[32:33], v[112:113], v[206:207]
    v_add_f32 v198, v204, v205
    v_add_f32 v199, v206, v207
    s_waitcnt lgkmcnt(0)
    ds_read_b128 v[156:159], v8 offset:624
    ds_read_b128 v[160:163], v8 offset:640
    ds_read_b128 v[164:167], v8 offset:656
    ds_read_b128 v[168:171], v8 offset:672
    ds_read_b128 v[172:175], v8 offset:688
    ds_read_b128 v[176:179], v8 offset:80
    ds_read_b128 v[180:183], v8 offset:96
    ds_read_b128 v[184:187], v8 offset:112
    ds_read_b128 v[188:191], v8 offset:128
    ds_read_b128 v[192:195], v8 offset:144
    v_pk_mul_f32 v[204:205], v[16:17], v[116:117]
    v_pk_mul_f32 v[206:207], v[16:17], v[136:137]
    v_pk_fma_f32 v[204:205], v[18:19], v[118:119], v[204:205]
    v_pk_fma_f32 v[206:207], v[18:19], v[138:139], v[206:207]
    v_pk_fma_f32 v[204:205], v[20:21], v[120:121], v[204:205]
    v_pk_fma_f32 v[206:207], v[20:21], v[140:141], v[206:207]
    v_pk_fma_f32 v[204:205], v[22:23], v[122:123], v[204:205]
    v_pk_fma_f32 v[206:207], v[22:23], v[142:143], v[206:207]
    v_pk_fma_f32 v[204:205], v[24:25], v[124:125], v[204:205]
    v_pk_fma_f32 v[206:207], v[24:25], v[144:145], v[206:207]
    v_pk_fma_f32 v[204:205], v[26:27], v[126:127], v[204:205]
    v_pk_fma_f32 v[206:207], v[26:27], v[146:147], v[206:207]
    v_pk_fma_f32 v[204:205], v[28:29], v[128:129], v[204:205]
    v_pk_fma_f32 v[206:207], v[28:29], v[148:149], v[206:207]
    v_pk_fma_f32 v[204:205], v[30:31], v[130:131], v[204:205]
    v_pk_fma_f32 v[206:207], v[30:31], v[150:151], v[206:207]
    v_pk_fma_f32 v[204:205], v[32:33], v[132:133], v[204:205]
    v_pk_fma_f32 v[206:207], v[32:33], v[152:153], v[206:207]
    v_add_f32 v200, v204, v205
    v_add_f32 v201, v206, v207
    s_waitcnt lgkmcnt(0)
    v_pk_mul_f32 v[204:205], v[16:17], v[156:157]
    v_pk_mul_f32 v[206:207], v[16:17], v[176:177]
    v_pk_fma_f32 v[204:205], v[18:19], v[158:159], v[204:205]
    v_pk_fma_f32 v[206:207], v[18:19], v[178:179], v[206:207]
    v_pk_fma_f32 v[204:205], v[20:21], v[160:161], v[204:205]
    v_pk_fma_f32 v[206:207], v[20:21], v[180:181], v[206:207]
    v_pk_fma_f32 v[204:205], v[22:23], v[162:163], v[204:205]
    v_pk_fma_f32 v[206:207], v[22:23], v[182:183], v[206:207]
    v_pk_fma_f32 v[204:205], v[24:25], v[164:165], v[204:205]
    v_pk_fma_f32 v[206:207], v[24:25], v[184:185], v[206:207]
    v_pk_fma_f32 v[204:205], v[26:27], v[166:167], v[204:205]
    v_pk_fma_f32 v[206:207], v[26:27], v[186:187], v[206:207]
    v_pk_fma_f32 v[204:205], v[28:29], v[168:169], v[204:205]
    v_pk_fma_f32 v[206:207], v[28:29], v[188:189], v[206:207]
    v_pk_fma_f32 v[204:205], v[30:31], v[170:171], v[204:205]
    v_pk_fma_f32 v[206:207], v[30:31], v[190:191], v[206:207]
    v_pk_fma_f32 v[204:205], v[32:33], v[172:173], v[204:205]
    v_pk_fma_f32 v[206:207], v[32:33], v[192:193], v[206:207]
    v_add_f32 v202, v204, v205
    v_add_f32 v203, v206, v207
    ds_read_b128 v[36:39], v8 offset:3968
    ds_read_b128 v[40:43], v8 offset:3984
    ds_read_b128 v[44:47], v8 offset:4000
    ds_read_b128 v[48:51], v8 offset:4016
    ds_read_b128 v[56:59], v8 offset:3424
    ds_read_b128 v[60:63], v8 offset:3440
    ds_read_b128 v[64:67], v8 offset:3456
    ds_read_b128 v[68:71], v8 offset:3472
    ds_read_b128 v[76:79], v8 offset:2880
    ds_read_b128 v[80:83], v8 offset:2896
    ds_read_b128 v[84:87], v8 offset:2912
    ds_read_b128 v[88:91], v8 offset:2928
    s_cmp_lg_u32 s20, 0
    s_cbranch_scc1 L_qkv_nomask_6
    v_mov_b32 v9, 0xf149f2ca
    v_cmp_le_u32 vcc, 2, v0
    s_nop 1
    v_cndmask_b32 v197, v9, v197, vcc
    v_cmp_le_u32 vcc, 4, v0
    s_nop 1
    v_cndmask_b32 v198, v9, v198, vcc
    v_cmp_le_u32 vcc, 6, v0
    s_nop 1
    v_cndmask_b32 v199, v9, v199, vcc
    v_cmp_le_u32 vcc, 8, v0
    s_nop 1
    v_cndmask_b32 v200, v9, v200, vcc
    v_cmp_le_u32 vcc, 10, v0
    s_nop 1
    v_cndmask_b32 v201, v9, v201, vcc
    v_cmp_le_u32 vcc, 12, v0
    s_nop 1
    v_cndmask_b32 v202, v9, v202, vcc
    v_cmp_le_u32 vcc, 14, v0
    s_nop 1
    v_cndmask_b32 v203, v9, v203, vcc
L_qkv_nomask_6:
    v_max3_f32 v9, v196, v197, v198
    v_max3_f32 v10, v199, v200, v201
    v_max3_f32 v9, v9, v202, v203
    s_mov_b32 s7, 0x3eae1a93
    v_max_f32 v9, v9, v10
    v_sub_f32 v196, v196, v9
    v_sub_f32 v197, v197, v9
    v_sub_f32 v198, v198, v9
    v_sub_f32 v199, v199, v9
    v_sub_f32 v200, v200, v9
    v_sub_f32 v201, v201, v9
    v_sub_f32 v202, v202, v9
    v_sub_f32 v203, v203, v9
    v_mul_f32 v196, s7, v196
    v_mul_f32 v197, s7, v197
    v_mul_f32 v198, s7, v198
    v_mul_f32 v199, s7, v199
    v_mul_f32 v200, s7, v200
    v_mul_f32 v201, s7, v201
    v_mul_f32 v202, s7, v202
    v_mul_f32 v203, s7, v203
    v_exp_f32 v196, v196
    v_exp_f32 v197, v197
    v_exp_f32 v198, v198
    v_exp_f32 v199, v199
    v_exp_f32 v200, v200
    v_exp_f32 v201, v201
    v_exp_f32 v202, v202
    v_exp_f32 v203, v203
    v_add_f32 v9, v196, v197
    v_add_f32 v10, v198, v199
    v_add_f32 v11, v200, v201
    v_add_f32 v12, v202, v203
    v_add_f32 v9, v9, v10
    v_add_f32 v11, v11, v12
    v_add_f32 v9, v9, v11
    v_rcp_f32 v10, v9
    s_waitcnt lgkmcnt(8)
    ds_read_b128 v[96:99], v8 offset:2336
    ds_read_b128 v[100:103], v8 offset:2352
    ds_read_b128 v[104:107], v8 offset:2368
    ds_read_b128 v[108:111], v8 offset:2384
    v_pk_mul_f32 v[208:209], v[196:197], v[54:55] op_sel:[0,0] op_sel_hi:[0,1]
    v_pk_mul_f32 v[210:211], v[196:197], v[36:37] op_sel:[0,0] op_sel_hi:[0,1]
    v_pk_mul_f32 v[212:213], v[196:197], v[38:39] op_sel:[0,0] op_sel_hi:[0,1]
    v_pk_mul_f32 v[214:215], v[196:197], v[40:41] op_sel:[0,0] op_sel_hi:[0,1]
    v_pk_mul_f32 v[216:217], v[196:197], v[42:43] op_sel:[0,0] op_sel_hi:[0,1]
    v_pk_mul_f32 v[218:219], v[196:197], v[44:45] op_sel:[0,0] op_sel_hi:[0,1]
    v_pk_mul_f32 v[220:221], v[196:197], v[46:47] op_sel:[0,0] op_sel_hi:[0,1]
    v_pk_mul_f32 v[222:223], v[196:197], v[48:49] op_sel:[0,0] op_sel_hi:[0,1]
    v_pk_mul_f32 v[224:225], v[196:197], v[50:51] op_sel:[0,0] op_sel_hi:[0,1]
    s_waitcnt lgkmcnt(8)
    ds_read_b128 v[116:119], v8 offset:1792
    ds_read_b128 v[120:123], v8 offset:1808
    ds_read_b128 v[124:127], v8 offset:1824
    ds_read_b128 v[128:131], v8 offset:1840
    v_pk_fma_f32 v[208:209], v[196:197], v[74:75], v[208:209] op_sel:[1,0,0] op_sel_hi:[1,1,1]
    v_pk_fma_f32 v[210:211], v[196:197], v[56:57], v[210:211] op_sel:[1,0,0] op_sel_hi:[1,1,1]
    v_pk_fma_f32 v[212:213], v[196:197], v[58:59], v[212:213] op_sel:[1,0,0] op_sel_hi:[1,1,1]
    v_pk_fma_f32 v[214:215], v[196:197], v[60:61], v[214:215] op_sel:[1,0,0] op_sel_hi:[1,1,1]
    v_pk_fma_f32 v[216:217], v[196:197], v[62:63], v[216:217] op_sel:[1,0,0] op_sel_hi:[1,1,1]
    v_pk_fma_f32 v[218:219], v[196:197], v[64:65], v[218:219] op_sel:[1,0,0] op_sel_hi:[1,1,1]
    v_pk_fma_f32 v[220:221], v[196:197], v[66:67], v[220:221] op_sel:[1,0,0] op_sel_hi:[1,1,1]
    v_pk_fma_f32 v[222:223], v[196:197], v[68:69], v[222:223] op_sel:[1,0,0] op_sel_hi:[1,1,1]
    v_pk_fma_f32 v[224:225], v[196:197], v[70:71], v[224:225] op_sel:[1,0,0] op_sel_hi:[1,1,1]
    s_waitcnt lgkmcnt(8)
    ds_read_b128 v[136:139], v8 offset:1248
    ds_read_b128 v[140:143], v8 offset:1264
    ds_read_b128 v[144:147], v8 offset:1280
    ds_read_b128 v[148:151], v8 offset:1296
    v_pk_fma_f32 v[208:209], v[198:199], v[94:95], v[208:209] op_sel:[0,0,0] op_sel_hi:[0,1,1]
    v_pk_fma_f32 v[210:211], v[198:199], v[76:77], v[210:211] op_sel:[0,0,0] op_sel_hi:[0,1,1]
    v_pk_fma_f32 v[212:213], v[198:199], v[78:79], v[212:213] op_sel:[0,0,0] op_sel_hi:[0,1,1]
    v_pk_fma_f32 v[214:215], v[198:199], v[80:81], v[214:215] op_sel:[0,0,0] op_sel_hi:[0,1,1]
    v_pk_fma_f32 v[216:217], v[198:199], v[82:83], v[216:217] op_sel:[0,0,0] op_sel_hi:[0,1,1]
    v_pk_fma_f32 v[218:219], v[198:199], v[84:85], v[218:219] op_sel:[0,0,0] op_sel_hi:[0,1,1]
    v_pk_fma_f32 v[220:221], v[198:199], v[86:87], v[220:221] op_sel:[0,0,0] op_sel_hi:[0,1,1]
    v_pk_fma_f32 v[222:223], v[198:199], v[88:89], v[222:223] op_sel:[0,0,0] op_sel_hi:[0,1,1]
    v_pk_fma_f32 v[224:225], v[198:199], v[90:91], v[224:225] op_sel:[0,0,0] op_sel_hi:[0,1,1]
    s_waitcnt lgkmcnt(8)
    ds_read_b128 v[156:159], v8 offset:704
    ds_read_b128 v[160:163], v8 offset:720
    ds_read_b128 v[164:167], v8 offset:736
    ds_read_b128 v[168:171], v8 offset:752
    v_pk_fma_f32 v[208:209], v[198:199], v[114:115], v[208:209] op_sel:[1,0,0] op_sel_hi:[1,1,1]
    v_pk_fma_f32 v[210:211], v[198:199], v[96:97], v[210:211] op_sel:[1,0,0] op_sel_hi:[1,1,1]
    v_pk_fma_f32 v[212:213], v[198:199], v[98:99], v[212:213] op_sel:[1,0,0] op_sel_hi:[1,1,1]
    v_pk_fma_f32 v[214:215], v[198:199], v[100:101], v[214:215] op_sel:[1,0,0] op_sel_hi:[1,1,1]
    v_pk_fma_f32 v[216:217], v[198:199], v[102:103], v[216:217] op_sel:[1,0,0] op_sel_hi:[1,1,1]
    v_pk_fma_f32 v[218:219], v[198:199], v[104:105], v[218:219] op_sel:[1,0,0] op_sel_hi:[1,1,1]
    v_pk_fma_f32 v[220:221], v[198:199], v[106:107], v[220:221] op_sel:[1,0,0] op_sel_hi:[1,1,1]
    v_pk_fma_f32 v[222:223], v[198:199], v[108:109], v[222:223] op_sel:[1,0,0] op_sel_hi:[1,1,1]
    v_pk_fma_f32 v[224:225], v[198:199], v[110:111], v[224:225] op_sel:[1,0,0] op_sel_hi:[1,1,1]
    s_waitcnt lgkmcnt(8)
    ds_read_b128 v[176:179], v8 offset:160
    ds_read_b128 v[180:183], v8 offset:176
    ds_read_b128 v[184:187], v8 offset:192
    ds_read_b128 v[188:191], v8 offset:208
    v_pk_fma_f32 v[208:209], v[200:201], v[134:135], v[208:209] op_sel:[0,0,0] op_sel_hi:[0,1,1]
    v_pk_fma_f32 v[210:211], v[200:201], v[116:117], v[210:211] op_sel:[0,0,0] op_sel_hi:[0,1,1]
    v_pk_fma_f32 v[212:213], v[200:201], v[118:119], v[212:213] op_sel:[0,0,0] op_sel_hi:[0,1,1]
    v_pk_fma_f32 v[214:215], v[200:201], v[120:121], v[214:215] op_sel:[0,0,0] op_sel_hi:[0,1,1]
    v_pk_fma_f32 v[216:217], v[200:201], v[122:123], v[216:217] op_sel:[0,0,0] op_sel_hi:[0,1,1]
    v_pk_fma_f32 v[218:219], v[200:201], v[124:125], v[218:219] op_sel:[0,0,0] op_sel_hi:[0,1,1]
    v_pk_fma_f32 v[220:221], v[200:201], v[126:127], v[220:221] op_sel:[0,0,0] op_sel_hi:[0,1,1]
    v_pk_fma_f32 v[222:223], v[200:201], v[128:129], v[222:223] op_sel:[0,0,0] op_sel_hi:[0,1,1]
    v_pk_fma_f32 v[224:225], v[200:201], v[130:131], v[224:225] op_sel:[0,0,0] op_sel_hi:[0,1,1]
    s_waitcnt lgkmcnt(8)
    v_pk_fma_f32 v[208:209], v[200:201], v[154:155], v[208:209] op_sel:[1,0,0] op_sel_hi:[1,1,1]
    v_pk_fma_f32 v[210:211], v[200:201], v[136:137], v[210:211] op_sel:[1,0,0] op_sel_hi:[1,1,1]
    v_pk_fma_f32 v[212:213], v[200:201], v[138:139], v[212:213] op_sel:[1,0,0] op_sel_hi:[1,1,1]
    v_pk_fma_f32 v[214:215], v[200:201], v[140:141], v[214:215] op_sel:[1,0,0] op_sel_hi:[1,1,1]
    v_pk_fma_f32 v[216:217], v[200:201], v[142:143], v[216:217] op_sel:[1,0,0] op_sel_hi:[1,1,1]
    v_pk_fma_f32 v[218:219], v[200:201], v[144:145], v[218:219] op_sel:[1,0,0] op_sel_hi:[1,1,1]
    v_pk_fma_f32 v[220:221], v[200:201], v[146:147], v[220:221] op_sel:[1,0,0] op_sel_hi:[1,1,1]
    v_pk_fma_f32 v[222:223], v[200:201], v[148:149], v[222:223] op_sel:[1,0,0] op_sel_hi:[1,1,1]
    v_pk_fma_f32 v[224:225], v[200:201], v[150:151], v[224:225] op_sel:[1,0,0] op_sel_hi:[1,1,1]
    s_waitcnt lgkmcnt(4)
    v_pk_fma_f32 v[208:209], v[202:203], v[174:175], v[208:209] op_sel:[0,0,0] op_sel_hi:[0,1,1]
    v_pk_fma_f32 v[210:211], v[202:203], v[156:157], v[210:211] op_sel:[0,0,0] op_sel_hi:[0,1,1]
    v_pk_fma_f32 v[212:213], v[202:203], v[158:159], v[212:213] op_sel:[0,0,0] op_sel_hi:[0,1,1]
    v_pk_fma_f32 v[214:215], v[202:203], v[160:161], v[214:215] op_sel:[0,0,0] op_sel_hi:[0,1,1]
    v_pk_fma_f32 v[216:217], v[202:203], v[162:163], v[216:217] op_sel:[0,0,0] op_sel_hi:[0,1,1]
    v_pk_fma_f32 v[218:219], v[202:203], v[164:165], v[218:219] op_sel:[0,0,0] op_sel_hi:[0,1,1]
    v_pk_fma_f32 v[220:221], v[202:203], v[166:167], v[220:221] op_sel:[0,0,0] op_sel_hi:[0,1,1]
    v_pk_fma_f32 v[222:223], v[202:203], v[168:169], v[222:223] op_sel:[0,0,0] op_sel_hi:[0,1,1]
    v_pk_fma_f32 v[224:225], v[202:203], v[170:171], v[224:225] op_sel:[0,0,0] op_sel_hi:[0,1,1]
    s_waitcnt lgkmcnt(0)
    v_pk_fma_f32 v[208:209], v[202:203], v[194:195], v[208:209] op_sel:[1,0,0] op_sel_hi:[1,1,1]
    v_pk_fma_f32 v[210:211], v[202:203], v[176:177], v[210:211] op_sel:[1,0,0] op_sel_hi:[1,1,1]
    v_pk_fma_f32 v[212:213], v[202:203], v[178:179], v[212:213] op_sel:[1,0,0] op_sel_hi:[1,1,1]
    v_pk_fma_f32 v[214:215], v[202:203], v[180:181], v[214:215] op_sel:[1,0,0] op_sel_hi:[1,1,1]
    v_pk_fma_f32 v[216:217], v[202:203], v[182:183], v[216:217] op_sel:[1,0,0] op_sel_hi:[1,1,1]
    v_pk_fma_f32 v[218:219], v[202:203], v[184:185], v[218:219] op_sel:[1,0,0] op_sel_hi:[1,1,1]
    v_pk_fma_f32 v[220:221], v[202:203], v[186:187], v[220:221] op_sel:[1,0,0] op_sel_hi:[1,1,1]
    v_pk_fma_f32 v[222:223], v[202:203], v[188:189], v[222:223] op_sel:[1,0,0] op_sel_hi:[1,1,1]
    v_pk_fma_f32 v[224:225], v[202:203], v[190:191], v[224:225] op_sel:[1,0,0] op_sel_hi:[1,1,1]
    v_pk_mul_f32 v[208:209], v[10:11], v[208:209] op_sel:[0,0] op_sel_hi:[0,1]
    v_pk_mul_f32 v[210:211], v[10:11], v[210:211] op_sel:[0,0] op_sel_hi:[0,1]
    v_pk_mul_f32 v[212:213], v[10:11], v[212:213] op_sel:[0,0] op_sel_hi:[0,1]
    v_pk_mul_f32 v[214:215], v[10:11], v[214:215] op_sel:[0,0] op_sel_hi:[0,1]
    v_pk_mul_f32 v[216:217], v[10:11], v[216:217] op_sel:[0,0] op_sel_hi:[0,1]
    v_pk_mul_f32 v[218:219], v[10:11], v[218:219] op_sel:[0,0] op_sel_hi:[0,1]
    v_pk_mul_f32 v[220:221], v[10:11], v[220:221] op_sel:[0,0] op_sel_hi:[0,1]
    v_pk_mul_f32 v[222:223], v[10:11], v[222:223] op_sel:[0,0] op_sel_hi:[0,1]
    v_pk_mul_f32 v[224:225], v[10:11], v[224:225] op_sel:[0,0] op_sel_hi:[0,1]
    v_cvt_pk_bf16_f32 v16, v208, v209
    v_cvt_pk_bf16_f32 v17, v210, v211
    v_cvt_pk_bf16_f32 v18, v212, v213
    v_cvt_pk_bf16_f32 v19, v214, v215
    v_cvt_pk_bf16_f32 v20, v216, v217
    v_cvt_pk_bf16_f32 v21, v218, v219
    v_cvt_pk_bf16_f32 v22, v220, v221
    v_cvt_pk_bf16_f32 v23, v222, v223
    v_cvt_pk_bf16_f32 v24, v224, v225
    v_lshrrev_b32 v9, 3, v0
    v_mul_u32_u24 v9, 9216, v9
    v_and_b32 v10, 7, v0
    v_lshl_add_u32 v9, v10, 4, v9
    s_mul_i32 s7, s21, 1152
    s_add_u32 s22, s22, s7
    s_add_u32 s22, s22, 22282240
    s_lshl_b32 s7, s3, 8
    s_add_u32 s23, s22, s7
    s_lshl_b32 s7, s3, 2
    s_add_u32 s22, s22, s7
    buffer_store_dwordx4 v[16:19], v9, s[8:11], s23 offen
    buffer_store_dwordx4 v[20:23], v9, s[8:11], s23 offen offset:128
    buffer_store_dword v24, v9, s[8:11], s22 offen offset:1024
L_qkv_end:
    s_endpgm
.text
.globl wo_kernel
.p2align 8
.type wo_kernel,@function
wo_kernel:
    s_cmp_ge_u32 s2, 256
    s_cbranch_scc1 L_wo_end
    s_load_dwordx2 s[4:5], s[0:1], 72
    v_lshrrev_b32 v1, 6, v0
    v_and_b32 v0, 63, v0
    v_readfirstlane_b32 s3, v1
    s_waitcnt lgkmcnt(0)
    s_mov_b32 s8, s4
    s_and_b32 s9, s5, 0xffff
    s_mov_b32 s10, 268435456
    s_mov_b32 s11, 0x20000
    s_lshr_b32 s20, s2, 2
    s_and_b32 s21, s2, 3
    v_bfe_u32 v3, v0, 3, 1
    v_mul_u32_u24 v2, 9216, v3
    v_lshrrev_b32 v3, 4, v0
    v_lshl_add_u32 v2, v3, 7, v2
    v_and_b32 v3, 7, v0
    v_lshl_add_u32 v2, v3, 4, v2
    s_mul_i32 s22, s20, 36864
    s_and_b32 s7, s3, 1
    s_mul_i32 s7, s7, 18432
    s_add_u32 s23, s22, s7
    s_lshr_b32 s7, s3, 1
    s_lshl_b32 s7, s7, 9
    s_add_u32 s23, s23, s7
    s_add_u32 s23, s23, 22282240
    s_lshl_b32 m0, s3, 10
    s_mul_i32 s24, s21, 9
    buffer_load_dwordx4 v2, s[8:11], s23 offen lds
    s_add_u32 m0, m0, 4096
    s_add_u32 s23, s23, 1024
    buffer_load_dwordx4 v2, s[8:11], s23 offen lds
    s_add_u32 m0, m0, 4096
    s_add_u32 s23, s23, 1024
    buffer_load_dwordx4 v2, s[8:11], s23 offen lds
    s_add_u32 m0, m0, 4096
    s_add_u32 s23, s23, 1024
    buffer_load_dwordx4 v2, s[8:11], s23 offen lds
    s_add_u32 m0, m0, 4096
    s_add_u32 s23, s23, 1024
    buffer_load_dwordx4 v2, s[8:11], s23 offen lds
    s_add_u32 m0, m0, 4096
    s_add_u32 s23, s23, 1024
    buffer_load_dwordx4 v2, s[8:11], s23 offen lds
    s_add_u32 m0, m0, 4096
    s_add_u32 s23, s23, 1024
    buffer_load_dwordx4 v2, s[8:11], s23 offen lds
    s_add_u32 m0, m0, 4096
    s_add_u32 s23, s23, 1024
    buffer_load_dwordx4 v2, s[8:11], s23 offen lds
    s_add_u32 m0, m0, 4096
    s_add_u32 s23, s23, 1024
    buffer_load_dwordx4 v2, s[8:11], s23 offen lds
    s_add_u32 s24, s24, s3
    s_mul_i32 s25, s24, 18432
    s_add_u32 s25, s25, 2359296
    s_add_u32 s26, s25, 73728
    s_add_u32 s27, s25, 147456
    s_cmp_eq_u32 s3, 0
    s_cselect_b32 s28, 0, 1073741824
    v_lshlrev_b32 v4, 4, v0
    v_add_u32 v5, s28, v4
    buffer_load_dwordx4 a[0:3], v4, s[8:11], s25 offen offset:0
    buffer_load_dwordx4 a[4:7], v4, s[8:11], s26 offen offset:0
    buffer_load_dwordx4 a[8:11], v5, s[8:11], s27 offen offset:0
    buffer_load_dwordx4 a[12:15], v4, s[8:11], s25 offen offset:1024
    buffer_load_dwordx4 a[16:19], v4, s[8:11], s26 offen offset:1024
    buffer_load_dwordx4 a[20:23], v5, s[8:11], s27 offen offset:1024
    buffer_load_dwordx4 a[24:27], v4, s[8:11], s25 offen offset:2048
    buffer_load_dwordx4 a[28:31], v4, s[8:11], s26 offen offset:2048
    buffer_load_dwordx4 a[32:35], v5, s[8:11], s27 offen offset:2048
    buffer_load_dwordx4 a[36:39], v4, s[8:11], s25 offen offset:3072
    buffer_load_dwordx4 a[40:43], v4, s[8:11], s26 offen offset:3072
    buffer_load_dwordx4 a[44:47], v5, s[8:11], s27 offen offset:3072
    s_add_u32 s25, s25, 4096
    s_add_u32 s26, s26, 4096
    s_add_u32 s27, s27, 4096
    buffer_load_dwordx4 a[48:51], v4, s[8:11], s25 offen offset:0
    buffer_load_dwordx4 a[52:55], v4, s[8:11], s26 offen offset:0
    buffer_load_dwordx4 a[56:59], v5, s[8:11], s27 offen offset:0
    buffer_load_dwordx4 a[60:63], v4, s[8:11], s25 offen offset:1024
    buffer_load_dwordx4 a[64:67], v4, s[8:11], s26 offen offset:1024
    buffer_load_dwordx4 a[68:71], v5, s[8:11], s27 offen offset:1024
    buffer_load_dwordx4 a[72:75], v4, s[8:11], s25 offen offset:2048
    buffer_load_dwordx4 a[76:79], v4, s[8:11], s26 offen offset:2048
    buffer_load_dwordx4 a[80:83], v5, s[8:11], s27 offen offset:2048
    buffer_load_dwordx4 a[84:87], v4, s[8:11], s25 offen offset:3072
    buffer_load_dwordx4 a[88:91], v4, s[8:11], s26 offen offset:3072
    buffer_load_dwordx4 a[92:95], v5, s[8:11], s27 offen offset:3072
    s_add_u32 s25, s25, 4096
    s_add_u32 s26, s26, 4096
    s_add_u32 s27, s27, 4096
    buffer_load_dwordx4 a[96:99], v4, s[8:11], s25 offen offset:0
    buffer_load_dwordx4 a[100:103], v4, s[8:11], s26 offen offset:0
    buffer_load_dwordx4 a[104:107], v5, s[8:11], s27 offen offset:0
    buffer_load_dwordx4 a[108:111], v4, s[8:11], s25 offen offset:1024
    buffer_load_dwordx4 a[112:115], v4, s[8:11], s26 offen offset:1024
    buffer_load_dwordx4 a[116:119], v5, s[8:11], s27 offen offset:1024
    buffer_load_dwordx4 a[120:123], v4, s[8:11], s25 offen offset:2048
    buffer_load_dwordx4 a[124:127], v4, s[8:11], s26 offen offset:2048
    buffer_load_dwordx4 a[128:131], v5, s[8:11], s27 offen offset:2048
    buffer_load_dwordx4 a[132:135], v4, s[8:11], s25 offen offset:3072
    buffer_load_dwordx4 a[136:139], v4, s[8:11], s26 offen offset:3072
    buffer_load_dwordx4 a[140:143], v5, s[8:11], s27 offen offset:3072
    s_add_u32 s25, s25, 4096
    s_add_u32 s26, s26, 4096
    s_add_u32 s27, s27, 4096
    buffer_load_dwordx4 a[144:147], v4, s[8:11], s25 offen offset:0
    buffer_load_dwordx4 a[148:151], v4, s[8:11], s26 offen offset:0
    buffer_load_dwordx4 a[152:155], v5, s[8:11], s27 offen offset:0
    buffer_load_dwordx4 a[156:159], v4, s[8:11], s25 offen offset:1024
    buffer_load_dwordx4 a[160:163], v4, s[8:11], s26 offen offset:1024
    buffer_load_dwordx4 a[164:167], v5, s[8:11], s27 offen offset:1024
    buffer_load_dwordx4 a[168:171], v4, s[8:11], s25 offen offset:2048
    buffer_load_dwordx4 a[172:175], v4, s[8:11], s26 offen offset:2048
    buffer_load_dwordx4 a[176:179], v5, s[8:11], s27 offen offset:2048
    buffer_load_dwordx4 a[180:183], v4, s[8:11], s25 offen offset:3072
    buffer_load_dwordx4 a[184:187], v4, s[8:11], s26 offen offset:3072
    buffer_load_dwordx4 a[188:191], v5, s[8:11], s27 offen offset:3072
    s_add_u32 s25, s25, 4096
    s_add_u32 s26, s26, 4096
    s_add_u32 s27, s27, 4096
    buffer_load_dwordx4 a[192:195], v4, s[8:11], s25 offen offset:0
    buffer_load_dwordx4 a[196:199], v4, s[8:11], s26 offen offset:0
    buffer_load_dwordx4 a[200:203], v5, s[8:11], s27 offen offset:0
    buffer_load_dwordx4 a[204:207], v4, s[8:11], s25 offen offset:1024
    buffer_load_dwordx4 a[208:211], v4, s[8:11], s26 offen offset:1024
    buffer_load_dwordx4 a[212:215], v5, s[8:11], s27 offen offset:1024
    v_bfe_u32 v3, v0, 3, 2
    s_mov_b32 s7, 9216
    v_mul_lo_u32 v6, v3, s7
    v_lshrrev_b32 v3, 5, v0
    v_lshl_add_u32 v6, v3, 7, v6
    v_and_b32 v3, 7, v0
    v_lshl_add_u32 v6, v3, 4, v6
    v_add_u32 v7, s28, v6
    s_lshl_b32 s7, s24, 8
    s_add_u32 s22, s22, s7
    s_add_u32 s23, s22, 27000832
    s_add_u32 s22, s22, 24641536
    s_mov_b32 s16, 0xffff0000
    s_waitcnt vmcnt(54)
    s_barrier
    ds_read_b128 v[20:23], v4 offset:0
    ds_read_b128 v[24:27], v4 offset:1024
    buffer_load_dwordx4 v[8:11], v6, s[8:11], s23 offen offset:0
    buffer_load_dwordx4 v[12:15], v6, s[8:11], s23 offen offset:1024
    buffer_load_dwordx4 v[16:19], v7, s[8:11], s23 offen offset:2048
    s_waitcnt vmcnt(54) lgkmcnt(0)
    v_mfma_f32_16x16x32_bf16 v[40:43], a[0:3], v[20:23], 0
    ds_read_b128 v[28:31], v4 offset:2048
    v_mfma_f32_16x16x32_bf16 v[44:47], a[0:3], v[24:27], 0
    ds_read_b128 v[32:35], v4 offset:3072
    v_mfma_f32_16x16x32_bf16 v[48:51], a[4:7], v[20:23], 0
    v_mfma_f32_16x16x32_bf16 v[52:55], a[4:7], v[24:27], 0
    v_mfma_f32_16x16x32_bf16 v[56:59], a[8:11], v[20:23], 0
    v_mfma_f32_16x16x32_bf16 v[60:63], a[8:11], v[24:27], 0
    s_waitcnt vmcnt(51) lgkmcnt(0)
    v_mfma_f32_16x16x32_bf16 v[40:43], a[12:15], v[28:31], v[40:43]
    ds_read_b128 v[20:23], v4 offset:4096
    v_mfma_f32_16x16x32_bf16 v[44:47], a[12:15], v[32:35], v[44:47]
    ds_read_b128 v[24:27], v4 offset:5120
    v_mfma_f32_16x16x32_bf16 v[48:51], a[16:19], v[28:31], v[48:51]
    v_mfma_f32_16x16x32_bf16 v[52:55], a[16:19], v[32:35], v[52:55]
    v_mfma_f32_16x16x32_bf16 v[56:59], a[20:23], v[28:31], v[56:59]
    v_mfma_f32_16x16x32_bf16 v[60:63], a[20:23], v[32:35], v[60:63]
    s_waitcnt vmcnt(48) lgkmcnt(0)
    v_mfma_f32_16x16x32_bf16 v[40:43], a[24:27], v[20:23], v[40:43]
    ds_read_b128 v[28:31], v4 offset:6144
    v_mfma_f32_16x16x32_bf16 v[44:47], a[24:27], v[24:27], v[44:47]
    ds_read_b128 v[32:35], v4 offset:7168
    v_mfma_f32_16x16x32_bf16 v[48:51], a[28:31], v[20:23], v[48:51]
    v_mfma_f32_16x16x32_bf16 v[52:55], a[28:31], v[24:27], v[52:55]
    v_mfma_f32_16x16x32_bf16 v[56:59], a[32:35], v[20:23], v[56:59]
    v_mfma_f32_16x16x32_bf16 v[60:63], a[32:35], v[24:27], v[60:63]
    s_waitcnt vmcnt(45) lgkmcnt(0)
    v_mfma_f32_16x16x32_bf16 v[40:43], a[36:39], v[28:31], v[40:43]
    ds_read_b128 v[20:23], v4 offset:8192
    v_mfma_f32_16x16x32_bf16 v[44:47], a[36:39], v[32:35], v[44:47]
    ds_read_b128 v[24:27], v4 offset:9216
    v_mfma_f32_16x16x32_bf16 v[48:51], a[40:43], v[28:31], v[48:51]
    v_mfma_f32_16x16x32_bf16 v[52:55], a[40:43], v[32:35], v[52:55]
    v_mfma_f32_16x16x32_bf16 v[56:59], a[44:47], v[28:31], v[56:59]
    v_mfma_f32_16x16x32_bf16 v[60:63], a[44:47], v[32:35], v[60:63]
    s_waitcnt vmcnt(42) lgkmcnt(0)
    v_mfma_f32_16x16x32_bf16 v[40:43], a[48:51], v[20:23], v[40:43]
    ds_read_b128 v[28:31], v4 offset:10240
    v_mfma_f32_16x16x32_bf16 v[44:47], a[48:51], v[24:27], v[44:47]
    ds_read_b128 v[32:35], v4 offset:11264
    v_mfma_f32_16x16x32_bf16 v[48:51], a[52:55], v[20:23], v[48:51]
    v_mfma_f32_16x16x32_bf16 v[52:55], a[52:55], v[24:27], v[52:55]
    v_mfma_f32_16x16x32_bf16 v[56:59], a[56:59], v[20:23], v[56:59]
    v_mfma_f32_16x16x32_bf16 v[60:63], a[56:59], v[24:27], v[60:63]
    s_waitcnt vmcnt(39) lgkmcnt(0)
    v_mfma_f32_16x16x32_bf16 v[40:43], a[60:63], v[28:31], v[40:43]
    ds_read_b128 v[20:23], v4 offset:12288
    v_mfma_f32_16x16x32_bf16 v[44:47], a[60:63], v[32:35], v[44:47]
    ds_read_b128 v[24:27], v4 offset:13312
    v_mfma_f32_16x16x32_bf16 v[48:51], a[64:67], v[28:31], v[48:51]
    v_mfma_f32_16x16x32_bf16 v[52:55], a[64:67], v[32:35], v[52:55]
    v_mfma_f32_16x16x32_bf16 v[56:59], a[68:71], v[28:31], v[56:59]
    v_mfma_f32_16x16x32_bf16 v[60:63], a[68:71], v[32:35], v[60:63]
    s_waitcnt vmcnt(36) lgkmcnt(0)
    v_mfma_f32_16x16x32_bf16 v[40:43], a[72:75], v[20:23], v[40:43]
    ds_read_b128 v[28:31], v4 offset:14336
    v_mfma_f32_16x16x32_bf16 v[44:47], a[72:75], v[24:27], v[44:47]
    ds_read_b128 v[32:35], v4 offset:15360
    v_mfma_f32_16x16x32_bf16 v[48:51], a[76:79], v[20:23], v[48:51]
    v_mfma_f32_16x16x32_bf16 v[52:55], a[76:79], v[24:27], v[52:55]
    v_mfma_f32_16x16x32_bf16 v[56:59], a[80:83], v[20:23], v[56:59]
    v_mfma_f32_16x16x32_bf16 v[60:63], a[80:83], v[24:27], v[60:63]
    s_waitcnt vmcnt(33) lgkmcnt(0)
    v_mfma_f32_16x16x32_bf16 v[40:43], a[84:87], v[28:31], v[40:43]
    ds_read_b128 v[20:23], v4 offset:16384
    v_mfma_f32_16x16x32_bf16 v[44:47], a[84:87], v[32:35], v[44:47]
    ds_read_b128 v[24:27], v4 offset:17408
    v_mfma_f32_16x16x32_bf16 v[48:51], a[88:91], v[28:31], v[48:51]
    v_mfma_f32_16x16x32_bf16 v[52:55], a[88:91], v[32:35], v[52:55]
    v_mfma_f32_16x16x32_bf16 v[56:59], a[92:95], v[28:31], v[56:59]
    v_mfma_f32_16x16x32_bf16 v[60:63], a[92:95], v[32:35], v[60:63]
    s_waitcnt vmcnt(30) lgkmcnt(0)
    v_mfma_f32_16x16x32_bf16 v[40:43], a[96:99], v[20:23], v[40:43]
    ds_read_b128 v[28:31], v4 offset:18432
    v_mfma_f32_16x16x32_bf16 v[44:47], a[96:99], v[24:27], v[44:47]
    ds_read_b128 v[32:35], v4 offset:19456
    v_mfma_f32_16x16x32_bf16 v[48:51], a[100:103], v[20:23], v[48:51]
    v_mfma_f32_16x16x32_bf16 v[52:55], a[100:103], v[24:27], v[52:55]
    v_mfma_f32_16x16x32_bf16 v[56:59], a[104:107], v[20:23], v[56:59]
    v_mfma_f32_16x16x32_bf16 v[60:63], a[104:107], v[24:27], v[60:63]
    s_waitcnt vmcnt(27) lgkmcnt(0)
    v_mfma_f32_16x16x32_bf16 v[40:43], a[108:111], v[28:31], v[40:43]
    ds_read_b128 v[20:23], v4 offset:20480
    v_mfma_f32_16x16x32_bf16 v[44:47], a[108:111], v[32:35], v[44:47]
    ds_read_b128 v[24:27], v4 offset:21504
    v_mfma_f32_16x16x32_bf16 v[48:51], a[112:115], v[28:31], v[48:51]
    v_mfma_f32_16x16x32_bf16 v[52:55], a[112:115], v[32:35], v[52:55]
    v_mfma_f32_16x16x32_bf16 v[56:59], a[116:119], v[28:31], v[56:59]
    v_mfma_f32_16x16x32_bf16 v[60:63], a[116:119], v[32:35], v[60:63]
    s_waitcnt vmcnt(24) lgkmcnt(0)
    v_mfma_f32_16x16x32_bf16 v[40:43], a[120:123], v[20:23], v[40:43]
    ds_read_b128 v[28:31], v4 offset:22528
    v_mfma_f32_16x16x32_bf16 v[44:47], a[120:123], v[24:27], v[44:47]
    ds_read_b128 v[32:35], v4 offset:23552
    v_mfma_f32_16x16x32_bf16 v[48:51], a[124:127], v[20:23], v[48:51]
    v_mfma_f32_16x16x32_bf16 v[52:55], a[124:127], v[24:27], v[52:55]
    v_mfma_f32_16x16x32_bf16 v[56:59], a[128:131], v[20:23], v[56:59]
    v_mfma_f32_16x16x32_bf16 v[60:63], a[128:131], v[24:27], v[60:63]
    s_waitcnt vmcnt(21) lgkmcnt(0)
    v_mfma_f32_16x16x32_bf16 v[40:43], a[132:135], v[28:31], v[40:43]
    ds_read_b128 v[20:23], v4 offset:24576
    v_mfma_f32_16x16x32_bf16 v[44:47], a[132:135], v[32:35], v[44:47]
    ds_read_b128 v[24:27], v4 offset:25600
    v_mfma_f32_16x16x32_bf16 v[48:51], a[136:139], v[28:31], v[48:51]
    v_mfma_f32_16x16x32_bf16 v[52:55], a[136:139], v[32:35], v[52:55]
    v_mfma_f32_16x16x32_bf16 v[56:59], a[140:143], v[28:31], v[56:59]
    v_mfma_f32_16x16x32_bf16 v[60:63], a[140:143], v[32:35], v[60:63]
    s_waitcnt vmcnt(18) lgkmcnt(0)
    v_mfma_f32_16x16x32_bf16 v[40:43], a[144:147], v[20:23], v[40:43]
    ds_read_b128 v[28:31], v4 offset:26624
    v_mfma_f32_16x16x32_bf16 v[44:47], a[144:147], v[24:27], v[44:47]
    ds_read_b128 v[32:35], v4 offset:27648
    v_mfma_f32_16x16x32_bf16 v[48:51], a[148:151], v[20:23], v[48:51]
    v_mfma_f32_16x16x32_bf16 v[52:55], a[148:151], v[24:27], v[52:55]
    v_mfma_f32_16x16x32_bf16 v[56:59], a[152:155], v[20:23], v[56:59]
    v_mfma_f32_16x16x32_bf16 v[60:63], a[152:155], v[24:27], v[60:63]
    s_waitcnt vmcnt(15) lgkmcnt(0)
    v_mfma_f32_16x16x32_bf16 v[40:43], a[156:159], v[28:31], v[40:43]
    ds_read_b128 v[20:23], v4 offset:28672
    v_mfma_f32_16x16x32_bf16 v[44:47], a[156:159], v[32:35], v[44:47]
    ds_read_b128 v[24:27], v4 offset:29696
    v_mfma_f32_16x16x32_bf16 v[48:51], a[160:163], v[28:31], v[48:51]
    v_mfma_f32_16x16x32_bf16 v[52:55], a[160:163], v[32:35], v[52:55]
    v_mfma_f32_16x16x32_bf16 v[56:59], a[164:167], v[28:31], v[56:59]
    v_mfma_f32_16x16x32_bf16 v[60:63], a[164:167], v[32:35], v[60:63]
    s_waitcnt vmcnt(12) lgkmcnt(0)
    v_mfma_f32_16x16x32_bf16 v[40:43], a[168:171], v[20:23], v[40:43]
    ds_read_b128 v[28:31], v4 offset:30720
    v_mfma_f32_16x16x32_bf16 v[44:47], a[168:171], v[24:27], v[44:47]
    ds_read_b128 v[32:35], v4 offset:31744
    v_mfma_f32_16x16x32_bf16 v[48:51], a[172:175], v[20:23], v[48:51]
    v_mfma_f32_16x16x32_bf16 v[52:55], a[172:175], v[24:27], v[52:55]
    v_mfma_f32_16x16x32_bf16 v[56:59], a[176:179], v[20:23], v[56:59]
    v_mfma_f32_16x16x32_bf16 v[60:63], a[176:179], v[24:27], v[60:63]
    s_waitcnt vmcnt(9) lgkmcnt(0)
    v_mfma_f32_16x16x32_bf16 v[40:43], a[180:183], v[28:31], v[40:43]
    ds_read_b128 v[20:23], v4 offset:32768
    v_mfma_f32_16x16x32_bf16 v[44:47], a[180:183], v[32:35], v[44:47]
    ds_read_b128 v[24:27], v4 offset:33792
    v_mfma_f32_16x16x32_bf16 v[48:51], a[184:187], v[28:31], v[48:51]
    v_mfma_f32_16x16x32_bf16 v[52:55], a[184:187], v[32:35], v[52:55]
    v_mfma_f32_16x16x32_bf16 v[56:59], a[188:191], v[28:31], v[56:59]
    v_mfma_f32_16x16x32_bf16 v[60:63], a[188:191], v[32:35], v[60:63]
    s_waitcnt vmcnt(6) lgkmcnt(0)
    v_mfma_f32_16x16x32_bf16 v[40:43], a[192:195], v[20:23], v[40:43]
    ds_read_b128 v[28:31], v4 offset:34816
    v_mfma_f32_16x16x32_bf16 v[44:47], a[192:195], v[24:27], v[44:47]
    ds_read_b128 v[32:35], v4 offset:35840
    v_mfma_f32_16x16x32_bf16 v[48:51], a[196:199], v[20:23], v[48:51]
    v_mfma_f32_16x16x32_bf16 v[52:55], a[196:199], v[24:27], v[52:55]
    v_mfma_f32_16x16x32_bf16 v[56:59], a[200:203], v[20:23], v[56:59]
    v_mfma_f32_16x16x32_bf16 v[60:63], a[200:203], v[24:27], v[60:63]
    s_waitcnt vmcnt(3) lgkmcnt(0)
    v_mfma_f32_16x16x32_bf16 v[40:43], a[204:207], v[28:31], v[40:43]
    v_mfma_f32_16x16x32_bf16 v[44:47], a[204:207], v[32:35], v[44:47]
    v_mfma_f32_16x16x32_bf16 v[48:51], a[208:211], v[28:31], v[48:51]
    v_mfma_f32_16x16x32_bf16 v[52:55], a[208:211], v[32:35], v[52:55]
    v_mfma_f32_16x16x32_bf16 v[56:59], a[212:215], v[28:31], v[56:59]
    v_mfma_f32_16x16x32_bf16 v[60:63], a[212:215], v[32:35], v[60:63]
    s_waitcnt vmcnt(0)
    v_lshlrev_b32 v64, 16, v8
    v_and_b32 v65, s16, v8
    v_lshlrev_b32 v66, 16, v9
    v_and_b32 v67, s16, v9
    v_lshlrev_b32 v68, 16, v10
    v_and_b32 v69, s16, v10
    v_lshlrev_b32 v70, 16, v11
    v_and_b32 v71, s16, v11
    v_lshlrev_b32 v72, 16, v12
    v_and_b32 v73, s16, v12
    v_lshlrev_b32 v74, 16, v13
    v_and_b32 v75, s16, v13
    v_lshlrev_b32 v76, 16, v14
    v_and_b32 v77, s16, v14
    v_lshlrev_b32 v78, 16, v15
    v_and_b32 v79, s16, v15
    v_lshlrev_b32 v80, 16, v16
    v_and_b32 v81, s16, v16
    v_lshlrev_b32 v82, 16, v17
    v_and_b32 v83, s16, v17
    v_lshlrev_b32 v84, 16, v18
    v_and_b32 v85, s16, v18
    v_lshlrev_b32 v86, 16, v19
    v_and_b32 v87, s16, v19
    v_permlane16_swap_b32 v40, v44
    v_permlane16_swap_b32 v41, v45
    v_permlane16_swap_b32 v42, v46
    v_permlane16_swap_b32 v43, v47
    v_pk_add_f32 v[64:65], v[64:65], v[40:41]
    v_pk_add_f32 v[66:67], v[66:67], v[42:43]
    v_pk_add_f32 v[68:69], v[68:69], v[44:45]
    v_pk_add_f32 v[70:71], v[70:71], v[46:47]
    v_cvt_pk_bf16_f32 v8, v64, v65
    v_cvt_pk_bf16_f32 v9, v66, v67
    v_cvt_pk_bf16_f32 v10, v68, v69
    v_cvt_pk_bf16_f32 v11, v70, v71
    buffer_store_dwordx4 v[8:11], v6, s[8:11], s22 offen offset:0
    v_permlane16_swap_b32 v48, v52
    v_permlane16_swap_b32 v49, v53
    v_permlane16_swap_b32 v50, v54
    v_permlane16_swap_b32 v51, v55
    v_pk_add_f32 v[72:73], v[72:73], v[48:49]
    v_pk_add_f32 v[74:75], v[74:75], v[50:51]
    v_pk_add_f32 v[76:77], v[76:77], v[52:53]
    v_pk_add_f32 v[78:79], v[78:79], v[54:55]
    v_cvt_pk_bf16_f32 v12, v72, v73
    v_cvt_pk_bf16_f32 v13, v74, v75
    v_cvt_pk_bf16_f32 v14, v76, v77
    v_cvt_pk_bf16_f32 v15, v78, v79
    buffer_store_dwordx4 v[12:15], v6, s[8:11], s22 offen offset:1024
    v_permlane16_swap_b32 v56, v60
    v_permlane16_swap_b32 v57, v61
    v_permlane16_swap_b32 v58, v62
    v_permlane16_swap_b32 v59, v63
    v_pk_add_f32 v[80:81], v[80:81], v[56:57]
    v_pk_add_f32 v[82:83], v[82:83], v[58:59]
    v_pk_add_f32 v[84:85], v[84:85], v[60:61]
    v_pk_add_f32 v[86:87], v[86:87], v[62:63]
    v_cvt_pk_bf16_f32 v16, v80, v81
    v_cvt_pk_bf16_f32 v17, v82, v83
    v_cvt_pk_bf16_f32 v18, v84, v85
    v_cvt_pk_bf16_f32 v19, v86, v87
    buffer_store_dwordx4 v[16:19], v7, s[8:11], s22 offen offset:2048
L_wo_end:
    s_endpgm
.text
.globl ffn_kernel
.p2align 8
.type ffn_kernel,@function
ffn_kernel:
    s_cmp_ge_u32 s2, 256
    s_cbranch_scc1 L_ffn_end
    s_load_dwordx2 s[4:5], s[0:1], 72
    v_lshrrev_b32 v1, 6, v0
    v_and_b32 v0, 63, v0
    v_readfirstlane_b32 s3, v1
    s_waitcnt lgkmcnt(0)
    s_mov_b32 s8, s4
    s_and_b32 s9, s5, 0xffff
    s_mov_b32 s10, 268435456
    s_mov_b32 s11, 0x20000
    s_and_b32 s20, s2, 7
    s_lshr_b32 s21, s2, 3
    v_bfe_u32 v3, v0, 3, 1
    v_mul_u32_u24 v2, 9216, v3
    v_lshrrev_b32 v3, 4, v0
    v_lshl_add_u32 v2, v3, 7, v2
    v_and_b32 v3, 7, v0
    v_lshl_add_u32 v2, v3, 4, v2
    s_lshl_b32 s7, s21, 2
    s_add_u32 s7, s7, s3
    s_mul_i32 s22, s7, 18432
    s_add_u32 s22, s22, 24641536
    buffer_load_dwordx4 v[88:91], v2, s[8:11], s22 offen offset:0
    buffer_load_dwordx4 v[92:95], v2, s[8:11], s22 offen offset:512
    buffer_load_dwordx4 v[96:99], v2, s[8:11], s22 offen offset:1024
    buffer_load_dwordx4 v[100:103], v2, s[8:11], s22 offen offset:1536
    buffer_load_dwordx4 v[104:107], v2, s[8:11], s22 offen offset:2048
    buffer_load_dwordx4 v[108:111], v2, s[8:11], s22 offen offset:2560
    buffer_load_dwordx4 v[112:115], v2, s[8:11], s22 offen offset:3072
    buffer_load_dwordx4 v[116:119], v2, s[8:11], s22 offen offset:3584
    s_add_u32 s22, s22, 4096
    buffer_load_dwordx4 v[120:123], v2, s[8:11], s22 offen offset:0
    buffer_load_dwordx4 v[124:127], v2, s[8:11], s22 offen offset:512
    buffer_load_dwordx4 v[128:131], v2, s[8:11], s22 offen offset:1024
    buffer_load_dwordx4 v[132:135], v2, s[8:11], s22 offen offset:1536
    buffer_load_dwordx4 v[136:139], v2, s[8:11], s22 offen offset:2048
    buffer_load_dwordx4 v[140:143], v2, s[8:11], s22 offen offset:2560
    buffer_load_dwordx4 v[144:147], v2, s[8:11], s22 offen offset:3072
    buffer_load_dwordx4 v[148:151], v2, s[8:11], s22 offen offset:3584
    s_add_u32 s22, s22, 4096
    buffer_load_dwordx4 v[152:155], v2, s[8:11], s22 offen offset:0
    buffer_load_dwordx4 v[156:159], v2, s[8:11], s22 offen offset:512
    s_lshl_b32 s7, s20, 2
    s_add_u32 s7, s7, s3
    s_mul_i32 s23, s7, 497664
    s_add_u32 s23, s23, 3145728
    v_lshlrev_b32 v184, 4, v0
    v_add_u32 v185, 4096, v184
    v_add_u32 v186, 8192, v184
    v_add_u32 v187, 12288, v184
    v_add_u32 v188, 16384, v184
    v_add_u32 v189, 20480, v184
    v_add_u32 v190, 24576, v184
    v_add_u32 v191, 28672, v184
    v_add_u32 v192, 32768, v184
    buffer_load_dwordx4 v[16:19], v184, s[8:11], s23 offen offset:0
    buffer_load_dwordx4 v[20:23], v184, s[8:11], s23 offen offset:1024
    buffer_load_dwordx4 v[24:27], v184, s[8:11], s23 offen offset:2048
    buffer_load_dwordx4 v[28:31], v184, s[8:11], s23 offen offset:3072
    buffer_load_dwordx4 v[32:35], v185, s[8:11], s23 offen offset:0
    buffer_load_dwordx4 v[36:39], v185, s[8:11], s23 offen offset:1024
    buffer_load_dwordx4 v[40:43], v185, s[8:11], s23 offen offset:2048
    buffer_load_dwordx4 v[44:47], v185, s[8:11], s23 offen offset:3072
    buffer_load_dwordx4 v[48:51], v186, s[8:11], s23 offen offset:0
    buffer_load_dwordx4 v[52:55], v186, s[8:11], s23 offen offset:1024
    buffer_load_dwordx4 v[56:59], v186, s[8:11], s23 offen offset:2048
    buffer_load_dwordx4 v[60:63], v186, s[8:11], s23 offen offset:3072
    buffer_load_dwordx4 v[64:67], v187, s[8:11], s23 offen offset:0
    buffer_load_dwordx4 v[68:71], v187, s[8:11], s23 offen offset:1024
    buffer_load_dwordx4 v[72:75], v187, s[8:11], s23 offen offset:2048
    s_add_u32 s23, s23, 15360
    s_mov_b32 s16, 0xffff0000
    s_mov_b32 s17, 0x3f803f80
    v_mov_b32 v4, 0
    v_mov_b32 v5, 0
    v_mov_b32 v6, 0
    v_mov_b32 v7, 0
    v_mov_b32 v8, 0
    v_mov_b32 v9, 0
    v_mov_b32 v10, 0
    v_mov_b32 v11, 0
    s_waitcnt vmcnt(32)
    v_dot2c_f32_bf16 v4, s17, v88
    v_dot2c_f32_bf16 v8, v88, v88
    v_dot2c_f32_bf16 v5, s17, v89
    v_dot2c_f32_bf16 v9, v89, v89
    v_dot2c_f32_bf16 v6, s17, v90
    v_dot2c_f32_bf16 v10, v90, v90
    v_dot2c_f32_bf16 v7, s17, v91
    v_dot2c_f32_bf16 v11, v91, v91
    s_waitcnt vmcnt(31)
    v_dot2c_f32_bf16 v4, s17, v92
    v_dot2c_f32_bf16 v8, v92, v92
    v_dot2c_f32_bf16 v5, s17, v93
    v_dot2c_f32_bf16 v9, v93, v93
    v_dot2c_f32_bf16 v6, s17, v94
    v_dot2c_f32_bf16 v10, v94, v94
    v_dot2c_f32_bf16 v7, s17, v95
    v_dot2c_f32_bf16 v11, v95, v95
    s_waitcnt vmcnt(30)
    v_dot2c_f32_bf16 v4, s17, v96
    v_dot2c_f32_bf16 v8, v96, v96
    v_dot2c_f32_bf16 v5, s17, v97
    v_dot2c_f32_bf16 v9, v97, v97
    v_dot2c_f32_bf16 v6, s17, v98
    v_dot2c_f32_bf16 v10, v98, v98
    v_dot2c_f32_bf16 v7, s17, v99
    v_dot2c_f32_bf16 v11, v99, v99
    s_waitcnt vmcnt(29)
    v_dot2c_f32_bf16 v4, s17, v100
    v_dot2c_f32_bf16 v8, v100, v100
    v_dot2c_f32_bf16 v5, s17, v101
    v_dot2c_f32_bf16 v9, v101, v101
    v_dot2c_f32_bf16 v6, s17, v102
    v_dot2c_f32_bf16 v10, v102, v102
    v_dot2c_f32_bf16 v7, s17, v103
    v_dot2c_f32_bf16 v11, v103, v103
    s_waitcnt vmcnt(28)
    v_dot2c_f32_bf16 v4, s17, v104
    v_dot2c_f32_bf16 v8, v104, v104
    v_dot2c_f32_bf16 v5, s17, v105
    v_dot2c_f32_bf16 v9, v105, v105
    v_dot2c_f32_bf16 v6, s17, v106
    v_dot2c_f32_bf16 v10, v106, v106
    v_dot2c_f32_bf16 v7, s17, v107
    v_dot2c_f32_bf16 v11, v107, v107
    s_waitcnt vmcnt(27)
    v_dot2c_f32_bf16 v4, s17, v108
    v_dot2c_f32_bf16 v8, v108, v108
    v_dot2c_f32_bf16 v5, s17, v109
    v_dot2c_f32_bf16 v9, v109, v109
    v_dot2c_f32_bf16 v6, s17, v110
    v_dot2c_f32_bf16 v10, v110, v110
    v_dot2c_f32_bf16 v7, s17, v111
    v_dot2c_f32_bf16 v11, v111, v111
    s_waitcnt vmcnt(26)
    v_dot2c_f32_bf16 v4, s17, v112
    v_dot2c_f32_bf16 v8, v112, v112
    v_dot2c_f32_bf16 v5, s17, v113
    v_dot2c_f32_bf16 v9, v113, v113
    v_dot2c_f32_bf16 v6, s17, v114
    v_dot2c_f32_bf16 v10, v114, v114
    v_dot2c_f32_bf16 v7, s17, v115
    v_dot2c_f32_bf16 v11, v115, v115
    s_waitcnt vmcnt(25)
    v_dot2c_f32_bf16 v4, s17, v116
    v_dot2c_f32_bf16 v8, v116, v116
    v_dot2c_f32_bf16 v5, s17, v117
    v_dot2c_f32_bf16 v9, v117, v117
    v_dot2c_f32_bf16 v6, s17, v118
    v_dot2c_f32_bf16 v10, v118, v118
    v_dot2c_f32_bf16 v7, s17, v119
    v_dot2c_f32_bf16 v11, v119, v119
    s_waitcnt vmcnt(24)
    v_dot2c_f32_bf16 v4, s17, v120
    v_dot2c_f32_bf16 v8, v120, v120
    v_dot2c_f32_bf16 v5, s17, v121
    v_dot2c_f32_bf16 v9, v121, v121
    v_dot2c_f32_bf16 v6, s17, v122
    v_dot2c_f32_bf16 v10, v122, v122
    v_dot2c_f32_bf16 v7, s17, v123
    v_dot2c_f32_bf16 v11, v123, v123
    s_waitcnt vmcnt(23)
    v_dot2c_f32_bf16 v4, s17, v124
    v_dot2c_f32_bf16 v8, v124, v124
    v_dot2c_f32_bf16 v5, s17, v125
    v_dot2c_f32_bf16 v9, v125, v125
    v_dot2c_f32_bf16 v6, s17, v126
    v_dot2c_f32_bf16 v10, v126, v126
    v_dot2c_f32_bf16 v7, s17, v127
    v_dot2c_f32_bf16 v11, v127, v127
    s_waitcnt vmcnt(22)
    v_dot2c_f32_bf16 v4, s17, v128
    v_dot2c_f32_bf16 v8, v128, v128
    v_dot2c_f32_bf16 v5, s17, v129
    v_dot2c_f32_bf16 v9, v129, v129
    v_dot2c_f32_bf16 v6, s17, v130
    v_dot2c_f32_bf16 v10, v130, v130
    v_dot2c_f32_bf16 v7, s17, v131
    v_dot2c_f32_bf16 v11, v131, v131
    s_waitcnt vmcnt(21)
    v_dot2c_f32_bf16 v4, s17, v132
    v_dot2c_f32_bf16 v8, v132, v132
    v_dot2c_f32_bf16 v5, s17, v133
    v_dot2c_f32_bf16 v9, v133, v133
    v_dot2c_f32_bf16 v6, s17, v134
    v_dot2c_f32_bf16 v10, v134, v134
    v_dot2c_f32_bf16 v7, s17, v135
    v_dot2c_f32_bf16 v11, v135, v135
    s_waitcnt vmcnt(20)
    v_dot2c_f32_bf16 v4, s17, v136
    v_dot2c_f32_bf16 v8, v136, v136
    v_dot2c_f32_bf16 v5, s17, v137
    v_dot2c_f32_bf16 v9, v137, v137
    v_dot2c_f32_bf16 v6, s17, v138
    v_dot2c_f32_bf16 v10, v138, v138
    v_dot2c_f32_bf16 v7, s17, v139
    v_dot2c_f32_bf16 v11, v139, v139
    s_waitcnt vmcnt(19)
    v_dot2c_f32_bf16 v4, s17, v140
    v_dot2c_f32_bf16 v8, v140, v140
    v_dot2c_f32_bf16 v5, s17, v141
    v_dot2c_f32_bf16 v9, v141, v141
    v_dot2c_f32_bf16 v6, s17, v142
    v_dot2c_f32_bf16 v10, v142, v142
    v_dot2c_f32_bf16 v7, s17, v143
    v_dot2c_f32_bf16 v11, v143, v143
    s_waitcnt vmcnt(18)
    v_dot2c_f32_bf16 v4, s17, v144
    v_dot2c_f32_bf16 v8, v144, v144
    v_dot2c_f32_bf16 v5, s17, v145
    v_dot2c_f32_bf16 v9, v145, v145
    v_dot2c_f32_bf16 v6, s17, v146
    v_dot2c_f32_bf16 v10, v146, v146
    v_dot2c_f32_bf16 v7, s17, v147
    v_dot2c_f32_bf16 v11, v147, v147
    s_waitcnt vmcnt(17)
    v_dot2c_f32_bf16 v4, s17, v148
    v_dot2c_f32_bf16 v8, v148, v148
    v_dot2c_f32_bf16 v5, s17, v149
    v_dot2c_f32_bf16 v9, v149, v149
    v_dot2c_f32_bf16 v6, s17, v150
    v_dot2c_f32_bf16 v10, v150, v150
    v_dot2c_f32_bf16 v7, s17, v151
    v_dot2c_f32_bf16 v11, v151, v151
    s_waitcnt vmcnt(16)
    v_dot2c_f32_bf16 v4, s17, v152
    v_dot2c_f32_bf16 v8, v152, v152
    v_dot2c_f32_bf16 v5, s17, v153
    v_dot2c_f32_bf16 v9, v153, v153
    v_dot2c_f32_bf16 v6, s17, v154
    v_dot2c_f32_bf16 v10, v154, v154
    v_dot2c_f32_bf16 v7, s17, v155
    v_dot2c_f32_bf16 v11, v155, v155
    s_waitcnt vmcnt(15)
    v_dot2c_f32_bf16 v4, s17, v156
    v_dot2c_f32_bf16 v8, v156, v156
    v_dot2c_f32_bf16 v5, s17, v157
    v_dot2c_f32_bf16 v9, v157, v157
    v_dot2c_f32_bf16 v6, s17, v158
    v_dot2c_f32_bf16 v10, v158, v158
    v_dot2c_f32_bf16 v7, s17, v159
    v_dot2c_f32_bf16 v11, v159, v159
    s_nop 2
    v_pk_add_f32 v[4:5], v[4:5], v[6:7]
    v_pk_add_f32 v[8:9], v[8:9], v[10:11]
    v_add_f32 v4, v4, v5
    v_add_f32 v5, v8, v9
    v_mov_b32 v6, v4
    v_mov_b32 v7, v5
    s_nop 1
    v_permlane32_swap_b32 v6, v4
    v_permlane32_swap_b32 v7, v5
    v_add_f32 v4, v4, v6
    v_add_f32 v5, v5, v7
    v_mov_b32 v6, v4
    v_mov_b32 v7, v5
    s_nop 1
    v_permlane16_swap_b32 v6, v4
    v_permlane16_swap_b32 v7, v5
    v_add_f32 v4, v4, v6
    v_add_f32 v5, v5, v7
    v_mul_f32 v4, 0x3ae38e39, v4
    v_mul_f32 v5, 0x3ae38e39, v5
    v_fma_f32 v5, -v4, v4, v5
    v_max_f32 v5, 0, v5
    v_add_f32 v5, 0x3727c5ac, v5
    v_rsq_f32 v6, v5
    s_nop 0
    v_mul_f32 v8, v4, v6
    v_mov_b32 v7, v6
    v_sub_f32 v8, 0, v8
    v_mov_b32 v9, v8
    s_mul_i32 s7, s3, 18432
    v_add_u32 v10, s7, v184
    v_lshlrev_b32 v160, 16, v88
    v_and_b32 v161, s16, v88
    v_lshlrev_b32 v162, 16, v89
    v_and_b32 v163, s16, v89
    v_lshlrev_b32 v164, 16, v90
    v_and_b32 v165, s16, v90
    v_lshlrev_b32 v166, 16, v91
    v_and_b32 v167, s16, v91
    v_pk_fma_f32 v[160:161], v[160:161], v[6:7], v[8:9]
    v_pk_fma_f32 v[162:163], v[162:163], v[6:7], v[8:9]
    v_pk_fma_f32 v[164:165], v[164:165], v[6:7], v[8:9]
    v_pk_fma_f32 v[166:167], v[166:167], v[6:7], v[8:9]
    v_cvt_pk_bf16_f32 v88, v160, v161
    v_cvt_pk_bf16_f32 v89, v162, v163
    v_cvt_pk_bf16_f32 v90, v164, v165
    v_cvt_pk_bf16_f32 v91, v166, v167
    ds_write_b128 v10, v[88:91] offset:0
    v_lshlrev_b32 v168, 16, v92
    v_and_b32 v169, s16, v92
    v_lshlrev_b32 v170, 16, v93
    v_and_b32 v171, s16, v93
    v_lshlrev_b32 v172, 16, v94
    v_and_b32 v173, s16, v94
    v_lshlrev_b32 v174, 16, v95
    v_and_b32 v175, s16, v95
    v_pk_fma_f32 v[168:169], v[168:169], v[6:7], v[8:9]
    v_pk_fma_f32 v[170:171], v[170:171], v[6:7], v[8:9]
    v_pk_fma_f32 v[172:173], v[172:173], v[6:7], v[8:9]
    v_pk_fma_f32 v[174:175], v[174:175], v[6:7], v[8:9]
    v_cvt_pk_bf16_f32 v92, v168, v169
    v_cvt_pk_bf16_f32 v93, v170, v171
    v_cvt_pk_bf16_f32 v94, v172, v173
    v_cvt_pk_bf16_f32 v95, v174, v175
    ds_write_b128 v10, v[92:95] offset:1024
    v_lshlrev_b32 v160, 16, v96
    v_and_b32 v161, s16, v96
    v_lshlrev_b32 v162, 16, v97
    v_and_b32 v163, s16, v97
    v_lshlrev_b32 v164, 16, v98
    v_and_b32 v165, s16, v98
    v_lshlrev_b32 v166, 16, v99
    v_and_b32 v167, s16, v99
    v_pk_fma_f32 v[160:161], v[160:161], v[6:7], v[8:9]
    v_pk_fma_f32 v[162:163], v[162:163], v[6:7], v[8:9]
    v_pk_fma_f32 v[164:165], v[164:165], v[6:7], v[8:9]
    v_pk_fma_f32 v[166:167], v[166:167], v[6:7], v[8:9]
    v_cvt_pk_bf16_f32 v96, v160, v161
    v_cvt_pk_bf16_f32 v97, v162, v163
    v_cvt_pk_bf16_f32 v98, v164, v165
    v_cvt_pk_bf16_f32 v99, v166, v167
    ds_write_b128 v10, v[96:99] offset:2048
    v_lshlrev_b32 v168, 16, v100
    v_and_b32 v169, s16, v100
    v_lshlrev_b32 v170, 16, v101
    v_and_b32 v171, s16, v101
    v_lshlrev_b32 v172, 16, v102
    v_and_b32 v173, s16, v102
    v_lshlrev_b32 v174, 16, v103
    v_and_b32 v175, s16, v103
    v_pk_fma_f32 v[168:169], v[168:169], v[6:7], v[8:9]
    v_pk_fma_f32 v[170:171], v[170:171], v[6:7], v[8:9]
    v_pk_fma_f32 v[172:173], v[172:173], v[6:7], v[8:9]
    v_pk_fma_f32 v[174:175], v[174:175], v[6:7], v[8:9]
    v_cvt_pk_bf16_f32 v100, v168, v169
    v_cvt_pk_bf16_f32 v101, v170, v171
    v_cvt_pk_bf16_f32 v102, v172, v173
    v_cvt_pk_bf16_f32 v103, v174, v175
    ds_write_b128 v10, v[100:103] offset:3072
    v_lshlrev_b32 v160, 16, v104
    v_and_b32 v161, s16, v104
    v_lshlrev_b32 v162, 16, v105
    v_and_b32 v163, s16, v105
    v_lshlrev_b32 v164, 16, v106
    v_and_b32 v165, s16, v106
    v_lshlrev_b32 v166, 16, v107
    v_and_b32 v167, s16, v107
    v_pk_fma_f32 v[160:161], v[160:161], v[6:7], v[8:9]
    v_pk_fma_f32 v[162:163], v[162:163], v[6:7], v[8:9]
    v_pk_fma_f32 v[164:165], v[164:165], v[6:7], v[8:9]
    v_pk_fma_f32 v[166:167], v[166:167], v[6:7], v[8:9]
    v_cvt_pk_bf16_f32 v104, v160, v161
    v_cvt_pk_bf16_f32 v105, v162, v163
    v_cvt_pk_bf16_f32 v106, v164, v165
    v_cvt_pk_bf16_f32 v107, v166, v167
    ds_write_b128 v10, v[104:107] offset:4096
    v_lshlrev_b32 v168, 16, v108
    v_and_b32 v169, s16, v108
    v_lshlrev_b32 v170, 16, v109
    v_and_b32 v171, s16, v109
    v_lshlrev_b32 v172, 16, v110
    v_and_b32 v173, s16, v110
    v_lshlrev_b32 v174, 16, v111
    v_and_b32 v175, s16, v111
    v_pk_fma_f32 v[168:169], v[168:169], v[6:7], v[8:9]
    v_pk_fma_f32 v[170:171], v[170:171], v[6:7], v[8:9]
    v_pk_fma_f32 v[172:173], v[172:173], v[6:7], v[8:9]
    v_pk_fma_f32 v[174:175], v[174:175], v[6:7], v[8:9]
    v_cvt_pk_bf16_f32 v108, v168, v169
    v_cvt_pk_bf16_f32 v109, v170, v171
    v_cvt_pk_bf16_f32 v110, v172, v173
    v_cvt_pk_bf16_f32 v111, v174, v175
    ds_write_b128 v10, v[108:111] offset:5120
    v_lshlrev_b32 v160, 16, v112
    v_and_b32 v161, s16, v112
    v_lshlrev_b32 v162, 16, v113
    v_and_b32 v163, s16, v113
    v_lshlrev_b32 v164, 16, v114
    v_and_b32 v165, s16, v114
    v_lshlrev_b32 v166, 16, v115
    v_and_b32 v167, s16, v115
    v_pk_fma_f32 v[160:161], v[160:161], v[6:7], v[8:9]
    v_pk_fma_f32 v[162:163], v[162:163], v[6:7], v[8:9]
    v_pk_fma_f32 v[164:165], v[164:165], v[6:7], v[8:9]
    v_pk_fma_f32 v[166:167], v[166:167], v[6:7], v[8:9]
    v_cvt_pk_bf16_f32 v112, v160, v161
    v_cvt_pk_bf16_f32 v113, v162, v163
    v_cvt_pk_bf16_f32 v114, v164, v165
    v_cvt_pk_bf16_f32 v115, v166, v167
    ds_write_b128 v10, v[112:115] offset:6144
    v_lshlrev_b32 v168, 16, v116
    v_and_b32 v169, s16, v116
    v_lshlrev_b32 v170, 16, v117
    v_and_b32 v171, s16, v117
    v_lshlrev_b32 v172, 16, v118
    v_and_b32 v173, s16, v118
    v_lshlrev_b32 v174, 16, v119
    v_and_b32 v175, s16, v119
    v_pk_fma_f32 v[168:169], v[168:169], v[6:7], v[8:9]
    v_pk_fma_f32 v[170:171], v[170:171], v[6:7], v[8:9]
    v_pk_fma_f32 v[172:173], v[172:173], v[6:7], v[8:9]
    v_pk_fma_f32 v[174:175], v[174:175], v[6:7], v[8:9]
    v_cvt_pk_bf16_f32 v116, v168, v169
    v_cvt_pk_bf16_f32 v117, v170, v171
    v_cvt_pk_bf16_f32 v118, v172, v173
    v_cvt_pk_bf16_f32 v119, v174, v175
    ds_write_b128 v10, v[116:119] offset:7168
    v_lshlrev_b32 v160, 16, v120
    v_and_b32 v161, s16, v120
    v_lshlrev_b32 v162, 16, v121
    v_and_b32 v163, s16, v121
    v_lshlrev_b32 v164, 16, v122
    v_and_b32 v165, s16, v122
    v_lshlrev_b32 v166, 16, v123
    v_and_b32 v167, s16, v123
    v_pk_fma_f32 v[160:161], v[160:161], v[6:7], v[8:9]
    v_pk_fma_f32 v[162:163], v[162:163], v[6:7], v[8:9]
    v_pk_fma_f32 v[164:165], v[164:165], v[6:7], v[8:9]
    v_pk_fma_f32 v[166:167], v[166:167], v[6:7], v[8:9]
    v_cvt_pk_bf16_f32 v120, v160, v161
    v_cvt_pk_bf16_f32 v121, v162, v163
    v_cvt_pk_bf16_f32 v122, v164, v165
    v_cvt_pk_bf16_f32 v123, v166, v167
    ds_write_b128 v10, v[120:123] offset:8192
    v_lshlrev_b32 v168, 16, v124
    v_and_b32 v169, s16, v124
    v_lshlrev_b32 v170, 16, v125
    v_and_b32 v171, s16, v125
    v_lshlrev_b32 v172, 16, v126
    v_and_b32 v173, s16, v126
    v_lshlrev_b32 v174, 16, v127
    v_and_b32 v175, s16, v127
    v_pk_fma_f32 v[168:169], v[168:169], v[6:7], v[8:9]
    v_pk_fma_f32 v[170:171], v[170:171], v[6:7], v[8:9]
    v_pk_fma_f32 v[172:173], v[172:173], v[6:7], v[8:9]
    v_pk_fma_f32 v[174:175], v[174:175], v[6:7], v[8:9]
    v_cvt_pk_bf16_f32 v124, v168, v169
    v_cvt_pk_bf16_f32 v125, v170, v171
    v_cvt_pk_bf16_f32 v126, v172, v173
    v_cvt_pk_bf16_f32 v127, v174, v175
    ds_write_b128 v10, v[124:127] offset:9216
    v_lshlrev_b32 v160, 16, v128
    v_and_b32 v161, s16, v128
    v_lshlrev_b32 v162, 16, v129
    v_and_b32 v163, s16, v129
    v_lshlrev_b32 v164, 16, v130
    v_and_b32 v165, s16, v130
    v_lshlrev_b32 v166, 16, v131
    v_and_b32 v167, s16, v131
    v_pk_fma_f32 v[160:161], v[160:161], v[6:7], v[8:9]
    v_pk_fma_f32 v[162:163], v[162:163], v[6:7], v[8:9]
    v_pk_fma_f32 v[164:165], v[164:165], v[6:7], v[8:9]
    v_pk_fma_f32 v[166:167], v[166:167], v[6:7], v[8:9]
    v_cvt_pk_bf16_f32 v128, v160, v161
    v_cvt_pk_bf16_f32 v129, v162, v163
    v_cvt_pk_bf16_f32 v130, v164, v165
    v_cvt_pk_bf16_f32 v131, v166, v167
    ds_write_b128 v10, v[128:131] offset:10240
    v_lshlrev_b32 v168, 16, v132
    v_and_b32 v169, s16, v132
    v_lshlrev_b32 v170, 16, v133
    v_and_b32 v171, s16, v133
    v_lshlrev_b32 v172, 16, v134
    v_and_b32 v173, s16, v134
    v_lshlrev_b32 v174, 16, v135
    v_and_b32 v175, s16, v135
    v_pk_fma_f32 v[168:169], v[168:169], v[6:7], v[8:9]
    v_pk_fma_f32 v[170:171], v[170:171], v[6:7], v[8:9]
    v_pk_fma_f32 v[172:173], v[172:173], v[6:7], v[8:9]
    v_pk_fma_f32 v[174:175], v[174:175], v[6:7], v[8:9]
    v_cvt_pk_bf16_f32 v132, v168, v169
    v_cvt_pk_bf16_f32 v133, v170, v171
    v_cvt_pk_bf16_f32 v134, v172, v173
    v_cvt_pk_bf16_f32 v135, v174, v175
    ds_write_b128 v10, v[132:135] offset:11264
    v_lshlrev_b32 v160, 16, v136
    v_and_b32 v161, s16, v136
    v_lshlrev_b32 v162, 16, v137
    v_and_b32 v163, s16, v137
    v_lshlrev_b32 v164, 16, v138
    v_and_b32 v165, s16, v138
    v_lshlrev_b32 v166, 16, v139
    v_and_b32 v167, s16, v139
    v_pk_fma_f32 v[160:161], v[160:161], v[6:7], v[8:9]
    v_pk_fma_f32 v[162:163], v[162:163], v[6:7], v[8:9]
    v_pk_fma_f32 v[164:165], v[164:165], v[6:7], v[8:9]
    v_pk_fma_f32 v[166:167], v[166:167], v[6:7], v[8:9]
    v_cvt_pk_bf16_f32 v136, v160, v161
    v_cvt_pk_bf16_f32 v137, v162, v163
    v_cvt_pk_bf16_f32 v138, v164, v165
    v_cvt_pk_bf16_f32 v139, v166, v167
    ds_write_b128 v10, v[136:139] offset:12288
    v_lshlrev_b32 v168, 16, v140
    v_and_b32 v169, s16, v140
    v_lshlrev_b32 v170, 16, v141
    v_and_b32 v171, s16, v141
    v_lshlrev_b32 v172, 16, v142
    v_and_b32 v173, s16, v142
    v_lshlrev_b32 v174, 16, v143
    v_and_b32 v175, s16, v143
    v_pk_fma_f32 v[168:169], v[168:169], v[6:7], v[8:9]
    v_pk_fma_f32 v[170:171], v[170:171], v[6:7], v[8:9]
    v_pk_fma_f32 v[172:173], v[172:173], v[6:7], v[8:9]
    v_pk_fma_f32 v[174:175], v[174:175], v[6:7], v[8:9]
    v_cvt_pk_bf16_f32 v140, v168, v169
    v_cvt_pk_bf16_f32 v141, v170, v171
    v_cvt_pk_bf16_f32 v142, v172, v173
    v_cvt_pk_bf16_f32 v143, v174, v175
    ds_write_b128 v10, v[140:143] offset:13312
    v_lshlrev_b32 v160, 16, v144
    v_and_b32 v161, s16, v144
    v_lshlrev_b32 v162, 16, v145
    v_and_b32 v163, s16, v145
    v_lshlrev_b32 v164, 16, v146
    v_and_b32 v165, s16, v146
    v_lshlrev_b32 v166, 16, v147
    v_and_b32 v167, s16, v147
    v_pk_fma_f32 v[160:161], v[160:161], v[6:7], v[8:9]
    v_pk_fma_f32 v[162:163], v[162:163], v[6:7], v[8:9]
    v_pk_fma_f32 v[164:165], v[164:165], v[6:7], v[8:9]
    v_pk_fma_f32 v[166:167], v[166:167], v[6:7], v[8:9]
    v_cvt_pk_bf16_f32 v144, v160, v161
    v_cvt_pk_bf16_f32 v145, v162, v163
    v_cvt_pk_bf16_f32 v146, v164, v165
    v_cvt_pk_bf16_f32 v147, v166, v167
    ds_write_b128 v10, v[144:147] offset:14336
    v_lshlrev_b32 v168, 16, v148
    v_and_b32 v169, s16, v148
    v_lshlrev_b32 v170, 16, v149
    v_and_b32 v171, s16, v149
    v_lshlrev_b32 v172, 16, v150
    v_and_b32 v173, s16, v150
    v_lshlrev_b32 v174, 16, v151
    v_and_b32 v175, s16, v151
    v_pk_fma_f32 v[168:169], v[168:169], v[6:7], v[8:9]
    v_pk_fma_f32 v[170:171], v[170:171], v[6:7], v[8:9]
    v_pk_fma_f32 v[172:173], v[172:173], v[6:7], v[8:9]
    v_pk_fma_f32 v[174:175], v[174:175], v[6:7], v[8:9]
    v_cvt_pk_bf16_f32 v148, v168, v169
    v_cvt_pk_bf16_f32 v149, v170, v171
    v_cvt_pk_bf16_f32 v150, v172, v173
    v_cvt_pk_bf16_f32 v151, v174, v175
    ds_write_b128 v10, v[148:151] offset:15360
    v_lshlrev_b32 v160, 16, v152
    v_and_b32 v161, s16, v152
    v_lshlrev_b32 v162, 16, v153
    v_and_b32 v163, s16, v153
    v_lshlrev_b32 v164, 16, v154
    v_and_b32 v165, s16, v154
    v_lshlrev_b32 v166, 16, v155
    v_and_b32 v167, s16, v155
    v_pk_fma_f32 v[160:161], v[160:161], v[6:7], v[8:9]
    v_pk_fma_f32 v[162:163], v[162:163], v[6:7], v[8:9]
    v_pk_fma_f32 v[164:165], v[164:165], v[6:7], v[8:9]
    v_pk_fma_f32 v[166:167], v[166:167], v[6:7], v[8:9]
    v_cvt_pk_bf16_f32 v152, v160, v161
    v_cvt_pk_bf16_f32 v153, v162, v163
    v_cvt_pk_bf16_f32 v154, v164, v165
    v_cvt_pk_bf16_f32 v155, v166, v167
    ds_write_b128 v10, v[152:155] offset:16384
    v_lshlrev_b32 v168, 16, v156
    v_and_b32 v169, s16, v156
    v_lshlrev_b32 v170, 16, v157
    v_and_b32 v171, s16, v157
    v_lshlrev_b32 v172, 16, v158
    v_and_b32 v173, s16, v158
    v_lshlrev_b32 v174, 16, v159
    v_and_b32 v175, s16, v159
    v_pk_fma_f32 v[168:169], v[168:169], v[6:7], v[8:9]
    v_pk_fma_f32 v[170:171], v[170:171], v[6:7], v[8:9]
    v_pk_fma_f32 v[172:173], v[172:173], v[6:7], v[8:9]
    v_pk_fma_f32 v[174:175], v[174:175], v[6:7], v[8:9]
    v_cvt_pk_bf16_f32 v156, v168, v169
    v_cvt_pk_bf16_f32 v157, v170, v171
    v_cvt_pk_bf16_f32 v158, v172, v173
    v_cvt_pk_bf16_f32 v159, v174, v175
    ds_write_b128 v10, v[156:159] offset:17408
    v_add_u32 v11, 36864, v184
    s_waitcnt lgkmcnt(0)
    s_barrier
    ds_read_b128 a[0:3], v184 offset:0
    ds_read_b128 a[72:75], v184 offset:18432
    ds_read_b128 a[144:147], v11 offset:0
    ds_read_b128 a[216:219], v11 offset:18432
    ds_read_b128 a[4:7], v184 offset:1024
    ds_read_b128 a[76:79], v184 offset:19456
    ds_read_b128 a[148:151], v11 offset:1024
    ds_read_b128 a[220:223], v11 offset:19456
    ds_read_b128 a[8:11], v184 offset:2048
    ds_read_b128 a[80:83], v184 offset:20480
    ds_read_b128 a[152:155], v11 offset:2048
    ds_read_b128 a[224:227], v11 offset:20480
    ds_read_b128 a[12:15], v184 offset:3072
    ds_read_b128 a[84:87], v184 offset:21504
    ds_read_b128 a[156:159], v11 offset:3072
    ds_read_b128 a[228:231], v11 offset:21504
    ds_read_b128 a[16:19], v184 offset:4096
    ds_read_b128 a[88:91], v184 offset:22528
    ds_read_b128 a[160:163], v11 offset:4096
    ds_read_b128 a[232:235], v11 offset:22528
    ds_read_b128 a[20:23], v184 offset:5120
    ds_read_b128 a[92:95], v184 offset:23552
    ds_read_b128 a[164:167], v11 offset:5120
    ds_read_b128 a[236:239], v11 offset:23552
    ds_read_b128 a[24:27], v184 offset:6144
    ds_read_b128 a[96:99], v184 offset:24576
    ds_read_b128 a[168:171], v11 offset:6144
    ds_read_b128 a[240:243], v11 offset:24576
    ds_read_b128 a[28:31], v184 offset:7168
    ds_read_b128 a[100:103], v184 offset:25600
    ds_read_b128 a[172:175], v11 offset:7168
    ds_read_b128 a[244:247], v11 offset:25600
    ds_read_b128 a[32:35], v184 offset:8192
    ds_read_b128 a[104:107], v184 offset:26624
    ds_read_b128 a[176:179], v11 offset:8192
    ds_read_b128 a[248:251], v11 offset:26624
    ds_read_b128 a[36:39], v184 offset:9216
    ds_read_b128 a[108:111], v184 offset:27648
    ds_read_b128 a[180:183], v11 offset:9216
    ds_read_b128 a[252:255], v11 offset:27648
    ds_read_b128 a[40:43], v184 offset:10240
    ds_read_b128 a[112:115], v184 offset:28672
    ds_read_b128 a[184:187], v11 offset:10240
    ds_read_b128 v[224:227], v11 offset:28672
    ds_read_b128 a[44:47], v184 offset:11264
    ds_read_b128 a[116:119], v184 offset:29696
    ds_read_b128 a[188:191], v11 offset:11264
    ds_read_b128 v[228:231], v11 offset:29696
    ds_read_b128 a[48:51], v184 offset:12288
    ds_read_b128 a[120:123], v184 offset:30720
    ds_read_b128 a[192:195], v11 offset:12288
    ds_read_b128 v[232:235], v11 offset:30720
    ds_read_b128 a[52:55], v184 offset:13312
    ds_read_b128 a[124:127], v184 offset:31744
    ds_read_b128 a[196:199], v11 offset:13312
    ds_read_b128 v[236:239], v11 offset:31744
    ds_read_b128 a[56:59], v184 offset:14336
    ds_read_b128 a[128:131], v184 offset:32768
    ds_read_b128 a[200:203], v11 offset:14336
    ds_read_b128 v[240:243], v11 offset:32768
    ds_read_b128 a[60:63], v184 offset:15360
    ds_read_b128 a[132:135], v184 offset:33792
    ds_read_b128 a[204:207], v11 offset:15360
    ds_read_b128 v[244:247], v11 offset:33792
    ds_read_b128 a[64:67], v184 offset:16384
    ds_read_b128 a[136:139], v184 offset:34816
    ds_read_b128 a[208:211], v11 offset:16384
    ds_read_b128 v[248:251], v11 offset:34816
    ds_read_b128 a[68:71], v184 offset:17408
    ds_read_b128 a[140:143], v184 offset:35840
    ds_read_b128 a[212:215], v11 offset:17408
    ds_read_b128 v[252:255], v11 offset:35840
    s_lshr_b32 s7, s3, 1
    s_lshl_b32 s7, s7, 10
    s_and_b32 s6, s3, 1
    s_lshl_b32 s6, s6, 3
    s_add_u32 s24, s7, s6
    s_add_u32 s24, s24, 73728
    s_add_u32 s7, s24, 16384
    v_add_u32 v12, s7, v184
    v_mov_b32 v13, 0xbdd2d3e8
    v_mov_b32 v14, 0xc0135761
    s_mov_b32 s25, 0
    s_waitcnt lgkmcnt(0)
L_ffn_gu_7:
    s_waitcnt vmcnt(12)
    v_mfma_f32_16x16x32_bf16 v[88:91], v[16:19], a[0:3], 0
    v_mfma_f32_16x16x32_bf16 v[88:91], v[20:23], a[4:7], v[88:91]
    buffer_load_dwordx4 v[76:79], v184, s[8:11], s23 offen offset:0
    v_mfma_f32_16x16x32_bf16 v[88:91], v[24:27], a[8:11], v[88:91]
    v_mul_f32 v152, v120, v120
    v_mul_f32 v153, v121, v121
    v_mfma_f32_16x16x32_bf16 v[92:95], v[16:19], a[72:75], 0
    v_mul_f32 v154, v122, v122
    v_mul_f32 v155, v123, v123
    v_mfma_f32_16x16x32_bf16 v[92:95], v[20:23], a[76:79], v[92:95]
    v_fma_f32 v152, v152, v13, v14
    v_fma_f32 v153, v153, v13, v14
    v_mfma_f32_16x16x32_bf16 v[92:95], v[24:27], a[80:83], v[92:95]
    buffer_load_dwordx4 v[80:83], v184, s[8:11], s23 offen offset:1024
    v_mfma_f32_16x16x32_bf16 v[96:99], v[16:19], a[144:147], 0
    v_fma_f32 v154, v154, v13, v14
    v_fma_f32 v155, v155, v13, v14
    v_mfma_f32_16x16x32_bf16 v[96:99], v[20:23], a[148:151], v[96:99]
    v_mul_f32 v152, v120, v152
    v_mul_f32 v153, v121, v153
    v_mfma_f32_16x16x32_bf16 v[96:99], v[24:27], a[152:155], v[96:99]
    v_mul_f32 v154, v122, v154
    v_mul_f32 v155, v123, v155
    v_mfma_f32_16x16x32_bf16 v[100:103], v[16:19], a[216:219], 0
    buffer_load_dwordx4 v[84:87], v184, s[8:11], s23 offen offset:2048
    v_mfma_f32_16x16x32_bf16 v[100:103], v[20:23], a[220:223], v[100:103]
    v_exp_f32 v152, v152
    v_mfma_f32_16x16x32_bf16 v[100:103], v[24:27], a[224:227], v[100:103]
    v_exp_f32 v153, v153
    s_waitcnt vmcnt(12)
    v_mfma_f32_16x16x32_bf16 v[104:107], v[28:31], a[0:3], 0
    v_exp_f32 v154, v154
    v_mfma_f32_16x16x32_bf16 v[104:107], v[32:35], a[4:7], v[104:107]
    buffer_load_dwordx4 v[16:19], v184, s[8:11], s23 offen offset:3072
    v_mfma_f32_16x16x32_bf16 v[104:107], v[36:39], a[8:11], v[104:107]
    v_exp_f32 v155, v155
    v_mfma_f32_16x16x32_bf16 v[108:111], v[28:31], a[72:75], 0
    v_mul_f32 v156, v120, v136
    v_mul_f32 v157, v121, v137
    v_mfma_f32_16x16x32_bf16 v[108:111], v[32:35], a[76:79], v[108:111]
    v_mul_f32 v158, v122, v138
    v_mul_f32 v159, v123, v139
    v_mfma_f32_16x16x32_bf16 v[108:111], v[36:39], a[80:83], v[108:111]
    buffer_load_dwordx4 v[20:23], v185, s[8:11], s23 offen offset:0
    v_mfma_f32_16x16x32_bf16 v[112:115], v[28:31], a[144:147], 0
    v_add_f32 v152, 1.0, v152
    v_add_f32 v153, 1.0, v153
    v_mfma_f32_16x16x32_bf16 v[112:115], v[32:35], a[148:151], v[112:115]
    v_add_f32 v154, 1.0, v154
    v_add_f32 v155, 1.0, v155
    v_mfma_f32_16x16x32_bf16 v[112:115], v[36:39], a[152:155], v[112:115]
    v_rcp_f32 v152, v152
    v_mfma_f32_16x16x32_bf16 v[116:119], v[28:31], a[216:219], 0
    buffer_load_dwordx4 v[24:27], v185, s[8:11], s23 offen offset:1024
    v_mfma_f32_16x16x32_bf16 v[116:119], v[32:35], a[220:223], v[116:119]
    v_rcp_f32 v153, v153
    v_mfma_f32_16x16x32_bf16 v[116:119], v[36:39], a[224:227], v[116:119]
    v_rcp_f32 v154, v154
    s_waitcnt vmcnt(12)
    v_mfma_f32_16x16x32_bf16 v[88:91], v[40:43], a[12:15], v[88:91]
    v_rcp_f32 v155, v155
    v_mfma_f32_16x16x32_bf16 v[88:91], v[44:47], a[16:19], v[88:91]
    buffer_load_dwordx4 v[28:31], v185, s[8:11], s23 offen offset:2048
    v_mfma_f32_16x16x32_bf16 v[88:91], v[48:51], a[20:23], v[88:91]
    v_mul_f32 v156, v156, v152
    v_mul_f32 v157, v157, v153
    v_mfma_f32_16x16x32_bf16 v[92:95], v[40:43], a[84:87], v[92:95]
    v_mul_f32 v158, v158, v154
    v_mul_f32 v159, v159, v155
    v_mfma_f32_16x16x32_bf16 v[92:95], v[44:47], a[88:91], v[92:95]
    v_cvt_pk_bf16_f32 v160, v156, v157
    v_cvt_pk_bf16_f32 v161, v158, v159
    v_mfma_f32_16x16x32_bf16 v[92:95], v[48:51], a[92:95], v[92:95]
    buffer_load_dwordx4 v[32:35], v185, s[8:11], s23 offen offset:3072
    v_mfma_f32_16x16x32_bf16 v[96:99], v[40:43], a[156:159], v[96:99]
    ds_write_b64 v12, v[160:161] offset:0
    v_mfma_f32_16x16x32_bf16 v[96:99], v[44:47], a[160:163], v[96:99]
    v_mul_f32 v162, v124, v124
    v_mul_f32 v163, v125, v125
    v_mfma_f32_16x16x32_bf16 v[96:99], v[48:51], a[164:167], v[96:99]
    v_mul_f32 v164, v126, v126
    v_mul_f32 v165, v127, v127
    v_mfma_f32_16x16x32_bf16 v[100:103], v[40:43], a[228:231], v[100:103]
    buffer_load_dwordx4 v[36:39], v186, s[8:11], s23 offen offset:0
    v_mfma_f32_16x16x32_bf16 v[100:103], v[44:47], a[232:235], v[100:103]
    v_fma_f32 v162, v162, v13, v14
    v_fma_f32 v163, v163, v13, v14
    v_mfma_f32_16x16x32_bf16 v[100:103], v[48:51], a[236:239], v[100:103]
    v_fma_f32 v164, v164, v13, v14
    v_fma_f32 v165, v165, v13, v14
    s_waitcnt vmcnt(12)
    v_mfma_f32_16x16x32_bf16 v[104:107], v[52:55], a[12:15], v[104:107]
    v_mul_f32 v162, v124, v162
    v_mul_f32 v163, v125, v163
    v_mfma_f32_16x16x32_bf16 v[104:107], v[56:59], a[16:19], v[104:107]
    buffer_load_dwordx4 v[40:43], v186, s[8:11], s23 offen offset:1024
    v_mfma_f32_16x16x32_bf16 v[104:107], v[60:63], a[20:23], v[104:107]
    v_mul_f32 v164, v126, v164
    v_mul_f32 v165, v127, v165
    v_mfma_f32_16x16x32_bf16 v[108:111], v[52:55], a[84:87], v[108:111]
    v_exp_f32 v162, v162
    v_mfma_f32_16x16x32_bf16 v[108:111], v[56:59], a[88:91], v[108:111]
    v_exp_f32 v163, v163
    v_mfma_f32_16x16x32_bf16 v[108:111], v[60:63], a[92:95], v[108:111]
    buffer_load_dwordx4 v[44:47], v186, s[8:11], s23 offen offset:2048
    v_mfma_f32_16x16x32_bf16 v[112:115], v[52:55], a[156:159], v[112:115]
    v_exp_f32 v164, v164
    v_mfma_f32_16x16x32_bf16 v[112:115], v[56:59], a[160:163], v[112:115]
    v_exp_f32 v165, v165
    v_mfma_f32_16x16x32_bf16 v[112:115], v[60:63], a[164:167], v[112:115]
    v_mul_f32 v166, v124, v140
    v_mul_f32 v167, v125, v141
    v_mfma_f32_16x16x32_bf16 v[116:119], v[52:55], a[228:231], v[116:119]
    buffer_load_dwordx4 v[48:51], v186, s[8:11], s23 offen offset:3072
    v_mfma_f32_16x16x32_bf16 v[116:119], v[56:59], a[232:235], v[116:119]
    v_mul_f32 v168, v126, v142
    v_mul_f32 v169, v127, v143
    v_mfma_f32_16x16x32_bf16 v[116:119], v[60:63], a[236:239], v[116:119]
    v_add_f32 v162, 1.0, v162
    v_add_f32 v163, 1.0, v163
    s_waitcnt vmcnt(12)
    v_mfma_f32_16x16x32_bf16 v[88:91], v[64:67], a[24:27], v[88:91]
    v_add_f32 v164, 1.0, v164
    v_add_f32 v165, 1.0, v165
    v_mfma_f32_16x16x32_bf16 v[88:91], v[68:71], a[28:31], v[88:91]
    buffer_load_dwordx4 v[52:55], v187, s[8:11], s23 offen offset:0
    v_mfma_f32_16x16x32_bf16 v[88:91], v[72:75], a[32:35], v[88:91]
    v_rcp_f32 v162, v162
    v_mfma_f32_16x16x32_bf16 v[92:95], v[64:67], a[96:99], v[92:95]
    v_rcp_f32 v163, v163
    v_mfma_f32_16x16x32_bf16 v[92:95], v[68:71], a[100:103], v[92:95]
    v_rcp_f32 v164, v164
    v_mfma_f32_16x16x32_bf16 v[92:95], v[72:75], a[104:107], v[92:95]
    buffer_load_dwordx4 v[56:59], v187, s[8:11], s23 offen offset:1024
    v_mfma_f32_16x16x32_bf16 v[96:99], v[64:67], a[168:171], v[96:99]
    v_rcp_f32 v165, v165
    v_mfma_f32_16x16x32_bf16 v[96:99], v[68:71], a[172:175], v[96:99]
    v_mul_f32 v166, v166, v162
    v_mul_f32 v167, v167, v163
    v_mfma_f32_16x16x32_bf16 v[96:99], v[72:75], a[176:179], v[96:99]
    v_mul_f32 v168, v168, v164
    v_mul_f32 v169, v169, v165
    v_mfma_f32_16x16x32_bf16 v[100:103], v[64:67], a[240:243], v[100:103]
    buffer_load_dwordx4 v[60:63], v187, s[8:11], s23 offen offset:2048
    v_mfma_f32_16x16x32_bf16 v[100:103], v[68:71], a[244:247], v[100:103]
    v_cvt_pk_bf16_f32 v170, v166, v167
    v_cvt_pk_bf16_f32 v171, v168, v169
    v_mfma_f32_16x16x32_bf16 v[100:103], v[72:75], a[248:251], v[100:103]
    ds_write_b64 v12, v[170:171] offset:18432
    s_waitcnt vmcnt(12)
    v_mfma_f32_16x16x32_bf16 v[104:107], v[76:79], a[24:27], v[104:107]
    v_mul_f32 v152, v128, v128
    v_mul_f32 v153, v129, v129
    v_mfma_f32_16x16x32_bf16 v[104:107], v[80:83], a[28:31], v[104:107]
    buffer_load_dwordx4 v[64:67], v187, s[8:11], s23 offen offset:3072
    v_mfma_f32_16x16x32_bf16 v[104:107], v[84:87], a[32:35], v[104:107]
    v_mul_f32 v154, v130, v130
    v_mul_f32 v155, v131, v131
    v_mfma_f32_16x16x32_bf16 v[108:111], v[76:79], a[96:99], v[108:111]
    v_fma_f32 v152, v152, v13, v14
    v_fma_f32 v153, v153, v13, v14
    v_mfma_f32_16x16x32_bf16 v[108:111], v[80:83], a[100:103], v[108:111]
    v_fma_f32 v154, v154, v13, v14
    v_fma_f32 v155, v155, v13, v14
    v_mfma_f32_16x16x32_bf16 v[108:111], v[84:87], a[104:107], v[108:111]
    buffer_load_dwordx4 v[68:71], v188, s[8:11], s23 offen offset:0
    v_mfma_f32_16x16x32_bf16 v[112:115], v[76:79], a[168:171], v[112:115]
    v_mul_f32 v152, v128, v152
    v_mul_f32 v153, v129, v153
    v_mfma_f32_16x16x32_bf16 v[112:115], v[80:83], a[172:175], v[112:115]
    v_mul_f32 v154, v130, v154
    v_mul_f32 v155, v131, v155
    v_mfma_f32_16x16x32_bf16 v[112:115], v[84:87], a[176:179], v[112:115]
    v_exp_f32 v152, v152
    v_mfma_f32_16x16x32_bf16 v[116:119], v[76:79], a[240:243], v[116:119]
    buffer_load_dwordx4 v[72:75], v188, s[8:11], s23 offen offset:1024
    v_mfma_f32_16x16x32_bf16 v[116:119], v[80:83], a[244:247], v[116:119]
    v_exp_f32 v153, v153
    v_mfma_f32_16x16x32_bf16 v[116:119], v[84:87], a[248:251], v[116:119]
    v_exp_f32 v154, v154
    s_waitcnt vmcnt(12)
    v_mfma_f32_16x16x32_bf16 v[88:91], v[16:19], a[36:39], v[88:91]
    v_exp_f32 v155, v155
    v_mfma_f32_16x16x32_bf16 v[88:91], v[20:23], a[40:43], v[88:91]
    buffer_load_dwordx4 v[76:79], v188, s[8:11], s23 offen offset:2048
    v_mfma_f32_16x16x32_bf16 v[88:91], v[24:27], a[44:47], v[88:91]
    v_mul_f32 v156, v128, v144
    v_mul_f32 v157, v129, v145
    v_mfma_f32_16x16x32_bf16 v[92:95], v[16:19], a[108:111], v[92:95]
    v_mul_f32 v158, v130, v146
    v_mul_f32 v159, v131, v147
    v_mfma_f32_16x16x32_bf16 v[92:95], v[20:23], a[112:115], v[92:95]
    v_add_f32 v152, 1.0, v152
    v_add_f32 v153, 1.0, v153
    v_mfma_f32_16x16x32_bf16 v[92:95], v[24:27], a[116:119], v[92:95]
    buffer_load_dwordx4 v[80:83], v188, s[8:11], s23 offen offset:3072
    v_mfma_f32_16x16x32_bf16 v[96:99], v[16:19], a[180:183], v[96:99]
    v_add_f32 v154, 1.0, v154
    v_add_f32 v155, 1.0, v155
    v_mfma_f32_16x16x32_bf16 v[96:99], v[20:23], a[184:187], v[96:99]
    v_rcp_f32 v152, v152
    v_mfma_f32_16x16x32_bf16 v[96:99], v[24:27], a[188:191], v[96:99]
    v_rcp_f32 v153, v153
    v_mfma_f32_16x16x32_bf16 v[100:103], v[16:19], a[252:255], v[100:103]
    buffer_load_dwordx4 v[84:87], v189, s[8:11], s23 offen offset:0
    v_mfma_f32_16x16x32_bf16 v[100:103], v[20:23], v[224:227], v[100:103]
    v_rcp_f32 v154, v154
    v_mfma_f32_16x16x32_bf16 v[100:103], v[24:27], v[228:231], v[100:103]
    v_rcp_f32 v155, v155
    s_waitcnt vmcnt(12)
    v_mfma_f32_16x16x32_bf16 v[104:107], v[28:31], a[36:39], v[104:107]
    v_mul_f32 v156, v156, v152
    v_mul_f32 v157, v157, v153
    v_mfma_f32_16x16x32_bf16 v[104:107], v[32:35], a[40:43], v[104:107]
    buffer_load_dwordx4 v[16:19], v189, s[8:11], s23 offen offset:1024
    v_mfma_f32_16x16x32_bf16 v[104:107], v[36:39], a[44:47], v[104:107]
    v_mul_f32 v158, v158, v154
    v_mul_f32 v159, v159, v155
    v_mfma_f32_16x16x32_bf16 v[108:111], v[28:31], a[108:111], v[108:111]
    v_cvt_pk_bf16_f32 v160, v156, v157
    v_cvt_pk_bf16_f32 v161, v158, v159
    v_mfma_f32_16x16x32_bf16 v[108:111], v[32:35], a[112:115], v[108:111]
    ds_write_b64 v12, v[160:161] offset:36864
    v_mfma_f32_16x16x32_bf16 v[108:111], v[36:39], a[116:119], v[108:111]
    buffer_load_dwordx4 v[20:23], v189, s[8:11], s23 offen offset:2048
    v_mfma_f32_16x16x32_bf16 v[112:115], v[28:31], a[180:183], v[112:115]
    v_mul_f32 v162, v132, v132
    v_mul_f32 v163, v133, v133
    v_mfma_f32_16x16x32_bf16 v[112:115], v[32:35], a[184:187], v[112:115]
    v_mul_f32 v164, v134, v134
    v_mul_f32 v165, v135, v135
    v_mfma_f32_16x16x32_bf16 v[112:115], v[36:39], a[188:191], v[112:115]
    v_fma_f32 v162, v162, v13, v14
    v_fma_f32 v163, v163, v13, v14
    v_mfma_f32_16x16x32_bf16 v[116:119], v[28:31], a[252:255], v[116:119]
    buffer_load_dwordx4 v[24:27], v189, s[8:11], s23 offen offset:3072
    v_mfma_f32_16x16x32_bf16 v[116:119], v[32:35], v[224:227], v[116:119]
    v_fma_f32 v164, v164, v13, v14
    v_fma_f32 v165, v165, v13, v14
    v_mfma_f32_16x16x32_bf16 v[116:119], v[36:39], v[228:231], v[116:119]
    v_mul_f32 v162, v132, v162
    v_mul_f32 v163, v133, v163
    s_waitcnt vmcnt(12)
    v_mfma_f32_16x16x32_bf16 v[88:91], v[40:43], a[48:51], v[88:91]
    v_mul_f32 v164, v134, v164
    v_mul_f32 v165, v135, v165
    v_mfma_f32_16x16x32_bf16 v[88:91], v[44:47], a[52:55], v[88:91]
    buffer_load_dwordx4 v[28:31], v190, s[8:11], s23 offen offset:0
    v_mfma_f32_16x16x32_bf16 v[88:91], v[48:51], a[56:59], v[88:91]
    v_exp_f32 v162, v162
    v_mfma_f32_16x16x32_bf16 v[92:95], v[40:43], a[120:123], v[92:95]
    v_exp_f32 v163, v163
    v_mfma_f32_16x16x32_bf16 v[92:95], v[44:47], a[124:127], v[92:95]
    v_exp_f32 v164, v164
    v_mfma_f32_16x16x32_bf16 v[92:95], v[48:51], a[128:131], v[92:95]
    buffer_load_dwordx4 v[32:35], v190, s[8:11], s23 offen offset:1024
    v_mfma_f32_16x16x32_bf16 v[96:99], v[40:43], a[192:195], v[96:99]
    v_exp_f32 v165, v165
    v_mfma_f32_16x16x32_bf16 v[96:99], v[44:47], a[196:199], v[96:99]
    v_mul_f32 v166, v132, v148
    v_mul_f32 v167, v133, v149
    v_mfma_f32_16x16x32_bf16 v[96:99], v[48:51], a[200:203], v[96:99]
    v_mul_f32 v168, v134, v150
    v_mul_f32 v169, v135, v151
    v_mfma_f32_16x16x32_bf16 v[100:103], v[40:43], v[232:235], v[100:103]
    buffer_load_dwordx4 v[36:39], v190, s[8:11], s23 offen offset:2048
    v_mfma_f32_16x16x32_bf16 v[100:103], v[44:47], v[236:239], v[100:103]
    v_add_f32 v162, 1.0, v162
    v_add_f32 v163, 1.0, v163
    v_mfma_f32_16x16x32_bf16 v[100:103], v[48:51], v[240:243], v[100:103]
    v_add_f32 v164, 1.0, v164
    v_add_f32 v165, 1.0, v165
    s_waitcnt vmcnt(12)
    v_mfma_f32_16x16x32_bf16 v[104:107], v[52:55], a[48:51], v[104:107]
    v_rcp_f32 v162, v162
    v_mfma_f32_16x16x32_bf16 v[104:107], v[56:59], a[52:55], v[104:107]
    buffer_load_dwordx4 v[40:43], v190, s[8:11], s23 offen offset:3072
    v_mfma_f32_16x16x32_bf16 v[104:107], v[60:63], a[56:59], v[104:107]
    v_rcp_f32 v163, v163
    v_mfma_f32_16x16x32_bf16 v[108:111], v[52:55], a[120:123], v[108:111]
    v_rcp_f32 v164, v164
    v_mfma_f32_16x16x32_bf16 v[108:111], v[56:59], a[124:127], v[108:111]
    v_rcp_f32 v165, v165
    v_mfma_f32_16x16x32_bf16 v[108:111], v[60:63], a[128:131], v[108:111]
    buffer_load_dwordx4 v[44:47], v191, s[8:11], s23 offen offset:0
    v_mfma_f32_16x16x32_bf16 v[112:115], v[52:55], a[192:195], v[112:115]
    v_mul_f32 v166, v166, v162
    v_mul_f32 v167, v167, v163
    v_mfma_f32_16x16x32_bf16 v[112:115], v[56:59], a[196:199], v[112:115]
    v_mul_f32 v168, v168, v164
    v_mul_f32 v169, v169, v165
    v_mfma_f32_16x16x32_bf16 v[112:115], v[60:63], a[200:203], v[112:115]
    v_cvt_pk_bf16_f32 v170, v166, v167
    v_cvt_pk_bf16_f32 v171, v168, v169
    v_mfma_f32_16x16x32_bf16 v[116:119], v[52:55], v[232:235], v[116:119]
    buffer_load_dwordx4 v[48:51], v191, s[8:11], s23 offen offset:1024
    v_mfma_f32_16x16x32_bf16 v[116:119], v[56:59], v[236:239], v[116:119]
    ds_write_b64 v12, v[170:171] offset:55296
    v_mfma_f32_16x16x32_bf16 v[116:119], v[60:63], v[240:243], v[116:119]
    s_waitcnt vmcnt(12)
    v_mfma_f32_16x16x32_bf16 v[88:91], v[64:67], a[60:63], v[88:91]
    v_mfma_f32_16x16x32_bf16 v[88:91], v[68:71], a[64:67], v[88:91]
    buffer_load_dwordx4 v[52:55], v191, s[8:11], s23 offen offset:2048
    v_mfma_f32_16x16x32_bf16 v[120:123], v[72:75], a[68:71], v[88:91]
    v_mfma_f32_16x16x32_bf16 v[92:95], v[64:67], a[132:135], v[92:95]
    v_mfma_f32_16x16x32_bf16 v[92:95], v[68:71], a[136:139], v[92:95]
    v_mfma_f32_16x16x32_bf16 v[124:127], v[72:75], a[140:143], v[92:95]
    buffer_load_dwordx4 v[56:59], v191, s[8:11], s23 offen offset:3072
    v_mfma_f32_16x16x32_bf16 v[96:99], v[64:67], a[204:207], v[96:99]
    v_mfma_f32_16x16x32_bf16 v[96:99], v[68:71], a[208:211], v[96:99]
    v_mfma_f32_16x16x32_bf16 v[128:131], v[72:75], a[212:215], v[96:99]
    v_mfma_f32_16x16x32_bf16 v[100:103], v[64:67], v[244:247], v[100:103]
    buffer_load_dwordx4 v[60:63], v192, s[8:11], s23 offen offset:0
    v_mfma_f32_16x16x32_bf16 v[100:103], v[68:71], v[248:251], v[100:103]
    v_mfma_f32_16x16x32_bf16 v[132:135], v[72:75], v[252:255], v[100:103]
    s_waitcnt vmcnt(12)
    v_mfma_f32_16x16x32_bf16 v[104:107], v[76:79], a[60:63], v[104:107]
    v_mfma_f32_16x16x32_bf16 v[104:107], v[80:83], a[64:67], v[104:107]
    buffer_load_dwordx4 v[64:67], v192, s[8:11], s23 offen offset:1024
    v_mfma_f32_16x16x32_bf16 v[136:139], v[84:87], a[68:71], v[104:107]
    v_mfma_f32_16x16x32_bf16 v[108:111], v[76:79], a[132:135], v[108:111]
    v_mfma_f32_16x16x32_bf16 v[108:111], v[80:83], a[136:139], v[108:111]
    v_mfma_f32_16x16x32_bf16 v[140:143], v[84:87], a[140:143], v[108:111]
    buffer_load_dwordx4 v[68:71], v192, s[8:11], s23 offen offset:2048
    v_mfma_f32_16x16x32_bf16 v[112:115], v[76:79], a[204:207], v[112:115]
    v_mfma_f32_16x16x32_bf16 v[112:115], v[80:83], a[208:211], v[112:115]
    s_lshl_b32 s7, s25, 11
    v_mfma_f32_16x16x32_bf16 v[144:147], v[84:87], a[212:215], v[112:115]
    s_add_u32 s7, s7, s24
    v_mfma_f32_16x16x32_bf16 v[116:119], v[76:79], v[244:247], v[116:119]
    buffer_load_dwordx4 v[72:75], v192, s[8:11], s23 offen offset:3072
    v_mfma_f32_16x16x32_bf16 v[116:119], v[80:83], v[248:251], v[116:119]
    s_add_u32 s23, s23, 36864
    v_mfma_f32_16x16x32_bf16 v[148:151], v[84:87], v[252:255], v[116:119]
    v_add_u32 v12, s7, v184
    s_add_u32 s25, s25, 1
    s_cmp_lt_u32 s25, 9
    s_cbranch_scc1 L_ffn_gu_7
    v_add_u32 v10, 73728, v184
    v_add_u32 v11, 110592, v184
    s_waitcnt lgkmcnt(0)
    s_barrier
    v_mul_f32 v152, v120, v120
    ds_read_b128 a[0:3], v10 offset:0
    v_mul_f32 v153, v121, v121
    v_mul_f32 v154, v122, v122
    v_mul_f32 v155, v123, v123
    ds_read_b128 a[72:75], v10 offset:18432
    v_fma_f32 v152, v152, v13, v14
    v_fma_f32 v153, v153, v13, v14
    v_fma_f32 v154, v154, v13, v14
    ds_read_b128 a[144:147], v11 offset:0
    v_fma_f32 v155, v155, v13, v14
    v_mul_f32 v152, v120, v152
    v_mul_f32 v153, v121, v153
    ds_read_b128 a[216:219], v11 offset:18432
    v_mul_f32 v154, v122, v154
    v_mul_f32 v155, v123, v155
    v_exp_f32 v152, v152
    ds_read_b128 a[4:7], v10 offset:1024
    v_exp_f32 v153, v153
    ds_read_b128 a[76:79], v10 offset:19456
    v_exp_f32 v154, v154
    ds_read_b128 a[148:151], v11 offset:1024
    v_exp_f32 v155, v155
    ds_read_b128 a[220:223], v11 offset:19456
    v_mul_f32 v156, v120, v136
    v_mul_f32 v157, v121, v137
    v_mul_f32 v158, v122, v138
    ds_read_b128 a[8:11], v10 offset:2048
    v_mul_f32 v159, v123, v139
    v_add_f32 v152, 1.0, v152
    v_add_f32 v153, 1.0, v153
    ds_read_b128 a[80:83], v10 offset:20480
    v_add_f32 v154, 1.0, v154
    v_add_f32 v155, 1.0, v155
    v_rcp_f32 v152, v152
    ds_read_b128 a[152:155], v11 offset:2048
    v_rcp_f32 v153, v153
    ds_read_b128 a[224:227], v11 offset:20480
    v_rcp_f32 v154, v154
    ds_read_b128 a[12:15], v10 offset:3072
    v_rcp_f32 v155, v155
    ds_read_b128 a[84:87], v10 offset:21504
    v_mul_f32 v156, v156, v152
    v_mul_f32 v157, v157, v153
    v_mul_f32 v158, v158, v154
    ds_read_b128 a[156:159], v11 offset:3072
    v_mul_f32 v159, v159, v155
    v_cvt_pk_bf16_f32 v160, v156, v157
    v_cvt_pk_bf16_f32 v161, v158, v159
    ds_read_b128 a[228:231], v11 offset:21504
    ds_write_b64 v12, v[160:161] offset:0
    v_mul_f32 v162, v124, v124
    v_mul_f32 v163, v125, v125
    ds_read_b128 a[16:19], v10 offset:4096
    v_mul_f32 v164, v126, v126
    v_mul_f32 v165, v127, v127
    v_fma_f32 v162, v162, v13, v14
    ds_read_b128 a[88:91], v10 offset:22528
    v_fma_f32 v163, v163, v13, v14
    v_fma_f32 v164, v164, v13, v14
    v_fma_f32 v165, v165, v13, v14
    ds_read_b128 a[160:163], v11 offset:4096
    v_mul_f32 v162, v124, v162
    v_mul_f32 v163, v125, v163
    v_mul_f32 v164, v126, v164
    ds_read_b128 a[232:235], v11 offset:22528
    v_mul_f32 v165, v127, v165
    v_exp_f32 v162, v162
    ds_read_b128 a[20:23], v10 offset:5120
    v_exp_f32 v163, v163
    ds_read_b128 a[92:95], v10 offset:23552
    v_exp_f32 v164, v164
    ds_read_b128 a[164:167], v11 offset:5120
    v_exp_f32 v165, v165
    ds_read_b128 a[236:239], v11 offset:23552
    v_mul_f32 v166, v124, v140
    ds_read_b128 a[24:27], v10 offset:6144
    v_mul_f32 v167, v125, v141
    v_mul_f32 v168, v126, v142
    v_mul_f32 v169, v127, v143
    ds_read_b128 a[96:99], v10 offset:24576
    v_add_f32 v162, 1.0, v162
    v_add_f32 v163, 1.0, v163
    v_add_f32 v164, 1.0, v164
    ds_read_b128 a[168:171], v11 offset:6144
    v_add_f32 v165, 1.0, v165
    v_rcp_f32 v162, v162
    ds_read_b128 a[240:243], v11 offset:24576
    v_rcp_f32 v163, v163
    ds_read_b128 a[28:31], v10 offset:7168
    v_rcp_f32 v164, v164
    ds_read_b128 a[100:103], v10 offset:25600
    v_rcp_f32 v165, v165
    ds_read_b128 a[172:175], v11 offset:7168
    v_mul_f32 v166, v166, v162
    ds_read_b128 a[244:247], v11 offset:25600
    v_mul_f32 v167, v167, v163
    v_mul_f32 v168, v168, v164
    v_mul_f32 v169, v169, v165
    ds_read_b128 a[32:35], v10 offset:8192
    v_cvt_pk_bf16_f32 v170, v166, v167
    v_cvt_pk_bf16_f32 v171, v168, v169
    ds_write_b64 v12, v[170:171] offset:18432
    ds_read_b128 a[104:107], v10 offset:26624
    v_mul_f32 v152, v128, v128
    v_mul_f32 v153, v129, v129
    v_mul_f32 v154, v130, v130
    ds_read_b128 a[176:179], v11 offset:8192
    v_mul_f32 v155, v131, v131
    v_fma_f32 v152, v152, v13, v14
    v_fma_f32 v153, v153, v13, v14
    ds_read_b128 a[248:251], v11 offset:26624
    v_fma_f32 v154, v154, v13, v14
    v_fma_f32 v155, v155, v13, v14
    v_mul_f32 v152, v128, v152
    ds_read_b128 a[36:39], v10 offset:9216
    v_mul_f32 v153, v129, v153
    v_mul_f32 v154, v130, v154
    v_mul_f32 v155, v131, v155
    ds_read_b128 a[108:111], v10 offset:27648
    v_exp_f32 v152, v152
    ds_read_b128 a[180:183], v11 offset:9216
    v_exp_f32 v153, v153
    ds_read_b128 a[252:255], v11 offset:27648
    v_exp_f32 v154, v154
    ds_read_b128 a[40:43], v10 offset:10240
    v_exp_f32 v155, v155
    ds_read_b128 a[112:115], v10 offset:28672
    v_mul_f32 v156, v128, v144
    v_mul_f32 v157, v129, v145
    ds_read_b128 a[184:187], v11 offset:10240
    v_mul_f32 v158, v130, v146
    v_mul_f32 v159, v131, v147
    v_add_f32 v152, 1.0, v152
    ds_read_b128 v[224:227], v11 offset:28672
    v_add_f32 v153, 1.0, v153
    v_add_f32 v154, 1.0, v154
    v_add_f32 v155, 1.0, v155
    ds_read_b128 a[44:47], v10 offset:11264
    v_rcp_f32 v152, v152
    ds_read_b128 a[116:119], v10 offset:29696
    v_rcp_f32 v153, v153
    ds_read_b128 a[188:191], v11 offset:11264
    v_rcp_f32 v154, v154
    ds_read_b128 v[228:231], v11 offset:29696
    v_rcp_f32 v155, v155
    ds_read_b128 a[48:51], v10 offset:12288
    v_mul_f32 v156, v156, v152
    v_mul_f32 v157, v157, v153
    ds_read_b128 a[120:123], v10 offset:30720
    v_mul_f32 v158, v158, v154
    v_mul_f32 v159, v159, v155
    v_cvt_pk_bf16_f32 v160, v156, v157
    ds_read_b128 a[192:195], v11 offset:12288
    v_cvt_pk_bf16_f32 v161, v158, v159
    ds_write_b64 v12, v[160:161] offset:36864
    v_mul_f32 v162, v132, v132
    ds_read_b128 v[232:235], v11 offset:30720
    v_mul_f32 v163, v133, v133
    v_mul_f32 v164, v134, v134
    v_mul_f32 v165, v135, v135
    ds_read_b128 a[52:55], v10 offset:13312
    v_fma_f32 v162, v162, v13, v14
    v_fma_f32 v163, v163, v13, v14
    v_fma_f32 v164, v164, v13, v14
    ds_read_b128 a[124:127], v10 offset:31744
    v_fma_f32 v165, v165, v13, v14
    v_mul_f32 v162, v132, v162
    v_mul_f32 v163, v133, v163
    ds_read_b128 a[196:199], v11 offset:13312
    v_mul_f32 v164, v134, v164
    v_mul_f32 v165, v135, v165
    v_exp_f32 v162, v162
    ds_read_b128 v[236:239], v11 offset:31744
    v_exp_f32 v163, v163
    ds_read_b128 a[56:59], v10 offset:14336
    v_exp_f32 v164, v164
    ds_read_b128 a[128:131], v10 offset:32768
    v_exp_f32 v165, v165
    ds_read_b128 a[200:203], v11 offset:14336
    v_mul_f32 v166, v132, v148
    v_mul_f32 v167, v133, v149
    v_mul_f32 v168, v134, v150
    ds_read_b128 v[240:243], v11 offset:32768
    v_mul_f32 v169, v135, v151
    v_add_f32 v162, 1.0, v162
    v_add_f32 v163, 1.0, v163
    ds_read_b128 a[60:63], v10 offset:15360
    v_add_f32 v164, 1.0, v164
    v_add_f32 v165, 1.0, v165
    v_rcp_f32 v162, v162
    ds_read_b128 a[132:135], v10 offset:33792
    v_rcp_f32 v163, v163
    ds_read_b128 a[204:207], v11 offset:15360
    v_rcp_f32 v164, v164
    ds_read_b128 v[244:247], v11 offset:33792
    v_rcp_f32 v165, v165
    v_mul_f32 v166, v166, v162
    v_mul_f32 v167, v167, v163
    v_mul_f32 v168, v168, v164
    v_mul_f32 v169, v169, v165
    v_cvt_pk_bf16_f32 v170, v166, v167
    v_cvt_pk_bf16_f32 v171, v168, v169
    ds_write_b64 v12, v[170:171] offset:55296
    v_bfe_u32 v4, v0, 3, 2
    s_mov_b32 s7, 73728
    v_mul_lo_u32 v2, v4, s7
    v_lshrrev_b32 v4, 5, v0
    v_lshl_add_u32 v2, v4, 7, v2
    v_and_b32 v4, 7, v0
    v_lshl_add_u32 v2, v4, 4, v2
    v_add_u32 v3, 294912, v2
    s_mul_i32 s26, s21, 589824
    s_mul_i32 s7, s20, 9216
    s_add_u32 s26, s26, s7
    s_mul_i32 s7, s3, 2304
    s_add_u32 s26, s26, s7
    s_add_u32 s26, s26, 29360128
    s_add_u32 s27, s26, 2048
    s_waitcnt lgkmcnt(0)
    s_barrier
    ds_read_b128 a[64:67], v10 offset:16384
    ds_read_b128 a[136:139], v10 offset:34816
    ds_read_b128 a[208:211], v11 offset:16384
    ds_read_b128 v[248:251], v11 offset:34816
    ds_read_b128 a[68:71], v10 offset:17408
    ds_read_b128 a[140:143], v10 offset:35840
    ds_read_b128 a[212:215], v11 offset:17408
    ds_read_b128 v[252:255], v11 offset:35840
    s_mov_b32 s25, 0
    s_waitcnt lgkmcnt(0)
L_ffn_dn_8:
    s_waitcnt vmcnt(12)
    v_mfma_f32_16x16x32_bf16 v[88:91], v[16:19], a[0:3], 0
    v_mfma_f32_16x16x32_bf16 v[88:91], v[20:23], a[4:7], v[88:91]
    buffer_load_dwordx4 v[76:79], v184, s[8:11], s23 offen offset:0
    v_mfma_f32_16x16x32_bf16 v[88:91], v[24:27], a[8:11], v[88:91]
    v_mfma_f32_16x16x32_bf16 v[92:95], v[16:19], a[72:75], 0
    v_mfma_f32_16x16x32_bf16 v[92:95], v[20:23], a[76:79], v[92:95]
    v_mfma_f32_16x16x32_bf16 v[92:95], v[24:27], a[80:83], v[92:95]
    buffer_load_dwordx4 v[80:83], v184, s[8:11], s23 offen offset:1024
    v_mfma_f32_16x16x32_bf16 v[96:99], v[16:19], a[144:147], 0
    v_cvt_pk_bf16_f32 v152, v120, v121
    v_cvt_pk_bf16_f32 v153, v122, v123
    v_mfma_f32_16x16x32_bf16 v[96:99], v[20:23], a[148:151], v[96:99]
    v_cvt_pk_bf16_f32 v154, v124, v125
    v_cvt_pk_bf16_f32 v155, v126, v127
    v_mfma_f32_16x16x32_bf16 v[96:99], v[24:27], a[152:155], v[96:99]
    v_cvt_pk_bf16_f32 v156, v128, v129
    v_cvt_pk_bf16_f32 v157, v130, v131
    v_mfma_f32_16x16x32_bf16 v[100:103], v[16:19], a[216:219], 0
    buffer_load_dwordx4 v[84:87], v184, s[8:11], s23 offen offset:2048
    v_mfma_f32_16x16x32_bf16 v[100:103], v[20:23], a[220:223], v[100:103]
    v_cvt_pk_bf16_f32 v158, v132, v133
    v_cvt_pk_bf16_f32 v159, v134, v135
    v_mfma_f32_16x16x32_bf16 v[100:103], v[24:27], a[224:227], v[100:103]
    v_permlane16_swap_b32 v152, v154
    s_waitcnt vmcnt(12)
    v_mfma_f32_16x16x32_bf16 v[88:91], v[28:31], a[12:15], v[88:91]
    v_permlane16_swap_b32 v153, v155
    v_mfma_f32_16x16x32_bf16 v[88:91], v[32:35], a[16:19], v[88:91]
    buffer_load_dwordx4 v[16:19], v184, s[8:11], s23 offen offset:3072
    v_mfma_f32_16x16x32_bf16 v[88:91], v[36:39], a[20:23], v[88:91]
    v_permlane16_swap_b32 v156, v158
    v_mfma_f32_16x16x32_bf16 v[92:95], v[28:31], a[84:87], v[92:95]
    v_permlane16_swap_b32 v157, v159
    v_mfma_f32_16x16x32_bf16 v[92:95], v[32:35], a[88:91], v[92:95]
    buffer_store_dwordx4 v[152:155], v2, s[8:11], s27 offen
    v_mfma_f32_16x16x32_bf16 v[92:95], v[36:39], a[92:95], v[92:95]
    buffer_load_dwordx4 v[20:23], v185, s[8:11], s23 offen offset:0
    v_mfma_f32_16x16x32_bf16 v[96:99], v[28:31], a[156:159], v[96:99]
    buffer_store_dwordx4 v[156:159], v3, s[8:11], s27 offen
    v_mfma_f32_16x16x32_bf16 v[96:99], v[32:35], a[160:163], v[96:99]
    v_mfma_f32_16x16x32_bf16 v[96:99], v[36:39], a[164:167], v[96:99]
    v_mfma_f32_16x16x32_bf16 v[100:103], v[28:31], a[228:231], v[100:103]
    buffer_load_dwordx4 v[24:27], v185, s[8:11], s23 offen offset:1024
    v_mfma_f32_16x16x32_bf16 v[100:103], v[32:35], a[232:235], v[100:103]
    v_mfma_f32_16x16x32_bf16 v[100:103], v[36:39], a[236:239], v[100:103]
    s_waitcnt vmcnt(14)
    v_mfma_f32_16x16x32_bf16 v[88:91], v[40:43], a[24:27], v[88:91]
    v_mfma_f32_16x16x32_bf16 v[88:91], v[44:47], a[28:31], v[88:91]
    buffer_load_dwordx4 v[28:31], v185, s[8:11], s23 offen offset:2048
    v_mfma_f32_16x16x32_bf16 v[88:91], v[48:51], a[32:35], v[88:91]
    v_mfma_f32_16x16x32_bf16 v[92:95], v[40:43], a[96:99], v[92:95]
    v_mfma_f32_16x16x32_bf16 v[92:95], v[44:47], a[100:103], v[92:95]
    v_mfma_f32_16x16x32_bf16 v[92:95], v[48:51], a[104:107], v[92:95]
    buffer_load_dwordx4 v[32:35], v185, s[8:11], s23 offen offset:3072
    v_mfma_f32_16x16x32_bf16 v[96:99], v[40:43], a[168:171], v[96:99]
    v_mfma_f32_16x16x32_bf16 v[96:99], v[44:47], a[172:175], v[96:99]
    v_mfma_f32_16x16x32_bf16 v[96:99], v[48:51], a[176:179], v[96:99]
    v_mfma_f32_16x16x32_bf16 v[100:103], v[40:43], a[240:243], v[100:103]
    buffer_load_dwordx4 v[36:39], v186, s[8:11], s23 offen offset:0
    v_mfma_f32_16x16x32_bf16 v[100:103], v[44:47], a[244:247], v[100:103]
    v_mfma_f32_16x16x32_bf16 v[100:103], v[48:51], a[248:251], v[100:103]
    s_waitcnt vmcnt(14)
    v_mfma_f32_16x16x32_bf16 v[88:91], v[52:55], a[36:39], v[88:91]
    v_mfma_f32_16x16x32_bf16 v[88:91], v[56:59], a[40:43], v[88:91]
    buffer_load_dwordx4 v[40:43], v186, s[8:11], s23 offen offset:1024
    v_mfma_f32_16x16x32_bf16 v[88:91], v[60:63], a[44:47], v[88:91]
    v_mfma_f32_16x16x32_bf16 v[92:95], v[52:55], a[108:111], v[92:95]
    v_mfma_f32_16x16x32_bf16 v[92:95], v[56:59], a[112:115], v[92:95]
    v_mfma_f32_16x16x32_bf16 v[92:95], v[60:63], a[116:119], v[92:95]
    buffer_load_dwordx4 v[44:47], v186, s[8:11], s23 offen offset:2048
    v_mfma_f32_16x16x32_bf16 v[96:99], v[52:55], a[180:183], v[96:99]
    v_mfma_f32_16x16x32_bf16 v[96:99], v[56:59], a[184:187], v[96:99]
    v_mfma_f32_16x16x32_bf16 v[96:99], v[60:63], a[188:191], v[96:99]
    v_mfma_f32_16x16x32_bf16 v[100:103], v[52:55], a[252:255], v[100:103]
    buffer_load_dwordx4 v[48:51], v186, s[8:11], s23 offen offset:3072
    v_mfma_f32_16x16x32_bf16 v[100:103], v[56:59], v[224:227], v[100:103]
    v_mfma_f32_16x16x32_bf16 v[100:103], v[60:63], v[228:231], v[100:103]
    s_waitcnt vmcnt(14)
    v_mfma_f32_16x16x32_bf16 v[88:91], v[64:67], a[48:51], v[88:91]
    v_mfma_f32_16x16x32_bf16 v[88:91], v[68:71], a[52:55], v[88:91]
    buffer_load_dwordx4 v[52:55], v187, s[8:11], s23 offen offset:0
    v_mfma_f32_16x16x32_bf16 v[88:91], v[72:75], a[56:59], v[88:91]
    v_mfma_f32_16x16x32_bf16 v[92:95], v[64:67], a[120:123], v[92:95]
    v_mfma_f32_16x16x32_bf16 v[92:95], v[68:71], a[124:127], v[92:95]
    v_mfma_f32_16x16x32_bf16 v[92:95], v[72:75], a[128:131], v[92:95]
    buffer_load_dwordx4 v[56:59], v187, s[8:11], s23 offen offset:1024
    v_mfma_f32_16x16x32_bf16 v[96:99], v[64:67], a[192:195], v[96:99]
    v_mfma_f32_16x16x32_bf16 v[96:99], v[68:71], a[196:199], v[96:99]
    v_mfma_f32_16x16x32_bf16 v[96:99], v[72:75], a[200:203], v[96:99]
    v_mfma_f32_16x16x32_bf16 v[100:103], v[64:67], v[232:235], v[100:103]
    buffer_load_dwordx4 v[60:63], v187, s[8:11], s23 offen offset:2048
    v_mfma_f32_16x16x32_bf16 v[100:103], v[68:71], v[236:239], v[100:103]
    v_mfma_f32_16x16x32_bf16 v[100:103], v[72:75], v[240:243], v[100:103]
    s_waitcnt vmcnt(14)
    v_mfma_f32_16x16x32_bf16 v[88:91], v[76:79], a[60:63], v[88:91]
    v_mfma_f32_16x16x32_bf16 v[88:91], v[80:83], a[64:67], v[88:91]
    buffer_load_dwordx4 v[64:67], v187, s[8:11], s23 offen offset:3072
    v_mfma_f32_16x16x32_bf16 v[120:123], v[84:87], a[68:71], v[88:91]
    v_mfma_f32_16x16x32_bf16 v[92:95], v[76:79], a[132:135], v[92:95]
    v_mfma_f32_16x16x32_bf16 v[92:95], v[80:83], a[136:139], v[92:95]
    v_mfma_f32_16x16x32_bf16 v[124:127], v[84:87], a[140:143], v[92:95]
    buffer_load_dwordx4 v[68:71], v188, s[8:11], s23 offen offset:0
    v_mfma_f32_16x16x32_bf16 v[96:99], v[76:79], a[204:207], v[96:99]
    s_lshl_b32 s7, s25, 8
    v_mfma_f32_16x16x32_bf16 v[96:99], v[80:83], a[208:211], v[96:99]
    s_add_u32 s27, s26, s7
    v_mfma_f32_16x16x32_bf16 v[128:131], v[84:87], a[212:215], v[96:99]
    v_mfma_f32_16x16x32_bf16 v[100:103], v[76:79], v[244:247], v[100:103]
    buffer_load_dwordx4 v[72:75], v188, s[8:11], s23 offen offset:1024
    v_mfma_f32_16x16x32_bf16 v[100:103], v[80:83], v[248:251], v[100:103]
    s_add_u32 s23, s23, 18432
    v_mfma_f32_16x16x32_bf16 v[132:135], v[84:87], v[252:255], v[100:103]
    s_add_u32 s25, s25, 1
    s_cmp_lt_u32 s25, 9
    s_cbranch_scc1 L_ffn_dn_8
    s_nop 7
    v_cvt_pk_bf16_f32 v152, v120, v121
    v_cvt_pk_bf16_f32 v153, v122, v123
    v_cvt_pk_bf16_f32 v154, v124, v125
    v_cvt_pk_bf16_f32 v155, v126, v127
    v_cvt_pk_bf16_f32 v156, v128, v129
    v_cvt_pk_bf16_f32 v157, v130, v131
    v_cvt_pk_bf16_f32 v158, v132, v133
    v_cvt_pk_bf16_f32 v159, v134, v135
    s_nop 1
    v_permlane16_swap_b32 v152, v154
    v_permlane16_swap_b32 v153, v155
    v_permlane16_swap_b32 v156, v158
    v_permlane16_swap_b32 v157, v159
    buffer_store_dwordx4 v[152:155], v2, s[8:11], s27 offen
    buffer_store_dwordx4 v[156:159], v3, s[8:11], s27 offen
L_ffn_end:
    s_endpgm
.text
.globl red1_kernel
.p2align 8
.type red1_kernel,@function
red1_kernel:
    s_cmp_ge_u32 s2, 256
    s_cbranch_scc1 L_red1_end
    s_load_dwordx2 s[4:5], s[0:1], 72
    v_lshrrev_b32 v1, 6, v0
    v_and_b32 v0, 63, v0
    v_readfirstlane_b32 s3, v1
    s_waitcnt lgkmcnt(0)
    s_mov_b32 s8, s4
    s_and_b32 s9, s5, 0xffff
    s_mov_b32 s10, 268435456
    s_mov_b32 s11, 0x20000
    s_mov_b32 s16, 0xffff0000
    s_lshl_b32 s7, s3, 10
    v_lshl_add_u32 v2, v0, 4, s7
    v_add_u32 v3, 4096, v2
    s_cmp_eq_u32 s3, 0
    s_mov_b32 s17, 1073741824
    s_cmov_b32 s17, 8192
    v_add_u32 v4, s17, v2
    s_mul_i32 s18, s2, 9216
    s_add_u32 s19, s18, 24641536
    s_mul_i32 s20, s2, 73728
    s_add_u32 s20, s20, 29360128
    buffer_load_dwordx4 v[16:19], v2, s[8:11], s19 offen
    buffer_load_dwordx4 v[20:23], v3, s[8:11], s19 offen
    buffer_load_dwordx4 v[24:27], v4, s[8:11], s19 offen
    buffer_load_dwordx4 v[28:31], v2, s[8:11], s20 offen
    buffer_load_dwordx4 v[32:35], v3, s[8:11], s20 offen
    buffer_load_dwordx4 v[36:39], v4, s[8:11], s20 offen
    s_add_u32 s20, s20, 9216
    buffer_load_dwordx4 v[40:43], v2, s[8:11], s20 offen
    buffer_load_dwordx4 v[44:47], v3, s[8:11], s20 offen
    buffer_load_dwordx4 v[48:51], v4, s[8:11], s20 offen
    s_add_u32 s20, s20, 9216
    buffer_load_dwordx4 v[52:55], v2, s[8:11], s20 offen
    buffer_load_dwordx4 v[56:59], v3, s[8:11], s20 offen
    buffer_load_dwordx4 v[60:63], v4, s[8:11], s20 offen
    s_add_u32 s20, s20, 9216
    buffer_load_dwordx4 v[64:67], v2, s[8:11], s20 offen
    buffer_load_dwordx4 v[68:71], v3, s[8:11], s20 offen
    buffer_load_dwordx4 v[72:75], v4, s[8:11], s20 offen
    s_add_u32 s20, s20, 9216
    buffer_load_dwordx4 v[76:79], v2, s[8:11], s20 offen
    buffer_load_dwordx4 v[80:83], v3, s[8:11], s20 offen
    buffer_load_dwordx4 v[84:87], v4, s[8:11], s20 offen
    s_add_u32 s20, s20, 9216
    buffer_load_dwordx4 v[88:91], v2, s[8:11], s20 offen
    buffer_load_dwordx4 v[92:95], v3, s[8:11], s20 offen
    buffer_load_dwordx4 v[96:99], v4, s[8:11], s20 offen
    s_add_u32 s20, s20, 9216
    buffer_load_dwordx4 v[100:103], v2, s[8:11], s20 offen
    buffer_load_dwordx4 v[104:107], v3, s[8:11], s20 offen
    buffer_load_dwordx4 v[108:111], v4, s[8:11], s20 offen
    s_add_u32 s20, s20, 9216
    buffer_load_dwordx4 v[112:115], v2, s[8:11], s20 offen
    buffer_load_dwordx4 v[116:119], v3, s[8:11], s20 offen
    buffer_load_dwordx4 v[120:123], v4, s[8:11], s20 offen
    s_waitcnt vmcnt(26)
    v_lshlrev_b32 v124, 16, v16
    v_and_b32 v125, s16, v16
    v_lshlrev_b32 v126, 16, v17
    v_and_b32 v127, s16, v17
    v_lshlrev_b32 v128, 16, v18
    v_and_b32 v129, s16, v18
    v_lshlrev_b32 v130, 16, v19
    v_and_b32 v131, s16, v19
    s_waitcnt vmcnt(25)
    v_lshlrev_b32 v132, 16, v20
    v_and_b32 v133, s16, v20
    v_lshlrev_b32 v134, 16, v21
    v_and_b32 v135, s16, v21
    v_lshlrev_b32 v136, 16, v22
    v_and_b32 v137, s16, v22
    v_lshlrev_b32 v138, 16, v23
    v_and_b32 v139, s16, v23
    s_waitcnt vmcnt(24)
    v_lshlrev_b32 v140, 16, v24
    v_and_b32 v141, s16, v24
    v_lshlrev_b32 v142, 16, v25
    v_and_b32 v143, s16, v25
    v_lshlrev_b32 v144, 16, v26
    v_and_b32 v145, s16, v26
    v_lshlrev_b32 v146, 16, v27
    v_and_b32 v147, s16, v27
    s_waitcnt vmcnt(23)
    v_lshlrev_b32 v148, 16, v28
    v_and_b32 v149, s16, v28
    v_lshlrev_b32 v150, 16, v29
    v_and_b32 v151, s16, v29
    v_lshlrev_b32 v152, 16, v30
    v_and_b32 v153, s16, v30
    v_lshlrev_b32 v154, 16, v31
    v_and_b32 v155, s16, v31
    v_pk_add_f32 v[124:125], v[124:125], v[148:149]
    v_pk_add_f32 v[126:127], v[126:127], v[150:151]
    v_pk_add_f32 v[128:129], v[128:129], v[152:153]
    v_pk_add_f32 v[130:131], v[130:131], v[154:155]
    s_waitcnt vmcnt(22)
    v_lshlrev_b32 v148, 16, v32
    v_and_b32 v149, s16, v32
    v_lshlrev_b32 v150, 16, v33
    v_and_b32 v151, s16, v33
    v_lshlrev_b32 v152, 16, v34
    v_and_b32 v153, s16, v34
    v_lshlrev_b32 v154, 16, v35
    v_and_b32 v155, s16, v35
    v_pk_add_f32 v[132:133], v[132:133], v[148:149]
    v_pk_add_f32 v[134:135], v[134:135], v[150:151]
    v_pk_add_f32 v[136:137], v[136:137], v[152:153]
    v_pk_add_f32 v[138:139], v[138:139], v[154:155]
    s_waitcnt vmcnt(21)
    v_lshlrev_b32 v148, 16, v36
    v_and_b32 v149, s16, v36
    v_lshlrev_b32 v150, 16, v37
    v_and_b32 v151, s16, v37
    v_lshlrev_b32 v152, 16, v38
    v_and_b32 v153, s16, v38
    v_lshlrev_b32 v154, 16, v39
    v_and_b32 v155, s16, v39
    v_pk_add_f32 v[140:141], v[140:141], v[148:149]
    v_pk_add_f32 v[142:143], v[142:143], v[150:151]
    v_pk_add_f32 v[144:145], v[144:145], v[152:153]
    v_pk_add_f32 v[146:147], v[146:147], v[154:155]
    s_waitcnt vmcnt(20)
    v_lshlrev_b32 v148, 16, v40
    v_and_b32 v149, s16, v40
    v_lshlrev_b32 v150, 16, v41
    v_and_b32 v151, s16, v41
    v_lshlrev_b32 v152, 16, v42
    v_and_b32 v153, s16, v42
    v_lshlrev_b32 v154, 16, v43
    v_and_b32 v155, s16, v43
    v_pk_add_f32 v[124:125], v[124:125], v[148:149]
    v_pk_add_f32 v[126:127], v[126:127], v[150:151]
    v_pk_add_f32 v[128:129], v[128:129], v[152:153]
    v_pk_add_f32 v[130:131], v[130:131], v[154:155]
    s_waitcnt vmcnt(19)
    v_lshlrev_b32 v148, 16, v44
    v_and_b32 v149, s16, v44
    v_lshlrev_b32 v150, 16, v45
    v_and_b32 v151, s16, v45
    v_lshlrev_b32 v152, 16, v46
    v_and_b32 v153, s16, v46
    v_lshlrev_b32 v154, 16, v47
    v_and_b32 v155, s16, v47
    v_pk_add_f32 v[132:133], v[132:133], v[148:149]
    v_pk_add_f32 v[134:135], v[134:135], v[150:151]
    v_pk_add_f32 v[136:137], v[136:137], v[152:153]
    v_pk_add_f32 v[138:139], v[138:139], v[154:155]
    s_waitcnt vmcnt(18)
    v_lshlrev_b32 v148, 16, v48
    v_and_b32 v149, s16, v48
    v_lshlrev_b32 v150, 16, v49
    v_and_b32 v151, s16, v49
    v_lshlrev_b32 v152, 16, v50
    v_and_b32 v153, s16, v50
    v_lshlrev_b32 v154, 16, v51
    v_and_b32 v155, s16, v51
    v_pk_add_f32 v[140:141], v[140:141], v[148:149]
    v_pk_add_f32 v[142:143], v[142:143], v[150:151]
    v_pk_add_f32 v[144:145], v[144:145], v[152:153]
    v_pk_add_f32 v[146:147], v[146:147], v[154:155]
    s_waitcnt vmcnt(17)
    v_lshlrev_b32 v148, 16, v52
    v_and_b32 v149, s16, v52
    v_lshlrev_b32 v150, 16, v53
    v_and_b32 v151, s16, v53
    v_lshlrev_b32 v152, 16, v54
    v_and_b32 v153, s16, v54
    v_lshlrev_b32 v154, 16, v55
    v_and_b32 v155, s16, v55
    v_pk_add_f32 v[124:125], v[124:125], v[148:149]
    v_pk_add_f32 v[126:127], v[126:127], v[150:151]
    v_pk_add_f32 v[128:129], v[128:129], v[152:153]
    v_pk_add_f32 v[130:131], v[130:131], v[154:155]
    s_waitcnt vmcnt(16)
    v_lshlrev_b32 v148, 16, v56
    v_and_b32 v149, s16, v56
    v_lshlrev_b32 v150, 16, v57
    v_and_b32 v151, s16, v57
    v_lshlrev_b32 v152, 16, v58
    v_and_b32 v153, s16, v58
    v_lshlrev_b32 v154, 16, v59
    v_and_b32 v155, s16, v59
    v_pk_add_f32 v[132:133], v[132:133], v[148:149]
    v_pk_add_f32 v[134:135], v[134:135], v[150:151]
    v_pk_add_f32 v[136:137], v[136:137], v[152:153]
    v_pk_add_f32 v[138:139], v[138:139], v[154:155]
    s_waitcnt vmcnt(15)
    v_lshlrev_b32 v148, 16, v60
    v_and_b32 v149, s16, v60
    v_lshlrev_b32 v150, 16, v61
    v_and_b32 v151, s16, v61
    v_lshlrev_b32 v152, 16, v62
    v_and_b32 v153, s16, v62
    v_lshlrev_b32 v154, 16, v63
    v_and_b32 v155, s16, v63
    v_pk_add_f32 v[140:141], v[140:141], v[148:149]
    v_pk_add_f32 v[142:143], v[142:143], v[150:151]
    v_pk_add_f32 v[144:145], v[144:145], v[152:153]
    v_pk_add_f32 v[146:147], v[146:147], v[154:155]
    s_waitcnt vmcnt(14)
    v_lshlrev_b32 v148, 16, v64
    v_and_b32 v149, s16, v64
    v_lshlrev_b32 v150, 16, v65
    v_and_b32 v151, s16, v65
    v_lshlrev_b32 v152, 16, v66
    v_and_b32 v153, s16, v66
    v_lshlrev_b32 v154, 16, v67
    v_and_b32 v155, s16, v67
    v_pk_add_f32 v[124:125], v[124:125], v[148:149]
    v_pk_add_f32 v[126:127], v[126:127], v[150:151]
    v_pk_add_f32 v[128:129], v[128:129], v[152:153]
    v_pk_add_f32 v[130:131], v[130:131], v[154:155]
    s_waitcnt vmcnt(13)
    v_lshlrev_b32 v148, 16, v68
    v_and_b32 v149, s16, v68
    v_lshlrev_b32 v150, 16, v69
    v_and_b32 v151, s16, v69
    v_lshlrev_b32 v152, 16, v70
    v_and_b32 v153, s16, v70
    v_lshlrev_b32 v154, 16, v71
    v_and_b32 v155, s16, v71
    v_pk_add_f32 v[132:133], v[132:133], v[148:149]
    v_pk_add_f32 v[134:135], v[134:135], v[150:151]
    v_pk_add_f32 v[136:137], v[136:137], v[152:153]
    v_pk_add_f32 v[138:139], v[138:139], v[154:155]
    s_waitcnt vmcnt(12)
    v_lshlrev_b32 v148, 16, v72
    v_and_b32 v149, s16, v72
    v_lshlrev_b32 v150, 16, v73
    v_and_b32 v151, s16, v73
    v_lshlrev_b32 v152, 16, v74
    v_and_b32 v153, s16, v74
    v_lshlrev_b32 v154, 16, v75
    v_and_b32 v155, s16, v75
    v_pk_add_f32 v[140:141], v[140:141], v[148:149]
    v_pk_add_f32 v[142:143], v[142:143], v[150:151]
    v_pk_add_f32 v[144:145], v[144:145], v[152:153]
    v_pk_add_f32 v[146:147], v[146:147], v[154:155]
    s_waitcnt vmcnt(11)
    v_lshlrev_b32 v148, 16, v76
    v_and_b32 v149, s16, v76
    v_lshlrev_b32 v150, 16, v77
    v_and_b32 v151, s16, v77
    v_lshlrev_b32 v152, 16, v78
    v_and_b32 v153, s16, v78
    v_lshlrev_b32 v154, 16, v79
    v_and_b32 v155, s16, v79
    v_pk_add_f32 v[124:125], v[124:125], v[148:149]
    v_pk_add_f32 v[126:127], v[126:127], v[150:151]
    v_pk_add_f32 v[128:129], v[128:129], v[152:153]
    v_pk_add_f32 v[130:131], v[130:131], v[154:155]
    s_waitcnt vmcnt(10)
    v_lshlrev_b32 v148, 16, v80
    v_and_b32 v149, s16, v80
    v_lshlrev_b32 v150, 16, v81
    v_and_b32 v151, s16, v81
    v_lshlrev_b32 v152, 16, v82
    v_and_b32 v153, s16, v82
    v_lshlrev_b32 v154, 16, v83
    v_and_b32 v155, s16, v83
    v_pk_add_f32 v[132:133], v[132:133], v[148:149]
    v_pk_add_f32 v[134:135], v[134:135], v[150:151]
    v_pk_add_f32 v[136:137], v[136:137], v[152:153]
    v_pk_add_f32 v[138:139], v[138:139], v[154:155]
    s_waitcnt vmcnt(9)
    v_lshlrev_b32 v148, 16, v84
    v_and_b32 v149, s16, v84
    v_lshlrev_b32 v150, 16, v85
    v_and_b32 v151, s16, v85
    v_lshlrev_b32 v152, 16, v86
    v_and_b32 v153, s16, v86
    v_lshlrev_b32 v154, 16, v87
    v_and_b32 v155, s16, v87
    v_pk_add_f32 v[140:141], v[140:141], v[148:149]
    v_pk_add_f32 v[142:143], v[142:143], v[150:151]
    v_pk_add_f32 v[144:145], v[144:145], v[152:153]
    v_pk_add_f32 v[146:147], v[146:147], v[154:155]
    s_waitcnt vmcnt(8)
    v_lshlrev_b32 v148, 16, v88
    v_and_b32 v149, s16, v88
    v_lshlrev_b32 v150, 16, v89
    v_and_b32 v151, s16, v89
    v_lshlrev_b32 v152, 16, v90
    v_and_b32 v153, s16, v90
    v_lshlrev_b32 v154, 16, v91
    v_and_b32 v155, s16, v91
    v_pk_add_f32 v[124:125], v[124:125], v[148:149]
    v_pk_add_f32 v[126:127], v[126:127], v[150:151]
    v_pk_add_f32 v[128:129], v[128:129], v[152:153]
    v_pk_add_f32 v[130:131], v[130:131], v[154:155]
    s_waitcnt vmcnt(7)
    v_lshlrev_b32 v148, 16, v92
    v_and_b32 v149, s16, v92
    v_lshlrev_b32 v150, 16, v93
    v_and_b32 v151, s16, v93
    v_lshlrev_b32 v152, 16, v94
    v_and_b32 v153, s16, v94
    v_lshlrev_b32 v154, 16, v95
    v_and_b32 v155, s16, v95
    v_pk_add_f32 v[132:133], v[132:133], v[148:149]
    v_pk_add_f32 v[134:135], v[134:135], v[150:151]
    v_pk_add_f32 v[136:137], v[136:137], v[152:153]
    v_pk_add_f32 v[138:139], v[138:139], v[154:155]
    s_waitcnt vmcnt(6)
    v_lshlrev_b32 v148, 16, v96
    v_and_b32 v149, s16, v96
    v_lshlrev_b32 v150, 16, v97
    v_and_b32 v151, s16, v97
    v_lshlrev_b32 v152, 16, v98
    v_and_b32 v153, s16, v98
    v_lshlrev_b32 v154, 16, v99
    v_and_b32 v155, s16, v99
    v_pk_add_f32 v[140:141], v[140:141], v[148:149]
    v_pk_add_f32 v[142:143], v[142:143], v[150:151]
    v_pk_add_f32 v[144:145], v[144:145], v[152:153]
    v_pk_add_f32 v[146:147], v[146:147], v[154:155]
    s_waitcnt vmcnt(5)
    v_lshlrev_b32 v148, 16, v100
    v_and_b32 v149, s16, v100
    v_lshlrev_b32 v150, 16, v101
    v_and_b32 v151, s16, v101
    v_lshlrev_b32 v152, 16, v102
    v_and_b32 v153, s16, v102
    v_lshlrev_b32 v154, 16, v103
    v_and_b32 v155, s16, v103
    v_pk_add_f32 v[124:125], v[124:125], v[148:149]
    v_pk_add_f32 v[126:127], v[126:127], v[150:151]
    v_pk_add_f32 v[128:129], v[128:129], v[152:153]
    v_pk_add_f32 v[130:131], v[130:131], v[154:155]
    s_waitcnt vmcnt(4)
    v_lshlrev_b32 v148, 16, v104
    v_and_b32 v149, s16, v104
    v_lshlrev_b32 v150, 16, v105
    v_and_b32 v151, s16, v105
    v_lshlrev_b32 v152, 16, v106
    v_and_b32 v153, s16, v106
    v_lshlrev_b32 v154, 16, v107
    v_and_b32 v155, s16, v107
    v_pk_add_f32 v[132:133], v[132:133], v[148:149]
    v_pk_add_f32 v[134:135], v[134:135], v[150:151]
    v_pk_add_f32 v[136:137], v[136:137], v[152:153]
    v_pk_add_f32 v[138:139], v[138:139], v[154:155]
    s_waitcnt vmcnt(3)
    v_lshlrev_b32 v148, 16, v108
    v_and_b32 v149, s16, v108
    v_lshlrev_b32 v150, 16, v109
    v_and_b32 v151, s16, v109
    v_lshlrev_b32 v152, 16, v110
    v_and_b32 v153, s16, v110
    v_lshlrev_b32 v154, 16, v111
    v_and_b32 v155, s16, v111
    v_pk_add_f32 v[140:141], v[140:141], v[148:149]
    v_pk_add_f32 v[142:143], v[142:143], v[150:151]
    v_pk_add_f32 v[144:145], v[144:145], v[152:153]
    v_pk_add_f32 v[146:147], v[146:147], v[154:155]
    s_waitcnt vmcnt(2)
    v_lshlrev_b32 v148, 16, v112
    v_and_b32 v149, s16, v112
    v_lshlrev_b32 v150, 16, v113
    v_and_b32 v151, s16, v113
    v_lshlrev_b32 v152, 16, v114
    v_and_b32 v153, s16, v114
    v_lshlrev_b32 v154, 16, v115
    v_and_b32 v155, s16, v115
    v_pk_add_f32 v[124:125], v[124:125], v[148:149]
    v_pk_add_f32 v[126:127], v[126:127], v[150:151]
    v_pk_add_f32 v[128:129], v[128:129], v[152:153]
    v_pk_add_f32 v[130:131], v[130:131], v[154:155]
    s_waitcnt vmcnt(1)
    v_lshlrev_b32 v148, 16, v116
    v_and_b32 v149, s16, v116
    v_lshlrev_b32 v150, 16, v117
    v_and_b32 v151, s16, v117
    v_lshlrev_b32 v152, 16, v118
    v_and_b32 v153, s16, v118
    v_lshlrev_b32 v154, 16, v119
    v_and_b32 v155, s16, v119
    v_pk_add_f32 v[132:133], v[132:133], v[148:149]
    v_pk_add_f32 v[134:135], v[134:135], v[150:151]
    v_pk_add_f32 v[136:137], v[136:137], v[152:153]
    v_pk_add_f32 v[138:139], v[138:139], v[154:155]
    s_waitcnt vmcnt(0)
    v_lshlrev_b32 v148, 16, v120
    v_and_b32 v149, s16, v120
    v_lshlrev_b32 v150, 16, v121
    v_and_b32 v151, s16, v121
    v_lshlrev_b32 v152, 16, v122
    v_and_b32 v153, s16, v122
    v_lshlrev_b32 v154, 16, v123
    v_and_b32 v155, s16, v123
    v_pk_add_f32 v[140:141], v[140:141], v[148:149]
    v_pk_add_f32 v[142:143], v[142:143], v[150:151]
    v_pk_add_f32 v[144:145], v[144:145], v[152:153]
    v_pk_add_f32 v[146:147], v[146:147], v[154:155]
    v_cvt_pk_bf16_f32 v156, v124, v125
    v_cvt_pk_bf16_f32 v157, v126, v127
    v_cvt_pk_bf16_f32 v158, v128, v129
    v_cvt_pk_bf16_f32 v159, v130, v131
    v_cvt_pk_bf16_f32 v160, v132, v133
    v_cvt_pk_bf16_f32 v161, v134, v135
    v_cvt_pk_bf16_f32 v162, v136, v137
    v_cvt_pk_bf16_f32 v163, v138, v139
    v_cvt_pk_bf16_f32 v164, v140, v141
    v_cvt_pk_bf16_f32 v165, v142, v143
    v_cvt_pk_bf16_f32 v166, v144, v145
    v_cvt_pk_bf16_f32 v167, v146, v147
    s_add_u32 s19, s18, 27000832
    buffer_store_dwordx4 v[156:159], v2, s[8:11], s19 offen
    buffer_store_dwordx4 v[160:163], v3, s[8:11], s19 offen
    buffer_store_dwordx4 v[164:167], v4, s[8:11], s19 offen
    s_mov_b32 s17, 0x3f803f80
    v_mov_b32 v8, 0
    v_mov_b32 v9, 0
    v_mov_b32 v10, 0
    v_mov_b32 v11, 0
    v_dot2c_f32_bf16 v8, s17, v156
    v_dot2c_f32_bf16 v9, v156, v156
    v_dot2c_f32_bf16 v10, s17, v157
    v_dot2c_f32_bf16 v11, v157, v157
    v_dot2c_f32_bf16 v8, s17, v158
    v_dot2c_f32_bf16 v9, v158, v158
    v_dot2c_f32_bf16 v10, s17, v159
    v_dot2c_f32_bf16 v11, v159, v159
    v_dot2c_f32_bf16 v8, s17, v160
    v_dot2c_f32_bf16 v9, v160, v160
    v_dot2c_f32_bf16 v10, s17, v161
    v_dot2c_f32_bf16 v11, v161, v161
    v_dot2c_f32_bf16 v8, s17, v162
    v_dot2c_f32_bf16 v9, v162, v162
    v_dot2c_f32_bf16 v10, s17, v163
    v_dot2c_f32_bf16 v11, v163, v163
    v_dot2c_f32_bf16 v8, s17, v164
    v_dot2c_f32_bf16 v9, v164, v164
    v_dot2c_f32_bf16 v10, s17, v165
    v_dot2c_f32_bf16 v11, v165, v165
    v_dot2c_f32_bf16 v8, s17, v166
    v_dot2c_f32_bf16 v9, v166, v166
    v_dot2c_f32_bf16 v10, s17, v167
    v_dot2c_f32_bf16 v11, v167, v167
    s_nop 2
    v_add_f32 v8, v8, v10
    v_add_f32 v9, v9, v11
    s_nop 1
    v_add_f32_dpp v8, v8, v8 row_ror:8 row_mask:0xf bank_mask:0xf
    v_add_f32_dpp v9, v9, v9 row_ror:8 row_mask:0xf bank_mask:0xf
    v_mov_b32 v10, v8
    v_mov_b32 v11, v9
    s_nop 1
    v_permlane32_swap_b32 v10, v8
    v_permlane32_swap_b32 v11, v9
    v_add_f32 v8, v8, v10
    v_add_f32 v9, v9, v11
    v_mov_b32 v10, v8
    v_mov_b32 v11, v9
    s_nop 1
    v_permlane16_swap_b32 v10, v8
    v_permlane16_swap_b32 v11, v9
    v_add_f32 v8, v8, v10
    v_add_f32 v9, v9, v11
    v_and_b32 v12, 7, v0
    v_lshlrev_b32 v12, 3, v12
    s_lshl_b32 s7, s3, 6
    v_add_u32 v13, s7, v12
    ds_write_b64 v13, v[8:9]
    s_waitcnt lgkmcnt(0)
    s_barrier
    ds_read_b64 v[40:41], v12 offset:0
    ds_read_b64 v[42:43], v12 offset:64
    ds_read_b64 v[44:45], v12 offset:128
    ds_read_b64 v[46:47], v12 offset:192
    s_waitcnt lgkmcnt(0)
    v_pk_add_f32 v[40:41], v[40:41], v[42:43]
    v_pk_add_f32 v[44:45], v[44:45], v[46:47]
    v_pk_add_f32 v[8:9], v[40:41], v[44:45]
    v_mul_f32 v8, 0x3ae38e39, v8
    v_mul_f32 v9, 0x3ae38e39, v9
    v_fma_f32 v9, -v8, v8, v9
    v_max_f32 v9, 0, v9
    v_add_f32 v9, 0x3727c5ac, v9
    v_rsq_f32 v10, v9
    s_nop 0
    v_mul_f32 v12, v8, v10
    v_mov_b32 v11, v10
    v_sub_f32 v12, 0, v12
    v_mov_b32 v13, v12
    v_lshlrev_b32 v40, 16, v156
    v_and_b32 v41, s16, v156
    v_lshlrev_b32 v42, 16, v157
    v_and_b32 v43, s16, v157
    v_lshlrev_b32 v44, 16, v158
    v_and_b32 v45, s16, v158
    v_lshlrev_b32 v46, 16, v159
    v_and_b32 v47, s16, v159
    v_pk_fma_f32 v[40:41], v[40:41], v[10:11], v[12:13]
    v_pk_fma_f32 v[42:43], v[42:43], v[10:11], v[12:13]
    v_pk_fma_f32 v[44:45], v[44:45], v[10:11], v[12:13]
    v_pk_fma_f32 v[46:47], v[46:47], v[10:11], v[12:13]
    v_cvt_pk_bf16_f32 v48, v40, v41
    v_cvt_pk_bf16_f32 v49, v42, v43
    v_cvt_pk_bf16_f32 v50, v44, v45
    v_cvt_pk_bf16_f32 v51, v46, v47
    v_lshlrev_b32 v40, 16, v160
    v_and_b32 v41, s16, v160
    v_lshlrev_b32 v42, 16, v161
    v_and_b32 v43, s16, v161
    v_lshlrev_b32 v44, 16, v162
    v_and_b32 v45, s16, v162
    v_lshlrev_b32 v46, 16, v163
    v_and_b32 v47, s16, v163
    v_pk_fma_f32 v[40:41], v[40:41], v[10:11], v[12:13]
    v_pk_fma_f32 v[42:43], v[42:43], v[10:11], v[12:13]
    v_pk_fma_f32 v[44:45], v[44:45], v[10:11], v[12:13]
    v_pk_fma_f32 v[46:47], v[46:47], v[10:11], v[12:13]
    v_cvt_pk_bf16_f32 v52, v40, v41
    v_cvt_pk_bf16_f32 v53, v42, v43
    v_cvt_pk_bf16_f32 v54, v44, v45
    v_cvt_pk_bf16_f32 v55, v46, v47
    v_lshlrev_b32 v40, 16, v164
    v_and_b32 v41, s16, v164
    v_lshlrev_b32 v42, 16, v165
    v_and_b32 v43, s16, v165
    v_lshlrev_b32 v44, 16, v166
    v_and_b32 v45, s16, v166
    v_lshlrev_b32 v46, 16, v167
    v_and_b32 v47, s16, v167
    v_pk_fma_f32 v[40:41], v[40:41], v[10:11], v[12:13]
    v_pk_fma_f32 v[42:43], v[42:43], v[10:11], v[12:13]
    v_pk_fma_f32 v[44:45], v[44:45], v[10:11], v[12:13]
    v_pk_fma_f32 v[46:47], v[46:47], v[10:11], v[12:13]
    v_cvt_pk_bf16_f32 v56, v40, v41
    v_cvt_pk_bf16_f32 v57, v42, v43
    v_cvt_pk_bf16_f32 v58, v44, v45
    v_cvt_pk_bf16_f32 v59, v46, v47
    s_add_u32 s19, s18, 19922944
    buffer_store_dwordx4 v[48:51], v2, s[8:11], s19 offen
    buffer_store_dwordx4 v[52:55], v3, s[8:11], s19 offen
    buffer_store_dwordx4 v[56:59], v4, s[8:11], s19 offen
L_red1_end:
    s_endpgm
.text
.globl red2_kernel
.p2align 8
.type red2_kernel,@function
red2_kernel:
    s_cmp_ge_u32 s2, 256
    s_cbranch_scc1 L_red2_end
    s_load_dwordx2 s[4:5], s[0:1], 72
    s_load_dwordx2 s[6:7], s[0:1], 56
    v_lshrrev_b32 v1, 6, v0
    v_and_b32 v0, 63, v0
    v_readfirstlane_b32 s3, v1
    s_waitcnt lgkmcnt(0)
    s_mov_b32 s8, s4
    s_and_b32 s9, s5, 0xffff
    s_mov_b32 s10, 268435456
    s_mov_b32 s11, 0x20000
    s_mov_b32 s12, s6
    s_and_b32 s13, s7, 0xffff
    s_mov_b32 s14, 2359296
    s_mov_b32 s15, 0x20000
    s_mov_b32 s16, 0xffff0000
    s_lshl_b32 s7, s3, 10
    v_lshl_add_u32 v2, v0, 4, s7
    v_add_u32 v3, 4096, v2
    s_cmp_eq_u32 s3, 0
    s_mov_b32 s17, 1073741824
    s_cmov_b32 s17, 8192
    v_add_u32 v4, s17, v2
    v_and_b32 v8, 7, v0
    v_mul_u32_u24 v8, 1152, v8
    v_lshrrev_b32 v9, 3, v0
    v_lshl_add_u32 v8, v9, 4, v8
    s_lshl_b32 s7, s3, 7
    v_add_u32 v5, s7, v8
    v_add_u32 v6, 512, v5
    s_cmp_eq_u32 s3, 0
    s_mov_b32 s17, 1073741824
    s_cmov_b32 s17, 1024
    v_add_u32 v7, s17, v5
    s_mul_i32 s18, s2, 9216
    s_add_u32 s19, s18, 24641536
    s_mul_i32 s20, s2, 73728
    s_add_u32 s20, s20, 29360128
    buffer_load_dwordx4 v[16:19], v2, s[8:11], s19 offen
    buffer_load_dwordx4 v[20:23], v3, s[8:11], s19 offen
    buffer_load_dwordx4 v[24:27], v4, s[8:11], s19 offen
    buffer_load_dwordx4 v[28:31], v2, s[8:11], s20 offen
    buffer_load_dwordx4 v[32:35], v3, s[8:11], s20 offen
    buffer_load_dwordx4 v[36:39], v4, s[8:11], s20 offen
    s_add_u32 s20, s20, 9216
    buffer_load_dwordx4 v[40:43], v2, s[8:11], s20 offen
    buffer_load_dwordx4 v[44:47], v3, s[8:11], s20 offen
    buffer_load_dwordx4 v[48:51], v4, s[8:11], s20 offen
    s_add_u32 s20, s20, 9216
    buffer_load_dwordx4 v[52:55], v2, s[8:11], s20 offen
    buffer_load_dwordx4 v[56:59], v3, s[8:11], s20 offen
    buffer_load_dwordx4 v[60:63], v4, s[8:11], s20 offen
    s_add_u32 s20, s20, 9216
    buffer_load_dwordx4 v[64:67], v2, s[8:11], s20 offen
    buffer_load_dwordx4 v[68:71], v3, s[8:11], s20 offen
    buffer_load_dwordx4 v[72:75], v4, s[8:11], s20 offen
    s_add_u32 s20, s20, 9216
    buffer_load_dwordx4 v[76:79], v2, s[8:11], s20 offen
    buffer_load_dwordx4 v[80:83], v3, s[8:11], s20 offen
    buffer_load_dwordx4 v[84:87], v4, s[8:11], s20 offen
    s_add_u32 s20, s20, 9216
    buffer_load_dwordx4 v[88:91], v2, s[8:11], s20 offen
    buffer_load_dwordx4 v[92:95], v3, s[8:11], s20 offen
    buffer_load_dwordx4 v[96:99], v4, s[8:11], s20 offen
    s_add_u32 s20, s20, 9216
    buffer_load_dwordx4 v[100:103], v2, s[8:11], s20 offen
    buffer_load_dwordx4 v[104:107], v3, s[8:11], s20 offen
    buffer_load_dwordx4 v[108:111], v4, s[8:11], s20 offen
    s_add_u32 s20, s20, 9216
    buffer_load_dwordx4 v[112:115], v2, s[8:11], s20 offen
    buffer_load_dwordx4 v[116:119], v3, s[8:11], s20 offen
    buffer_load_dwordx4 v[120:123], v4, s[8:11], s20 offen
    s_waitcnt vmcnt(26)
    v_lshlrev_b32 v124, 16, v16
    v_and_b32 v125, s16, v16
    v_lshlrev_b32 v126, 16, v17
    v_and_b32 v127, s16, v17
    v_lshlrev_b32 v128, 16, v18
    v_and_b32 v129, s16, v18
    v_lshlrev_b32 v130, 16, v19
    v_and_b32 v131, s16, v19
    s_waitcnt vmcnt(25)
    v_lshlrev_b32 v132, 16, v20
    v_and_b32 v133, s16, v20
    v_lshlrev_b32 v134, 16, v21
    v_and_b32 v135, s16, v21
    v_lshlrev_b32 v136, 16, v22
    v_and_b32 v137, s16, v22
    v_lshlrev_b32 v138, 16, v23
    v_and_b32 v139, s16, v23
    s_waitcnt vmcnt(24)
    v_lshlrev_b32 v140, 16, v24
    v_and_b32 v141, s16, v24
    v_lshlrev_b32 v142, 16, v25
    v_and_b32 v143, s16, v25
    v_lshlrev_b32 v144, 16, v26
    v_and_b32 v145, s16, v26
    v_lshlrev_b32 v146, 16, v27
    v_and_b32 v147, s16, v27
    s_waitcnt vmcnt(23)
    v_lshlrev_b32 v148, 16, v28
    v_and_b32 v149, s16, v28
    v_lshlrev_b32 v150, 16, v29
    v_and_b32 v151, s16, v29
    v_lshlrev_b32 v152, 16, v30
    v_and_b32 v153, s16, v30
    v_lshlrev_b32 v154, 16, v31
    v_and_b32 v155, s16, v31
    v_pk_add_f32 v[124:125], v[124:125], v[148:149]
    v_pk_add_f32 v[126:127], v[126:127], v[150:151]
    v_pk_add_f32 v[128:129], v[128:129], v[152:153]
    v_pk_add_f32 v[130:131], v[130:131], v[154:155]
    s_waitcnt vmcnt(22)
    v_lshlrev_b32 v148, 16, v32
    v_and_b32 v149, s16, v32
    v_lshlrev_b32 v150, 16, v33
    v_and_b32 v151, s16, v33
    v_lshlrev_b32 v152, 16, v34
    v_and_b32 v153, s16, v34
    v_lshlrev_b32 v154, 16, v35
    v_and_b32 v155, s16, v35
    v_pk_add_f32 v[132:133], v[132:133], v[148:149]
    v_pk_add_f32 v[134:135], v[134:135], v[150:151]
    v_pk_add_f32 v[136:137], v[136:137], v[152:153]
    v_pk_add_f32 v[138:139], v[138:139], v[154:155]
    s_waitcnt vmcnt(21)
    v_lshlrev_b32 v148, 16, v36
    v_and_b32 v149, s16, v36
    v_lshlrev_b32 v150, 16, v37
    v_and_b32 v151, s16, v37
    v_lshlrev_b32 v152, 16, v38
    v_and_b32 v153, s16, v38
    v_lshlrev_b32 v154, 16, v39
    v_and_b32 v155, s16, v39
    v_pk_add_f32 v[140:141], v[140:141], v[148:149]
    v_pk_add_f32 v[142:143], v[142:143], v[150:151]
    v_pk_add_f32 v[144:145], v[144:145], v[152:153]
    v_pk_add_f32 v[146:147], v[146:147], v[154:155]
    s_waitcnt vmcnt(20)
    v_lshlrev_b32 v148, 16, v40
    v_and_b32 v149, s16, v40
    v_lshlrev_b32 v150, 16, v41
    v_and_b32 v151, s16, v41
    v_lshlrev_b32 v152, 16, v42
    v_and_b32 v153, s16, v42
    v_lshlrev_b32 v154, 16, v43
    v_and_b32 v155, s16, v43
    v_pk_add_f32 v[124:125], v[124:125], v[148:149]
    v_pk_add_f32 v[126:127], v[126:127], v[150:151]
    v_pk_add_f32 v[128:129], v[128:129], v[152:153]
    v_pk_add_f32 v[130:131], v[130:131], v[154:155]
    s_waitcnt vmcnt(19)
    v_lshlrev_b32 v148, 16, v44
    v_and_b32 v149, s16, v44
    v_lshlrev_b32 v150, 16, v45
    v_and_b32 v151, s16, v45
    v_lshlrev_b32 v152, 16, v46
    v_and_b32 v153, s16, v46
    v_lshlrev_b32 v154, 16, v47
    v_and_b32 v155, s16, v47
    v_pk_add_f32 v[132:133], v[132:133], v[148:149]
    v_pk_add_f32 v[134:135], v[134:135], v[150:151]
    v_pk_add_f32 v[136:137], v[136:137], v[152:153]
    v_pk_add_f32 v[138:139], v[138:139], v[154:155]
    s_waitcnt vmcnt(18)
    v_lshlrev_b32 v148, 16, v48
    v_and_b32 v149, s16, v48
    v_lshlrev_b32 v150, 16, v49
    v_and_b32 v151, s16, v49
    v_lshlrev_b32 v152, 16, v50
    v_and_b32 v153, s16, v50
    v_lshlrev_b32 v154, 16, v51
    v_and_b32 v155, s16, v51
    v_pk_add_f32 v[140:141], v[140:141], v[148:149]
    v_pk_add_f32 v[142:143], v[142:143], v[150:151]
    v_pk_add_f32 v[144:145], v[144:145], v[152:153]
    v_pk_add_f32 v[146:147], v[146:147], v[154:155]
    s_waitcnt vmcnt(17)
    v_lshlrev_b32 v148, 16, v52
    v_and_b32 v149, s16, v52
    v_lshlrev_b32 v150, 16, v53
    v_and_b32 v151, s16, v53
    v_lshlrev_b32 v152, 16, v54
    v_and_b32 v153, s16, v54
    v_lshlrev_b32 v154, 16, v55
    v_and_b32 v155, s16, v55
    v_pk_add_f32 v[124:125], v[124:125], v[148:149]
    v_pk_add_f32 v[126:127], v[126:127], v[150:151]
    v_pk_add_f32 v[128:129], v[128:129], v[152:153]
    v_pk_add_f32 v[130:131], v[130:131], v[154:155]
    s_waitcnt vmcnt(16)
    v_lshlrev_b32 v148, 16, v56
    v_and_b32 v149, s16, v56
    v_lshlrev_b32 v150, 16, v57
    v_and_b32 v151, s16, v57
    v_lshlrev_b32 v152, 16, v58
    v_and_b32 v153, s16, v58
    v_lshlrev_b32 v154, 16, v59
    v_and_b32 v155, s16, v59
    v_pk_add_f32 v[132:133], v[132:133], v[148:149]
    v_pk_add_f32 v[134:135], v[134:135], v[150:151]
    v_pk_add_f32 v[136:137], v[136:137], v[152:153]
    v_pk_add_f32 v[138:139], v[138:139], v[154:155]
    s_waitcnt vmcnt(15)
    v_lshlrev_b32 v148, 16, v60
    v_and_b32 v149, s16, v60
    v_lshlrev_b32 v150, 16, v61
    v_and_b32 v151, s16, v61
    v_lshlrev_b32 v152, 16, v62
    v_and_b32 v153, s16, v62
    v_lshlrev_b32 v154, 16, v63
    v_and_b32 v155, s16, v63
    v_pk_add_f32 v[140:141], v[140:141], v[148:149]
    v_pk_add_f32 v[142:143], v[142:143], v[150:151]
    v_pk_add_f32 v[144:145], v[144:145], v[152:153]
    v_pk_add_f32 v[146:147], v[146:147], v[154:155]
    s_waitcnt vmcnt(14)
    v_lshlrev_b32 v148, 16, v64
    v_and_b32 v149, s16, v64
    v_lshlrev_b32 v150, 16, v65
    v_and_b32 v151, s16, v65
    v_lshlrev_b32 v152, 16, v66
    v_and_b32 v153, s16, v66
    v_lshlrev_b32 v154, 16, v67
    v_and_b32 v155, s16, v67
    v_pk_add_f32 v[124:125], v[124:125], v[148:149]
    v_pk_add_f32 v[126:127], v[126:127], v[150:151]
    v_pk_add_f32 v[128:129], v[128:129], v[152:153]
    v_pk_add_f32 v[130:131], v[130:131], v[154:155]
    s_waitcnt vmcnt(13)
    v_lshlrev_b32 v148, 16, v68
    v_and_b32 v149, s16, v68
    v_lshlrev_b32 v150, 16, v69
    v_and_b32 v151, s16, v69
    v_lshlrev_b32 v152, 16, v70
    v_and_b32 v153, s16, v70
    v_lshlrev_b32 v154, 16, v71
    v_and_b32 v155, s16, v71
    v_pk_add_f32 v[132:133], v[132:133], v[148:149]
    v_pk_add_f32 v[134:135], v[134:135], v[150:151]
    v_pk_add_f32 v[136:137], v[136:137], v[152:153]
    v_pk_add_f32 v[138:139], v[138:139], v[154:155]
    s_waitcnt vmcnt(12)
    v_lshlrev_b32 v148, 16, v72
    v_and_b32 v149, s16, v72
    v_lshlrev_b32 v150, 16, v73
    v_and_b32 v151, s16, v73
    v_lshlrev_b32 v152, 16, v74
    v_and_b32 v153, s16, v74
    v_lshlrev_b32 v154, 16, v75
    v_and_b32 v155, s16, v75
    v_pk_add_f32 v[140:141], v[140:141], v[148:149]
    v_pk_add_f32 v[142:143], v[142:143], v[150:151]
    v_pk_add_f32 v[144:145], v[144:145], v[152:153]
    v_pk_add_f32 v[146:147], v[146:147], v[154:155]
    s_waitcnt vmcnt(11)
    v_lshlrev_b32 v148, 16, v76
    v_and_b32 v149, s16, v76
    v_lshlrev_b32 v150, 16, v77
    v_and_b32 v151, s16, v77
    v_lshlrev_b32 v152, 16, v78
    v_and_b32 v153, s16, v78
    v_lshlrev_b32 v154, 16, v79
    v_and_b32 v155, s16, v79
    v_pk_add_f32 v[124:125], v[124:125], v[148:149]
    v_pk_add_f32 v[126:127], v[126:127], v[150:151]
    v_pk_add_f32 v[128:129], v[128:129], v[152:153]
    v_pk_add_f32 v[130:131], v[130:131], v[154:155]
    s_waitcnt vmcnt(10)
    v_lshlrev_b32 v148, 16, v80
    v_and_b32 v149, s16, v80
    v_lshlrev_b32 v150, 16, v81
    v_and_b32 v151, s16, v81
    v_lshlrev_b32 v152, 16, v82
    v_and_b32 v153, s16, v82
    v_lshlrev_b32 v154, 16, v83
    v_and_b32 v155, s16, v83
    v_pk_add_f32 v[132:133], v[132:133], v[148:149]
    v_pk_add_f32 v[134:135], v[134:135], v[150:151]
    v_pk_add_f32 v[136:137], v[136:137], v[152:153]
    v_pk_add_f32 v[138:139], v[138:139], v[154:155]
    s_waitcnt vmcnt(9)
    v_lshlrev_b32 v148, 16, v84
    v_and_b32 v149, s16, v84
    v_lshlrev_b32 v150, 16, v85
    v_and_b32 v151, s16, v85
    v_lshlrev_b32 v152, 16, v86
    v_and_b32 v153, s16, v86
    v_lshlrev_b32 v154, 16, v87
    v_and_b32 v155, s16, v87
    v_pk_add_f32 v[140:141], v[140:141], v[148:149]
    v_pk_add_f32 v[142:143], v[142:143], v[150:151]
    v_pk_add_f32 v[144:145], v[144:145], v[152:153]
    v_pk_add_f32 v[146:147], v[146:147], v[154:155]
    s_waitcnt vmcnt(8)
    v_lshlrev_b32 v148, 16, v88
    v_and_b32 v149, s16, v88
    v_lshlrev_b32 v150, 16, v89
    v_and_b32 v151, s16, v89
    v_lshlrev_b32 v152, 16, v90
    v_and_b32 v153, s16, v90
    v_lshlrev_b32 v154, 16, v91
    v_and_b32 v155, s16, v91
    v_pk_add_f32 v[124:125], v[124:125], v[148:149]
    v_pk_add_f32 v[126:127], v[126:127], v[150:151]
    v_pk_add_f32 v[128:129], v[128:129], v[152:153]
    v_pk_add_f32 v[130:131], v[130:131], v[154:155]
    s_waitcnt vmcnt(7)
    v_lshlrev_b32 v148, 16, v92
    v_and_b32 v149, s16, v92
    v_lshlrev_b32 v150, 16, v93
    v_and_b32 v151, s16, v93
    v_lshlrev_b32 v152, 16, v94
    v_and_b32 v153, s16, v94
    v_lshlrev_b32 v154, 16, v95
    v_and_b32 v155, s16, v95
    v_pk_add_f32 v[132:133], v[132:133], v[148:149]
    v_pk_add_f32 v[134:135], v[134:135], v[150:151]
    v_pk_add_f32 v[136:137], v[136:137], v[152:153]
    v_pk_add_f32 v[138:139], v[138:139], v[154:155]
    s_waitcnt vmcnt(6)
    v_lshlrev_b32 v148, 16, v96
    v_and_b32 v149, s16, v96
    v_lshlrev_b32 v150, 16, v97
    v_and_b32 v151, s16, v97
    v_lshlrev_b32 v152, 16, v98
    v_and_b32 v153, s16, v98
    v_lshlrev_b32 v154, 16, v99
    v_and_b32 v155, s16, v99
    v_pk_add_f32 v[140:141], v[140:141], v[148:149]
    v_pk_add_f32 v[142:143], v[142:143], v[150:151]
    v_pk_add_f32 v[144:145], v[144:145], v[152:153]
    v_pk_add_f32 v[146:147], v[146:147], v[154:155]
    s_waitcnt vmcnt(5)
    v_lshlrev_b32 v148, 16, v100
    v_and_b32 v149, s16, v100
    v_lshlrev_b32 v150, 16, v101
    v_and_b32 v151, s16, v101
    v_lshlrev_b32 v152, 16, v102
    v_and_b32 v153, s16, v102
    v_lshlrev_b32 v154, 16, v103
    v_and_b32 v155, s16, v103
    v_pk_add_f32 v[124:125], v[124:125], v[148:149]
    v_pk_add_f32 v[126:127], v[126:127], v[150:151]
    v_pk_add_f32 v[128:129], v[128:129], v[152:153]
    v_pk_add_f32 v[130:131], v[130:131], v[154:155]
    s_waitcnt vmcnt(4)
    v_lshlrev_b32 v148, 16, v104
    v_and_b32 v149, s16, v104
    v_lshlrev_b32 v150, 16, v105
    v_and_b32 v151, s16, v105
    v_lshlrev_b32 v152, 16, v106
    v_and_b32 v153, s16, v106
    v_lshlrev_b32 v154, 16, v107
    v_and_b32 v155, s16, v107
    v_pk_add_f32 v[132:133], v[132:133], v[148:149]
    v_pk_add_f32 v[134:135], v[134:135], v[150:151]
    v_pk_add_f32 v[136:137], v[136:137], v[152:153]
    v_pk_add_f32 v[138:139], v[138:139], v[154:155]
    s_waitcnt vmcnt(3)
    v_lshlrev_b32 v148, 16, v108
    v_and_b32 v149, s16, v108
    v_lshlrev_b32 v150, 16, v109
    v_and_b32 v151, s16, v109
    v_lshlrev_b32 v152, 16, v110
    v_and_b32 v153, s16, v110
    v_lshlrev_b32 v154, 16, v111
    v_and_b32 v155, s16, v111
    v_pk_add_f32 v[140:141], v[140:141], v[148:149]
    v_pk_add_f32 v[142:143], v[142:143], v[150:151]
    v_pk_add_f32 v[144:145], v[144:145], v[152:153]
    v_pk_add_f32 v[146:147], v[146:147], v[154:155]
    s_waitcnt vmcnt(2)
    v_lshlrev_b32 v148, 16, v112
    v_and_b32 v149, s16, v112
    v_lshlrev_b32 v150, 16, v113
    v_and_b32 v151, s16, v113
    v_lshlrev_b32 v152, 16, v114
    v_and_b32 v153, s16, v114
    v_lshlrev_b32 v154, 16, v115
    v_and_b32 v155, s16, v115
    v_pk_add_f32 v[124:125], v[124:125], v[148:149]
    v_pk_add_f32 v[126:127], v[126:127], v[150:151]
    v_pk_add_f32 v[128:129], v[128:129], v[152:153]
    v_pk_add_f32 v[130:131], v[130:131], v[154:155]
    s_waitcnt vmcnt(1)
    v_lshlrev_b32 v148, 16, v116
    v_and_b32 v149, s16, v116
    v_lshlrev_b32 v150, 16, v117
    v_and_b32 v151, s16, v117
    v_lshlrev_b32 v152, 16, v118
    v_and_b32 v153, s16, v118
    v_lshlrev_b32 v154, 16, v119
    v_and_b32 v155, s16, v119
    v_pk_add_f32 v[132:133], v[132:133], v[148:149]
    v_pk_add_f32 v[134:135], v[134:135], v[150:151]
    v_pk_add_f32 v[136:137], v[136:137], v[152:153]
    v_pk_add_f32 v[138:139], v[138:139], v[154:155]
    s_waitcnt vmcnt(0)
    v_lshlrev_b32 v148, 16, v120
    v_and_b32 v149, s16, v120
    v_lshlrev_b32 v150, 16, v121
    v_and_b32 v151, s16, v121
    v_lshlrev_b32 v152, 16, v122
    v_and_b32 v153, s16, v122
    v_lshlrev_b32 v154, 16, v123
    v_and_b32 v155, s16, v123
    v_pk_add_f32 v[140:141], v[140:141], v[148:149]
    v_pk_add_f32 v[142:143], v[142:143], v[150:151]
    v_pk_add_f32 v[144:145], v[144:145], v[152:153]
    v_pk_add_f32 v[146:147], v[146:147], v[154:155]
    v_cvt_pk_bf16_f32 v156, v124, v125
    v_cvt_pk_bf16_f32 v157, v126, v127
    v_cvt_pk_bf16_f32 v158, v128, v129
    v_cvt_pk_bf16_f32 v159, v130, v131
    v_cvt_pk_bf16_f32 v160, v132, v133
    v_cvt_pk_bf16_f32 v161, v134, v135
    v_cvt_pk_bf16_f32 v162, v136, v137
    v_cvt_pk_bf16_f32 v163, v138, v139
    v_cvt_pk_bf16_f32 v164, v140, v141
    v_cvt_pk_bf16_f32 v165, v142, v143
    v_cvt_pk_bf16_f32 v166, v144, v145
    v_cvt_pk_bf16_f32 v167, v146, v147
    buffer_store_dwordx4 v[156:159], v5, s[12:15], s18 offen
    buffer_store_dwordx4 v[160:163], v6, s[12:15], s18 offen
    buffer_store_dwordx4 v[164:167], v7, s[12:15], s18 offen
L_red2_end:
    s_endpgm
.section .rodata,"a"
.p2align 6
.amdhsa_kernel prep_kernel
.amdhsa_next_free_vgpr 64
.amdhsa_next_free_sgpr 64
.amdhsa_accum_offset 64
.amdhsa_group_segment_fixed_size 0
.amdhsa_kernarg_size 80
.amdhsa_user_sgpr_count 2
.amdhsa_user_sgpr_kernarg_segment_ptr 1
.amdhsa_system_sgpr_workgroup_id_x 1
.amdhsa_float_denorm_mode_32 3
.amdhsa_float_denorm_mode_16_64 3
.end_amdhsa_kernel
.section .rodata,"a"
.p2align 6
.amdhsa_kernel qkv_kernel
.amdhsa_next_free_vgpr 400
.amdhsa_next_free_sgpr 64
.amdhsa_accum_offset 228
.amdhsa_group_segment_fixed_size 0
.amdhsa_kernarg_size 80
.amdhsa_user_sgpr_count 2
.amdhsa_user_sgpr_kernarg_segment_ptr 1
.amdhsa_system_sgpr_workgroup_id_x 1
.amdhsa_float_denorm_mode_32 3
.amdhsa_float_denorm_mode_16_64 3
.end_amdhsa_kernel
.section .rodata,"a"
.p2align 6
.amdhsa_kernel wo_kernel
.amdhsa_next_free_vgpr 304
.amdhsa_next_free_sgpr 64
.amdhsa_accum_offset 88
.amdhsa_group_segment_fixed_size 0
.amdhsa_kernarg_size 80
.amdhsa_user_sgpr_count 2
.amdhsa_user_sgpr_kernarg_segment_ptr 1
.amdhsa_system_sgpr_workgroup_id_x 1
.amdhsa_float_denorm_mode_32 3
.amdhsa_float_denorm_mode_16_64 3
.end_amdhsa_kernel
.section .rodata,"a"
.p2align 6
.amdhsa_kernel ffn_kernel
.amdhsa_next_free_vgpr 512
.amdhsa_next_free_sgpr 64
.amdhsa_accum_offset 256
.amdhsa_group_segment_fixed_size 0
.amdhsa_kernarg_size 80
.amdhsa_user_sgpr_count 2
.amdhsa_user_sgpr_kernarg_segment_ptr 1
.amdhsa_system_sgpr_workgroup_id_x 1
.amdhsa_float_denorm_mode_32 3
.amdhsa_float_denorm_mode_16_64 3
.end_amdhsa_kernel
.section .rodata,"a"
.p2align 6
.amdhsa_kernel red1_kernel
.amdhsa_next_free_vgpr 168
.amdhsa_next_free_sgpr 64
.amdhsa_accum_offset 168
.amdhsa_group_segment_fixed_size 0
.amdhsa_kernarg_size 80
.amdhsa_user_sgpr_count 2
.amdhsa_user_sgpr_kernarg_segment_ptr 1
.amdhsa_system_sgpr_workgroup_id_x 1
.amdhsa_float_denorm_mode_32 3
.amdhsa_float_denorm_mode_16_64 3
.end_amdhsa_kernel
.section .rodata,"a"
.p2align 6
.amdhsa_kernel red2_kernel
.amdhsa_next_free_vgpr 168
.amdhsa_next_free_sgpr 64
.amdhsa_accum_offset 168
.amdhsa_group_segment_fixed_size 0
.amdhsa_kernarg_size 80
.amdhsa_user_sgpr_count 2
.amdhsa_user_sgpr_kernarg_segment_ptr 1
.amdhsa_system_sgpr_workgroup_id_x 1
.amdhsa_float_denorm_mode_32 3
.amdhsa_float_denorm_mode_16_64 3
.end_amdhsa_kernel
```

```asm
; @launch kernel=prep_kernel grid=(988,1,1) block=(256,1,1) lds=32768
; @launch kernel=main_kernel grid=(256,1,1) block=(256,1,1) lds=147456
.amdgcn_target "amdgcn-amd-amdhsa--gfx950"
.text
.globl prep_kernel
.p2align 8
.type prep_kernel,@function
prep_kernel:
    s_cmp_ge_u32 s2, 988
    s_cbranch_scc1 L_prep_end
    s_load_dwordx2 s[4:5], s[0:1], 72
    v_lshrrev_b32 v1, 6, v0
    v_and_b32 v0, 63, v0
    v_readfirstlane_b32 s3, v1
    s_waitcnt lgkmcnt(0)
    s_mov_b32 s8, s4
    s_and_b32 s9, s5, 0xffff
    s_mov_b32 s10, 268435456
    s_mov_b32 s11, 0x20000
    s_cmp_ge_u32 s2, 486
    s_cbranch_scc1 L_prep_q
    s_load_dwordx4 s[24:27], s[0:1], 32
    s_load_dwordx2 s[28:29], s[0:1], 48
    s_waitcnt lgkmcnt(0)
    s_mul_i32 s20, s2, 6473
    s_lshr_b32 s20, s20, 20
    s_mul_i32 s21, s20, 162
    s_sub_u32 s21, s2, s21
    s_cmp_eq_u32 s20, 1
    s_cselect_b32 s12, s26, s24
    s_cselect_b32 s13, s27, s25
    s_cmp_eq_u32 s20, 2
    s_cselect_b32 s12, s28, s12
    s_cselect_b32 s13, s29, s13
    s_and_b32 s13, s13, 0xffff
    s_mov_b32 s14, 5308416
    s_mov_b32 s15, 0x20000
    s_cmp_eq_u32 s20, 2
    s_mov_b32 s22, 9216
    s_cmov_b32 s22, 1152
    s_mov_b32 s23, 14564
    s_cmov_b32 s23, 116509
    s_cselect_b32 s30, 9, 72
    s_cselect_b32 s31, 2, 3
    s_mov_b32 s32, 512
    s_cmov_b32 s32, 2048
    s_lshl_b32 s21, s21, 2
    s_add_u32 s21, s21, s3
    s_mul_i32 s21, s21, 2
    v_lshrrev_b32 v2, 3, v0
    v_mul_lo_u32 v2, v2, s22
    v_and_b32 v3, 7, v0
    v_lshl_add_u32 v2, v3, 4, v2
    s_mul_i32 s33, s3, 8192
    s_lshl_b32 s34, s22, 3
    s_add_u32 s7, s21, 0
    s_mul_i32 s36, s7, s23
    s_lshr_b32 s36, s36, 20
    s_mul_i32 s37, s36, s30
    s_sub_u32 s37, s7, s37
    s_mul_i32 s7, s36, s34
    s_lshl_b32 s7, s7, 2
    s_lshl_b32 s35, s37, 7
    s_add_u32 s7, s7, s35
    s_add_u32 m0, s33, 0
    s_nop 0
    buffer_load_dwordx4 v2, s[12:15], s7 offen lds
    s_add_u32 m0, s33, 1024
    s_add_u32 s7, s7, s34
    buffer_load_dwordx4 v2, s[12:15], s7 offen lds
    s_add_u32 m0, s33, 2048
    s_add_u32 s7, s7, s34
    buffer_load_dwordx4 v2, s[12:15], s7 offen lds
    s_add_u32 m0, s33, 3072
    s_add_u32 s7, s7, s34
    buffer_load_dwordx4 v2, s[12:15], s7 offen lds
    s_add_u32 s7, s21, 1
    s_mul_i32 s38, s7, s23
    s_lshr_b32 s38, s38, 20
    s_mul_i32 s39, s38, s30
    s_sub_u32 s39, s7, s39
    s_mul_i32 s7, s38, s34
    s_lshl_b32 s7, s7, 2
    s_lshl_b32 s35, s39, 7
    s_add_u32 s7, s7, s35
    s_add_u32 m0, s33, 4096
    s_nop 0
    buffer_load_dwordx4 v2, s[12:15], s7 offen lds
    s_add_u32 m0, s33, 5120
    s_add_u32 s7, s7, s34
    buffer_load_dwordx4 v2, s[12:15], s7 offen lds
    s_add_u32 m0, s33, 6144
    s_add_u32 s7, s7, s34
    buffer_load_dwordx4 v2, s[12:15], s7 offen lds
    s_add_u32 m0, s33, 7168
    s_add_u32 s7, s7, s34
    buffer_load_dwordx4 v2, s[12:15], s7 offen lds
    v_lshrrev_b32 v3, 4, v0
    v_lshlrev_b32 v3, s31, v3
    v_bfe_u32 v4, v0, 2, 2
    v_add_u32 v3, v3, v4
    v_and_b32 v4, 3, v0
    v_lshlrev_b32 v4, 3, v4
    v_lshl_add_u32 v3, v3, 7, v4
    v_add_u32 v3, s33, v3
    v_add_u32 v4, s32, v3
    v_lshlrev_b32 v5, 4, v0
    s_cmp_eq_u32 s20, 2
    s_cbranch_scc1 L_swz_down_1
    s_mul_i32 s6, s37, 116509
    s_lshr_b32 s6, s6, 20
    s_mul_i32 s7, s6, 9
    s_sub_u32 s7, s37, s7
    s_mul_i32 s6, s6, 1990656
    s_mul_i32 s7, s7, 36
    s_mul_i32 s34, s36, 349526
    s_lshr_b32 s34, s34, 20
    s_mul_i32 s35, s34, 3
    s_sub_u32 s35, s36, s35
    s_mul_i32 s34, s34, 6
    s_add_u32 s7, s7, s34
    s_add_u32 s7, s7, s35
    s_mul_i32 s34, s20, 3
    s_add_u32 s7, s7, s34
    s_lshl_b32 s7, s7, 10
    s_add_u32 s6, s6, s7
    s_add_u32 s44, s6, 3145728
    s_add_u32 s45, s6, 3643392
    s_add_u32 s46, s6, 4141056
    s_add_u32 s47, s6, 4638720
    s_mul_i32 s6, s39, 116509
    s_lshr_b32 s6, s6, 20
    s_mul_i32 s7, s6, 9
    s_sub_u32 s7, s39, s7
    s_mul_i32 s6, s6, 1990656
    s_mul_i32 s7, s7, 36
    s_mul_i32 s34, s38, 349526
    s_lshr_b32 s34, s34, 20
    s_mul_i32 s35, s34, 3
    s_sub_u32 s35, s38, s35
    s_mul_i32 s34, s34, 6
    s_add_u32 s7, s7, s34
    s_add_u32 s7, s7, s35
    s_mul_i32 s34, s20, 3
    s_add_u32 s7, s7, s34
    s_lshl_b32 s7, s7, 10
    s_add_u32 s6, s6, s7
    s_add_u32 s48, s6, 3145728
    s_add_u32 s49, s6, 3643392
    s_add_u32 s50, s6, 4141056
    s_add_u32 s51, s6, 4638720
    s_branch L_swz_dest_2
L_swz_down_1:
    s_mul_i32 s6, s36, 58255
    s_lshr_b32 s6, s6, 20
    s_mul_i32 s7, s6, 18
    s_sub_u32 s7, s36, s7
    s_mul_i32 s6, s6, 1990656
    s_lshl_b32 s7, s7, 10
    s_add_u32 s6, s6, s7
    s_add_u32 s6, s6, 3477504
    s_lshl_b32 s7, s37, 2
    s_add_u32 s7, s7, 0
    s_mul_i32 s34, s7, 116509
    s_lshr_b32 s34, s34, 20
    s_mul_i32 s35, s34, 9
    s_sub_u32 s35, s7, s35
    s_mul_i32 s34, s34, 497664
    s_mul_i32 s35, s35, 18432
    s_add_u32 s34, s34, s35
    s_add_u32 s44, s6, s34
    s_lshl_b32 s7, s37, 2
    s_add_u32 s7, s7, 1
    s_mul_i32 s34, s7, 116509
    s_lshr_b32 s34, s34, 20
    s_mul_i32 s35, s34, 9
    s_sub_u32 s35, s7, s35
    s_mul_i32 s34, s34, 497664
    s_mul_i32 s35, s35, 18432
    s_add_u32 s34, s34, s35
    s_add_u32 s45, s6, s34
    s_lshl_b32 s7, s37, 2
    s_add_u32 s7, s7, 2
    s_mul_i32 s34, s7, 116509
    s_lshr_b32 s34, s34, 20
    s_mul_i32 s35, s34, 9
    s_sub_u32 s35, s7, s35
    s_mul_i32 s34, s34, 497664
    s_mul_i32 s35, s35, 18432
    s_add_u32 s34, s34, s35
    s_add_u32 s46, s6, s34
    s_lshl_b32 s7, s37, 2
    s_add_u32 s7, s7, 3
    s_mul_i32 s34, s7, 116509
    s_lshr_b32 s34, s34, 20
    s_mul_i32 s35, s34, 9
    s_sub_u32 s35, s7, s35
    s_mul_i32 s34, s34, 497664
    s_mul_i32 s35, s35, 18432
    s_add_u32 s34, s34, s35
    s_add_u32 s47, s6, s34
    s_mul_i32 s6, s38, 58255
    s_lshr_b32 s6, s6, 20
    s_mul_i32 s7, s6, 18
    s_sub_u32 s7, s38, s7
    s_mul_i32 s6, s6, 1990656
    s_lshl_b32 s7, s7, 10
    s_add_u32 s6, s6, s7
    s_add_u32 s6, s6, 3477504
    s_lshl_b32 s7, s39, 2
    s_add_u32 s7, s7, 0
    s_mul_i32 s34, s7, 116509
    s_lshr_b32 s34, s34, 20
    s_mul_i32 s35, s34, 9
    s_sub_u32 s35, s7, s35
    s_mul_i32 s34, s34, 497664
    s_mul_i32 s35, s35, 18432
    s_add_u32 s34, s34, s35
    s_add_u32 s48, s6, s34
    s_lshl_b32 s7, s39, 2
    s_add_u32 s7, s7, 1
    s_mul_i32 s34, s7, 116509
    s_lshr_b32 s34, s34, 20
    s_mul_i32 s35, s34, 9
    s_sub_u32 s35, s7, s35
    s_mul_i32 s34, s34, 497664
    s_mul_i32 s35, s35, 18432
    s_add_u32 s34, s34, s35
    s_add_u32 s49, s6, s34
    s_lshl_b32 s7, s39, 2
    s_add_u32 s7, s7, 2
    s_mul_i32 s34, s7, 116509
    s_lshr_b32 s34, s34, 20
    s_mul_i32 s35, s34, 9
    s_sub_u32 s35, s7, s35
    s_mul_i32 s34, s34, 497664
    s_mul_i32 s35, s35, 18432
    s_add_u32 s34, s34, s35
    s_add_u32 s50, s6, s34
    s_lshl_b32 s7, s39, 2
    s_add_u32 s7, s7, 3
    s_mul_i32 s34, s7, 116509
    s_lshr_b32 s34, s34, 20
    s_mul_i32 s35, s34, 9
    s_sub_u32 s35, s7, s35
    s_mul_i32 s34, s34, 497664
    s_mul_i32 s35, s35, 18432
    s_add_u32 s34, s34, s35
    s_add_u32 s51, s6, s34
L_swz_dest_2:
    s_waitcnt vmcnt(4)
    ds_read_b64_tr_b16 v[8:9], v3 offset:0
    ds_read_b64_tr_b16 v[10:11], v4 offset:0
    ds_read_b64_tr_b16 v[12:13], v3 offset:32
    ds_read_b64_tr_b16 v[14:15], v4 offset:32
    ds_read_b64_tr_b16 v[16:17], v3 offset:64
    ds_read_b64_tr_b16 v[18:19], v4 offset:64
    ds_read_b64_tr_b16 v[20:21], v3 offset:96
    ds_read_b64_tr_b16 v[22:23], v4 offset:96
    s_waitcnt lgkmcnt(6)
    buffer_store_dwordx4 v[8:11], v5, s[8:11], s44 offen
    s_waitcnt lgkmcnt(4)
    buffer_store_dwordx4 v[12:15], v5, s[8:11], s45 offen
    s_waitcnt lgkmcnt(2)
    buffer_store_dwordx4 v[16:19], v5, s[8:11], s46 offen
    s_waitcnt lgkmcnt(0)
    buffer_store_dwordx4 v[20:23], v5, s[8:11], s47 offen
    s_waitcnt vmcnt(4)
    ds_read_b64_tr_b16 v[24:25], v3 offset:4096
    ds_read_b64_tr_b16 v[26:27], v4 offset:4096
    ds_read_b64_tr_b16 v[28:29], v3 offset:4128
    ds_read_b64_tr_b16 v[30:31], v4 offset:4128
    ds_read_b64_tr_b16 v[32:33], v3 offset:4160
    ds_read_b64_tr_b16 v[34:35], v4 offset:4160
    ds_read_b64_tr_b16 v[36:37], v3 offset:4192
    ds_read_b64_tr_b16 v[38:39], v4 offset:4192
    s_waitcnt lgkmcnt(6)
    buffer_store_dwordx4 v[24:27], v5, s[8:11], s48 offen
    s_waitcnt lgkmcnt(4)
    buffer_store_dwordx4 v[28:31], v5, s[8:11], s49 offen
    s_waitcnt lgkmcnt(2)
    buffer_store_dwordx4 v[32:35], v5, s[8:11], s50 offen
    s_waitcnt lgkmcnt(0)
    buffer_store_dwordx4 v[36:39], v5, s[8:11], s51 offen
    s_branch L_prep_fin
L_prep_q:
    s_cmp_ge_u32 s2, 732
    s_cbranch_scc1 L_prep_ln
    s_load_dwordx2 s[24:25], s[0:1], 8
    s_load_dwordx2 s[26:27], s[0:1], 16
    s_waitcnt lgkmcnt(0)
    s_cmp_ge_u32 s2, 678
    s_cbranch_scc1 L_prep_o
    s_mov_b32 s12, s24
    s_and_b32 s13, s25, 0xffff
    s_mov_b32 s14, 1990656
    s_mov_b32 s15, 0x20000
    s_sub_u32 s20, s2, 486
    s_lshl_b32 s20, s20, 2
    s_add_u32 s20, s20, s3
    s_mul_i32 s20, s20, 3
    s_mul_i32 s21, s20, 14564
    s_lshr_b32 s21, s21, 20
    s_mul_i32 s22, s21, 72
    s_sub_u32 s22, s20, s22
    s_mul_i32 s21, s21, 36
    v_and_b32 v2, 15, v0
    v_lshrrev_b32 v3, 4, v0
    v_mul_u32_u24 v3, 27648, v3
    v_add_u32 v3, s21, v3
    v_lshlrev_b32 v5, 4, v0
    v_lshl_add_u32 v6, v2, 1, v3
    v_lshrrev_b32 v7, 1, v2
    v_mul_u32_u24 v7, 1152, v7
    v_and_b32 v8, 1, v2
    v_lshl_add_u32 v7, v8, 1, v7
    v_add3_u32 v7, v7, v3, 32
    v_mov_b32 v9, 1073741824
    v_cmp_gt_u32 vcc, 6, v2
    s_mov_b32 s31, 3456
    s_mov_b32 s32, 6912
    s_mov_b32 s33, 10368
    s_mov_b32 s34, 13824
    s_mov_b32 s35, 17280
    s_mov_b32 s36, 20736
    s_mov_b32 s37, 24192
    v_cndmask_b32 v7, v9, v7, vcc
    s_add_u32 s7, s22, 0
    s_and_b32 s6, s7, 3
    s_lshr_b32 s7, s7, 2
    s_mul_i32 s7, s7, 110592
    s_cmp_eq_u32 s6, 3
    s_cselect_b64 vcc, -1, 0
    s_mul_i32 s6, s6, 1152
    v_add_u32 v4, s6, v6
    v_cndmask_b32 v4, v4, v7, vcc
    v_add_u32 v10, s7, v4
    buffer_load_ushort v16, v10, s[12:15], 0 offen
    buffer_load_ushort v17, v10, s[12:15], s31 offen
    buffer_load_ushort v18, v10, s[12:15], s32 offen
    buffer_load_ushort v19, v10, s[12:15], s33 offen
    buffer_load_ushort v20, v10, s[12:15], s34 offen
    buffer_load_ushort v21, v10, s[12:15], s35 offen
    buffer_load_ushort v22, v10, s[12:15], s36 offen
    buffer_load_ushort v23, v10, s[12:15], s37 offen
    s_add_u32 s7, s22, 1
    s_and_b32 s6, s7, 3
    s_lshr_b32 s7, s7, 2
    s_mul_i32 s7, s7, 110592
    s_cmp_eq_u32 s6, 3
    s_cselect_b64 vcc, -1, 0
    s_mul_i32 s6, s6, 1152
    v_add_u32 v4, s6, v6
    v_cndmask_b32 v4, v4, v7, vcc
    v_add_u32 v11, s7, v4
    buffer_load_ushort v24, v11, s[12:15], 0 offen
    buffer_load_ushort v25, v11, s[12:15], s31 offen
    buffer_load_ushort v26, v11, s[12:15], s32 offen
    buffer_load_ushort v27, v11, s[12:15], s33 offen
    buffer_load_ushort v28, v11, s[12:15], s34 offen
    buffer_load_ushort v29, v11, s[12:15], s35 offen
    buffer_load_ushort v30, v11, s[12:15], s36 offen
    buffer_load_ushort v31, v11, s[12:15], s37 offen
    s_add_u32 s7, s22, 2
    s_and_b32 s6, s7, 3
    s_lshr_b32 s7, s7, 2
    s_mul_i32 s7, s7, 110592
    s_cmp_eq_u32 s6, 3
    s_cselect_b64 vcc, -1, 0
    s_mul_i32 s6, s6, 1152
    v_add_u32 v4, s6, v6
    v_cndmask_b32 v4, v4, v7, vcc
    v_add_u32 v12, s7, v4
    buffer_load_ushort v32, v12, s[12:15], 0 offen
    buffer_load_ushort v33, v12, s[12:15], s31 offen
    buffer_load_ushort v34, v12, s[12:15], s32 offen
    buffer_load_ushort v35, v12, s[12:15], s33 offen
    buffer_load_ushort v36, v12, s[12:15], s34 offen
    buffer_load_ushort v37, v12, s[12:15], s35 offen
    buffer_load_ushort v38, v12, s[12:15], s36 offen
    buffer_load_ushort v39, v12, s[12:15], s37 offen
    s_lshl_b32 s20, s20, 10
    s_add_u32 s20, s20, 0
    s_waitcnt vmcnt(16)
    v_lshl_or_b32 v44, v17, 16, v16
    v_lshl_or_b32 v45, v19, 16, v18
    v_lshl_or_b32 v46, v21, 16, v20
    v_lshl_or_b32 v47, v23, 16, v22
    buffer_store_dwordx4 v[44:47], v5, s[8:11], s20 offen offset:0
    s_waitcnt vmcnt(9)
    v_lshl_or_b32 v48, v25, 16, v24
    v_lshl_or_b32 v49, v27, 16, v26
    v_lshl_or_b32 v50, v29, 16, v28
    v_lshl_or_b32 v51, v31, 16, v30
    buffer_store_dwordx4 v[48:51], v5, s[8:11], s20 offen offset:1024
    s_waitcnt vmcnt(2)
    v_lshl_or_b32 v52, v33, 16, v32
    v_lshl_or_b32 v53, v35, 16, v34
    v_lshl_or_b32 v54, v37, 16, v36
    v_lshl_or_b32 v55, v39, 16, v38
    buffer_store_dwordx4 v[52:55], v5, s[8:11], s20 offen offset:2048
    s_branch L_prep_fin
L_prep_o:
    s_mov_b32 s12, s26
    s_and_b32 s13, s27, 0xffff
    s_mov_b32 s14, 663552
    s_mov_b32 s15, 0x20000
    s_sub_u32 s20, s2, 678
    s_lshl_b32 s20, s20, 2
    s_add_u32 s20, s20, s3
    s_mul_i32 s20, s20, 3
    s_mul_i32 s21, s20, 58255
    s_lshr_b32 s21, s21, 20
    s_mul_i32 s22, s21, 18
    s_sub_u32 s22, s20, s22
    s_lshl_b32 s21, s21, 5
    v_and_b32 v2, 15, v0
    v_lshl_add_u32 v2, v2, 1, s21
    v_lshrrev_b32 v3, 4, v0
    v_lshlrev_b32 v5, 4, v0
    s_movk_i32 s23, 1152
    s_add_u32 s7, s22, 0
    s_lshl_b32 s7, s7, 2
    v_add_u32 v4, s7, v3
    v_mul_u32_u24 v6, 7282, v4
    v_lshrrev_b32 v6, 16, v6
    v_mul_u32_u24 v7, 9, v6
    v_sub_u32 v7, v4, v7
    v_mul_u32_u24 v6, 72, v6
    v_cmp_eq_u32 vcc, 8, v7
    v_lshrrev_b32 v8, 1, v7
    v_mad_u32_u24 v8, v8, 18, v6
    v_and_b32 v7, 1, v7
    v_lshl_add_u32 v8, v7, 3, v8
    v_mad_u32_u24 v8, v8, s23, v2
    v_add_u32 v6, 16, v6
    v_mad_u32_u24 v6, v6, s23, v2
    v_add_u32 v9, 0, v8
    v_add_u32 v10, 0, v6
    v_cndmask_b32 v9, v9, v10, vcc
    buffer_load_ushort v16, v9, s[12:15], 0 offen
    v_add_u32 v9, 1152, v8
    v_add_u32 v10, 1152, v6
    v_cndmask_b32 v9, v9, v10, vcc
    buffer_load_ushort v17, v9, s[12:15], 0 offen
    v_add_u32 v9, 2304, v8
    v_add_u32 v10, 20736, v6
    v_cndmask_b32 v9, v9, v10, vcc
    buffer_load_ushort v18, v9, s[12:15], 0 offen
    v_add_u32 v9, 3456, v8
    v_add_u32 v10, 21888, v6
    v_cndmask_b32 v9, v9, v10, vcc
    buffer_load_ushort v19, v9, s[12:15], 0 offen
    v_add_u32 v9, 4608, v8
    v_add_u32 v10, 41472, v6
    v_cndmask_b32 v9, v9, v10, vcc
    buffer_load_ushort v20, v9, s[12:15], 0 offen
    v_add_u32 v9, 5760, v8
    v_add_u32 v10, 42624, v6
    v_cndmask_b32 v9, v9, v10, vcc
    buffer_load_ushort v21, v9, s[12:15], 0 offen
    v_add_u32 v9, 6912, v8
    v_add_u32 v10, 62208, v6
    v_cndmask_b32 v9, v9, v10, vcc
    buffer_load_ushort v22, v9, s[12:15], 0 offen
    v_add_u32 v9, 8064, v8
    v_add_u32 v10, 63360, v6
    v_cndmask_b32 v9, v9, v10, vcc
    buffer_load_ushort v23, v9, s[12:15], 0 offen
    s_add_u32 s7, s22, 1
    s_lshl_b32 s7, s7, 2
    v_add_u32 v4, s7, v3
    v_mul_u32_u24 v6, 7282, v4
    v_lshrrev_b32 v6, 16, v6
    v_mul_u32_u24 v7, 9, v6
    v_sub_u32 v7, v4, v7
    v_mul_u32_u24 v6, 72, v6
    v_cmp_eq_u32 vcc, 8, v7
    v_lshrrev_b32 v8, 1, v7
    v_mad_u32_u24 v8, v8, 18, v6
    v_and_b32 v7, 1, v7
    v_lshl_add_u32 v8, v7, 3, v8
    v_mad_u32_u24 v8, v8, s23, v2
    v_add_u32 v6, 16, v6
    v_mad_u32_u24 v6, v6, s23, v2
    v_add_u32 v9, 0, v8
    v_add_u32 v10, 0, v6
    v_cndmask_b32 v9, v9, v10, vcc
    buffer_load_ushort v24, v9, s[12:15], 0 offen
    v_add_u32 v9, 1152, v8
    v_add_u32 v10, 1152, v6
    v_cndmask_b32 v9, v9, v10, vcc
    buffer_load_ushort v25, v9, s[12:15], 0 offen
    v_add_u32 v9, 2304, v8
    v_add_u32 v10, 20736, v6
    v_cndmask_b32 v9, v9, v10, vcc
    buffer_load_ushort v26, v9, s[12:15], 0 offen
    v_add_u32 v9, 3456, v8
    v_add_u32 v10, 21888, v6
    v_cndmask_b32 v9, v9, v10, vcc
    buffer_load_ushort v27, v9, s[12:15], 0 offen
    v_add_u32 v9, 4608, v8
    v_add_u32 v10, 41472, v6
    v_cndmask_b32 v9, v9, v10, vcc
    buffer_load_ushort v28, v9, s[12:15], 0 offen
    v_add_u32 v9, 5760, v8
    v_add_u32 v10, 42624, v6
    v_cndmask_b32 v9, v9, v10, vcc
    buffer_load_ushort v29, v9, s[12:15], 0 offen
    v_add_u32 v9, 6912, v8
    v_add_u32 v10, 62208, v6
    v_cndmask_b32 v9, v9, v10, vcc
    buffer_load_ushort v30, v9, s[12:15], 0 offen
    v_add_u32 v9, 8064, v8
    v_add_u32 v10, 63360, v6
    v_cndmask_b32 v9, v9, v10, vcc
    buffer_load_ushort v31, v9, s[12:15], 0 offen
    s_add_u32 s7, s22, 2
    s_lshl_b32 s7, s7, 2
    v_add_u32 v4, s7, v3
    v_mul_u32_u24 v6, 7282, v4
    v_lshrrev_b32 v6, 16, v6
    v_mul_u32_u24 v7, 9, v6
    v_sub_u32 v7, v4, v7
    v_mul_u32_u24 v6, 72, v6
    v_cmp_eq_u32 vcc, 8, v7
    v_lshrrev_b32 v8, 1, v7
    v_mad_u32_u24 v8, v8, 18, v6
    v_and_b32 v7, 1, v7
    v_lshl_add_u32 v8, v7, 3, v8
    v_mad_u32_u24 v8, v8, s23, v2
    v_add_u32 v6, 16, v6
    v_mad_u32_u24 v6, v6, s23, v2
    v_add_u32 v9, 0, v8
    v_add_u32 v10, 0, v6
    v_cndmask_b32 v9, v9, v10, vcc
    buffer_load_ushort v32, v9, s[12:15], 0 offen
    v_add_u32 v9, 1152, v8
    v_add_u32 v10, 1152, v6
    v_cndmask_b32 v9, v9, v10, vcc
    buffer_load_ushort v33, v9, s[12:15], 0 offen
    v_add_u32 v9, 2304, v8
    v_add_u32 v10, 20736, v6
    v_cndmask_b32 v9, v9, v10, vcc
    buffer_load_ushort v34, v9, s[12:15], 0 offen
    v_add_u32 v9, 3456, v8
    v_add_u32 v10, 21888, v6
    v_cndmask_b32 v9, v9, v10, vcc
    buffer_load_ushort v35, v9, s[12:15], 0 offen
    v_add_u32 v9, 4608, v8
    v_add_u32 v10, 41472, v6
    v_cndmask_b32 v9, v9, v10, vcc
    buffer_load_ushort v36, v9, s[12:15], 0 offen
    v_add_u32 v9, 5760, v8
    v_add_u32 v10, 42624, v6
    v_cndmask_b32 v9, v9, v10, vcc
    buffer_load_ushort v37, v9, s[12:15], 0 offen
    v_add_u32 v9, 6912, v8
    v_add_u32 v10, 62208, v6
    v_cndmask_b32 v9, v9, v10, vcc
    buffer_load_ushort v38, v9, s[12:15], 0 offen
    v_add_u32 v9, 8064, v8
    v_add_u32 v10, 63360, v6
    v_cndmask_b32 v9, v9, v10, vcc
    buffer_load_ushort v39, v9, s[12:15], 0 offen
    s_lshl_b32 s20, s20, 10
    s_add_u32 s20, s20, 2359296
    s_waitcnt vmcnt(16)
    v_lshl_or_b32 v44, v17, 16, v16
    v_lshl_or_b32 v45, v19, 16, v18
    v_lshl_or_b32 v46, v21, 16, v20
    v_lshl_or_b32 v47, v23, 16, v22
    buffer_store_dwordx4 v[44:47], v5, s[8:11], s20 offen offset:0
    s_waitcnt vmcnt(9)
    v_lshl_or_b32 v48, v25, 16, v24
    v_lshl_or_b32 v49, v27, 16, v26
    v_lshl_or_b32 v50, v29, 16, v28
    v_lshl_or_b32 v51, v31, 16, v30
    buffer_store_dwordx4 v[48:51], v5, s[8:11], s20 offen offset:1024
    s_waitcnt vmcnt(2)
    v_lshl_or_b32 v52, v33, 16, v32
    v_lshl_or_b32 v53, v35, 16, v34
    v_lshl_or_b32 v54, v37, 16, v36
    v_lshl_or_b32 v55, v39, 16, v38
    buffer_store_dwordx4 v[52:55], v5, s[8:11], s20 offen offset:2048
    s_branch L_prep_fin
L_prep_ln:
    s_load_dwordx2 s[6:7], s[0:1], 0
    s_waitcnt lgkmcnt(0)
    s_mov_b32 s12, s6
    s_and_b32 s13, s7, 0xffff
    s_mov_b32 s14, 2359296
    s_mov_b32 s15, 0x20000
    s_sub_u32 s21, s2, 732
    s_mov_b32 s16, 0xffff0000
    s_lshl_b32 s7, s3, 10
    v_lshl_add_u32 v2, v0, 4, s7
    v_add_u32 v3, 4096, v2
    v_and_b32 v8, 7, v0
    v_mul_u32_u24 v8, 1152, v8
    v_lshrrev_b32 v9, 3, v0
    v_lshl_add_u32 v8, v9, 4, v8
    s_lshl_b32 s7, s3, 7
    v_add_u32 v5, s7, v8
    v_add_u32 v6, 512, v5
    s_cmp_eq_u32 s3, 0
    s_mov_b32 s17, 1073741824
    s_cmov_b32 s17, 8192
    v_add_u32 v4, s17, v2
    s_mov_b32 s17, 1073741824
    s_cmov_b32 s17, 1024
    v_add_u32 v7, s17, v5
    s_mul_i32 s18, s21, 9216
    buffer_load_dwordx4 v[16:19], v5, s[12:15], s18 offen
    buffer_load_dwordx4 v[20:23], v6, s[12:15], s18 offen
    buffer_load_dwordx4 v[24:27], v7, s[12:15], s18 offen
    v_mov_b32 v60, 0
    v_mov_b32 v61, 0
    v_mov_b32 v62, 0
    v_mov_b32 v63, 0
    s_lshl_b32 s19, s21, 7
    s_add_u32 s19, s19, 19136512
    v_and_b32 v14, 31, v0
    v_lshlrev_b32 v14, 2, v14
    buffer_store_dword v60, v14, s[8:11], s19 offen
    s_cmp_ge_u32 s21, 4
    s_cbranch_scc1 L_nopad_3
    s_and_b32 s19, s21, 1
    s_mul_i32 s19, s19, 9216
    s_lshr_b32 s20, s21, 1
    s_mul_i32 s20, s20, 29360128
    s_add_u32 s19, s19, s20
    s_add_u32 s19, s19, 19904512
    buffer_store_dwordx4 v[60:63], v2, s[8:11], s19 offen
    buffer_store_dwordx4 v[60:63], v3, s[8:11], s19 offen
    buffer_store_dwordx4 v[60:63], v4, s[8:11], s19 offen
L_nopad_3:
    s_add_u32 s19, s18, 27000832
    s_add_u32 s20, s18, 19922944
    s_waitcnt vmcnt(0)
    buffer_store_dwordx4 v[16:19], v2, s[8:11], s19 offen
    buffer_store_dwordx4 v[20:23], v3, s[8:11], s19 offen
    buffer_store_dwordx4 v[24:27], v4, s[8:11], s19 offen
    s_mov_b32 s17, 0x3f803f80
    v_mov_b32 v8, 0
    v_mov_b32 v9, 0
    v_mov_b32 v10, 0
    v_mov_b32 v11, 0
    v_dot2c_f32_bf16 v8, s17, v16
    v_dot2c_f32_bf16 v9, v16, v16
    v_dot2c_f32_bf16 v10, s17, v17
    v_dot2c_f32_bf16 v11, v17, v17
    v_dot2c_f32_bf16 v8, s17, v18
    v_dot2c_f32_bf16 v9, v18, v18
    v_dot2c_f32_bf16 v10, s17, v19
    v_dot2c_f32_bf16 v11, v19, v19
    v_dot2c_f32_bf16 v8, s17, v20
    v_dot2c_f32_bf16 v9, v20, v20
    v_dot2c_f32_bf16 v10, s17, v21
    v_dot2c_f32_bf16 v11, v21, v21
    v_dot2c_f32_bf16 v8, s17, v22
    v_dot2c_f32_bf16 v9, v22, v22
    v_dot2c_f32_bf16 v10, s17, v23
    v_dot2c_f32_bf16 v11, v23, v23
    v_dot2c_f32_bf16 v8, s17, v24
    v_dot2c_f32_bf16 v9, v24, v24
    v_dot2c_f32_bf16 v10, s17, v25
    v_dot2c_f32_bf16 v11, v25, v25
    v_dot2c_f32_bf16 v8, s17, v26
    v_dot2c_f32_bf16 v9, v26, v26
    v_dot2c_f32_bf16 v10, s17, v27
    v_dot2c_f32_bf16 v11, v27, v27
    v_and_b32 v12, 7, v0
    v_lshlrev_b32 v12, 3, v12
    s_lshl_b32 s7, s3, 6
    v_add_u32 v13, s7, v12
    v_pk_add_f32 v[8:9], v[8:9], v[10:11]
    s_nop 1
    v_add_f32_dpp v8, v8, v8 row_ror:8 row_mask:0xf bank_mask:0xf
    v_add_f32_dpp v9, v9, v9 row_ror:8 row_mask:0xf bank_mask:0xf
    v_mov_b32 v10, v8
    v_mov_b32 v11, v9
    s_nop 1
    v_permlane32_swap_b32 v10, v8
    v_permlane32_swap_b32 v11, v9
    v_add_f32 v8, v8, v10
    v_add_f32 v9, v9, v11
    v_mov_b32 v10, v8
    v_mov_b32 v11, v9
    s_nop 1
    v_permlane16_swap_b32 v10, v8
    v_permlane16_swap_b32 v11, v9
    v_add_f32 v8, v8, v10
    v_add_f32 v9, v9, v11
    ds_write_b64 v13, v[8:9]
    s_waitcnt lgkmcnt(0)
    s_barrier
    ds_read_b64 v[40:41], v12 offset:0
    ds_read_b64 v[42:43], v12 offset:64
    ds_read_b64 v[44:45], v12 offset:128
    ds_read_b64 v[46:47], v12 offset:192
    s_waitcnt lgkmcnt(0)
    v_pk_add_f32 v[40:41], v[40:41], v[42:43]
    v_pk_add_f32 v[44:45], v[44:45], v[46:47]
    v_pk_add_f32 v[8:9], v[40:41], v[44:45]
    v_mul_f32 v8, 0x3ae38e39, v8
    v_mul_f32 v9, 0x3ae38e39, v9
    v_fma_f32 v9, -v8, v8, v9
    v_max_f32 v9, 0, v9
    v_add_f32 v9, 0x3727c5ac, v9
    v_rsq_f32 v10, v9
    s_nop 0
    v_mul_f32 v12, v8, v10
    v_mov_b32 v11, v10
    v_sub_f32 v12, 0, v12
    v_mov_b32 v13, v12
    v_lshlrev_b32 v40, 16, v16
    v_and_b32 v41, s16, v16
    v_lshlrev_b32 v42, 16, v17
    v_and_b32 v43, s16, v17
    v_lshlrev_b32 v44, 16, v18
    v_and_b32 v45, s16, v18
    v_lshlrev_b32 v46, 16, v19
    v_and_b32 v47, s16, v19
    v_pk_fma_f32 v[40:41], v[40:41], v[10:11], v[12:13]
    v_pk_fma_f32 v[42:43], v[42:43], v[10:11], v[12:13]
    v_pk_fma_f32 v[44:45], v[44:45], v[10:11], v[12:13]
    v_pk_fma_f32 v[46:47], v[46:47], v[10:11], v[12:13]
    v_cvt_pk_bf16_f32 v48, v40, v41
    v_cvt_pk_bf16_f32 v49, v42, v43
    v_cvt_pk_bf16_f32 v50, v44, v45
    v_cvt_pk_bf16_f32 v51, v46, v47
    v_lshlrev_b32 v40, 16, v20
    v_and_b32 v41, s16, v20
    v_lshlrev_b32 v42, 16, v21
    v_and_b32 v43, s16, v21
    v_lshlrev_b32 v44, 16, v22
    v_and_b32 v45, s16, v22
    v_lshlrev_b32 v46, 16, v23
    v_and_b32 v47, s16, v23
    v_pk_fma_f32 v[40:41], v[40:41], v[10:11], v[12:13]
    v_pk_fma_f32 v[42:43], v[42:43], v[10:11], v[12:13]
    v_pk_fma_f32 v[44:45], v[44:45], v[10:11], v[12:13]
    v_pk_fma_f32 v[46:47], v[46:47], v[10:11], v[12:13]
    v_cvt_pk_bf16_f32 v52, v40, v41
    v_cvt_pk_bf16_f32 v53, v42, v43
    v_cvt_pk_bf16_f32 v54, v44, v45
    v_cvt_pk_bf16_f32 v55, v46, v47
    v_lshlrev_b32 v40, 16, v24
    v_and_b32 v41, s16, v24
    v_lshlrev_b32 v42, 16, v25
    v_and_b32 v43, s16, v25
    v_lshlrev_b32 v44, 16, v26
    v_and_b32 v45, s16, v26
    v_lshlrev_b32 v46, 16, v27
    v_and_b32 v47, s16, v27
    v_pk_fma_f32 v[40:41], v[40:41], v[10:11], v[12:13]
    v_pk_fma_f32 v[42:43], v[42:43], v[10:11], v[12:13]
    v_pk_fma_f32 v[44:45], v[44:45], v[10:11], v[12:13]
    v_pk_fma_f32 v[46:47], v[46:47], v[10:11], v[12:13]
    v_cvt_pk_bf16_f32 v56, v40, v41
    v_cvt_pk_bf16_f32 v57, v42, v43
    v_cvt_pk_bf16_f32 v58, v44, v45
    v_cvt_pk_bf16_f32 v59, v46, v47
    buffer_store_dwordx4 v[48:51], v2, s[8:11], s20 offen
    buffer_store_dwordx4 v[52:55], v3, s[8:11], s20 offen
    buffer_store_dwordx4 v[56:59], v4, s[8:11], s20 offen
L_prep_fin:
L_prep_end:
    s_endpgm
.text
.globl main_kernel
.p2align 8
.type main_kernel,@function
main_kernel:
    s_cmp_ge_u32 s2, 256
    s_cbranch_scc1 L_main_end
    s_load_dwordx2 s[4:5], s[0:1], 72
    s_load_dwordx2 s[6:7], s[0:1], 56
    v_lshrrev_b32 v1, 6, v0
    v_and_b32 v0, 63, v0
    v_readfirstlane_b32 s3, v1
    s_waitcnt lgkmcnt(0)
    s_mov_b32 s8, s4
    s_and_b32 s9, s5, 0xffff
    s_mov_b32 s10, 268435456
    s_mov_b32 s11, 0x20000
    s_mov_b32 s12, s6
    s_and_b32 s13, s7, 0xffff
    s_mov_b32 s14, 2359296
    s_mov_b32 s15, 0x20000
    s_mov_b32 s48, s4
    s_and_b32 s49, s5, 0xffff
    s_mov_b32 s50, 268435456
    s_mov_b32 s51, 0x20000
    s_and_b32 s40, s2, 1
    s_lshl_b32 s40, s40, 2
    s_bfe_u32 s7, s2, 131075
    s_add_u32 s40, s40, s7
    s_bfe_u32 s41, s2, 131073
    s_lshl_b32 s41, s41, 3
    s_lshr_b32 s7, s2, 5
    s_add_u32 s41, s41, s7
    s_mov_b32 s42, 0
    s_mov_b32 s43, 0
    s_lshl_b32 s44, s41, 7
    s_add_u32 s44, s44, 19136512
L_main_layer:
    s_lshl_b32 s27, s40, 2
    s_add_u32 s27, s27, s3
    s_mul_i32 s28, s27, 73728
    s_add_u32 s50, s28, 73728
    v_lshlrev_b32 v4, 4, v0
    buffer_load_dwordx4 a[0:3], v4, s[48:51], s28 offen offset:0
    buffer_load_dwordx4 a[4:7], v4, s[48:51], s28 offen offset:1024
    buffer_load_dwordx4 a[8:11], v4, s[48:51], s28 offen offset:2048
    buffer_load_dwordx4 a[12:15], v4, s[48:51], s28 offen offset:3072
    s_add_u32 s28, s28, 4096
    buffer_load_dwordx4 a[16:19], v4, s[48:51], s28 offen offset:0
    buffer_load_dwordx4 a[20:23], v4, s[48:51], s28 offen offset:1024
    buffer_load_dwordx4 a[24:27], v4, s[48:51], s28 offen offset:2048
    buffer_load_dwordx4 a[28:31], v4, s[48:51], s28 offen offset:3072
    s_add_u32 s28, s28, 4096
    buffer_load_dwordx4 a[32:35], v4, s[48:51], s28 offen offset:0
    buffer_load_dwordx4 a[36:39], v4, s[48:51], s28 offen offset:1024
    buffer_load_dwordx4 a[40:43], v4, s[48:51], s28 offen offset:2048
    buffer_load_dwordx4 a[44:47], v4, s[48:51], s28 offen offset:3072
    s_add_u32 s28, s28, 4096
    buffer_load_dwordx4 a[48:51], v4, s[48:51], s28 offen offset:0
    buffer_load_dwordx4 a[52:55], v4, s[48:51], s28 offen offset:1024
    buffer_load_dwordx4 a[56:59], v4, s[48:51], s28 offen offset:2048
    buffer_load_dwordx4 a[60:63], v4, s[48:51], s28 offen offset:3072
    s_add_u32 s28, s28, 4096
    buffer_load_dwordx4 a[64:67], v4, s[48:51], s28 offen offset:0
    buffer_load_dwordx4 a[68:71], v4, s[48:51], s28 offen offset:1024
    buffer_load_dwordx4 a[72:75], v4, s[48:51], s28 offen offset:2048
    buffer_load_dwordx4 a[76:79], v4, s[48:51], s28 offen offset:3072
    s_add_u32 s28, s28, 4096
    v_bfe_u32 v3, v0, 3, 1
    v_mul_u32_u24 v2, 9216, v3
    v_lshrrev_b32 v3, 4, v0
    v_lshl_add_u32 v2, v3, 7, v2
    v_and_b32 v3, 7, v0
    v_lshl_add_u32 v2, v3, 4, v2
    v_bfe_u32 v3, v0, 3, 2
    s_mov_b32 s7, 9216
    v_mul_lo_u32 v9, v3, s7
    v_lshrrev_b32 v3, 5, v0
    v_lshl_add_u32 v9, v3, 7, v9
    v_and_b32 v3, 7, v0
    v_lshl_add_u32 v9, v3, 4, v9
    s_mul_i32 s22, s41, 73728
    s_add_u32 s22, s22, s43
    s_add_u32 s23, s22, 19904512
    s_mul_i32 s7, s3, 18432
    s_add_u32 s24, s23, s7
    s_add_u32 s24, s24, 18432
    v_mov_b32 v56, 0
    v_mov_b32 v57, 0
    v_mov_b32 v58, 0
    v_mov_b32 v59, 0
    v_mov_b32 v60, 0
    v_mov_b32 v61, 0
    v_mov_b32 v62, 0
    v_mov_b32 v63, 0
    v_mov_b32 v64, 0
    v_mov_b32 v65, 0
    v_mov_b32 v66, 0
    v_mov_b32 v67, 0
    v_mov_b32 v68, 0
    v_mov_b32 v69, 0
    v_mov_b32 v70, 0
    v_mov_b32 v71, 0
    v_mov_b32 v72, 0
    v_mov_b32 v73, 0
    v_mov_b32 v74, 0
    v_mov_b32 v75, 0
    v_mov_b32 v76, 0
    v_mov_b32 v77, 0
    v_mov_b32 v78, 0
    v_mov_b32 v79, 0
    v_mov_b32 v80, 0
    v_mov_b32 v81, 0
    v_mov_b32 v82, 0
    v_mov_b32 v83, 0
    v_mov_b32 v84, 0
    v_mov_b32 v85, 0
    v_mov_b32 v86, 0
    v_mov_b32 v87, 0
    v_mov_b32 v88, 0
    v_mov_b32 v89, 0
    v_mov_b32 v90, 0
    v_mov_b32 v91, 0
    v_mov_b32 v92, 0
    v_mov_b32 v93, 0
    v_mov_b32 v94, 0
    v_mov_b32 v95, 0
    v_mov_b32 v96, 0
    v_mov_b32 v97, 0
    v_mov_b32 v98, 0
    v_mov_b32 v99, 0
    v_mov_b32 v100, 0
    v_mov_b32 v101, 0
    v_mov_b32 v102, 0
    v_mov_b32 v103, 0
    v_mov_b32 v104, 0
    v_mov_b32 v105, 0
    v_mov_b32 v106, 0
    v_mov_b32 v107, 0
    v_mov_b32 v108, 0
    v_mov_b32 v109, 0
    v_mov_b32 v110, 0
    v_mov_b32 v111, 0
    v_mov_b32 v112, 0
    v_mov_b32 v113, 0
    v_mov_b32 v114, 0
    v_mov_b32 v115, 0
    v_mov_b32 v116, 0
    v_mov_b32 v117, 0
    v_mov_b32 v118, 0
    v_mov_b32 v119, 0
    v_mov_b32 v120, 0
    v_mov_b32 v121, 0
    v_mov_b32 v122, 0
    v_mov_b32 v123, 0
    v_mov_b32 v124, 0
    v_mov_b32 v125, 0
    v_mov_b32 v126, 0
    v_mov_b32 v127, 0
    v_mov_b32 v128, 0
    v_mov_b32 v129, 0
    v_mov_b32 v130, 0
    v_mov_b32 v131, 0
    v_mov_b32 v132, 0
    v_mov_b32 v133, 0
    v_mov_b32 v192, 0
    v_mov_b32 v193, 0
    v_mov_b32 v195, 0
    v_mov_b32 v135, 0
    v_mov_b32 v139, 0
    v_mov_b32 v143, 0
    v_mov_b32 v147, 0
    v_mov_b32 v151, 0
    v_mov_b32 v155, 0
    v_mov_b32 v159, 0
    v_mov_b32 v163, 0
    v_mov_b32 v167, 0
    v_mov_b32 v171, 0
    v_cmp_eq_u32 vcc, 16, v0
    v_mov_b32 v10, 0x3f80
    v_cmp_eq_u32 s[20:21], 17, v0
    v_cndmask_b32 v194, 0, v10, vcc
    v_and_b32 v11, 3, v0
    v_cndmask_b32 v194, v194, 1.0, s[20:21]
    v_cmp_eq_u32 vcc, 2, v11
    v_and_b32 v10, 15, v0
    v_lshrrev_b32 v11, 4, v0
    v_cndmask_b32 v196, 0, 1.0, vcc
    v_cndmask_b32 v197, 0, 1.0, vcc
    v_cndmask_b32 v198, 0, 1.0, vcc
    v_cndmask_b32 v199, 0, 1.0, vcc
    v_lshlrev_b32 v11, 2, v11
    v_sub_u32 v10, v11, v10
    v_mov_b32 v12, 0xf149f2ca
    s_cmp_eq_u32 s41, 0
    s_cselect_b64 s[38:39], 0, -1
    v_add_u32 v11, 0, v10
    v_and_b32 v13, 1, v11
    v_cmp_eq_u32 s[20:21], 0, v13
    v_cmp_lt_i32 vcc, 1, v11
    v_cmp_gt_i32 s[18:19], 1, v11
    s_and_b64 vcc, vcc, s[20:21]
    s_and_b64 s[18:19], s[18:19], s[20:21]
    s_and_b64 s[20:21], vcc, s[38:39]
    v_cndmask_b32 v200, v12, 0, vcc
    v_cndmask_b32 v204, v12, 0, s[18:19]
    v_cndmask_b32 v208, v12, 0, s[20:21]
    v_add_u32 v11, 1, v10
    v_and_b32 v13, 1, v11
    v_cmp_eq_u32 s[20:21], 0, v13
    v_cmp_lt_i32 vcc, 1, v11
    v_cmp_gt_i32 s[18:19], 1, v11
    s_and_b64 vcc, vcc, s[20:21]
    s_and_b64 s[18:19], s[18:19], s[20:21]
    s_and_b64 s[20:21], vcc, s[38:39]
    v_cndmask_b32 v201, v12, 0, vcc
    v_cndmask_b32 v205, v12, 0, s[18:19]
    v_cndmask_b32 v209, v12, 0, s[20:21]
    v_add_u32 v11, 2, v10
    v_and_b32 v13, 1, v11
    v_cmp_eq_u32 s[20:21], 0, v13
    v_cmp_lt_i32 vcc, 1, v11
    v_cmp_gt_i32 s[18:19], 1, v11
    s_and_b64 vcc, vcc, s[20:21]
    s_and_b64 s[18:19], s[18:19], s[20:21]
    s_and_b64 s[20:21], vcc, s[38:39]
    v_cndmask_b32 v202, v12, 0, vcc
    v_cndmask_b32 v206, v12, 0, s[18:19]
    v_cndmask_b32 v210, v12, 0, s[20:21]
    v_add_u32 v11, 3, v10
    v_and_b32 v13, 1, v11
    v_cmp_eq_u32 s[20:21], 0, v13
    v_cmp_lt_i32 vcc, 1, v11
    v_cmp_gt_i32 s[18:19], 1, v11
    s_and_b64 vcc, vcc, s[20:21]
    s_and_b64 s[18:19], s[18:19], s[20:21]
    s_and_b64 s[20:21], vcc, s[38:39]
    v_cndmask_b32 v203, v12, 0, vcc
    v_cndmask_b32 v207, v12, 0, s[18:19]
    v_cndmask_b32 v211, v12, 0, s[20:21]
    s_cmp_eq_u32 s42, 0
    s_cbranch_scc1 L_qkv_go_4
    v_cmp_gt_u32 vcc, 40, v0
    s_cmp_eq_u32 s41, 0
    s_cselect_b32 s7, 8, 0
    v_cndmask_b32 v15, 8, v0, vcc
    v_max_u32 v15, s7, v15
    v_lshlrev_b32 v15, 2, v15
    s_sub_u32 s7, s44, 4128
    s_mov_b32 s6, 0
L_poll_5:
    buffer_load_dword v1, v15, s[8:11], s7 offen sc1
    s_add_u32 s6, s6, 1
    s_waitcnt vmcnt(0)
    v_cmp_ne_u32 vcc, 0, v1
    s_cmp_eq_u64 vcc, exec
    s_cbranch_scc1 L_polled_6
    s_cmp_ge_u32 s6, 1048576
    s_cbranch_scc1 L_main_end
    s_sleep 1
    s_branch L_poll_5
L_polled_6:
L_qkv_go_4:
    s_lshl_b32 s25, s3, 10
    s_add_u32 m0, s25, 1024
    s_mov_b32 s26, 0
L_qkv_dma_7:
    s_add_u32 s26, s26, 1
    buffer_load_dwordx4 v2, s[8:11], s24 offen sc1 lds
    s_add_u32 s24, s24, 512
    s_add_u32 m0, m0, 5120
    s_cmp_lt_u32 s26, 18
    s_cbranch_scc1 L_qkv_dma_7
    s_add_u32 s7, s3, 0
    s_mul_i32 m0, s7, 5120
    s_lshl_b32 s7, s7, 9
    s_add_u32 s7, s7, s23
    buffer_load_dwordx4 v2, s[8:11], s7 offen sc1 lds
    s_add_u32 s7, s3, 4
    s_mul_i32 m0, s7, 5120
    s_lshl_b32 s7, s7, 9
    s_add_u32 s7, s7, s23
    buffer_load_dwordx4 v2, s[8:11], s7 offen sc1 lds
    s_add_u32 s7, s3, 8
    s_mul_i32 m0, s7, 5120
    s_lshl_b32 s7, s7, 9
    s_add_u32 s7, s7, s23
    buffer_load_dwordx4 v2, s[8:11], s7 offen sc1 lds
    s_add_u32 s7, s3, 12
    s_mul_i32 m0, s7, 5120
    s_lshl_b32 s7, s7, 9
    s_add_u32 s7, s7, s23
    buffer_load_dwordx4 v2, s[8:11], s7 offen sc1 lds
    s_add_u32 s7, s3, 16
    s_min_u32 s7, s7, 17
    s_mul_i32 m0, s7, 5120
    s_lshl_b32 s7, s7, 9
    s_add_u32 s7, s7, s23
    buffer_load_dwordx4 v2, s[8:11], s7 offen sc1 lds
    v_mov_b32 v6, v4
    s_mov_b32 s26, 0
    s_waitcnt vmcnt(0)
    s_barrier
    ds_read_b128 v[16:19], v6 offset:0
    ds_read_b128 v[20:23], v6 offset:1024
    ds_read_b128 v[24:27], v6 offset:2048
    ds_read_b128 v[28:31], v6 offset:3072
    ds_read_b128 v[32:35], v6 offset:4096
L_qkv_k_8:
    s_waitcnt vmcnt(16) lgkmcnt(0)
    v_mfma_f32_16x16x32_bf16 v[56:59], a[0:3], v[20:23], v[56:59]
    ds_read_b128 v[36:39], v6 offset:5120
    v_mfma_f32_16x16x32_bf16 v[60:63], a[0:3], v[24:27], v[60:63]
    ds_read_b128 v[40:43], v6 offset:6144
    v_mfma_f32_16x16x32_bf16 v[64:67], a[0:3], v[28:31], v[64:67]
    ds_read_b128 v[44:47], v6 offset:7168
    v_mfma_f32_16x16x32_bf16 v[68:71], a[0:3], v[32:35], v[68:71]
    ds_read_b128 v[48:51], v6 offset:8192
    v_mfma_f32_16x16x32_bf16 v[72:75], a[4:7], v[16:19], v[72:75]
    ds_read_b128 v[52:55], v6 offset:9216
    v_mfma_f32_16x16x32_bf16 v[76:79], a[4:7], v[20:23], v[76:79]
    v_mfma_f32_16x16x32_bf16 v[80:83], a[4:7], v[24:27], v[80:83]
    buffer_load_dwordx4 a[80:83], v4, s[48:51], s28 offen offset:0
    v_mfma_f32_16x16x32_bf16 v[84:87], a[4:7], v[28:31], v[84:87]
    v_mfma_f32_16x16x32_bf16 v[88:91], a[4:7], v[32:35], v[88:91]
    v_mfma_f32_16x16x32_bf16 v[92:95], v[16:19], a[8:11], v[92:95]
    buffer_load_dwordx4 a[84:87], v4, s[48:51], s28 offen offset:1024
    v_mfma_f32_16x16x32_bf16 v[96:99], v[20:23], a[8:11], v[96:99]
    v_mfma_f32_16x16x32_bf16 v[100:103], v[24:27], a[8:11], v[100:103]
    v_mfma_f32_16x16x32_bf16 v[104:107], v[28:31], a[8:11], v[104:107]
    buffer_load_dwordx4 a[88:91], v4, s[48:51], s28 offen offset:2048
    v_mfma_f32_16x16x32_bf16 v[108:111], v[32:35], a[8:11], v[108:111]
    v_mfma_f32_16x16x32_bf16 v[112:115], a[12:15], v[16:19], v[112:115]
    v_mfma_f32_16x16x32_bf16 v[116:119], a[12:15], v[20:23], v[116:119]
    buffer_load_dwordx4 a[92:95], v4, s[48:51], s28 offen offset:3072
    v_mfma_f32_16x16x32_bf16 v[120:123], a[12:15], v[24:27], v[120:123]
    s_add_u32 s28, s28, 4096
    v_mfma_f32_16x16x32_bf16 v[124:127], a[12:15], v[28:31], v[124:127]
    v_mfma_f32_16x16x32_bf16 v[128:131], a[12:15], v[32:35], v[128:131]
    s_waitcnt vmcnt(16) lgkmcnt(0)
    v_mfma_f32_16x16x32_bf16 v[56:59], a[16:19], v[40:43], v[56:59]
    ds_read_b128 v[16:19], v6 offset:10240
    v_mfma_f32_16x16x32_bf16 v[60:63], a[16:19], v[44:47], v[60:63]
    ds_read_b128 v[20:23], v6 offset:11264
    v_mfma_f32_16x16x32_bf16 v[64:67], a[16:19], v[48:51], v[64:67]
    ds_read_b128 v[24:27], v6 offset:12288
    v_mfma_f32_16x16x32_bf16 v[68:71], a[16:19], v[52:55], v[68:71]
    ds_read_b128 v[28:31], v6 offset:13312
    v_mfma_f32_16x16x32_bf16 v[72:75], a[20:23], v[36:39], v[72:75]
    ds_read_b128 v[32:35], v6 offset:14336
    v_mfma_f32_16x16x32_bf16 v[76:79], a[20:23], v[40:43], v[76:79]
    v_mfma_f32_16x16x32_bf16 v[80:83], a[20:23], v[44:47], v[80:83]
    buffer_load_dwordx4 a[0:3], v4, s[48:51], s28 offen offset:0
    v_mfma_f32_16x16x32_bf16 v[84:87], a[20:23], v[48:51], v[84:87]
    v_mfma_f32_16x16x32_bf16 v[88:91], a[20:23], v[52:55], v[88:91]
    v_mfma_f32_16x16x32_bf16 v[92:95], v[36:39], a[24:27], v[92:95]
    buffer_load_dwordx4 a[4:7], v4, s[48:51], s28 offen offset:1024
    v_mfma_f32_16x16x32_bf16 v[96:99], v[40:43], a[24:27], v[96:99]
    v_mfma_f32_16x16x32_bf16 v[100:103], v[44:47], a[24:27], v[100:103]
    v_mfma_f32_16x16x32_bf16 v[104:107], v[48:51], a[24:27], v[104:107]
    buffer_load_dwordx4 a[8:11], v4, s[48:51], s28 offen offset:2048
    v_mfma_f32_16x16x32_bf16 v[108:111], v[52:55], a[24:27], v[108:111]
    v_mfma_f32_16x16x32_bf16 v[112:115], a[28:31], v[36:39], v[112:115]
    v_mfma_f32_16x16x32_bf16 v[116:119], a[28:31], v[40:43], v[116:119]
    buffer_load_dwordx4 a[12:15], v4, s[48:51], s28 offen offset:3072
    v_mfma_f32_16x16x32_bf16 v[120:123], a[28:31], v[44:47], v[120:123]
    s_add_u32 s28, s28, 4096
    v_mfma_f32_16x16x32_bf16 v[124:127], a[28:31], v[48:51], v[124:127]
    v_mfma_f32_16x16x32_bf16 v[128:131], a[28:31], v[52:55], v[128:131]
    s_waitcnt vmcnt(16) lgkmcnt(0)
    v_mfma_f32_16x16x32_bf16 v[56:59], a[32:35], v[20:23], v[56:59]
    ds_read_b128 v[36:39], v6 offset:15360
    v_mfma_f32_16x16x32_bf16 v[60:63], a[32:35], v[24:27], v[60:63]
    ds_read_b128 v[40:43], v6 offset:16384
    v_mfma_f32_16x16x32_bf16 v[64:67], a[32:35], v[28:31], v[64:67]
    ds_read_b128 v[44:47], v6 offset:17408
    v_mfma_f32_16x16x32_bf16 v[68:71], a[32:35], v[32:35], v[68:71]
    ds_read_b128 v[48:51], v6 offset:18432
    v_mfma_f32_16x16x32_bf16 v[72:75], a[36:39], v[16:19], v[72:75]
    ds_read_b128 v[52:55], v6 offset:19456
    v_mfma_f32_16x16x32_bf16 v[76:79], a[36:39], v[20:23], v[76:79]
    v_mfma_f32_16x16x32_bf16 v[80:83], a[36:39], v[24:27], v[80:83]
    buffer_load_dwordx4 a[16:19], v4, s[48:51], s28 offen offset:0
    v_mfma_f32_16x16x32_bf16 v[84:87], a[36:39], v[28:31], v[84:87]
    v_mfma_f32_16x16x32_bf16 v[88:91], a[36:39], v[32:35], v[88:91]
    v_mfma_f32_16x16x32_bf16 v[92:95], v[16:19], a[40:43], v[92:95]
    buffer_load_dwordx4 a[20:23], v4, s[48:51], s28 offen offset:1024
    v_mfma_f32_16x16x32_bf16 v[96:99], v[20:23], a[40:43], v[96:99]
    v_mfma_f32_16x16x32_bf16 v[100:103], v[24:27], a[40:43], v[100:103]
    v_mfma_f32_16x16x32_bf16 v[104:107], v[28:31], a[40:43], v[104:107]
    buffer_load_dwordx4 a[24:27], v4, s[48:51], s28 offen offset:2048
    v_mfma_f32_16x16x32_bf16 v[108:111], v[32:35], a[40:43], v[108:111]
    v_mfma_f32_16x16x32_bf16 v[112:115], a[44:47], v[16:19], v[112:115]
    v_mfma_f32_16x16x32_bf16 v[116:119], a[44:47], v[20:23], v[116:119]
    buffer_load_dwordx4 a[28:31], v4, s[48:51], s28 offen offset:3072
    v_mfma_f32_16x16x32_bf16 v[120:123], a[44:47], v[24:27], v[120:123]
    s_add_u32 s28, s28, 4096
    v_mfma_f32_16x16x32_bf16 v[124:127], a[44:47], v[28:31], v[124:127]
    v_mfma_f32_16x16x32_bf16 v[128:131], a[44:47], v[32:35], v[128:131]
    s_waitcnt vmcnt(16) lgkmcnt(0)
    v_mfma_f32_16x16x32_bf16 v[56:59], a[48:51], v[40:43], v[56:59]
    ds_read_b128 v[16:19], v6 offset:20480
    v_mfma_f32_16x16x32_bf16 v[60:63], a[48:51], v[44:47], v[60:63]
    ds_read_b128 v[20:23], v6 offset:21504
    v_mfma_f32_16x16x32_bf16 v[64:67], a[48:51], v[48:51], v[64:67]
    ds_read_b128 v[24:27], v6 offset:22528
    v_mfma_f32_16x16x32_bf16 v[68:71], a[48:51], v[52:55], v[68:71]
    ds_read_b128 v[28:31], v6 offset:23552
    v_mfma_f32_16x16x32_bf16 v[72:75], a[52:55], v[36:39], v[72:75]
    ds_read_b128 v[32:35], v6 offset:24576
    v_mfma_f32_16x16x32_bf16 v[76:79], a[52:55], v[40:43], v[76:79]
    v_mfma_f32_16x16x32_bf16 v[80:83], a[52:55], v[44:47], v[80:83]
    buffer_load_dwordx4 a[32:35], v4, s[48:51], s28 offen offset:0
    v_mfma_f32_16x16x32_bf16 v[84:87], a[52:55], v[48:51], v[84:87]
    v_mfma_f32_16x16x32_bf16 v[88:91], a[52:55], v[52:55], v[88:91]
    v_mfma_f32_16x16x32_bf16 v[92:95], v[36:39], a[56:59], v[92:95]
    buffer_load_dwordx4 a[36:39], v4, s[48:51], s28 offen offset:1024
    v_mfma_f32_16x16x32_bf16 v[96:99], v[40:43], a[56:59], v[96:99]
    v_mfma_f32_16x16x32_bf16 v[100:103], v[44:47], a[56:59], v[100:103]
    v_mfma_f32_16x16x32_bf16 v[104:107], v[48:51], a[56:59], v[104:107]
    buffer_load_dwordx4 a[40:43], v4, s[48:51], s28 offen offset:2048
    v_mfma_f32_16x16x32_bf16 v[108:111], v[52:55], a[56:59], v[108:111]
    v_mfma_f32_16x16x32_bf16 v[112:115], a[60:63], v[36:39], v[112:115]
    v_mfma_f32_16x16x32_bf16 v[116:119], a[60:63], v[40:43], v[116:119]
    buffer_load_dwordx4 a[44:47], v4, s[48:51], s28 offen offset:3072
    v_mfma_f32_16x16x32_bf16 v[120:123], a[60:63], v[44:47], v[120:123]
    s_add_u32 s28, s28, 4096
    v_mfma_f32_16x16x32_bf16 v[124:127], a[60:63], v[48:51], v[124:127]
    v_mfma_f32_16x16x32_bf16 v[128:131], a[60:63], v[52:55], v[128:131]
    s_waitcnt vmcnt(16) lgkmcnt(0)
    v_mfma_f32_16x16x32_bf16 v[56:59], a[64:67], v[20:23], v[56:59]
    ds_read_b128 v[36:39], v6 offset:25600
    v_mfma_f32_16x16x32_bf16 v[60:63], a[64:67], v[24:27], v[60:63]
    ds_read_b128 v[40:43], v6 offset:26624
    v_mfma_f32_16x16x32_bf16 v[64:67], a[64:67], v[28:31], v[64:67]
    ds_read_b128 v[44:47], v6 offset:27648
    v_mfma_f32_16x16x32_bf16 v[68:71], a[64:67], v[32:35], v[68:71]
    ds_read_b128 v[48:51], v6 offset:28672
    v_mfma_f32_16x16x32_bf16 v[72:75], a[68:71], v[16:19], v[72:75]
    ds_read_b128 v[52:55], v6 offset:29696
    v_mfma_f32_16x16x32_bf16 v[76:79], a[68:71], v[20:23], v[76:79]
    v_mfma_f32_16x16x32_bf16 v[80:83], a[68:71], v[24:27], v[80:83]
    buffer_load_dwordx4 a[48:51], v4, s[48:51], s28 offen offset:0
    v_mfma_f32_16x16x32_bf16 v[84:87], a[68:71], v[28:31], v[84:87]
    v_mfma_f32_16x16x32_bf16 v[88:91], a[68:71], v[32:35], v[88:91]
    v_mfma_f32_16x16x32_bf16 v[92:95], v[16:19], a[72:75], v[92:95]
    buffer_load_dwordx4 a[52:55], v4, s[48:51], s28 offen offset:1024
    v_mfma_f32_16x16x32_bf16 v[96:99], v[20:23], a[72:75], v[96:99]
    v_mfma_f32_16x16x32_bf16 v[100:103], v[24:27], a[72:75], v[100:103]
    v_mfma_f32_16x16x32_bf16 v[104:107], v[28:31], a[72:75], v[104:107]
    buffer_load_dwordx4 a[56:59], v4, s[48:51], s28 offen offset:2048
    v_mfma_f32_16x16x32_bf16 v[108:111], v[32:35], a[72:75], v[108:111]
    v_mfma_f32_16x16x32_bf16 v[112:115], a[76:79], v[16:19], v[112:115]
    v_mfma_f32_16x16x32_bf16 v[116:119], a[76:79], v[20:23], v[116:119]
    buffer_load_dwordx4 a[60:63], v4, s[48:51], s28 offen offset:3072
    v_mfma_f32_16x16x32_bf16 v[120:123], a[76:79], v[24:27], v[120:123]
    s_add_u32 s28, s28, 4096
    v_mfma_f32_16x16x32_bf16 v[124:127], a[76:79], v[28:31], v[124:127]
    v_mfma_f32_16x16x32_bf16 v[128:131], a[76:79], v[32:35], v[128:131]
    s_waitcnt vmcnt(16) lgkmcnt(0)
    v_mfma_f32_16x16x32_bf16 v[56:59], a[80:83], v[40:43], v[56:59]
    ds_read_b128 v[16:19], v6 offset:30720
    v_mfma_f32_16x16x32_bf16 v[60:63], a[80:83], v[44:47], v[60:63]
    ds_read_b128 v[20:23], v6 offset:31744
    v_mfma_f32_16x16x32_bf16 v[64:67], a[80:83], v[48:51], v[64:67]
    ds_read_b128 v[24:27], v6 offset:32768
    v_mfma_f32_16x16x32_bf16 v[68:71], a[80:83], v[52:55], v[68:71]
    ds_read_b128 v[28:31], v6 offset:33792
    v_mfma_f32_16x16x32_bf16 v[72:75], a[84:87], v[36:39], v[72:75]
    ds_read_b128 v[32:35], v6 offset:34816
    v_mfma_f32_16x16x32_bf16 v[76:79], a[84:87], v[40:43], v[76:79]
    v_mfma_f32_16x16x32_bf16 v[80:83], a[84:87], v[44:47], v[80:83]
    buffer_load_dwordx4 a[64:67], v4, s[48:51], s28 offen offset:0
    v_mfma_f32_16x16x32_bf16 v[84:87], a[84:87], v[48:51], v[84:87]
    v_mfma_f32_16x16x32_bf16 v[88:91], a[84:87], v[52:55], v[88:91]
    v_mfma_f32_16x16x32_bf16 v[92:95], v[36:39], a[88:91], v[92:95]
    buffer_load_dwordx4 a[68:71], v4, s[48:51], s28 offen offset:1024
    v_mfma_f32_16x16x32_bf16 v[96:99], v[40:43], a[88:91], v[96:99]
    v_mfma_f32_16x16x32_bf16 v[100:103], v[44:47], a[88:91], v[100:103]
    v_mfma_f32_16x16x32_bf16 v[104:107], v[48:51], a[88:91], v[104:107]
    buffer_load_dwordx4 a[72:75], v4, s[48:51], s28 offen offset:2048
    v_mfma_f32_16x16x32_bf16 v[108:111], v[52:55], a[88:91], v[108:111]
    v_mfma_f32_16x16x32_bf16 v[112:115], a[92:95], v[36:39], v[112:115]
    v_mfma_f32_16x16x32_bf16 v[116:119], a[92:95], v[40:43], v[116:119]
    buffer_load_dwordx4 a[76:79], v4, s[48:51], s28 offen offset:3072
    v_mfma_f32_16x16x32_bf16 v[120:123], a[92:95], v[44:47], v[120:123]
    s_add_u32 s28, s28, 4096
    v_mfma_f32_16x16x32_bf16 v[124:127], a[92:95], v[48:51], v[124:127]
    v_mfma_f32_16x16x32_bf16 v[128:131], a[92:95], v[52:55], v[128:131]
    v_add_u32 v6, 30720, v6
    s_add_u32 s26, s26, 1
    s_cmp_lt_u32 s26, 3
    s_cbranch_scc1 L_qkv_k_8
    s_waitcnt lgkmcnt(0)
    s_lshl_b32 s30, s41, 1
    s_lshr_b32 s7, s40, 2
    s_add_u32 s30, s30, s7
    s_mul_i32 s30, s30, 36864
    s_add_u32 s30, s30, s43
    s_and_b32 s31, s40, 3
    s_mul_i32 s31, s31, 9
    s_add_u32 s31, s31, s3
    s_mul_i32 s32, s31, 18432
    s_add_u32 s32, s32, 2359296
    s_add_u32 s33, s32, 73728
    s_add_u32 s34, s32, 147456
    s_cmp_eq_u32 s3, 0
    s_cselect_b32 s35, 0, 1073741824
    v_add_u32 v5, s35, v4
    v_add_u32 v7, s35, v9
    s_lshl_b32 s7, s31, 8
    s_add_u32 s36, s30, s7
    s_add_u32 s37, s36, 27000832
    s_add_u32 s36, s36, 24641536
    v_cvt_pk_bf16_f32 v136, v56, v57
    v_cvt_pk_bf16_f32 v137, v58, v59
    v_cvt_pk_bf16_f32 v140, v60, v61
    buffer_load_dwordx4 a[0:3], v4, s[8:11], s32 offen offset:0
    v_cvt_pk_bf16_f32 v141, v62, v63
    v_cvt_pk_bf16_f32 v144, v64, v65
    v_cvt_pk_bf16_f32 v145, v66, v67
    buffer_load_dwordx4 a[4:7], v4, s[8:11], s33 offen offset:0
    v_cvt_pk_bf16_f32 v148, v68, v69
    v_cvt_pk_bf16_f32 v149, v70, v71
    v_cvt_pk_bf16_f32 v152, v72, v73
    buffer_load_dwordx4 a[8:11], v5, s[8:11], s34 offen offset:0
    v_cvt_pk_bf16_f32 v153, v74, v75
    v_cvt_pk_bf16_f32 v156, v76, v77
    v_cvt_pk_bf16_f32 v157, v78, v79
    buffer_load_dwordx4 a[12:15], v4, s[8:11], s32 offen offset:1024
    v_cvt_pk_bf16_f32 v160, v80, v81
    v_cvt_pk_bf16_f32 v161, v82, v83
    v_cvt_pk_bf16_f32 v164, v84, v85
    buffer_load_dwordx4 a[16:19], v4, s[8:11], s33 offen offset:1024
    v_cvt_pk_bf16_f32 v165, v86, v87
    v_cvt_pk_bf16_f32 v168, v88, v89
    v_cvt_pk_bf16_f32 v169, v90, v91
    buffer_load_dwordx4 a[20:23], v5, s[8:11], s34 offen offset:1024
    v_cvt_pk_bf16_f32 v134, v112, v113
    v_cvt_pk_bf16_f32 v154, v114, v115
    v_cvt_pk_bf16_f32 v138, v116, v117
    buffer_load_dwordx4 a[24:27], v4, s[8:11], s32 offen offset:2048
    v_cvt_pk_bf16_f32 v158, v118, v119
    v_cvt_pk_bf16_f32 v142, v120, v121
    v_cvt_pk_bf16_f32 v162, v122, v123
    buffer_load_dwordx4 a[28:31], v4, s[8:11], s33 offen offset:2048
    v_cvt_pk_bf16_f32 v146, v124, v125
    v_cvt_pk_bf16_f32 v166, v126, v127
    v_cvt_pk_bf16_f32 v150, v128, v129
    buffer_load_dwordx4 a[32:35], v5, s[8:11], s34 offen offset:2048
    v_cvt_pk_bf16_f32 v170, v130, v131
    v_cvt_pk_bf16_f32 v172, v92, v93
    v_cvt_pk_bf16_f32 v173, v94, v95
    buffer_load_dwordx4 a[36:39], v4, s[8:11], s32 offen offset:3072
    s_add_u32 s32, s32, 4096
    v_cvt_pk_bf16_f32 v174, v96, v97
    v_cvt_pk_bf16_f32 v175, v98, v99
    v_cvt_pk_bf16_f32 v176, v100, v101
    buffer_load_dwordx4 a[40:43], v4, s[8:11], s33 offen offset:3072
    s_add_u32 s33, s33, 4096
    v_cvt_pk_bf16_f32 v177, v102, v103
    v_cvt_pk_bf16_f32 v178, v104, v105
    v_cvt_pk_bf16_f32 v179, v106, v107
    buffer_load_dwordx4 a[44:47], v5, s[8:11], s34 offen offset:3072
    s_add_u32 s34, s34, 4096
    v_cvt_pk_bf16_f32 v180, v108, v109
    v_cvt_pk_bf16_f32 v181, v110, v111
    v_mfma_f32_16x16x32_bf16 v[16:19], v[152:155], v[136:139], v[208:211]
    buffer_load_dwordx4 a[48:51], v4, s[8:11], s32 offen offset:0
    v_mfma_f32_16x16x32_bf16 v[20:23], v[156:159], v[136:139], v[204:207]
    v_mfma_f32_16x16x32_bf16 v[24:27], v[156:159], v[140:143], v[200:203]
    v_mfma_f32_16x16x32_bf16 v[28:31], v[160:163], v[140:143], v[204:207]
    buffer_load_dwordx4 a[52:55], v4, s[8:11], s33 offen offset:0
    v_mfma_f32_16x16x32_bf16 v[32:35], v[160:163], v[144:147], v[200:203]
    v_mfma_f32_16x16x32_bf16 v[36:39], v[164:167], v[144:147], v[204:207]
    v_mfma_f32_16x16x32_bf16 v[40:43], v[164:167], v[148:151], v[200:203]
    buffer_load_dwordx4 a[56:59], v5, s[8:11], s34 offen offset:0
    v_mfma_f32_16x16x32_bf16 v[44:47], v[168:171], v[148:151], v[204:207]
    v_mfma_f32_16x16x32_bf16 v[56:59], v[132:135], v[192:195], v[196:199]
    v_mfma_f32_16x16x32_bf16 v[60:63], v[136:139], v[192:195], v[196:199]
    buffer_load_dwordx4 a[60:63], v4, s[8:11], s32 offen offset:1024
    v_mfma_f32_16x16x32_bf16 v[64:67], v[140:143], v[192:195], v[196:199]
    v_mfma_f32_16x16x32_bf16 v[68:71], v[144:147], v[192:195], v[196:199]
    v_mfma_f32_16x16x32_bf16 v[72:75], v[148:151], v[192:195], v[196:199]
    buffer_load_dwordx4 a[64:67], v4, s[8:11], s33 offen offset:1024
    v_max3_f32 v92, v16, v17, v18
    v_max3_f32 v96, v19, v20, v21
    v_max3_f32 v93, v24, v25, v26
    buffer_load_dwordx4 a[68:71], v5, s[8:11], s34 offen offset:1024
    v_max3_f32 v97, v27, v28, v29
    v_max3_f32 v94, v32, v33, v34
    v_max3_f32 v98, v35, v36, v37
    buffer_load_dwordx4 a[72:75], v4, s[8:11], s32 offen offset:2048
    v_max3_f32 v95, v40, v41, v42
    v_max3_f32 v99, v43, v44, v45
    v_max3_f32 v92, v92, v22, v23
    buffer_load_dwordx4 a[76:79], v4, s[8:11], s33 offen offset:2048
    v_max3_f32 v93, v93, v30, v31
    v_max3_f32 v94, v94, v38, v39
    v_max3_f32 v95, v95, v46, v47
    buffer_load_dwordx4 a[80:83], v5, s[8:11], s34 offen offset:2048
    v_max_f32 v92, v92, v96
    v_max_f32 v93, v93, v97
    v_max_f32 v94, v94, v98
    buffer_load_dwordx4 a[84:87], v4, s[8:11], s32 offen offset:3072
    s_add_u32 s32, s32, 4096
    v_max_f32 v95, v95, v99
    s_mov_b32 s18, 0x3eae1a93
    v_cvt_pk_bf16_f32 v182, v56, v57
    buffer_load_dwordx4 a[88:91], v4, s[8:11], s33 offen offset:3072
    s_add_u32 s33, s33, 4096
    v_permlane32_swap_b32 v92, v93
    v_permlane32_swap_b32 v94, v95
    v_max_f32 v92, v92, v93
    buffer_load_dwordx4 a[92:95], v5, s[8:11], s34 offen offset:3072
    s_add_u32 s34, s34, 4096
    v_max_f32 v94, v94, v95
    v_cvt_pk_bf16_f32 v183, v58, v59
    v_cvt_pk_bf16_f32 v184, v60, v61
    buffer_load_dwordx4 a[96:99], v4, s[8:11], s32 offen offset:0
    v_permlane16_swap_b32 v92, v94
    v_max_f32 v92, v92, v94
    v_mul_f32 v92, 0xbeae1a93, v92
    buffer_load_dwordx4 a[100:103], v4, s[8:11], s33 offen offset:0
    v_mov_b32 v94, v92
    v_cvt_pk_bf16_f32 v185, v62, v63
    v_cvt_pk_bf16_f32 v186, v64, v65
    buffer_load_dwordx4 a[104:107], v5, s[8:11], s34 offen offset:0
    v_permlane16_swap_b32 v92, v94
    v_mov_b32 v93, v92
    v_mov_b32 v95, v94
    buffer_load_dwordx4 a[108:111], v4, s[8:11], s32 offen offset:1024
    v_cvt_pk_bf16_f32 v187, v66, v67
    v_cvt_pk_bf16_f32 v188, v68, v69
    v_permlane32_swap_b32 v92, v93
    buffer_load_dwordx4 a[112:115], v4, s[8:11], s33 offen offset:1024
    v_permlane32_swap_b32 v94, v95
    v_cvt_pk_bf16_f32 v189, v70, v71
    v_cvt_pk_bf16_f32 v190, v72, v73
    buffer_load_dwordx4 a[116:119], v5, s[8:11], s34 offen offset:1024
    v_cvt_pk_bf16_f32 v191, v74, v75
    v_fma_f32 v16, v16, s18, v92
    v_fma_f32 v17, v17, s18, v92
    buffer_load_dwordx4 a[120:123], v4, s[8:11], s32 offen offset:2048
    v_fma_f32 v18, v18, s18, v92
    v_fma_f32 v19, v19, s18, v92
    v_fma_f32 v20, v20, s18, v92
    buffer_load_dwordx4 a[124:127], v4, s[8:11], s33 offen offset:2048
    v_fma_f32 v21, v21, s18, v92
    v_fma_f32 v22, v22, s18, v92
    v_fma_f32 v23, v23, s18, v92
    buffer_load_dwordx4 a[128:131], v5, s[8:11], s34 offen offset:2048
    v_exp_f32 v16, v16
    v_exp_f32 v17, v17
    v_exp_f32 v18, v18
    buffer_load_dwordx4 a[132:135], v4, s[8:11], s32 offen offset:3072
    s_add_u32 s32, s32, 4096
    v_exp_f32 v19, v19
    v_exp_f32 v20, v20
    v_exp_f32 v21, v21
    buffer_load_dwordx4 a[136:139], v4, s[8:11], s33 offen offset:3072
    s_add_u32 s33, s33, 4096
    v_exp_f32 v22, v22
    v_exp_f32 v23, v23
    s_nop 0
    buffer_load_dwordx4 a[140:143], v5, s[8:11], s34 offen offset:3072
    s_add_u32 s34, s34, 4096
    v_cvt_pk_bf16_f32 v76, v16, v17
    v_cvt_pk_bf16_f32 v77, v18, v19
    v_cvt_pk_bf16_f32 v78, v20, v21
    buffer_load_dwordx4 a[144:147], v4, s[8:11], s32 offen offset:0
    v_cvt_pk_bf16_f32 v79, v22, v23
    v_fma_f32 v24, v24, s18, v93
    v_fma_f32 v25, v25, s18, v93
    buffer_load_dwordx4 a[148:151], v4, s[8:11], s33 offen offset:0
    v_fma_f32 v26, v26, s18, v93
    v_fma_f32 v27, v27, s18, v93
    v_fma_f32 v28, v28, s18, v93
    buffer_load_dwordx4 a[152:155], v5, s[8:11], s34 offen offset:0
    v_fma_f32 v29, v29, s18, v93
    v_fma_f32 v30, v30, s18, v93
    v_fma_f32 v31, v31, s18, v93
    buffer_load_dwordx4 a[156:159], v4, s[8:11], s32 offen offset:1024
    v_exp_f32 v24, v24
    v_exp_f32 v25, v25
    v_exp_f32 v26, v26
    buffer_load_dwordx4 a[160:163], v4, s[8:11], s33 offen offset:1024
    v_exp_f32 v27, v27
    v_exp_f32 v28, v28
    v_exp_f32 v29, v29
    buffer_load_dwordx4 a[164:167], v5, s[8:11], s34 offen offset:1024
    v_exp_f32 v30, v30
    v_exp_f32 v31, v31
    v_mfma_f32_16x16x32_bf16 v[100:103], v[172:175], v[76:79], 0
    buffer_load_dwordx4 a[168:171], v4, s[8:11], s32 offen offset:2048
    v_mfma_f32_16x16x32_bf16 v[116:119], v[182:185], v[76:79], 0
    v_cvt_pk_bf16_f32 v80, v24, v25
    v_cvt_pk_bf16_f32 v81, v26, v27
    buffer_load_dwordx4 a[172:175], v4, s[8:11], s33 offen offset:2048
    v_cvt_pk_bf16_f32 v82, v28, v29
    v_cvt_pk_bf16_f32 v83, v30, v31
    v_fma_f32 v32, v32, s18, v94
    buffer_load_dwordx4 a[176:179], v5, s[8:11], s34 offen offset:2048
    v_fma_f32 v33, v33, s18, v94
    v_fma_f32 v34, v34, s18, v94
    v_fma_f32 v35, v35, s18, v94
    buffer_load_dwordx4 a[180:183], v4, s[8:11], s32 offen offset:3072
    s_add_u32 s32, s32, 4096
    v_fma_f32 v36, v36, s18, v94
    v_fma_f32 v37, v37, s18, v94
    v_fma_f32 v38, v38, s18, v94
    buffer_load_dwordx4 a[184:187], v4, s[8:11], s33 offen offset:3072
    s_add_u32 s33, s33, 4096
    v_fma_f32 v39, v39, s18, v94
    v_exp_f32 v32, v32
    v_exp_f32 v33, v33
    buffer_load_dwordx4 a[188:191], v5, s[8:11], s34 offen offset:3072
    s_add_u32 s34, s34, 4096
    v_exp_f32 v34, v34
    v_exp_f32 v35, v35
    v_exp_f32 v36, v36
    buffer_load_dwordx4 a[192:195], v4, s[8:11], s32 offen offset:0
    v_exp_f32 v37, v37
    v_exp_f32 v38, v38
    v_exp_f32 v39, v39
    buffer_load_dwordx4 a[196:199], v4, s[8:11], s33 offen offset:0
    v_mfma_f32_16x16x32_bf16 v[104:107], v[174:177], v[80:83], 0
    v_mfma_f32_16x16x32_bf16 v[120:123], v[184:187], v[80:83], 0
    v_cvt_pk_bf16_f32 v84, v32, v33
    buffer_load_dwordx4 a[200:203], v5, s[8:11], s34 offen offset:0
    v_cvt_pk_bf16_f32 v85, v34, v35
    v_cvt_pk_bf16_f32 v86, v36, v37
    v_cvt_pk_bf16_f32 v87, v38, v39
    buffer_load_dwordx4 a[204:207], v4, s[8:11], s32 offen offset:1024
    v_fma_f32 v40, v40, s18, v95
    v_fma_f32 v41, v41, s18, v95
    v_fma_f32 v42, v42, s18, v95
    buffer_load_dwordx4 a[208:211], v4, s[8:11], s33 offen offset:1024
    v_fma_f32 v43, v43, s18, v95
    v_fma_f32 v44, v44, s18, v95
    v_fma_f32 v45, v45, s18, v95
    buffer_load_dwordx4 a[212:215], v5, s[8:11], s34 offen offset:1024
    v_fma_f32 v46, v46, s18, v95
    v_fma_f32 v47, v47, s18, v95
    v_exp_f32 v40, v40
    buffer_load_dwordx4 v[240:243], v9, s[8:11], s37 offen offset:0 sc1
    v_exp_f32 v41, v41
    v_exp_f32 v42, v42
    v_exp_f32 v43, v43
    buffer_load_dwordx4 v[244:247], v9, s[8:11], s37 offen offset:1024 sc1
    v_exp_f32 v44, v44
    v_exp_f32 v45, v45
    v_exp_f32 v46, v46
    buffer_load_dwordx4 v[248:251], v7, s[8:11], s37 offen offset:2048 sc1
    v_exp_f32 v47, v47
    v_mfma_f32_16x16x32_bf16 v[108:111], v[176:179], v[84:87], 0
    v_mfma_f32_16x16x32_bf16 v[124:127], v[186:189], v[84:87], 0
    v_cvt_pk_bf16_f32 v88, v40, v41
    v_cvt_pk_bf16_f32 v89, v42, v43
    v_cvt_pk_bf16_f32 v90, v44, v45
    v_cvt_pk_bf16_f32 v91, v46, v47
    v_rcp_f32 v96, v118
    v_rcp_f32 v97, v122
    v_mfma_f32_16x16x32_bf16 v[112:115], v[178:181], v[88:91], 0
    v_mfma_f32_16x16x32_bf16 v[128:131], v[188:191], v[88:91], 0
    v_pk_mul_f32 v[100:101], v[96:97], v[100:101] op_sel:[0,0] op_sel_hi:[0,1]
    v_pk_mul_f32 v[102:103], v[96:97], v[102:103] op_sel:[0,0] op_sel_hi:[0,1]
    v_pk_mul_f32 v[116:117], v[96:97], v[116:117] op_sel:[0,0] op_sel_hi:[0,1]
    v_cvt_pk_bf16_f32 v212, v100, v101
    v_cvt_pk_bf16_f32 v213, v102, v103
    v_cvt_pk_bf16_f32 v220, v116, v117
    v_rcp_f32 v98, v126
    v_pk_mul_f32 v[104:105], v[96:97], v[104:105] op_sel:[1,0] op_sel_hi:[1,1]
    v_pk_mul_f32 v[106:107], v[96:97], v[106:107] op_sel:[1,0] op_sel_hi:[1,1]
    v_pk_mul_f32 v[120:121], v[96:97], v[120:121] op_sel:[1,0] op_sel_hi:[1,1]
    v_cvt_pk_bf16_f32 v214, v104, v105
    v_cvt_pk_bf16_f32 v215, v106, v107
    v_cvt_pk_bf16_f32 v221, v120, v121
    v_rcp_f32 v99, v130
    v_permlane16_swap_b32 v212, v214
    v_permlane16_swap_b32 v213, v215
    v_pk_mul_f32 v[108:109], v[98:99], v[108:109] op_sel:[0,0] op_sel_hi:[0,1]
    v_pk_mul_f32 v[110:111], v[98:99], v[110:111] op_sel:[0,0] op_sel_hi:[0,1]
    v_pk_mul_f32 v[124:125], v[98:99], v[124:125] op_sel:[0,0] op_sel_hi:[0,1]
    v_cvt_pk_bf16_f32 v216, v108, v109
    v_cvt_pk_bf16_f32 v217, v110, v111
    v_cvt_pk_bf16_f32 v222, v124, v125
    v_pk_mul_f32 v[112:113], v[98:99], v[112:113] op_sel:[1,0] op_sel_hi:[1,1]
    v_pk_mul_f32 v[114:115], v[98:99], v[114:115] op_sel:[1,0] op_sel_hi:[1,1]
    v_pk_mul_f32 v[128:129], v[98:99], v[128:129] op_sel:[1,0] op_sel_hi:[1,1]
    v_cvt_pk_bf16_f32 v218, v112, v113
    v_cvt_pk_bf16_f32 v219, v114, v115
    v_cvt_pk_bf16_f32 v223, v128, v129
    v_lshrrev_b32 v10, 3, v0
    v_permlane16_swap_b32 v220, v221
    v_permlane16_swap_b32 v216, v218
    v_permlane16_swap_b32 v217, v219
    v_permlane16_swap_b32 v222, v223
    v_mul_u32_u24 v10, 9216, v10
    v_and_b32 v11, 7, v0
    v_permlane32_swap_b32 v220, v222
    v_lshl_add_u32 v10, v11, 4, v10
    s_mul_i32 s7, s40, 1152
    s_add_u32 s22, s22, s7
    s_add_u32 s22, s22, 22282240
    s_lshl_b32 s7, s3, 8
    s_add_u32 s23, s22, s7
    s_add_u32 s24, s23, 36864
    s_lshl_b32 s7, s3, 2
    s_add_u32 s22, s22, s7
    buffer_store_dwordx4 v[212:215], v9, s[8:11], s23 offen sc1
    buffer_store_dwordx4 v[216:219], v9, s[8:11], s24 offen sc1
    buffer_store_dword v220, v10, s[8:11], s22 offen offset:1024 sc1
    s_lshl_b32 s6, s40, 4
    s_lshl_b32 s7, s3, 2
    s_add_u32 s6, s6, s7
    s_add_u32 s6, s6, s44
    v_mov_b32 v1, 1
    s_waitcnt vmcnt(0)
    s_mov_b64 exec, 1
    buffer_store_dword v1, off, s[8:11], s6 offset:0 sc1
    s_mov_b64 exec, -1
    s_and_b32 s7, s3, 1
    s_mul_i32 s7, s7, 18432
    s_add_u32 s23, s30, s7
    s_lshr_b32 s7, s3, 1
    s_lshl_b32 s7, s7, 9
    s_add_u32 s23, s23, s7
    s_add_u32 s23, s23, 22282240
    s_mov_b32 s16, 0xffff0000
    v_lshlrev_b32 v64, 16, v240
    v_and_b32 v65, s16, v240
    v_lshlrev_b32 v66, 16, v241
    v_and_b32 v67, s16, v241
    v_lshlrev_b32 v68, 16, v242
    v_and_b32 v69, s16, v242
    v_lshlrev_b32 v70, 16, v243
    v_and_b32 v71, s16, v243
    v_lshlrev_b32 v72, 16, v244
    v_and_b32 v73, s16, v244
    v_lshlrev_b32 v74, 16, v245
    v_and_b32 v75, s16, v245
    v_lshlrev_b32 v76, 16, v246
    v_and_b32 v77, s16, v246
    v_lshlrev_b32 v78, 16, v247
    v_and_b32 v79, s16, v247
    v_lshlrev_b32 v80, 16, v248
    v_and_b32 v81, s16, v248
    v_lshlrev_b32 v82, 16, v249
    v_and_b32 v83, s16, v249
    v_lshlrev_b32 v84, 16, v250
    v_and_b32 v85, s16, v250
    v_lshlrev_b32 v86, 16, v251
    v_and_b32 v87, s16, v251
    v_and_b32 v15, 31, v0
    v_lshlrev_b32 v15, 2, v15
    s_add_u32 s7, s44, 0
    s_mov_b32 s6, 0
L_poll_9:
    buffer_load_dword v1, v15, s[8:11], s7 offen sc1
    s_add_u32 s6, s6, 1
    s_waitcnt vmcnt(0)
    v_cmp_ne_u32 vcc, 0, v1
    s_cmp_eq_u64 vcc, exec
    s_cbranch_scc1 L_polled_10
    s_cmp_ge_u32 s6, 1048576
    s_cbranch_scc1 L_main_end
    s_sleep 1
    s_branch L_poll_9
L_polled_10:
    s_lshl_b32 m0, s3, 10
    s_nop 0
    buffer_load_dwordx4 v2, s[8:11], s23 offen sc1 lds
    s_add_u32 m0, m0, 4096
    s_add_u32 s23, s23, 1024
    buffer_load_dwordx4 v2, s[8:11], s23 offen sc1 lds
    s_add_u32 m0, m0, 4096
    s_add_u32 s23, s23, 1024
    buffer_load_dwordx4 v2, s[8:11], s23 offen sc1 lds
    s_add_u32 m0, m0, 4096
    s_add_u32 s23, s23, 1024
    buffer_load_dwordx4 v2, s[8:11], s23 offen sc1 lds
    s_add_u32 m0, m0, 4096
    s_add_u32 s23, s23, 1024
    buffer_load_dwordx4 v2, s[8:11], s23 offen sc1 lds
    s_add_u32 m0, m0, 4096
    s_add_u32 s23, s23, 1024
    buffer_load_dwordx4 v2, s[8:11], s23 offen sc1 lds
    s_add_u32 m0, m0, 4096
    s_add_u32 s23, s23, 1024
    buffer_load_dwordx4 v2, s[8:11], s23 offen sc1 lds
    s_add_u32 m0, m0, 4096
    s_add_u32 s23, s23, 1024
    buffer_load_dwordx4 v2, s[8:11], s23 offen sc1 lds
    s_add_u32 m0, m0, 4096
    s_add_u32 s23, s23, 1024
    buffer_load_dwordx4 v2, s[8:11], s23 offen sc1 lds
    s_waitcnt vmcnt(0)
    s_barrier
    ds_read_b128 v[20:23], v4 offset:0
    ds_read_b128 v[24:27], v4 offset:1024
    s_waitcnt lgkmcnt(0)
    v_mfma_f32_16x16x32_bf16 v[40:43], a[0:3], v[20:23], 0
    ds_read_b128 v[28:31], v4 offset:2048
    v_mfma_f32_16x16x32_bf16 v[44:47], a[0:3], v[24:27], 0
    ds_read_b128 v[32:35], v4 offset:3072
    v_mfma_f32_16x16x32_bf16 v[48:51], a[4:7], v[20:23], 0
    v_mfma_f32_16x16x32_bf16 v[52:55], a[4:7], v[24:27], 0
    v_mfma_f32_16x16x32_bf16 v[56:59], a[8:11], v[20:23], 0
    v_mfma_f32_16x16x32_bf16 v[60:63], a[8:11], v[24:27], 0
    s_waitcnt lgkmcnt(0)
    v_mfma_f32_16x16x32_bf16 v[40:43], a[12:15], v[28:31], v[40:43]
    ds_read_b128 v[20:23], v4 offset:4096
    v_mfma_f32_16x16x32_bf16 v[44:47], a[12:15], v[32:35], v[44:47]
    ds_read_b128 v[24:27], v4 offset:5120
    v_mfma_f32_16x16x32_bf16 v[48:51], a[16:19], v[28:31], v[48:51]
    v_mfma_f32_16x16x32_bf16 v[52:55], a[16:19], v[32:35], v[52:55]
    v_mfma_f32_16x16x32_bf16 v[56:59], a[20:23], v[28:31], v[56:59]
    v_mfma_f32_16x16x32_bf16 v[60:63], a[20:23], v[32:35], v[60:63]
    s_waitcnt lgkmcnt(0)
    v_mfma_f32_16x16x32_bf16 v[40:43], a[24:27], v[20:23], v[40:43]
    ds_read_b128 v[28:31], v4 offset:6144
    v_mfma_f32_16x16x32_bf16 v[44:47], a[24:27], v[24:27], v[44:47]
    ds_read_b128 v[32:35], v4 offset:7168
    v_mfma_f32_16x16x32_bf16 v[48:51], a[28:31], v[20:23], v[48:51]
    v_mfma_f32_16x16x32_bf16 v[52:55], a[28:31], v[24:27], v[52:55]
    v_mfma_f32_16x16x32_bf16 v[56:59], a[32:35], v[20:23], v[56:59]
    v_mfma_f32_16x16x32_bf16 v[60:63], a[32:35], v[24:27], v[60:63]
    s_waitcnt lgkmcnt(0)
    v_mfma_f32_16x16x32_bf16 v[40:43], a[36:39], v[28:31], v[40:43]
    ds_read_b128 v[20:23], v4 offset:8192
    v_mfma_f32_16x16x32_bf16 v[44:47], a[36:39], v[32:35], v[44:47]
    ds_read_b128 v[24:27], v4 offset:9216
    v_mfma_f32_16x16x32_bf16 v[48:51], a[40:43], v[28:31], v[48:51]
    v_mfma_f32_16x16x32_bf16 v[52:55], a[40:43], v[32:35], v[52:55]
    v_mfma_f32_16x16x32_bf16 v[56:59], a[44:47], v[28:31], v[56:59]
    v_mfma_f32_16x16x32_bf16 v[60:63], a[44:47], v[32:35], v[60:63]
    s_waitcnt lgkmcnt(0)
    v_mfma_f32_16x16x32_bf16 v[40:43], a[48:51], v[20:23], v[40:43]
    ds_read_b128 v[28:31], v4 offset:10240
    v_mfma_f32_16x16x32_bf16 v[44:47], a[48:51], v[24:27], v[44:47]
    ds_read_b128 v[32:35], v4 offset:11264
    v_mfma_f32_16x16x32_bf16 v[48:51], a[52:55], v[20:23], v[48:51]
    v_mfma_f32_16x16x32_bf16 v[52:55], a[52:55], v[24:27], v[52:55]
    v_mfma_f32_16x16x32_bf16 v[56:59], a[56:59], v[20:23], v[56:59]
    v_mfma_f32_16x16x32_bf16 v[60:63], a[56:59], v[24:27], v[60:63]
    s_waitcnt lgkmcnt(0)
    v_mfma_f32_16x16x32_bf16 v[40:43], a[60:63], v[28:31], v[40:43]
    ds_read_b128 v[20:23], v4 offset:12288
    v_mfma_f32_16x16x32_bf16 v[44:47], a[60:63], v[32:35], v[44:47]
    ds_read_b128 v[24:27], v4 offset:13312
    v_mfma_f32_16x16x32_bf16 v[48:51], a[64:67], v[28:31], v[48:51]
    v_mfma_f32_16x16x32_bf16 v[52:55], a[64:67], v[32:35], v[52:55]
    v_mfma_f32_16x16x32_bf16 v[56:59], a[68:71], v[28:31], v[56:59]
    v_mfma_f32_16x16x32_bf16 v[60:63], a[68:71], v[32:35], v[60:63]
    s_waitcnt lgkmcnt(0)
    v_mfma_f32_16x16x32_bf16 v[40:43], a[72:75], v[20:23], v[40:43]
    ds_read_b128 v[28:31], v4 offset:14336
    v_mfma_f32_16x16x32_bf16 v[44:47], a[72:75], v[24:27], v[44:47]
    ds_read_b128 v[32:35], v4 offset:15360
    v_mfma_f32_16x16x32_bf16 v[48:51], a[76:79], v[20:23], v[48:51]
    v_mfma_f32_16x16x32_bf16 v[52:55], a[76:79], v[24:27], v[52:55]
    v_mfma_f32_16x16x32_bf16 v[56:59], a[80:83], v[20:23], v[56:59]
    v_mfma_f32_16x16x32_bf16 v[60:63], a[80:83], v[24:27], v[60:63]
    s_waitcnt lgkmcnt(0)
    v_mfma_f32_16x16x32_bf16 v[40:43], a[84:87], v[28:31], v[40:43]
    ds_read_b128 v[20:23], v4 offset:16384
    v_mfma_f32_16x16x32_bf16 v[44:47], a[84:87], v[32:35], v[44:47]
    ds_read_b128 v[24:27], v4 offset:17408
    v_mfma_f32_16x16x32_bf16 v[48:51], a[88:91], v[28:31], v[48:51]
    v_mfma_f32_16x16x32_bf16 v[52:55], a[88:91], v[32:35], v[52:55]
    v_mfma_f32_16x16x32_bf16 v[56:59], a[92:95], v[28:31], v[56:59]
    v_mfma_f32_16x16x32_bf16 v[60:63], a[92:95], v[32:35], v[60:63]
    s_waitcnt lgkmcnt(0)
    v_mfma_f32_16x16x32_bf16 v[40:43], a[96:99], v[20:23], v[40:43]
    ds_read_b128 v[28:31], v4 offset:18432
    v_mfma_f32_16x16x32_bf16 v[44:47], a[96:99], v[24:27], v[44:47]
    ds_read_b128 v[32:35], v4 offset:19456
    v_mfma_f32_16x16x32_bf16 v[48:51], a[100:103], v[20:23], v[48:51]
    v_mfma_f32_16x16x32_bf16 v[52:55], a[100:103], v[24:27], v[52:55]
    v_mfma_f32_16x16x32_bf16 v[56:59], a[104:107], v[20:23], v[56:59]
    v_mfma_f32_16x16x32_bf16 v[60:63], a[104:107], v[24:27], v[60:63]
    s_waitcnt lgkmcnt(0)
    v_mfma_f32_16x16x32_bf16 v[40:43], a[108:111], v[28:31], v[40:43]
    ds_read_b128 v[20:23], v4 offset:20480
    v_mfma_f32_16x16x32_bf16 v[44:47], a[108:111], v[32:35], v[44:47]
    ds_read_b128 v[24:27], v4 offset:21504
    v_mfma_f32_16x16x32_bf16 v[48:51], a[112:115], v[28:31], v[48:51]
    v_mfma_f32_16x16x32_bf16 v[52:55], a[112:115], v[32:35], v[52:55]
    v_mfma_f32_16x16x32_bf16 v[56:59], a[116:119], v[28:31], v[56:59]
    v_mfma_f32_16x16x32_bf16 v[60:63], a[116:119], v[32:35], v[60:63]
    s_waitcnt lgkmcnt(0)
    v_mfma_f32_16x16x32_bf16 v[40:43], a[120:123], v[20:23], v[40:43]
    ds_read_b128 v[28:31], v4 offset:22528
    v_mfma_f32_16x16x32_bf16 v[44:47], a[120:123], v[24:27], v[44:47]
    ds_read_b128 v[32:35], v4 offset:23552
    v_mfma_f32_16x16x32_bf16 v[48:51], a[124:127], v[20:23], v[48:51]
    v_mfma_f32_16x16x32_bf16 v[52:55], a[124:127], v[24:27], v[52:55]
    v_mfma_f32_16x16x32_bf16 v[56:59], a[128:131], v[20:23], v[56:59]
    v_mfma_f32_16x16x32_bf16 v[60:63], a[128:131], v[24:27], v[60:63]
    s_waitcnt lgkmcnt(0)
    v_mfma_f32_16x16x32_bf16 v[40:43], a[132:135], v[28:31], v[40:43]
    ds_read_b128 v[20:23], v4 offset:24576
    v_mfma_f32_16x16x32_bf16 v[44:47], a[132:135], v[32:35], v[44:47]
    ds_read_b128 v[24:27], v4 offset:25600
    v_mfma_f32_16x16x32_bf16 v[48:51], a[136:139], v[28:31], v[48:51]
    v_mfma_f32_16x16x32_bf16 v[52:55], a[136:139], v[32:35], v[52:55]
    v_mfma_f32_16x16x32_bf16 v[56:59], a[140:143], v[28:31], v[56:59]
    v_mfma_f32_16x16x32_bf16 v[60:63], a[140:143], v[32:35], v[60:63]
    s_waitcnt lgkmcnt(0)
    v_mfma_f32_16x16x32_bf16 v[40:43], a[144:147], v[20:23], v[40:43]
    ds_read_b128 v[28:31], v4 offset:26624
    v_mfma_f32_16x16x32_bf16 v[44:47], a[144:147], v[24:27], v[44:47]
    ds_read_b128 v[32:35], v4 offset:27648
    v_mfma_f32_16x16x32_bf16 v[48:51], a[148:151], v[20:23], v[48:51]
    v_mfma_f32_16x16x32_bf16 v[52:55], a[148:151], v[24:27], v[52:55]
    v_mfma_f32_16x16x32_bf16 v[56:59], a[152:155], v[20:23], v[56:59]
    v_mfma_f32_16x16x32_bf16 v[60:63], a[152:155], v[24:27], v[60:63]
    s_waitcnt lgkmcnt(0)
    v_mfma_f32_16x16x32_bf16 v[40:43], a[156:159], v[28:31], v[40:43]
    ds_read_b128 v[20:23], v4 offset:28672
    v_mfma_f32_16x16x32_bf16 v[44:47], a[156:159], v[32:35], v[44:47]
    ds_read_b128 v[24:27], v4 offset:29696
    v_mfma_f32_16x16x32_bf16 v[48:51], a[160:163], v[28:31], v[48:51]
    v_mfma_f32_16x16x32_bf16 v[52:55], a[160:163], v[32:35], v[52:55]
    v_mfma_f32_16x16x32_bf16 v[56:59], a[164:167], v[28:31], v[56:59]
    v_mfma_f32_16x16x32_bf16 v[60:63], a[164:167], v[32:35], v[60:63]
    s_waitcnt lgkmcnt(0)
    v_mfma_f32_16x16x32_bf16 v[40:43], a[168:171], v[20:23], v[40:43]
    ds_read_b128 v[28:31], v4 offset:30720
    v_mfma_f32_16x16x32_bf16 v[44:47], a[168:171], v[24:27], v[44:47]
    ds_read_b128 v[32:35], v4 offset:31744
    v_mfma_f32_16x16x32_bf16 v[48:51], a[172:175], v[20:23], v[48:51]
    v_mfma_f32_16x16x32_bf16 v[52:55], a[172:175], v[24:27], v[52:55]
    v_mfma_f32_16x16x32_bf16 v[56:59], a[176:179], v[20:23], v[56:59]
    v_mfma_f32_16x16x32_bf16 v[60:63], a[176:179], v[24:27], v[60:63]
    s_waitcnt lgkmcnt(0)
    v_mfma_f32_16x16x32_bf16 v[40:43], a[180:183], v[28:31], v[40:43]
    ds_read_b128 v[20:23], v4 offset:32768
    v_mfma_f32_16x16x32_bf16 v[44:47], a[180:183], v[32:35], v[44:47]
    ds_read_b128 v[24:27], v4 offset:33792
    v_mfma_f32_16x16x32_bf16 v[48:51], a[184:187], v[28:31], v[48:51]
    v_mfma_f32_16x16x32_bf16 v[52:55], a[184:187], v[32:35], v[52:55]
    v_mfma_f32_16x16x32_bf16 v[56:59], a[188:191], v[28:31], v[56:59]
    v_mfma_f32_16x16x32_bf16 v[60:63], a[188:191], v[32:35], v[60:63]
    s_waitcnt lgkmcnt(0)
    v_mfma_f32_16x16x32_bf16 v[40:43], a[192:195], v[20:23], v[40:43]
    ds_read_b128 v[28:31], v4 offset:34816
    v_mfma_f32_16x16x32_bf16 v[44:47], a[192:195], v[24:27], v[44:47]
    ds_read_b128 v[32:35], v4 offset:35840
    v_mfma_f32_16x16x32_bf16 v[48:51], a[196:199], v[20:23], v[48:51]
    v_mfma_f32_16x16x32_bf16 v[52:55], a[196:199], v[24:27], v[52:55]
    v_mfma_f32_16x16x32_bf16 v[56:59], a[200:203], v[20:23], v[56:59]
    v_mfma_f32_16x16x32_bf16 v[60:63], a[200:203], v[24:27], v[60:63]
    s_waitcnt lgkmcnt(0)
    v_mfma_f32_16x16x32_bf16 v[40:43], a[204:207], v[28:31], v[40:43]
    v_mfma_f32_16x16x32_bf16 v[44:47], a[204:207], v[32:35], v[44:47]
    v_mfma_f32_16x16x32_bf16 v[48:51], a[208:211], v[28:31], v[48:51]
    v_mfma_f32_16x16x32_bf16 v[52:55], a[208:211], v[32:35], v[52:55]
    v_mfma_f32_16x16x32_bf16 v[56:59], a[212:215], v[28:31], v[56:59]
    v_mfma_f32_16x16x32_bf16 v[60:63], a[212:215], v[32:35], v[60:63]
    s_nop 3
    v_permlane16_swap_b32 v40, v44
    v_permlane16_swap_b32 v41, v45
    v_permlane16_swap_b32 v42, v46
    v_permlane16_swap_b32 v43, v47
    v_pk_add_f32 v[64:65], v[64:65], v[40:41]
    v_pk_add_f32 v[66:67], v[66:67], v[42:43]
    v_pk_add_f32 v[68:69], v[68:69], v[44:45]
    v_pk_add_f32 v[70:71], v[70:71], v[46:47]
    v_cvt_pk_bf16_f32 v240, v64, v65
    v_cvt_pk_bf16_f32 v241, v66, v67
    v_cvt_pk_bf16_f32 v242, v68, v69
    v_cvt_pk_bf16_f32 v243, v70, v71
    buffer_store_dwordx4 v[240:243], v9, s[8:11], s36 offen offset:0 sc1
    v_permlane16_swap_b32 v48, v52
    v_permlane16_swap_b32 v49, v53
    v_permlane16_swap_b32 v50, v54
    v_permlane16_swap_b32 v51, v55
    v_pk_add_f32 v[72:73], v[72:73], v[48:49]
    v_pk_add_f32 v[74:75], v[74:75], v[50:51]
    v_pk_add_f32 v[76:77], v[76:77], v[52:53]
    v_pk_add_f32 v[78:79], v[78:79], v[54:55]
    v_cvt_pk_bf16_f32 v244, v72, v73
    v_cvt_pk_bf16_f32 v245, v74, v75
    v_cvt_pk_bf16_f32 v246, v76, v77
    v_cvt_pk_bf16_f32 v247, v78, v79
    buffer_store_dwordx4 v[244:247], v9, s[8:11], s36 offen offset:1024 sc1
    v_permlane16_swap_b32 v56, v60
    v_permlane16_swap_b32 v57, v61
    v_permlane16_swap_b32 v58, v62
    v_permlane16_swap_b32 v59, v63
    v_pk_add_f32 v[80:81], v[80:81], v[56:57]
    v_pk_add_f32 v[82:83], v[82:83], v[58:59]
    v_pk_add_f32 v[84:85], v[84:85], v[60:61]
    v_pk_add_f32 v[86:87], v[86:87], v[62:63]
    v_cvt_pk_bf16_f32 v248, v80, v81
    v_cvt_pk_bf16_f32 v249, v82, v83
    v_cvt_pk_bf16_f32 v250, v84, v85
    v_cvt_pk_bf16_f32 v251, v86, v87
    buffer_store_dwordx4 v[248:251], v7, s[8:11], s36 offen offset:2048 sc1
    s_lshl_b32 s6, s40, 4
    s_lshl_b32 s7, s3, 2
    s_add_u32 s6, s6, s7
    s_add_u32 s6, s6, s44
    v_mov_b32 v1, 1
    s_waitcnt vmcnt(0)
    s_mov_b64 exec, 1
    s_add_u32 s6, s6, 4096
    buffer_store_dword v1, off, s[8:11], s6 sc1
    s_mov_b64 exec, -1
    s_lshl_b32 s7, s40, 2
    s_add_u32 s7, s7, s3
    s_mul_i32 s23, s7, 497664
    s_add_u32 s23, s23, 3145728
    s_add_u32 s50, s23, 497664
    v_lshlrev_b32 v184, 4, v0
    v_add_u32 v185, 4096, v184
    v_add_u32 v186, 8192, v184
    v_add_u32 v187, 12288, v184
    v_add_u32 v188, 16384, v184
    v_add_u32 v189, 20480, v184
    v_add_u32 v190, 24576, v184
    v_add_u32 v191, 28672, v184
    v_add_u32 v192, 32768, v184
    buffer_load_dwordx4 v[16:19], v184, s[48:51], s23 offen offset:0
    buffer_load_dwordx4 v[20:23], v184, s[48:51], s23 offen offset:1024
    buffer_load_dwordx4 v[24:27], v184, s[48:51], s23 offen offset:2048
    buffer_load_dwordx4 v[28:31], v184, s[48:51], s23 offen offset:3072
    buffer_load_dwordx4 v[32:35], v185, s[48:51], s23 offen offset:0
    buffer_load_dwordx4 v[36:39], v185, s[48:51], s23 offen offset:1024
    buffer_load_dwordx4 v[40:43], v185, s[48:51], s23 offen offset:2048
    buffer_load_dwordx4 v[44:47], v185, s[48:51], s23 offen offset:3072
    buffer_load_dwordx4 v[48:51], v186, s[48:51], s23 offen offset:0
    buffer_load_dwordx4 v[52:55], v186, s[48:51], s23 offen offset:1024
    buffer_load_dwordx4 v[56:59], v186, s[48:51], s23 offen offset:2048
    buffer_load_dwordx4 v[60:63], v186, s[48:51], s23 offen offset:3072
    buffer_load_dwordx4 v[64:67], v187, s[48:51], s23 offen offset:0
    buffer_load_dwordx4 v[68:71], v187, s[48:51], s23 offen offset:1024
    buffer_load_dwordx4 v[72:75], v187, s[48:51], s23 offen offset:2048
    s_add_u32 s23, s23, 15360
    s_lshl_b32 s7, s41, 2
    s_add_u32 s7, s7, s3
    s_mul_i32 s22, s7, 18432
    s_add_u32 s22, s22, s43
    s_add_u32 s22, s22, 24641536
    v_and_b32 v15, 31, v0
    v_lshlrev_b32 v15, 2, v15
    s_add_u32 s7, s44, 4096
    s_mov_b32 s6, 0
L_poll_11:
    buffer_load_dword v1, v15, s[8:11], s7 offen sc1
    s_add_u32 s6, s6, 1
    s_waitcnt vmcnt(0)
    v_cmp_ne_u32 vcc, 0, v1
    s_cmp_eq_u64 vcc, exec
    s_cbranch_scc1 L_polled_12
    s_cmp_ge_u32 s6, 1048576
    s_cbranch_scc1 L_main_end
    s_sleep 1
    s_branch L_poll_11
L_polled_12:
    buffer_load_dwordx4 v[88:91], v2, s[8:11], s22 offen offset:0 sc1
    buffer_load_dwordx4 v[92:95], v2, s[8:11], s22 offen offset:512 sc1
    buffer_load_dwordx4 v[96:99], v2, s[8:11], s22 offen offset:1024 sc1
    buffer_load_dwordx4 v[100:103], v2, s[8:11], s22 offen offset:1536 sc1
    buffer_load_dwordx4 v[104:107], v2, s[8:11], s22 offen offset:2048 sc1
    buffer_load_dwordx4 v[108:111], v2, s[8:11], s22 offen offset:2560 sc1
    buffer_load_dwordx4 v[112:115], v2, s[8:11], s22 offen offset:3072 sc1
    buffer_load_dwordx4 v[116:119], v2, s[8:11], s22 offen offset:3584 sc1
    s_add_u32 s22, s22, 4096
    buffer_load_dwordx4 v[120:123], v2, s[8:11], s22 offen offset:0 sc1
    buffer_load_dwordx4 v[124:127], v2, s[8:11], s22 offen offset:512 sc1
    buffer_load_dwordx4 v[128:131], v2, s[8:11], s22 offen offset:1024 sc1
    buffer_load_dwordx4 v[132:135], v2, s[8:11], s22 offen offset:1536 sc1
    buffer_load_dwordx4 v[136:139], v2, s[8:11], s22 offen offset:2048 sc1
    buffer_load_dwordx4 v[140:143], v2, s[8:11], s22 offen offset:2560 sc1
    buffer_load_dwordx4 v[144:147], v2, s[8:11], s22 offen offset:3072 sc1
    buffer_load_dwordx4 v[148:151], v2, s[8:11], s22 offen offset:3584 sc1
    s_add_u32 s22, s22, 4096
    buffer_load_dwordx4 v[152:155], v2, s[8:11], s22 offen offset:0 sc1
    buffer_load_dwordx4 v[156:159], v2, s[8:11], s22 offen offset:512 sc1
    s_mov_b32 s16, 0xffff0000
    s_mov_b32 s17, 0x3f803f80
    v_mov_b32 v4, 0
    v_mov_b32 v5, 0
    v_mov_b32 v6, 0
    v_mov_b32 v7, 0
    v_mov_b32 v8, 0
    v_mov_b32 v9, 0
    v_mov_b32 v10, 0
    v_mov_b32 v11, 0
    s_waitcnt vmcnt(17)
    v_dot2c_f32_bf16 v4, s17, v88
    v_dot2c_f32_bf16 v8, v88, v88
    v_dot2c_f32_bf16 v5, s17, v89
    v_dot2c_f32_bf16 v9, v89, v89
    v_dot2c_f32_bf16 v6, s17, v90
    v_dot2c_f32_bf16 v10, v90, v90
    v_dot2c_f32_bf16 v7, s17, v91
    v_dot2c_f32_bf16 v11, v91, v91
    s_waitcnt vmcnt(16)
    v_dot2c_f32_bf16 v4, s17, v92
    v_dot2c_f32_bf16 v8, v92, v92
    v_dot2c_f32_bf16 v5, s17, v93
    v_dot2c_f32_bf16 v9, v93, v93
    v_dot2c_f32_bf16 v6, s17, v94
    v_dot2c_f32_bf16 v10, v94, v94
    v_dot2c_f32_bf16 v7, s17, v95
    v_dot2c_f32_bf16 v11, v95, v95
    s_waitcnt vmcnt(15)
    v_dot2c_f32_bf16 v4, s17, v96
    v_dot2c_f32_bf16 v8, v96, v96
    v_dot2c_f32_bf16 v5, s17, v97
    v_dot2c_f32_bf16 v9, v97, v97
    v_dot2c_f32_bf16 v6, s17, v98
    v_dot2c_f32_bf16 v10, v98, v98
    v_dot2c_f32_bf16 v7, s17, v99
    v_dot2c_f32_bf16 v11, v99, v99
    s_waitcnt vmcnt(14)
    v_dot2c_f32_bf16 v4, s17, v100
    v_dot2c_f32_bf16 v8, v100, v100
    v_dot2c_f32_bf16 v5, s17, v101
    v_dot2c_f32_bf16 v9, v101, v101
    v_dot2c_f32_bf16 v6, s17, v102
    v_dot2c_f32_bf16 v10, v102, v102
    v_dot2c_f32_bf16 v7, s17, v103
    v_dot2c_f32_bf16 v11, v103, v103
    s_waitcnt vmcnt(13)
    v_dot2c_f32_bf16 v4, s17, v104
    v_dot2c_f32_bf16 v8, v104, v104
    v_dot2c_f32_bf16 v5, s17, v105
    v_dot2c_f32_bf16 v9, v105, v105
    v_dot2c_f32_bf16 v6, s17, v106
    v_dot2c_f32_bf16 v10, v106, v106
    v_dot2c_f32_bf16 v7, s17, v107
    v_dot2c_f32_bf16 v11, v107, v107
    s_waitcnt vmcnt(12)
    v_dot2c_f32_bf16 v4, s17, v108
    v_dot2c_f32_bf16 v8, v108, v108
    v_dot2c_f32_bf16 v5, s17, v109
    v_dot2c_f32_bf16 v9, v109, v109
    v_dot2c_f32_bf16 v6, s17, v110
    v_dot2c_f32_bf16 v10, v110, v110
    v_dot2c_f32_bf16 v7, s17, v111
    v_dot2c_f32_bf16 v11, v111, v111
    s_waitcnt vmcnt(11)
    v_dot2c_f32_bf16 v4, s17, v112
    v_dot2c_f32_bf16 v8, v112, v112
    v_dot2c_f32_bf16 v5, s17, v113
    v_dot2c_f32_bf16 v9, v113, v113
    v_dot2c_f32_bf16 v6, s17, v114
    v_dot2c_f32_bf16 v10, v114, v114
    v_dot2c_f32_bf16 v7, s17, v115
    v_dot2c_f32_bf16 v11, v115, v115
    s_waitcnt vmcnt(10)
    v_dot2c_f32_bf16 v4, s17, v116
    v_dot2c_f32_bf16 v8, v116, v116
    v_dot2c_f32_bf16 v5, s17, v117
    v_dot2c_f32_bf16 v9, v117, v117
    v_dot2c_f32_bf16 v6, s17, v118
    v_dot2c_f32_bf16 v10, v118, v118
    v_dot2c_f32_bf16 v7, s17, v119
    v_dot2c_f32_bf16 v11, v119, v119
    s_waitcnt vmcnt(9)
    v_dot2c_f32_bf16 v4, s17, v120
    v_dot2c_f32_bf16 v8, v120, v120
    v_dot2c_f32_bf16 v5, s17, v121
    v_dot2c_f32_bf16 v9, v121, v121
    v_dot2c_f32_bf16 v6, s17, v122
    v_dot2c_f32_bf16 v10, v122, v122
    v_dot2c_f32_bf16 v7, s17, v123
    v_dot2c_f32_bf16 v11, v123, v123
    s_waitcnt vmcnt(8)
    v_dot2c_f32_bf16 v4, s17, v124
    v_dot2c_f32_bf16 v8, v124, v124
    v_dot2c_f32_bf16 v5, s17, v125
    v_dot2c_f32_bf16 v9, v125, v125
    v_dot2c_f32_bf16 v6, s17, v126
    v_dot2c_f32_bf16 v10, v126, v126
    v_dot2c_f32_bf16 v7, s17, v127
    v_dot2c_f32_bf16 v11, v127, v127
    s_waitcnt vmcnt(7)
    v_dot2c_f32_bf16 v4, s17, v128
    v_dot2c_f32_bf16 v8, v128, v128
    v_dot2c_f32_bf16 v5, s17, v129
    v_dot2c_f32_bf16 v9, v129, v129
    v_dot2c_f32_bf16 v6, s17, v130
    v_dot2c_f32_bf16 v10, v130, v130
    v_dot2c_f32_bf16 v7, s17, v131
    v_dot2c_f32_bf16 v11, v131, v131
    s_waitcnt vmcnt(6)
    v_dot2c_f32_bf16 v4, s17, v132
    v_dot2c_f32_bf16 v8, v132, v132
    v_dot2c_f32_bf16 v5, s17, v133
    v_dot2c_f32_bf16 v9, v133, v133
    v_dot2c_f32_bf16 v6, s17, v134
    v_dot2c_f32_bf16 v10, v134, v134
    v_dot2c_f32_bf16 v7, s17, v135
    v_dot2c_f32_bf16 v11, v135, v135
    s_waitcnt vmcnt(5)
    v_dot2c_f32_bf16 v4, s17, v136
    v_dot2c_f32_bf16 v8, v136, v136
    v_dot2c_f32_bf16 v5, s17, v137
    v_dot2c_f32_bf16 v9, v137, v137
    v_dot2c_f32_bf16 v6, s17, v138
    v_dot2c_f32_bf16 v10, v138, v138
    v_dot2c_f32_bf16 v7, s17, v139
    v_dot2c_f32_bf16 v11, v139, v139
    s_waitcnt vmcnt(4)
    v_dot2c_f32_bf16 v4, s17, v140
    v_dot2c_f32_bf16 v8, v140, v140
    v_dot2c_f32_bf16 v5, s17, v141
    v_dot2c_f32_bf16 v9, v141, v141
    v_dot2c_f32_bf16 v6, s17, v142
    v_dot2c_f32_bf16 v10, v142, v142
    v_dot2c_f32_bf16 v7, s17, v143
    v_dot2c_f32_bf16 v11, v143, v143
    s_waitcnt vmcnt(3)
    v_dot2c_f32_bf16 v4, s17, v144
    v_dot2c_f32_bf16 v8, v144, v144
    v_dot2c_f32_bf16 v5, s17, v145
    v_dot2c_f32_bf16 v9, v145, v145
    v_dot2c_f32_bf16 v6, s17, v146
    v_dot2c_f32_bf16 v10, v146, v146
    v_dot2c_f32_bf16 v7, s17, v147
    v_dot2c_f32_bf16 v11, v147, v147
    s_waitcnt vmcnt(2)
    v_dot2c_f32_bf16 v4, s17, v148
    v_dot2c_f32_bf16 v8, v148, v148
    v_dot2c_f32_bf16 v5, s17, v149
    v_dot2c_f32_bf16 v9, v149, v149
    v_dot2c_f32_bf16 v6, s17, v150
    v_dot2c_f32_bf16 v10, v150, v150
    v_dot2c_f32_bf16 v7, s17, v151
    v_dot2c_f32_bf16 v11, v151, v151
    s_waitcnt vmcnt(1)
    v_dot2c_f32_bf16 v4, s17, v152
    v_dot2c_f32_bf16 v8, v152, v152
    v_dot2c_f32_bf16 v5, s17, v153
    v_dot2c_f32_bf16 v9, v153, v153
    v_dot2c_f32_bf16 v6, s17, v154
    v_dot2c_f32_bf16 v10, v154, v154
    v_dot2c_f32_bf16 v7, s17, v155
    v_dot2c_f32_bf16 v11, v155, v155
    s_waitcnt vmcnt(0)
    v_dot2c_f32_bf16 v4, s17, v156
    v_dot2c_f32_bf16 v8, v156, v156
    v_dot2c_f32_bf16 v5, s17, v157
    v_dot2c_f32_bf16 v9, v157, v157
    v_dot2c_f32_bf16 v6, s17, v158
    v_dot2c_f32_bf16 v10, v158, v158
    v_dot2c_f32_bf16 v7, s17, v159
    v_dot2c_f32_bf16 v11, v159, v159
    s_nop 2
    v_pk_add_f32 v[4:5], v[4:5], v[6:7]
    v_pk_add_f32 v[8:9], v[8:9], v[10:11]
    v_add_f32 v4, v4, v5
    v_add_f32 v5, v8, v9
    v_mov_b32 v6, v4
    v_mov_b32 v7, v5
    s_nop 1
    v_permlane32_swap_b32 v6, v4
    v_permlane32_swap_b32 v7, v5
    v_add_f32 v4, v4, v6
    v_add_f32 v5, v5, v7
    v_mov_b32 v6, v4
    v_mov_b32 v7, v5
    s_nop 1
    v_permlane16_swap_b32 v6, v4
    v_permlane16_swap_b32 v7, v5
    v_add_f32 v4, v4, v6
    v_add_f32 v5, v5, v7
    v_mul_f32 v4, 0x3ae38e39, v4
    v_mul_f32 v5, 0x3ae38e39, v5
    v_fma_f32 v5, -v4, v4, v5
    v_max_f32 v5, 0, v5
    v_add_f32 v5, 0x3727c5ac, v5
    v_rsq_f32 v6, v5
    s_nop 0
    v_mul_f32 v8, v4, v6
    v_mov_b32 v7, v6
    v_sub_f32 v8, 0, v8
    v_mov_b32 v9, v8
    s_mul_i32 s7, s3, 18432
    v_add_u32 v10, s7, v184
    v_lshlrev_b32 v160, 16, v88
    v_and_b32 v161, s16, v88
    v_lshlrev_b32 v162, 16, v89
    v_and_b32 v163, s16, v89
    v_lshlrev_b32 v164, 16, v90
    v_and_b32 v165, s16, v90
    v_lshlrev_b32 v166, 16, v91
    v_and_b32 v167, s16, v91
    v_pk_fma_f32 v[160:161], v[160:161], v[6:7], v[8:9]
    v_pk_fma_f32 v[162:163], v[162:163], v[6:7], v[8:9]
    v_pk_fma_f32 v[164:165], v[164:165], v[6:7], v[8:9]
    v_pk_fma_f32 v[166:167], v[166:167], v[6:7], v[8:9]
    v_cvt_pk_bf16_f32 v88, v160, v161
    v_cvt_pk_bf16_f32 v89, v162, v163
    v_cvt_pk_bf16_f32 v90, v164, v165
    v_cvt_pk_bf16_f32 v91, v166, v167
    ds_write_b128 v10, v[88:91] offset:0
    v_lshlrev_b32 v168, 16, v92
    v_and_b32 v169, s16, v92
    v_lshlrev_b32 v170, 16, v93
    v_and_b32 v171, s16, v93
    v_lshlrev_b32 v172, 16, v94
    v_and_b32 v173, s16, v94
    v_lshlrev_b32 v174, 16, v95
    v_and_b32 v175, s16, v95
    v_pk_fma_f32 v[168:169], v[168:169], v[6:7], v[8:9]
    v_pk_fma_f32 v[170:171], v[170:171], v[6:7], v[8:9]
    v_pk_fma_f32 v[172:173], v[172:173], v[6:7], v[8:9]
    v_pk_fma_f32 v[174:175], v[174:175], v[6:7], v[8:9]
    v_cvt_pk_bf16_f32 v92, v168, v169
    v_cvt_pk_bf16_f32 v93, v170, v171
    v_cvt_pk_bf16_f32 v94, v172, v173
    v_cvt_pk_bf16_f32 v95, v174, v175
    ds_write_b128 v10, v[92:95] offset:1024
    v_lshlrev_b32 v160, 16, v96
    v_and_b32 v161, s16, v96
    v_lshlrev_b32 v162, 16, v97
    v_and_b32 v163, s16, v97
    v_lshlrev_b32 v164, 16, v98
    v_and_b32 v165, s16, v98
    v_lshlrev_b32 v166, 16, v99
    v_and_b32 v167, s16, v99
    v_pk_fma_f32 v[160:161], v[160:161], v[6:7], v[8:9]
    v_pk_fma_f32 v[162:163], v[162:163], v[6:7], v[8:9]
    v_pk_fma_f32 v[164:165], v[164:165], v[6:7], v[8:9]
    v_pk_fma_f32 v[166:167], v[166:167], v[6:7], v[8:9]
    v_cvt_pk_bf16_f32 v96, v160, v161
    v_cvt_pk_bf16_f32 v97, v162, v163
    v_cvt_pk_bf16_f32 v98, v164, v165
    v_cvt_pk_bf16_f32 v99, v166, v167
    ds_write_b128 v10, v[96:99] offset:2048
    v_lshlrev_b32 v168, 16, v100
    v_and_b32 v169, s16, v100
    v_lshlrev_b32 v170, 16, v101
    v_and_b32 v171, s16, v101
    v_lshlrev_b32 v172, 16, v102
    v_and_b32 v173, s16, v102
    v_lshlrev_b32 v174, 16, v103
    v_and_b32 v175, s16, v103
    v_pk_fma_f32 v[168:169], v[168:169], v[6:7], v[8:9]
    v_pk_fma_f32 v[170:171], v[170:171], v[6:7], v[8:9]
    v_pk_fma_f32 v[172:173], v[172:173], v[6:7], v[8:9]
    v_pk_fma_f32 v[174:175], v[174:175], v[6:7], v[8:9]
    v_cvt_pk_bf16_f32 v100, v168, v169
    v_cvt_pk_bf16_f32 v101, v170, v171
    v_cvt_pk_bf16_f32 v102, v172, v173
    v_cvt_pk_bf16_f32 v103, v174, v175
    ds_write_b128 v10, v[100:103] offset:3072
    v_lshlrev_b32 v160, 16, v104
    v_and_b32 v161, s16, v104
    v_lshlrev_b32 v162, 16, v105
    v_and_b32 v163, s16, v105
    v_lshlrev_b32 v164, 16, v106
    v_and_b32 v165, s16, v106
    v_lshlrev_b32 v166, 16, v107
    v_and_b32 v167, s16, v107
    v_pk_fma_f32 v[160:161], v[160:161], v[6:7], v[8:9]
    v_pk_fma_f32 v[162:163], v[162:163], v[6:7], v[8:9]
    v_pk_fma_f32 v[164:165], v[164:165], v[6:7], v[8:9]
    v_pk_fma_f32 v[166:167], v[166:167], v[6:7], v[8:9]
    v_cvt_pk_bf16_f32 v104, v160, v161
    v_cvt_pk_bf16_f32 v105, v162, v163
    v_cvt_pk_bf16_f32 v106, v164, v165
    v_cvt_pk_bf16_f32 v107, v166, v167
    ds_write_b128 v10, v[104:107] offset:4096
    v_lshlrev_b32 v168, 16, v108
    v_and_b32 v169, s16, v108
    v_lshlrev_b32 v170, 16, v109
    v_and_b32 v171, s16, v109
    v_lshlrev_b32 v172, 16, v110
    v_and_b32 v173, s16, v110
    v_lshlrev_b32 v174, 16, v111
    v_and_b32 v175, s16, v111
    v_pk_fma_f32 v[168:169], v[168:169], v[6:7], v[8:9]
    v_pk_fma_f32 v[170:171], v[170:171], v[6:7], v[8:9]
    v_pk_fma_f32 v[172:173], v[172:173], v[6:7], v[8:9]
    v_pk_fma_f32 v[174:175], v[174:175], v[6:7], v[8:9]
    v_cvt_pk_bf16_f32 v108, v168, v169
    v_cvt_pk_bf16_f32 v109, v170, v171
    v_cvt_pk_bf16_f32 v110, v172, v173
    v_cvt_pk_bf16_f32 v111, v174, v175
    ds_write_b128 v10, v[108:111] offset:5120
    v_lshlrev_b32 v160, 16, v112
    v_and_b32 v161, s16, v112
    v_lshlrev_b32 v162, 16, v113
    v_and_b32 v163, s16, v113
    v_lshlrev_b32 v164, 16, v114
    v_and_b32 v165, s16, v114
    v_lshlrev_b32 v166, 16, v115
    v_and_b32 v167, s16, v115
    v_pk_fma_f32 v[160:161], v[160:161], v[6:7], v[8:9]
    v_pk_fma_f32 v[162:163], v[162:163], v[6:7], v[8:9]
    v_pk_fma_f32 v[164:165], v[164:165], v[6:7], v[8:9]
    v_pk_fma_f32 v[166:167], v[166:167], v[6:7], v[8:9]
    v_cvt_pk_bf16_f32 v112, v160, v161
    v_cvt_pk_bf16_f32 v113, v162, v163
    v_cvt_pk_bf16_f32 v114, v164, v165
    v_cvt_pk_bf16_f32 v115, v166, v167
    ds_write_b128 v10, v[112:115] offset:6144
    v_lshlrev_b32 v168, 16, v116
    v_and_b32 v169, s16, v116
    v_lshlrev_b32 v170, 16, v117
    v_and_b32 v171, s16, v117
    v_lshlrev_b32 v172, 16, v118
    v_and_b32 v173, s16, v118
    v_lshlrev_b32 v174, 16, v119
    v_and_b32 v175, s16, v119
    v_pk_fma_f32 v[168:169], v[168:169], v[6:7], v[8:9]
    v_pk_fma_f32 v[170:171], v[170:171], v[6:7], v[8:9]
    v_pk_fma_f32 v[172:173], v[172:173], v[6:7], v[8:9]
    v_pk_fma_f32 v[174:175], v[174:175], v[6:7], v[8:9]
    v_cvt_pk_bf16_f32 v116, v168, v169
    v_cvt_pk_bf16_f32 v117, v170, v171
    v_cvt_pk_bf16_f32 v118, v172, v173
    v_cvt_pk_bf16_f32 v119, v174, v175
    ds_write_b128 v10, v[116:119] offset:7168
    v_lshlrev_b32 v160, 16, v120
    v_and_b32 v161, s16, v120
    v_lshlrev_b32 v162, 16, v121
    v_and_b32 v163, s16, v121
    v_lshlrev_b32 v164, 16, v122
    v_and_b32 v165, s16, v122
    v_lshlrev_b32 v166, 16, v123
    v_and_b32 v167, s16, v123
    v_pk_fma_f32 v[160:161], v[160:161], v[6:7], v[8:9]
    v_pk_fma_f32 v[162:163], v[162:163], v[6:7], v[8:9]
    v_pk_fma_f32 v[164:165], v[164:165], v[6:7], v[8:9]
    v_pk_fma_f32 v[166:167], v[166:167], v[6:7], v[8:9]
    v_cvt_pk_bf16_f32 v120, v160, v161
    v_cvt_pk_bf16_f32 v121, v162, v163
    v_cvt_pk_bf16_f32 v122, v164, v165
    v_cvt_pk_bf16_f32 v123, v166, v167
    ds_write_b128 v10, v[120:123] offset:8192
    v_lshlrev_b32 v168, 16, v124
    v_and_b32 v169, s16, v124
    v_lshlrev_b32 v170, 16, v125
    v_and_b32 v171, s16, v125
    v_lshlrev_b32 v172, 16, v126
    v_and_b32 v173, s16, v126
    v_lshlrev_b32 v174, 16, v127
    v_and_b32 v175, s16, v127
    v_pk_fma_f32 v[168:169], v[168:169], v[6:7], v[8:9]
    v_pk_fma_f32 v[170:171], v[170:171], v[6:7], v[8:9]
    v_pk_fma_f32 v[172:173], v[172:173], v[6:7], v[8:9]
    v_pk_fma_f32 v[174:175], v[174:175], v[6:7], v[8:9]
    v_cvt_pk_bf16_f32 v124, v168, v169
    v_cvt_pk_bf16_f32 v125, v170, v171
    v_cvt_pk_bf16_f32 v126, v172, v173
    v_cvt_pk_bf16_f32 v127, v174, v175
    ds_write_b128 v10, v[124:127] offset:9216
    v_lshlrev_b32 v160, 16, v128
    v_and_b32 v161, s16, v128
    v_lshlrev_b32 v162, 16, v129
    v_and_b32 v163, s16, v129
    v_lshlrev_b32 v164, 16, v130
    v_and_b32 v165, s16, v130
    v_lshlrev_b32 v166, 16, v131
    v_and_b32 v167, s16, v131
    v_pk_fma_f32 v[160:161], v[160:161], v[6:7], v[8:9]
    v_pk_fma_f32 v[162:163], v[162:163], v[6:7], v[8:9]
    v_pk_fma_f32 v[164:165], v[164:165], v[6:7], v[8:9]
    v_pk_fma_f32 v[166:167], v[166:167], v[6:7], v[8:9]
    v_cvt_pk_bf16_f32 v128, v160, v161
    v_cvt_pk_bf16_f32 v129, v162, v163
    v_cvt_pk_bf16_f32 v130, v164, v165
    v_cvt_pk_bf16_f32 v131, v166, v167
    ds_write_b128 v10, v[128:131] offset:10240
    v_lshlrev_b32 v168, 16, v132
    v_and_b32 v169, s16, v132
    v_lshlrev_b32 v170, 16, v133
    v_and_b32 v171, s16, v133
    v_lshlrev_b32 v172, 16, v134
    v_and_b32 v173, s16, v134
    v_lshlrev_b32 v174, 16, v135
    v_and_b32 v175, s16, v135
    v_pk_fma_f32 v[168:169], v[168:169], v[6:7], v[8:9]
    v_pk_fma_f32 v[170:171], v[170:171], v[6:7], v[8:9]
    v_pk_fma_f32 v[172:173], v[172:173], v[6:7], v[8:9]
    v_pk_fma_f32 v[174:175], v[174:175], v[6:7], v[8:9]
    v_cvt_pk_bf16_f32 v132, v168, v169
    v_cvt_pk_bf16_f32 v133, v170, v171
    v_cvt_pk_bf16_f32 v134, v172, v173
    v_cvt_pk_bf16_f32 v135, v174, v175
    ds_write_b128 v10, v[132:135] offset:11264
    v_lshlrev_b32 v160, 16, v136
    v_and_b32 v161, s16, v136
    v_lshlrev_b32 v162, 16, v137
    v_and_b32 v163, s16, v137
    v_lshlrev_b32 v164, 16, v138
    v_and_b32 v165, s16, v138
    v_lshlrev_b32 v166, 16, v139
    v_and_b32 v167, s16, v139
    v_pk_fma_f32 v[160:161], v[160:161], v[6:7], v[8:9]
    v_pk_fma_f32 v[162:163], v[162:163], v[6:7], v[8:9]
    v_pk_fma_f32 v[164:165], v[164:165], v[6:7], v[8:9]
    v_pk_fma_f32 v[166:167], v[166:167], v[6:7], v[8:9]
    v_cvt_pk_bf16_f32 v136, v160, v161
    v_cvt_pk_bf16_f32 v137, v162, v163
    v_cvt_pk_bf16_f32 v138, v164, v165
    v_cvt_pk_bf16_f32 v139, v166, v167
    ds_write_b128 v10, v[136:139] offset:12288
    v_lshlrev_b32 v168, 16, v140
    v_and_b32 v169, s16, v140
    v_lshlrev_b32 v170, 16, v141
    v_and_b32 v171, s16, v141
    v_lshlrev_b32 v172, 16, v142
    v_and_b32 v173, s16, v142
    v_lshlrev_b32 v174, 16, v143
    v_and_b32 v175, s16, v143
    v_pk_fma_f32 v[168:169], v[168:169], v[6:7], v[8:9]
    v_pk_fma_f32 v[170:171], v[170:171], v[6:7], v[8:9]
    v_pk_fma_f32 v[172:173], v[172:173], v[6:7], v[8:9]
    v_pk_fma_f32 v[174:175], v[174:175], v[6:7], v[8:9]
    v_cvt_pk_bf16_f32 v140, v168, v169
    v_cvt_pk_bf16_f32 v141, v170, v171
    v_cvt_pk_bf16_f32 v142, v172, v173
    v_cvt_pk_bf16_f32 v143, v174, v175
    ds_write_b128 v10, v[140:143] offset:13312
    v_lshlrev_b32 v160, 16, v144
    v_and_b32 v161, s16, v144
    v_lshlrev_b32 v162, 16, v145
    v_and_b32 v163, s16, v145
    v_lshlrev_b32 v164, 16, v146
    v_and_b32 v165, s16, v146
    v_lshlrev_b32 v166, 16, v147
    v_and_b32 v167, s16, v147
    v_pk_fma_f32 v[160:161], v[160:161], v[6:7], v[8:9]
    v_pk_fma_f32 v[162:163], v[162:163], v[6:7], v[8:9]
    v_pk_fma_f32 v[164:165], v[164:165], v[6:7], v[8:9]
    v_pk_fma_f32 v[166:167], v[166:167], v[6:7], v[8:9]
    v_cvt_pk_bf16_f32 v144, v160, v161
    v_cvt_pk_bf16_f32 v145, v162, v163
    v_cvt_pk_bf16_f32 v146, v164, v165
    v_cvt_pk_bf16_f32 v147, v166, v167
    ds_write_b128 v10, v[144:147] offset:14336
    v_lshlrev_b32 v168, 16, v148
    v_and_b32 v169, s16, v148
    v_lshlrev_b32 v170, 16, v149
    v_and_b32 v171, s16, v149
    v_lshlrev_b32 v172, 16, v150
    v_and_b32 v173, s16, v150
    v_lshlrev_b32 v174, 16, v151
    v_and_b32 v175, s16, v151
    v_pk_fma_f32 v[168:169], v[168:169], v[6:7], v[8:9]
    v_pk_fma_f32 v[170:171], v[170:171], v[6:7], v[8:9]
    v_pk_fma_f32 v[172:173], v[172:173], v[6:7], v[8:9]
    v_pk_fma_f32 v[174:175], v[174:175], v[6:7], v[8:9]
    v_cvt_pk_bf16_f32 v148, v168, v169
    v_cvt_pk_bf16_f32 v149, v170, v171
    v_cvt_pk_bf16_f32 v150, v172, v173
    v_cvt_pk_bf16_f32 v151, v174, v175
    ds_write_b128 v10, v[148:151] offset:15360
    v_lshlrev_b32 v160, 16, v152
    v_and_b32 v161, s16, v152
    v_lshlrev_b32 v162, 16, v153
    v_and_b32 v163, s16, v153
    v_lshlrev_b32 v164, 16, v154
    v_and_b32 v165, s16, v154
    v_lshlrev_b32 v166, 16, v155
    v_and_b32 v167, s16, v155
    v_pk_fma_f32 v[160:161], v[160:161], v[6:7], v[8:9]
    v_pk_fma_f32 v[162:163], v[162:163], v[6:7], v[8:9]
    v_pk_fma_f32 v[164:165], v[164:165], v[6:7], v[8:9]
    v_pk_fma_f32 v[166:167], v[166:167], v[6:7], v[8:9]
    v_cvt_pk_bf16_f32 v152, v160, v161
    v_cvt_pk_bf16_f32 v153, v162, v163
    v_cvt_pk_bf16_f32 v154, v164, v165
    v_cvt_pk_bf16_f32 v155, v166, v167
    ds_write_b128 v10, v[152:155] offset:16384
    v_lshlrev_b32 v168, 16, v156
    v_and_b32 v169, s16, v156
    v_lshlrev_b32 v170, 16, v157
    v_and_b32 v171, s16, v157
    v_lshlrev_b32 v172, 16, v158
    v_and_b32 v173, s16, v158
    v_lshlrev_b32 v174, 16, v159
    v_and_b32 v175, s16, v159
    v_pk_fma_f32 v[168:169], v[168:169], v[6:7], v[8:9]
    v_pk_fma_f32 v[170:171], v[170:171], v[6:7], v[8:9]
    v_pk_fma_f32 v[172:173], v[172:173], v[6:7], v[8:9]
    v_pk_fma_f32 v[174:175], v[174:175], v[6:7], v[8:9]
    v_cvt_pk_bf16_f32 v156, v168, v169
    v_cvt_pk_bf16_f32 v157, v170, v171
    v_cvt_pk_bf16_f32 v158, v172, v173
    v_cvt_pk_bf16_f32 v159, v174, v175
    ds_write_b128 v10, v[156:159] offset:17408
    v_add_u32 v11, 36864, v184
    s_waitcnt lgkmcnt(0)
    s_barrier
    ds_read_b128 a[0:3], v184 offset:0
    ds_read_b128 a[72:75], v184 offset:18432
    ds_read_b128 a[144:147], v11 offset:0
    ds_read_b128 a[216:219], v11 offset:18432
    ds_read_b128 a[4:7], v184 offset:1024
    ds_read_b128 a[76:79], v184 offset:19456
    ds_read_b128 a[148:151], v11 offset:1024
    ds_read_b128 a[220:223], v11 offset:19456
    ds_read_b128 a[8:11], v184 offset:2048
    ds_read_b128 a[80:83], v184 offset:20480
    ds_read_b128 a[152:155], v11 offset:2048
    ds_read_b128 a[224:227], v11 offset:20480
    ds_read_b128 a[12:15], v184 offset:3072
    ds_read_b128 a[84:87], v184 offset:21504
    ds_read_b128 a[156:159], v11 offset:3072
    ds_read_b128 a[228:231], v11 offset:21504
    ds_read_b128 a[16:19], v184 offset:4096
    ds_read_b128 a[88:91], v184 offset:22528
    ds_read_b128 a[160:163], v11 offset:4096
    ds_read_b128 a[232:235], v11 offset:22528
    ds_read_b128 a[20:23], v184 offset:5120
    ds_read_b128 a[92:95], v184 offset:23552
    ds_read_b128 a[164:167], v11 offset:5120
    ds_read_b128 a[236:239], v11 offset:23552
    ds_read_b128 a[24:27], v184 offset:6144
    ds_read_b128 a[96:99], v184 offset:24576
    ds_read_b128 a[168:171], v11 offset:6144
    ds_read_b128 a[240:243], v11 offset:24576
    ds_read_b128 a[28:31], v184 offset:7168
    ds_read_b128 a[100:103], v184 offset:25600
    ds_read_b128 a[172:175], v11 offset:7168
    ds_read_b128 a[244:247], v11 offset:25600
    ds_read_b128 a[32:35], v184 offset:8192
    ds_read_b128 a[104:107], v184 offset:26624
    ds_read_b128 a[176:179], v11 offset:8192
    ds_read_b128 a[248:251], v11 offset:26624
    ds_read_b128 a[36:39], v184 offset:9216
    ds_read_b128 a[108:111], v184 offset:27648
    ds_read_b128 a[180:183], v11 offset:9216
    ds_read_b128 a[252:255], v11 offset:27648
    ds_read_b128 a[40:43], v184 offset:10240
    ds_read_b128 a[112:115], v184 offset:28672
    ds_read_b128 a[184:187], v11 offset:10240
    ds_read_b128 v[220:223], v11 offset:28672
    ds_read_b128 a[44:47], v184 offset:11264
    ds_read_b128 a[116:119], v184 offset:29696
    ds_read_b128 a[188:191], v11 offset:11264
    ds_read_b128 v[224:227], v11 offset:29696
    ds_read_b128 a[48:51], v184 offset:12288
    ds_read_b128 a[120:123], v184 offset:30720
    ds_read_b128 a[192:195], v11 offset:12288
    ds_read_b128 v[228:231], v11 offset:30720
    ds_read_b128 a[52:55], v184 offset:13312
    ds_read_b128 a[124:127], v184 offset:31744
    ds_read_b128 a[196:199], v11 offset:13312
    ds_read_b128 v[232:235], v11 offset:31744
    ds_read_b128 a[56:59], v184 offset:14336
    ds_read_b128 a[128:131], v184 offset:32768
    ds_read_b128 a[200:203], v11 offset:14336
    ds_read_b128 v[236:239], v11 offset:32768
    ds_read_b128 a[60:63], v184 offset:15360
    ds_read_b128 a[132:135], v184 offset:33792
    ds_read_b128 a[204:207], v11 offset:15360
    ds_read_b128 v[240:243], v11 offset:33792
    ds_read_b128 a[64:67], v184 offset:16384
    ds_read_b128 a[136:139], v184 offset:34816
    ds_read_b128 a[208:211], v11 offset:16384
    ds_read_b128 v[244:247], v11 offset:34816
    ds_read_b128 a[68:71], v184 offset:17408
    ds_read_b128 a[140:143], v184 offset:35840
    ds_read_b128 a[212:215], v11 offset:17408
    ds_read_b128 v[248:251], v11 offset:35840
    s_lshr_b32 s7, s3, 1
    s_lshl_b32 s7, s7, 10
    s_and_b32 s6, s3, 1
    s_lshl_b32 s6, s6, 3
    s_add_u32 s24, s7, s6
    s_add_u32 s24, s24, 73728
    s_add_u32 s7, s24, 16384
    v_add_u32 v12, s7, v184
    v_mov_b32 v13, 0xbdd2d3e8
    v_mov_b32 v14, 0xc0135761
    s_mov_b32 s25, 0
    s_waitcnt lgkmcnt(0)
L_ffn_gu_13:
    s_waitcnt vmcnt(12)
    v_mfma_f32_16x16x32_bf16 v[88:91], v[16:19], a[0:3], 0
    v_mfma_f32_16x16x32_bf16 v[88:91], v[20:23], a[4:7], v[88:91]
    buffer_load_dwordx4 v[76:79], v184, s[48:51], s23 offen offset:0
    v_mfma_f32_16x16x32_bf16 v[88:91], v[24:27], a[8:11], v[88:91]
    v_mul_f32 v152, v120, v120
    v_mul_f32 v153, v121, v121
    v_mfma_f32_16x16x32_bf16 v[92:95], v[16:19], a[72:75], 0
    v_mul_f32 v154, v122, v122
    v_mul_f32 v155, v123, v123
    v_mfma_f32_16x16x32_bf16 v[92:95], v[20:23], a[76:79], v[92:95]
    v_fma_f32 v152, v152, v13, v14
    v_fma_f32 v153, v153, v13, v14
    v_mfma_f32_16x16x32_bf16 v[92:95], v[24:27], a[80:83], v[92:95]
    buffer_load_dwordx4 v[80:83], v184, s[48:51], s23 offen offset:1024
    v_mfma_f32_16x16x32_bf16 v[96:99], v[16:19], a[144:147], 0
    v_fma_f32 v154, v154, v13, v14
    v_fma_f32 v155, v155, v13, v14
    v_mfma_f32_16x16x32_bf16 v[96:99], v[20:23], a[148:151], v[96:99]
    v_mul_f32 v152, v120, v152
    v_mul_f32 v153, v121, v153
    v_mfma_f32_16x16x32_bf16 v[96:99], v[24:27], a[152:155], v[96:99]
    v_mul_f32 v154, v122, v154
    v_mul_f32 v155, v123, v155
    v_mfma_f32_16x16x32_bf16 v[100:103], v[16:19], a[216:219], 0
    buffer_load_dwordx4 v[84:87], v184, s[48:51], s23 offen offset:2048
    v_mfma_f32_16x16x32_bf16 v[100:103], v[20:23], a[220:223], v[100:103]
    v_exp_f32 v152, v152
    v_mfma_f32_16x16x32_bf16 v[100:103], v[24:27], a[224:227], v[100:103]
    v_exp_f32 v153, v153
    s_waitcnt vmcnt(12)
    v_mfma_f32_16x16x32_bf16 v[104:107], v[28:31], a[0:3], 0
    v_exp_f32 v154, v154
    v_mfma_f32_16x16x32_bf16 v[104:107], v[32:35], a[4:7], v[104:107]
    buffer_load_dwordx4 v[16:19], v184, s[48:51], s23 offen offset:3072
    v_mfma_f32_16x16x32_bf16 v[104:107], v[36:39], a[8:11], v[104:107]
    v_exp_f32 v155, v155
    v_mfma_f32_16x16x32_bf16 v[108:111], v[28:31], a[72:75], 0
    v_mul_f32 v156, v120, v136
    v_mul_f32 v157, v121, v137
    v_mfma_f32_16x16x32_bf16 v[108:111], v[32:35], a[76:79], v[108:111]
    v_mul_f32 v158, v122, v138
    v_mul_f32 v159, v123, v139
    v_mfma_f32_16x16x32_bf16 v[108:111], v[36:39], a[80:83], v[108:111]
    buffer_load_dwordx4 v[20:23], v185, s[48:51], s23 offen offset:0
    v_mfma_f32_16x16x32_bf16 v[112:115], v[28:31], a[144:147], 0
    v_add_f32 v152, 1.0, v152
    v_add_f32 v153, 1.0, v153
    v_mfma_f32_16x16x32_bf16 v[112:115], v[32:35], a[148:151], v[112:115]
    v_add_f32 v154, 1.0, v154
    v_add_f32 v155, 1.0, v155
    v_mfma_f32_16x16x32_bf16 v[112:115], v[36:39], a[152:155], v[112:115]
    v_rcp_f32 v152, v152
    v_mfma_f32_16x16x32_bf16 v[116:119], v[28:31], a[216:219], 0
    buffer_load_dwordx4 v[24:27], v185, s[48:51], s23 offen offset:1024
    v_mfma_f32_16x16x32_bf16 v[116:119], v[32:35], a[220:223], v[116:119]
    v_rcp_f32 v153, v153
    v_mfma_f32_16x16x32_bf16 v[116:119], v[36:39], a[224:227], v[116:119]
    v_rcp_f32 v154, v154
    s_waitcnt vmcnt(12)
    v_mfma_f32_16x16x32_bf16 v[88:91], v[40:43], a[12:15], v[88:91]
    v_rcp_f32 v155, v155
    v_mfma_f32_16x16x32_bf16 v[88:91], v[44:47], a[16:19], v[88:91]
    buffer_load_dwordx4 v[28:31], v185, s[48:51], s23 offen offset:2048
    v_mfma_f32_16x16x32_bf16 v[88:91], v[48:51], a[20:23], v[88:91]
    v_mul_f32 v156, v156, v152
    v_mul_f32 v157, v157, v153
    v_mfma_f32_16x16x32_bf16 v[92:95], v[40:43], a[84:87], v[92:95]
    v_mul_f32 v158, v158, v154
    v_mul_f32 v159, v159, v155
    v_mfma_f32_16x16x32_bf16 v[92:95], v[44:47], a[88:91], v[92:95]
    v_cvt_pk_bf16_f32 v160, v156, v157
    v_cvt_pk_bf16_f32 v161, v158, v159
    v_mfma_f32_16x16x32_bf16 v[92:95], v[48:51], a[92:95], v[92:95]
    buffer_load_dwordx4 v[32:35], v185, s[48:51], s23 offen offset:3072
    v_mfma_f32_16x16x32_bf16 v[96:99], v[40:43], a[156:159], v[96:99]
    ds_write_b64 v12, v[160:161] offset:0
    v_mfma_f32_16x16x32_bf16 v[96:99], v[44:47], a[160:163], v[96:99]
    v_mul_f32 v162, v124, v124
    v_mul_f32 v163, v125, v125
    v_mfma_f32_16x16x32_bf16 v[96:99], v[48:51], a[164:167], v[96:99]
    v_mul_f32 v164, v126, v126
    v_mul_f32 v165, v127, v127
    v_mfma_f32_16x16x32_bf16 v[100:103], v[40:43], a[228:231], v[100:103]
    buffer_load_dwordx4 v[36:39], v186, s[48:51], s23 offen offset:0
    v_mfma_f32_16x16x32_bf16 v[100:103], v[44:47], a[232:235], v[100:103]
    v_fma_f32 v162, v162, v13, v14
    v_fma_f32 v163, v163, v13, v14
    v_mfma_f32_16x16x32_bf16 v[100:103], v[48:51], a[236:239], v[100:103]
    v_fma_f32 v164, v164, v13, v14
    v_fma_f32 v165, v165, v13, v14
    s_waitcnt vmcnt(12)
    v_mfma_f32_16x16x32_bf16 v[104:107], v[52:55], a[12:15], v[104:107]
    v_mul_f32 v162, v124, v162
    v_mul_f32 v163, v125, v163
    v_mfma_f32_16x16x32_bf16 v[104:107], v[56:59], a[16:19], v[104:107]
    buffer_load_dwordx4 v[40:43], v186, s[48:51], s23 offen offset:1024
    v_mfma_f32_16x16x32_bf16 v[104:107], v[60:63], a[20:23], v[104:107]
    v_mul_f32 v164, v126, v164
    v_mul_f32 v165, v127, v165
    v_mfma_f32_16x16x32_bf16 v[108:111], v[52:55], a[84:87], v[108:111]
    v_exp_f32 v162, v162
    v_mfma_f32_16x16x32_bf16 v[108:111], v[56:59], a[88:91], v[108:111]
    v_exp_f32 v163, v163
    v_mfma_f32_16x16x32_bf16 v[108:111], v[60:63], a[92:95], v[108:111]
    buffer_load_dwordx4 v[44:47], v186, s[48:51], s23 offen offset:2048
    v_mfma_f32_16x16x32_bf16 v[112:115], v[52:55], a[156:159], v[112:115]
    v_exp_f32 v164, v164
    v_mfma_f32_16x16x32_bf16 v[112:115], v[56:59], a[160:163], v[112:115]
    v_exp_f32 v165, v165
    v_mfma_f32_16x16x32_bf16 v[112:115], v[60:63], a[164:167], v[112:115]
    v_mul_f32 v166, v124, v140
    v_mul_f32 v167, v125, v141
    v_mfma_f32_16x16x32_bf16 v[116:119], v[52:55], a[228:231], v[116:119]
    buffer_load_dwordx4 v[48:51], v186, s[48:51], s23 offen offset:3072
    v_mfma_f32_16x16x32_bf16 v[116:119], v[56:59], a[232:235], v[116:119]
    v_mul_f32 v168, v126, v142
    v_mul_f32 v169, v127, v143
    v_mfma_f32_16x16x32_bf16 v[116:119], v[60:63], a[236:239], v[116:119]
    v_add_f32 v162, 1.0, v162
    v_add_f32 v163, 1.0, v163
    s_waitcnt vmcnt(12)
    v_mfma_f32_16x16x32_bf16 v[88:91], v[64:67], a[24:27], v[88:91]
    v_add_f32 v164, 1.0, v164
    v_add_f32 v165, 1.0, v165
    v_mfma_f32_16x16x32_bf16 v[88:91], v[68:71], a[28:31], v[88:91]
    buffer_load_dwordx4 v[52:55], v187, s[48:51], s23 offen offset:0
    v_mfma_f32_16x16x32_bf16 v[88:91], v[72:75], a[32:35], v[88:91]
    v_rcp_f32 v162, v162
    v_mfma_f32_16x16x32_bf16 v[92:95], v[64:67], a[96:99], v[92:95]
    v_rcp_f32 v163, v163
    v_mfma_f32_16x16x32_bf16 v[92:95], v[68:71], a[100:103], v[92:95]
    v_rcp_f32 v164, v164
    v_mfma_f32_16x16x32_bf16 v[92:95], v[72:75], a[104:107], v[92:95]
    buffer_load_dwordx4 v[56:59], v187, s[48:51], s23 offen offset:1024
    v_mfma_f32_16x16x32_bf16 v[96:99], v[64:67], a[168:171], v[96:99]
    v_rcp_f32 v165, v165
    v_mfma_f32_16x16x32_bf16 v[96:99], v[68:71], a[172:175], v[96:99]
    v_mul_f32 v166, v166, v162
    v_mul_f32 v167, v167, v163
    v_mfma_f32_16x16x32_bf16 v[96:99], v[72:75], a[176:179], v[96:99]
    v_mul_f32 v168, v168, v164
    v_mul_f32 v169, v169, v165
    v_mfma_f32_16x16x32_bf16 v[100:103], v[64:67], a[240:243], v[100:103]
    buffer_load_dwordx4 v[60:63], v187, s[48:51], s23 offen offset:2048
    v_mfma_f32_16x16x32_bf16 v[100:103], v[68:71], a[244:247], v[100:103]
    v_cvt_pk_bf16_f32 v170, v166, v167
    v_cvt_pk_bf16_f32 v171, v168, v169
    v_mfma_f32_16x16x32_bf16 v[100:103], v[72:75], a[248:251], v[100:103]
    ds_write_b64 v12, v[170:171] offset:18432
    s_waitcnt vmcnt(12)
    v_mfma_f32_16x16x32_bf16 v[104:107], v[76:79], a[24:27], v[104:107]
    v_mul_f32 v152, v128, v128
    v_mul_f32 v153, v129, v129
    v_mfma_f32_16x16x32_bf16 v[104:107], v[80:83], a[28:31], v[104:107]
    buffer_load_dwordx4 v[64:67], v187, s[48:51], s23 offen offset:3072
    v_mfma_f32_16x16x32_bf16 v[104:107], v[84:87], a[32:35], v[104:107]
    v_mul_f32 v154, v130, v130
    v_mul_f32 v155, v131, v131
    v_mfma_f32_16x16x32_bf16 v[108:111], v[76:79], a[96:99], v[108:111]
    v_fma_f32 v152, v152, v13, v14
    v_fma_f32 v153, v153, v13, v14
    v_mfma_f32_16x16x32_bf16 v[108:111], v[80:83], a[100:103], v[108:111]
    v_fma_f32 v154, v154, v13, v14
    v_fma_f32 v155, v155, v13, v14
    v_mfma_f32_16x16x32_bf16 v[108:111], v[84:87], a[104:107], v[108:111]
    buffer_load_dwordx4 v[68:71], v188, s[48:51], s23 offen offset:0
    v_mfma_f32_16x16x32_bf16 v[112:115], v[76:79], a[168:171], v[112:115]
    v_mul_f32 v152, v128, v152
    v_mul_f32 v153, v129, v153
    v_mfma_f32_16x16x32_bf16 v[112:115], v[80:83], a[172:175], v[112:115]
    v_mul_f32 v154, v130, v154
    v_mul_f32 v155, v131, v155
    v_mfma_f32_16x16x32_bf16 v[112:115], v[84:87], a[176:179], v[112:115]
    v_exp_f32 v152, v152
    v_mfma_f32_16x16x32_bf16 v[116:119], v[76:79], a[240:243], v[116:119]
    buffer_load_dwordx4 v[72:75], v188, s[48:51], s23 offen offset:1024
    v_mfma_f32_16x16x32_bf16 v[116:119], v[80:83], a[244:247], v[116:119]
    v_exp_f32 v153, v153
    v_mfma_f32_16x16x32_bf16 v[116:119], v[84:87], a[248:251], v[116:119]
    v_exp_f32 v154, v154
    s_waitcnt vmcnt(12)
    v_mfma_f32_16x16x32_bf16 v[88:91], v[16:19], a[36:39], v[88:91]
    v_exp_f32 v155, v155
    v_mfma_f32_16x16x32_bf16 v[88:91], v[20:23], a[40:43], v[88:91]
    buffer_load_dwordx4 v[76:79], v188, s[48:51], s23 offen offset:2048
    v_mfma_f32_16x16x32_bf16 v[88:91], v[24:27], a[44:47], v[88:91]
    v_mul_f32 v156, v128, v144
    v_mul_f32 v157, v129, v145
    v_mfma_f32_16x16x32_bf16 v[92:95], v[16:19], a[108:111], v[92:95]
    v_mul_f32 v158, v130, v146
    v_mul_f32 v159, v131, v147
    v_mfma_f32_16x16x32_bf16 v[92:95], v[20:23], a[112:115], v[92:95]
    v_add_f32 v152, 1.0, v152
    v_add_f32 v153, 1.0, v153
    v_mfma_f32_16x16x32_bf16 v[92:95], v[24:27], a[116:119], v[92:95]
    buffer_load_dwordx4 v[80:83], v188, s[48:51], s23 offen offset:3072
    v_mfma_f32_16x16x32_bf16 v[96:99], v[16:19], a[180:183], v[96:99]
    v_add_f32 v154, 1.0, v154
    v_add_f32 v155, 1.0, v155
    v_mfma_f32_16x16x32_bf16 v[96:99], v[20:23], a[184:187], v[96:99]
    v_rcp_f32 v152, v152
    v_mfma_f32_16x16x32_bf16 v[96:99], v[24:27], a[188:191], v[96:99]
    v_rcp_f32 v153, v153
    v_mfma_f32_16x16x32_bf16 v[100:103], v[16:19], a[252:255], v[100:103]
    buffer_load_dwordx4 v[84:87], v189, s[48:51], s23 offen offset:0
    v_mfma_f32_16x16x32_bf16 v[100:103], v[20:23], v[220:223], v[100:103]
    v_rcp_f32 v154, v154
    v_mfma_f32_16x16x32_bf16 v[100:103], v[24:27], v[224:227], v[100:103]
    v_rcp_f32 v155, v155
    s_waitcnt vmcnt(12)
    v_mfma_f32_16x16x32_bf16 v[104:107], v[28:31], a[36:39], v[104:107]
    v_mul_f32 v156, v156, v152
    v_mul_f32 v157, v157, v153
    v_mfma_f32_16x16x32_bf16 v[104:107], v[32:35], a[40:43], v[104:107]
    buffer_load_dwordx4 v[16:19], v189, s[48:51], s23 offen offset:1024
    v_mfma_f32_16x16x32_bf16 v[104:107], v[36:39], a[44:47], v[104:107]
    v_mul_f32 v158, v158, v154
    v_mul_f32 v159, v159, v155
    v_mfma_f32_16x16x32_bf16 v[108:111], v[28:31], a[108:111], v[108:111]
    v_cvt_pk_bf16_f32 v160, v156, v157
    v_cvt_pk_bf16_f32 v161, v158, v159
    v_mfma_f32_16x16x32_bf16 v[108:111], v[32:35], a[112:115], v[108:111]
    ds_write_b64 v12, v[160:161] offset:36864
    v_mfma_f32_16x16x32_bf16 v[108:111], v[36:39], a[116:119], v[108:111]
    buffer_load_dwordx4 v[20:23], v189, s[48:51], s23 offen offset:2048
    v_mfma_f32_16x16x32_bf16 v[112:115], v[28:31], a[180:183], v[112:115]
    v_mul_f32 v162, v132, v132
    v_mul_f32 v163, v133, v133
    v_mfma_f32_16x16x32_bf16 v[112:115], v[32:35], a[184:187], v[112:115]
    v_mul_f32 v164, v134, v134
    v_mul_f32 v165, v135, v135
    v_mfma_f32_16x16x32_bf16 v[112:115], v[36:39], a[188:191], v[112:115]
    v_fma_f32 v162, v162, v13, v14
    v_fma_f32 v163, v163, v13, v14
    v_mfma_f32_16x16x32_bf16 v[116:119], v[28:31], a[252:255], v[116:119]
    buffer_load_dwordx4 v[24:27], v189, s[48:51], s23 offen offset:3072
    v_mfma_f32_16x16x32_bf16 v[116:119], v[32:35], v[220:223], v[116:119]
    v_fma_f32 v164, v164, v13, v14
    v_fma_f32 v165, v165, v13, v14
    v_mfma_f32_16x16x32_bf16 v[116:119], v[36:39], v[224:227], v[116:119]
    v_mul_f32 v162, v132, v162
    v_mul_f32 v163, v133, v163
    s_waitcnt vmcnt(12)
    v_mfma_f32_16x16x32_bf16 v[88:91], v[40:43], a[48:51], v[88:91]
    v_mul_f32 v164, v134, v164
    v_mul_f32 v165, v135, v165
    v_mfma_f32_16x16x32_bf16 v[88:91], v[44:47], a[52:55], v[88:91]
    buffer_load_dwordx4 v[28:31], v190, s[48:51], s23 offen offset:0
    v_mfma_f32_16x16x32_bf16 v[88:91], v[48:51], a[56:59], v[88:91]
    v_exp_f32 v162, v162
    v_mfma_f32_16x16x32_bf16 v[92:95], v[40:43], a[120:123], v[92:95]
    v_exp_f32 v163, v163
    v_mfma_f32_16x16x32_bf16 v[92:95], v[44:47], a[124:127], v[92:95]
    v_exp_f32 v164, v164
    v_mfma_f32_16x16x32_bf16 v[92:95], v[48:51], a[128:131], v[92:95]
    buffer_load_dwordx4 v[32:35], v190, s[48:51], s23 offen offset:1024
    v_mfma_f32_16x16x32_bf16 v[96:99], v[40:43], a[192:195], v[96:99]
    v_exp_f32 v165, v165
    v_mfma_f32_16x16x32_bf16 v[96:99], v[44:47], a[196:199], v[96:99]
    v_mul_f32 v166, v132, v148
    v_mul_f32 v167, v133, v149
    v_mfma_f32_16x16x32_bf16 v[96:99], v[48:51], a[200:203], v[96:99]
    v_mul_f32 v168, v134, v150
    v_mul_f32 v169, v135, v151
    v_mfma_f32_16x16x32_bf16 v[100:103], v[40:43], v[228:231], v[100:103]
    buffer_load_dwordx4 v[36:39], v190, s[48:51], s23 offen offset:2048
    v_mfma_f32_16x16x32_bf16 v[100:103], v[44:47], v[232:235], v[100:103]
    v_add_f32 v162, 1.0, v162
    v_add_f32 v163, 1.0, v163
    v_mfma_f32_16x16x32_bf16 v[100:103], v[48:51], v[236:239], v[100:103]
    v_add_f32 v164, 1.0, v164
    v_add_f32 v165, 1.0, v165
    s_waitcnt vmcnt(12)
    v_mfma_f32_16x16x32_bf16 v[104:107], v[52:55], a[48:51], v[104:107]
    v_rcp_f32 v162, v162
    v_mfma_f32_16x16x32_bf16 v[104:107], v[56:59], a[52:55], v[104:107]
    buffer_load_dwordx4 v[40:43], v190, s[48:51], s23 offen offset:3072
    v_mfma_f32_16x16x32_bf16 v[104:107], v[60:63], a[56:59], v[104:107]
    v_rcp_f32 v163, v163
    v_mfma_f32_16x16x32_bf16 v[108:111], v[52:55], a[120:123], v[108:111]
    v_rcp_f32 v164, v164
    v_mfma_f32_16x16x32_bf16 v[108:111], v[56:59], a[124:127], v[108:111]
    v_rcp_f32 v165, v165
    v_mfma_f32_16x16x32_bf16 v[108:111], v[60:63], a[128:131], v[108:111]
    buffer_load_dwordx4 v[44:47], v191, s[48:51], s23 offen offset:0
    v_mfma_f32_16x16x32_bf16 v[112:115], v[52:55], a[192:195], v[112:115]
    v_mul_f32 v166, v166, v162
    v_mul_f32 v167, v167, v163
    v_mfma_f32_16x16x32_bf16 v[112:115], v[56:59], a[196:199], v[112:115]
    v_mul_f32 v168, v168, v164
    v_mul_f32 v169, v169, v165
    v_mfma_f32_16x16x32_bf16 v[112:115], v[60:63], a[200:203], v[112:115]
    v_cvt_pk_bf16_f32 v170, v166, v167
    v_cvt_pk_bf16_f32 v171, v168, v169
    v_mfma_f32_16x16x32_bf16 v[116:119], v[52:55], v[228:231], v[116:119]
    buffer_load_dwordx4 v[48:51], v191, s[48:51], s23 offen offset:1024
    v_mfma_f32_16x16x32_bf16 v[116:119], v[56:59], v[232:235], v[116:119]
    ds_write_b64 v12, v[170:171] offset:55296
    v_mfma_f32_16x16x32_bf16 v[116:119], v[60:63], v[236:239], v[116:119]
    s_waitcnt vmcnt(12)
    v_mfma_f32_16x16x32_bf16 v[88:91], v[64:67], a[60:63], v[88:91]
    v_mfma_f32_16x16x32_bf16 v[88:91], v[68:71], a[64:67], v[88:91]
    buffer_load_dwordx4 v[52:55], v191, s[48:51], s23 offen offset:2048
    v_mfma_f32_16x16x32_bf16 v[120:123], v[72:75], a[68:71], v[88:91]
    v_mfma_f32_16x16x32_bf16 v[92:95], v[64:67], a[132:135], v[92:95]
    v_mfma_f32_16x16x32_bf16 v[92:95], v[68:71], a[136:139], v[92:95]
    v_mfma_f32_16x16x32_bf16 v[124:127], v[72:75], a[140:143], v[92:95]
    buffer_load_dwordx4 v[56:59], v191, s[48:51], s23 offen offset:3072
    v_mfma_f32_16x16x32_bf16 v[96:99], v[64:67], a[204:207], v[96:99]
    v_mfma_f32_16x16x32_bf16 v[96:99], v[68:71], a[208:211], v[96:99]
    v_mfma_f32_16x16x32_bf16 v[128:131], v[72:75], a[212:215], v[96:99]
    v_mfma_f32_16x16x32_bf16 v[100:103], v[64:67], v[240:243], v[100:103]
    buffer_load_dwordx4 v[60:63], v192, s[48:51], s23 offen offset:0
    v_mfma_f32_16x16x32_bf16 v[100:103], v[68:71], v[244:247], v[100:103]
    v_mfma_f32_16x16x32_bf16 v[132:135], v[72:75], v[248:251], v[100:103]
    s_waitcnt vmcnt(12)
    v_mfma_f32_16x16x32_bf16 v[104:107], v[76:79], a[60:63], v[104:107]
    v_mfma_f32_16x16x32_bf16 v[104:107], v[80:83], a[64:67], v[104:107]
    buffer_load_dwordx4 v[64:67], v192, s[48:51], s23 offen offset:1024
    v_mfma_f32_16x16x32_bf16 v[136:139], v[84:87], a[68:71], v[104:107]
    v_mfma_f32_16x16x32_bf16 v[108:111], v[76:79], a[132:135], v[108:111]
    v_mfma_f32_16x16x32_bf16 v[108:111], v[80:83], a[136:139], v[108:111]
    v_mfma_f32_16x16x32_bf16 v[140:143], v[84:87], a[140:143], v[108:111]
    buffer_load_dwordx4 v[68:71], v192, s[48:51], s23 offen offset:2048
    v_mfma_f32_16x16x32_bf16 v[112:115], v[76:79], a[204:207], v[112:115]
    v_mfma_f32_16x16x32_bf16 v[112:115], v[80:83], a[208:211], v[112:115]
    s_lshl_b32 s7, s25, 11
    v_mfma_f32_16x16x32_bf16 v[144:147], v[84:87], a[212:215], v[112:115]
    s_add_u32 s7, s7, s24
    v_mfma_f32_16x16x32_bf16 v[116:119], v[76:79], v[240:243], v[116:119]
    buffer_load_dwordx4 v[72:75], v192, s[48:51], s23 offen offset:3072
    v_mfma_f32_16x16x32_bf16 v[116:119], v[80:83], v[244:247], v[116:119]
    s_add_u32 s23, s23, 36864
    v_mfma_f32_16x16x32_bf16 v[148:151], v[84:87], v[248:251], v[116:119]
    v_add_u32 v12, s7, v184
    s_add_u32 s25, s25, 1
    s_cmp_lt_u32 s25, 9
    s_cbranch_scc1 L_ffn_gu_13
    v_add_u32 v10, 73728, v184
    v_add_u32 v11, 110592, v184
    s_waitcnt lgkmcnt(0)
    s_barrier
    v_mul_f32 v152, v120, v120
    ds_read_b128 a[0:3], v10 offset:0
    v_mul_f32 v153, v121, v121
    v_mul_f32 v154, v122, v122
    v_mul_f32 v155, v123, v123
    ds_read_b128 a[72:75], v10 offset:18432
    v_fma_f32 v152, v152, v13, v14
    v_fma_f32 v153, v153, v13, v14
    v_fma_f32 v154, v154, v13, v14
    ds_read_b128 a[144:147], v11 offset:0
    v_fma_f32 v155, v155, v13, v14
    v_mul_f32 v152, v120, v152
    v_mul_f32 v153, v121, v153
    ds_read_b128 a[216:219], v11 offset:18432
    v_mul_f32 v154, v122, v154
    v_mul_f32 v155, v123, v155
    v_exp_f32 v152, v152
    ds_read_b128 a[4:7], v10 offset:1024
    v_exp_f32 v153, v153
    ds_read_b128 a[76:79], v10 offset:19456
    v_exp_f32 v154, v154
    ds_read_b128 a[148:151], v11 offset:1024
    v_exp_f32 v155, v155
    ds_read_b128 a[220:223], v11 offset:19456
    v_mul_f32 v156, v120, v136
    v_mul_f32 v157, v121, v137
    v_mul_f32 v158, v122, v138
    ds_read_b128 a[8:11], v10 offset:2048
    v_mul_f32 v159, v123, v139
    v_add_f32 v152, 1.0, v152
    v_add_f32 v153, 1.0, v153
    ds_read_b128 a[80:83], v10 offset:20480
    v_add_f32 v154, 1.0, v154
    v_add_f32 v155, 1.0, v155
    v_rcp_f32 v152, v152
    ds_read_b128 a[152:155], v11 offset:2048
    v_rcp_f32 v153, v153
    ds_read_b128 a[224:227], v11 offset:20480
    v_rcp_f32 v154, v154
    ds_read_b128 a[12:15], v10 offset:3072
    v_rcp_f32 v155, v155
    ds_read_b128 a[84:87], v10 offset:21504
    v_mul_f32 v156, v156, v152
    v_mul_f32 v157, v157, v153
    v_mul_f32 v158, v158, v154
    ds_read_b128 a[156:159], v11 offset:3072
    v_mul_f32 v159, v159, v155
    v_cvt_pk_bf16_f32 v160, v156, v157
    v_cvt_pk_bf16_f32 v161, v158, v159
    ds_read_b128 a[228:231], v11 offset:21504
    ds_write_b64 v12, v[160:161] offset:0
    v_mul_f32 v162, v124, v124
    v_mul_f32 v163, v125, v125
    ds_read_b128 a[16:19], v10 offset:4096
    v_mul_f32 v164, v126, v126
    v_mul_f32 v165, v127, v127
    v_fma_f32 v162, v162, v13, v14
    ds_read_b128 a[88:91], v10 offset:22528
    v_fma_f32 v163, v163, v13, v14
    v_fma_f32 v164, v164, v13, v14
    v_fma_f32 v165, v165, v13, v14
    ds_read_b128 a[160:163], v11 offset:4096
    v_mul_f32 v162, v124, v162
    v_mul_f32 v163, v125, v163
    v_mul_f32 v164, v126, v164
    ds_read_b128 a[232:235], v11 offset:22528
    v_mul_f32 v165, v127, v165
    v_exp_f32 v162, v162
    ds_read_b128 a[20:23], v10 offset:5120
    v_exp_f32 v163, v163
    ds_read_b128 a[92:95], v10 offset:23552
    v_exp_f32 v164, v164
    ds_read_b128 a[164:167], v11 offset:5120
    v_exp_f32 v165, v165
    ds_read_b128 a[236:239], v11 offset:23552
    v_mul_f32 v166, v124, v140
    ds_read_b128 a[24:27], v10 offset:6144
    v_mul_f32 v167, v125, v141
    v_mul_f32 v168, v126, v142
    v_mul_f32 v169, v127, v143
    ds_read_b128 a[96:99], v10 offset:24576
    v_add_f32 v162, 1.0, v162
    v_add_f32 v163, 1.0, v163
    v_add_f32 v164, 1.0, v164
    ds_read_b128 a[168:171], v11 offset:6144
    v_add_f32 v165, 1.0, v165
    v_rcp_f32 v162, v162
    ds_read_b128 a[240:243], v11 offset:24576
    v_rcp_f32 v163, v163
    ds_read_b128 a[28:31], v10 offset:7168
    v_rcp_f32 v164, v164
    ds_read_b128 a[100:103], v10 offset:25600
    v_rcp_f32 v165, v165
    ds_read_b128 a[172:175], v11 offset:7168
    v_mul_f32 v166, v166, v162
    ds_read_b128 a[244:247], v11 offset:25600
    v_mul_f32 v167, v167, v163
    v_mul_f32 v168, v168, v164
    v_mul_f32 v169, v169, v165
    ds_read_b128 a[32:35], v10 offset:8192
    v_cvt_pk_bf16_f32 v170, v166, v167
    v_cvt_pk_bf16_f32 v171, v168, v169
    ds_write_b64 v12, v[170:171] offset:18432
    ds_read_b128 a[104:107], v10 offset:26624
    v_mul_f32 v152, v128, v128
    v_mul_f32 v153, v129, v129
    v_mul_f32 v154, v130, v130
    ds_read_b128 a[176:179], v11 offset:8192
    v_mul_f32 v155, v131, v131
    v_fma_f32 v152, v152, v13, v14
    v_fma_f32 v153, v153, v13, v14
    ds_read_b128 a[248:251], v11 offset:26624
    v_fma_f32 v154, v154, v13, v14
    v_fma_f32 v155, v155, v13, v14
    v_mul_f32 v152, v128, v152
    ds_read_b128 a[36:39], v10 offset:9216
    v_mul_f32 v153, v129, v153
    v_mul_f32 v154, v130, v154
    v_mul_f32 v155, v131, v155
    ds_read_b128 a[108:111], v10 offset:27648
    v_exp_f32 v152, v152
    ds_read_b128 a[180:183], v11 offset:9216
    v_exp_f32 v153, v153
    ds_read_b128 a[252:255], v11 offset:27648
    v_exp_f32 v154, v154
    ds_read_b128 a[40:43], v10 offset:10240
    v_exp_f32 v155, v155
    ds_read_b128 a[112:115], v10 offset:28672
    v_mul_f32 v156, v128, v144
    v_mul_f32 v157, v129, v145
    ds_read_b128 a[184:187], v11 offset:10240
    v_mul_f32 v158, v130, v146
    v_mul_f32 v159, v131, v147
    v_add_f32 v152, 1.0, v152
    ds_read_b128 v[220:223], v11 offset:28672
    v_add_f32 v153, 1.0, v153
    v_add_f32 v154, 1.0, v154
    v_add_f32 v155, 1.0, v155
    ds_read_b128 a[44:47], v10 offset:11264
    v_rcp_f32 v152, v152
    ds_read_b128 a[116:119], v10 offset:29696
    v_rcp_f32 v153, v153
    ds_read_b128 a[188:191], v11 offset:11264
    v_rcp_f32 v154, v154
    ds_read_b128 v[224:227], v11 offset:29696
    v_rcp_f32 v155, v155
    ds_read_b128 a[48:51], v10 offset:12288
    v_mul_f32 v156, v156, v152
    v_mul_f32 v157, v157, v153
    ds_read_b128 a[120:123], v10 offset:30720
    v_mul_f32 v158, v158, v154
    v_mul_f32 v159, v159, v155
    v_cvt_pk_bf16_f32 v160, v156, v157
    ds_read_b128 a[192:195], v11 offset:12288
    v_cvt_pk_bf16_f32 v161, v158, v159
    ds_write_b64 v12, v[160:161] offset:36864
    v_mul_f32 v162, v132, v132
    ds_read_b128 v[228:231], v11 offset:30720
    v_mul_f32 v163, v133, v133
    v_mul_f32 v164, v134, v134
    v_mul_f32 v165, v135, v135
    ds_read_b128 a[52:55], v10 offset:13312
    v_fma_f32 v162, v162, v13, v14
    v_fma_f32 v163, v163, v13, v14
    v_fma_f32 v164, v164, v13, v14
    ds_read_b128 a[124:127], v10 offset:31744
    v_fma_f32 v165, v165, v13, v14
    v_mul_f32 v162, v132, v162
    v_mul_f32 v163, v133, v163
    ds_read_b128 a[196:199], v11 offset:13312
    v_mul_f32 v164, v134, v164
    v_mul_f32 v165, v135, v165
    v_exp_f32 v162, v162
    ds_read_b128 v[232:235], v11 offset:31744
    v_exp_f32 v163, v163
    ds_read_b128 a[56:59], v10 offset:14336
    v_exp_f32 v164, v164
    ds_read_b128 a[128:131], v10 offset:32768
    v_exp_f32 v165, v165
    ds_read_b128 a[200:203], v11 offset:14336
    v_mul_f32 v166, v132, v148
    v_mul_f32 v167, v133, v149
    v_mul_f32 v168, v134, v150
    ds_read_b128 v[236:239], v11 offset:32768
    v_mul_f32 v169, v135, v151
    v_add_f32 v162, 1.0, v162
    v_add_f32 v163, 1.0, v163
    ds_read_b128 a[60:63], v10 offset:15360
    v_add_f32 v164, 1.0, v164
    v_add_f32 v165, 1.0, v165
    v_rcp_f32 v162, v162
    ds_read_b128 a[132:135], v10 offset:33792
    v_rcp_f32 v163, v163
    ds_read_b128 a[204:207], v11 offset:15360
    v_rcp_f32 v164, v164
    ds_read_b128 v[240:243], v11 offset:33792
    v_rcp_f32 v165, v165
    v_mul_f32 v166, v166, v162
    v_mul_f32 v167, v167, v163
    v_mul_f32 v168, v168, v164
    v_mul_f32 v169, v169, v165
    v_cvt_pk_bf16_f32 v170, v166, v167
    v_cvt_pk_bf16_f32 v171, v168, v169
    ds_write_b64 v12, v[170:171] offset:55296
    v_bfe_u32 v4, v0, 3, 2
    s_mov_b32 s7, 73728
    v_mul_lo_u32 v2, v4, s7
    v_lshrrev_b32 v4, 5, v0
    v_lshl_add_u32 v2, v4, 7, v2
    v_and_b32 v4, 7, v0
    v_lshl_add_u32 v2, v4, 4, v2
    v_add_u32 v3, 294912, v2
    s_mul_i32 s26, s41, 589824
    s_add_u32 s26, s26, s43
    s_mul_i32 s7, s40, 9216
    s_add_u32 s26, s26, s7
    s_mul_i32 s7, s3, 2304
    s_add_u32 s26, s26, s7
    s_add_u32 s26, s26, 29360128
    s_add_u32 s27, s26, 2048
    s_waitcnt lgkmcnt(0)
    s_barrier
    ds_read_b128 a[64:67], v10 offset:16384
    ds_read_b128 a[136:139], v10 offset:34816
    ds_read_b128 a[208:211], v11 offset:16384
    ds_read_b128 v[244:247], v11 offset:34816
    ds_read_b128 a[68:71], v10 offset:17408
    ds_read_b128 a[140:143], v10 offset:35840
    ds_read_b128 a[212:215], v11 offset:17408
    ds_read_b128 v[248:251], v11 offset:35840
    s_mov_b32 s25, 0
    s_waitcnt lgkmcnt(0)
L_ffn_dn_14:
    s_waitcnt vmcnt(12)
    v_mfma_f32_16x16x32_bf16 v[88:91], v[16:19], a[0:3], 0
    v_mfma_f32_16x16x32_bf16 v[88:91], v[20:23], a[4:7], v[88:91]
    buffer_load_dwordx4 v[76:79], v184, s[48:51], s23 offen offset:0
    v_mfma_f32_16x16x32_bf16 v[88:91], v[24:27], a[8:11], v[88:91]
    v_mfma_f32_16x16x32_bf16 v[92:95], v[16:19], a[72:75], 0
    v_mfma_f32_16x16x32_bf16 v[92:95], v[20:23], a[76:79], v[92:95]
    v_mfma_f32_16x16x32_bf16 v[92:95], v[24:27], a[80:83], v[92:95]
    buffer_load_dwordx4 v[80:83], v184, s[48:51], s23 offen offset:1024
    v_mfma_f32_16x16x32_bf16 v[96:99], v[16:19], a[144:147], 0
    v_cvt_pk_bf16_f32 v152, v120, v121
    v_cvt_pk_bf16_f32 v153, v122, v123
    v_mfma_f32_16x16x32_bf16 v[96:99], v[20:23], a[148:151], v[96:99]
    v_cvt_pk_bf16_f32 v154, v124, v125
    v_cvt_pk_bf16_f32 v155, v126, v127
    v_mfma_f32_16x16x32_bf16 v[96:99], v[24:27], a[152:155], v[96:99]
    v_cvt_pk_bf16_f32 v156, v128, v129
    v_cvt_pk_bf16_f32 v157, v130, v131
    v_mfma_f32_16x16x32_bf16 v[100:103], v[16:19], a[216:219], 0
    buffer_load_dwordx4 v[84:87], v184, s[48:51], s23 offen offset:2048
    v_mfma_f32_16x16x32_bf16 v[100:103], v[20:23], a[220:223], v[100:103]
    v_cvt_pk_bf16_f32 v158, v132, v133
    v_cvt_pk_bf16_f32 v159, v134, v135
    v_mfma_f32_16x16x32_bf16 v[100:103], v[24:27], a[224:227], v[100:103]
    v_permlane16_swap_b32 v152, v154
    s_waitcnt vmcnt(12)
    v_mfma_f32_16x16x32_bf16 v[88:91], v[28:31], a[12:15], v[88:91]
    v_permlane16_swap_b32 v153, v155
    v_mfma_f32_16x16x32_bf16 v[88:91], v[32:35], a[16:19], v[88:91]
    buffer_load_dwordx4 v[16:19], v184, s[48:51], s23 offen offset:3072
    v_mfma_f32_16x16x32_bf16 v[88:91], v[36:39], a[20:23], v[88:91]
    v_permlane16_swap_b32 v156, v158
    v_mfma_f32_16x16x32_bf16 v[92:95], v[28:31], a[84:87], v[92:95]
    v_permlane16_swap_b32 v157, v159
    v_mfma_f32_16x16x32_bf16 v[92:95], v[32:35], a[88:91], v[92:95]
    buffer_store_dwordx4 v[152:155], v2, s[8:11], s27 offen sc1
    v_mfma_f32_16x16x32_bf16 v[92:95], v[36:39], a[92:95], v[92:95]
    buffer_load_dwordx4 v[20:23], v185, s[48:51], s23 offen offset:0
    v_mfma_f32_16x16x32_bf16 v[96:99], v[28:31], a[156:159], v[96:99]
    buffer_store_dwordx4 v[156:159], v3, s[8:11], s27 offen sc1
    v_mfma_f32_16x16x32_bf16 v[96:99], v[32:35], a[160:163], v[96:99]
    v_mfma_f32_16x16x32_bf16 v[96:99], v[36:39], a[164:167], v[96:99]
    v_mfma_f32_16x16x32_bf16 v[100:103], v[28:31], a[228:231], v[100:103]
    buffer_load_dwordx4 v[24:27], v185, s[48:51], s23 offen offset:1024
    v_mfma_f32_16x16x32_bf16 v[100:103], v[32:35], a[232:235], v[100:103]
    v_mfma_f32_16x16x32_bf16 v[100:103], v[36:39], a[236:239], v[100:103]
    s_waitcnt vmcnt(14)
    v_mfma_f32_16x16x32_bf16 v[88:91], v[40:43], a[24:27], v[88:91]
    v_mfma_f32_16x16x32_bf16 v[88:91], v[44:47], a[28:31], v[88:91]
    buffer_load_dwordx4 v[28:31], v185, s[48:51], s23 offen offset:2048
    v_mfma_f32_16x16x32_bf16 v[88:91], v[48:51], a[32:35], v[88:91]
    v_mfma_f32_16x16x32_bf16 v[92:95], v[40:43], a[96:99], v[92:95]
    v_mfma_f32_16x16x32_bf16 v[92:95], v[44:47], a[100:103], v[92:95]
    v_mfma_f32_16x16x32_bf16 v[92:95], v[48:51], a[104:107], v[92:95]
    buffer_load_dwordx4 v[32:35], v185, s[48:51], s23 offen offset:3072
    v_mfma_f32_16x16x32_bf16 v[96:99], v[40:43], a[168:171], v[96:99]
    v_mfma_f32_16x16x32_bf16 v[96:99], v[44:47], a[172:175], v[96:99]
    v_mfma_f32_16x16x32_bf16 v[96:99], v[48:51], a[176:179], v[96:99]
    v_mfma_f32_16x16x32_bf16 v[100:103], v[40:43], a[240:243], v[100:103]
    buffer_load_dwordx4 v[36:39], v186, s[48:51], s23 offen offset:0
    v_mfma_f32_16x16x32_bf16 v[100:103], v[44:47], a[244:247], v[100:103]
    v_mfma_f32_16x16x32_bf16 v[100:103], v[48:51], a[248:251], v[100:103]
    s_waitcnt vmcnt(14)
    v_mfma_f32_16x16x32_bf16 v[88:91], v[52:55], a[36:39], v[88:91]
    v_mfma_f32_16x16x32_bf16 v[88:91], v[56:59], a[40:43], v[88:91]
    buffer_load_dwordx4 v[40:43], v186, s[48:51], s23 offen offset:1024
    v_mfma_f32_16x16x32_bf16 v[88:91], v[60:63], a[44:47], v[88:91]
    v_mfma_f32_16x16x32_bf16 v[92:95], v[52:55], a[108:111], v[92:95]
    v_mfma_f32_16x16x32_bf16 v[92:95], v[56:59], a[112:115], v[92:95]
    v_mfma_f32_16x16x32_bf16 v[92:95], v[60:63], a[116:119], v[92:95]
    buffer_load_dwordx4 v[44:47], v186, s[48:51], s23 offen offset:2048
    v_mfma_f32_16x16x32_bf16 v[96:99], v[52:55], a[180:183], v[96:99]
    v_mfma_f32_16x16x32_bf16 v[96:99], v[56:59], a[184:187], v[96:99]
    v_mfma_f32_16x16x32_bf16 v[96:99], v[60:63], a[188:191], v[96:99]
    v_mfma_f32_16x16x32_bf16 v[100:103], v[52:55], a[252:255], v[100:103]
    buffer_load_dwordx4 v[48:51], v186, s[48:51], s23 offen offset:3072
    v_mfma_f32_16x16x32_bf16 v[100:103], v[56:59], v[220:223], v[100:103]
    v_mfma_f32_16x16x32_bf16 v[100:103], v[60:63], v[224:227], v[100:103]
    s_waitcnt vmcnt(14)
    v_mfma_f32_16x16x32_bf16 v[88:91], v[64:67], a[48:51], v[88:91]
    v_mfma_f32_16x16x32_bf16 v[88:91], v[68:71], a[52:55], v[88:91]
    buffer_load_dwordx4 v[52:55], v187, s[48:51], s23 offen offset:0
    v_mfma_f32_16x16x32_bf16 v[88:91], v[72:75], a[56:59], v[88:91]
    v_mfma_f32_16x16x32_bf16 v[92:95], v[64:67], a[120:123], v[92:95]
    v_mfma_f32_16x16x32_bf16 v[92:95], v[68:71], a[124:127], v[92:95]
    v_mfma_f32_16x16x32_bf16 v[92:95], v[72:75], a[128:131], v[92:95]
    buffer_load_dwordx4 v[56:59], v187, s[48:51], s23 offen offset:1024
    v_mfma_f32_16x16x32_bf16 v[96:99], v[64:67], a[192:195], v[96:99]
    v_mfma_f32_16x16x32_bf16 v[96:99], v[68:71], a[196:199], v[96:99]
    v_mfma_f32_16x16x32_bf16 v[96:99], v[72:75], a[200:203], v[96:99]
    v_mfma_f32_16x16x32_bf16 v[100:103], v[64:67], v[228:231], v[100:103]
    buffer_load_dwordx4 v[60:63], v187, s[48:51], s23 offen offset:2048
    v_mfma_f32_16x16x32_bf16 v[100:103], v[68:71], v[232:235], v[100:103]
    v_mfma_f32_16x16x32_bf16 v[100:103], v[72:75], v[236:239], v[100:103]
    s_waitcnt vmcnt(14)
    v_mfma_f32_16x16x32_bf16 v[88:91], v[76:79], a[60:63], v[88:91]
    v_mfma_f32_16x16x32_bf16 v[88:91], v[80:83], a[64:67], v[88:91]
    buffer_load_dwordx4 v[64:67], v187, s[48:51], s23 offen offset:3072
    v_mfma_f32_16x16x32_bf16 v[120:123], v[84:87], a[68:71], v[88:91]
    v_mfma_f32_16x16x32_bf16 v[92:95], v[76:79], a[132:135], v[92:95]
    v_mfma_f32_16x16x32_bf16 v[92:95], v[80:83], a[136:139], v[92:95]
    v_mfma_f32_16x16x32_bf16 v[124:127], v[84:87], a[140:143], v[92:95]
    buffer_load_dwordx4 v[68:71], v188, s[48:51], s23 offen offset:0
    v_mfma_f32_16x16x32_bf16 v[96:99], v[76:79], a[204:207], v[96:99]
    s_lshl_b32 s7, s25, 8
    v_mfma_f32_16x16x32_bf16 v[96:99], v[80:83], a[208:211], v[96:99]
    s_add_u32 s27, s26, s7
    v_mfma_f32_16x16x32_bf16 v[128:131], v[84:87], a[212:215], v[96:99]
    v_mfma_f32_16x16x32_bf16 v[100:103], v[76:79], v[240:243], v[100:103]
    buffer_load_dwordx4 v[72:75], v188, s[48:51], s23 offen offset:1024
    v_mfma_f32_16x16x32_bf16 v[100:103], v[80:83], v[244:247], v[100:103]
    s_add_u32 s23, s23, 18432
    v_mfma_f32_16x16x32_bf16 v[132:135], v[84:87], v[248:251], v[100:103]
    s_add_u32 s25, s25, 1
    s_cmp_lt_u32 s25, 9
    s_cbranch_scc1 L_ffn_dn_14
    s_nop 7
    v_cvt_pk_bf16_f32 v152, v120, v121
    v_cvt_pk_bf16_f32 v153, v122, v123
    v_cvt_pk_bf16_f32 v154, v124, v125
    v_cvt_pk_bf16_f32 v155, v126, v127
    v_cvt_pk_bf16_f32 v156, v128, v129
    v_cvt_pk_bf16_f32 v157, v130, v131
    v_cvt_pk_bf16_f32 v158, v132, v133
    v_cvt_pk_bf16_f32 v159, v134, v135
    s_nop 1
    v_permlane16_swap_b32 v152, v154
    v_permlane16_swap_b32 v153, v155
    v_permlane16_swap_b32 v156, v158
    v_permlane16_swap_b32 v157, v159
    buffer_store_dwordx4 v[152:155], v2, s[8:11], s27 offen sc1
    buffer_store_dwordx4 v[156:159], v3, s[8:11], s27 offen sc1
    s_lshl_b32 s6, s40, 4
    s_lshl_b32 s7, s3, 2
    s_add_u32 s6, s6, s7
    s_add_u32 s6, s6, s44
    v_mov_b32 v1, 1
    s_waitcnt vmcnt(0)
    s_mov_b64 exec, 1
    s_add_u32 s6, s6, 8192
    buffer_store_dword v1, off, s[8:11], s6 sc1
    s_mov_b64 exec, -1
    s_mov_b32 s16, 0xffff0000
    s_lshl_b32 s7, s3, 10
    v_lshl_add_u32 v2, v0, 4, s7
    v_add_u32 v3, 4096, v2
    v_and_b32 v8, 7, v0
    v_mul_u32_u24 v8, 1152, v8
    v_lshrrev_b32 v9, 3, v0
    v_lshl_add_u32 v8, v9, 4, v8
    s_lshl_b32 s7, s3, 7
    v_add_u32 v5, s7, v8
    v_add_u32 v6, 512, v5
    s_cmp_eq_u32 s3, 0
    s_mov_b32 s17, 1073741824
    s_cmov_b32 s17, 8192
    v_add_u32 v4, s17, v2
    s_mov_b32 s17, 1073741824
    s_cmov_b32 s17, 1024
    v_add_u32 v7, s17, v5
    s_lshl_b32 s21, s41, 3
    s_add_u32 s21, s21, s40
    s_mul_i32 s18, s21, 9216
    s_add_u32 s19, s18, s43
    s_add_u32 s22, s19, 24641536
    s_mul_i32 s20, s21, 73728
    s_add_u32 s20, s20, s43
    s_add_u32 s20, s20, 29360128
    buffer_load_dwordx4 v[16:19], v2, s[8:11], s22 offen sc1
    buffer_load_dwordx4 v[20:23], v3, s[8:11], s22 offen sc1
    buffer_load_dwordx4 v[24:27], v4, s[8:11], s22 offen sc1
    v_and_b32 v15, 31, v0
    v_lshlrev_b32 v15, 2, v15
    s_add_u32 s7, s44, 8192
    s_mov_b32 s6, 0
L_poll_15:
    buffer_load_dword v1, v15, s[8:11], s7 offen sc1
    s_add_u32 s6, s6, 1
    s_waitcnt vmcnt(0)
    v_cmp_ne_u32 vcc, 0, v1
    s_cmp_eq_u64 vcc, exec
    s_cbranch_scc1 L_polled_16
    s_cmp_ge_u32 s6, 1048576
    s_cbranch_scc1 L_main_end
    s_sleep 1
    s_branch L_poll_15
L_polled_16:
    buffer_load_dwordx4 v[28:31], v2, s[8:11], s20 offen sc1
    buffer_load_dwordx4 v[32:35], v3, s[8:11], s20 offen sc1
    buffer_load_dwordx4 v[36:39], v4, s[8:11], s20 offen sc1
    s_add_u32 s20, s20, 9216
    buffer_load_dwordx4 v[40:43], v2, s[8:11], s20 offen sc1
    buffer_load_dwordx4 v[44:47], v3, s[8:11], s20 offen sc1
    buffer_load_dwordx4 v[48:51], v4, s[8:11], s20 offen sc1
    s_add_u32 s20, s20, 9216
    buffer_load_dwordx4 v[52:55], v2, s[8:11], s20 offen sc1
    buffer_load_dwordx4 v[56:59], v3, s[8:11], s20 offen sc1
    buffer_load_dwordx4 v[60:63], v4, s[8:11], s20 offen sc1
    s_add_u32 s20, s20, 9216
    buffer_load_dwordx4 v[64:67], v2, s[8:11], s20 offen sc1
    buffer_load_dwordx4 v[68:71], v3, s[8:11], s20 offen sc1
    buffer_load_dwordx4 v[72:75], v4, s[8:11], s20 offen sc1
    s_add_u32 s20, s20, 9216
    buffer_load_dwordx4 v[76:79], v2, s[8:11], s20 offen sc1
    buffer_load_dwordx4 v[80:83], v3, s[8:11], s20 offen sc1
    buffer_load_dwordx4 v[84:87], v4, s[8:11], s20 offen sc1
    s_add_u32 s20, s20, 9216
    buffer_load_dwordx4 v[88:91], v2, s[8:11], s20 offen sc1
    buffer_load_dwordx4 v[92:95], v3, s[8:11], s20 offen sc1
    buffer_load_dwordx4 v[96:99], v4, s[8:11], s20 offen sc1
    s_add_u32 s20, s20, 9216
    buffer_load_dwordx4 v[100:103], v2, s[8:11], s20 offen sc1
    buffer_load_dwordx4 v[104:107], v3, s[8:11], s20 offen sc1
    buffer_load_dwordx4 v[108:111], v4, s[8:11], s20 offen sc1
    s_add_u32 s20, s20, 9216
    buffer_load_dwordx4 v[112:115], v2, s[8:11], s20 offen sc1
    buffer_load_dwordx4 v[116:119], v3, s[8:11], s20 offen sc1
    buffer_load_dwordx4 v[120:123], v4, s[8:11], s20 offen sc1
    v_lshlrev_b32 v124, 16, v16
    v_and_b32 v125, s16, v16
    v_lshlrev_b32 v126, 16, v17
    v_and_b32 v127, s16, v17
    v_lshlrev_b32 v128, 16, v18
    v_and_b32 v129, s16, v18
    v_lshlrev_b32 v130, 16, v19
    v_and_b32 v131, s16, v19
    v_lshlrev_b32 v132, 16, v20
    v_and_b32 v133, s16, v20
    v_lshlrev_b32 v134, 16, v21
    v_and_b32 v135, s16, v21
    v_lshlrev_b32 v136, 16, v22
    v_and_b32 v137, s16, v22
    v_lshlrev_b32 v138, 16, v23
    v_and_b32 v139, s16, v23
    v_lshlrev_b32 v140, 16, v24
    v_and_b32 v141, s16, v24
    v_lshlrev_b32 v142, 16, v25
    v_and_b32 v143, s16, v25
    v_lshlrev_b32 v144, 16, v26
    v_and_b32 v145, s16, v26
    v_lshlrev_b32 v146, 16, v27
    v_and_b32 v147, s16, v27
    s_waitcnt vmcnt(23)
    v_lshlrev_b32 v148, 16, v28
    v_and_b32 v149, s16, v28
    v_lshlrev_b32 v150, 16, v29
    v_and_b32 v151, s16, v29
    v_lshlrev_b32 v152, 16, v30
    v_and_b32 v153, s16, v30
    v_lshlrev_b32 v154, 16, v31
    v_and_b32 v155, s16, v31
    v_pk_add_f32 v[124:125], v[124:125], v[148:149]
    v_pk_add_f32 v[126:127], v[126:127], v[150:151]
    v_pk_add_f32 v[128:129], v[128:129], v[152:153]
    v_pk_add_f32 v[130:131], v[130:131], v[154:155]
    s_waitcnt vmcnt(22)
    v_lshlrev_b32 v148, 16, v32
    v_and_b32 v149, s16, v32
    v_lshlrev_b32 v150, 16, v33
    v_and_b32 v151, s16, v33
    v_lshlrev_b32 v152, 16, v34
    v_and_b32 v153, s16, v34
    v_lshlrev_b32 v154, 16, v35
    v_and_b32 v155, s16, v35
    v_pk_add_f32 v[132:133], v[132:133], v[148:149]
    v_pk_add_f32 v[134:135], v[134:135], v[150:151]
    v_pk_add_f32 v[136:137], v[136:137], v[152:153]
    v_pk_add_f32 v[138:139], v[138:139], v[154:155]
    s_waitcnt vmcnt(21)
    v_lshlrev_b32 v148, 16, v36
    v_and_b32 v149, s16, v36
    v_lshlrev_b32 v150, 16, v37
    v_and_b32 v151, s16, v37
    v_lshlrev_b32 v152, 16, v38
    v_and_b32 v153, s16, v38
    v_lshlrev_b32 v154, 16, v39
    v_and_b32 v155, s16, v39
    v_pk_add_f32 v[140:141], v[140:141], v[148:149]
    v_pk_add_f32 v[142:143], v[142:143], v[150:151]
    v_pk_add_f32 v[144:145], v[144:145], v[152:153]
    v_pk_add_f32 v[146:147], v[146:147], v[154:155]
    s_waitcnt vmcnt(20)
    v_lshlrev_b32 v148, 16, v40
    v_and_b32 v149, s16, v40
    v_lshlrev_b32 v150, 16, v41
    v_and_b32 v151, s16, v41
    v_lshlrev_b32 v152, 16, v42
    v_and_b32 v153, s16, v42
    v_lshlrev_b32 v154, 16, v43
    v_and_b32 v155, s16, v43
    v_pk_add_f32 v[124:125], v[124:125], v[148:149]
    v_pk_add_f32 v[126:127], v[126:127], v[150:151]
    v_pk_add_f32 v[128:129], v[128:129], v[152:153]
    v_pk_add_f32 v[130:131], v[130:131], v[154:155]
    s_waitcnt vmcnt(19)
    v_lshlrev_b32 v148, 16, v44
    v_and_b32 v149, s16, v44
    v_lshlrev_b32 v150, 16, v45
    v_and_b32 v151, s16, v45
    v_lshlrev_b32 v152, 16, v46
    v_and_b32 v153, s16, v46
    v_lshlrev_b32 v154, 16, v47
    v_and_b32 v155, s16, v47
    v_pk_add_f32 v[132:133], v[132:133], v[148:149]
    v_pk_add_f32 v[134:135], v[134:135], v[150:151]
    v_pk_add_f32 v[136:137], v[136:137], v[152:153]
    v_pk_add_f32 v[138:139], v[138:139], v[154:155]
    s_waitcnt vmcnt(18)
    v_lshlrev_b32 v148, 16, v48
    v_and_b32 v149, s16, v48
    v_lshlrev_b32 v150, 16, v49
    v_and_b32 v151, s16, v49
    v_lshlrev_b32 v152, 16, v50
    v_and_b32 v153, s16, v50
    v_lshlrev_b32 v154, 16, v51
    v_and_b32 v155, s16, v51
    v_pk_add_f32 v[140:141], v[140:141], v[148:149]
    v_pk_add_f32 v[142:143], v[142:143], v[150:151]
    v_pk_add_f32 v[144:145], v[144:145], v[152:153]
    v_pk_add_f32 v[146:147], v[146:147], v[154:155]
    s_waitcnt vmcnt(17)
    v_lshlrev_b32 v148, 16, v52
    v_and_b32 v149, s16, v52
    v_lshlrev_b32 v150, 16, v53
    v_and_b32 v151, s16, v53
    v_lshlrev_b32 v152, 16, v54
    v_and_b32 v153, s16, v54
    v_lshlrev_b32 v154, 16, v55
    v_and_b32 v155, s16, v55
    v_pk_add_f32 v[124:125], v[124:125], v[148:149]
    v_pk_add_f32 v[126:127], v[126:127], v[150:151]
    v_pk_add_f32 v[128:129], v[128:129], v[152:153]
    v_pk_add_f32 v[130:131], v[130:131], v[154:155]
    s_waitcnt vmcnt(16)
    v_lshlrev_b32 v148, 16, v56
    v_and_b32 v149, s16, v56
    v_lshlrev_b32 v150, 16, v57
    v_and_b32 v151, s16, v57
    v_lshlrev_b32 v152, 16, v58
    v_and_b32 v153, s16, v58
    v_lshlrev_b32 v154, 16, v59
    v_and_b32 v155, s16, v59
    v_pk_add_f32 v[132:133], v[132:133], v[148:149]
    v_pk_add_f32 v[134:135], v[134:135], v[150:151]
    v_pk_add_f32 v[136:137], v[136:137], v[152:153]
    v_pk_add_f32 v[138:139], v[138:139], v[154:155]
    s_waitcnt vmcnt(15)
    v_lshlrev_b32 v148, 16, v60
    v_and_b32 v149, s16, v60
    v_lshlrev_b32 v150, 16, v61
    v_and_b32 v151, s16, v61
    v_lshlrev_b32 v152, 16, v62
    v_and_b32 v153, s16, v62
    v_lshlrev_b32 v154, 16, v63
    v_and_b32 v155, s16, v63
    v_pk_add_f32 v[140:141], v[140:141], v[148:149]
    v_pk_add_f32 v[142:143], v[142:143], v[150:151]
    v_pk_add_f32 v[144:145], v[144:145], v[152:153]
    v_pk_add_f32 v[146:147], v[146:147], v[154:155]
    s_waitcnt vmcnt(14)
    v_lshlrev_b32 v148, 16, v64
    v_and_b32 v149, s16, v64
    v_lshlrev_b32 v150, 16, v65
    v_and_b32 v151, s16, v65
    v_lshlrev_b32 v152, 16, v66
    v_and_b32 v153, s16, v66
    v_lshlrev_b32 v154, 16, v67
    v_and_b32 v155, s16, v67
    v_pk_add_f32 v[124:125], v[124:125], v[148:149]
    v_pk_add_f32 v[126:127], v[126:127], v[150:151]
    v_pk_add_f32 v[128:129], v[128:129], v[152:153]
    v_pk_add_f32 v[130:131], v[130:131], v[154:155]
    s_waitcnt vmcnt(13)
    v_lshlrev_b32 v148, 16, v68
    v_and_b32 v149, s16, v68
    v_lshlrev_b32 v150, 16, v69
    v_and_b32 v151, s16, v69
    v_lshlrev_b32 v152, 16, v70
    v_and_b32 v153, s16, v70
    v_lshlrev_b32 v154, 16, v71
    v_and_b32 v155, s16, v71
    v_pk_add_f32 v[132:133], v[132:133], v[148:149]
    v_pk_add_f32 v[134:135], v[134:135], v[150:151]
    v_pk_add_f32 v[136:137], v[136:137], v[152:153]
    v_pk_add_f32 v[138:139], v[138:139], v[154:155]
    s_waitcnt vmcnt(12)
    v_lshlrev_b32 v148, 16, v72
    v_and_b32 v149, s16, v72
    v_lshlrev_b32 v150, 16, v73
    v_and_b32 v151, s16, v73
    v_lshlrev_b32 v152, 16, v74
    v_and_b32 v153, s16, v74
    v_lshlrev_b32 v154, 16, v75
    v_and_b32 v155, s16, v75
    v_pk_add_f32 v[140:141], v[140:141], v[148:149]
    v_pk_add_f32 v[142:143], v[142:143], v[150:151]
    v_pk_add_f32 v[144:145], v[144:145], v[152:153]
    v_pk_add_f32 v[146:147], v[146:147], v[154:155]
    s_waitcnt vmcnt(11)
    v_lshlrev_b32 v148, 16, v76
    v_and_b32 v149, s16, v76
    v_lshlrev_b32 v150, 16, v77
    v_and_b32 v151, s16, v77
    v_lshlrev_b32 v152, 16, v78
    v_and_b32 v153, s16, v78
    v_lshlrev_b32 v154, 16, v79
    v_and_b32 v155, s16, v79
    v_pk_add_f32 v[124:125], v[124:125], v[148:149]
    v_pk_add_f32 v[126:127], v[126:127], v[150:151]
    v_pk_add_f32 v[128:129], v[128:129], v[152:153]
    v_pk_add_f32 v[130:131], v[130:131], v[154:155]
    s_waitcnt vmcnt(10)
    v_lshlrev_b32 v148, 16, v80
    v_and_b32 v149, s16, v80
    v_lshlrev_b32 v150, 16, v81
    v_and_b32 v151, s16, v81
    v_lshlrev_b32 v152, 16, v82
    v_and_b32 v153, s16, v82
    v_lshlrev_b32 v154, 16, v83
    v_and_b32 v155, s16, v83
    v_pk_add_f32 v[132:133], v[132:133], v[148:149]
    v_pk_add_f32 v[134:135], v[134:135], v[150:151]
    v_pk_add_f32 v[136:137], v[136:137], v[152:153]
    v_pk_add_f32 v[138:139], v[138:139], v[154:155]
    s_waitcnt vmcnt(9)
    v_lshlrev_b32 v148, 16, v84
    v_and_b32 v149, s16, v84
    v_lshlrev_b32 v150, 16, v85
    v_and_b32 v151, s16, v85
    v_lshlrev_b32 v152, 16, v86
    v_and_b32 v153, s16, v86
    v_lshlrev_b32 v154, 16, v87
    v_and_b32 v155, s16, v87
    v_pk_add_f32 v[140:141], v[140:141], v[148:149]
    v_pk_add_f32 v[142:143], v[142:143], v[150:151]
    v_pk_add_f32 v[144:145], v[144:145], v[152:153]
    v_pk_add_f32 v[146:147], v[146:147], v[154:155]
    s_waitcnt vmcnt(8)
    v_lshlrev_b32 v148, 16, v88
    v_and_b32 v149, s16, v88
    v_lshlrev_b32 v150, 16, v89
    v_and_b32 v151, s16, v89
    v_lshlrev_b32 v152, 16, v90
    v_and_b32 v153, s16, v90
    v_lshlrev_b32 v154, 16, v91
    v_and_b32 v155, s16, v91
    v_pk_add_f32 v[124:125], v[124:125], v[148:149]
    v_pk_add_f32 v[126:127], v[126:127], v[150:151]
    v_pk_add_f32 v[128:129], v[128:129], v[152:153]
    v_pk_add_f32 v[130:131], v[130:131], v[154:155]
    s_waitcnt vmcnt(7)
    v_lshlrev_b32 v148, 16, v92
    v_and_b32 v149, s16, v92
    v_lshlrev_b32 v150, 16, v93
    v_and_b32 v151, s16, v93
    v_lshlrev_b32 v152, 16, v94
    v_and_b32 v153, s16, v94
    v_lshlrev_b32 v154, 16, v95
    v_and_b32 v155, s16, v95
    v_pk_add_f32 v[132:133], v[132:133], v[148:149]
    v_pk_add_f32 v[134:135], v[134:135], v[150:151]
    v_pk_add_f32 v[136:137], v[136:137], v[152:153]
    v_pk_add_f32 v[138:139], v[138:139], v[154:155]
    s_waitcnt vmcnt(6)
    v_lshlrev_b32 v148, 16, v96
    v_and_b32 v149, s16, v96
    v_lshlrev_b32 v150, 16, v97
    v_and_b32 v151, s16, v97
    v_lshlrev_b32 v152, 16, v98
    v_and_b32 v153, s16, v98
    v_lshlrev_b32 v154, 16, v99
    v_and_b32 v155, s16, v99
    v_pk_add_f32 v[140:141], v[140:141], v[148:149]
    v_pk_add_f32 v[142:143], v[142:143], v[150:151]
    v_pk_add_f32 v[144:145], v[144:145], v[152:153]
    v_pk_add_f32 v[146:147], v[146:147], v[154:155]
    s_waitcnt vmcnt(5)
    v_lshlrev_b32 v148, 16, v100
    v_and_b32 v149, s16, v100
    v_lshlrev_b32 v150, 16, v101
    v_and_b32 v151, s16, v101
    v_lshlrev_b32 v152, 16, v102
    v_and_b32 v153, s16, v102
    v_lshlrev_b32 v154, 16, v103
    v_and_b32 v155, s16, v103
    v_pk_add_f32 v[124:125], v[124:125], v[148:149]
    v_pk_add_f32 v[126:127], v[126:127], v[150:151]
    v_pk_add_f32 v[128:129], v[128:129], v[152:153]
    v_pk_add_f32 v[130:131], v[130:131], v[154:155]
    s_waitcnt vmcnt(4)
    v_lshlrev_b32 v148, 16, v104
    v_and_b32 v149, s16, v104
    v_lshlrev_b32 v150, 16, v105
    v_and_b32 v151, s16, v105
    v_lshlrev_b32 v152, 16, v106
    v_and_b32 v153, s16, v106
    v_lshlrev_b32 v154, 16, v107
    v_and_b32 v155, s16, v107
    v_pk_add_f32 v[132:133], v[132:133], v[148:149]
    v_pk_add_f32 v[134:135], v[134:135], v[150:151]
    v_pk_add_f32 v[136:137], v[136:137], v[152:153]
    v_pk_add_f32 v[138:139], v[138:139], v[154:155]
    s_waitcnt vmcnt(3)
    v_lshlrev_b32 v148, 16, v108
    v_and_b32 v149, s16, v108
    v_lshlrev_b32 v150, 16, v109
    v_and_b32 v151, s16, v109
    v_lshlrev_b32 v152, 16, v110
    v_and_b32 v153, s16, v110
    v_lshlrev_b32 v154, 16, v111
    v_and_b32 v155, s16, v111
    v_pk_add_f32 v[140:141], v[140:141], v[148:149]
    v_pk_add_f32 v[142:143], v[142:143], v[150:151]
    v_pk_add_f32 v[144:145], v[144:145], v[152:153]
    v_pk_add_f32 v[146:147], v[146:147], v[154:155]
    s_waitcnt vmcnt(2)
    v_lshlrev_b32 v148, 16, v112
    v_and_b32 v149, s16, v112
    v_lshlrev_b32 v150, 16, v113
    v_and_b32 v151, s16, v113
    v_lshlrev_b32 v152, 16, v114
    v_and_b32 v153, s16, v114
    v_lshlrev_b32 v154, 16, v115
    v_and_b32 v155, s16, v115
    v_pk_add_f32 v[124:125], v[124:125], v[148:149]
    v_pk_add_f32 v[126:127], v[126:127], v[150:151]
    v_pk_add_f32 v[128:129], v[128:129], v[152:153]
    v_pk_add_f32 v[130:131], v[130:131], v[154:155]
    s_waitcnt vmcnt(1)
    v_lshlrev_b32 v148, 16, v116
    v_and_b32 v149, s16, v116
    v_lshlrev_b32 v150, 16, v117
    v_and_b32 v151, s16, v117
    v_lshlrev_b32 v152, 16, v118
    v_and_b32 v153, s16, v118
    v_lshlrev_b32 v154, 16, v119
    v_and_b32 v155, s16, v119
    v_pk_add_f32 v[132:133], v[132:133], v[148:149]
    v_pk_add_f32 v[134:135], v[134:135], v[150:151]
    v_pk_add_f32 v[136:137], v[136:137], v[152:153]
    v_pk_add_f32 v[138:139], v[138:139], v[154:155]
    s_waitcnt vmcnt(0)
    v_lshlrev_b32 v148, 16, v120
    v_and_b32 v149, s16, v120
    v_lshlrev_b32 v150, 16, v121
    v_and_b32 v151, s16, v121
    v_lshlrev_b32 v152, 16, v122
    v_and_b32 v153, s16, v122
    v_lshlrev_b32 v154, 16, v123
    v_and_b32 v155, s16, v123
    v_pk_add_f32 v[140:141], v[140:141], v[148:149]
    v_pk_add_f32 v[142:143], v[142:143], v[150:151]
    v_pk_add_f32 v[144:145], v[144:145], v[152:153]
    v_pk_add_f32 v[146:147], v[146:147], v[154:155]
    v_cvt_pk_bf16_f32 v156, v124, v125
    v_cvt_pk_bf16_f32 v157, v126, v127
    v_cvt_pk_bf16_f32 v158, v128, v129
    v_cvt_pk_bf16_f32 v159, v130, v131
    v_cvt_pk_bf16_f32 v160, v132, v133
    v_cvt_pk_bf16_f32 v161, v134, v135
    v_cvt_pk_bf16_f32 v162, v136, v137
    v_cvt_pk_bf16_f32 v163, v138, v139
    v_cvt_pk_bf16_f32 v164, v140, v141
    v_cvt_pk_bf16_f32 v165, v142, v143
    v_cvt_pk_bf16_f32 v166, v144, v145
    v_cvt_pk_bf16_f32 v167, v146, v147
    s_cmp_lg_u32 s42, 0
    s_cbranch_scc1 L_main_last
    s_add_u32 s19, s18, 56360960
    s_add_u32 s20, s18, 49283072
    buffer_store_dwordx4 v[156:159], v2, s[8:11], s19 offen sc1
    buffer_store_dwordx4 v[160:163], v3, s[8:11], s19 offen sc1
    buffer_store_dwordx4 v[164:167], v4, s[8:11], s19 offen sc1
    s_mov_b32 s17, 0x3f803f80
    v_mov_b32 v8, 0
    v_mov_b32 v9, 0
    v_mov_b32 v10, 0
    v_mov_b32 v11, 0
    v_dot2c_f32_bf16 v8, s17, v156
    v_dot2c_f32_bf16 v9, v156, v156
    v_dot2c_f32_bf16 v10, s17, v157
    v_dot2c_f32_bf16 v11, v157, v157
    v_dot2c_f32_bf16 v8, s17, v158
    v_dot2c_f32_bf16 v9, v158, v158
    v_dot2c_f32_bf16 v10, s17, v159
    v_dot2c_f32_bf16 v11, v159, v159
    v_dot2c_f32_bf16 v8, s17, v160
    v_dot2c_f32_bf16 v9, v160, v160
    v_dot2c_f32_bf16 v10, s17, v161
    v_dot2c_f32_bf16 v11, v161, v161
    v_dot2c_f32_bf16 v8, s17, v162
    v_dot2c_f32_bf16 v9, v162, v162
    v_dot2c_f32_bf16 v10, s17, v163
    v_dot2c_f32_bf16 v11, v163, v163
    v_dot2c_f32_bf16 v8, s17, v164
    v_dot2c_f32_bf16 v9, v164, v164
    v_dot2c_f32_bf16 v10, s17, v165
    v_dot2c_f32_bf16 v11, v165, v165
    v_dot2c_f32_bf16 v8, s17, v166
    v_dot2c_f32_bf16 v9, v166, v166
    v_dot2c_f32_bf16 v10, s17, v167
    v_dot2c_f32_bf16 v11, v167, v167
    v_and_b32 v12, 7, v0
    v_lshlrev_b32 v12, 3, v12
    s_lshl_b32 s7, s3, 6
    v_add_u32 v13, s7, v12
    v_pk_add_f32 v[8:9], v[8:9], v[10:11]
    s_nop 1
    v_add_f32_dpp v8, v8, v8 row_ror:8 row_mask:0xf bank_mask:0xf
    v_add_f32_dpp v9, v9, v9 row_ror:8 row_mask:0xf bank_mask:0xf
    v_mov_b32 v10, v8
    v_mov_b32 v11, v9
    s_nop 1
    v_permlane32_swap_b32 v10, v8
    v_permlane32_swap_b32 v11, v9
    v_add_f32 v8, v8, v10
    v_add_f32 v9, v9, v11
    v_mov_b32 v10, v8
    v_mov_b32 v11, v9
    s_nop 1
    v_permlane16_swap_b32 v10, v8
    v_permlane16_swap_b32 v11, v9
    v_add_f32 v8, v8, v10
    v_add_f32 v9, v9, v11
    ds_write_b64 v13, v[8:9]
    s_waitcnt lgkmcnt(0)
    s_barrier
    ds_read_b64 v[40:41], v12 offset:0
    ds_read_b64 v[42:43], v12 offset:64
    ds_read_b64 v[44:45], v12 offset:128
    ds_read_b64 v[46:47], v12 offset:192
    s_waitcnt lgkmcnt(0)
    v_pk_add_f32 v[40:41], v[40:41], v[42:43]
    v_pk_add_f32 v[44:45], v[44:45], v[46:47]
    v_pk_add_f32 v[8:9], v[40:41], v[44:45]
    v_mul_f32 v8, 0x3ae38e39, v8
    v_mul_f32 v9, 0x3ae38e39, v9
    v_fma_f32 v9, -v8, v8, v9
    v_max_f32 v9, 0, v9
    v_add_f32 v9, 0x3727c5ac, v9
    v_rsq_f32 v10, v9
    s_nop 0
    v_mul_f32 v12, v8, v10
    v_mov_b32 v11, v10
    v_sub_f32 v12, 0, v12
    v_mov_b32 v13, v12
    v_lshlrev_b32 v40, 16, v156
    v_and_b32 v41, s16, v156
    v_lshlrev_b32 v42, 16, v157
    v_and_b32 v43, s16, v157
    v_lshlrev_b32 v44, 16, v158
    v_and_b32 v45, s16, v158
    v_lshlrev_b32 v46, 16, v159
    v_and_b32 v47, s16, v159
    v_pk_fma_f32 v[40:41], v[40:41], v[10:11], v[12:13]
    v_pk_fma_f32 v[42:43], v[42:43], v[10:11], v[12:13]
    v_pk_fma_f32 v[44:45], v[44:45], v[10:11], v[12:13]
    v_pk_fma_f32 v[46:47], v[46:47], v[10:11], v[12:13]
    v_cvt_pk_bf16_f32 v48, v40, v41
    v_cvt_pk_bf16_f32 v49, v42, v43
    v_cvt_pk_bf16_f32 v50, v44, v45
    v_cvt_pk_bf16_f32 v51, v46, v47
    v_lshlrev_b32 v40, 16, v160
    v_and_b32 v41, s16, v160
    v_lshlrev_b32 v42, 16, v161
    v_and_b32 v43, s16, v161
    v_lshlrev_b32 v44, 16, v162
    v_and_b32 v45, s16, v162
    v_lshlrev_b32 v46, 16, v163
    v_and_b32 v47, s16, v163
    v_pk_fma_f32 v[40:41], v[40:41], v[10:11], v[12:13]
    v_pk_fma_f32 v[42:43], v[42:43], v[10:11], v[12:13]
    v_pk_fma_f32 v[44:45], v[44:45], v[10:11], v[12:13]
    v_pk_fma_f32 v[46:47], v[46:47], v[10:11], v[12:13]
    v_cvt_pk_bf16_f32 v52, v40, v41
    v_cvt_pk_bf16_f32 v53, v42, v43
    v_cvt_pk_bf16_f32 v54, v44, v45
    v_cvt_pk_bf16_f32 v55, v46, v47
    v_lshlrev_b32 v40, 16, v164
    v_and_b32 v41, s16, v164
    v_lshlrev_b32 v42, 16, v165
    v_and_b32 v43, s16, v165
    v_lshlrev_b32 v44, 16, v166
    v_and_b32 v45, s16, v166
    v_lshlrev_b32 v46, 16, v167
    v_and_b32 v47, s16, v167
    v_pk_fma_f32 v[40:41], v[40:41], v[10:11], v[12:13]
    v_pk_fma_f32 v[42:43], v[42:43], v[10:11], v[12:13]
    v_pk_fma_f32 v[44:45], v[44:45], v[10:11], v[12:13]
    v_pk_fma_f32 v[46:47], v[46:47], v[10:11], v[12:13]
    v_cvt_pk_bf16_f32 v56, v40, v41
    v_cvt_pk_bf16_f32 v57, v42, v43
    v_cvt_pk_bf16_f32 v58, v44, v45
    v_cvt_pk_bf16_f32 v59, v46, v47
    buffer_store_dwordx4 v[48:51], v2, s[8:11], s20 offen sc1
    buffer_store_dwordx4 v[52:55], v3, s[8:11], s20 offen sc1
    buffer_store_dwordx4 v[56:59], v4, s[8:11], s20 offen sc1
    s_lshl_b32 s6, s40, 4
    s_lshl_b32 s7, s3, 2
    s_add_u32 s6, s6, s7
    s_add_u32 s6, s6, s44
    v_mov_b32 v1, 1
    s_waitcnt vmcnt(0)
    s_mov_b64 exec, 1
    s_add_u32 s6, s6, 12288
    buffer_store_dword v1, off, s[8:11], s6 sc1
    s_mov_b64 exec, -1
    s_mov_b32 s42, 1
    s_mov_b32 s43, 29360128
    s_add_u32 s44, s44, 16384
    s_branch L_main_layer
L_main_last:
    buffer_store_dwordx4 v[156:159], v5, s[12:15], s18 offen
    buffer_store_dwordx4 v[160:163], v6, s[12:15], s18 offen
    buffer_store_dwordx4 v[164:167], v7, s[12:15], s18 offen
L_main_end:
    s_endpgm
.section .rodata,"a"
.p2align 6
.amdhsa_kernel prep_kernel
.amdhsa_next_free_vgpr 64
.amdhsa_next_free_sgpr 64
.amdhsa_accum_offset 64
.amdhsa_group_segment_fixed_size 0
.amdhsa_kernarg_size 80
.amdhsa_user_sgpr_count 2
.amdhsa_user_sgpr_kernarg_segment_ptr 1
.amdhsa_system_sgpr_workgroup_id_x 1
.amdhsa_float_denorm_mode_32 3
.amdhsa_float_denorm_mode_16_64 3
.end_amdhsa_kernel
.section .rodata,"a"
.p2align 6
.amdhsa_kernel main_kernel
.amdhsa_next_free_vgpr 512
.amdhsa_next_free_sgpr 64
.amdhsa_accum_offset 256
.amdhsa_group_segment_fixed_size 0
.amdhsa_kernarg_size 80
.amdhsa_user_sgpr_count 2
.amdhsa_user_sgpr_kernarg_segment_ptr 1
.amdhsa_system_sgpr_workgroup_id_x 1
.amdhsa_float_denorm_mode_32 3
.amdhsa_float_denorm_mode_16_64 3
.end_amdhsa_kernel
```

```asm
; @launch kernel=prep_kernel grid=(997,1,1) block=(256,1,1) lds=32768
; @launch kernel=main_kernel grid=(256,1,1) block=(256,1,1) lds=147456
.amdgcn_target "amdgcn-amd-amdhsa--gfx950"
.text
.globl prep_kernel
.p2align 8
.type prep_kernel,@function
prep_kernel:
    s_cmp_ge_u32 s2, 997
    s_cbranch_scc1 L_prep_end
    s_load_dwordx2 s[4:5], s[0:1], 72
    v_lshrrev_b32 v1, 6, v0
    v_and_b32 v0, 63, v0
    v_readfirstlane_b32 s3, v1
    s_waitcnt lgkmcnt(0)
    s_mov_b32 s8, s4
    s_and_b32 s9, s5, 0xffff
    s_mov_b32 s10, 268435456
    s_mov_b32 s11, 0x20000
    s_cmp_ge_u32 s2, 486
    s_cbranch_scc1 L_prep_q
    s_load_dwordx4 s[24:27], s[0:1], 32
    s_load_dwordx2 s[28:29], s[0:1], 48
    s_waitcnt lgkmcnt(0)
    s_mul_i32 s20, s2, 6473
    s_lshr_b32 s20, s20, 20
    s_mul_i32 s21, s20, 162
    s_sub_u32 s21, s2, s21
    s_cmp_eq_u32 s20, 1
    s_cselect_b32 s12, s26, s24
    s_cselect_b32 s13, s27, s25
    s_cmp_eq_u32 s20, 2
    s_cselect_b32 s12, s28, s12
    s_cselect_b32 s13, s29, s13
    s_and_b32 s13, s13, 0xffff
    s_mov_b32 s14, 5308416
    s_mov_b32 s15, 0x20000
    s_cmp_eq_u32 s20, 2
    s_mov_b32 s22, 9216
    s_cmov_b32 s22, 1152
    s_mov_b32 s23, 14564
    s_cmov_b32 s23, 116509
    s_cselect_b32 s30, 9, 72
    s_cselect_b32 s31, 2, 3
    s_mov_b32 s32, 512
    s_cmov_b32 s32, 2048
    s_lshl_b32 s21, s21, 2
    s_add_u32 s21, s21, s3
    s_mul_i32 s21, s21, 2
    v_lshrrev_b32 v2, 3, v0
    v_mul_lo_u32 v2, v2, s22
    v_and_b32 v3, 7, v0
    v_lshl_add_u32 v2, v3, 4, v2
    s_mul_i32 s33, s3, 8192
    s_lshl_b32 s34, s22, 3
    s_add_u32 s7, s21, 0
    s_mul_i32 s36, s7, s23
    s_lshr_b32 s36, s36, 20
    s_mul_i32 s37, s36, s30
    s_sub_u32 s37, s7, s37
    s_mul_i32 s7, s36, s34
    s_lshl_b32 s7, s7, 2
    s_lshl_b32 s35, s37, 7
    s_add_u32 s7, s7, s35
    s_add_u32 m0, s33, 0
    s_nop 0
    buffer_load_dwordx4 v2, s[12:15], s7 offen lds
    s_add_u32 m0, s33, 1024
    s_add_u32 s7, s7, s34
    buffer_load_dwordx4 v2, s[12:15], s7 offen lds
    s_add_u32 m0, s33, 2048
    s_add_u32 s7, s7, s34
    buffer_load_dwordx4 v2, s[12:15], s7 offen lds
    s_add_u32 m0, s33, 3072
    s_add_u32 s7, s7, s34
    buffer_load_dwordx4 v2, s[12:15], s7 offen lds
    s_add_u32 s7, s21, 1
    s_mul_i32 s38, s7, s23
    s_lshr_b32 s38, s38, 20
    s_mul_i32 s39, s38, s30
    s_sub_u32 s39, s7, s39
    s_mul_i32 s7, s38, s34
    s_lshl_b32 s7, s7, 2
    s_lshl_b32 s35, s39, 7
    s_add_u32 s7, s7, s35
    s_add_u32 m0, s33, 4096
    s_nop 0
    buffer_load_dwordx4 v2, s[12:15], s7 offen lds
    s_add_u32 m0, s33, 5120
    s_add_u32 s7, s7, s34
    buffer_load_dwordx4 v2, s[12:15], s7 offen lds
    s_add_u32 m0, s33, 6144
    s_add_u32 s7, s7, s34
    buffer_load_dwordx4 v2, s[12:15], s7 offen lds
    s_add_u32 m0, s33, 7168
    s_add_u32 s7, s7, s34
    buffer_load_dwordx4 v2, s[12:15], s7 offen lds
    v_lshrrev_b32 v3, 4, v0
    v_lshlrev_b32 v3, s31, v3
    v_bfe_u32 v4, v0, 2, 2
    v_add_u32 v3, v3, v4
    v_and_b32 v4, 3, v0
    v_lshlrev_b32 v4, 3, v4
    v_lshl_add_u32 v3, v3, 7, v4
    v_add_u32 v3, s33, v3
    v_add_u32 v4, s32, v3
    v_lshlrev_b32 v5, 4, v0
    s_cmp_eq_u32 s20, 2
    s_cbranch_scc1 L_swz_down_1
    s_mul_i32 s6, s37, 116509
    s_lshr_b32 s6, s6, 20
    s_mul_i32 s7, s6, 9
    s_sub_u32 s7, s37, s7
    s_mul_i32 s6, s6, 1990656
    s_mul_i32 s7, s7, 36
    s_mul_i32 s34, s36, 349526
    s_lshr_b32 s34, s34, 20
    s_mul_i32 s35, s34, 3
    s_sub_u32 s35, s36, s35
    s_mul_i32 s34, s34, 6
    s_add_u32 s7, s7, s34
    s_add_u32 s7, s7, s35
    s_mul_i32 s34, s20, 3
    s_add_u32 s7, s7, s34
    s_lshl_b32 s7, s7, 10
    s_add_u32 s6, s6, s7
    s_add_u32 s44, s6, 3145728
    s_add_u32 s45, s6, 3643392
    s_add_u32 s46, s6, 4141056
    s_add_u32 s47, s6, 4638720
    s_mul_i32 s6, s39, 116509
    s_lshr_b32 s6, s6, 20
    s_mul_i32 s7, s6, 9
    s_sub_u32 s7, s39, s7
    s_mul_i32 s6, s6, 1990656
    s_mul_i32 s7, s7, 36
    s_mul_i32 s34, s38, 349526
    s_lshr_b32 s34, s34, 20
    s_mul_i32 s35, s34, 3
    s_sub_u32 s35, s38, s35
    s_mul_i32 s34, s34, 6
    s_add_u32 s7, s7, s34
    s_add_u32 s7, s7, s35
    s_mul_i32 s34, s20, 3
    s_add_u32 s7, s7, s34
    s_lshl_b32 s7, s7, 10
    s_add_u32 s6, s6, s7
    s_add_u32 s48, s6, 3145728
    s_add_u32 s49, s6, 3643392
    s_add_u32 s50, s6, 4141056
    s_add_u32 s51, s6, 4638720
    s_branch L_swz_dest_2
L_swz_down_1:
    s_mul_i32 s6, s36, 58255
    s_lshr_b32 s6, s6, 20
    s_mul_i32 s7, s6, 18
    s_sub_u32 s7, s36, s7
    s_mul_i32 s6, s6, 1990656
    s_lshl_b32 s7, s7, 10
    s_add_u32 s6, s6, s7
    s_add_u32 s6, s6, 3477504
    s_lshl_b32 s7, s37, 2
    s_add_u32 s7, s7, 0
    s_mul_i32 s34, s7, 116509
    s_lshr_b32 s34, s34, 20
    s_mul_i32 s35, s34, 9
    s_sub_u32 s35, s7, s35
    s_mul_i32 s34, s34, 497664
    s_mul_i32 s35, s35, 18432
    s_add_u32 s34, s34, s35
    s_add_u32 s44, s6, s34
    s_lshl_b32 s7, s37, 2
    s_add_u32 s7, s7, 1
    s_mul_i32 s34, s7, 116509
    s_lshr_b32 s34, s34, 20
    s_mul_i32 s35, s34, 9
    s_sub_u32 s35, s7, s35
    s_mul_i32 s34, s34, 497664
    s_mul_i32 s35, s35, 18432
    s_add_u32 s34, s34, s35
    s_add_u32 s45, s6, s34
    s_lshl_b32 s7, s37, 2
    s_add_u32 s7, s7, 2
    s_mul_i32 s34, s7, 116509
    s_lshr_b32 s34, s34, 20
    s_mul_i32 s35, s34, 9
    s_sub_u32 s35, s7, s35
    s_mul_i32 s34, s34, 497664
    s_mul_i32 s35, s35, 18432
    s_add_u32 s34, s34, s35
    s_add_u32 s46, s6, s34
    s_lshl_b32 s7, s37, 2
    s_add_u32 s7, s7, 3
    s_mul_i32 s34, s7, 116509
    s_lshr_b32 s34, s34, 20
    s_mul_i32 s35, s34, 9
    s_sub_u32 s35, s7, s35
    s_mul_i32 s34, s34, 497664
    s_mul_i32 s35, s35, 18432
    s_add_u32 s34, s34, s35
    s_add_u32 s47, s6, s34
    s_mul_i32 s6, s38, 58255
    s_lshr_b32 s6, s6, 20
    s_mul_i32 s7, s6, 18
    s_sub_u32 s7, s38, s7
    s_mul_i32 s6, s6, 1990656
    s_lshl_b32 s7, s7, 10
    s_add_u32 s6, s6, s7
    s_add_u32 s6, s6, 3477504
    s_lshl_b32 s7, s39, 2
    s_add_u32 s7, s7, 0
    s_mul_i32 s34, s7, 116509
    s_lshr_b32 s34, s34, 20
    s_mul_i32 s35, s34, 9
    s_sub_u32 s35, s7, s35
    s_mul_i32 s34, s34, 497664
    s_mul_i32 s35, s35, 18432
    s_add_u32 s34, s34, s35
    s_add_u32 s48, s6, s34
    s_lshl_b32 s7, s39, 2
    s_add_u32 s7, s7, 1
    s_mul_i32 s34, s7, 116509
    s_lshr_b32 s34, s34, 20
    s_mul_i32 s35, s34, 9
    s_sub_u32 s35, s7, s35
    s_mul_i32 s34, s34, 497664
    s_mul_i32 s35, s35, 18432
    s_add_u32 s34, s34, s35
    s_add_u32 s49, s6, s34
    s_lshl_b32 s7, s39, 2
    s_add_u32 s7, s7, 2
    s_mul_i32 s34, s7, 116509
    s_lshr_b32 s34, s34, 20
    s_mul_i32 s35, s34, 9
    s_sub_u32 s35, s7, s35
    s_mul_i32 s34, s34, 497664
    s_mul_i32 s35, s35, 18432
    s_add_u32 s34, s34, s35
    s_add_u32 s50, s6, s34
    s_lshl_b32 s7, s39, 2
    s_add_u32 s7, s7, 3
    s_mul_i32 s34, s7, 116509
    s_lshr_b32 s34, s34, 20
    s_mul_i32 s35, s34, 9
    s_sub_u32 s35, s7, s35
    s_mul_i32 s34, s34, 497664
    s_mul_i32 s35, s35, 18432
    s_add_u32 s34, s34, s35
    s_add_u32 s51, s6, s34
L_swz_dest_2:
    s_waitcnt vmcnt(4)
    ds_read_b64_tr_b16 v[8:9], v3 offset:0
    ds_read_b64_tr_b16 v[10:11], v4 offset:0
    ds_read_b64_tr_b16 v[12:13], v3 offset:32
    ds_read_b64_tr_b16 v[14:15], v4 offset:32
    ds_read_b64_tr_b16 v[16:17], v3 offset:64
    ds_read_b64_tr_b16 v[18:19], v4 offset:64
    ds_read_b64_tr_b16 v[20:21], v3 offset:96
    ds_read_b64_tr_b16 v[22:23], v4 offset:96
    s_waitcnt lgkmcnt(6)
    buffer_store_dwordx4 v[8:11], v5, s[8:11], s44 offen
    s_waitcnt lgkmcnt(4)
    buffer_store_dwordx4 v[12:15], v5, s[8:11], s45 offen
    s_waitcnt lgkmcnt(2)
    buffer_store_dwordx4 v[16:19], v5, s[8:11], s46 offen
    s_waitcnt lgkmcnt(0)
    buffer_store_dwordx4 v[20:23], v5, s[8:11], s47 offen
    s_waitcnt vmcnt(4)
    ds_read_b64_tr_b16 v[24:25], v3 offset:4096
    ds_read_b64_tr_b16 v[26:27], v4 offset:4096
    ds_read_b64_tr_b16 v[28:29], v3 offset:4128
    ds_read_b64_tr_b16 v[30:31], v4 offset:4128
    ds_read_b64_tr_b16 v[32:33], v3 offset:4160
    ds_read_b64_tr_b16 v[34:35], v4 offset:4160
    ds_read_b64_tr_b16 v[36:37], v3 offset:4192
    ds_read_b64_tr_b16 v[38:39], v4 offset:4192
    s_waitcnt lgkmcnt(6)
    buffer_store_dwordx4 v[24:27], v5, s[8:11], s48 offen
    s_waitcnt lgkmcnt(4)
    buffer_store_dwordx4 v[28:31], v5, s[8:11], s49 offen
    s_waitcnt lgkmcnt(2)
    buffer_store_dwordx4 v[32:35], v5, s[8:11], s50 offen
    s_waitcnt lgkmcnt(0)
    buffer_store_dwordx4 v[36:39], v5, s[8:11], s51 offen
    s_branch L_prep_fin
L_prep_q:
    s_cmp_ge_u32 s2, 732
    s_cbranch_scc1 L_prep_ln
    s_load_dwordx2 s[24:25], s[0:1], 8
    s_load_dwordx2 s[26:27], s[0:1], 16
    s_waitcnt lgkmcnt(0)
    s_cmp_ge_u32 s2, 678
    s_cbranch_scc1 L_prep_o
    s_mov_b32 s12, s24
    s_and_b32 s13, s25, 0xffff
    s_mov_b32 s14, 1990656
    s_mov_b32 s15, 0x20000
    s_sub_u32 s20, s2, 486
    s_lshl_b32 s20, s20, 2
    s_add_u32 s20, s20, s3
    s_mul_i32 s20, s20, 3
    s_mul_i32 s21, s20, 14564
    s_lshr_b32 s21, s21, 20
    s_mul_i32 s22, s21, 72
    s_sub_u32 s22, s20, s22
    s_mul_i32 s21, s21, 36
    v_and_b32 v2, 15, v0
    v_lshrrev_b32 v3, 4, v0
    v_mul_u32_u24 v3, 27648, v3
    v_add_u32 v3, s21, v3
    v_lshlrev_b32 v5, 4, v0
    v_lshl_add_u32 v6, v2, 1, v3
    v_lshrrev_b32 v7, 1, v2
    v_mul_u32_u24 v7, 1152, v7
    v_and_b32 v8, 1, v2
    v_lshl_add_u32 v7, v8, 1, v7
    v_add3_u32 v7, v7, v3, 32
    v_mov_b32 v9, 1073741824
    v_cmp_gt_u32 vcc, 6, v2
    s_mov_b32 s31, 3456
    s_mov_b32 s32, 6912
    s_mov_b32 s33, 10368
    s_mov_b32 s34, 13824
    s_mov_b32 s35, 17280
    s_mov_b32 s36, 20736
    s_mov_b32 s37, 24192
    v_cndmask_b32 v7, v9, v7, vcc
    s_add_u32 s7, s22, 0
    s_and_b32 s6, s7, 3
    s_lshr_b32 s7, s7, 2
    s_mul_i32 s7, s7, 110592
    s_cmp_eq_u32 s6, 3
    s_cselect_b64 vcc, -1, 0
    s_mul_i32 s6, s6, 1152
    v_add_u32 v4, s6, v6
    v_cndmask_b32 v4, v4, v7, vcc
    v_add_u32 v10, s7, v4
    buffer_load_ushort v16, v10, s[12:15], 0 offen
    buffer_load_ushort v17, v10, s[12:15], s31 offen
    buffer_load_ushort v18, v10, s[12:15], s32 offen
    buffer_load_ushort v19, v10, s[12:15], s33 offen
    buffer_load_ushort v20, v10, s[12:15], s34 offen
    buffer_load_ushort v21, v10, s[12:15], s35 offen
    buffer_load_ushort v22, v10, s[12:15], s36 offen
    buffer_load_ushort v23, v10, s[12:15], s37 offen
    s_add_u32 s7, s22, 1
    s_and_b32 s6, s7, 3
    s_lshr_b32 s7, s7, 2
    s_mul_i32 s7, s7, 110592
    s_cmp_eq_u32 s6, 3
    s_cselect_b64 vcc, -1, 0
    s_mul_i32 s6, s6, 1152
    v_add_u32 v4, s6, v6
    v_cndmask_b32 v4, v4, v7, vcc
    v_add_u32 v11, s7, v4
    buffer_load_ushort v24, v11, s[12:15], 0 offen
    buffer_load_ushort v25, v11, s[12:15], s31 offen
    buffer_load_ushort v26, v11, s[12:15], s32 offen
    buffer_load_ushort v27, v11, s[12:15], s33 offen
    buffer_load_ushort v28, v11, s[12:15], s34 offen
    buffer_load_ushort v29, v11, s[12:15], s35 offen
    buffer_load_ushort v30, v11, s[12:15], s36 offen
    buffer_load_ushort v31, v11, s[12:15], s37 offen
    s_add_u32 s7, s22, 2
    s_and_b32 s6, s7, 3
    s_lshr_b32 s7, s7, 2
    s_mul_i32 s7, s7, 110592
    s_cmp_eq_u32 s6, 3
    s_cselect_b64 vcc, -1, 0
    s_mul_i32 s6, s6, 1152
    v_add_u32 v4, s6, v6
    v_cndmask_b32 v4, v4, v7, vcc
    v_add_u32 v12, s7, v4
    buffer_load_ushort v32, v12, s[12:15], 0 offen
    buffer_load_ushort v33, v12, s[12:15], s31 offen
    buffer_load_ushort v34, v12, s[12:15], s32 offen
    buffer_load_ushort v35, v12, s[12:15], s33 offen
    buffer_load_ushort v36, v12, s[12:15], s34 offen
    buffer_load_ushort v37, v12, s[12:15], s35 offen
    buffer_load_ushort v38, v12, s[12:15], s36 offen
    buffer_load_ushort v39, v12, s[12:15], s37 offen
    s_lshl_b32 s20, s20, 10
    s_add_u32 s20, s20, 0
    s_waitcnt vmcnt(16)
    v_lshl_or_b32 v44, v17, 16, v16
    v_lshl_or_b32 v45, v19, 16, v18
    v_lshl_or_b32 v46, v21, 16, v20
    v_lshl_or_b32 v47, v23, 16, v22
    buffer_store_dwordx4 v[44:47], v5, s[8:11], s20 offen offset:0
    s_waitcnt vmcnt(9)
    v_lshl_or_b32 v48, v25, 16, v24
    v_lshl_or_b32 v49, v27, 16, v26
    v_lshl_or_b32 v50, v29, 16, v28
    v_lshl_or_b32 v51, v31, 16, v30
    buffer_store_dwordx4 v[48:51], v5, s[8:11], s20 offen offset:1024
    s_waitcnt vmcnt(2)
    v_lshl_or_b32 v52, v33, 16, v32
    v_lshl_or_b32 v53, v35, 16, v34
    v_lshl_or_b32 v54, v37, 16, v36
    v_lshl_or_b32 v55, v39, 16, v38
    buffer_store_dwordx4 v[52:55], v5, s[8:11], s20 offen offset:2048
    s_branch L_prep_fin
L_prep_o:
    s_mov_b32 s12, s26
    s_and_b32 s13, s27, 0xffff
    s_mov_b32 s14, 663552
    s_mov_b32 s15, 0x20000
    s_sub_u32 s20, s2, 678
    s_lshl_b32 s20, s20, 2
    s_add_u32 s20, s20, s3
    s_mul_i32 s20, s20, 3
    s_mul_i32 s21, s20, 58255
    s_lshr_b32 s21, s21, 20
    s_mul_i32 s22, s21, 18
    s_sub_u32 s22, s20, s22
    s_lshl_b32 s21, s21, 5
    v_and_b32 v2, 15, v0
    v_lshl_add_u32 v2, v2, 1, s21
    v_lshrrev_b32 v3, 4, v0
    v_lshlrev_b32 v5, 4, v0
    s_movk_i32 s23, 1152
    s_add_u32 s7, s22, 0
    s_lshl_b32 s7, s7, 2
    v_add_u32 v4, s7, v3
    v_mul_u32_u24 v6, 7282, v4
    v_lshrrev_b32 v6, 16, v6
    v_mul_u32_u24 v7, 9, v6
    v_sub_u32 v7, v4, v7
    v_mul_u32_u24 v6, 72, v6
    v_cmp_eq_u32 vcc, 8, v7
    v_lshrrev_b32 v8, 1, v7
    v_mad_u32_u24 v8, v8, 18, v6
    v_and_b32 v7, 1, v7
    v_lshl_add_u32 v8, v7, 3, v8
    v_mad_u32_u24 v8, v8, s23, v2
    v_add_u32 v6, 16, v6
    v_mad_u32_u24 v6, v6, s23, v2
    v_add_u32 v9, 0, v8
    v_add_u32 v10, 0, v6
    v_cndmask_b32 v9, v9, v10, vcc
    buffer_load_ushort v16, v9, s[12:15], 0 offen
    v_add_u32 v9, 1152, v8
    v_add_u32 v10, 1152, v6
    v_cndmask_b32 v9, v9, v10, vcc
    buffer_load_ushort v17, v9, s[12:15], 0 offen
    v_add_u32 v9, 2304, v8
    v_add_u32 v10, 20736, v6
    v_cndmask_b32 v9, v9, v10, vcc
    buffer_load_ushort v18, v9, s[12:15], 0 offen
    v_add_u32 v9, 3456, v8
    v_add_u32 v10, 21888, v6
    v_cndmask_b32 v9, v9, v10, vcc
    buffer_load_ushort v19, v9, s[12:15], 0 offen
    v_add_u32 v9, 4608, v8
    v_add_u32 v10, 41472, v6
    v_cndmask_b32 v9, v9, v10, vcc
    buffer_load_ushort v20, v9, s[12:15], 0 offen
    v_add_u32 v9, 5760, v8
    v_add_u32 v10, 42624, v6
    v_cndmask_b32 v9, v9, v10, vcc
    buffer_load_ushort v21, v9, s[12:15], 0 offen
    v_add_u32 v9, 6912, v8
    v_add_u32 v10, 62208, v6
    v_cndmask_b32 v9, v9, v10, vcc
    buffer_load_ushort v22, v9, s[12:15], 0 offen
    v_add_u32 v9, 8064, v8
    v_add_u32 v10, 63360, v6
    v_cndmask_b32 v9, v9, v10, vcc
    buffer_load_ushort v23, v9, s[12:15], 0 offen
    s_add_u32 s7, s22, 1
    s_lshl_b32 s7, s7, 2
    v_add_u32 v4, s7, v3
    v_mul_u32_u24 v6, 7282, v4
    v_lshrrev_b32 v6, 16, v6
    v_mul_u32_u24 v7, 9, v6
    v_sub_u32 v7, v4, v7
    v_mul_u32_u24 v6, 72, v6
    v_cmp_eq_u32 vcc, 8, v7
    v_lshrrev_b32 v8, 1, v7
    v_mad_u32_u24 v8, v8, 18, v6
    v_and_b32 v7, 1, v7
    v_lshl_add_u32 v8, v7, 3, v8
    v_mad_u32_u24 v8, v8, s23, v2
    v_add_u32 v6, 16, v6
    v_mad_u32_u24 v6, v6, s23, v2
    v_add_u32 v9, 0, v8
    v_add_u32 v10, 0, v6
    v_cndmask_b32 v9, v9, v10, vcc
    buffer_load_ushort v24, v9, s[12:15], 0 offen
    v_add_u32 v9, 1152, v8
    v_add_u32 v10, 1152, v6
    v_cndmask_b32 v9, v9, v10, vcc
    buffer_load_ushort v25, v9, s[12:15], 0 offen
    v_add_u32 v9, 2304, v8
    v_add_u32 v10, 20736, v6
    v_cndmask_b32 v9, v9, v10, vcc
    buffer_load_ushort v26, v9, s[12:15], 0 offen
    v_add_u32 v9, 3456, v8
    v_add_u32 v10, 21888, v6
    v_cndmask_b32 v9, v9, v10, vcc
    buffer_load_ushort v27, v9, s[12:15], 0 offen
    v_add_u32 v9, 4608, v8
    v_add_u32 v10, 41472, v6
    v_cndmask_b32 v9, v9, v10, vcc
    buffer_load_ushort v28, v9, s[12:15], 0 offen
    v_add_u32 v9, 5760, v8
    v_add_u32 v10, 42624, v6
    v_cndmask_b32 v9, v9, v10, vcc
    buffer_load_ushort v29, v9, s[12:15], 0 offen
    v_add_u32 v9, 6912, v8
    v_add_u32 v10, 62208, v6
    v_cndmask_b32 v9, v9, v10, vcc
    buffer_load_ushort v30, v9, s[12:15], 0 offen
    v_add_u32 v9, 8064, v8
    v_add_u32 v10, 63360, v6
    v_cndmask_b32 v9, v9, v10, vcc
    buffer_load_ushort v31, v9, s[12:15], 0 offen
    s_add_u32 s7, s22, 2
    s_lshl_b32 s7, s7, 2
    v_add_u32 v4, s7, v3
    v_mul_u32_u24 v6, 7282, v4
    v_lshrrev_b32 v6, 16, v6
    v_mul_u32_u24 v7, 9, v6
    v_sub_u32 v7, v4, v7
    v_mul_u32_u24 v6, 72, v6
    v_cmp_eq_u32 vcc, 8, v7
    v_lshrrev_b32 v8, 1, v7
    v_mad_u32_u24 v8, v8, 18, v6
    v_and_b32 v7, 1, v7
    v_lshl_add_u32 v8, v7, 3, v8
    v_mad_u32_u24 v8, v8, s23, v2
    v_add_u32 v6, 16, v6
    v_mad_u32_u24 v6, v6, s23, v2
    v_add_u32 v9, 0, v8
    v_add_u32 v10, 0, v6
    v_cndmask_b32 v9, v9, v10, vcc
    buffer_load_ushort v32, v9, s[12:15], 0 offen
    v_add_u32 v9, 1152, v8
    v_add_u32 v10, 1152, v6
    v_cndmask_b32 v9, v9, v10, vcc
    buffer_load_ushort v33, v9, s[12:15], 0 offen
    v_add_u32 v9, 2304, v8
    v_add_u32 v10, 20736, v6
    v_cndmask_b32 v9, v9, v10, vcc
    buffer_load_ushort v34, v9, s[12:15], 0 offen
    v_add_u32 v9, 3456, v8
    v_add_u32 v10, 21888, v6
    v_cndmask_b32 v9, v9, v10, vcc
    buffer_load_ushort v35, v9, s[12:15], 0 offen
    v_add_u32 v9, 4608, v8
    v_add_u32 v10, 41472, v6
    v_cndmask_b32 v9, v9, v10, vcc
    buffer_load_ushort v36, v9, s[12:15], 0 offen
    v_add_u32 v9, 5760, v8
    v_add_u32 v10, 42624, v6
    v_cndmask_b32 v9, v9, v10, vcc
    buffer_load_ushort v37, v9, s[12:15], 0 offen
    v_add_u32 v9, 6912, v8
    v_add_u32 v10, 62208, v6
    v_cndmask_b32 v9, v9, v10, vcc
    buffer_load_ushort v38, v9, s[12:15], 0 offen
    v_add_u32 v9, 8064, v8
    v_add_u32 v10, 63360, v6
    v_cndmask_b32 v9, v9, v10, vcc
    buffer_load_ushort v39, v9, s[12:15], 0 offen
    s_lshl_b32 s20, s20, 10
    s_add_u32 s20, s20, 2359296
    s_waitcnt vmcnt(16)
    v_lshl_or_b32 v44, v17, 16, v16
    v_lshl_or_b32 v45, v19, 16, v18
    v_lshl_or_b32 v46, v21, 16, v20
    v_lshl_or_b32 v47, v23, 16, v22
    buffer_store_dwordx4 v[44:47], v5, s[8:11], s20 offen offset:0
    s_waitcnt vmcnt(9)
    v_lshl_or_b32 v48, v25, 16, v24
    v_lshl_or_b32 v49, v27, 16, v26
    v_lshl_or_b32 v50, v29, 16, v28
    v_lshl_or_b32 v51, v31, 16, v30
    buffer_store_dwordx4 v[48:51], v5, s[8:11], s20 offen offset:1024
    s_waitcnt vmcnt(2)
    v_lshl_or_b32 v52, v33, 16, v32
    v_lshl_or_b32 v53, v35, 16, v34
    v_lshl_or_b32 v54, v37, 16, v36
    v_lshl_or_b32 v55, v39, 16, v38
    buffer_store_dwordx4 v[52:55], v5, s[8:11], s20 offen offset:2048
    s_branch L_prep_fin
L_prep_ln:
    s_cmp_lt_u32 s2, 988
    s_cbranch_scc1 L_prep_ln0
    s_load_dwordx2 s[26:27], s[0:1], 16
    s_waitcnt lgkmcnt(0)
    s_mov_b32 s12, s26
    s_and_b32 s13, s27, 0xffff
    s_mov_b32 s14, 663552
    s_mov_b32 s15, 0x20000
    s_sub_u32 s21, s2, 988
    s_lshl_b32 s21, s21, 2
    s_add_u32 s21, s21, s3
    v_and_b32 v2, 15, v0
    v_lshrrev_b32 v3, 3, v2
    s_lshl_b32 s7, s21, 1
    v_add_u32 v4, s7, v3
    v_mul_u32_u24 v6, 7282, v4
    v_lshrrev_b32 v6, 16, v6
    v_mul_u32_u24 v7, 9, v6
    v_sub_u32 v7, v4, v7
    v_mul_u32_u24 v6, 72, v6
    v_cmp_eq_u32 vcc, 8, v7
    v_lshrrev_b32 v8, 1, v7
    v_mad_u32_u24 v8, v8, 18, v6
    v_and_b32 v7, 1, v7
    v_lshl_add_u32 v8, v7, 3, v8
    v_and_b32 v9, 7, v0
    v_add_u32 v8, v8, v9
    v_lshrrev_b32 v10, 1, v9
    v_mad_u32_u24 v6, v10, 18, v6
    v_and_b32 v10, 1, v9
    v_add3_u32 v6, v6, v10, 16
    v_cndmask_b32 v8, v8, v6, vcc
    v_mul_u32_u24 v8, 1152, v8
    v_lshrrev_b32 v3, 4, v0
    v_lshl_add_u32 v8, v3, 4, v8
    buffer_load_dwordx4 v[16:19], v8, s[12:15], 0 offen offset:0
    buffer_load_dwordx4 v[20:23], v8, s[12:15], 0 offen offset:64
    buffer_load_dwordx4 v[24:27], v8, s[12:15], 0 offen offset:128
    buffer_load_dwordx4 v[28:31], v8, s[12:15], 0 offen offset:192
    buffer_load_dwordx4 v[32:35], v8, s[12:15], 0 offen offset:256
    buffer_load_dwordx4 v[36:39], v8, s[12:15], 0 offen offset:320
    buffer_load_dwordx4 v[40:43], v8, s[12:15], 0 offen offset:384
    buffer_load_dwordx4 v[44:47], v8, s[12:15], 0 offen offset:448
    buffer_load_dwordx4 v[48:51], v8, s[12:15], 0 offen offset:512
    buffer_load_dwordx4 v[52:55], v8, s[12:15], 0 offen offset:576
    buffer_load_dwordx4 v[56:59], v8, s[12:15], 0 offen offset:640
    buffer_load_dwordx4 v[60:63], v8, s[12:15], 0 offen offset:704
    buffer_load_dwordx4 v[64:67], v8, s[12:15], 0 offen offset:768
    buffer_load_dwordx4 v[68:71], v8, s[12:15], 0 offen offset:832
    buffer_load_dwordx4 v[72:75], v8, s[12:15], 0 offen offset:896
    buffer_load_dwordx4 v[76:79], v8, s[12:15], 0 offen offset:960
    buffer_load_dwordx4 v[80:83], v8, s[12:15], 0 offen offset:1024
    buffer_load_dwordx4 v[84:87], v8, s[12:15], 0 offen offset:1088
    v_mov_b32 v12, 0x3f803f80
    v_mov_b32 v13, 0x3f803f80
    v_mov_b32 v14, 0x3f803f80
    v_mov_b32 v15, 0x3f803f80
    s_and_b32 s7, s21, 1
    s_lshl_b32 s7, s7, 9
    v_lshrrev_b32 v4, 1, v3
    v_lshlrev_b32 v4, 8, v4
    v_lshl_add_u32 v4, v2, 4, v4
    v_and_b32 v3, 1, v3
    v_lshl_add_u32 v4, v3, 3, v4
    v_add_u32 v4, s7, v4
    s_lshr_b32 s7, s21, 1
    s_lshl_b32 s7, s7, 10
    s_add_u32 s7, s7, 3022848
    s_waitcnt vmcnt(17)
    v_mfma_f32_16x16x32_bf16 v[8:11], v[16:19], v[12:15], 0
    s_waitcnt vmcnt(16)
    v_mfma_f32_16x16x32_bf16 v[8:11], v[20:23], v[12:15], v[8:11]
    s_waitcnt vmcnt(15)
    v_mfma_f32_16x16x32_bf16 v[8:11], v[24:27], v[12:15], v[8:11]
    s_waitcnt vmcnt(14)
    v_mfma_f32_16x16x32_bf16 v[8:11], v[28:31], v[12:15], v[8:11]
    s_waitcnt vmcnt(13)
    v_mfma_f32_16x16x32_bf16 v[8:11], v[32:35], v[12:15], v[8:11]
    s_waitcnt vmcnt(12)
    v_mfma_f32_16x16x32_bf16 v[8:11], v[36:39], v[12:15], v[8:11]
    s_waitcnt vmcnt(11)
    v_mfma_f32_16x16x32_bf16 v[8:11], v[40:43], v[12:15], v[8:11]
    s_waitcnt vmcnt(10)
    v_mfma_f32_16x16x32_bf16 v[8:11], v[44:47], v[12:15], v[8:11]
    s_waitcnt vmcnt(9)
    v_mfma_f32_16x16x32_bf16 v[8:11], v[48:51], v[12:15], v[8:11]
    s_waitcnt vmcnt(8)
    v_mfma_f32_16x16x32_bf16 v[8:11], v[52:55], v[12:15], v[8:11]
    s_waitcnt vmcnt(7)
    v_mfma_f32_16x16x32_bf16 v[8:11], v[56:59], v[12:15], v[8:11]
    s_waitcnt vmcnt(6)
    v_mfma_f32_16x16x32_bf16 v[8:11], v[60:63], v[12:15], v[8:11]
    s_waitcnt vmcnt(5)
    v_mfma_f32_16x16x32_bf16 v[8:11], v[64:67], v[12:15], v[8:11]
    s_waitcnt vmcnt(4)
    v_mfma_f32_16x16x32_bf16 v[8:11], v[68:71], v[12:15], v[8:11]
    s_waitcnt vmcnt(3)
    v_mfma_f32_16x16x32_bf16 v[8:11], v[72:75], v[12:15], v[8:11]
    s_waitcnt vmcnt(2)
    v_mfma_f32_16x16x32_bf16 v[8:11], v[76:79], v[12:15], v[8:11]
    s_waitcnt vmcnt(1)
    v_mfma_f32_16x16x32_bf16 v[8:11], v[80:83], v[12:15], v[8:11]
    s_waitcnt vmcnt(0)
    v_mfma_f32_16x16x32_bf16 v[8:11], v[84:87], v[12:15], v[8:11]
    v_cmp_eq_u32 vcc, 0, v2
    v_cmp_eq_u32 s[18:19], 1, v2
    s_nop 5
    v_mul_f32 v8, 0x3ae38e39, v8
    v_mul_f32 v9, 0x3ae38e39, v9
    v_mul_f32 v10, 0x3ae38e39, v10
    v_mul_f32 v11, 0x3ae38e39, v11
    v_cvt_pk_bf16_f32 v16, v8, v9
    v_cvt_pk_bf16_f32 v17, v10, v11
    v_lshlrev_b32 v18, 16, v16
    v_and_b32 v19, 0xffff0000, v16
    v_sub_f32 v18, v8, v18
    v_sub_f32 v19, v9, v19
    v_cvt_pk_bf16_f32 v20, v18, v19
    v_cndmask_b32 v20, 0, v20, s[18:19]
    v_cndmask_b32 v20, v20, v16, vcc
    v_lshlrev_b32 v18, 16, v17
    v_and_b32 v19, 0xffff0000, v17
    v_sub_f32 v18, v10, v18
    v_sub_f32 v19, v11, v19
    v_cvt_pk_bf16_f32 v21, v18, v19
    v_cndmask_b32 v21, 0, v21, s[18:19]
    v_cndmask_b32 v21, v21, v17, vcc
    buffer_store_dwordx2 v[20:21], v4, s[8:11], s7 offen
    s_branch L_prep_fin
L_prep_ln0:
    s_load_dwordx2 s[6:7], s[0:1], 0
    s_waitcnt lgkmcnt(0)
    s_mov_b32 s12, s6
    s_and_b32 s13, s7, 0xffff
    s_mov_b32 s14, 2359296
    s_mov_b32 s15, 0x20000
    s_sub_u32 s21, s2, 732
    s_mov_b32 s16, 0xffff0000
    s_lshl_b32 s7, s3, 10
    v_lshl_add_u32 v2, v0, 4, s7
    v_add_u32 v3, 4096, v2
    v_and_b32 v8, 7, v0
    v_mul_u32_u24 v8, 1152, v8
    v_lshrrev_b32 v9, 3, v0
    v_lshl_add_u32 v8, v9, 4, v8
    s_lshl_b32 s7, s3, 7
    v_add_u32 v5, s7, v8
    v_add_u32 v6, 512, v5
    s_cmp_eq_u32 s3, 0
    s_mov_b32 s17, 1073741824
    s_cmov_b32 s17, 8192
    v_add_u32 v4, s17, v2
    s_mov_b32 s17, 1073741824
    s_cmov_b32 s17, 1024
    v_add_u32 v7, s17, v5
    s_mul_i32 s18, s21, 9216
    buffer_load_dwordx4 v[16:19], v5, s[12:15], s18 offen
    buffer_load_dwordx4 v[20:23], v6, s[12:15], s18 offen
    buffer_load_dwordx4 v[24:27], v7, s[12:15], s18 offen
    v_mov_b32 v60, 0
    v_mov_b32 v61, 0
    v_mov_b32 v62, 0
    v_mov_b32 v63, 0
    s_lshl_b32 s19, s21, 10
    s_add_u32 s19, s19, 19136512
    v_lshlrev_b32 v14, 4, v0
    buffer_store_dwordx4 v[60:63], v14, s[8:11], s19 offen
    s_cmp_ge_u32 s21, 4
    s_cbranch_scc1 L_nopad_3
    s_and_b32 s19, s21, 1
    s_mul_i32 s19, s19, 9216
    s_lshr_b32 s20, s21, 1
    s_mul_i32 s20, s20, 33554432
    s_add_u32 s19, s19, s20
    s_add_u32 s19, s19, 19904512
    buffer_store_dwordx4 v[60:63], v2, s[8:11], s19 offen
    buffer_store_dwordx4 v[60:63], v3, s[8:11], s19 offen
    buffer_store_dwordx4 v[60:63], v4, s[8:11], s19 offen
L_nopad_3:
    s_add_u32 s19, s18, 27000832
    s_add_u32 s20, s18, 19922944
    s_lshl_b32 s22, s21, 7
    s_add_u32 s22, s22, 50593792
    s_waitcnt vmcnt(0)
    buffer_store_dwordx4 v[16:19], v2, s[8:11], s19 offen
    buffer_store_dwordx4 v[20:23], v3, s[8:11], s19 offen
    buffer_store_dwordx4 v[24:27], v4, s[8:11], s19 offen
    s_mov_b32 s17, 0x3f803f80
    v_mov_b32 v8, 0
    v_mov_b32 v9, 0
    v_mov_b32 v10, 0
    v_mov_b32 v11, 0
    v_dot2c_f32_bf16 v8, s17, v16
    v_dot2c_f32_bf16 v9, v16, v16
    v_dot2c_f32_bf16 v10, s17, v17
    v_dot2c_f32_bf16 v11, v17, v17
    v_dot2c_f32_bf16 v8, s17, v18
    v_dot2c_f32_bf16 v9, v18, v18
    v_dot2c_f32_bf16 v10, s17, v19
    v_dot2c_f32_bf16 v11, v19, v19
    v_dot2c_f32_bf16 v8, s17, v20
    v_dot2c_f32_bf16 v9, v20, v20
    v_dot2c_f32_bf16 v10, s17, v21
    v_dot2c_f32_bf16 v11, v21, v21
    v_dot2c_f32_bf16 v8, s17, v22
    v_dot2c_f32_bf16 v9, v22, v22
    v_dot2c_f32_bf16 v10, s17, v23
    v_dot2c_f32_bf16 v11, v23, v23
    v_dot2c_f32_bf16 v8, s17, v24
    v_dot2c_f32_bf16 v9, v24, v24
    v_dot2c_f32_bf16 v10, s17, v25
    v_dot2c_f32_bf16 v11, v25, v25
    v_dot2c_f32_bf16 v8, s17, v26
    v_dot2c_f32_bf16 v9, v26, v26
    v_dot2c_f32_bf16 v10, s17, v27
    v_dot2c_f32_bf16 v11, v27, v27
    v_and_b32 v12, 7, v0
    v_lshlrev_b32 v12, 3, v12
    s_lshl_b32 s7, s3, 6
    v_add_u32 v13, s7, v12
    v_pk_add_f32 v[8:9], v[8:9], v[10:11]
    s_nop 1
    v_add_f32_dpp v8, v8, v8 row_ror:8 row_mask:0xf bank_mask:0xf
    v_add_f32_dpp v9, v9, v9 row_ror:8 row_mask:0xf bank_mask:0xf
    v_mov_b32 v10, v8
    v_mov_b32 v11, v9
    s_nop 1
    v_permlane32_swap_b32 v10, v8
    v_permlane32_swap_b32 v11, v9
    v_add_f32 v8, v8, v10
    v_add_f32 v9, v9, v11
    v_mov_b32 v10, v8
    v_mov_b32 v11, v9
    s_nop 1
    v_permlane16_swap_b32 v10, v8
    v_permlane16_swap_b32 v11, v9
    v_add_f32 v8, v8, v10
    v_add_f32 v9, v9, v11
    ds_write_b64 v13, v[8:9]
    s_waitcnt lgkmcnt(0)
    s_barrier
    ds_read_b64 v[40:41], v12 offset:0
    ds_read_b64 v[42:43], v12 offset:64
    ds_read_b64 v[44:45], v12 offset:128
    ds_read_b64 v[46:47], v12 offset:192
    s_waitcnt lgkmcnt(0)
    v_pk_add_f32 v[40:41], v[40:41], v[42:43]
    v_pk_add_f32 v[44:45], v[44:45], v[46:47]
    v_pk_add_f32 v[8:9], v[40:41], v[44:45]
    v_mul_f32 v8, 0x3ae38e39, v8
    v_mul_f32 v9, 0x3ae38e39, v9
    v_fma_f32 v9, -v8, v8, v9
    v_max_f32 v9, 0, v9
    v_add_f32 v9, 0x3727c5ac, v9
    v_rsq_f32 v10, v9
    s_nop 0
    v_mul_f32 v12, v8, v10
    v_mov_b32 v11, v10
    v_sub_f32 v12, 0, v12
    v_mov_b32 v13, v12
    s_cmp_eq_u32 s3, 0
    s_cselect_b32 s7, 32, 0
    v_lshlrev_b32 v14, 2, v0
    v_cmp_gt_u32 vcc, s7, v0
    v_mov_b32 v9, 1073741824
    s_nop 0
    v_cndmask_b32 v14, v9, v14, vcc
    buffer_store_dword v8, v14, s[8:11], s22 offen
    v_lshlrev_b32 v40, 16, v16
    v_and_b32 v41, s16, v16
    v_lshlrev_b32 v42, 16, v17
    v_and_b32 v43, s16, v17
    v_lshlrev_b32 v44, 16, v18
    v_and_b32 v45, s16, v18
    v_lshlrev_b32 v46, 16, v19
    v_and_b32 v47, s16, v19
    v_pk_fma_f32 v[40:41], v[40:41], v[10:11], v[12:13]
    v_pk_fma_f32 v[42:43], v[42:43], v[10:11], v[12:13]
    v_pk_fma_f32 v[44:45], v[44:45], v[10:11], v[12:13]
    v_pk_fma_f32 v[46:47], v[46:47], v[10:11], v[12:13]
    v_cvt_pk_bf16_f32 v48, v40, v41
    v_cvt_pk_bf16_f32 v49, v42, v43
    v_cvt_pk_bf16_f32 v50, v44, v45
    v_cvt_pk_bf16_f32 v51, v46, v47
    v_lshlrev_b32 v40, 16, v20
    v_and_b32 v41, s16, v20
    v_lshlrev_b32 v42, 16, v21
    v_and_b32 v43, s16, v21
    v_lshlrev_b32 v44, 16, v22
    v_and_b32 v45, s16, v22
    v_lshlrev_b32 v46, 16, v23
    v_and_b32 v47, s16, v23
    v_pk_fma_f32 v[40:41], v[40:41], v[10:11], v[12:13]
    v_pk_fma_f32 v[42:43], v[42:43], v[10:11], v[12:13]
    v_pk_fma_f32 v[44:45], v[44:45], v[10:11], v[12:13]
    v_pk_fma_f32 v[46:47], v[46:47], v[10:11], v[12:13]
    v_cvt_pk_bf16_f32 v52, v40, v41
    v_cvt_pk_bf16_f32 v53, v42, v43
    v_cvt_pk_bf16_f32 v54, v44, v45
    v_cvt_pk_bf16_f32 v55, v46, v47
    v_lshlrev_b32 v40, 16, v24
    v_and_b32 v41, s16, v24
    v_lshlrev_b32 v42, 16, v25
    v_and_b32 v43, s16, v25
    v_lshlrev_b32 v44, 16, v26
    v_and_b32 v45, s16, v26
    v_lshlrev_b32 v46, 16, v27
    v_and_b32 v47, s16, v27
    v_pk_fma_f32 v[40:41], v[40:41], v[10:11], v[12:13]
    v_pk_fma_f32 v[42:43], v[42:43], v[10:11], v[12:13]
    v_pk_fma_f32 v[44:45], v[44:45], v[10:11], v[12:13]
    v_pk_fma_f32 v[46:47], v[46:47], v[10:11], v[12:13]
    v_cvt_pk_bf16_f32 v56, v40, v41
    v_cvt_pk_bf16_f32 v57, v42, v43
    v_cvt_pk_bf16_f32 v58, v44, v45
    v_cvt_pk_bf16_f32 v59, v46, v47
    buffer_store_dwordx4 v[48:51], v2, s[8:11], s20 offen
    buffer_store_dwordx4 v[52:55], v3, s[8:11], s20 offen
    buffer_store_dwordx4 v[56:59], v4, s[8:11], s20 offen
L_prep_fin:
L_prep_end:
    s_endpgm
.text
.globl main_kernel
.p2align 8
.type main_kernel,@function
main_kernel:
    s_cmp_ge_u32 s2, 256
    s_cbranch_scc1 L_main_end
    s_load_dwordx2 s[4:5], s[0:1], 72
    s_load_dwordx2 s[6:7], s[0:1], 56
    v_lshrrev_b32 v1, 6, v0
    v_and_b32 v0, 63, v0
    v_readfirstlane_b32 s3, v1
    s_waitcnt lgkmcnt(0)
    s_mov_b32 s8, s4
    s_and_b32 s9, s5, 0xffff
    s_mov_b32 s10, 268435456
    s_mov_b32 s11, 0x20000
    s_mov_b32 s12, s6
    s_and_b32 s13, s7, 0xffff
    s_mov_b32 s14, 2359296
    s_mov_b32 s15, 0x20000
    s_mov_b32 s48, s4
    s_and_b32 s49, s5, 0xffff
    s_mov_b32 s50, 268435456
    s_mov_b32 s51, 0x20000
    s_and_b32 s40, s2, 1
    s_lshl_b32 s40, s40, 2
    s_bfe_u32 s7, s2, 131075
    s_add_u32 s40, s40, s7
    s_bfe_u32 s41, s2, 131073
    s_lshl_b32 s41, s41, 3
    s_lshr_b32 s7, s2, 5
    s_add_u32 s41, s41, s7
    s_mov_b32 s42, 0
    s_mov_b32 s43, 0
    s_lshl_b32 s44, s41, 10
    s_add_u32 s44, s44, 19136512
    v_lshlrev_b32 v253, 4, v0
    s_lshl_b32 s28, s40, 2
    s_add_u32 s28, s28, s3
    s_mul_i32 s28, s28, 73728
    buffer_load_dwordx4 a[0:3], v253, s[8:11], s28 offen offset:0
    buffer_load_dwordx4 a[4:7], v253, s[8:11], s28 offen offset:1024
    buffer_load_dwordx4 a[8:11], v253, s[8:11], s28 offen offset:2048
    buffer_load_dwordx4 a[12:15], v253, s[8:11], s28 offen offset:3072
    s_add_u32 s28, s28, 4096
    buffer_load_dwordx4 a[16:19], v253, s[8:11], s28 offen offset:0
    buffer_load_dwordx4 a[20:23], v253, s[8:11], s28 offen offset:1024
    buffer_load_dwordx4 a[24:27], v253, s[8:11], s28 offen offset:2048
    buffer_load_dwordx4 a[28:31], v253, s[8:11], s28 offen offset:3072
    s_add_u32 s28, s28, 4096
    buffer_load_dwordx4 a[32:35], v253, s[8:11], s28 offen offset:0
    buffer_load_dwordx4 a[36:39], v253, s[8:11], s28 offen offset:1024
    buffer_load_dwordx4 a[40:43], v253, s[8:11], s28 offen offset:2048
    buffer_load_dwordx4 a[44:47], v253, s[8:11], s28 offen offset:3072
    s_add_u32 s28, s28, 4096
    buffer_load_dwordx4 a[48:51], v253, s[8:11], s28 offen offset:0
    buffer_load_dwordx4 a[52:55], v253, s[8:11], s28 offen offset:1024
    buffer_load_dwordx4 a[56:59], v253, s[8:11], s28 offen offset:2048
    buffer_load_dwordx4 a[60:63], v253, s[8:11], s28 offen offset:3072
    s_add_u32 s28, s28, 4096
    buffer_load_dwordx4 a[64:67], v253, s[8:11], s28 offen offset:0
    buffer_load_dwordx4 a[68:71], v253, s[8:11], s28 offen offset:1024
    buffer_load_dwordx4 a[72:75], v253, s[8:11], s28 offen offset:2048
    buffer_load_dwordx4 a[76:79], v253, s[8:11], s28 offen offset:3072
    s_add_u32 s28, s28, 4096
    buffer_load_dwordx4 a[80:83], v253, s[8:11], s28 offen offset:0
    buffer_load_dwordx4 a[84:87], v253, s[8:11], s28 offen offset:1024
    buffer_load_dwordx4 a[88:91], v253, s[8:11], s28 offen offset:2048
    buffer_load_dwordx4 a[92:95], v253, s[8:11], s28 offen offset:3072
    s_add_u32 s28, s28, 4096
L_main_layer:
    buffer_load_dwordx4 a[96:99], v253, s[8:11], s28 offen offset:0
    buffer_load_dwordx4 a[100:103], v253, s[8:11], s28 offen offset:1024
    buffer_load_dwordx4 a[104:107], v253, s[8:11], s28 offen offset:2048
    buffer_load_dwordx4 a[108:111], v253, s[8:11], s28 offen offset:3072
    s_add_u32 s28, s28, 4096
    buffer_load_dwordx4 a[112:115], v253, s[8:11], s28 offen offset:0
    buffer_load_dwordx4 a[116:119], v253, s[8:11], s28 offen offset:1024
    buffer_load_dwordx4 a[120:123], v253, s[8:11], s28 offen offset:2048
    buffer_load_dwordx4 a[124:127], v253, s[8:11], s28 offen offset:3072
    s_add_u32 s28, s28, 4096
    buffer_load_dwordx4 a[128:131], v253, s[8:11], s28 offen offset:0
    buffer_load_dwordx4 a[132:135], v253, s[8:11], s28 offen offset:1024
    buffer_load_dwordx4 a[136:139], v253, s[8:11], s28 offen offset:2048
    buffer_load_dwordx4 a[140:143], v253, s[8:11], s28 offen offset:3072
    s_add_u32 s28, s28, 4096
    v_bfe_u32 v3, v0, 3, 1
    v_mul_u32_u24 v2, 9216, v3
    v_lshrrev_b32 v3, 4, v0
    v_lshl_add_u32 v2, v3, 7, v2
    v_and_b32 v3, 7, v0
    v_lshl_add_u32 v2, v3, 4, v2
    v_bfe_u32 v3, v0, 3, 2
    s_mov_b32 s7, 9216
    v_mul_lo_u32 v9, v3, s7
    v_lshrrev_b32 v3, 5, v0
    v_lshl_add_u32 v9, v3, 7, v9
    v_and_b32 v3, 7, v0
    v_lshl_add_u32 v9, v3, 4, v9
    s_mul_i32 s22, s41, 73728
    s_add_u32 s22, s22, s43
    s_add_u32 s23, s22, 19904512
    s_mul_i32 s7, s3, 18432
    s_add_u32 s24, s23, s7
    s_add_u32 s24, s24, 18432
    s_lshl_b32 s25, s3, 10
    s_add_u32 s25, s25, 1024
    s_mul_i32 s26, s3, 5120
    s_lshl_b32 s7, s3, 9
    s_add_u32 s27, s23, s7
    s_and_b32 s7, s3, 1
    s_add_u32 s7, s7, 4
    s_mul_i32 s29, s7, 5120
    s_lshl_b32 s7, s7, 9
    s_add_u32 s23, s23, s7
    s_cmp_eq_u32 s42, 0
    s_cbranch_scc1 L_qkv_go_4
    s_cmp_lg_u32 s3, 0
    s_cbranch_scc1 L_polled_6
    s_lshl_b32 s7, s40, 7
    s_add_u32 s7, s7, s44
    s_sub_u32 s7, s7, 32768
    s_add_u32 s52, s4, s7
    s_addc_u32 s53, s5, 0
    s_cmp_eq_u32 s41, 0
    s_cselect_b32 s7, 0, 32
    s_mov_b32 s6, 0
L_poll_5:
    s_load_dwordx8 s[56:63], s[52:53], 0 glc
    s_load_dwordx2 s[54:55], s[52:53], s7 glc
    s_add_u32 s6, s6, 1
    s_waitcnt lgkmcnt(0)
    s_and_b64 s[56:57], s[56:57], s[58:59]
    s_and_b64 s[60:61], s[60:61], s[62:63]
    s_and_b64 s[56:57], s[56:57], s[60:61]
    s_and_b64 s[56:57], s[56:57], s[54:55]
    s_and_b32 s56, s56, s57
    s_cbranch_scc1 L_polled_6
    s_cmp_ge_u32 s6, 1048576
    s_cbranch_scc1 L_main_end
    s_branch L_poll_5
L_polled_6:
    s_barrier
L_qkv_go_4:
    s_add_u32 m0, s25, 0
    s_nop 0
    buffer_load_dwordx4 v2, s[8:11], s24 offen offset:0 sc1 lds
    s_add_u32 m0, s25, 4608
    s_nop 0
    buffer_load_dwordx4 v2, s[8:11], s24 offen offset:512 sc1 lds
    s_add_u32 m0, s25, 9216
    s_nop 0
    buffer_load_dwordx4 v2, s[8:11], s24 offen offset:1024 sc1 lds
    s_add_u32 m0, s25, 13824
    s_nop 0
    buffer_load_dwordx4 v2, s[8:11], s24 offen offset:1536 sc1 lds
    s_add_u32 m0, s25, 18432
    s_nop 0
    buffer_load_dwordx4 v2, s[8:11], s24 offen offset:2048 sc1 lds
    s_add_u32 m0, s25, 23040
    s_nop 0
    buffer_load_dwordx4 v2, s[8:11], s24 offen offset:2560 sc1 lds
    s_add_u32 m0, s26, 0
    s_add_u32 s7, s27, 0
    buffer_load_dwordx4 v2, s[8:11], s7 offen sc1 lds
    s_add_u32 m0, s29, 0
    s_add_u32 s7, s23, 0
    buffer_load_dwordx4 v2, s[8:11], s7 offen sc1 lds
    v_mov_b32 v132, 0
    v_mov_b32 v133, 0
    v_mov_b32 v192, 0
    v_mov_b32 v193, 0
    v_mov_b32 v195, 0
    v_mov_b32 v135, 0
    v_mov_b32 v139, 0
    v_mov_b32 v143, 0
    v_mov_b32 v147, 0
    v_mov_b32 v151, 0
    v_mov_b32 v155, 0
    v_mov_b32 v159, 0
    v_mov_b32 v163, 0
    v_mov_b32 v167, 0
    v_mov_b32 v171, 0
    v_cmp_eq_u32 vcc, 16, v0
    v_mov_b32 v10, 0x3f80
    v_cmp_eq_u32 s[20:21], 17, v0
    v_cndmask_b32 v194, 0, v10, vcc
    v_and_b32 v11, 3, v0
    v_cndmask_b32 v194, v194, 1.0, s[20:21]
    v_cmp_eq_u32 vcc, 2, v11
    v_and_b32 v10, 15, v0
    v_lshrrev_b32 v11, 4, v0
    v_cndmask_b32 v196, 0, 1.0, vcc
    v_cndmask_b32 v197, 0, 1.0, vcc
    v_cndmask_b32 v198, 0, 1.0, vcc
    v_cndmask_b32 v199, 0, 1.0, vcc
    v_lshlrev_b32 v11, 2, v11
    v_sub_u32 v10, v11, v10
    v_mov_b32 v12, 0xf149f2ca
    s_cmp_eq_u32 s41, 0
    s_cselect_b64 s[38:39], 0, -1
    v_add_u32 v11, 0, v10
    v_and_b32 v13, 1, v11
    v_cmp_eq_u32 s[20:21], 0, v13
    v_cmp_lt_i32 vcc, 1, v11
    v_cmp_gt_i32 s[18:19], 1, v11
    s_and_b64 vcc, vcc, s[20:21]
    s_and_b64 s[18:19], s[18:19], s[20:21]
    s_and_b64 s[20:21], vcc, s[38:39]
    v_cndmask_b32 v200, v12, 0, vcc
    v_cndmask_b32 v204, v12, 0, s[18:19]
    v_cndmask_b32 v208, v12, 0, s[20:21]
    v_add_u32 v11, 1, v10
    v_and_b32 v13, 1, v11
    v_cmp_eq_u32 s[20:21], 0, v13
    v_cmp_lt_i32 vcc, 1, v11
    v_cmp_gt_i32 s[18:19], 1, v11
    s_and_b64 vcc, vcc, s[20:21]
    s_and_b64 s[18:19], s[18:19], s[20:21]
    s_and_b64 s[20:21], vcc, s[38:39]
    v_cndmask_b32 v201, v12, 0, vcc
    v_cndmask_b32 v205, v12, 0, s[18:19]
    v_cndmask_b32 v209, v12, 0, s[20:21]
    v_add_u32 v11, 2, v10
    v_and_b32 v13, 1, v11
    v_cmp_eq_u32 s[20:21], 0, v13
    v_cmp_lt_i32 vcc, 1, v11
    v_cmp_gt_i32 s[18:19], 1, v11
    s_and_b64 vcc, vcc, s[20:21]
    s_and_b64 s[18:19], s[18:19], s[20:21]
    s_and_b64 s[20:21], vcc, s[38:39]
    v_cndmask_b32 v202, v12, 0, vcc
    v_cndmask_b32 v206, v12, 0, s[18:19]
    v_cndmask_b32 v210, v12, 0, s[20:21]
    v_add_u32 v11, 3, v10
    v_and_b32 v13, 1, v11
    v_cmp_eq_u32 s[20:21], 0, v13
    v_cmp_lt_i32 vcc, 1, v11
    v_cmp_gt_i32 s[18:19], 1, v11
    s_and_b64 vcc, vcc, s[20:21]
    s_and_b64 s[18:19], s[18:19], s[20:21]
    s_and_b64 s[20:21], vcc, s[38:39]
    v_cndmask_b32 v203, v12, 0, vcc
    v_cndmask_b32 v207, v12, 0, s[18:19]
    v_cndmask_b32 v211, v12, 0, s[20:21]
    s_lshl_b32 s45, s41, 1
    s_lshr_b32 s7, s40, 2
    s_add_u32 s45, s45, s7
    s_mul_i32 s30, s45, 36864
    s_add_u32 s30, s30, s43
    s_and_b32 s31, s40, 3
    s_mul_i32 s31, s31, 9
    s_add_u32 s31, s31, s3
    s_mul_i32 s32, s31, 18432
    s_add_u32 s32, s32, 2359296
    s_add_u32 s33, s32, 73728
    s_add_u32 s34, s32, 147456
    s_cmp_eq_u32 s3, 1
    s_cmov_b32 s34, 3022848
    s_cmp_lt_u32 s3, 2
    s_cselect_b32 s35, 0, 1073741824
    v_add_u32 v5, s35, v253
    s_cmp_eq_u32 s3, 0
    s_cselect_b32 s35, 0, 1073741824
    v_add_u32 v7, s35, v9
    s_lshl_b32 s7, s31, 8
    s_add_u32 s36, s30, s7
    s_add_u32 s37, s36, 27000832
    s_add_u32 s46, s36, 48234496
    s_lshl_b32 s36, s45, 7
    s_add_u32 s36, s36, s43
    s_add_u32 s36, s36, 24641536
    s_lshl_b32 s47, s45, 9
    s_add_u32 s47, s47, s43
    s_add_u32 s47, s47, 50593792
    v_bfe_u32 v10, v0, 3, 2
    v_and_b32 v8, 7, v0
    v_lshlrev_b32 v8, 2, v8
    v_lshl_add_u32 v8, v10, 7, v8
    v_add_u32 v6, 46080, v253
    s_waitcnt vmcnt(0)
    s_barrier
    ds_read_b128 v[16:19], v253 offset:0
    ds_read_b128 v[20:23], v253 offset:1024
    ds_read_b128 v[24:27], v253 offset:2048
    ds_read_b128 v[28:31], v253 offset:3072
    ds_read_b128 v[32:35], v253 offset:4096
    s_waitcnt lgkmcnt(0)
    v_mfma_f32_16x16x32_bf16 v[56:59], a[0:3], v[20:23], 0
    ds_read_b128 v[36:39], v253 offset:5120
    v_mfma_f32_16x16x32_bf16 v[60:63], a[0:3], v[24:27], 0
    ds_read_b128 v[40:43], v253 offset:6144
    v_mfma_f32_16x16x32_bf16 v[64:67], a[0:3], v[28:31], 0
    ds_read_b128 v[44:47], v253 offset:7168
    v_mfma_f32_16x16x32_bf16 v[68:71], a[0:3], v[32:35], 0
    ds_read_b128 v[48:51], v253 offset:8192
    v_mfma_f32_16x16x32_bf16 v[72:75], a[4:7], v[16:19], 0
    ds_read_b128 v[52:55], v253 offset:9216
    v_mfma_f32_16x16x32_bf16 v[76:79], a[4:7], v[20:23], 0
    s_add_u32 m0, s25, 27648
    s_nop 0
    buffer_load_dwordx4 v2, s[8:11], s24 offen offset:3072 sc1 lds
    v_mfma_f32_16x16x32_bf16 v[80:83], a[4:7], v[24:27], 0
    v_mfma_f32_16x16x32_bf16 v[84:87], a[4:7], v[28:31], 0
    s_add_u32 m0, s25, 32256
    s_nop 0
    buffer_load_dwordx4 v2, s[8:11], s24 offen offset:3584 sc1 lds
    v_mfma_f32_16x16x32_bf16 v[88:91], a[4:7], v[32:35], 0
    v_mfma_f32_16x16x32_bf16 v[92:95], v[16:19], a[8:11], 0
    buffer_load_dwordx4 a[144:147], v253, s[8:11], s28 offen offset:0
    v_mfma_f32_16x16x32_bf16 v[96:99], v[20:23], a[8:11], 0
    v_mfma_f32_16x16x32_bf16 v[100:103], v[24:27], a[8:11], 0
    buffer_load_dwordx4 a[148:151], v253, s[8:11], s28 offen offset:1024
    v_mfma_f32_16x16x32_bf16 v[104:107], v[28:31], a[8:11], 0
    v_mfma_f32_16x16x32_bf16 v[108:111], v[32:35], a[8:11], 0
    buffer_load_dwordx4 a[152:155], v253, s[8:11], s28 offen offset:2048
    v_mfma_f32_16x16x32_bf16 v[112:115], a[12:15], v[16:19], 0
    v_mfma_f32_16x16x32_bf16 v[116:119], a[12:15], v[20:23], 0
    buffer_load_dwordx4 a[156:159], v253, s[8:11], s28 offen offset:3072
    v_mfma_f32_16x16x32_bf16 v[120:123], a[12:15], v[24:27], 0
    v_mfma_f32_16x16x32_bf16 v[124:127], a[12:15], v[28:31], 0
    s_add_u32 s28, s28, 4096
    v_mfma_f32_16x16x32_bf16 v[128:131], a[12:15], v[32:35], 0
    s_waitcnt lgkmcnt(0)
    v_mfma_f32_16x16x32_bf16 v[56:59], a[16:19], v[40:43], v[56:59]
    ds_read_b128 v[16:19], v253 offset:10240
    v_mfma_f32_16x16x32_bf16 v[60:63], a[16:19], v[44:47], v[60:63]
    ds_read_b128 v[20:23], v253 offset:11264
    v_mfma_f32_16x16x32_bf16 v[64:67], a[16:19], v[48:51], v[64:67]
    ds_read_b128 v[24:27], v253 offset:12288
    v_mfma_f32_16x16x32_bf16 v[68:71], a[16:19], v[52:55], v[68:71]
    ds_read_b128 v[28:31], v253 offset:13312
    v_mfma_f32_16x16x32_bf16 v[72:75], a[20:23], v[36:39], v[72:75]
    ds_read_b128 v[32:35], v253 offset:14336
    v_mfma_f32_16x16x32_bf16 v[76:79], a[20:23], v[40:43], v[76:79]
    s_add_u32 m0, s25, 40960
    s_add_u32 s24, s24, 4096
    buffer_load_dwordx4 v2, s[8:11], s24 offen offset:0 sc1 lds
    v_mfma_f32_16x16x32_bf16 v[80:83], a[20:23], v[44:47], v[80:83]
    v_mfma_f32_16x16x32_bf16 v[84:87], a[20:23], v[48:51], v[84:87]
    s_add_u32 m0, s25, 45568
    s_nop 0
    buffer_load_dwordx4 v2, s[8:11], s24 offen offset:512 sc1 lds
    v_mfma_f32_16x16x32_bf16 v[88:91], a[20:23], v[52:55], v[88:91]
    v_mfma_f32_16x16x32_bf16 v[92:95], v[36:39], a[24:27], v[92:95]
    buffer_load_dwordx4 a[0:3], v253, s[8:11], s28 offen offset:0
    v_mfma_f32_16x16x32_bf16 v[96:99], v[40:43], a[24:27], v[96:99]
    v_mfma_f32_16x16x32_bf16 v[100:103], v[44:47], a[24:27], v[100:103]
    buffer_load_dwordx4 a[4:7], v253, s[8:11], s28 offen offset:1024
    v_mfma_f32_16x16x32_bf16 v[104:107], v[48:51], a[24:27], v[104:107]
    v_mfma_f32_16x16x32_bf16 v[108:111], v[52:55], a[24:27], v[108:111]
    buffer_load_dwordx4 a[8:11], v253, s[8:11], s28 offen offset:2048
    v_mfma_f32_16x16x32_bf16 v[112:115], a[28:31], v[36:39], v[112:115]
    v_mfma_f32_16x16x32_bf16 v[116:119], a[28:31], v[40:43], v[116:119]
    buffer_load_dwordx4 a[12:15], v253, s[8:11], s28 offen offset:3072
    v_mfma_f32_16x16x32_bf16 v[120:123], a[28:31], v[44:47], v[120:123]
    v_mfma_f32_16x16x32_bf16 v[124:127], a[28:31], v[48:51], v[124:127]
    s_add_u32 s28, s28, 4096
    v_mfma_f32_16x16x32_bf16 v[128:131], a[28:31], v[52:55], v[128:131]
    s_waitcnt lgkmcnt(0)
    v_mfma_f32_16x16x32_bf16 v[56:59], a[32:35], v[20:23], v[56:59]
    ds_read_b128 v[36:39], v253 offset:15360
    v_mfma_f32_16x16x32_bf16 v[60:63], a[32:35], v[24:27], v[60:63]
    ds_read_b128 v[40:43], v253 offset:16384
    v_mfma_f32_16x16x32_bf16 v[64:67], a[32:35], v[28:31], v[64:67]
    ds_read_b128 v[44:47], v253 offset:17408
    v_mfma_f32_16x16x32_bf16 v[68:71], a[32:35], v[32:35], v[68:71]
    ds_read_b128 v[48:51], v253 offset:18432
    v_mfma_f32_16x16x32_bf16 v[72:75], a[36:39], v[16:19], v[72:75]
    ds_read_b128 v[52:55], v253 offset:19456
    v_mfma_f32_16x16x32_bf16 v[76:79], a[36:39], v[20:23], v[76:79]
    s_add_u32 m0, s25, 50176
    s_nop 0
    buffer_load_dwordx4 v2, s[8:11], s24 offen offset:1024 sc1 lds
    v_mfma_f32_16x16x32_bf16 v[80:83], a[36:39], v[24:27], v[80:83]
    v_mfma_f32_16x16x32_bf16 v[84:87], a[36:39], v[28:31], v[84:87]
    s_add_u32 m0, s25, 54784
    s_nop 0
    buffer_load_dwordx4 v2, s[8:11], s24 offen offset:1536 sc1 lds
    v_mfma_f32_16x16x32_bf16 v[88:91], a[36:39], v[32:35], v[88:91]
    v_mfma_f32_16x16x32_bf16 v[92:95], v[16:19], a[40:43], v[92:95]
    buffer_load_dwordx4 a[16:19], v253, s[8:11], s28 offen offset:0
    v_mfma_f32_16x16x32_bf16 v[96:99], v[20:23], a[40:43], v[96:99]
    v_mfma_f32_16x16x32_bf16 v[100:103], v[24:27], a[40:43], v[100:103]
    buffer_load_dwordx4 a[20:23], v253, s[8:11], s28 offen offset:1024
    v_mfma_f32_16x16x32_bf16 v[104:107], v[28:31], a[40:43], v[104:107]
    v_mfma_f32_16x16x32_bf16 v[108:111], v[32:35], a[40:43], v[108:111]
    buffer_load_dwordx4 a[24:27], v253, s[8:11], s28 offen offset:2048
    v_mfma_f32_16x16x32_bf16 v[112:115], a[44:47], v[16:19], v[112:115]
    v_mfma_f32_16x16x32_bf16 v[116:119], a[44:47], v[20:23], v[116:119]
    buffer_load_dwordx4 a[28:31], v253, s[8:11], s28 offen offset:3072
    v_mfma_f32_16x16x32_bf16 v[120:123], a[44:47], v[24:27], v[120:123]
    v_mfma_f32_16x16x32_bf16 v[124:127], a[44:47], v[28:31], v[124:127]
    s_add_u32 s28, s28, 4096
    v_mfma_f32_16x16x32_bf16 v[128:131], a[44:47], v[32:35], v[128:131]
    s_waitcnt lgkmcnt(0)
    v_mfma_f32_16x16x32_bf16 v[56:59], a[48:51], v[40:43], v[56:59]
    ds_read_b128 v[16:19], v253 offset:20480
    v_mfma_f32_16x16x32_bf16 v[60:63], a[48:51], v[44:47], v[60:63]
    ds_read_b128 v[20:23], v253 offset:21504
    v_mfma_f32_16x16x32_bf16 v[64:67], a[48:51], v[48:51], v[64:67]
    ds_read_b128 v[24:27], v253 offset:22528
    v_mfma_f32_16x16x32_bf16 v[68:71], a[48:51], v[52:55], v[68:71]
    ds_read_b128 v[28:31], v253 offset:23552
    v_mfma_f32_16x16x32_bf16 v[72:75], a[52:55], v[36:39], v[72:75]
    ds_read_b128 v[32:35], v253 offset:24576
    v_mfma_f32_16x16x32_bf16 v[76:79], a[52:55], v[40:43], v[76:79]
    s_add_u32 m0, s26, 30720
    s_add_u32 s7, s27, 3072
    buffer_load_dwordx4 v2, s[8:11], s7 offen sc1 lds
    v_mfma_f32_16x16x32_bf16 v[80:83], a[52:55], v[44:47], v[80:83]
    v_mfma_f32_16x16x32_bf16 v[84:87], a[52:55], v[48:51], v[84:87]
    s_add_u32 m0, s29, 30720
    s_add_u32 s7, s23, 3072
    buffer_load_dwordx4 v2, s[8:11], s7 offen sc1 lds
    v_mfma_f32_16x16x32_bf16 v[88:91], a[52:55], v[52:55], v[88:91]
    v_mfma_f32_16x16x32_bf16 v[92:95], v[36:39], a[56:59], v[92:95]
    buffer_load_dwordx4 a[32:35], v253, s[8:11], s28 offen offset:0
    v_mfma_f32_16x16x32_bf16 v[96:99], v[40:43], a[56:59], v[96:99]
    v_mfma_f32_16x16x32_bf16 v[100:103], v[44:47], a[56:59], v[100:103]
    buffer_load_dwordx4 a[36:39], v253, s[8:11], s28 offen offset:1024
    v_mfma_f32_16x16x32_bf16 v[104:107], v[48:51], a[56:59], v[104:107]
    v_mfma_f32_16x16x32_bf16 v[108:111], v[52:55], a[56:59], v[108:111]
    buffer_load_dwordx4 a[40:43], v253, s[8:11], s28 offen offset:2048
    v_mfma_f32_16x16x32_bf16 v[112:115], a[60:63], v[36:39], v[112:115]
    v_mfma_f32_16x16x32_bf16 v[116:119], a[60:63], v[40:43], v[116:119]
    buffer_load_dwordx4 a[44:47], v253, s[8:11], s28 offen offset:3072
    v_mfma_f32_16x16x32_bf16 v[120:123], a[60:63], v[44:47], v[120:123]
    v_mfma_f32_16x16x32_bf16 v[124:127], a[60:63], v[48:51], v[124:127]
    s_add_u32 s28, s28, 4096
    v_mfma_f32_16x16x32_bf16 v[128:131], a[60:63], v[52:55], v[128:131]
    s_waitcnt lgkmcnt(0)
    v_mfma_f32_16x16x32_bf16 v[56:59], a[64:67], v[20:23], v[56:59]
    ds_read_b128 v[36:39], v253 offset:25600
    v_mfma_f32_16x16x32_bf16 v[60:63], a[64:67], v[24:27], v[60:63]
    ds_read_b128 v[40:43], v253 offset:26624
    v_mfma_f32_16x16x32_bf16 v[64:67], a[64:67], v[28:31], v[64:67]
    ds_read_b128 v[44:47], v253 offset:27648
    v_mfma_f32_16x16x32_bf16 v[68:71], a[64:67], v[32:35], v[68:71]
    ds_read_b128 v[48:51], v253 offset:28672
    v_mfma_f32_16x16x32_bf16 v[72:75], a[68:71], v[16:19], v[72:75]
    ds_read_b128 v[52:55], v253 offset:29696
    v_mfma_f32_16x16x32_bf16 v[76:79], a[68:71], v[20:23], v[76:79]
    buffer_load_dwordx4 a[48:51], v253, s[8:11], s28 offen offset:0
    v_mfma_f32_16x16x32_bf16 v[80:83], a[68:71], v[24:27], v[80:83]
    v_mfma_f32_16x16x32_bf16 v[84:87], a[68:71], v[28:31], v[84:87]
    buffer_load_dwordx4 a[52:55], v253, s[8:11], s28 offen offset:1024
    v_mfma_f32_16x16x32_bf16 v[88:91], a[68:71], v[32:35], v[88:91]
    v_mfma_f32_16x16x32_bf16 v[92:95], v[16:19], a[72:75], v[92:95]
    buffer_load_dwordx4 a[56:59], v253, s[8:11], s28 offen offset:2048
    v_mfma_f32_16x16x32_bf16 v[96:99], v[20:23], a[72:75], v[96:99]
    v_mfma_f32_16x16x32_bf16 v[100:103], v[24:27], a[72:75], v[100:103]
    buffer_load_dwordx4 a[60:63], v253, s[8:11], s28 offen offset:3072
    v_mfma_f32_16x16x32_bf16 v[104:107], v[28:31], a[72:75], v[104:107]
    v_mfma_f32_16x16x32_bf16 v[108:111], v[32:35], a[72:75], v[108:111]
    v_mfma_f32_16x16x32_bf16 v[112:115], a[76:79], v[16:19], v[112:115]
    v_mfma_f32_16x16x32_bf16 v[116:119], a[76:79], v[20:23], v[116:119]
    v_mfma_f32_16x16x32_bf16 v[120:123], a[76:79], v[24:27], v[120:123]
    v_mfma_f32_16x16x32_bf16 v[124:127], a[76:79], v[28:31], v[124:127]
    s_add_u32 s28, s28, 4096
    v_mfma_f32_16x16x32_bf16 v[128:131], a[76:79], v[32:35], v[128:131]
    s_waitcnt vmcnt(8) lgkmcnt(0)
    s_barrier
    v_mfma_f32_16x16x32_bf16 v[56:59], a[80:83], v[40:43], v[56:59]
    ds_read_b128 v[16:19], v253 offset:30720
    v_mfma_f32_16x16x32_bf16 v[60:63], a[80:83], v[44:47], v[60:63]
    ds_read_b128 v[20:23], v253 offset:31744
    v_mfma_f32_16x16x32_bf16 v[64:67], a[80:83], v[48:51], v[64:67]
    ds_read_b128 v[24:27], v253 offset:32768
    v_mfma_f32_16x16x32_bf16 v[68:71], a[80:83], v[52:55], v[68:71]
    ds_read_b128 v[28:31], v253 offset:33792
    v_mfma_f32_16x16x32_bf16 v[72:75], a[84:87], v[36:39], v[72:75]
    ds_read_b128 v[32:35], v253 offset:34816
    v_mfma_f32_16x16x32_bf16 v[76:79], a[84:87], v[40:43], v[76:79]
    s_add_u32 m0, s25, 59392
    s_nop 0
    buffer_load_dwordx4 v2, s[8:11], s24 offen offset:2048 sc1 lds
    v_mfma_f32_16x16x32_bf16 v[80:83], a[84:87], v[44:47], v[80:83]
    v_mfma_f32_16x16x32_bf16 v[84:87], a[84:87], v[48:51], v[84:87]
    s_add_u32 m0, s25, 64000
    s_nop 0
    buffer_load_dwordx4 v2, s[8:11], s24 offen offset:2560 sc1 lds
    v_mfma_f32_16x16x32_bf16 v[88:91], a[84:87], v[52:55], v[88:91]
    v_mfma_f32_16x16x32_bf16 v[92:95], v[36:39], a[88:91], v[92:95]
    buffer_load_dwordx4 a[64:67], v253, s[8:11], s28 offen offset:0
    v_mfma_f32_16x16x32_bf16 v[96:99], v[40:43], a[88:91], v[96:99]
    v_mfma_f32_16x16x32_bf16 v[100:103], v[44:47], a[88:91], v[100:103]
    buffer_load_dwordx4 a[68:71], v253, s[8:11], s28 offen offset:1024
    v_mfma_f32_16x16x32_bf16 v[104:107], v[48:51], a[88:91], v[104:107]
    v_mfma_f32_16x16x32_bf16 v[108:111], v[52:55], a[88:91], v[108:111]
    buffer_load_dwordx4 a[72:75], v253, s[8:11], s28 offen offset:2048
    v_mfma_f32_16x16x32_bf16 v[112:115], a[92:95], v[36:39], v[112:115]
    v_mfma_f32_16x16x32_bf16 v[116:119], a[92:95], v[40:43], v[116:119]
    buffer_load_dwordx4 a[76:79], v253, s[8:11], s28 offen offset:3072
    v_mfma_f32_16x16x32_bf16 v[120:123], a[92:95], v[44:47], v[120:123]
    v_mfma_f32_16x16x32_bf16 v[124:127], a[92:95], v[48:51], v[124:127]
    s_add_u32 s28, s28, 4096
    v_mfma_f32_16x16x32_bf16 v[128:131], a[92:95], v[52:55], v[128:131]
    s_waitcnt lgkmcnt(0)
    v_mfma_f32_16x16x32_bf16 v[56:59], a[96:99], v[20:23], v[56:59]
    ds_read_b128 v[36:39], v253 offset:35840
    v_mfma_f32_16x16x32_bf16 v[60:63], a[96:99], v[24:27], v[60:63]
    ds_read_b128 v[40:43], v253 offset:36864
    v_mfma_f32_16x16x32_bf16 v[64:67], a[96:99], v[28:31], v[64:67]
    ds_read_b128 v[44:47], v253 offset:37888
    v_mfma_f32_16x16x32_bf16 v[68:71], a[96:99], v[32:35], v[68:71]
    ds_read_b128 v[48:51], v253 offset:38912
    v_mfma_f32_16x16x32_bf16 v[72:75], a[100:103], v[16:19], v[72:75]
    ds_read_b128 v[52:55], v253 offset:39936
    v_mfma_f32_16x16x32_bf16 v[76:79], a[100:103], v[20:23], v[76:79]
    s_add_u32 m0, s25, 68608
    s_nop 0
    buffer_load_dwordx4 v2, s[8:11], s24 offen offset:3072 sc1 lds
    v_mfma_f32_16x16x32_bf16 v[80:83], a[100:103], v[24:27], v[80:83]
    v_mfma_f32_16x16x32_bf16 v[84:87], a[100:103], v[28:31], v[84:87]
    s_add_u32 m0, s25, 73216
    s_nop 0
    buffer_load_dwordx4 v2, s[8:11], s24 offen offset:3584 sc1 lds
    v_mfma_f32_16x16x32_bf16 v[88:91], a[100:103], v[32:35], v[88:91]
    v_mfma_f32_16x16x32_bf16 v[92:95], v[16:19], a[104:107], v[92:95]
    buffer_load_dwordx4 a[80:83], v253, s[8:11], s28 offen offset:0
    v_mfma_f32_16x16x32_bf16 v[96:99], v[20:23], a[104:107], v[96:99]
    v_mfma_f32_16x16x32_bf16 v[100:103], v[24:27], a[104:107], v[100:103]
    buffer_load_dwordx4 a[84:87], v253, s[8:11], s28 offen offset:1024
    v_mfma_f32_16x16x32_bf16 v[104:107], v[28:31], a[104:107], v[104:107]
    v_mfma_f32_16x16x32_bf16 v[108:111], v[32:35], a[104:107], v[108:111]
    buffer_load_dwordx4 a[88:91], v253, s[8:11], s28 offen offset:2048
    v_mfma_f32_16x16x32_bf16 v[112:115], a[108:111], v[16:19], v[112:115]
    v_mfma_f32_16x16x32_bf16 v[116:119], a[108:111], v[20:23], v[116:119]
    buffer_load_dwordx4 a[92:95], v253, s[8:11], s28 offen offset:3072
    v_mfma_f32_16x16x32_bf16 v[120:123], a[108:111], v[24:27], v[120:123]
    v_mfma_f32_16x16x32_bf16 v[124:127], a[108:111], v[28:31], v[124:127]
    s_add_u32 s28, s28, 4096
    v_mfma_f32_16x16x32_bf16 v[128:131], a[108:111], v[32:35], v[128:131]
    s_waitcnt lgkmcnt(0)
    v_mfma_f32_16x16x32_bf16 v[56:59], a[112:115], v[40:43], v[56:59]
    ds_read_b128 v[16:19], v253 offset:40960
    v_mfma_f32_16x16x32_bf16 v[60:63], a[112:115], v[44:47], v[60:63]
    ds_read_b128 v[20:23], v253 offset:41984
    v_mfma_f32_16x16x32_bf16 v[64:67], a[112:115], v[48:51], v[64:67]
    ds_read_b128 v[24:27], v253 offset:43008
    v_mfma_f32_16x16x32_bf16 v[68:71], a[112:115], v[52:55], v[68:71]
    ds_read_b128 v[28:31], v253 offset:44032
    v_mfma_f32_16x16x32_bf16 v[72:75], a[116:119], v[36:39], v[72:75]
    ds_read_b128 v[32:35], v253 offset:45056
    v_mfma_f32_16x16x32_bf16 v[76:79], a[116:119], v[40:43], v[76:79]
    s_add_u32 m0, s25, 81920
    s_add_u32 s24, s24, 4096
    buffer_load_dwordx4 v2, s[8:11], s24 offen offset:0 sc1 lds
    v_mfma_f32_16x16x32_bf16 v[80:83], a[116:119], v[44:47], v[80:83]
    v_mfma_f32_16x16x32_bf16 v[84:87], a[116:119], v[48:51], v[84:87]
    s_add_u32 m0, s25, 86528
    s_nop 0
    buffer_load_dwordx4 v2, s[8:11], s24 offen offset:512 sc1 lds
    v_mfma_f32_16x16x32_bf16 v[88:91], a[116:119], v[52:55], v[88:91]
    v_mfma_f32_16x16x32_bf16 v[92:95], v[36:39], a[120:123], v[92:95]
    buffer_load_dwordx4 a[96:99], v253, s[8:11], s28 offen offset:0
    v_mfma_f32_16x16x32_bf16 v[96:99], v[40:43], a[120:123], v[96:99]
    v_mfma_f32_16x16x32_bf16 v[100:103], v[44:47], a[120:123], v[100:103]
    buffer_load_dwordx4 a[100:103], v253, s[8:11], s28 offen offset:1024
    v_mfma_f32_16x16x32_bf16 v[104:107], v[48:51], a[120:123], v[104:107]
    v_mfma_f32_16x16x32_bf16 v[108:111], v[52:55], a[120:123], v[108:111]
    buffer_load_dwordx4 a[104:107], v253, s[8:11], s28 offen offset:2048
    v_mfma_f32_16x16x32_bf16 v[112:115], a[124:127], v[36:39], v[112:115]
    v_mfma_f32_16x16x32_bf16 v[116:119], a[124:127], v[40:43], v[116:119]
    buffer_load_dwordx4 a[108:111], v253, s[8:11], s28 offen offset:3072
    v_mfma_f32_16x16x32_bf16 v[120:123], a[124:127], v[44:47], v[120:123]
    v_mfma_f32_16x16x32_bf16 v[124:127], a[124:127], v[48:51], v[124:127]
    s_add_u32 s28, s28, 4096
    v_mfma_f32_16x16x32_bf16 v[128:131], a[124:127], v[52:55], v[128:131]
    s_waitcnt lgkmcnt(0)
    v_mfma_f32_16x16x32_bf16 v[56:59], a[128:131], v[20:23], v[56:59]
    ds_read_b128 v[36:39], v6 offset:0
    v_mfma_f32_16x16x32_bf16 v[60:63], a[128:131], v[24:27], v[60:63]
    ds_read_b128 v[40:43], v6 offset:1024
    v_mfma_f32_16x16x32_bf16 v[64:67], a[128:131], v[28:31], v[64:67]
    ds_read_b128 v[44:47], v6 offset:2048
    v_mfma_f32_16x16x32_bf16 v[68:71], a[128:131], v[32:35], v[68:71]
    ds_read_b128 v[48:51], v6 offset:3072
    v_mfma_f32_16x16x32_bf16 v[72:75], a[132:135], v[16:19], v[72:75]
    ds_read_b128 v[52:55], v6 offset:4096
    v_mfma_f32_16x16x32_bf16 v[76:79], a[132:135], v[20:23], v[76:79]
    s_add_u32 m0, s26, 61440
    s_add_u32 s7, s27, 6144
    buffer_load_dwordx4 v2, s[8:11], s7 offen sc1 lds
    v_mfma_f32_16x16x32_bf16 v[80:83], a[132:135], v[24:27], v[80:83]
    v_mfma_f32_16x16x32_bf16 v[84:87], a[132:135], v[28:31], v[84:87]
    s_add_u32 m0, s29, 61440
    s_add_u32 s7, s23, 6144
    buffer_load_dwordx4 v2, s[8:11], s7 offen sc1 lds
    v_mfma_f32_16x16x32_bf16 v[88:91], a[132:135], v[32:35], v[88:91]
    v_mfma_f32_16x16x32_bf16 v[92:95], v[16:19], a[136:139], v[92:95]
    buffer_load_dwordx4 a[112:115], v253, s[8:11], s28 offen offset:0
    v_mfma_f32_16x16x32_bf16 v[96:99], v[20:23], a[136:139], v[96:99]
    v_mfma_f32_16x16x32_bf16 v[100:103], v[24:27], a[136:139], v[100:103]
    buffer_load_dwordx4 a[116:119], v253, s[8:11], s28 offen offset:1024
    v_mfma_f32_16x16x32_bf16 v[104:107], v[28:31], a[136:139], v[104:107]
    v_mfma_f32_16x16x32_bf16 v[108:111], v[32:35], a[136:139], v[108:111]
    buffer_load_dwordx4 a[120:123], v253, s[8:11], s28 offen offset:2048
    v_mfma_f32_16x16x32_bf16 v[112:115], a[140:143], v[16:19], v[112:115]
    v_mfma_f32_16x16x32_bf16 v[116:119], a[140:143], v[20:23], v[116:119]
    buffer_load_dwordx4 a[124:127], v253, s[8:11], s28 offen offset:3072
    v_mfma_f32_16x16x32_bf16 v[120:123], a[140:143], v[24:27], v[120:123]
    v_mfma_f32_16x16x32_bf16 v[124:127], a[140:143], v[28:31], v[124:127]
    s_add_u32 s28, s28, 4096
    v_mfma_f32_16x16x32_bf16 v[128:131], a[140:143], v[32:35], v[128:131]
    s_waitcnt vmcnt(46) lgkmcnt(0)
    v_mfma_f32_16x16x32_bf16 v[56:59], a[144:147], v[40:43], v[56:59]
    ds_read_b128 v[16:19], v6 offset:5120
    v_mfma_f32_16x16x32_bf16 v[60:63], a[144:147], v[44:47], v[60:63]
    ds_read_b128 v[20:23], v6 offset:6144
    v_mfma_f32_16x16x32_bf16 v[64:67], a[144:147], v[48:51], v[64:67]
    ds_read_b128 v[24:27], v6 offset:7168
    v_mfma_f32_16x16x32_bf16 v[68:71], a[144:147], v[52:55], v[68:71]
    ds_read_b128 v[28:31], v6 offset:8192
    v_mfma_f32_16x16x32_bf16 v[72:75], a[148:151], v[36:39], v[72:75]
    ds_read_b128 v[32:35], v6 offset:9216
    v_mfma_f32_16x16x32_bf16 v[76:79], a[148:151], v[40:43], v[76:79]
    buffer_load_dwordx4 a[160:163], v253, s[8:11], s32 offen offset:0
    v_mfma_f32_16x16x32_bf16 v[80:83], a[148:151], v[44:47], v[80:83]
    v_mfma_f32_16x16x32_bf16 v[84:87], a[148:151], v[48:51], v[84:87]
    buffer_load_dwordx4 a[164:167], v253, s[8:11], s33 offen offset:0
    v_mfma_f32_16x16x32_bf16 v[88:91], a[148:151], v[52:55], v[88:91]
    v_mfma_f32_16x16x32_bf16 v[92:95], v[36:39], a[152:155], v[92:95]
    buffer_load_dwordx4 a[168:171], v5, s[8:11], s34 offen offset:0
    v_mfma_f32_16x16x32_bf16 v[96:99], v[40:43], a[152:155], v[96:99]
    v_mfma_f32_16x16x32_bf16 v[100:103], v[44:47], a[152:155], v[100:103]
    buffer_load_dwordx4 a[172:175], v253, s[8:11], s32 offen offset:1024
    v_mfma_f32_16x16x32_bf16 v[104:107], v[48:51], a[152:155], v[104:107]
    v_mfma_f32_16x16x32_bf16 v[108:111], v[52:55], a[152:155], v[108:111]
    v_mfma_f32_16x16x32_bf16 v[112:115], a[156:159], v[36:39], v[112:115]
    v_mfma_f32_16x16x32_bf16 v[116:119], a[156:159], v[40:43], v[116:119]
    v_mfma_f32_16x16x32_bf16 v[120:123], a[156:159], v[44:47], v[120:123]
    v_mfma_f32_16x16x32_bf16 v[124:127], a[156:159], v[48:51], v[124:127]
    v_mfma_f32_16x16x32_bf16 v[128:131], a[156:159], v[52:55], v[128:131]
    s_waitcnt vmcnt(44) lgkmcnt(0)
    v_mfma_f32_16x16x32_bf16 v[56:59], a[0:3], v[20:23], v[56:59]
    ds_read_b128 v[36:39], v6 offset:10240
    v_mfma_f32_16x16x32_bf16 v[60:63], a[0:3], v[24:27], v[60:63]
    ds_read_b128 v[40:43], v6 offset:11264
    v_mfma_f32_16x16x32_bf16 v[64:67], a[0:3], v[28:31], v[64:67]
    ds_read_b128 v[44:47], v6 offset:12288
    v_mfma_f32_16x16x32_bf16 v[68:71], a[0:3], v[32:35], v[68:71]
    ds_read_b128 v[48:51], v6 offset:13312
    v_mfma_f32_16x16x32_bf16 v[72:75], a[4:7], v[16:19], v[72:75]
    ds_read_b128 v[52:55], v6 offset:14336
    v_mfma_f32_16x16x32_bf16 v[76:79], a[4:7], v[20:23], v[76:79]
    buffer_load_dwordx4 a[176:179], v253, s[8:11], s33 offen offset:1024
    v_mfma_f32_16x16x32_bf16 v[80:83], a[4:7], v[24:27], v[80:83]
    v_mfma_f32_16x16x32_bf16 v[84:87], a[4:7], v[28:31], v[84:87]
    buffer_load_dwordx4 a[180:183], v5, s[8:11], s34 offen offset:1024
    v_mfma_f32_16x16x32_bf16 v[88:91], a[4:7], v[32:35], v[88:91]
    v_mfma_f32_16x16x32_bf16 v[92:95], v[16:19], a[8:11], v[92:95]
    buffer_load_dwordx4 a[184:187], v253, s[8:11], s32 offen offset:2048
    v_mfma_f32_16x16x32_bf16 v[96:99], v[20:23], a[8:11], v[96:99]
    v_mfma_f32_16x16x32_bf16 v[100:103], v[24:27], a[8:11], v[100:103]
    buffer_load_dwordx4 a[188:191], v253, s[8:11], s33 offen offset:2048
    v_mfma_f32_16x16x32_bf16 v[104:107], v[28:31], a[8:11], v[104:107]
    v_mfma_f32_16x16x32_bf16 v[108:111], v[32:35], a[8:11], v[108:111]
    v_mfma_f32_16x16x32_bf16 v[112:115], a[12:15], v[16:19], v[112:115]
    v_mfma_f32_16x16x32_bf16 v[116:119], a[12:15], v[20:23], v[116:119]
    v_mfma_f32_16x16x32_bf16 v[120:123], a[12:15], v[24:27], v[120:123]
    v_mfma_f32_16x16x32_bf16 v[124:127], a[12:15], v[28:31], v[124:127]
    v_mfma_f32_16x16x32_bf16 v[128:131], a[12:15], v[32:35], v[128:131]
    s_waitcnt vmcnt(12) lgkmcnt(0)
    s_barrier
    v_mfma_f32_16x16x32_bf16 v[56:59], a[16:19], v[40:43], v[56:59]
    ds_read_b128 v[16:19], v6 offset:15360
    v_mfma_f32_16x16x32_bf16 v[60:63], a[16:19], v[44:47], v[60:63]
    ds_read_b128 v[20:23], v6 offset:16384
    v_mfma_f32_16x16x32_bf16 v[64:67], a[16:19], v[48:51], v[64:67]
    ds_read_b128 v[24:27], v6 offset:17408
    v_mfma_f32_16x16x32_bf16 v[68:71], a[16:19], v[52:55], v[68:71]
    ds_read_b128 v[28:31], v6 offset:18432
    v_mfma_f32_16x16x32_bf16 v[72:75], a[20:23], v[36:39], v[72:75]
    ds_read_b128 v[32:35], v6 offset:19456
    v_mfma_f32_16x16x32_bf16 v[76:79], a[20:23], v[40:43], v[76:79]
    buffer_load_dwordx4 a[192:195], v5, s[8:11], s34 offen offset:2048
    v_mfma_f32_16x16x32_bf16 v[80:83], a[20:23], v[44:47], v[80:83]
    v_mfma_f32_16x16x32_bf16 v[84:87], a[20:23], v[48:51], v[84:87]
    buffer_load_dwordx4 a[196:199], v253, s[8:11], s32 offen offset:3072
    s_add_u32 s32, s32, 4096
    v_mfma_f32_16x16x32_bf16 v[88:91], a[20:23], v[52:55], v[88:91]
    v_mfma_f32_16x16x32_bf16 v[92:95], v[36:39], a[24:27], v[92:95]
    buffer_load_dwordx4 a[200:203], v253, s[8:11], s33 offen offset:3072
    s_add_u32 s33, s33, 4096
    v_mfma_f32_16x16x32_bf16 v[96:99], v[40:43], a[24:27], v[96:99]
    v_mfma_f32_16x16x32_bf16 v[100:103], v[44:47], a[24:27], v[100:103]
    buffer_load_dwordx4 a[204:207], v5, s[8:11], s34 offen offset:3072
    s_add_u32 s34, s34, 4096
    v_mfma_f32_16x16x32_bf16 v[104:107], v[48:51], a[24:27], v[104:107]
    v_mfma_f32_16x16x32_bf16 v[108:111], v[52:55], a[24:27], v[108:111]
    v_mfma_f32_16x16x32_bf16 v[112:115], a[28:31], v[36:39], v[112:115]
    v_mfma_f32_16x16x32_bf16 v[116:119], a[28:31], v[40:43], v[116:119]
    v_mfma_f32_16x16x32_bf16 v[120:123], a[28:31], v[44:47], v[120:123]
    v_mfma_f32_16x16x32_bf16 v[124:127], a[28:31], v[48:51], v[124:127]
    v_mfma_f32_16x16x32_bf16 v[128:131], a[28:31], v[52:55], v[128:131]
    s_waitcnt vmcnt(40) lgkmcnt(0)
    v_mfma_f32_16x16x32_bf16 v[56:59], a[32:35], v[20:23], v[56:59]
    ds_read_b128 v[36:39], v6 offset:20480
    v_mfma_f32_16x16x32_bf16 v[60:63], a[32:35], v[24:27], v[60:63]
    ds_read_b128 v[40:43], v6 offset:21504
    v_mfma_f32_16x16x32_bf16 v[64:67], a[32:35], v[28:31], v[64:67]
    ds_read_b128 v[44:47], v6 offset:22528
    v_mfma_f32_16x16x32_bf16 v[68:71], a[32:35], v[32:35], v[68:71]
    ds_read_b128 v[48:51], v6 offset:23552
    v_mfma_f32_16x16x32_bf16 v[72:75], a[36:39], v[16:19], v[72:75]
    ds_read_b128 v[52:55], v6 offset:24576
    v_mfma_f32_16x16x32_bf16 v[76:79], a[36:39], v[20:23], v[76:79]
    buffer_load_dwordx4 a[208:211], v253, s[8:11], s32 offen offset:0
    v_mfma_f32_16x16x32_bf16 v[80:83], a[36:39], v[24:27], v[80:83]
    v_mfma_f32_16x16x32_bf16 v[84:87], a[36:39], v[28:31], v[84:87]
    buffer_load_dwordx4 a[212:215], v253, s[8:11], s33 offen offset:0
    v_mfma_f32_16x16x32_bf16 v[88:91], a[36:39], v[32:35], v[88:91]
    v_mfma_f32_16x16x32_bf16 v[92:95], v[16:19], a[40:43], v[92:95]
    buffer_load_dwordx4 a[216:219], v5, s[8:11], s34 offen offset:0
    v_mfma_f32_16x16x32_bf16 v[96:99], v[20:23], a[40:43], v[96:99]
    v_mfma_f32_16x16x32_bf16 v[100:103], v[24:27], a[40:43], v[100:103]
    buffer_load_dwordx4 a[220:223], v253, s[8:11], s32 offen offset:1024
    v_mfma_f32_16x16x32_bf16 v[104:107], v[28:31], a[40:43], v[104:107]
    v_mfma_f32_16x16x32_bf16 v[108:111], v[32:35], a[40:43], v[108:111]
    v_mfma_f32_16x16x32_bf16 v[112:115], a[44:47], v[16:19], v[112:115]
    v_mfma_f32_16x16x32_bf16 v[116:119], a[44:47], v[20:23], v[116:119]
    v_mfma_f32_16x16x32_bf16 v[120:123], a[44:47], v[24:27], v[120:123]
    v_mfma_f32_16x16x32_bf16 v[124:127], a[44:47], v[28:31], v[124:127]
    v_mfma_f32_16x16x32_bf16 v[128:131], a[44:47], v[32:35], v[128:131]
    s_waitcnt vmcnt(40) lgkmcnt(0)
    v_mfma_f32_16x16x32_bf16 v[56:59], a[48:51], v[40:43], v[56:59]
    ds_read_b128 v[16:19], v6 offset:25600
    v_mfma_f32_16x16x32_bf16 v[60:63], a[48:51], v[44:47], v[60:63]
    ds_read_b128 v[20:23], v6 offset:26624
    v_mfma_f32_16x16x32_bf16 v[64:67], a[48:51], v[48:51], v[64:67]
    ds_read_b128 v[24:27], v6 offset:27648
    v_mfma_f32_16x16x32_bf16 v[68:71], a[48:51], v[52:55], v[68:71]
    ds_read_b128 v[28:31], v6 offset:28672
    v_mfma_f32_16x16x32_bf16 v[72:75], a[52:55], v[36:39], v[72:75]
    ds_read_b128 v[32:35], v6 offset:29696
    v_mfma_f32_16x16x32_bf16 v[76:79], a[52:55], v[40:43], v[76:79]
    buffer_load_dwordx4 a[224:227], v253, s[8:11], s33 offen offset:1024
    v_mfma_f32_16x16x32_bf16 v[80:83], a[52:55], v[44:47], v[80:83]
    v_mfma_f32_16x16x32_bf16 v[84:87], a[52:55], v[48:51], v[84:87]
    buffer_load_dwordx4 a[228:231], v5, s[8:11], s34 offen offset:1024
    v_mfma_f32_16x16x32_bf16 v[88:91], a[52:55], v[52:55], v[88:91]
    v_mfma_f32_16x16x32_bf16 v[92:95], v[36:39], a[56:59], v[92:95]
    buffer_load_dwordx4 a[232:235], v253, s[8:11], s32 offen offset:2048
    v_mfma_f32_16x16x32_bf16 v[96:99], v[40:43], a[56:59], v[96:99]
    v_mfma_f32_16x16x32_bf16 v[100:103], v[44:47], a[56:59], v[100:103]
    buffer_load_dwordx4 a[236:239], v253, s[8:11], s33 offen offset:2048
    v_mfma_f32_16x16x32_bf16 v[104:107], v[48:51], a[56:59], v[104:107]
    v_mfma_f32_16x16x32_bf16 v[108:111], v[52:55], a[56:59], v[108:111]
    v_mfma_f32_16x16x32_bf16 v[112:115], a[60:63], v[36:39], v[112:115]
    v_mfma_f32_16x16x32_bf16 v[116:119], a[60:63], v[40:43], v[116:119]
    v_mfma_f32_16x16x32_bf16 v[120:123], a[60:63], v[44:47], v[120:123]
    v_mfma_f32_16x16x32_bf16 v[124:127], a[60:63], v[48:51], v[124:127]
    v_mfma_f32_16x16x32_bf16 v[128:131], a[60:63], v[52:55], v[128:131]
    s_waitcnt vmcnt(38) lgkmcnt(0)
    v_mfma_f32_16x16x32_bf16 v[56:59], a[64:67], v[20:23], v[56:59]
    ds_read_b128 v[36:39], v6 offset:30720
    v_mfma_f32_16x16x32_bf16 v[60:63], a[64:67], v[24:27], v[60:63]
    ds_read_b128 v[40:43], v6 offset:31744
    v_mfma_f32_16x16x32_bf16 v[64:67], a[64:67], v[28:31], v[64:67]
    ds_read_b128 v[44:47], v6 offset:32768
    v_mfma_f32_16x16x32_bf16 v[68:71], a[64:67], v[32:35], v[68:71]
    ds_read_b128 v[48:51], v6 offset:33792
    v_mfma_f32_16x16x32_bf16 v[72:75], a[68:71], v[16:19], v[72:75]
    ds_read_b128 v[52:55], v6 offset:34816
    v_mfma_f32_16x16x32_bf16 v[76:79], a[68:71], v[20:23], v[76:79]
    buffer_load_dwordx4 a[240:243], v5, s[8:11], s34 offen offset:2048
    v_mfma_f32_16x16x32_bf16 v[80:83], a[68:71], v[24:27], v[80:83]
    v_mfma_f32_16x16x32_bf16 v[84:87], a[68:71], v[28:31], v[84:87]
    buffer_load_dwordx4 a[244:247], v253, s[8:11], s32 offen offset:3072
    s_add_u32 s32, s32, 4096
    v_mfma_f32_16x16x32_bf16 v[88:91], a[68:71], v[32:35], v[88:91]
    v_mfma_f32_16x16x32_bf16 v[92:95], v[16:19], a[72:75], v[92:95]
    buffer_load_dwordx4 a[248:251], v253, s[8:11], s33 offen offset:3072
    s_add_u32 s33, s33, 4096
    v_mfma_f32_16x16x32_bf16 v[96:99], v[20:23], a[72:75], v[96:99]
    v_mfma_f32_16x16x32_bf16 v[100:103], v[24:27], a[72:75], v[100:103]
    buffer_load_dwordx4 a[252:255], v5, s[8:11], s34 offen offset:3072
    s_add_u32 s34, s34, 4096
    v_mfma_f32_16x16x32_bf16 v[104:107], v[28:31], a[72:75], v[104:107]
    v_mfma_f32_16x16x32_bf16 v[108:111], v[32:35], a[72:75], v[108:111]
    v_mfma_f32_16x16x32_bf16 v[112:115], a[76:79], v[16:19], v[112:115]
    v_mfma_f32_16x16x32_bf16 v[116:119], a[76:79], v[20:23], v[116:119]
    v_mfma_f32_16x16x32_bf16 v[120:123], a[76:79], v[24:27], v[120:123]
    v_mfma_f32_16x16x32_bf16 v[124:127], a[76:79], v[28:31], v[124:127]
    v_mfma_f32_16x16x32_bf16 v[128:131], a[76:79], v[32:35], v[128:131]
    s_waitcnt vmcnt(36) lgkmcnt(0)
    v_mfma_f32_16x16x32_bf16 v[56:59], a[80:83], v[40:43], v[56:59]
    ds_read_b128 v[16:19], v6 offset:35840
    v_mfma_f32_16x16x32_bf16 v[60:63], a[80:83], v[44:47], v[60:63]
    ds_read_b128 v[20:23], v6 offset:36864
    v_mfma_f32_16x16x32_bf16 v[64:67], a[80:83], v[48:51], v[64:67]
    ds_read_b128 v[24:27], v6 offset:37888
    v_mfma_f32_16x16x32_bf16 v[68:71], a[80:83], v[52:55], v[68:71]
    ds_read_b128 v[28:31], v6 offset:38912
    v_mfma_f32_16x16x32_bf16 v[72:75], a[84:87], v[36:39], v[72:75]
    ds_read_b128 v[32:35], v6 offset:39936
    v_mfma_f32_16x16x32_bf16 v[76:79], a[84:87], v[40:43], v[76:79]
    buffer_load_dwordx4 a[128:131], v253, s[8:11], s32 offen offset:0
    v_mfma_f32_16x16x32_bf16 v[80:83], a[84:87], v[44:47], v[80:83]
    v_mfma_f32_16x16x32_bf16 v[84:87], a[84:87], v[48:51], v[84:87]
    buffer_load_dwordx4 a[132:135], v253, s[8:11], s33 offen offset:0
    v_mfma_f32_16x16x32_bf16 v[88:91], a[84:87], v[52:55], v[88:91]
    v_mfma_f32_16x16x32_bf16 v[92:95], v[36:39], a[88:91], v[92:95]
    buffer_load_dwordx4 a[136:139], v5, s[8:11], s34 offen offset:0
    v_mfma_f32_16x16x32_bf16 v[96:99], v[40:43], a[88:91], v[96:99]
    v_mfma_f32_16x16x32_bf16 v[100:103], v[44:47], a[88:91], v[100:103]
    buffer_load_dwordx4 a[140:143], v253, s[8:11], s32 offen offset:1024
    v_mfma_f32_16x16x32_bf16 v[104:107], v[48:51], a[88:91], v[104:107]
    v_mfma_f32_16x16x32_bf16 v[108:111], v[52:55], a[88:91], v[108:111]
    v_mfma_f32_16x16x32_bf16 v[112:115], a[92:95], v[36:39], v[112:115]
    v_mfma_f32_16x16x32_bf16 v[116:119], a[92:95], v[40:43], v[116:119]
    v_mfma_f32_16x16x32_bf16 v[120:123], a[92:95], v[44:47], v[120:123]
    v_mfma_f32_16x16x32_bf16 v[124:127], a[92:95], v[48:51], v[124:127]
    v_mfma_f32_16x16x32_bf16 v[128:131], a[92:95], v[52:55], v[128:131]
    s_waitcnt vmcnt(34) lgkmcnt(0)
    v_mfma_f32_16x16x32_bf16 v[56:59], a[96:99], v[20:23], v[56:59]
    ds_read_b128 v[36:39], v6 offset:40960
    v_mfma_f32_16x16x32_bf16 v[60:63], a[96:99], v[24:27], v[60:63]
    ds_read_b128 v[40:43], v6 offset:41984
    v_mfma_f32_16x16x32_bf16 v[64:67], a[96:99], v[28:31], v[64:67]
    ds_read_b128 v[44:47], v6 offset:43008
    v_mfma_f32_16x16x32_bf16 v[68:71], a[96:99], v[32:35], v[68:71]
    ds_read_b128 v[48:51], v6 offset:44032
    v_mfma_f32_16x16x32_bf16 v[72:75], a[100:103], v[16:19], v[72:75]
    ds_read_b128 v[52:55], v6 offset:45056
    v_mfma_f32_16x16x32_bf16 v[76:79], a[100:103], v[20:23], v[76:79]
    buffer_load_dwordx4 a[144:147], v253, s[8:11], s33 offen offset:1024
    v_mfma_f32_16x16x32_bf16 v[80:83], a[100:103], v[24:27], v[80:83]
    v_mfma_f32_16x16x32_bf16 v[84:87], a[100:103], v[28:31], v[84:87]
    buffer_load_dwordx4 a[148:151], v5, s[8:11], s34 offen offset:1024
    v_mfma_f32_16x16x32_bf16 v[88:91], a[100:103], v[32:35], v[88:91]
    v_mfma_f32_16x16x32_bf16 v[92:95], v[16:19], a[104:107], v[92:95]
    buffer_load_dwordx4 a[152:155], v253, s[8:11], s32 offen offset:2048
    v_mfma_f32_16x16x32_bf16 v[96:99], v[20:23], a[104:107], v[96:99]
    v_mfma_f32_16x16x32_bf16 v[100:103], v[24:27], a[104:107], v[100:103]
    buffer_load_dwordx4 a[156:159], v253, s[8:11], s33 offen offset:2048
    v_mfma_f32_16x16x32_bf16 v[104:107], v[28:31], a[104:107], v[104:107]
    v_mfma_f32_16x16x32_bf16 v[108:111], v[32:35], a[104:107], v[108:111]
    v_mfma_f32_16x16x32_bf16 v[112:115], a[108:111], v[16:19], v[112:115]
    v_mfma_f32_16x16x32_bf16 v[116:119], a[108:111], v[20:23], v[116:119]
    v_mfma_f32_16x16x32_bf16 v[120:123], a[108:111], v[24:27], v[120:123]
    v_mfma_f32_16x16x32_bf16 v[124:127], a[108:111], v[28:31], v[124:127]
    v_mfma_f32_16x16x32_bf16 v[128:131], a[108:111], v[32:35], v[128:131]
    s_waitcnt vmcnt(32) lgkmcnt(0)
    v_mfma_f32_16x16x32_bf16 v[56:59], a[112:115], v[40:43], v[56:59]
    v_mfma_f32_16x16x32_bf16 v[60:63], a[112:115], v[44:47], v[60:63]
    v_mfma_f32_16x16x32_bf16 v[64:67], a[112:115], v[48:51], v[64:67]
    v_mfma_f32_16x16x32_bf16 v[68:71], a[112:115], v[52:55], v[68:71]
    v_mfma_f32_16x16x32_bf16 v[72:75], a[116:119], v[36:39], v[72:75]
    v_mfma_f32_16x16x32_bf16 v[76:79], a[116:119], v[40:43], v[76:79]
    buffer_load_dwordx4 a[0:3], v5, s[8:11], s34 offen offset:2048
    v_mfma_f32_16x16x32_bf16 v[80:83], a[116:119], v[44:47], v[80:83]
    v_mfma_f32_16x16x32_bf16 v[84:87], a[116:119], v[48:51], v[84:87]
    buffer_load_dwordx4 a[4:7], v253, s[8:11], s32 offen offset:3072
    s_add_u32 s32, s32, 4096
    v_mfma_f32_16x16x32_bf16 v[88:91], a[116:119], v[52:55], v[88:91]
    v_mfma_f32_16x16x32_bf16 v[92:95], v[36:39], a[120:123], v[92:95]
    buffer_load_dwordx4 a[8:11], v253, s[8:11], s33 offen offset:3072
    s_add_u32 s33, s33, 4096
    v_mfma_f32_16x16x32_bf16 v[96:99], v[40:43], a[120:123], v[96:99]
    v_mfma_f32_16x16x32_bf16 v[100:103], v[44:47], a[120:123], v[100:103]
    buffer_load_dwordx4 a[12:15], v5, s[8:11], s34 offen offset:3072
    s_add_u32 s34, s34, 4096
    v_mfma_f32_16x16x32_bf16 v[104:107], v[48:51], a[120:123], v[104:107]
    v_mfma_f32_16x16x32_bf16 v[108:111], v[52:55], a[120:123], v[108:111]
    v_mfma_f32_16x16x32_bf16 v[112:115], a[124:127], v[36:39], v[112:115]
    v_mfma_f32_16x16x32_bf16 v[116:119], a[124:127], v[40:43], v[116:119]
    v_mfma_f32_16x16x32_bf16 v[120:123], a[124:127], v[44:47], v[120:123]
    v_mfma_f32_16x16x32_bf16 v[124:127], a[124:127], v[48:51], v[124:127]
    v_mfma_f32_16x16x32_bf16 v[128:131], a[124:127], v[52:55], v[128:131]
    v_cvt_pk_bf16_f32 v136, v56, v57
    v_cvt_pk_bf16_f32 v137, v58, v59
    v_cvt_pk_bf16_f32 v140, v60, v61
    v_cvt_pk_bf16_f32 v141, v62, v63
    v_cvt_pk_bf16_f32 v144, v64, v65
    v_cvt_pk_bf16_f32 v145, v66, v67
    v_cvt_pk_bf16_f32 v148, v68, v69
    v_cvt_pk_bf16_f32 v149, v70, v71
    v_cvt_pk_bf16_f32 v152, v72, v73
    v_cvt_pk_bf16_f32 v153, v74, v75
    buffer_load_dwordx4 a[16:19], v253, s[8:11], s32 offen offset:0
    v_cvt_pk_bf16_f32 v156, v76, v77
    v_cvt_pk_bf16_f32 v157, v78, v79
    v_cvt_pk_bf16_f32 v160, v80, v81
    v_cvt_pk_bf16_f32 v161, v82, v83
    v_cvt_pk_bf16_f32 v164, v84, v85
    v_cvt_pk_bf16_f32 v165, v86, v87
    v_cvt_pk_bf16_f32 v168, v88, v89
    v_cvt_pk_bf16_f32 v169, v90, v91
    v_cvt_pk_bf16_f32 v134, v112, v113
    v_cvt_pk_bf16_f32 v154, v114, v115
    buffer_load_dwordx4 a[20:23], v253, s[8:11], s33 offen offset:0
    v_cvt_pk_bf16_f32 v138, v116, v117
    v_cvt_pk_bf16_f32 v158, v118, v119
    v_cvt_pk_bf16_f32 v142, v120, v121
    v_cvt_pk_bf16_f32 v162, v122, v123
    v_cvt_pk_bf16_f32 v146, v124, v125
    v_cvt_pk_bf16_f32 v166, v126, v127
    v_cvt_pk_bf16_f32 v150, v128, v129
    v_cvt_pk_bf16_f32 v170, v130, v131
    v_cvt_pk_bf16_f32 v172, v92, v93
    v_cvt_pk_bf16_f32 v173, v94, v95
    buffer_load_dwordx4 a[24:27], v5, s[8:11], s34 offen offset:0
    v_cvt_pk_bf16_f32 v174, v96, v97
    v_cvt_pk_bf16_f32 v175, v98, v99
    v_cvt_pk_bf16_f32 v176, v100, v101
    v_cvt_pk_bf16_f32 v177, v102, v103
    v_cvt_pk_bf16_f32 v178, v104, v105
    v_cvt_pk_bf16_f32 v179, v106, v107
    v_cvt_pk_bf16_f32 v180, v108, v109
    v_cvt_pk_bf16_f32 v181, v110, v111
    v_mfma_f32_16x16x32_bf16 v[16:19], v[152:155], v[136:139], v[208:211]
    v_mfma_f32_16x16x32_bf16 v[20:23], v[156:159], v[136:139], v[204:207]
    buffer_load_dwordx4 a[28:31], v253, s[8:11], s32 offen offset:1024
    v_mfma_f32_16x16x32_bf16 v[24:27], v[156:159], v[140:143], v[200:203]
    v_mfma_f32_16x16x32_bf16 v[28:31], v[160:163], v[140:143], v[204:207]
    v_mfma_f32_16x16x32_bf16 v[32:35], v[160:163], v[144:147], v[200:203]
    v_mfma_f32_16x16x32_bf16 v[36:39], v[164:167], v[144:147], v[204:207]
    v_mfma_f32_16x16x32_bf16 v[40:43], v[164:167], v[148:151], v[200:203]
    v_mfma_f32_16x16x32_bf16 v[44:47], v[168:171], v[148:151], v[204:207]
    v_mfma_f32_16x16x32_bf16 v[56:59], v[132:135], v[192:195], v[196:199]
    v_mfma_f32_16x16x32_bf16 v[60:63], v[136:139], v[192:195], v[196:199]
    v_mfma_f32_16x16x32_bf16 v[64:67], v[140:143], v[192:195], v[196:199]
    v_mfma_f32_16x16x32_bf16 v[68:71], v[144:147], v[192:195], v[196:199]
    buffer_load_dwordx4 a[32:35], v253, s[8:11], s33 offen offset:1024
    v_mfma_f32_16x16x32_bf16 v[72:75], v[148:151], v[192:195], v[196:199]
    v_max3_f32 v92, v16, v17, v18
    v_max3_f32 v96, v19, v20, v21
    v_max3_f32 v93, v24, v25, v26
    v_max3_f32 v97, v27, v28, v29
    v_max3_f32 v94, v32, v33, v34
    v_max3_f32 v98, v35, v36, v37
    v_max3_f32 v95, v40, v41, v42
    v_max3_f32 v99, v43, v44, v45
    v_max3_f32 v92, v92, v22, v23
    buffer_load_dwordx4 a[36:39], v5, s[8:11], s34 offen offset:1024
    v_max3_f32 v93, v93, v30, v31
    v_max3_f32 v94, v94, v38, v39
    v_max3_f32 v95, v95, v46, v47
    v_max_f32 v92, v92, v96
    v_max_f32 v93, v93, v97
    v_max_f32 v94, v94, v98
    v_max_f32 v95, v95, v99
    s_mov_b32 s18, 0x3eae1a93
    v_cvt_pk_bf16_f32 v182, v56, v57
    v_permlane32_swap_b32 v92, v93
    buffer_load_dwordx4 a[40:43], v253, s[8:11], s32 offen offset:2048
    v_permlane32_swap_b32 v94, v95
    v_max_f32 v92, v92, v93
    v_max_f32 v94, v94, v95
    v_cvt_pk_bf16_f32 v183, v58, v59
    v_cvt_pk_bf16_f32 v184, v60, v61
    v_permlane16_swap_b32 v92, v94
    v_max_f32 v92, v92, v94
    v_mul_f32 v92, 0xbeae1a93, v92
    v_mov_b32 v94, v92
    v_cvt_pk_bf16_f32 v185, v62, v63
    buffer_load_dwordx4 a[44:47], v253, s[8:11], s33 offen offset:2048
    v_cvt_pk_bf16_f32 v186, v64, v65
    v_permlane16_swap_b32 v92, v94
    v_mov_b32 v93, v92
    v_mov_b32 v95, v94
    v_cvt_pk_bf16_f32 v187, v66, v67
    v_cvt_pk_bf16_f32 v188, v68, v69
    v_permlane32_swap_b32 v92, v93
    v_permlane32_swap_b32 v94, v95
    v_cvt_pk_bf16_f32 v189, v70, v71
    v_cvt_pk_bf16_f32 v190, v72, v73
    buffer_load_dwordx4 a[48:51], v5, s[8:11], s34 offen offset:2048
    v_cvt_pk_bf16_f32 v191, v74, v75
    v_fma_f32 v16, v16, s18, v92
    v_fma_f32 v17, v17, s18, v92
    v_fma_f32 v18, v18, s18, v92
    v_fma_f32 v19, v19, s18, v92
    v_fma_f32 v20, v20, s18, v92
    v_fma_f32 v21, v21, s18, v92
    v_fma_f32 v22, v22, s18, v92
    v_fma_f32 v23, v23, s18, v92
    v_exp_f32 v16, v16
    buffer_load_dwordx4 a[52:55], v253, s[8:11], s32 offen offset:3072
    s_add_u32 s32, s32, 4096
    v_exp_f32 v17, v17
    v_exp_f32 v18, v18
    v_exp_f32 v19, v19
    v_exp_f32 v20, v20
    v_exp_f32 v21, v21
    v_exp_f32 v22, v22
    v_exp_f32 v23, v23
    s_nop 0
    v_cvt_pk_bf16_f32 v76, v16, v17
    v_cvt_pk_bf16_f32 v77, v18, v19
    buffer_load_dwordx4 a[56:59], v253, s[8:11], s33 offen offset:3072
    s_add_u32 s33, s33, 4096
    v_cvt_pk_bf16_f32 v78, v20, v21
    v_cvt_pk_bf16_f32 v79, v22, v23
    v_fma_f32 v24, v24, s18, v93
    v_fma_f32 v25, v25, s18, v93
    v_fma_f32 v26, v26, s18, v93
    v_fma_f32 v27, v27, s18, v93
    v_fma_f32 v28, v28, s18, v93
    v_fma_f32 v29, v29, s18, v93
    v_fma_f32 v30, v30, s18, v93
    v_fma_f32 v31, v31, s18, v93
    buffer_load_dwordx4 a[60:63], v5, s[8:11], s34 offen offset:3072
    s_add_u32 s34, s34, 4096
    v_exp_f32 v24, v24
    v_exp_f32 v25, v25
    v_exp_f32 v26, v26
    v_exp_f32 v27, v27
    v_exp_f32 v28, v28
    v_exp_f32 v29, v29
    v_exp_f32 v30, v30
    v_exp_f32 v31, v31
    v_mfma_f32_16x16x32_bf16 v[100:103], v[172:175], v[76:79], 0
    v_mfma_f32_16x16x32_bf16 v[116:119], v[182:185], v[76:79], 0
    buffer_load_dwordx4 a[64:67], v253, s[8:11], s32 offen offset:0
    v_cvt_pk_bf16_f32 v80, v24, v25
    v_cvt_pk_bf16_f32 v81, v26, v27
    v_cvt_pk_bf16_f32 v82, v28, v29
    v_cvt_pk_bf16_f32 v83, v30, v31
    v_fma_f32 v32, v32, s18, v94
    v_fma_f32 v33, v33, s18, v94
    v_fma_f32 v34, v34, s18, v94
    v_fma_f32 v35, v35, s18, v94
    v_fma_f32 v36, v36, s18, v94
    v_fma_f32 v37, v37, s18, v94
    buffer_load_dwordx4 a[68:71], v253, s[8:11], s33 offen offset:0
    v_fma_f32 v38, v38, s18, v94
    v_fma_f32 v39, v39, s18, v94
    v_exp_f32 v32, v32
    v_exp_f32 v33, v33
    v_exp_f32 v34, v34
    v_exp_f32 v35, v35
    v_exp_f32 v36, v36
    v_exp_f32 v37, v37
    v_exp_f32 v38, v38
    v_exp_f32 v39, v39
    buffer_load_dwordx4 a[72:75], v5, s[8:11], s34 offen offset:0
    v_mfma_f32_16x16x32_bf16 v[104:107], v[174:177], v[80:83], 0
    v_mfma_f32_16x16x32_bf16 v[120:123], v[184:187], v[80:83], 0
    v_cvt_pk_bf16_f32 v84, v32, v33
    v_cvt_pk_bf16_f32 v85, v34, v35
    v_cvt_pk_bf16_f32 v86, v36, v37
    v_cvt_pk_bf16_f32 v87, v38, v39
    v_fma_f32 v40, v40, s18, v95
    v_fma_f32 v41, v41, s18, v95
    v_fma_f32 v42, v42, s18, v95
    v_fma_f32 v43, v43, s18, v95
    buffer_load_dwordx4 a[76:79], v253, s[8:11], s32 offen offset:1024
    v_fma_f32 v44, v44, s18, v95
    v_fma_f32 v45, v45, s18, v95
    v_fma_f32 v46, v46, s18, v95
    v_fma_f32 v47, v47, s18, v95
    v_exp_f32 v40, v40
    v_exp_f32 v41, v41
    v_exp_f32 v42, v42
    v_exp_f32 v43, v43
    v_exp_f32 v44, v44
    v_exp_f32 v45, v45
    buffer_load_dwordx4 a[80:83], v253, s[8:11], s33 offen offset:1024
    v_exp_f32 v46, v46
    v_exp_f32 v47, v47
    v_mfma_f32_16x16x32_bf16 v[108:111], v[176:179], v[84:87], 0
    v_mfma_f32_16x16x32_bf16 v[124:127], v[186:189], v[84:87], 0
    v_cvt_pk_bf16_f32 v88, v40, v41
    v_cvt_pk_bf16_f32 v89, v42, v43
    v_cvt_pk_bf16_f32 v90, v44, v45
    v_cvt_pk_bf16_f32 v91, v46, v47
    v_rcp_f32 v96, v118
    v_rcp_f32 v97, v122
    buffer_load_dwordx4 a[84:87], v5, s[8:11], s34 offen offset:1024
    v_mfma_f32_16x16x32_bf16 v[112:115], v[178:181], v[88:91], 0
    v_mfma_f32_16x16x32_bf16 v[128:131], v[188:191], v[88:91], 0
    v_pk_mul_f32 v[100:101], v[96:97], v[100:101] op_sel:[0,0] op_sel_hi:[0,1]
    v_pk_mul_f32 v[102:103], v[96:97], v[102:103] op_sel:[0,0] op_sel_hi:[0,1]
    v_pk_mul_f32 v[116:117], v[96:97], v[116:117] op_sel:[0,0] op_sel_hi:[0,1]
    v_cvt_pk_bf16_f32 v212, v100, v101
    v_cvt_pk_bf16_f32 v213, v102, v103
    v_cvt_pk_bf16_f32 v220, v116, v117
    v_rcp_f32 v98, v126
    v_pk_mul_f32 v[104:105], v[96:97], v[104:105] op_sel:[1,0] op_sel_hi:[1,1]
    buffer_load_dwordx4 v[240:243], v9, s[8:11], s37 offen offset:0 sc1
    v_pk_mul_f32 v[106:107], v[96:97], v[106:107] op_sel:[1,0] op_sel_hi:[1,1]
    v_pk_mul_f32 v[120:121], v[96:97], v[120:121] op_sel:[1,0] op_sel_hi:[1,1]
    v_cvt_pk_bf16_f32 v214, v104, v105
    v_cvt_pk_bf16_f32 v215, v106, v107
    v_cvt_pk_bf16_f32 v221, v120, v121
    v_rcp_f32 v99, v130
    v_permlane16_swap_b32 v212, v214
    v_permlane16_swap_b32 v213, v215
    v_pk_mul_f32 v[108:109], v[98:99], v[108:109] op_sel:[0,0] op_sel_hi:[0,1]
    v_pk_mul_f32 v[110:111], v[98:99], v[110:111] op_sel:[0,0] op_sel_hi:[0,1]
    buffer_load_dwordx4 v[244:247], v9, s[8:11], s37 offen offset:1024 sc1
    v_pk_mul_f32 v[124:125], v[98:99], v[124:125] op_sel:[0,0] op_sel_hi:[0,1]
    v_cvt_pk_bf16_f32 v216, v108, v109
    v_cvt_pk_bf16_f32 v217, v110, v111
    v_cvt_pk_bf16_f32 v222, v124, v125
    v_pk_mul_f32 v[112:113], v[98:99], v[112:113] op_sel:[1,0] op_sel_hi:[1,1]
    v_pk_mul_f32 v[114:115], v[98:99], v[114:115] op_sel:[1,0] op_sel_hi:[1,1]
    v_pk_mul_f32 v[128:129], v[98:99], v[128:129] op_sel:[1,0] op_sel_hi:[1,1]
    v_cvt_pk_bf16_f32 v218, v112, v113
    v_cvt_pk_bf16_f32 v219, v114, v115
    v_cvt_pk_bf16_f32 v223, v128, v129
    buffer_load_dwordx4 v[248:251], v7, s[8:11], s37 offen offset:2048 sc1
    s_lshl_b32 s7, s3, 2
    s_add_u32 s7, s7, 94208
    v_permlane16_swap_b32 v220, v221
    v_permlane16_swap_b32 v222, v223
    v_add_u32 v11, s7, v253
    v_lshrrev_b32 v10, 3, v0
    v_permlane32_swap_b32 v220, v222
    v_mul_u32_u24 v10, 9216, v10
    ds_write_b32 v11, v220
    v_permlane16_swap_b32 v216, v218
    buffer_load_dword v252, v8, s[8:11], s47 offen sc1
    v_permlane16_swap_b32 v217, v219
    s_mul_i32 s7, s40, 1152
    s_add_u32 s22, s22, s7
    s_add_u32 s22, s22, 22282240
    s_lshl_b32 s7, s3, 8
    s_add_u32 s23, s22, s7
    s_add_u32 s24, s23, 36864
    buffer_store_dwordx4 v[212:215], v9, s[8:11], s23 offen sc1
    buffer_store_dwordx4 v[216:219], v9, s[8:11], s24 offen sc1
    v_and_b32 v11, 7, v0
    v_lshl_add_u32 v10, v11, 4, v10
    s_cmp_eq_u32 s3, 3
    s_cselect_b32 s7, 0, 1073741824
    v_add_u32 v10, s7, v10
    v_add_u32 v11, 94208, v253
    s_waitcnt lgkmcnt(0)
    s_barrier
    ds_read_b128 v[220:223], v11
    s_waitcnt lgkmcnt(0)
    buffer_store_dwordx4 v[220:223], v10, s[8:11], s22 offen offset:1024 sc1
    v_lshlrev_b32 v15, 7, v0
    s_lshl_b32 s6, s40, 2
    s_add_u32 s6, s6, s44
    v_mov_b32 v1, 1
    s_mov_b64 vcc, 0xff
    s_waitcnt vmcnt(0)
    s_barrier
    s_cmp_lg_u32 s3, 0
    s_cbranch_scc1 L_pub_7
    s_mov_b64 exec, vcc
    buffer_store_dword v1, v15, s[8:11], s6 offen sc1
    s_mov_b64 exec, -1
L_pub_7:
    s_and_b32 s7, s3, 1
    s_mul_i32 s7, s7, 18432
    s_add_u32 s24, s30, s7
    s_lshr_b32 s7, s3, 1
    s_lshl_b32 s7, s7, 9
    s_add_u32 s24, s24, s7
    s_add_u32 s24, s24, 22282240
    s_mov_b32 s16, 0xffff0000
    v_lshlrev_b32 v124, 16, v240
    v_and_b32 v125, s16, v240
    v_lshlrev_b32 v126, 16, v241
    v_and_b32 v127, s16, v241
    v_lshlrev_b32 v128, 16, v242
    v_and_b32 v129, s16, v242
    v_lshlrev_b32 v130, 16, v243
    v_and_b32 v131, s16, v243
    v_lshlrev_b32 v132, 16, v244
    v_and_b32 v133, s16, v244
    v_lshlrev_b32 v134, 16, v245
    v_and_b32 v135, s16, v245
    v_lshlrev_b32 v136, 16, v246
    v_and_b32 v137, s16, v246
    v_lshlrev_b32 v138, 16, v247
    v_and_b32 v139, s16, v247
    v_lshlrev_b32 v140, 16, v248
    v_and_b32 v141, s16, v248
    v_lshlrev_b32 v142, 16, v249
    v_and_b32 v143, s16, v249
    v_lshlrev_b32 v144, 16, v250
    v_and_b32 v145, s16, v250
    v_lshlrev_b32 v146, 16, v251
    v_and_b32 v147, s16, v251
    s_cmp_eq_u32 s3, 1
    s_cselect_b32 s7, 16, 0
    v_lshlrev_b32 v12, 2, v0
    v_cmp_gt_u32 vcc, s7, v0
    v_add_u32 v10, 40960, v12
    v_add_u32 v11, 41472, v12
    v_cndmask_b32 v10, v11, v10, vcc
    v_and_b32 v11, 0x7c, v12
    v_cmp_gt_u32 vcc, 32, v0
    v_mov_b32 v13, 1073741824
    s_and_b32 s7, s40, 3
    s_lshl_b32 s45, s45, 2
    v_cndmask_b32 v8, v13, v12, vcc
    s_add_u32 s6, s7, s3
    s_cmp_eq_u32 s6, 0
    s_cselect_b32 s6, 0, 1073741824
    v_add_u32 v6, s6, v8
    s_add_u32 s45, s45, s7
    s_lshl_b32 s45, s45, 2
    s_add_u32 s45, s45, s3
    s_lshl_b32 s45, s45, 7
    s_add_u32 s45, s45, s43
    s_add_u32 s45, s45, 50659328
    s_cmp_eq_u32 s3, 0
    s_cselect_b32 s35, 1.0, 0
    s_lshl_b32 s7, s40, 2
    s_add_u32 s7, s7, s3
    s_mul_i32 s23, s7, 497664
    s_add_u32 s23, s23, 3145728
    s_add_u32 s50, s23, 497664
    v_mov_b32 v184, v253
    v_add_u32 v185, 4096, v253
    v_add_u32 v186, 8192, v253
    v_add_u32 v187, 12288, v253
    v_add_u32 v188, 16384, v253
    v_add_u32 v189, 20480, v253
    v_add_u32 v190, 24576, v253
    v_add_u32 v191, 28672, v253
    v_add_u32 v192, 32768, v253
    s_cmp_lg_u32 s3, 0
    s_cbranch_scc1 L_polled_9
    s_lshl_b32 s7, s40, 7
    s_add_u32 s7, s7, s44
    s_add_u32 s52, s4, s7
    s_addc_u32 s53, s5, 0
    s_mov_b32 s6, 0
L_poll_8:
    s_load_dwordx8 s[56:63], s[52:53], 0 glc
    s_add_u32 s6, s6, 1
    s_waitcnt lgkmcnt(0)
    s_and_b64 s[56:57], s[56:57], s[58:59]
    s_and_b64 s[60:61], s[60:61], s[62:63]
    s_and_b64 s[56:57], s[56:57], s[60:61]
    s_and_b32 s56, s56, s57
    s_cbranch_scc1 L_polled_9
    s_cmp_ge_u32 s6, 1048576
    s_cbranch_scc1 L_main_end
    s_branch L_poll_8
L_polled_9:
    s_barrier
    s_lshl_b32 m0, s3, 10
    s_nop 0
    buffer_load_dwordx4 v2, s[8:11], s24 offen sc1 lds
    s_add_u32 m0, m0, 4096
    s_add_u32 s24, s24, 1024
    buffer_load_dwordx4 v2, s[8:11], s24 offen sc1 lds
    s_add_u32 m0, m0, 4096
    s_add_u32 s24, s24, 1024
    buffer_load_dwordx4 v2, s[8:11], s24 offen sc1 lds
    s_add_u32 m0, m0, 4096
    s_add_u32 s24, s24, 1024
    buffer_load_dwordx4 v2, s[8:11], s24 offen sc1 lds
    s_add_u32 m0, m0, 4096
    s_add_u32 s24, s24, 1024
    buffer_load_dwordx4 v2, s[8:11], s24 offen sc1 lds
    s_add_u32 m0, m0, 4096
    s_add_u32 s24, s24, 1024
    buffer_load_dwordx4 v2, s[8:11], s24 offen sc1 lds
    s_add_u32 m0, m0, 4096
    s_add_u32 s24, s24, 1024
    buffer_load_dwordx4 v2, s[8:11], s24 offen sc1 lds
    s_add_u32 m0, m0, 4096
    s_add_u32 s24, s24, 1024
    buffer_load_dwordx4 v2, s[8:11], s24 offen sc1 lds
    s_add_u32 m0, m0, 4096
    s_add_u32 s24, s24, 1024
    buffer_load_dwordx4 v2, s[8:11], s24 offen sc1 lds
    s_waitcnt vmcnt(0)
    s_barrier
    ds_read_b128 v[160:163], v253 offset:0
    ds_read_b128 v[164:167], v253 offset:1024
    s_waitcnt lgkmcnt(0)
    v_mfma_f32_16x16x32_bf16 v[100:103], a[160:163], v[160:163], 0
    ds_read_b128 v[168:171], v253 offset:2048
    v_mfma_f32_16x16x32_bf16 v[104:107], a[160:163], v[164:167], 0
    ds_read_b128 v[172:175], v253 offset:3072
    v_mfma_f32_16x16x32_bf16 v[108:111], a[164:167], v[160:163], 0
    v_mfma_f32_16x16x32_bf16 v[112:115], a[164:167], v[164:167], 0
    buffer_load_dwordx4 v[16:19], v184, s[48:51], s23 offen offset:0
    v_mfma_f32_16x16x32_bf16 v[116:119], a[168:171], v[160:163], 0
    v_mfma_f32_16x16x32_bf16 v[120:123], a[168:171], v[164:167], 0
    s_waitcnt lgkmcnt(0)
    v_mfma_f32_16x16x32_bf16 v[100:103], a[172:175], v[168:171], v[100:103]
    ds_read_b128 v[160:163], v253 offset:4096
    v_mfma_f32_16x16x32_bf16 v[104:107], a[172:175], v[172:175], v[104:107]
    ds_read_b128 v[164:167], v253 offset:5120
    v_mfma_f32_16x16x32_bf16 v[108:111], a[176:179], v[168:171], v[108:111]
    v_mfma_f32_16x16x32_bf16 v[112:115], a[176:179], v[172:175], v[112:115]
    buffer_load_dwordx4 v[20:23], v184, s[48:51], s23 offen offset:1024
    v_mfma_f32_16x16x32_bf16 v[116:119], a[180:183], v[168:171], v[116:119]
    v_mfma_f32_16x16x32_bf16 v[120:123], a[180:183], v[172:175], v[120:123]
    s_waitcnt lgkmcnt(0)
    v_mfma_f32_16x16x32_bf16 v[100:103], a[184:187], v[160:163], v[100:103]
    ds_read_b128 v[168:171], v253 offset:6144
    v_mfma_f32_16x16x32_bf16 v[104:107], a[184:187], v[164:167], v[104:107]
    ds_read_b128 v[172:175], v253 offset:7168
    v_mfma_f32_16x16x32_bf16 v[108:111], a[188:191], v[160:163], v[108:111]
    v_mfma_f32_16x16x32_bf16 v[112:115], a[188:191], v[164:167], v[112:115]
    buffer_load_dwordx4 v[24:27], v184, s[48:51], s23 offen offset:2048
    v_mfma_f32_16x16x32_bf16 v[116:119], a[192:195], v[160:163], v[116:119]
    v_mfma_f32_16x16x32_bf16 v[120:123], a[192:195], v[164:167], v[120:123]
    s_waitcnt lgkmcnt(0)
    v_mfma_f32_16x16x32_bf16 v[100:103], a[196:199], v[168:171], v[100:103]
    ds_read_b128 v[160:163], v253 offset:8192
    v_mfma_f32_16x16x32_bf16 v[104:107], a[196:199], v[172:175], v[104:107]
    ds_read_b128 v[164:167], v253 offset:9216
    v_mfma_f32_16x16x32_bf16 v[108:111], a[200:203], v[168:171], v[108:111]
    v_mfma_f32_16x16x32_bf16 v[112:115], a[200:203], v[172:175], v[112:115]
    buffer_load_dwordx4 v[28:31], v184, s[48:51], s23 offen offset:3072
    v_mfma_f32_16x16x32_bf16 v[116:119], a[204:207], v[168:171], v[116:119]
    v_mfma_f32_16x16x32_bf16 v[120:123], a[204:207], v[172:175], v[120:123]
    s_waitcnt lgkmcnt(0)
    v_mfma_f32_16x16x32_bf16 v[100:103], a[208:211], v[160:163], v[100:103]
    ds_read_b128 v[168:171], v253 offset:10240
    v_mfma_f32_16x16x32_bf16 v[104:107], a[208:211], v[164:167], v[104:107]
    ds_read_b128 v[172:175], v253 offset:11264
    v_mfma_f32_16x16x32_bf16 v[108:111], a[212:215], v[160:163], v[108:111]
    v_mfma_f32_16x16x32_bf16 v[112:115], a[212:215], v[164:167], v[112:115]
    buffer_load_dwordx4 v[32:35], v185, s[48:51], s23 offen offset:0
    v_mfma_f32_16x16x32_bf16 v[116:119], a[216:219], v[160:163], v[116:119]
    v_mfma_f32_16x16x32_bf16 v[120:123], a[216:219], v[164:167], v[120:123]
    s_waitcnt lgkmcnt(0)
    v_mfma_f32_16x16x32_bf16 v[100:103], a[220:223], v[168:171], v[100:103]
    ds_read_b128 v[160:163], v253 offset:12288
    v_mfma_f32_16x16x32_bf16 v[104:107], a[220:223], v[172:175], v[104:107]
    ds_read_b128 v[164:167], v253 offset:13312
    v_mfma_f32_16x16x32_bf16 v[108:111], a[224:227], v[168:171], v[108:111]
    v_mfma_f32_16x16x32_bf16 v[112:115], a[224:227], v[172:175], v[112:115]
    buffer_load_dwordx4 v[36:39], v185, s[48:51], s23 offen offset:1024
    v_mfma_f32_16x16x32_bf16 v[116:119], a[228:231], v[168:171], v[116:119]
    v_mfma_f32_16x16x32_bf16 v[120:123], a[228:231], v[172:175], v[120:123]
    s_waitcnt lgkmcnt(0)
    v_mfma_f32_16x16x32_bf16 v[100:103], a[232:235], v[160:163], v[100:103]
    ds_read_b128 v[168:171], v253 offset:14336
    v_mfma_f32_16x16x32_bf16 v[104:107], a[232:235], v[164:167], v[104:107]
    ds_read_b128 v[172:175], v253 offset:15360
    v_mfma_f32_16x16x32_bf16 v[108:111], a[236:239], v[160:163], v[108:111]
    v_mfma_f32_16x16x32_bf16 v[112:115], a[236:239], v[164:167], v[112:115]
    buffer_load_dwordx4 v[40:43], v185, s[48:51], s23 offen offset:2048
    v_mfma_f32_16x16x32_bf16 v[116:119], a[240:243], v[160:163], v[116:119]
    v_mfma_f32_16x16x32_bf16 v[120:123], a[240:243], v[164:167], v[120:123]
    s_waitcnt lgkmcnt(0)
    v_mfma_f32_16x16x32_bf16 v[100:103], a[244:247], v[168:171], v[100:103]
    ds_read_b128 v[160:163], v253 offset:16384
    v_mfma_f32_16x16x32_bf16 v[104:107], a[244:247], v[172:175], v[104:107]
    ds_read_b128 v[164:167], v253 offset:17408
    v_mfma_f32_16x16x32_bf16 v[108:111], a[248:251], v[168:171], v[108:111]
    v_mfma_f32_16x16x32_bf16 v[112:115], a[248:251], v[172:175], v[112:115]
    buffer_load_dwordx4 v[44:47], v185, s[48:51], s23 offen offset:3072
    v_mfma_f32_16x16x32_bf16 v[116:119], a[252:255], v[168:171], v[116:119]
    v_mfma_f32_16x16x32_bf16 v[120:123], a[252:255], v[172:175], v[120:123]
    s_waitcnt lgkmcnt(0)
    v_mfma_f32_16x16x32_bf16 v[100:103], a[128:131], v[160:163], v[100:103]
    ds_read_b128 v[168:171], v253 offset:18432
    v_mfma_f32_16x16x32_bf16 v[104:107], a[128:131], v[164:167], v[104:107]
    ds_read_b128 v[172:175], v253 offset:19456
    v_mfma_f32_16x16x32_bf16 v[108:111], a[132:135], v[160:163], v[108:111]
    v_mfma_f32_16x16x32_bf16 v[112:115], a[132:135], v[164:167], v[112:115]
    buffer_load_dwordx4 v[48:51], v186, s[48:51], s23 offen offset:0
    v_mfma_f32_16x16x32_bf16 v[116:119], a[136:139], v[160:163], v[116:119]
    v_mfma_f32_16x16x32_bf16 v[120:123], a[136:139], v[164:167], v[120:123]
    s_waitcnt lgkmcnt(0)
    v_mfma_f32_16x16x32_bf16 v[100:103], a[140:143], v[168:171], v[100:103]
    ds_read_b128 v[160:163], v253 offset:20480
    v_mfma_f32_16x16x32_bf16 v[104:107], a[140:143], v[172:175], v[104:107]
    ds_read_b128 v[164:167], v253 offset:21504
    v_mfma_f32_16x16x32_bf16 v[108:111], a[144:147], v[168:171], v[108:111]
    v_mfma_f32_16x16x32_bf16 v[112:115], a[144:147], v[172:175], v[112:115]
    buffer_load_dwordx4 v[52:55], v186, s[48:51], s23 offen offset:1024
    v_mfma_f32_16x16x32_bf16 v[116:119], a[148:151], v[168:171], v[116:119]
    v_mfma_f32_16x16x32_bf16 v[120:123], a[148:151], v[172:175], v[120:123]
    s_waitcnt lgkmcnt(0)
    v_mfma_f32_16x16x32_bf16 v[100:103], a[152:155], v[160:163], v[100:103]
    ds_read_b128 v[168:171], v253 offset:22528
    v_mfma_f32_16x16x32_bf16 v[104:107], a[152:155], v[164:167], v[104:107]
    ds_read_b128 v[172:175], v253 offset:23552
    v_mfma_f32_16x16x32_bf16 v[108:111], a[156:159], v[160:163], v[108:111]
    v_mfma_f32_16x16x32_bf16 v[112:115], a[156:159], v[164:167], v[112:115]
    buffer_load_dwordx4 v[56:59], v186, s[48:51], s23 offen offset:2048
    v_mfma_f32_16x16x32_bf16 v[116:119], a[0:3], v[160:163], v[116:119]
    v_mfma_f32_16x16x32_bf16 v[120:123], a[0:3], v[164:167], v[120:123]
    s_waitcnt lgkmcnt(0)
    v_mfma_f32_16x16x32_bf16 v[100:103], a[4:7], v[168:171], v[100:103]
    ds_read_b128 v[160:163], v253 offset:24576
    v_mfma_f32_16x16x32_bf16 v[104:107], a[4:7], v[172:175], v[104:107]
    ds_read_b128 v[164:167], v253 offset:25600
    v_mfma_f32_16x16x32_bf16 v[108:111], a[8:11], v[168:171], v[108:111]
    v_mfma_f32_16x16x32_bf16 v[112:115], a[8:11], v[172:175], v[112:115]
    buffer_load_dwordx4 v[60:63], v186, s[48:51], s23 offen offset:3072
    v_mfma_f32_16x16x32_bf16 v[116:119], a[12:15], v[168:171], v[116:119]
    v_mfma_f32_16x16x32_bf16 v[120:123], a[12:15], v[172:175], v[120:123]
    s_waitcnt lgkmcnt(0)
    v_mfma_f32_16x16x32_bf16 v[100:103], a[16:19], v[160:163], v[100:103]
    ds_read_b128 v[168:171], v253 offset:26624
    v_mfma_f32_16x16x32_bf16 v[104:107], a[16:19], v[164:167], v[104:107]
    ds_read_b128 v[172:175], v253 offset:27648
    v_mfma_f32_16x16x32_bf16 v[108:111], a[20:23], v[160:163], v[108:111]
    v_mfma_f32_16x16x32_bf16 v[112:115], a[20:23], v[164:167], v[112:115]
    buffer_load_dwordx4 v[64:67], v187, s[48:51], s23 offen offset:0
    v_mfma_f32_16x16x32_bf16 v[116:119], a[24:27], v[160:163], v[116:119]
    v_mfma_f32_16x16x32_bf16 v[120:123], a[24:27], v[164:167], v[120:123]
    s_waitcnt lgkmcnt(0)
    v_mfma_f32_16x16x32_bf16 v[100:103], a[28:31], v[168:171], v[100:103]
    ds_read_b128 v[160:163], v253 offset:28672
    v_mfma_f32_16x16x32_bf16 v[104:107], a[28:31], v[172:175], v[104:107]
    ds_read_b128 v[164:167], v253 offset:29696
    v_mfma_f32_16x16x32_bf16 v[108:111], a[32:35], v[168:171], v[108:111]
    v_mfma_f32_16x16x32_bf16 v[112:115], a[32:35], v[172:175], v[112:115]
    buffer_load_dwordx4 v[68:71], v187, s[48:51], s23 offen offset:1024
    v_mfma_f32_16x16x32_bf16 v[116:119], a[36:39], v[168:171], v[116:119]
    v_mfma_f32_16x16x32_bf16 v[120:123], a[36:39], v[172:175], v[120:123]
    s_waitcnt lgkmcnt(0)
    v_mfma_f32_16x16x32_bf16 v[100:103], a[40:43], v[160:163], v[100:103]
    ds_read_b128 v[168:171], v253 offset:30720
    v_mfma_f32_16x16x32_bf16 v[104:107], a[40:43], v[164:167], v[104:107]
    ds_read_b128 v[172:175], v253 offset:31744
    v_mfma_f32_16x16x32_bf16 v[108:111], a[44:47], v[160:163], v[108:111]
    v_mfma_f32_16x16x32_bf16 v[112:115], a[44:47], v[164:167], v[112:115]
    buffer_load_dwordx4 v[72:75], v187, s[48:51], s23 offen offset:2048
    v_mfma_f32_16x16x32_bf16 v[116:119], a[48:51], v[160:163], v[116:119]
    v_mfma_f32_16x16x32_bf16 v[120:123], a[48:51], v[164:167], v[120:123]
    s_waitcnt lgkmcnt(0)
    v_mfma_f32_16x16x32_bf16 v[100:103], a[52:55], v[168:171], v[100:103]
    ds_read_b128 v[160:163], v253 offset:32768
    v_mfma_f32_16x16x32_bf16 v[104:107], a[52:55], v[172:175], v[104:107]
    ds_read_b128 v[164:167], v253 offset:33792
    v_mfma_f32_16x16x32_bf16 v[108:111], a[56:59], v[168:171], v[108:111]
    v_mfma_f32_16x16x32_bf16 v[112:115], a[56:59], v[172:175], v[112:115]
    v_mfma_f32_16x16x32_bf16 v[116:119], a[60:63], v[168:171], v[116:119]
    v_mfma_f32_16x16x32_bf16 v[120:123], a[60:63], v[172:175], v[120:123]
    s_waitcnt lgkmcnt(0)
    v_mfma_f32_16x16x32_bf16 v[100:103], a[64:67], v[160:163], v[100:103]
    ds_read_b128 v[168:171], v253 offset:34816
    v_mfma_f32_16x16x32_bf16 v[104:107], a[64:67], v[164:167], v[104:107]
    ds_read_b128 v[172:175], v253 offset:35840
    v_mfma_f32_16x16x32_bf16 v[108:111], a[68:71], v[160:163], v[108:111]
    v_mfma_f32_16x16x32_bf16 v[112:115], a[68:71], v[164:167], v[112:115]
    v_mfma_f32_16x16x32_bf16 v[116:119], a[72:75], v[160:163], v[116:119]
    v_mfma_f32_16x16x32_bf16 v[120:123], a[72:75], v[164:167], v[120:123]
    s_waitcnt lgkmcnt(0)
    v_mfma_f32_16x16x32_bf16 v[100:103], a[76:79], v[168:171], v[100:103]
    v_mfma_f32_16x16x32_bf16 v[104:107], a[76:79], v[172:175], v[104:107]
    v_mfma_f32_16x16x32_bf16 v[108:111], a[80:83], v[168:171], v[108:111]
    v_mfma_f32_16x16x32_bf16 v[112:115], a[80:83], v[172:175], v[112:115]
    v_mfma_f32_16x16x32_bf16 v[116:119], a[84:87], v[168:171], v[116:119]
    v_mfma_f32_16x16x32_bf16 v[120:123], a[84:87], v[172:175], v[120:123]
    s_nop 3
    v_permlane16_swap_b32 v100, v104
    v_permlane16_swap_b32 v101, v105
    v_permlane16_swap_b32 v102, v106
    v_permlane16_swap_b32 v103, v107
    v_add_f32 v12, v116, v117
    v_add_f32 v13, v120, v121
    ds_write_b32 v10, v12
    ds_write_b32 v10, v13 offset:64
    v_permlane16_swap_b32 v108, v112
    v_permlane16_swap_b32 v109, v113
    v_permlane16_swap_b32 v110, v114
    v_permlane16_swap_b32 v111, v115
    v_permlane16_swap_b32 v116, v120
    v_permlane16_swap_b32 v117, v121
    v_permlane16_swap_b32 v118, v122
    v_permlane16_swap_b32 v119, v123
    s_waitcnt lgkmcnt(0)
    s_barrier
    ds_read_b32 v12, v11 offset:40960
    v_pk_add_f32 v[124:125], v[124:125], v[100:101]
    v_pk_add_f32 v[126:127], v[126:127], v[102:103]
    v_pk_add_f32 v[128:129], v[128:129], v[104:105]
    v_pk_add_f32 v[130:131], v[130:131], v[106:107]
    v_pk_add_f32 v[132:133], v[132:133], v[108:109]
    v_pk_add_f32 v[134:135], v[134:135], v[110:111]
    v_pk_add_f32 v[136:137], v[136:137], v[112:113]
    v_pk_add_f32 v[138:139], v[138:139], v[114:115]
    v_pk_add_f32 v[140:141], v[140:141], v[116:117]
    v_pk_add_f32 v[142:143], v[142:143], v[118:119]
    v_pk_add_f32 v[144:145], v[144:145], v[120:121]
    v_pk_add_f32 v[146:147], v[146:147], v[122:123]
    v_mov_b32 v14, 0
    v_mov_b32 v15, 0
    s_waitcnt lgkmcnt(0)
    v_add_f32 v12, v12, v252
    v_pk_add_f32 v[100:101], v[124:125], v[12:13] op_sel_hi:[1,0] neg_lo:[0,1] neg_hi:[0,1]
    v_pk_add_f32 v[102:103], v[126:127], v[12:13] op_sel_hi:[1,0] neg_lo:[0,1] neg_hi:[0,1]
    v_pk_add_f32 v[104:105], v[128:129], v[12:13] op_sel_hi:[1,0] neg_lo:[0,1] neg_hi:[0,1]
    v_pk_add_f32 v[106:107], v[130:131], v[12:13] op_sel_hi:[1,0] neg_lo:[0,1] neg_hi:[0,1]
    v_cvt_pk_bf16_f32 v148, v100, v101
    v_cvt_pk_bf16_f32 v149, v102, v103
    v_cvt_pk_bf16_f32 v150, v104, v105
    v_cvt_pk_bf16_f32 v151, v106, v107
    buffer_store_dwordx4 v[148:151], v9, s[8:11], s46 offen offset:0 sc1
    v_pk_add_f32 v[108:109], v[132:133], v[12:13] op_sel_hi:[1,0] neg_lo:[0,1] neg_hi:[0,1]
    v_pk_add_f32 v[110:111], v[134:135], v[12:13] op_sel_hi:[1,0] neg_lo:[0,1] neg_hi:[0,1]
    v_pk_add_f32 v[112:113], v[136:137], v[12:13] op_sel_hi:[1,0] neg_lo:[0,1] neg_hi:[0,1]
    v_pk_add_f32 v[114:115], v[138:139], v[12:13] op_sel_hi:[1,0] neg_lo:[0,1] neg_hi:[0,1]
    v_cvt_pk_bf16_f32 v152, v108, v109
    v_cvt_pk_bf16_f32 v153, v110, v111
    v_cvt_pk_bf16_f32 v154, v112, v113
    v_cvt_pk_bf16_f32 v155, v114, v115
    buffer_store_dwordx4 v[152:155], v9, s[8:11], s46 offen offset:1024 sc1
    v_pk_add_f32 v[116:117], v[140:141], v[12:13] op_sel_hi:[1,0] neg_lo:[0,1] neg_hi:[0,1]
    v_pk_add_f32 v[118:119], v[142:143], v[12:13] op_sel_hi:[1,0] neg_lo:[0,1] neg_hi:[0,1]
    v_pk_add_f32 v[120:121], v[144:145], v[12:13] op_sel_hi:[1,0] neg_lo:[0,1] neg_hi:[0,1]
    v_pk_add_f32 v[122:123], v[146:147], v[12:13] op_sel_hi:[1,0] neg_lo:[0,1] neg_hi:[0,1]
    v_cvt_pk_bf16_f32 v156, v116, v117
    v_cvt_pk_bf16_f32 v157, v118, v119
    v_cvt_pk_bf16_f32 v158, v120, v121
    v_cvt_pk_bf16_f32 v159, v122, v123
    buffer_store_dwordx4 v[156:159], v7, s[8:11], s46 offen offset:2048 sc1
    v_dot2c_f32_bf16 v14, v148, v148
    v_dot2c_f32_bf16 v14, v149, v149
    v_dot2c_f32_bf16 v14, v150, v150
    v_dot2c_f32_bf16 v14, v151, v151
    v_dot2c_f32_bf16 v14, v152, v152
    v_dot2c_f32_bf16 v14, v153, v153
    v_dot2c_f32_bf16 v14, v154, v154
    v_dot2c_f32_bf16 v14, v155, v155
    v_dot2c_f32_bf16 v15, v156, v156
    v_dot2c_f32_bf16 v15, v157, v157
    v_dot2c_f32_bf16 v15, v158, v158
    v_dot2c_f32_bf16 v15, v159, v159
    buffer_store_dword v12, v6, s[8:11], s36 offen sc1
    s_nop 1
    v_fma_f32 v14, v15, s35, v14
    v_mov_b32 v15, v14
    s_nop 1
    v_permlane32_swap_b32 v14, v15
    v_add_f32 v14, v14, v15
    buffer_store_dword v14, v8, s[8:11], s45 offen sc1
    v_lshlrev_b32 v15, 7, v0
    s_lshl_b32 s6, s40, 2
    s_add_u32 s6, s6, s44
    s_add_u32 s6, s6, 32768
    v_mov_b32 v1, 1
    s_mov_b64 vcc, 0xff
    s_waitcnt vmcnt(0)
    s_barrier
    s_cmp_lg_u32 s3, 0
    s_cbranch_scc1 L_pub_10
    s_mov_b64 exec, vcc
    buffer_store_dword v1, v15, s[8:11], s6 offen sc1
    s_mov_b64 exec, -1
L_pub_10:
    s_add_u32 s23, s23, 15360
    s_lshl_b32 s7, s41, 2
    s_add_u32 s7, s7, s3
    s_mul_i32 s22, s7, 18432
    s_add_u32 s22, s22, s43
    s_add_u32 s22, s22, 48234496
    s_mul_i32 s24, s3, 18432
    s_lshl_b32 s25, s41, 12
    s_add_u32 s25, s25, s43
    s_add_u32 s25, s25, 50659328
    v_lshrrev_b32 v3, 5, v0
    v_and_b32 v10, 31, v0
    v_lshlrev_b32 v10, 2, v10
    v_lshl_add_u32 v3, v3, 11, v10
    v_add_u32 v11, 36864, v184
    s_cmp_lg_u32 s3, 0
    s_cbranch_scc1 L_polled_12
    s_lshl_b32 s7, s40, 7
    s_add_u32 s7, s7, s44
    s_add_u32 s7, s7, 32768
    s_add_u32 s52, s4, s7
    s_addc_u32 s53, s5, 0
    s_mov_b32 s6, 0
L_poll_11:
    s_load_dwordx8 s[56:63], s[52:53], 0 glc
    s_add_u32 s6, s6, 1
    s_waitcnt lgkmcnt(0)
    s_and_b64 s[56:57], s[56:57], s[58:59]
    s_and_b64 s[60:61], s[60:61], s[62:63]
    s_and_b64 s[56:57], s[56:57], s[60:61]
    s_and_b32 s56, s56, s57
    s_cbranch_scc1 L_polled_12
    s_cmp_ge_u32 s6, 1048576
    s_cbranch_scc1 L_main_end
    s_branch L_poll_11
L_polled_12:
    s_barrier
    buffer_load_dword v88, v3, s[8:11], s25 offen offset:0 sc1
    buffer_load_dword v89, v3, s[8:11], s25 offen offset:128 sc1
    buffer_load_dword v90, v3, s[8:11], s25 offen offset:256 sc1
    buffer_load_dword v91, v3, s[8:11], s25 offen offset:384 sc1
    buffer_load_dword v92, v3, s[8:11], s25 offen offset:512 sc1
    buffer_load_dword v93, v3, s[8:11], s25 offen offset:640 sc1
    buffer_load_dword v94, v3, s[8:11], s25 offen offset:768 sc1
    buffer_load_dword v95, v3, s[8:11], s25 offen offset:896 sc1
    buffer_load_dword v96, v3, s[8:11], s25 offen offset:1024 sc1
    buffer_load_dword v97, v3, s[8:11], s25 offen offset:1152 sc1
    buffer_load_dword v98, v3, s[8:11], s25 offen offset:1280 sc1
    buffer_load_dword v99, v3, s[8:11], s25 offen offset:1408 sc1
    buffer_load_dword v100, v3, s[8:11], s25 offen offset:1536 sc1
    buffer_load_dword v101, v3, s[8:11], s25 offen offset:1664 sc1
    buffer_load_dword v102, v3, s[8:11], s25 offen offset:1792 sc1
    buffer_load_dword v103, v3, s[8:11], s25 offen offset:1920 sc1
    s_add_u32 m0, s24, 0
    s_nop 0
    buffer_load_dwordx4 v2, s[8:11], s22 offen offset:0 sc1 lds
    s_add_u32 m0, s24, 512
    s_nop 0
    buffer_load_dwordx4 v2, s[8:11], s22 offen offset:512 sc1 lds
    s_add_u32 m0, s24, 1024
    s_nop 0
    buffer_load_dwordx4 v2, s[8:11], s22 offen offset:1024 sc1 lds
    s_add_u32 m0, s24, 1536
    s_nop 0
    buffer_load_dwordx4 v2, s[8:11], s22 offen offset:1536 sc1 lds
    s_add_u32 m0, s24, 2048
    s_nop 0
    buffer_load_dwordx4 v2, s[8:11], s22 offen offset:2048 sc1 lds
    s_add_u32 m0, s24, 2560
    s_nop 0
    buffer_load_dwordx4 v2, s[8:11], s22 offen offset:2560 sc1 lds
    s_add_u32 m0, s24, 3072
    s_nop 0
    buffer_load_dwordx4 v2, s[8:11], s22 offen offset:3072 sc1 lds
    s_add_u32 m0, s24, 3584
    s_nop 0
    buffer_load_dwordx4 v2, s[8:11], s22 offen offset:3584 sc1 lds
    s_add_u32 m0, s24, 8192
    s_add_u32 s22, s22, 4096
    buffer_load_dwordx4 v2, s[8:11], s22 offen offset:0 sc1 lds
    s_add_u32 m0, s24, 8704
    s_nop 0
    buffer_load_dwordx4 v2, s[8:11], s22 offen offset:512 sc1 lds
    s_add_u32 m0, s24, 9216
    s_nop 0
    buffer_load_dwordx4 v2, s[8:11], s22 offen offset:1024 sc1 lds
    s_add_u32 m0, s24, 9728
    s_nop 0
    buffer_load_dwordx4 v2, s[8:11], s22 offen offset:1536 sc1 lds
    s_add_u32 m0, s24, 10240
    s_nop 0
    buffer_load_dwordx4 v2, s[8:11], s22 offen offset:2048 sc1 lds
    s_add_u32 m0, s24, 10752
    s_nop 0
    buffer_load_dwordx4 v2, s[8:11], s22 offen offset:2560 sc1 lds
    s_add_u32 m0, s24, 11264
    s_nop 0
    buffer_load_dwordx4 v2, s[8:11], s22 offen offset:3072 sc1 lds
    s_add_u32 m0, s24, 11776
    s_nop 0
    buffer_load_dwordx4 v2, s[8:11], s22 offen offset:3584 sc1 lds
    s_add_u32 m0, s24, 16384
    s_add_u32 s22, s22, 4096
    buffer_load_dwordx4 v2, s[8:11], s22 offen offset:0 sc1 lds
    s_add_u32 m0, s24, 16896
    s_nop 0
    buffer_load_dwordx4 v2, s[8:11], s22 offen offset:512 sc1 lds
    s_waitcnt vmcnt(18)
    v_pk_add_f32 v[88:89], v[88:89], v[96:97]
    v_pk_add_f32 v[90:91], v[90:91], v[98:99]
    v_pk_add_f32 v[92:93], v[92:93], v[100:101]
    v_pk_add_f32 v[94:95], v[94:95], v[102:103]
    v_pk_add_f32 v[88:89], v[88:89], v[92:93]
    v_pk_add_f32 v[90:91], v[90:91], v[94:95]
    v_pk_add_f32 v[88:89], v[88:89], v[90:91]
    v_add_f32 v88, v88, v89
    v_mov_b32 v89, 0x3727c5ac
    v_fmac_f32 v89, 0x3ae38e39, v88
    v_mov_b32 v193, v89
    s_nop 1
    v_permlane16_swap_b32 v193, v89
    v_mov_b32 v195, v193
    v_mov_b32 v194, v89
    v_mov_b32 v252, v89
    v_permlane32_swap_b32 v193, v195
    s_nop 0
    v_permlane32_swap_b32 v194, v252
    v_rsq_f32 v4, v193
    v_rsq_f32 v5, v194
    v_rsq_f32 v6, v195
    v_rsq_f32 v7, v252
    v_mul_f32 v8, v4, v4
    v_mul_f32 v9, v5, v5
    v_mul_f32 v13, v6, v6
    v_mul_f32 v14, v7, v7
    v_mul_f32 v4, 0xc0135761, v4
    v_mul_f32 v5, 0xc0135761, v5
    v_mul_f32 v6, 0xc0135761, v6
    v_mul_f32 v7, 0xc0135761, v7
    v_mul_f32 v8, 0x3d372713, v8
    v_mul_f32 v9, 0x3d372713, v9
    v_mul_f32 v13, 0x3d372713, v13
    v_mul_f32 v14, 0x3d372713, v14
    v_mul_f32 v8, v8, v4
    v_mul_f32 v9, v9, v5
    v_mul_f32 v13, v13, v6
    v_mul_f32 v14, v14, v7
    s_waitcnt vmcnt(12)
    s_barrier
    ds_read_b128 a[0:3], v184 offset:0
    ds_read_b128 a[72:75], v184 offset:18432
    ds_read_b128 a[144:147], v11 offset:0
    ds_read_b128 a[216:219], v11 offset:18432
    ds_read_b128 a[4:7], v184 offset:1024
    ds_read_b128 a[76:79], v184 offset:19456
    ds_read_b128 a[148:151], v11 offset:1024
    ds_read_b128 a[220:223], v11 offset:19456
    ds_read_b128 a[8:11], v184 offset:2048
    ds_read_b128 a[80:83], v184 offset:20480
    ds_read_b128 a[152:155], v11 offset:2048
    ds_read_b128 a[224:227], v11 offset:20480
    ds_read_b128 a[12:15], v184 offset:3072
    ds_read_b128 a[84:87], v184 offset:21504
    ds_read_b128 a[156:159], v11 offset:3072
    ds_read_b128 a[228:231], v11 offset:21504
    ds_read_b128 a[16:19], v184 offset:4096
    ds_read_b128 a[88:91], v184 offset:22528
    ds_read_b128 a[160:163], v11 offset:4096
    ds_read_b128 a[232:235], v11 offset:22528
    ds_read_b128 a[20:23], v184 offset:5120
    ds_read_b128 a[92:95], v184 offset:23552
    ds_read_b128 a[164:167], v11 offset:5120
    ds_read_b128 a[236:239], v11 offset:23552
    s_waitcnt vmcnt(6)
    s_barrier
    ds_read_b128 a[24:27], v184 offset:6144
    ds_read_b128 a[96:99], v184 offset:24576
    ds_read_b128 a[168:171], v11 offset:6144
    ds_read_b128 a[240:243], v11 offset:24576
    ds_read_b128 a[28:31], v184 offset:7168
    ds_read_b128 a[100:103], v184 offset:25600
    ds_read_b128 a[172:175], v11 offset:7168
    ds_read_b128 a[244:247], v11 offset:25600
    ds_read_b128 a[32:35], v184 offset:8192
    ds_read_b128 a[104:107], v184 offset:26624
    ds_read_b128 a[176:179], v11 offset:8192
    ds_read_b128 a[248:251], v11 offset:26624
    ds_read_b128 a[36:39], v184 offset:9216
    ds_read_b128 a[108:111], v184 offset:27648
    ds_read_b128 a[180:183], v11 offset:9216
    ds_read_b128 a[252:255], v11 offset:27648
    ds_read_b128 a[40:43], v184 offset:10240
    ds_read_b128 a[112:115], v184 offset:28672
    ds_read_b128 a[184:187], v11 offset:10240
    ds_read_b128 v[220:223], v11 offset:28672
    ds_read_b128 a[44:47], v184 offset:11264
    ds_read_b128 a[116:119], v184 offset:29696
    ds_read_b128 a[188:191], v11 offset:11264
    ds_read_b128 v[224:227], v11 offset:29696
    s_waitcnt vmcnt(0)
    s_barrier
    ds_read_b128 a[48:51], v184 offset:12288
    ds_read_b128 a[120:123], v184 offset:30720
    ds_read_b128 a[192:195], v11 offset:12288
    ds_read_b128 v[228:231], v11 offset:30720
    ds_read_b128 a[52:55], v184 offset:13312
    ds_read_b128 a[124:127], v184 offset:31744
    ds_read_b128 a[196:199], v11 offset:13312
    ds_read_b128 v[232:235], v11 offset:31744
    ds_read_b128 a[56:59], v184 offset:14336
    ds_read_b128 a[128:131], v184 offset:32768
    ds_read_b128 a[200:203], v11 offset:14336
    ds_read_b128 v[236:239], v11 offset:32768
    ds_read_b128 a[60:63], v184 offset:15360
    ds_read_b128 a[132:135], v184 offset:33792
    ds_read_b128 a[204:207], v11 offset:15360
    ds_read_b128 v[240:243], v11 offset:33792
    ds_read_b128 a[64:67], v184 offset:16384
    ds_read_b128 a[136:139], v184 offset:34816
    ds_read_b128 a[208:211], v11 offset:16384
    ds_read_b128 v[244:247], v11 offset:34816
    ds_read_b128 a[68:71], v184 offset:17408
    ds_read_b128 a[140:143], v184 offset:35840
    ds_read_b128 a[212:215], v11 offset:17408
    ds_read_b128 v[248:251], v11 offset:35840
    s_lshr_b32 s7, s3, 1
    s_lshl_b32 s7, s7, 10
    s_and_b32 s6, s3, 1
    s_lshl_b32 s6, s6, 3
    s_add_u32 s24, s7, s6
    s_add_u32 s24, s24, 73728
    s_add_u32 s7, s24, 16384
    v_add_u32 v12, s7, v184
    s_mov_b32 s25, 0
    s_waitcnt lgkmcnt(0)
L_ffn_gu_13:
    s_waitcnt vmcnt(12)
    v_mfma_f32_16x16x32_bf16 v[88:91], v[16:19], a[0:3], 0
    v_mfma_f32_16x16x32_bf16 v[88:91], v[20:23], a[4:7], v[88:91]
    buffer_load_dwordx4 v[76:79], v184, s[48:51], s23 offen offset:0
    v_mfma_f32_16x16x32_bf16 v[88:91], v[24:27], a[8:11], v[88:91]
    v_mul_f32 v152, v120, v120
    v_mul_f32 v153, v121, v121
    v_mfma_f32_16x16x32_bf16 v[92:95], v[16:19], a[72:75], 0
    v_mul_f32 v154, v122, v122
    v_mul_f32 v155, v123, v123
    v_mfma_f32_16x16x32_bf16 v[92:95], v[20:23], a[76:79], v[92:95]
    v_fma_f32 v152, v152, v8, v4
    v_fma_f32 v153, v153, v8, v4
    v_mfma_f32_16x16x32_bf16 v[92:95], v[24:27], a[80:83], v[92:95]
    buffer_load_dwordx4 v[80:83], v184, s[48:51], s23 offen offset:1024
    v_mfma_f32_16x16x32_bf16 v[96:99], v[16:19], a[144:147], 0
    v_fma_f32 v154, v154, v8, v4
    v_fma_f32 v155, v155, v8, v4
    v_mfma_f32_16x16x32_bf16 v[96:99], v[20:23], a[148:151], v[96:99]
    v_mul_f32 v152, v120, v152
    v_mul_f32 v153, v121, v153
    v_mfma_f32_16x16x32_bf16 v[96:99], v[24:27], a[152:155], v[96:99]
    v_mul_f32 v154, v122, v154
    v_mul_f32 v155, v123, v155
    v_mfma_f32_16x16x32_bf16 v[100:103], v[16:19], a[216:219], 0
    buffer_load_dwordx4 v[84:87], v184, s[48:51], s23 offen offset:2048
    v_mfma_f32_16x16x32_bf16 v[100:103], v[20:23], a[220:223], v[100:103]
    v_exp_f32 v152, v152
    v_mfma_f32_16x16x32_bf16 v[100:103], v[24:27], a[224:227], v[100:103]
    v_exp_f32 v153, v153
    s_waitcnt vmcnt(12)
    v_mfma_f32_16x16x32_bf16 v[104:107], v[28:31], a[0:3], 0
    v_exp_f32 v154, v154
    v_mfma_f32_16x16x32_bf16 v[104:107], v[32:35], a[4:7], v[104:107]
    buffer_load_dwordx4 v[16:19], v184, s[48:51], s23 offen offset:3072
    v_mfma_f32_16x16x32_bf16 v[104:107], v[36:39], a[8:11], v[104:107]
    v_exp_f32 v155, v155
    v_mfma_f32_16x16x32_bf16 v[108:111], v[28:31], a[72:75], 0
    v_mul_f32 v156, v120, v136
    v_mul_f32 v157, v121, v137
    v_mfma_f32_16x16x32_bf16 v[108:111], v[32:35], a[76:79], v[108:111]
    v_mul_f32 v158, v122, v138
    v_mul_f32 v159, v123, v139
    v_mfma_f32_16x16x32_bf16 v[108:111], v[36:39], a[80:83], v[108:111]
    buffer_load_dwordx4 v[20:23], v185, s[48:51], s23 offen offset:0
    v_mfma_f32_16x16x32_bf16 v[112:115], v[28:31], a[144:147], 0
    v_fma_f32 v152, v152, v193, v193
    v_fma_f32 v153, v153, v193, v193
    v_mfma_f32_16x16x32_bf16 v[112:115], v[32:35], a[148:151], v[112:115]
    v_fma_f32 v154, v154, v193, v193
    v_fma_f32 v155, v155, v193, v193
    v_mfma_f32_16x16x32_bf16 v[112:115], v[36:39], a[152:155], v[112:115]
    v_rcp_f32 v152, v152
    v_mfma_f32_16x16x32_bf16 v[116:119], v[28:31], a[216:219], 0
    buffer_load_dwordx4 v[24:27], v185, s[48:51], s23 offen offset:1024
    v_mfma_f32_16x16x32_bf16 v[116:119], v[32:35], a[220:223], v[116:119]
    v_rcp_f32 v153, v153
    v_mfma_f32_16x16x32_bf16 v[116:119], v[36:39], a[224:227], v[116:119]
    v_rcp_f32 v154, v154
    s_waitcnt vmcnt(12)
    v_mfma_f32_16x16x32_bf16 v[88:91], v[40:43], a[12:15], v[88:91]
    v_rcp_f32 v155, v155
    v_mfma_f32_16x16x32_bf16 v[88:91], v[44:47], a[16:19], v[88:91]
    buffer_load_dwordx4 v[28:31], v185, s[48:51], s23 offen offset:2048
    v_mfma_f32_16x16x32_bf16 v[88:91], v[48:51], a[20:23], v[88:91]
    v_mul_f32 v156, v156, v152
    v_mul_f32 v157, v157, v153
    v_mfma_f32_16x16x32_bf16 v[92:95], v[40:43], a[84:87], v[92:95]
    v_mul_f32 v158, v158, v154
    v_mul_f32 v159, v159, v155
    v_mfma_f32_16x16x32_bf16 v[92:95], v[44:47], a[88:91], v[92:95]
    v_cvt_pk_bf16_f32 v160, v156, v157
    v_cvt_pk_bf16_f32 v161, v158, v159
    v_mfma_f32_16x16x32_bf16 v[92:95], v[48:51], a[92:95], v[92:95]
    buffer_load_dwordx4 v[32:35], v185, s[48:51], s23 offen offset:3072
    v_mfma_f32_16x16x32_bf16 v[96:99], v[40:43], a[156:159], v[96:99]
    ds_write_b64 v12, v[160:161] offset:0
    v_mfma_f32_16x16x32_bf16 v[96:99], v[44:47], a[160:163], v[96:99]
    v_mul_f32 v162, v124, v124
    v_mul_f32 v163, v125, v125
    v_mfma_f32_16x16x32_bf16 v[96:99], v[48:51], a[164:167], v[96:99]
    v_mul_f32 v164, v126, v126
    v_mul_f32 v165, v127, v127
    v_mfma_f32_16x16x32_bf16 v[100:103], v[40:43], a[228:231], v[100:103]
    buffer_load_dwordx4 v[36:39], v186, s[48:51], s23 offen offset:0
    v_mfma_f32_16x16x32_bf16 v[100:103], v[44:47], a[232:235], v[100:103]
    v_fma_f32 v162, v162, v9, v5
    v_fma_f32 v163, v163, v9, v5
    v_mfma_f32_16x16x32_bf16 v[100:103], v[48:51], a[236:239], v[100:103]
    v_fma_f32 v164, v164, v9, v5
    v_fma_f32 v165, v165, v9, v5
    s_waitcnt vmcnt(12)
    v_mfma_f32_16x16x32_bf16 v[104:107], v[52:55], a[12:15], v[104:107]
    v_mul_f32 v162, v124, v162
    v_mul_f32 v163, v125, v163
    v_mfma_f32_16x16x32_bf16 v[104:107], v[56:59], a[16:19], v[104:107]
    buffer_load_dwordx4 v[40:43], v186, s[48:51], s23 offen offset:1024
    v_mfma_f32_16x16x32_bf16 v[104:107], v[60:63], a[20:23], v[104:107]
    v_mul_f32 v164, v126, v164
    v_mul_f32 v165, v127, v165
    v_mfma_f32_16x16x32_bf16 v[108:111], v[52:55], a[84:87], v[108:111]
    v_exp_f32 v162, v162
    v_mfma_f32_16x16x32_bf16 v[108:111], v[56:59], a[88:91], v[108:111]
    v_exp_f32 v163, v163
    v_mfma_f32_16x16x32_bf16 v[108:111], v[60:63], a[92:95], v[108:111]
    buffer_load_dwordx4 v[44:47], v186, s[48:51], s23 offen offset:2048
    v_mfma_f32_16x16x32_bf16 v[112:115], v[52:55], a[156:159], v[112:115]
    v_exp_f32 v164, v164
    v_mfma_f32_16x16x32_bf16 v[112:115], v[56:59], a[160:163], v[112:115]
    v_exp_f32 v165, v165
    v_mfma_f32_16x16x32_bf16 v[112:115], v[60:63], a[164:167], v[112:115]
    v_mul_f32 v166, v124, v140
    v_mul_f32 v167, v125, v141
    v_mfma_f32_16x16x32_bf16 v[116:119], v[52:55], a[228:231], v[116:119]
    buffer_load_dwordx4 v[48:51], v186, s[48:51], s23 offen offset:3072
    v_mfma_f32_16x16x32_bf16 v[116:119], v[56:59], a[232:235], v[116:119]
    v_mul_f32 v168, v126, v142
    v_mul_f32 v169, v127, v143
    v_mfma_f32_16x16x32_bf16 v[116:119], v[60:63], a[236:239], v[116:119]
    v_fma_f32 v162, v162, v194, v194
    v_fma_f32 v163, v163, v194, v194
    s_waitcnt vmcnt(12)
    v_mfma_f32_16x16x32_bf16 v[88:91], v[64:67], a[24:27], v[88:91]
    v_fma_f32 v164, v164, v194, v194
    v_fma_f32 v165, v165, v194, v194
    v_mfma_f32_16x16x32_bf16 v[88:91], v[68:71], a[28:31], v[88:91]
    buffer_load_dwordx4 v[52:55], v187, s[48:51], s23 offen offset:0
    v_mfma_f32_16x16x32_bf16 v[88:91], v[72:75], a[32:35], v[88:91]
    v_rcp_f32 v162, v162
    v_mfma_f32_16x16x32_bf16 v[92:95], v[64:67], a[96:99], v[92:95]
    v_rcp_f32 v163, v163
    v_mfma_f32_16x16x32_bf16 v[92:95], v[68:71], a[100:103], v[92:95]
    v_rcp_f32 v164, v164
    v_mfma_f32_16x16x32_bf16 v[92:95], v[72:75], a[104:107], v[92:95]
    buffer_load_dwordx4 v[56:59], v187, s[48:51], s23 offen offset:1024
    v_mfma_f32_16x16x32_bf16 v[96:99], v[64:67], a[168:171], v[96:99]
    v_rcp_f32 v165, v165
    v_mfma_f32_16x16x32_bf16 v[96:99], v[68:71], a[172:175], v[96:99]
    v_mul_f32 v166, v166, v162
    v_mul_f32 v167, v167, v163
    v_mfma_f32_16x16x32_bf16 v[96:99], v[72:75], a[176:179], v[96:99]
    v_mul_f32 v168, v168, v164
    v_mul_f32 v169, v169, v165
    v_mfma_f32_16x16x32_bf16 v[100:103], v[64:67], a[240:243], v[100:103]
    buffer_load_dwordx4 v[60:63], v187, s[48:51], s23 offen offset:2048
    v_mfma_f32_16x16x32_bf16 v[100:103], v[68:71], a[244:247], v[100:103]
    v_cvt_pk_bf16_f32 v170, v166, v167
    v_cvt_pk_bf16_f32 v171, v168, v169
    v_mfma_f32_16x16x32_bf16 v[100:103], v[72:75], a[248:251], v[100:103]
    ds_write_b64 v12, v[170:171] offset:18432
    s_waitcnt vmcnt(12)
    v_mfma_f32_16x16x32_bf16 v[104:107], v[76:79], a[24:27], v[104:107]
    v_mul_f32 v152, v128, v128
    v_mul_f32 v153, v129, v129
    v_mfma_f32_16x16x32_bf16 v[104:107], v[80:83], a[28:31], v[104:107]
    buffer_load_dwordx4 v[64:67], v187, s[48:51], s23 offen offset:3072
    v_mfma_f32_16x16x32_bf16 v[104:107], v[84:87], a[32:35], v[104:107]
    v_mul_f32 v154, v130, v130
    v_mul_f32 v155, v131, v131
    v_mfma_f32_16x16x32_bf16 v[108:111], v[76:79], a[96:99], v[108:111]
    v_fma_f32 v152, v152, v13, v6
    v_fma_f32 v153, v153, v13, v6
    v_mfma_f32_16x16x32_bf16 v[108:111], v[80:83], a[100:103], v[108:111]
    v_fma_f32 v154, v154, v13, v6
    v_fma_f32 v155, v155, v13, v6
    v_mfma_f32_16x16x32_bf16 v[108:111], v[84:87], a[104:107], v[108:111]
    buffer_load_dwordx4 v[68:71], v188, s[48:51], s23 offen offset:0
    v_mfma_f32_16x16x32_bf16 v[112:115], v[76:79], a[168:171], v[112:115]
    v_mul_f32 v152, v128, v152
    v_mul_f32 v153, v129, v153
    v_mfma_f32_16x16x32_bf16 v[112:115], v[80:83], a[172:175], v[112:115]
    v_mul_f32 v154, v130, v154
    v_mul_f32 v155, v131, v155
    v_mfma_f32_16x16x32_bf16 v[112:115], v[84:87], a[176:179], v[112:115]
    v_exp_f32 v152, v152
    v_mfma_f32_16x16x32_bf16 v[116:119], v[76:79], a[240:243], v[116:119]
    buffer_load_dwordx4 v[72:75], v188, s[48:51], s23 offen offset:1024
    v_mfma_f32_16x16x32_bf16 v[116:119], v[80:83], a[244:247], v[116:119]
    v_exp_f32 v153, v153
    v_mfma_f32_16x16x32_bf16 v[116:119], v[84:87], a[248:251], v[116:119]
    v_exp_f32 v154, v154
    s_waitcnt vmcnt(12)
    v_mfma_f32_16x16x32_bf16 v[88:91], v[16:19], a[36:39], v[88:91]
    v_exp_f32 v155, v155
    v_mfma_f32_16x16x32_bf16 v[88:91], v[20:23], a[40:43], v[88:91]
    buffer_load_dwordx4 v[76:79], v188, s[48:51], s23 offen offset:2048
    v_mfma_f32_16x16x32_bf16 v[88:91], v[24:27], a[44:47], v[88:91]
    v_mul_f32 v156, v128, v144
    v_mul_f32 v157, v129, v145
    v_mfma_f32_16x16x32_bf16 v[92:95], v[16:19], a[108:111], v[92:95]
    v_mul_f32 v158, v130, v146
    v_mul_f32 v159, v131, v147
    v_mfma_f32_16x16x32_bf16 v[92:95], v[20:23], a[112:115], v[92:95]
    v_fma_f32 v152, v152, v195, v195
    v_fma_f32 v153, v153, v195, v195
    v_mfma_f32_16x16x32_bf16 v[92:95], v[24:27], a[116:119], v[92:95]
    buffer_load_dwordx4 v[80:83], v188, s[48:51], s23 offen offset:3072
    v_mfma_f32_16x16x32_bf16 v[96:99], v[16:19], a[180:183], v[96:99]
    v_fma_f32 v154, v154, v195, v195
    v_fma_f32 v155, v155, v195, v195
    v_mfma_f32_16x16x32_bf16 v[96:99], v[20:23], a[184:187], v[96:99]
    v_rcp_f32 v152, v152
    v_mfma_f32_16x16x32_bf16 v[96:99], v[24:27], a[188:191], v[96:99]
    v_rcp_f32 v153, v153
    v_mfma_f32_16x16x32_bf16 v[100:103], v[16:19], a[252:255], v[100:103]
    buffer_load_dwordx4 v[84:87], v189, s[48:51], s23 offen offset:0
    v_mfma_f32_16x16x32_bf16 v[100:103], v[20:23], v[220:223], v[100:103]
    v_rcp_f32 v154, v154
    v_mfma_f32_16x16x32_bf16 v[100:103], v[24:27], v[224:227], v[100:103]
    v_rcp_f32 v155, v155
    s_waitcnt vmcnt(12)
    v_mfma_f32_16x16x32_bf16 v[104:107], v[28:31], a[36:39], v[104:107]
    v_mul_f32 v156, v156, v152
    v_mul_f32 v157, v157, v153
    v_mfma_f32_16x16x32_bf16 v[104:107], v[32:35], a[40:43], v[104:107]
    buffer_load_dwordx4 v[16:19], v189, s[48:51], s23 offen offset:1024
    v_mfma_f32_16x16x32_bf16 v[104:107], v[36:39], a[44:47], v[104:107]
    v_mul_f32 v158, v158, v154
    v_mul_f32 v159, v159, v155
    v_mfma_f32_16x16x32_bf16 v[108:111], v[28:31], a[108:111], v[108:111]
    v_cvt_pk_bf16_f32 v160, v156, v157
    v_cvt_pk_bf16_f32 v161, v158, v159
    v_mfma_f32_16x16x32_bf16 v[108:111], v[32:35], a[112:115], v[108:111]
    ds_write_b64 v12, v[160:161] offset:36864
    v_mfma_f32_16x16x32_bf16 v[108:111], v[36:39], a[116:119], v[108:111]
    buffer_load_dwordx4 v[20:23], v189, s[48:51], s23 offen offset:2048
    v_mfma_f32_16x16x32_bf16 v[112:115], v[28:31], a[180:183], v[112:115]
    v_mul_f32 v162, v132, v132
    v_mul_f32 v163, v133, v133
    v_mfma_f32_16x16x32_bf16 v[112:115], v[32:35], a[184:187], v[112:115]
    v_mul_f32 v164, v134, v134
    v_mul_f32 v165, v135, v135
    v_mfma_f32_16x16x32_bf16 v[112:115], v[36:39], a[188:191], v[112:115]
    v_fma_f32 v162, v162, v14, v7
    v_fma_f32 v163, v163, v14, v7
    v_mfma_f32_16x16x32_bf16 v[116:119], v[28:31], a[252:255], v[116:119]
    buffer_load_dwordx4 v[24:27], v189, s[48:51], s23 offen offset:3072
    v_mfma_f32_16x16x32_bf16 v[116:119], v[32:35], v[220:223], v[116:119]
    v_fma_f32 v164, v164, v14, v7
    v_fma_f32 v165, v165, v14, v7
    v_mfma_f32_16x16x32_bf16 v[116:119], v[36:39], v[224:227], v[116:119]
    v_mul_f32 v162, v132, v162
    v_mul_f32 v163, v133, v163
    s_waitcnt vmcnt(12)
    v_mfma_f32_16x16x32_bf16 v[88:91], v[40:43], a[48:51], v[88:91]
    v_mul_f32 v164, v134, v164
    v_mul_f32 v165, v135, v165
    v_mfma_f32_16x16x32_bf16 v[88:91], v[44:47], a[52:55], v[88:91]
    buffer_load_dwordx4 v[28:31], v190, s[48:51], s23 offen offset:0
    v_mfma_f32_16x16x32_bf16 v[88:91], v[48:51], a[56:59], v[88:91]
    v_exp_f32 v162, v162
    v_mfma_f32_16x16x32_bf16 v[92:95], v[40:43], a[120:123], v[92:95]
    v_exp_f32 v163, v163
    v_mfma_f32_16x16x32_bf16 v[92:95], v[44:47], a[124:127], v[92:95]
    v_exp_f32 v164, v164
    v_mfma_f32_16x16x32_bf16 v[92:95], v[48:51], a[128:131], v[92:95]
    buffer_load_dwordx4 v[32:35], v190, s[48:51], s23 offen offset:1024
    v_mfma_f32_16x16x32_bf16 v[96:99], v[40:43], a[192:195], v[96:99]
    v_exp_f32 v165, v165
    v_mfma_f32_16x16x32_bf16 v[96:99], v[44:47], a[196:199], v[96:99]
    v_mul_f32 v166, v132, v148
    v_mul_f32 v167, v133, v149
    v_mfma_f32_16x16x32_bf16 v[96:99], v[48:51], a[200:203], v[96:99]
    v_mul_f32 v168, v134, v150
    v_mul_f32 v169, v135, v151
    v_mfma_f32_16x16x32_bf16 v[100:103], v[40:43], v[228:231], v[100:103]
    buffer_load_dwordx4 v[36:39], v190, s[48:51], s23 offen offset:2048
    v_mfma_f32_16x16x32_bf16 v[100:103], v[44:47], v[232:235], v[100:103]
    v_fma_f32 v162, v162, v252, v252
    v_fma_f32 v163, v163, v252, v252
    v_mfma_f32_16x16x32_bf16 v[100:103], v[48:51], v[236:239], v[100:103]
    v_fma_f32 v164, v164, v252, v252
    v_fma_f32 v165, v165, v252, v252
    s_waitcnt vmcnt(12)
    v_mfma_f32_16x16x32_bf16 v[104:107], v[52:55], a[48:51], v[104:107]
    v_rcp_f32 v162, v162
    v_mfma_f32_16x16x32_bf16 v[104:107], v[56:59], a[52:55], v[104:107]
    buffer_load_dwordx4 v[40:43], v190, s[48:51], s23 offen offset:3072
    v_mfma_f32_16x16x32_bf16 v[104:107], v[60:63], a[56:59], v[104:107]
    v_rcp_f32 v163, v163
    v_mfma_f32_16x16x32_bf16 v[108:111], v[52:55], a[120:123], v[108:111]
    v_rcp_f32 v164, v164
    v_mfma_f32_16x16x32_bf16 v[108:111], v[56:59], a[124:127], v[108:111]
    v_rcp_f32 v165, v165
    v_mfma_f32_16x16x32_bf16 v[108:111], v[60:63], a[128:131], v[108:111]
    buffer_load_dwordx4 v[44:47], v191, s[48:51], s23 offen offset:0
    v_mfma_f32_16x16x32_bf16 v[112:115], v[52:55], a[192:195], v[112:115]
    v_mul_f32 v166, v166, v162
    v_mul_f32 v167, v167, v163
    v_mfma_f32_16x16x32_bf16 v[112:115], v[56:59], a[196:199], v[112:115]
    v_mul_f32 v168, v168, v164
    v_mul_f32 v169, v169, v165
    v_mfma_f32_16x16x32_bf16 v[112:115], v[60:63], a[200:203], v[112:115]
    v_cvt_pk_bf16_f32 v170, v166, v167
    v_cvt_pk_bf16_f32 v171, v168, v169
    v_mfma_f32_16x16x32_bf16 v[116:119], v[52:55], v[228:231], v[116:119]
    buffer_load_dwordx4 v[48:51], v191, s[48:51], s23 offen offset:1024
    v_mfma_f32_16x16x32_bf16 v[116:119], v[56:59], v[232:235], v[116:119]
    ds_write_b64 v12, v[170:171] offset:55296
    v_mfma_f32_16x16x32_bf16 v[116:119], v[60:63], v[236:239], v[116:119]
    s_waitcnt vmcnt(12)
    v_mfma_f32_16x16x32_bf16 v[88:91], v[64:67], a[60:63], v[88:91]
    v_mfma_f32_16x16x32_bf16 v[88:91], v[68:71], a[64:67], v[88:91]
    buffer_load_dwordx4 v[52:55], v191, s[48:51], s23 offen offset:2048
    v_mfma_f32_16x16x32_bf16 v[120:123], v[72:75], a[68:71], v[88:91]
    v_mfma_f32_16x16x32_bf16 v[92:95], v[64:67], a[132:135], v[92:95]
    v_mfma_f32_16x16x32_bf16 v[92:95], v[68:71], a[136:139], v[92:95]
    v_mfma_f32_16x16x32_bf16 v[124:127], v[72:75], a[140:143], v[92:95]
    buffer_load_dwordx4 v[56:59], v191, s[48:51], s23 offen offset:3072
    v_mfma_f32_16x16x32_bf16 v[96:99], v[64:67], a[204:207], v[96:99]
    v_mfma_f32_16x16x32_bf16 v[96:99], v[68:71], a[208:211], v[96:99]
    v_mfma_f32_16x16x32_bf16 v[128:131], v[72:75], a[212:215], v[96:99]
    v_mfma_f32_16x16x32_bf16 v[100:103], v[64:67], v[240:243], v[100:103]
    buffer_load_dwordx4 v[60:63], v192, s[48:51], s23 offen offset:0
    v_mfma_f32_16x16x32_bf16 v[100:103], v[68:71], v[244:247], v[100:103]
    v_mfma_f32_16x16x32_bf16 v[132:135], v[72:75], v[248:251], v[100:103]
    s_waitcnt vmcnt(12)
    v_mfma_f32_16x16x32_bf16 v[104:107], v[76:79], a[60:63], v[104:107]
    v_mfma_f32_16x16x32_bf16 v[104:107], v[80:83], a[64:67], v[104:107]
    buffer_load_dwordx4 v[64:67], v192, s[48:51], s23 offen offset:1024
    v_mfma_f32_16x16x32_bf16 v[136:139], v[84:87], a[68:71], v[104:107]
    v_mfma_f32_16x16x32_bf16 v[108:111], v[76:79], a[132:135], v[108:111]
    v_mfma_f32_16x16x32_bf16 v[108:111], v[80:83], a[136:139], v[108:111]
    v_mfma_f32_16x16x32_bf16 v[140:143], v[84:87], a[140:143], v[108:111]
    buffer_load_dwordx4 v[68:71], v192, s[48:51], s23 offen offset:2048
    v_mfma_f32_16x16x32_bf16 v[112:115], v[76:79], a[204:207], v[112:115]
    v_mfma_f32_16x16x32_bf16 v[112:115], v[80:83], a[208:211], v[112:115]
    s_lshl_b32 s7, s25, 11
    v_mfma_f32_16x16x32_bf16 v[144:147], v[84:87], a[212:215], v[112:115]
    s_add_u32 s7, s7, s24
    v_mfma_f32_16x16x32_bf16 v[116:119], v[76:79], v[240:243], v[116:119]
    buffer_load_dwordx4 v[72:75], v192, s[48:51], s23 offen offset:3072
    v_mfma_f32_16x16x32_bf16 v[116:119], v[80:83], v[244:247], v[116:119]
    s_add_u32 s23, s23, 36864
    v_mfma_f32_16x16x32_bf16 v[148:151], v[84:87], v[248:251], v[116:119]
    v_add_u32 v12, s7, v184
    s_add_u32 s25, s25, 1
    s_cmp_lt_u32 s25, 9
    s_cbranch_scc1 L_ffn_gu_13
    v_add_u32 v10, 73728, v184
    v_add_u32 v11, 110592, v184
    s_waitcnt lgkmcnt(0)
    s_barrier
    v_pk_mul_f32 v[152:153], v[120:121], v[120:121]
    ds_read_b128 a[0:3], v10 offset:0
    v_pk_mul_f32 v[154:155], v[122:123], v[122:123]
    ds_read_b128 a[72:75], v10 offset:18432
    v_pk_fma_f32 v[152:153], v[152:153], v[8:9], v[4:5] op_sel:[0,0,0] op_sel_hi:[1,0,0]
    ds_read_b128 a[144:147], v11 offset:0
    v_pk_fma_f32 v[154:155], v[154:155], v[8:9], v[4:5] op_sel:[0,0,0] op_sel_hi:[1,0,0]
    v_pk_mul_f32 v[152:153], v[120:121], v[152:153]
    ds_read_b128 a[216:219], v11 offset:18432
    v_pk_mul_f32 v[154:155], v[122:123], v[154:155]
    ds_read_b128 a[4:7], v10 offset:1024
    buffer_load_dwordx4 v[76:79], v184, s[48:51], s23 offen offset:0
    v_exp_f32 v152, v152
    ds_read_b128 a[76:79], v10 offset:19456
    v_exp_f32 v153, v153
    v_exp_f32 v154, v154
    ds_read_b128 a[148:151], v11 offset:1024
    v_exp_f32 v155, v155
    ds_read_b128 a[220:223], v11 offset:19456
    v_pk_mul_f32 v[156:157], v[120:121], v[136:137]
    ds_read_b128 a[8:11], v10 offset:2048
    v_pk_mul_f32 v[158:159], v[122:123], v[138:139]
    buffer_load_dwordx4 v[80:83], v184, s[48:51], s23 offen offset:1024
    v_pk_fma_f32 v[152:153], v[152:153], v[192:193], v[192:193] op_sel:[0,1,1] op_sel_hi:[1,1,1]
    ds_read_b128 a[80:83], v10 offset:20480
    v_pk_fma_f32 v[154:155], v[154:155], v[192:193], v[192:193] op_sel:[0,1,1] op_sel_hi:[1,1,1]
    ds_read_b128 a[152:155], v11 offset:2048
    v_rcp_f32 v152, v152
    ds_read_b128 a[224:227], v11 offset:20480
    v_rcp_f32 v153, v153
    v_rcp_f32 v154, v154
    ds_read_b128 a[12:15], v10 offset:3072
    v_rcp_f32 v155, v155
    ds_read_b128 a[84:87], v10 offset:21504
    buffer_load_dwordx4 v[84:87], v184, s[48:51], s23 offen offset:2048
    s_nop 0
    ds_read_b128 a[156:159], v11 offset:3072
    v_pk_mul_f32 v[156:157], v[156:157], v[152:153]
    v_pk_mul_f32 v[158:159], v[158:159], v[154:155]
    ds_read_b128 a[228:231], v11 offset:21504
    v_cvt_pk_bf16_f32 v160, v156, v157
    ds_read_b128 a[16:19], v10 offset:4096
    v_cvt_pk_bf16_f32 v161, v158, v159
    ds_read_b128 a[88:91], v10 offset:22528
    ds_write_b64 v12, v[160:161] offset:0
    buffer_load_dwordx4 v[104:107], v184, s[48:51], s23 offen offset:3072
    v_pk_mul_f32 v[162:163], v[124:125], v[124:125]
    ds_read_b128 a[160:163], v11 offset:4096
    v_pk_mul_f32 v[164:165], v[126:127], v[126:127]
    ds_read_b128 a[232:235], v11 offset:22528
    v_pk_fma_f32 v[162:163], v[162:163], v[8:9], v[4:5] op_sel:[0,1,1] op_sel_hi:[1,1,1]
    ds_read_b128 a[20:23], v10 offset:5120
    v_pk_fma_f32 v[164:165], v[164:165], v[8:9], v[4:5] op_sel:[0,1,1] op_sel_hi:[1,1,1]
    v_pk_mul_f32 v[162:163], v[124:125], v[162:163]
    ds_read_b128 a[92:95], v10 offset:23552
    v_pk_mul_f32 v[164:165], v[126:127], v[164:165]
    ds_read_b128 a[164:167], v11 offset:5120
    buffer_load_dwordx4 v[108:111], v185, s[48:51], s23 offen offset:0
    v_exp_f32 v162, v162
    ds_read_b128 a[236:239], v11 offset:23552
    v_exp_f32 v163, v163
    v_exp_f32 v164, v164
    ds_read_b128 a[24:27], v10 offset:6144
    v_exp_f32 v165, v165
    ds_read_b128 a[96:99], v10 offset:24576
    v_pk_mul_f32 v[166:167], v[124:125], v[140:141]
    ds_read_b128 a[168:171], v11 offset:6144
    v_pk_mul_f32 v[168:169], v[126:127], v[142:143]
    buffer_load_dwordx4 v[112:115], v185, s[48:51], s23 offen offset:1024
    v_pk_fma_f32 v[162:163], v[162:163], v[194:195], v[194:195] op_sel:[0,0,0] op_sel_hi:[1,0,0]
    ds_read_b128 a[240:243], v11 offset:24576
    v_pk_fma_f32 v[164:165], v[164:165], v[194:195], v[194:195] op_sel:[0,0,0] op_sel_hi:[1,0,0]
    ds_read_b128 a[28:31], v10 offset:7168
    v_rcp_f32 v162, v162
    ds_read_b128 a[100:103], v10 offset:25600
    v_rcp_f32 v163, v163
    v_rcp_f32 v164, v164
    ds_read_b128 a[172:175], v11 offset:7168
    v_rcp_f32 v165, v165
    ds_read_b128 a[244:247], v11 offset:25600
    buffer_load_dwordx4 v[116:119], v185, s[48:51], s23 offen offset:2048
    s_nop 0
    ds_read_b128 a[32:35], v10 offset:8192
    v_pk_mul_f32 v[166:167], v[166:167], v[162:163]
    v_pk_mul_f32 v[168:169], v[168:169], v[164:165]
    ds_read_b128 a[104:107], v10 offset:26624
    v_cvt_pk_bf16_f32 v170, v166, v167
    ds_read_b128 a[176:179], v11 offset:8192
    v_cvt_pk_bf16_f32 v171, v168, v169
    ds_read_b128 a[248:251], v11 offset:26624
    ds_write_b64 v12, v[170:171] offset:18432
    buffer_load_dwordx4 v[172:175], v185, s[48:51], s23 offen offset:3072
    v_pk_mul_f32 v[152:153], v[128:129], v[128:129]
    ds_read_b128 a[36:39], v10 offset:9216
    v_pk_mul_f32 v[154:155], v[130:131], v[130:131]
    ds_read_b128 a[108:111], v10 offset:27648
    v_pk_fma_f32 v[152:153], v[152:153], v[12:13], v[6:7] op_sel:[0,1,0] op_sel_hi:[1,1,0]
    ds_read_b128 a[180:183], v11 offset:9216
    v_pk_fma_f32 v[154:155], v[154:155], v[12:13], v[6:7] op_sel:[0,1,0] op_sel_hi:[1,1,0]
    v_pk_mul_f32 v[152:153], v[128:129], v[152:153]
    ds_read_b128 a[252:255], v11 offset:27648
    v_pk_mul_f32 v[154:155], v[130:131], v[154:155]
    ds_read_b128 a[40:43], v10 offset:10240
    buffer_load_dwordx4 v[176:179], v186, s[48:51], s23 offen offset:0
    v_exp_f32 v152, v152
    ds_read_b128 a[112:115], v10 offset:28672
    v_exp_f32 v153, v153
    v_exp_f32 v154, v154
    ds_read_b128 a[184:187], v11 offset:10240
    v_exp_f32 v155, v155
    ds_read_b128 v[220:223], v11 offset:28672
    v_pk_mul_f32 v[156:157], v[128:129], v[144:145]
    ds_read_b128 a[44:47], v10 offset:11264
    v_pk_mul_f32 v[158:159], v[130:131], v[146:147]
    buffer_load_dwordx4 v[180:183], v186, s[48:51], s23 offen offset:1024
    v_pk_fma_f32 v[152:153], v[152:153], v[194:195], v[194:195] op_sel:[0,1,1] op_sel_hi:[1,1,1]
    ds_read_b128 a[116:119], v10 offset:29696
    v_pk_fma_f32 v[154:155], v[154:155], v[194:195], v[194:195] op_sel:[0,1,1] op_sel_hi:[1,1,1]
    ds_read_b128 a[188:191], v11 offset:11264
    v_rcp_f32 v152, v152
    ds_read_b128 v[224:227], v11 offset:29696
    v_rcp_f32 v153, v153
    v_rcp_f32 v154, v154
    ds_read_b128 a[48:51], v10 offset:12288
    v_rcp_f32 v155, v155
    ds_read_b128 a[120:123], v10 offset:30720
    buffer_load_dwordx4 v[196:199], v186, s[48:51], s23 offen offset:2048
    s_nop 0
    ds_read_b128 a[192:195], v11 offset:12288
    v_pk_mul_f32 v[156:157], v[156:157], v[152:153]
    v_pk_mul_f32 v[158:159], v[158:159], v[154:155]
    ds_read_b128 v[228:231], v11 offset:30720
    v_cvt_pk_bf16_f32 v160, v156, v157
    ds_read_b128 a[52:55], v10 offset:13312
    v_cvt_pk_bf16_f32 v161, v158, v159
    ds_read_b128 a[124:127], v10 offset:31744
    ds_write_b64 v12, v[160:161] offset:36864
    buffer_load_dwordx4 v[200:203], v186, s[48:51], s23 offen offset:3072
    v_pk_mul_f32 v[162:163], v[132:133], v[132:133]
    ds_read_b128 a[196:199], v11 offset:13312
    v_pk_mul_f32 v[164:165], v[134:135], v[134:135]
    ds_read_b128 v[232:235], v11 offset:31744
    v_pk_fma_f32 v[162:163], v[162:163], v[14:15], v[6:7] op_sel:[0,0,1] op_sel_hi:[1,0,1]
    ds_read_b128 a[56:59], v10 offset:14336
    v_pk_fma_f32 v[164:165], v[164:165], v[14:15], v[6:7] op_sel:[0,0,1] op_sel_hi:[1,0,1]
    v_pk_mul_f32 v[162:163], v[132:133], v[162:163]
    ds_read_b128 a[128:131], v10 offset:32768
    v_pk_mul_f32 v[164:165], v[134:135], v[164:165]
    ds_read_b128 a[200:203], v11 offset:14336
    buffer_load_dwordx4 v[204:207], v187, s[48:51], s23 offen offset:0
    v_exp_f32 v162, v162
    ds_read_b128 v[236:239], v11 offset:32768
    v_exp_f32 v163, v163
    v_exp_f32 v164, v164
    ds_read_b128 a[60:63], v10 offset:15360
    v_exp_f32 v165, v165
    ds_read_b128 a[132:135], v10 offset:33792
    v_pk_mul_f32 v[166:167], v[132:133], v[148:149]
    ds_read_b128 a[204:207], v11 offset:15360
    v_pk_mul_f32 v[168:169], v[134:135], v[150:151]
    buffer_load_dwordx4 v[208:211], v187, s[48:51], s23 offen offset:1024
    v_pk_fma_f32 v[162:163], v[162:163], v[252:253], v[252:253] op_sel:[0,0,0] op_sel_hi:[1,0,0]
    ds_read_b128 v[240:243], v11 offset:33792
    v_pk_fma_f32 v[164:165], v[164:165], v[252:253], v[252:253] op_sel:[0,0,0] op_sel_hi:[1,0,0]
    v_rcp_f32 v162, v162
    v_rcp_f32 v163, v163
    v_rcp_f32 v164, v164
    v_rcp_f32 v165, v165
    buffer_load_dwordx4 v[212:215], v187, s[48:51], s23 offen offset:2048
    s_nop 0
    v_pk_mul_f32 v[166:167], v[166:167], v[162:163]
    v_pk_mul_f32 v[168:169], v[168:169], v[164:165]
    v_cvt_pk_bf16_f32 v170, v166, v167
    v_cvt_pk_bf16_f32 v171, v168, v169
    ds_write_b64 v12, v[170:171] offset:55296
    buffer_load_dwordx4 v[216:219], v187, s[48:51], s23 offen offset:3072
    buffer_load_dwordx4 v[136:139], v188, s[48:51], s23 offen offset:0
    buffer_load_dwordx4 v[140:143], v188, s[48:51], s23 offen offset:1024
    s_add_u32 s23, s23, 18432
    v_bfe_u32 v1, v0, 3, 2
    s_mov_b32 s7, 73728
    v_mul_lo_u32 v2, v1, s7
    v_lshrrev_b32 v1, 5, v0
    v_lshl_add_u32 v2, v1, 7, v2
    v_and_b32 v1, 7, v0
    v_lshl_add_u32 v2, v1, 4, v2
    v_add_u32 v3, 294912, v2
    s_mul_i32 s26, s41, 589824
    s_add_u32 s26, s26, s43
    s_mul_i32 s7, s40, 9216
    s_add_u32 s26, s26, s7
    s_mul_i32 s7, s3, 2304
    s_add_u32 s26, s26, s7
    s_add_u32 s26, s26, 29360128
    s_add_u32 s27, s26, 2048
    s_waitcnt lgkmcnt(0)
    s_barrier
    ds_read_b128 a[64:67], v10 offset:16384
    ds_read_b128 a[136:139], v10 offset:34816
    ds_read_b128 a[208:211], v11 offset:16384
    ds_read_b128 v[244:247], v11 offset:34816
    ds_read_b128 a[68:71], v10 offset:17408
    ds_read_b128 a[140:143], v10 offset:35840
    ds_read_b128 a[212:215], v11 offset:17408
    ds_read_b128 v[248:251], v11 offset:35840
    s_mov_b32 s25, 0
    s_waitcnt lgkmcnt(0)
    s_branch L_ffn_dn_mid_15
L_ffn_dn_14:
    s_waitcnt vmcnt(32)
    v_mfma_f32_16x16x32_bf16 v[88:91], v[104:107], a[0:3], 0
    v_mfma_f32_16x16x32_bf16 v[88:91], v[108:111], a[4:7], v[88:91]
    buffer_load_dwordx4 v[76:79], v184, s[48:51], s23 offen offset:0
    v_mfma_f32_16x16x32_bf16 v[88:91], v[112:115], a[8:11], v[88:91]
    v_mfma_f32_16x16x32_bf16 v[92:95], v[104:107], a[72:75], 0
    v_mfma_f32_16x16x32_bf16 v[92:95], v[108:111], a[76:79], v[92:95]
    v_mfma_f32_16x16x32_bf16 v[92:95], v[112:115], a[80:83], v[92:95]
    buffer_load_dwordx4 v[80:83], v184, s[48:51], s23 offen offset:1024
    v_mfma_f32_16x16x32_bf16 v[96:99], v[104:107], a[144:147], 0
    v_cvt_pk_bf16_f32 v152, v120, v121
    v_cvt_pk_bf16_f32 v153, v122, v123
    v_mfma_f32_16x16x32_bf16 v[96:99], v[108:111], a[148:151], v[96:99]
    v_cvt_pk_bf16_f32 v154, v124, v125
    v_cvt_pk_bf16_f32 v155, v126, v127
    v_mfma_f32_16x16x32_bf16 v[96:99], v[112:115], a[152:155], v[96:99]
    v_cvt_pk_bf16_f32 v156, v128, v129
    v_cvt_pk_bf16_f32 v157, v130, v131
    v_mfma_f32_16x16x32_bf16 v[100:103], v[104:107], a[216:219], 0
    buffer_load_dwordx4 v[84:87], v184, s[48:51], s23 offen offset:2048
    v_mfma_f32_16x16x32_bf16 v[100:103], v[108:111], a[220:223], v[100:103]
    v_cvt_pk_bf16_f32 v158, v132, v133
    v_cvt_pk_bf16_f32 v159, v134, v135
    v_mfma_f32_16x16x32_bf16 v[100:103], v[112:115], a[224:227], v[100:103]
    v_permlane16_swap_b32 v152, v154
    s_waitcnt vmcnt(32)
    v_mfma_f32_16x16x32_bf16 v[88:91], v[116:119], a[12:15], v[88:91]
    v_permlane16_swap_b32 v153, v155
    v_mfma_f32_16x16x32_bf16 v[88:91], v[172:175], a[16:19], v[88:91]
    buffer_load_dwordx4 v[104:107], v184, s[48:51], s23 offen offset:3072
    v_mfma_f32_16x16x32_bf16 v[88:91], v[176:179], a[20:23], v[88:91]
    v_permlane16_swap_b32 v156, v158
    v_mfma_f32_16x16x32_bf16 v[92:95], v[116:119], a[84:87], v[92:95]
    v_permlane16_swap_b32 v157, v159
    v_mfma_f32_16x16x32_bf16 v[92:95], v[172:175], a[88:91], v[92:95]
    buffer_store_dwordx4 v[152:155], v2, s[8:11], s27 offen sc1
    v_mfma_f32_16x16x32_bf16 v[92:95], v[176:179], a[92:95], v[92:95]
    buffer_load_dwordx4 v[108:111], v185, s[48:51], s23 offen offset:0
    v_mfma_f32_16x16x32_bf16 v[96:99], v[116:119], a[156:159], v[96:99]
    buffer_store_dwordx4 v[156:159], v3, s[8:11], s27 offen sc1
    v_mfma_f32_16x16x32_bf16 v[96:99], v[172:175], a[160:163], v[96:99]
    v_mfma_f32_16x16x32_bf16 v[96:99], v[176:179], a[164:167], v[96:99]
    v_mfma_f32_16x16x32_bf16 v[100:103], v[116:119], a[228:231], v[100:103]
    buffer_load_dwordx4 v[112:115], v185, s[48:51], s23 offen offset:1024
    v_mfma_f32_16x16x32_bf16 v[100:103], v[172:175], a[232:235], v[100:103]
    v_mfma_f32_16x16x32_bf16 v[100:103], v[176:179], a[236:239], v[100:103]
    s_waitcnt vmcnt(34)
    v_mfma_f32_16x16x32_bf16 v[88:91], v[180:183], a[24:27], v[88:91]
    v_mfma_f32_16x16x32_bf16 v[88:91], v[196:199], a[28:31], v[88:91]
    buffer_load_dwordx4 v[116:119], v185, s[48:51], s23 offen offset:2048
    v_mfma_f32_16x16x32_bf16 v[88:91], v[200:203], a[32:35], v[88:91]
    v_mfma_f32_16x16x32_bf16 v[92:95], v[180:183], a[96:99], v[92:95]
    v_mfma_f32_16x16x32_bf16 v[92:95], v[196:199], a[100:103], v[92:95]
    v_mfma_f32_16x16x32_bf16 v[92:95], v[200:203], a[104:107], v[92:95]
    buffer_load_dwordx4 v[172:175], v185, s[48:51], s23 offen offset:3072
    v_mfma_f32_16x16x32_bf16 v[96:99], v[180:183], a[168:171], v[96:99]
    v_mfma_f32_16x16x32_bf16 v[96:99], v[196:199], a[172:175], v[96:99]
    v_mfma_f32_16x16x32_bf16 v[96:99], v[200:203], a[176:179], v[96:99]
    v_mfma_f32_16x16x32_bf16 v[100:103], v[180:183], a[240:243], v[100:103]
    buffer_load_dwordx4 v[176:179], v186, s[48:51], s23 offen offset:0
    v_mfma_f32_16x16x32_bf16 v[100:103], v[196:199], a[244:247], v[100:103]
    v_mfma_f32_16x16x32_bf16 v[100:103], v[200:203], a[248:251], v[100:103]
    s_waitcnt vmcnt(34)
    v_mfma_f32_16x16x32_bf16 v[88:91], v[204:207], a[36:39], v[88:91]
    v_mfma_f32_16x16x32_bf16 v[88:91], v[208:211], a[40:43], v[88:91]
    buffer_load_dwordx4 v[180:183], v186, s[48:51], s23 offen offset:1024
    v_mfma_f32_16x16x32_bf16 v[88:91], v[212:215], a[44:47], v[88:91]
    v_mfma_f32_16x16x32_bf16 v[92:95], v[204:207], a[108:111], v[92:95]
    v_mfma_f32_16x16x32_bf16 v[92:95], v[208:211], a[112:115], v[92:95]
    v_mfma_f32_16x16x32_bf16 v[92:95], v[212:215], a[116:119], v[92:95]
    buffer_load_dwordx4 v[196:199], v186, s[48:51], s23 offen offset:2048
    v_mfma_f32_16x16x32_bf16 v[96:99], v[204:207], a[180:183], v[96:99]
    v_mfma_f32_16x16x32_bf16 v[96:99], v[208:211], a[184:187], v[96:99]
    v_mfma_f32_16x16x32_bf16 v[96:99], v[212:215], a[188:191], v[96:99]
    v_mfma_f32_16x16x32_bf16 v[100:103], v[204:207], a[252:255], v[100:103]
    buffer_load_dwordx4 v[200:203], v186, s[48:51], s23 offen offset:3072
    v_mfma_f32_16x16x32_bf16 v[100:103], v[208:211], v[220:223], v[100:103]
    v_mfma_f32_16x16x32_bf16 v[100:103], v[212:215], v[224:227], v[100:103]
    s_waitcnt vmcnt(34)
    v_mfma_f32_16x16x32_bf16 v[88:91], v[216:219], a[48:51], v[88:91]
    v_mfma_f32_16x16x32_bf16 v[88:91], v[136:139], a[52:55], v[88:91]
    buffer_load_dwordx4 v[204:207], v187, s[48:51], s23 offen offset:0
    v_mfma_f32_16x16x32_bf16 v[88:91], v[140:143], a[56:59], v[88:91]
    v_mfma_f32_16x16x32_bf16 v[92:95], v[216:219], a[120:123], v[92:95]
    v_mfma_f32_16x16x32_bf16 v[92:95], v[136:139], a[124:127], v[92:95]
    v_mfma_f32_16x16x32_bf16 v[92:95], v[140:143], a[128:131], v[92:95]
    buffer_load_dwordx4 v[208:211], v187, s[48:51], s23 offen offset:1024
    v_mfma_f32_16x16x32_bf16 v[96:99], v[216:219], a[192:195], v[96:99]
    v_mfma_f32_16x16x32_bf16 v[96:99], v[136:139], a[196:199], v[96:99]
    v_mfma_f32_16x16x32_bf16 v[96:99], v[140:143], a[200:203], v[96:99]
    v_mfma_f32_16x16x32_bf16 v[100:103], v[216:219], v[228:231], v[100:103]
    buffer_load_dwordx4 v[212:215], v187, s[48:51], s23 offen offset:2048
    v_mfma_f32_16x16x32_bf16 v[100:103], v[136:139], v[232:235], v[100:103]
    v_mfma_f32_16x16x32_bf16 v[100:103], v[140:143], v[236:239], v[100:103]
    s_waitcnt vmcnt(34)
    v_mfma_f32_16x16x32_bf16 v[88:91], v[144:147], a[60:63], v[88:91]
    v_mfma_f32_16x16x32_bf16 v[88:91], v[148:151], a[64:67], v[88:91]
    buffer_load_dwordx4 v[216:219], v187, s[48:51], s23 offen offset:3072
    v_mfma_f32_16x16x32_bf16 v[120:123], v[160:163], a[68:71], v[88:91]
    v_mfma_f32_16x16x32_bf16 v[92:95], v[144:147], a[132:135], v[92:95]
    v_mfma_f32_16x16x32_bf16 v[92:95], v[148:151], a[136:139], v[92:95]
    v_mfma_f32_16x16x32_bf16 v[124:127], v[160:163], a[140:143], v[92:95]
    buffer_load_dwordx4 v[136:139], v188, s[48:51], s23 offen offset:0
    v_mfma_f32_16x16x32_bf16 v[96:99], v[144:147], a[204:207], v[96:99]
    s_lshl_b32 s7, s25, 8
    v_mfma_f32_16x16x32_bf16 v[96:99], v[148:151], a[208:211], v[96:99]
    s_add_u32 s27, s26, s7
    v_mfma_f32_16x16x32_bf16 v[128:131], v[160:163], a[212:215], v[96:99]
    s_add_u32 s25, s25, 1
    v_mfma_f32_16x16x32_bf16 v[100:103], v[144:147], v[240:243], v[100:103]
    buffer_load_dwordx4 v[140:143], v188, s[48:51], s23 offen offset:1024
    v_mfma_f32_16x16x32_bf16 v[100:103], v[148:151], v[244:247], v[100:103]
    s_add_u32 s23, s23, 18432
    v_mfma_f32_16x16x32_bf16 v[132:135], v[160:163], v[248:251], v[100:103]
L_ffn_dn_mid_15:
    s_waitcnt vmcnt(30)
    v_mfma_f32_16x16x32_bf16 v[88:91], v[16:19], a[0:3], 0
    v_mfma_f32_16x16x32_bf16 v[88:91], v[20:23], a[4:7], v[88:91]
    buffer_load_dwordx4 v[144:147], v184, s[48:51], s23 offen offset:0
    v_mfma_f32_16x16x32_bf16 v[88:91], v[24:27], a[8:11], v[88:91]
    v_mfma_f32_16x16x32_bf16 v[92:95], v[16:19], a[72:75], 0
    v_mfma_f32_16x16x32_bf16 v[92:95], v[20:23], a[76:79], v[92:95]
    v_mfma_f32_16x16x32_bf16 v[92:95], v[24:27], a[80:83], v[92:95]
    buffer_load_dwordx4 v[148:151], v184, s[48:51], s23 offen offset:1024
    v_mfma_f32_16x16x32_bf16 v[96:99], v[16:19], a[144:147], 0
    v_cvt_pk_bf16_f32 v152, v120, v121
    v_cvt_pk_bf16_f32 v153, v122, v123
    v_mfma_f32_16x16x32_bf16 v[96:99], v[20:23], a[148:151], v[96:99]
    v_cvt_pk_bf16_f32 v154, v124, v125
    v_cvt_pk_bf16_f32 v155, v126, v127
    v_mfma_f32_16x16x32_bf16 v[96:99], v[24:27], a[152:155], v[96:99]
    v_cvt_pk_bf16_f32 v156, v128, v129
    v_cvt_pk_bf16_f32 v157, v130, v131
    v_mfma_f32_16x16x32_bf16 v[100:103], v[16:19], a[216:219], 0
    buffer_load_dwordx4 v[160:163], v184, s[48:51], s23 offen offset:2048
    v_mfma_f32_16x16x32_bf16 v[100:103], v[20:23], a[220:223], v[100:103]
    v_cvt_pk_bf16_f32 v158, v132, v133
    v_cvt_pk_bf16_f32 v159, v134, v135
    v_mfma_f32_16x16x32_bf16 v[100:103], v[24:27], a[224:227], v[100:103]
    v_permlane16_swap_b32 v152, v154
    s_waitcnt vmcnt(30)
    v_mfma_f32_16x16x32_bf16 v[88:91], v[28:31], a[12:15], v[88:91]
    v_permlane16_swap_b32 v153, v155
    v_mfma_f32_16x16x32_bf16 v[88:91], v[32:35], a[16:19], v[88:91]
    buffer_load_dwordx4 v[16:19], v184, s[48:51], s23 offen offset:3072
    v_mfma_f32_16x16x32_bf16 v[88:91], v[36:39], a[20:23], v[88:91]
    v_permlane16_swap_b32 v156, v158
    v_mfma_f32_16x16x32_bf16 v[92:95], v[28:31], a[84:87], v[92:95]
    v_permlane16_swap_b32 v157, v159
    v_mfma_f32_16x16x32_bf16 v[92:95], v[32:35], a[88:91], v[92:95]
    buffer_store_dwordx4 v[152:155], v2, s[8:11], s27 offen sc1
    v_mfma_f32_16x16x32_bf16 v[92:95], v[36:39], a[92:95], v[92:95]
    buffer_load_dwordx4 v[20:23], v185, s[48:51], s23 offen offset:0
    v_mfma_f32_16x16x32_bf16 v[96:99], v[28:31], a[156:159], v[96:99]
    buffer_store_dwordx4 v[156:159], v3, s[8:11], s27 offen sc1
    v_mfma_f32_16x16x32_bf16 v[96:99], v[32:35], a[160:163], v[96:99]
    v_mfma_f32_16x16x32_bf16 v[96:99], v[36:39], a[164:167], v[96:99]
    v_mfma_f32_16x16x32_bf16 v[100:103], v[28:31], a[228:231], v[100:103]
    buffer_load_dwordx4 v[24:27], v185, s[48:51], s23 offen offset:1024
    v_mfma_f32_16x16x32_bf16 v[100:103], v[32:35], a[232:235], v[100:103]
    v_mfma_f32_16x16x32_bf16 v[100:103], v[36:39], a[236:239], v[100:103]
    s_waitcnt vmcnt(32)
    v_mfma_f32_16x16x32_bf16 v[88:91], v[40:43], a[24:27], v[88:91]
    v_mfma_f32_16x16x32_bf16 v[88:91], v[44:47], a[28:31], v[88:91]
    buffer_load_dwordx4 v[28:31], v185, s[48:51], s23 offen offset:2048
    v_mfma_f32_16x16x32_bf16 v[88:91], v[48:51], a[32:35], v[88:91]
    v_mfma_f32_16x16x32_bf16 v[92:95], v[40:43], a[96:99], v[92:95]
    v_mfma_f32_16x16x32_bf16 v[92:95], v[44:47], a[100:103], v[92:95]
    v_mfma_f32_16x16x32_bf16 v[92:95], v[48:51], a[104:107], v[92:95]
    buffer_load_dwordx4 v[32:35], v185, s[48:51], s23 offen offset:3072
    v_mfma_f32_16x16x32_bf16 v[96:99], v[40:43], a[168:171], v[96:99]
    v_mfma_f32_16x16x32_bf16 v[96:99], v[44:47], a[172:175], v[96:99]
    v_mfma_f32_16x16x32_bf16 v[96:99], v[48:51], a[176:179], v[96:99]
    v_mfma_f32_16x16x32_bf16 v[100:103], v[40:43], a[240:243], v[100:103]
    buffer_load_dwordx4 v[36:39], v186, s[48:51], s23 offen offset:0
    v_mfma_f32_16x16x32_bf16 v[100:103], v[44:47], a[244:247], v[100:103]
    v_mfma_f32_16x16x32_bf16 v[100:103], v[48:51], a[248:251], v[100:103]
    s_waitcnt vmcnt(32)
    v_mfma_f32_16x16x32_bf16 v[88:91], v[52:55], a[36:39], v[88:91]
    v_mfma_f32_16x16x32_bf16 v[88:91], v[56:59], a[40:43], v[88:91]
    buffer_load_dwordx4 v[40:43], v186, s[48:51], s23 offen offset:1024
    v_mfma_f32_16x16x32_bf16 v[88:91], v[60:63], a[44:47], v[88:91]
    v_mfma_f32_16x16x32_bf16 v[92:95], v[52:55], a[108:111], v[92:95]
    v_mfma_f32_16x16x32_bf16 v[92:95], v[56:59], a[112:115], v[92:95]
    v_mfma_f32_16x16x32_bf16 v[92:95], v[60:63], a[116:119], v[92:95]
    buffer_load_dwordx4 v[44:47], v186, s[48:51], s23 offen offset:2048
    v_mfma_f32_16x16x32_bf16 v[96:99], v[52:55], a[180:183], v[96:99]
    v_mfma_f32_16x16x32_bf16 v[96:99], v[56:59], a[184:187], v[96:99]
    v_mfma_f32_16x16x32_bf16 v[96:99], v[60:63], a[188:191], v[96:99]
    v_mfma_f32_16x16x32_bf16 v[100:103], v[52:55], a[252:255], v[100:103]
    buffer_load_dwordx4 v[48:51], v186, s[48:51], s23 offen offset:3072
    v_mfma_f32_16x16x32_bf16 v[100:103], v[56:59], v[220:223], v[100:103]
    v_mfma_f32_16x16x32_bf16 v[100:103], v[60:63], v[224:227], v[100:103]
    s_waitcnt vmcnt(32)
    v_mfma_f32_16x16x32_bf16 v[88:91], v[64:67], a[48:51], v[88:91]
    v_mfma_f32_16x16x32_bf16 v[88:91], v[68:71], a[52:55], v[88:91]
    buffer_load_dwordx4 v[52:55], v187, s[48:51], s23 offen offset:0
    v_mfma_f32_16x16x32_bf16 v[88:91], v[72:75], a[56:59], v[88:91]
    v_mfma_f32_16x16x32_bf16 v[92:95], v[64:67], a[120:123], v[92:95]
    v_mfma_f32_16x16x32_bf16 v[92:95], v[68:71], a[124:127], v[92:95]
    v_mfma_f32_16x16x32_bf16 v[92:95], v[72:75], a[128:131], v[92:95]
    buffer_load_dwordx4 v[56:59], v187, s[48:51], s23 offen offset:1024
    v_mfma_f32_16x16x32_bf16 v[96:99], v[64:67], a[192:195], v[96:99]
    v_mfma_f32_16x16x32_bf16 v[96:99], v[68:71], a[196:199], v[96:99]
    v_mfma_f32_16x16x32_bf16 v[96:99], v[72:75], a[200:203], v[96:99]
    v_mfma_f32_16x16x32_bf16 v[100:103], v[64:67], v[228:231], v[100:103]
    buffer_load_dwordx4 v[60:63], v187, s[48:51], s23 offen offset:2048
    v_mfma_f32_16x16x32_bf16 v[100:103], v[68:71], v[232:235], v[100:103]
    v_mfma_f32_16x16x32_bf16 v[100:103], v[72:75], v[236:239], v[100:103]
    s_waitcnt vmcnt(32)
    v_mfma_f32_16x16x32_bf16 v[88:91], v[76:79], a[60:63], v[88:91]
    v_mfma_f32_16x16x32_bf16 v[88:91], v[80:83], a[64:67], v[88:91]
    buffer_load_dwordx4 v[64:67], v187, s[48:51], s23 offen offset:3072
    v_mfma_f32_16x16x32_bf16 v[120:123], v[84:87], a[68:71], v[88:91]
    v_mfma_f32_16x16x32_bf16 v[92:95], v[76:79], a[132:135], v[92:95]
    v_mfma_f32_16x16x32_bf16 v[92:95], v[80:83], a[136:139], v[92:95]
    v_mfma_f32_16x16x32_bf16 v[124:127], v[84:87], a[140:143], v[92:95]
    buffer_load_dwordx4 v[68:71], v188, s[48:51], s23 offen offset:0
    v_mfma_f32_16x16x32_bf16 v[96:99], v[76:79], a[204:207], v[96:99]
    s_lshl_b32 s7, s25, 8
    v_mfma_f32_16x16x32_bf16 v[96:99], v[80:83], a[208:211], v[96:99]
    s_add_u32 s27, s26, s7
    v_mfma_f32_16x16x32_bf16 v[128:131], v[84:87], a[212:215], v[96:99]
    s_add_u32 s25, s25, 1
    v_mfma_f32_16x16x32_bf16 v[100:103], v[76:79], v[240:243], v[100:103]
    buffer_load_dwordx4 v[72:75], v188, s[48:51], s23 offen offset:1024
    v_mfma_f32_16x16x32_bf16 v[100:103], v[80:83], v[244:247], v[100:103]
    s_add_u32 s23, s23, 18432
    v_mfma_f32_16x16x32_bf16 v[132:135], v[84:87], v[248:251], v[100:103]
    s_cmp_lt_u32 s25, 9
    s_cbranch_scc1 L_ffn_dn_14
    s_nop 7
    v_cvt_pk_bf16_f32 v152, v120, v121
    v_cvt_pk_bf16_f32 v153, v122, v123
    v_cvt_pk_bf16_f32 v154, v124, v125
    v_cvt_pk_bf16_f32 v155, v126, v127
    v_cvt_pk_bf16_f32 v156, v128, v129
    v_cvt_pk_bf16_f32 v157, v130, v131
    v_cvt_pk_bf16_f32 v158, v132, v133
    v_cvt_pk_bf16_f32 v159, v134, v135
    s_nop 1
    v_permlane16_swap_b32 v152, v154
    v_permlane16_swap_b32 v153, v155
    v_permlane16_swap_b32 v156, v158
    v_permlane16_swap_b32 v157, v159
    buffer_store_dwordx4 v[152:155], v2, s[8:11], s27 offen sc1
    buffer_store_dwordx4 v[156:159], v3, s[8:11], s27 offen sc1
    v_lshlrev_b32 v15, 7, v0
    s_lshl_b32 s6, s40, 2
    s_add_u32 s6, s6, s44
    s_add_u32 s6, s6, 65536
    v_mov_b32 v1, 1
    s_mov_b64 vcc, 0xff
    s_waitcnt vmcnt(0)
    s_barrier
    s_cmp_lg_u32 s3, 0
    s_cbranch_scc1 L_pub_16
    s_mov_b64 exec, vcc
    buffer_store_dword v1, v15, s[8:11], s6 offen sc1
    s_mov_b64 exec, -1
L_pub_16:
    s_mov_b32 s16, 0xffff0000
    s_lshl_b32 s7, s3, 10
    v_lshl_add_u32 v2, v0, 4, s7
    v_add_u32 v3, 4096, v2
    v_and_b32 v8, 7, v0
    v_mul_u32_u24 v8, 1152, v8
    v_lshrrev_b32 v9, 3, v0
    v_lshl_add_u32 v8, v9, 4, v8
    s_lshl_b32 s7, s3, 7
    v_add_u32 v5, s7, v8
    v_add_u32 v6, 512, v5
    s_cmp_eq_u32 s3, 0
    s_mov_b32 s17, 1073741824
    s_cmov_b32 s17, 8192
    v_add_u32 v4, s17, v2
    s_mov_b32 s17, 1073741824
    s_cmov_b32 s17, 1024
    v_add_u32 v7, s17, v5
    s_lshl_b32 s21, s41, 3
    s_add_u32 s21, s21, s40
    s_mul_i32 s18, s21, 9216
    s_add_u32 s19, s18, s43
    s_add_u32 s22, s19, 48234496
    s_mul_i32 s20, s21, 73728
    s_add_u32 s20, s20, s43
    s_add_u32 s20, s20, 29360128
    s_lshl_b32 s23, s21, 5
    s_add_u32 s23, s23, s43
    s_add_u32 s23, s23, 24641536
    v_and_b32 v8, 7, v0
    v_lshlrev_b32 v8, 2, v8
    buffer_load_dword v10, v8, s[8:11], s23 offen sc1
    buffer_load_dwordx4 v[16:19], v2, s[8:11], s22 offen sc1
    buffer_load_dwordx4 v[20:23], v3, s[8:11], s22 offen sc1
    buffer_load_dwordx4 v[24:27], v4, s[8:11], s22 offen sc1
    s_cmp_eq_u32 s3, 0
    s_cselect_b32 s7, 1.0, 0
    s_waitcnt vmcnt(0)
    v_mul_f32 v11, s7, v10
    v_lshlrev_b32 v124, 16, v16
    v_and_b32 v125, s16, v16
    v_lshlrev_b32 v126, 16, v17
    v_and_b32 v127, s16, v17
    v_lshlrev_b32 v128, 16, v18
    v_and_b32 v129, s16, v18
    v_lshlrev_b32 v130, 16, v19
    v_and_b32 v131, s16, v19
    v_pk_add_f32 v[124:125], v[124:125], v[10:11] op_sel_hi:[1,0]
    v_pk_add_f32 v[126:127], v[126:127], v[10:11] op_sel_hi:[1,0]
    v_pk_add_f32 v[128:129], v[128:129], v[10:11] op_sel_hi:[1,0]
    v_pk_add_f32 v[130:131], v[130:131], v[10:11] op_sel_hi:[1,0]
    v_lshlrev_b32 v132, 16, v20
    v_and_b32 v133, s16, v20
    v_lshlrev_b32 v134, 16, v21
    v_and_b32 v135, s16, v21
    v_lshlrev_b32 v136, 16, v22
    v_and_b32 v137, s16, v22
    v_lshlrev_b32 v138, 16, v23
    v_and_b32 v139, s16, v23
    v_pk_add_f32 v[132:133], v[132:133], v[10:11] op_sel_hi:[1,0]
    v_pk_add_f32 v[134:135], v[134:135], v[10:11] op_sel_hi:[1,0]
    v_pk_add_f32 v[136:137], v[136:137], v[10:11] op_sel_hi:[1,0]
    v_pk_add_f32 v[138:139], v[138:139], v[10:11] op_sel_hi:[1,0]
    v_lshlrev_b32 v140, 16, v24
    v_and_b32 v141, s16, v24
    v_lshlrev_b32 v142, 16, v25
    v_and_b32 v143, s16, v25
    v_lshlrev_b32 v144, 16, v26
    v_and_b32 v145, s16, v26
    v_lshlrev_b32 v146, 16, v27
    v_and_b32 v147, s16, v27
    v_pk_add_f32 v[140:141], v[140:141], v[10:11] op_sel:[0,1] op_sel_hi:[1,1]
    v_pk_add_f32 v[142:143], v[142:143], v[10:11] op_sel:[0,1] op_sel_hi:[1,1]
    v_pk_add_f32 v[144:145], v[144:145], v[10:11] op_sel:[0,1] op_sel_hi:[1,1]
    v_pk_add_f32 v[146:147], v[146:147], v[10:11] op_sel:[0,1] op_sel_hi:[1,1]
    s_cmp_lg_u32 s3, 0
    s_cbranch_scc1 L_polled_18
    s_lshl_b32 s7, s40, 7
    s_add_u32 s7, s7, s44
    s_add_u32 s7, s7, 65536
    s_add_u32 s52, s4, s7
    s_addc_u32 s53, s5, 0
    s_mov_b32 s6, 0
L_poll_17:
    s_load_dwordx8 s[56:63], s[52:53], 0 glc
    s_add_u32 s6, s6, 1
    s_waitcnt lgkmcnt(0)
    s_and_b64 s[56:57], s[56:57], s[58:59]
    s_and_b64 s[60:61], s[60:61], s[62:63]
    s_and_b64 s[56:57], s[56:57], s[60:61]
    s_and_b32 s56, s56, s57
    s_cbranch_scc1 L_polled_18
    s_cmp_ge_u32 s6, 1048576
    s_cbranch_scc1 L_main_end
    s_branch L_poll_17
L_polled_18:
    s_barrier
    buffer_load_dwordx4 v[28:31], v2, s[8:11], s20 offen sc1
    buffer_load_dwordx4 v[32:35], v3, s[8:11], s20 offen sc1
    buffer_load_dwordx4 v[36:39], v4, s[8:11], s20 offen sc1
    s_add_u32 s20, s20, 9216
    buffer_load_dwordx4 v[40:43], v2, s[8:11], s20 offen sc1
    buffer_load_dwordx4 v[44:47], v3, s[8:11], s20 offen sc1
    buffer_load_dwordx4 v[48:51], v4, s[8:11], s20 offen sc1
    s_add_u32 s20, s20, 9216
    buffer_load_dwordx4 v[52:55], v2, s[8:11], s20 offen sc1
    buffer_load_dwordx4 v[56:59], v3, s[8:11], s20 offen sc1
    s_waitcnt vmcnt(7)
    buffer_load_dwordx4 v[60:63], v4, s[8:11], s20 offen sc1
    s_add_u32 s20, s20, 9216
    v_lshlrev_b32 v148, 16, v28
    v_and_b32 v149, s16, v28
    v_lshlrev_b32 v150, 16, v29
    v_and_b32 v151, s16, v29
    v_lshlrev_b32 v152, 16, v30
    v_and_b32 v153, s16, v30
    v_lshlrev_b32 v154, 16, v31
    v_and_b32 v155, s16, v31
    v_pk_add_f32 v[124:125], v[124:125], v[148:149]
    v_pk_add_f32 v[126:127], v[126:127], v[150:151]
    v_pk_add_f32 v[128:129], v[128:129], v[152:153]
    v_pk_add_f32 v[130:131], v[130:131], v[154:155]
    s_waitcnt vmcnt(7)
    buffer_load_dwordx4 v[64:67], v2, s[8:11], s20 offen sc1
    v_lshlrev_b32 v148, 16, v32
    v_and_b32 v149, s16, v32
    v_lshlrev_b32 v150, 16, v33
    v_and_b32 v151, s16, v33
    v_lshlrev_b32 v152, 16, v34
    v_and_b32 v153, s16, v34
    v_lshlrev_b32 v154, 16, v35
    v_and_b32 v155, s16, v35
    v_pk_add_f32 v[132:133], v[132:133], v[148:149]
    v_pk_add_f32 v[134:135], v[134:135], v[150:151]
    v_pk_add_f32 v[136:137], v[136:137], v[152:153]
    v_pk_add_f32 v[138:139], v[138:139], v[154:155]
    s_waitcnt vmcnt(7)
    buffer_load_dwordx4 v[68:71], v3, s[8:11], s20 offen sc1
    v_lshlrev_b32 v148, 16, v36
    v_and_b32 v149, s16, v36
    v_lshlrev_b32 v150, 16, v37
    v_and_b32 v151, s16, v37
    v_lshlrev_b32 v152, 16, v38
    v_and_b32 v153, s16, v38
    v_lshlrev_b32 v154, 16, v39
    v_and_b32 v155, s16, v39
    v_pk_add_f32 v[140:141], v[140:141], v[148:149]
    v_pk_add_f32 v[142:143], v[142:143], v[150:151]
    v_pk_add_f32 v[144:145], v[144:145], v[152:153]
    v_pk_add_f32 v[146:147], v[146:147], v[154:155]
    s_waitcnt vmcnt(7)
    buffer_load_dwordx4 v[72:75], v4, s[8:11], s20 offen sc1
    s_add_u32 s20, s20, 9216
    v_lshlrev_b32 v148, 16, v40
    v_and_b32 v149, s16, v40
    v_lshlrev_b32 v150, 16, v41
    v_and_b32 v151, s16, v41
    v_lshlrev_b32 v152, 16, v42
    v_and_b32 v153, s16, v42
    v_lshlrev_b32 v154, 16, v43
    v_and_b32 v155, s16, v43
    v_pk_add_f32 v[124:125], v[124:125], v[148:149]
    v_pk_add_f32 v[126:127], v[126:127], v[150:151]
    v_pk_add_f32 v[128:129], v[128:129], v[152:153]
    v_pk_add_f32 v[130:131], v[130:131], v[154:155]
    s_waitcnt vmcnt(7)
    buffer_load_dwordx4 v[76:79], v2, s[8:11], s20 offen sc1
    v_lshlrev_b32 v148, 16, v44
    v_and_b32 v149, s16, v44
    v_lshlrev_b32 v150, 16, v45
    v_and_b32 v151, s16, v45
    v_lshlrev_b32 v152, 16, v46
    v_and_b32 v153, s16, v46
    v_lshlrev_b32 v154, 16, v47
    v_and_b32 v155, s16, v47
    v_pk_add_f32 v[132:133], v[132:133], v[148:149]
    v_pk_add_f32 v[134:135], v[134:135], v[150:151]
    v_pk_add_f32 v[136:137], v[136:137], v[152:153]
    v_pk_add_f32 v[138:139], v[138:139], v[154:155]
    s_waitcnt vmcnt(7)
    buffer_load_dwordx4 v[80:83], v3, s[8:11], s20 offen sc1
    v_lshlrev_b32 v148, 16, v48
    v_and_b32 v149, s16, v48
    v_lshlrev_b32 v150, 16, v49
    v_and_b32 v151, s16, v49
    v_lshlrev_b32 v152, 16, v50
    v_and_b32 v153, s16, v50
    v_lshlrev_b32 v154, 16, v51
    v_and_b32 v155, s16, v51
    v_pk_add_f32 v[140:141], v[140:141], v[148:149]
    v_pk_add_f32 v[142:143], v[142:143], v[150:151]
    v_pk_add_f32 v[144:145], v[144:145], v[152:153]
    v_pk_add_f32 v[146:147], v[146:147], v[154:155]
    s_waitcnt vmcnt(7)
    buffer_load_dwordx4 v[84:87], v4, s[8:11], s20 offen sc1
    s_add_u32 s20, s20, 9216
    v_lshlrev_b32 v148, 16, v52
    v_and_b32 v149, s16, v52
    v_lshlrev_b32 v150, 16, v53
    v_and_b32 v151, s16, v53
    v_lshlrev_b32 v152, 16, v54
    v_and_b32 v153, s16, v54
    v_lshlrev_b32 v154, 16, v55
    v_and_b32 v155, s16, v55
    v_pk_add_f32 v[124:125], v[124:125], v[148:149]
    v_pk_add_f32 v[126:127], v[126:127], v[150:151]
    v_pk_add_f32 v[128:129], v[128:129], v[152:153]
    v_pk_add_f32 v[130:131], v[130:131], v[154:155]
    s_waitcnt vmcnt(7)
    buffer_load_dwordx4 v[88:91], v2, s[8:11], s20 offen sc1
    v_lshlrev_b32 v148, 16, v56
    v_and_b32 v149, s16, v56
    v_lshlrev_b32 v150, 16, v57
    v_and_b32 v151, s16, v57
    v_lshlrev_b32 v152, 16, v58
    v_and_b32 v153, s16, v58
    v_lshlrev_b32 v154, 16, v59
    v_and_b32 v155, s16, v59
    v_pk_add_f32 v[132:133], v[132:133], v[148:149]
    v_pk_add_f32 v[134:135], v[134:135], v[150:151]
    v_pk_add_f32 v[136:137], v[136:137], v[152:153]
    v_pk_add_f32 v[138:139], v[138:139], v[154:155]
    s_waitcnt vmcnt(7)
    buffer_load_dwordx4 v[92:95], v3, s[8:11], s20 offen sc1
    v_lshlrev_b32 v148, 16, v60
    v_and_b32 v149, s16, v60
    v_lshlrev_b32 v150, 16, v61
    v_and_b32 v151, s16, v61
    v_lshlrev_b32 v152, 16, v62
    v_and_b32 v153, s16, v62
    v_lshlrev_b32 v154, 16, v63
    v_and_b32 v155, s16, v63
    v_pk_add_f32 v[140:141], v[140:141], v[148:149]
    v_pk_add_f32 v[142:143], v[142:143], v[150:151]
    v_pk_add_f32 v[144:145], v[144:145], v[152:153]
    v_pk_add_f32 v[146:147], v[146:147], v[154:155]
    s_waitcnt vmcnt(7)
    buffer_load_dwordx4 v[96:99], v4, s[8:11], s20 offen sc1
    s_add_u32 s20, s20, 9216
    v_lshlrev_b32 v148, 16, v64
    v_and_b32 v149, s16, v64
    v_lshlrev_b32 v150, 16, v65
    v_and_b32 v151, s16, v65
    v_lshlrev_b32 v152, 16, v66
    v_and_b32 v153, s16, v66
    v_lshlrev_b32 v154, 16, v67
    v_and_b32 v155, s16, v67
    v_pk_add_f32 v[124:125], v[124:125], v[148:149]
    v_pk_add_f32 v[126:127], v[126:127], v[150:151]
    v_pk_add_f32 v[128:129], v[128:129], v[152:153]
    v_pk_add_f32 v[130:131], v[130:131], v[154:155]
    s_waitcnt vmcnt(7)
    buffer_load_dwordx4 v[100:103], v2, s[8:11], s20 offen sc1
    v_lshlrev_b32 v148, 16, v68
    v_and_b32 v149, s16, v68
    v_lshlrev_b32 v150, 16, v69
    v_and_b32 v151, s16, v69
    v_lshlrev_b32 v152, 16, v70
    v_and_b32 v153, s16, v70
    v_lshlrev_b32 v154, 16, v71
    v_and_b32 v155, s16, v71
    v_pk_add_f32 v[132:133], v[132:133], v[148:149]
    v_pk_add_f32 v[134:135], v[134:135], v[150:151]
    v_pk_add_f32 v[136:137], v[136:137], v[152:153]
    v_pk_add_f32 v[138:139], v[138:139], v[154:155]
    s_waitcnt vmcnt(7)
    buffer_load_dwordx4 v[104:107], v3, s[8:11], s20 offen sc1
    v_lshlrev_b32 v148, 16, v72
    v_and_b32 v149, s16, v72
    v_lshlrev_b32 v150, 16, v73
    v_and_b32 v151, s16, v73
    v_lshlrev_b32 v152, 16, v74
    v_and_b32 v153, s16, v74
    v_lshlrev_b32 v154, 16, v75
    v_and_b32 v155, s16, v75
    v_pk_add_f32 v[140:141], v[140:141], v[148:149]
    v_pk_add_f32 v[142:143], v[142:143], v[150:151]
    v_pk_add_f32 v[144:145], v[144:145], v[152:153]
    v_pk_add_f32 v[146:147], v[146:147], v[154:155]
    s_waitcnt vmcnt(7)
    buffer_load_dwordx4 v[108:111], v4, s[8:11], s20 offen sc1
    s_add_u32 s20, s20, 9216
    v_lshlrev_b32 v148, 16, v76
    v_and_b32 v149, s16, v76
    v_lshlrev_b32 v150, 16, v77
    v_and_b32 v151, s16, v77
    v_lshlrev_b32 v152, 16, v78
    v_and_b32 v153, s16, v78
    v_lshlrev_b32 v154, 16, v79
    v_and_b32 v155, s16, v79
    v_pk_add_f32 v[124:125], v[124:125], v[148:149]
    v_pk_add_f32 v[126:127], v[126:127], v[150:151]
    v_pk_add_f32 v[128:129], v[128:129], v[152:153]
    v_pk_add_f32 v[130:131], v[130:131], v[154:155]
    s_waitcnt vmcnt(7)
    buffer_load_dwordx4 v[112:115], v2, s[8:11], s20 offen sc1
    v_lshlrev_b32 v148, 16, v80
    v_and_b32 v149, s16, v80
    v_lshlrev_b32 v150, 16, v81
    v_and_b32 v151, s16, v81
    v_lshlrev_b32 v152, 16, v82
    v_and_b32 v153, s16, v82
    v_lshlrev_b32 v154, 16, v83
    v_and_b32 v155, s16, v83
    v_pk_add_f32 v[132:133], v[132:133], v[148:149]
    v_pk_add_f32 v[134:135], v[134:135], v[150:151]
    v_pk_add_f32 v[136:137], v[136:137], v[152:153]
    v_pk_add_f32 v[138:139], v[138:139], v[154:155]
    s_waitcnt vmcnt(7)
    buffer_load_dwordx4 v[116:119], v3, s[8:11], s20 offen sc1
    v_lshlrev_b32 v148, 16, v84
    v_and_b32 v149, s16, v84
    v_lshlrev_b32 v150, 16, v85
    v_and_b32 v151, s16, v85
    v_lshlrev_b32 v152, 16, v86
    v_and_b32 v153, s16, v86
    v_lshlrev_b32 v154, 16, v87
    v_and_b32 v155, s16, v87
    v_pk_add_f32 v[140:141], v[140:141], v[148:149]
    v_pk_add_f32 v[142:143], v[142:143], v[150:151]
    v_pk_add_f32 v[144:145], v[144:145], v[152:153]
    v_pk_add_f32 v[146:147], v[146:147], v[154:155]
    s_waitcnt vmcnt(7)
    buffer_load_dwordx4 v[120:123], v4, s[8:11], s20 offen sc1
    v_lshlrev_b32 v148, 16, v88
    v_and_b32 v149, s16, v88
    v_lshlrev_b32 v150, 16, v89
    v_and_b32 v151, s16, v89
    v_lshlrev_b32 v152, 16, v90
    v_and_b32 v153, s16, v90
    v_lshlrev_b32 v154, 16, v91
    v_and_b32 v155, s16, v91
    s_lshl_b32 s28, s40, 2
    s_add_u32 s28, s28, s3
    s_mul_i32 s28, s28, 73728
    s_mul_i32 s7, s42, 1073741824
    v_add_u32 v1, s7, v253
    buffer_load_dwordx4 a[0:3], v1, s[8:11], s28 offen offset:0
    v_pk_add_f32 v[124:125], v[124:125], v[148:149]
    v_pk_add_f32 v[126:127], v[126:127], v[150:151]
    v_pk_add_f32 v[128:129], v[128:129], v[152:153]
    v_pk_add_f32 v[130:131], v[130:131], v[154:155]
    s_waitcnt vmcnt(8)
    buffer_load_dwordx4 a[4:7], v1, s[8:11], s28 offen offset:1024
    v_lshlrev_b32 v148, 16, v92
    v_and_b32 v149, s16, v92
    v_lshlrev_b32 v150, 16, v93
    v_and_b32 v151, s16, v93
    v_lshlrev_b32 v152, 16, v94
    v_and_b32 v153, s16, v94
    v_lshlrev_b32 v154, 16, v95
    v_and_b32 v155, s16, v95
    buffer_load_dwordx4 a[8:11], v1, s[8:11], s28 offen offset:2048
    v_pk_add_f32 v[132:133], v[132:133], v[148:149]
    v_pk_add_f32 v[134:135], v[134:135], v[150:151]
    v_pk_add_f32 v[136:137], v[136:137], v[152:153]
    v_pk_add_f32 v[138:139], v[138:139], v[154:155]
    s_waitcnt vmcnt(9)
    buffer_load_dwordx4 a[12:15], v1, s[8:11], s28 offen offset:3072
    v_lshlrev_b32 v148, 16, v96
    v_and_b32 v149, s16, v96
    v_lshlrev_b32 v150, 16, v97
    v_and_b32 v151, s16, v97
    v_lshlrev_b32 v152, 16, v98
    v_and_b32 v153, s16, v98
    v_lshlrev_b32 v154, 16, v99
    v_and_b32 v155, s16, v99
    s_add_u32 s28, s28, 4096
    buffer_load_dwordx4 a[16:19], v1, s[8:11], s28 offen offset:0
    v_pk_add_f32 v[140:141], v[140:141], v[148:149]
    v_pk_add_f32 v[142:143], v[142:143], v[150:151]
    v_pk_add_f32 v[144:145], v[144:145], v[152:153]
    v_pk_add_f32 v[146:147], v[146:147], v[154:155]
    s_waitcnt vmcnt(10)
    buffer_load_dwordx4 a[20:23], v1, s[8:11], s28 offen offset:1024
    v_lshlrev_b32 v148, 16, v100
    v_and_b32 v149, s16, v100
    v_lshlrev_b32 v150, 16, v101
    v_and_b32 v151, s16, v101
    v_lshlrev_b32 v152, 16, v102
    v_and_b32 v153, s16, v102
    v_lshlrev_b32 v154, 16, v103
    v_and_b32 v155, s16, v103
    buffer_load_dwordx4 a[24:27], v1, s[8:11], s28 offen offset:2048
    v_pk_add_f32 v[124:125], v[124:125], v[148:149]
    v_pk_add_f32 v[126:127], v[126:127], v[150:151]
    v_pk_add_f32 v[128:129], v[128:129], v[152:153]
    v_pk_add_f32 v[130:131], v[130:131], v[154:155]
    s_waitcnt vmcnt(11)
    buffer_load_dwordx4 a[28:31], v1, s[8:11], s28 offen offset:3072
    v_lshlrev_b32 v148, 16, v104
    v_and_b32 v149, s16, v104
    v_lshlrev_b32 v150, 16, v105
    v_and_b32 v151, s16, v105
    v_lshlrev_b32 v152, 16, v106
    v_and_b32 v153, s16, v106
    v_lshlrev_b32 v154, 16, v107
    v_and_b32 v155, s16, v107
    s_add_u32 s28, s28, 4096
    buffer_load_dwordx4 a[32:35], v1, s[8:11], s28 offen offset:0
    v_pk_add_f32 v[132:133], v[132:133], v[148:149]
    v_pk_add_f32 v[134:135], v[134:135], v[150:151]
    v_pk_add_f32 v[136:137], v[136:137], v[152:153]
    v_pk_add_f32 v[138:139], v[138:139], v[154:155]
    s_waitcnt vmcnt(12)
    buffer_load_dwordx4 a[36:39], v1, s[8:11], s28 offen offset:1024
    v_lshlrev_b32 v148, 16, v108
    v_and_b32 v149, s16, v108
    v_lshlrev_b32 v150, 16, v109
    v_and_b32 v151, s16, v109
    v_lshlrev_b32 v152, 16, v110
    v_and_b32 v153, s16, v110
    v_lshlrev_b32 v154, 16, v111
    v_and_b32 v155, s16, v111
    buffer_load_dwordx4 a[40:43], v1, s[8:11], s28 offen offset:2048
    v_pk_add_f32 v[140:141], v[140:141], v[148:149]
    v_pk_add_f32 v[142:143], v[142:143], v[150:151]
    v_pk_add_f32 v[144:145], v[144:145], v[152:153]
    v_pk_add_f32 v[146:147], v[146:147], v[154:155]
    s_waitcnt vmcnt(13)
    buffer_load_dwordx4 a[44:47], v1, s[8:11], s28 offen offset:3072
    v_lshlrev_b32 v148, 16, v112
    v_and_b32 v149, s16, v112
    v_lshlrev_b32 v150, 16, v113
    v_and_b32 v151, s16, v113
    v_lshlrev_b32 v152, 16, v114
    v_and_b32 v153, s16, v114
    v_lshlrev_b32 v154, 16, v115
    v_and_b32 v155, s16, v115
    s_add_u32 s28, s28, 4096
    buffer_load_dwordx4 a[48:51], v1, s[8:11], s28 offen offset:0
    v_pk_add_f32 v[124:125], v[124:125], v[148:149]
    v_pk_add_f32 v[126:127], v[126:127], v[150:151]
    v_pk_add_f32 v[128:129], v[128:129], v[152:153]
    v_pk_add_f32 v[130:131], v[130:131], v[154:155]
    s_waitcnt vmcnt(14)
    buffer_load_dwordx4 a[52:55], v1, s[8:11], s28 offen offset:1024
    v_lshlrev_b32 v148, 16, v116
    v_and_b32 v149, s16, v116
    v_lshlrev_b32 v150, 16, v117
    v_and_b32 v151, s16, v117
    v_lshlrev_b32 v152, 16, v118
    v_and_b32 v153, s16, v118
    v_lshlrev_b32 v154, 16, v119
    v_and_b32 v155, s16, v119
    buffer_load_dwordx4 a[56:59], v1, s[8:11], s28 offen offset:2048
    v_pk_add_f32 v[132:133], v[132:133], v[148:149]
    v_pk_add_f32 v[134:135], v[134:135], v[150:151]
    v_pk_add_f32 v[136:137], v[136:137], v[152:153]
    v_pk_add_f32 v[138:139], v[138:139], v[154:155]
    s_waitcnt vmcnt(15)
    buffer_load_dwordx4 a[60:63], v1, s[8:11], s28 offen offset:3072
    v_lshlrev_b32 v148, 16, v120
    v_and_b32 v149, s16, v120
    v_lshlrev_b32 v150, 16, v121
    v_and_b32 v151, s16, v121
    v_lshlrev_b32 v152, 16, v122
    v_and_b32 v153, s16, v122
    v_lshlrev_b32 v154, 16, v123
    v_and_b32 v155, s16, v123
    s_add_u32 s28, s28, 4096
    buffer_load_dwordx4 a[64:67], v1, s[8:11], s28 offen offset:0
    v_pk_add_f32 v[140:141], v[140:141], v[148:149]
    v_pk_add_f32 v[142:143], v[142:143], v[150:151]
    v_pk_add_f32 v[144:145], v[144:145], v[152:153]
    v_pk_add_f32 v[146:147], v[146:147], v[154:155]
    buffer_load_dwordx4 a[68:71], v1, s[8:11], s28 offen offset:1024
    buffer_load_dwordx4 a[72:75], v1, s[8:11], s28 offen offset:2048
    buffer_load_dwordx4 a[76:79], v1, s[8:11], s28 offen offset:3072
    s_add_u32 s28, s28, 4096
    buffer_load_dwordx4 a[80:83], v1, s[8:11], s28 offen offset:0
    buffer_load_dwordx4 a[84:87], v1, s[8:11], s28 offen offset:1024
    buffer_load_dwordx4 a[88:91], v1, s[8:11], s28 offen offset:2048
    buffer_load_dwordx4 a[92:95], v1, s[8:11], s28 offen offset:3072
    s_add_u32 s28, s28, 4096
    v_cvt_pk_bf16_f32 v156, v124, v125
    v_cvt_pk_bf16_f32 v157, v126, v127
    v_cvt_pk_bf16_f32 v158, v128, v129
    v_cvt_pk_bf16_f32 v159, v130, v131
    v_cvt_pk_bf16_f32 v160, v132, v133
    v_cvt_pk_bf16_f32 v161, v134, v135
    v_cvt_pk_bf16_f32 v162, v136, v137
    v_cvt_pk_bf16_f32 v163, v138, v139
    v_cvt_pk_bf16_f32 v164, v140, v141
    v_cvt_pk_bf16_f32 v165, v142, v143
    v_cvt_pk_bf16_f32 v166, v144, v145
    v_cvt_pk_bf16_f32 v167, v146, v147
    s_cmp_lg_u32 s42, 0
    s_cbranch_scc1 L_main_last
    s_add_u32 s19, s18, 60555264
    s_add_u32 s20, s18, 53477376
    s_lshl_b32 s22, s21, 7
    s_add_u32 s22, s22, 84148224
    buffer_store_dwordx4 v[156:159], v2, s[8:11], s19 offen sc1
    buffer_store_dwordx4 v[160:163], v3, s[8:11], s19 offen sc1
    buffer_store_dwordx4 v[164:167], v4, s[8:11], s19 offen sc1
    s_mov_b32 s17, 0x3f803f80
    v_mov_b32 v8, 0
    v_mov_b32 v9, 0
    v_mov_b32 v10, 0
    v_mov_b32 v11, 0
    v_dot2c_f32_bf16 v8, s17, v156
    v_dot2c_f32_bf16 v9, v156, v156
    v_dot2c_f32_bf16 v10, s17, v157
    v_dot2c_f32_bf16 v11, v157, v157
    v_dot2c_f32_bf16 v8, s17, v158
    v_dot2c_f32_bf16 v9, v158, v158
    v_dot2c_f32_bf16 v10, s17, v159
    v_dot2c_f32_bf16 v11, v159, v159
    v_dot2c_f32_bf16 v8, s17, v160
    v_dot2c_f32_bf16 v9, v160, v160
    v_dot2c_f32_bf16 v10, s17, v161
    v_dot2c_f32_bf16 v11, v161, v161
    v_dot2c_f32_bf16 v8, s17, v162
    v_dot2c_f32_bf16 v9, v162, v162
    v_dot2c_f32_bf16 v10, s17, v163
    v_dot2c_f32_bf16 v11, v163, v163
    v_dot2c_f32_bf16 v8, s17, v164
    v_dot2c_f32_bf16 v9, v164, v164
    v_dot2c_f32_bf16 v10, s17, v165
    v_dot2c_f32_bf16 v11, v165, v165
    v_dot2c_f32_bf16 v8, s17, v166
    v_dot2c_f32_bf16 v9, v166, v166
    v_dot2c_f32_bf16 v10, s17, v167
    v_dot2c_f32_bf16 v11, v167, v167
    v_and_b32 v12, 7, v0
    v_lshlrev_b32 v12, 3, v12
    s_lshl_b32 s7, s3, 6
    v_add_u32 v13, s7, v12
    v_pk_add_f32 v[8:9], v[8:9], v[10:11]
    s_nop 1
    v_add_f32_dpp v8, v8, v8 row_ror:8 row_mask:0xf bank_mask:0xf
    v_add_f32_dpp v9, v9, v9 row_ror:8 row_mask:0xf bank_mask:0xf
    v_mov_b32 v10, v8
    v_mov_b32 v11, v9
    s_nop 1
    v_permlane32_swap_b32 v10, v8
    v_permlane32_swap_b32 v11, v9
    v_add_f32 v8, v8, v10
    v_add_f32 v9, v9, v11
    v_mov_b32 v10, v8
    v_mov_b32 v11, v9
    s_nop 1
    v_permlane16_swap_b32 v10, v8
    v_permlane16_swap_b32 v11, v9
    v_add_f32 v8, v8, v10
    v_add_f32 v9, v9, v11
    ds_write_b64 v13, v[8:9]
    s_waitcnt lgkmcnt(0)
    s_barrier
    ds_read_b64 v[40:41], v12 offset:0
    ds_read_b64 v[42:43], v12 offset:64
    ds_read_b64 v[44:45], v12 offset:128
    ds_read_b64 v[46:47], v12 offset:192
    s_waitcnt lgkmcnt(0)
    v_pk_add_f32 v[40:41], v[40:41], v[42:43]
    v_pk_add_f32 v[44:45], v[44:45], v[46:47]
    v_pk_add_f32 v[8:9], v[40:41], v[44:45]
    v_mul_f32 v8, 0x3ae38e39, v8
    v_mul_f32 v9, 0x3ae38e39, v9
    v_fma_f32 v9, -v8, v8, v9
    v_max_f32 v9, 0, v9
    v_add_f32 v9, 0x3727c5ac, v9
    v_rsq_f32 v10, v9
    s_nop 0
    v_mul_f32 v12, v8, v10
    v_mov_b32 v11, v10
    v_sub_f32 v12, 0, v12
    v_mov_b32 v13, v12
    s_cmp_eq_u32 s3, 0
    s_cselect_b32 s7, 32, 0
    v_lshlrev_b32 v14, 2, v0
    v_cmp_gt_u32 vcc, s7, v0
    v_mov_b32 v9, 1073741824
    s_nop 0
    v_cndmask_b32 v14, v9, v14, vcc
    buffer_store_dword v8, v14, s[8:11], s22 offen sc1
    v_lshlrev_b32 v40, 16, v156
    v_and_b32 v41, s16, v156
    v_lshlrev_b32 v42, 16, v157
    v_and_b32 v43, s16, v157
    v_lshlrev_b32 v44, 16, v158
    v_and_b32 v45, s16, v158
    v_lshlrev_b32 v46, 16, v159
    v_and_b32 v47, s16, v159
    v_pk_fma_f32 v[40:41], v[40:41], v[10:11], v[12:13]
    v_pk_fma_f32 v[42:43], v[42:43], v[10:11], v[12:13]
    v_pk_fma_f32 v[44:45], v[44:45], v[10:11], v[12:13]
    v_pk_fma_f32 v[46:47], v[46:47], v[10:11], v[12:13]
    v_cvt_pk_bf16_f32 v48, v40, v41
    v_cvt_pk_bf16_f32 v49, v42, v43
    v_cvt_pk_bf16_f32 v50, v44, v45
    v_cvt_pk_bf16_f32 v51, v46, v47
    v_lshlrev_b32 v40, 16, v160
    v_and_b32 v41, s16, v160
    v_lshlrev_b32 v42, 16, v161
    v_and_b32 v43, s16, v161
    v_lshlrev_b32 v44, 16, v162
    v_and_b32 v45, s16, v162
    v_lshlrev_b32 v46, 16, v163
    v_and_b32 v47, s16, v163
    v_pk_fma_f32 v[40:41], v[40:41], v[10:11], v[12:13]
    v_pk_fma_f32 v[42:43], v[42:43], v[10:11], v[12:13]
    v_pk_fma_f32 v[44:45], v[44:45], v[10:11], v[12:13]
    v_pk_fma_f32 v[46:47], v[46:47], v[10:11], v[12:13]
    v_cvt_pk_bf16_f32 v52, v40, v41
    v_cvt_pk_bf16_f32 v53, v42, v43
    v_cvt_pk_bf16_f32 v54, v44, v45
    v_cvt_pk_bf16_f32 v55, v46, v47
    v_lshlrev_b32 v40, 16, v164
    v_and_b32 v41, s16, v164
    v_lshlrev_b32 v42, 16, v165
    v_and_b32 v43, s16, v165
    v_lshlrev_b32 v44, 16, v166
    v_and_b32 v45, s16, v166
    v_lshlrev_b32 v46, 16, v167
    v_and_b32 v47, s16, v167
    v_pk_fma_f32 v[40:41], v[40:41], v[10:11], v[12:13]
    v_pk_fma_f32 v[42:43], v[42:43], v[10:11], v[12:13]
    v_pk_fma_f32 v[44:45], v[44:45], v[10:11], v[12:13]
    v_pk_fma_f32 v[46:47], v[46:47], v[10:11], v[12:13]
    v_cvt_pk_bf16_f32 v56, v40, v41
    v_cvt_pk_bf16_f32 v57, v42, v43
    v_cvt_pk_bf16_f32 v58, v44, v45
    v_cvt_pk_bf16_f32 v59, v46, v47
    buffer_store_dwordx4 v[48:51], v2, s[8:11], s20 offen sc1
    buffer_store_dwordx4 v[52:55], v3, s[8:11], s20 offen sc1
    buffer_store_dwordx4 v[56:59], v4, s[8:11], s20 offen sc1
    v_lshlrev_b32 v15, 7, v0
    s_lshl_b32 s6, s40, 2
    s_add_u32 s6, s6, s44
    s_add_u32 s6, s6, 98304
    v_mov_b32 v1, 1
    s_mov_b64 vcc, 0xff
    v_lshrrev_b32 v14, 3, v0
    v_lshl_add_u32 v15, v14, 3, v15
    s_cmp_ge_u32 s40, 6
    s_cselect_b32 s7, s41, 31
    s_cmp_lt_u32 s7, 31
    s_cmov_b64 vcc, 0xffff
    s_waitcnt vmcnt(0)
    s_barrier
    s_cmp_lg_u32 s3, 0
    s_cbranch_scc1 L_pub_19
    s_mov_b64 exec, vcc
    buffer_store_dword v1, v15, s[8:11], s6 offen sc1
    s_mov_b64 exec, -1
L_pub_19:
    s_mov_b32 s42, 1
    s_mov_b32 s43, 33554432
    s_add_u32 s44, s44, 131072
    s_branch L_main_layer
L_main_last:
    buffer_store_dwordx4 v[156:159], v5, s[12:15], s18 offen
    buffer_store_dwordx4 v[160:163], v6, s[12:15], s18 offen
    buffer_store_dwordx4 v[164:167], v7, s[12:15], s18 offen
L_main_end:
    s_endpgm
.section .rodata,"a"
.p2align 6
.amdhsa_kernel prep_kernel
.amdhsa_next_free_vgpr 88
.amdhsa_next_free_sgpr 64
.amdhsa_accum_offset 88
.amdhsa_group_segment_fixed_size 0
.amdhsa_kernarg_size 80
.amdhsa_user_sgpr_count 2
.amdhsa_user_sgpr_kernarg_segment_ptr 1
.amdhsa_system_sgpr_workgroup_id_x 1
.amdhsa_float_denorm_mode_32 3
.amdhsa_float_denorm_mode_16_64 3
.end_amdhsa_kernel
.section .rodata,"a"
.p2align 6
.amdhsa_kernel main_kernel
.amdhsa_next_free_vgpr 512
.amdhsa_next_free_sgpr 64
.amdhsa_accum_offset 256
.amdhsa_group_segment_fixed_size 0
.amdhsa_kernarg_size 80
.amdhsa_user_sgpr_count 2
.amdhsa_user_sgpr_kernarg_segment_ptr 1
.amdhsa_system_sgpr_workgroup_id_x 1
.amdhsa_float_denorm_mode_32 3
.amdhsa_float_denorm_mode_16_64 3
.end_amdhsa_kernel
```

```asm
; @launch grid=(256,1,1) block=(256,1,1) lds=163840
.amdgcn_target "amdgcn-amd-amdhsa--gfx950"
.text
.globl interleave_layers__sliding_local_dilated__glu_gated_geglu__prompt_kernel
.p2align 8
.type interleave_layers__sliding_local_dilated__glu_gated_geglu__prompt_kernel,@function
interleave_layers__sliding_local_dilated__glu_gated_geglu__prompt_kernel:
    s_cmp_ge_u32 s2, 256
    s_cbranch_scc1 L_main_end
    s_load_dwordx2 s[4:5], s[0:1], 72
    s_load_dwordx4 s[16:19], s[0:1], 0
    s_load_dwordx2 s[22:23], s[0:1], 16
    s_load_dwordx8 s[24:31], s[0:1], 32
    v_lshrrev_b32 v1, 6, v0
    v_and_b32 v0, 63, v0
    v_readfirstlane_b32 s3, v1
    s_waitcnt lgkmcnt(0)
    s_mov_b32 s8, s4
    s_and_b32 s9, s5, 0xffff
    s_mov_b32 s10, 268435456
    s_mov_b32 s11, 0x20000
    s_mov_b32 s7, 19660800
    s_load_dword s76, s[4:5], s7
    s_mov_b64 s[20:21], s[18:19]
    s_mov_b64 s[18:19], s[16:17]
    s_mov_b32 s48, s4
    s_and_b32 s49, s5, 0xffff
    s_mov_b32 s50, 268435456
    s_mov_b32 s51, 0x20000
    s_and_b32 s40, s2, 1
    s_lshl_b32 s40, s40, 2
    s_bfe_u32 s7, s2, 131075
    s_add_u32 s40, s40, s7
    s_bfe_u32 s41, s2, 131073
    s_lshl_b32 s41, s41, 3
    s_lshr_b32 s7, s2, 5
    s_add_u32 s41, s41, s7
    s_mov_b32 s42, 0
    s_mov_b32 s43, 0
    s_lshl_b32 s44, s41, 10
    s_add_u32 s44, s44, 19169280
    v_lshlrev_b32 v253, 4, v0
    s_mov_b32 s12, s18
    s_and_b32 s13, s19, 0xffff
    s_mov_b32 s14, 2359296
    s_mov_b32 s15, 0x20000
    s_mov_b32 s64, s20
    s_and_b32 s65, s21, 0xffff
    s_mov_b32 s66, 1990656
    s_mov_b32 s67, 0x20000
    s_mov_b32 s68, s22
    s_and_b32 s69, s23, 0xffff
    s_mov_b32 s70, 663552
    s_mov_b32 s71, 0x20000
    s_mov_b32 s16, 0xffff0000
    s_lshl_b32 s7, s3, 10
    v_lshl_add_u32 v2, v0, 4, s7
    v_add_u32 v3, 4096, v2
    v_and_b32 v8, 7, v0
    v_mul_u32_u24 v8, 1152, v8
    v_lshrrev_b32 v9, 3, v0
    v_lshl_add_u32 v8, v9, 4, v8
    s_lshl_b32 s7, s3, 7
    v_add_u32 v5, s7, v8
    v_add_u32 v6, 512, v5
    s_cmp_eq_u32 s3, 0
    s_mov_b32 s17, 1073741824
    s_cmov_b32 s17, 8192
    v_add_u32 v4, s17, v2
    s_mov_b32 s17, 1073741824
    s_cmov_b32 s17, 1024
    v_add_u32 v7, s17, v5
    s_lshl_b32 s21, s41, 3
    s_add_u32 s21, s21, s40
    s_mul_i32 s18, s21, 9216
    buffer_load_dwordx4 v[16:19], v5, s[12:15], s18 offen
    buffer_load_dwordx4 v[20:23], v6, s[12:15], s18 offen
    buffer_load_dwordx4 v[24:27], v7, s[12:15], s18 offen
    s_mov_b32 s12, s30
    s_and_b32 s13, s31, 0xffff
    s_mov_b32 s14, 2359296
    s_mov_b32 s15, 0x20000
    s_lshl_b32 s79, s3, 14
    s_add_u32 s79, s79, 98304
    s_lshl_b32 s32, s3, 5
    s_add_u32 s32, s32, s41
    s_cmp_ge_u32 s32, 72
    s_cbranch_scc1 L_noq_1
    s_mul_i32 s33, s32, 58255
    s_lshr_b32 s33, s33, 20
    s_mul_i32 s34, s33, 18
    s_sub_u32 s34, s32, s34
    s_lshl_b32 s7, s40, 2
    s_add_u32 s33, s33, s7
    s_mul_i32 s35, s34, 110592
    s_mul_i32 s7, s33, 36
    s_add_u32 s35, s35, s7
    v_mov_b32 v13, 1073741824
    v_add_u32 v8, 0, v0
    v_mul_u32_u24 v9, 21846, v8
    v_lshrrev_b32 v9, 16, v9
    v_mul_u32_u24 v10, 3, v9
    v_sub_u32 v10, v8, v10
    v_and_b32 v11, 31, v9
    v_mul_u32_u24 v11, 3456, v11
    v_lshl_add_u32 v11, v10, 4, v11
    v_lshrrev_b32 v9, 5, v9
    v_mul_u32_u24 v9, 1152, v9
    s_add_u32 m0, s79, 0
    v_add_u32 v11, v11, v9
    buffer_load_dwordx4 v11, s[64:67], s35 offen lds
    v_add_u32 v8, 64, v0
    v_mul_u32_u24 v9, 21846, v8
    v_lshrrev_b32 v9, 16, v9
    v_mul_u32_u24 v10, 3, v9
    v_sub_u32 v10, v8, v10
    v_and_b32 v11, 31, v9
    v_mul_u32_u24 v11, 3456, v11
    v_lshl_add_u32 v11, v10, 4, v11
    v_lshrrev_b32 v9, 5, v9
    v_mul_u32_u24 v9, 1152, v9
    s_add_u32 m0, s79, 1024
    v_add_u32 v11, v11, v9
    buffer_load_dwordx4 v11, s[64:67], s35 offen lds
    v_add_u32 v8, 128, v0
    v_mul_u32_u24 v9, 21846, v8
    v_lshrrev_b32 v9, 16, v9
    v_mul_u32_u24 v10, 3, v9
    v_sub_u32 v10, v8, v10
    v_and_b32 v11, 31, v9
    v_mul_u32_u24 v11, 3456, v11
    v_lshl_add_u32 v11, v10, 4, v11
    v_lshrrev_b32 v9, 5, v9
    v_mul_u32_u24 v9, 1152, v9
    s_add_u32 m0, s79, 2048
    v_add_u32 v11, v11, v9
    buffer_load_dwordx4 v11, s[64:67], s35 offen lds
    v_add_u32 v8, 192, v0
    v_mul_u32_u24 v9, 21846, v8
    v_lshrrev_b32 v9, 16, v9
    v_mul_u32_u24 v10, 3, v9
    v_sub_u32 v10, v8, v10
    v_and_b32 v11, 31, v9
    v_mul_u32_u24 v11, 3456, v11
    v_lshl_add_u32 v11, v10, 4, v11
    v_lshrrev_b32 v9, 5, v9
    v_mul_u32_u24 v9, 1152, v9
    s_add_u32 m0, s79, 3072
    v_add_u32 v11, v11, v9
    buffer_load_dwordx4 v11, s[64:67], s35 offen lds
    v_add_u32 v8, 256, v0
    v_mul_u32_u24 v9, 21846, v8
    v_lshrrev_b32 v9, 16, v9
    v_mul_u32_u24 v10, 3, v9
    v_sub_u32 v10, v8, v10
    v_and_b32 v11, 31, v9
    v_mul_u32_u24 v11, 3456, v11
    v_lshl_add_u32 v11, v10, 4, v11
    v_lshrrev_b32 v9, 5, v9
    v_mul_u32_u24 v9, 1152, v9
    s_add_u32 m0, s79, 4096
    v_add_u32 v11, v11, v9
    v_cmp_gt_u32 vcc, 32, v0
    s_nop 1
    v_cndmask_b32 v11, v13, v11, vcc
    buffer_load_dwordx4 v11, s[64:67], s35 offen lds
L_noq_1:
    s_lshl_b32 s36, s41, 1
    s_lshr_b32 s7, s40, 2
    s_add_u32 s36, s36, s7
    s_and_b32 s37, s40, 3
    s_cmp_eq_u32 s3, 3
    s_cbranch_scc1 L_wbar_3
    s_mul_i32 s38, s36, 3
    s_add_u32 s38, s38, s3
    s_cmp_ge_u32 s38, 162
    s_cbranch_scc1 L_p3_4
    s_mul_i32 s39, s38, 58255
    s_lshr_b32 s39, s39, 20
    s_mul_i32 s45, s39, 18
    s_sub_u32 s45, s38, s45
    s_mul_i32 s7, s37, 9
    s_add_u32 s39, s39, s7
    s_lshl_b32 s7, s45, 2
    v_lshrrev_b32 v8, 4, v0
    v_add_u32 v8, s7, v8
    v_bfe_u32 v9, v0, 1, 3
    v_mul_u32_u24 v11, 7282, v8
    v_lshrrev_b32 v11, 16, v11
    v_mul_u32_u24 v12, 9, v11
    v_sub_u32 v12, v8, v12
    v_mul_u32_u24 v11, 72, v11
    v_cmp_eq_u32 vcc, 8, v12
    v_lshrrev_b32 v10, 1, v12
    v_mad_u32_u24 v10, v10, 18, v11
    v_and_b32 v12, 1, v12
    v_lshl_add_u32 v10, v12, 3, v10
    v_add_u32 v10, v10, v9
    v_lshrrev_b32 v12, 1, v9
    v_mad_u32_u24 v11, v12, 18, v11
    v_and_b32 v12, 1, v9
    v_add3_u32 v11, v11, v12, 16
    v_cndmask_b32 v10, v10, v11, vcc
    v_mul_u32_u24 v10, 1152, v10
    v_and_b32 v9, 1, v0
    v_lshl_add_u32 v10, v9, 4, v10
    s_add_u32 m0, s79, 6144
    s_lshl_b32 s7, s39, 5
    buffer_load_dwordx4 v10, s[68:71], s7 offen lds
    s_branch L_p3_4
L_wbar_3:
    s_cmp_ge_u32 s36, 36
    s_cbranch_scc1 L_p3_4
    s_lshl_b32 s7, s36, 1
    v_bfe_u32 v8, v0, 3, 1
    v_add_u32 v8, s7, v8
    v_and_b32 v9, 7, v0
    v_mul_u32_u24 v11, 7282, v8
    v_lshrrev_b32 v11, 16, v11
    v_mul_u32_u24 v12, 9, v11
    v_sub_u32 v12, v8, v12
    v_mul_u32_u24 v11, 72, v11
    v_cmp_eq_u32 vcc, 8, v12
    v_lshrrev_b32 v10, 1, v12
    v_mad_u32_u24 v10, v10, 18, v11
    v_and_b32 v12, 1, v12
    v_lshl_add_u32 v10, v12, 3, v10
    v_add_u32 v10, v10, v9
    v_lshrrev_b32 v12, 1, v9
    v_mad_u32_u24 v11, v12, 18, v11
    v_and_b32 v12, 1, v9
    v_add3_u32 v11, v11, v12, 16
    v_cndmask_b32 v10, v10, v11, vcc
    v_mul_u32_u24 v10, 1152, v10
    v_lshrrev_b32 v9, 4, v0
    v_lshl_add_u32 v10, v9, 4, v10
    buffer_load_dwordx4 v[64:67], v10, s[68:71], 0 offen offset:0
    buffer_load_dwordx4 v[68:71], v10, s[68:71], 0 offen offset:64
    buffer_load_dwordx4 v[72:75], v10, s[68:71], 0 offen offset:128
    buffer_load_dwordx4 v[76:79], v10, s[68:71], 0 offen offset:192
    buffer_load_dwordx4 v[80:83], v10, s[68:71], 0 offen offset:256
    buffer_load_dwordx4 v[84:87], v10, s[68:71], 0 offen offset:320
    buffer_load_dwordx4 v[88:91], v10, s[68:71], 0 offen offset:384
    buffer_load_dwordx4 v[92:95], v10, s[68:71], 0 offen offset:448
    buffer_load_dwordx4 v[96:99], v10, s[68:71], 0 offen offset:512
    buffer_load_dwordx4 v[100:103], v10, s[68:71], 0 offen offset:576
    buffer_load_dwordx4 v[104:107], v10, s[68:71], 0 offen offset:640
    buffer_load_dwordx4 v[108:111], v10, s[68:71], 0 offen offset:704
    buffer_load_dwordx4 v[112:115], v10, s[68:71], 0 offen offset:768
    buffer_load_dwordx4 v[116:119], v10, s[68:71], 0 offen offset:832
    buffer_load_dwordx4 v[120:123], v10, s[68:71], 0 offen offset:896
    buffer_load_dwordx4 v[124:127], v10, s[68:71], 0 offen offset:960
    buffer_load_dwordx4 v[128:131], v10, s[68:71], 0 offen offset:1024
    buffer_load_dwordx4 v[132:135], v10, s[68:71], 0 offen offset:1088
L_p3_4:
    s_lshl_b32 s7, s41, 2
    s_add_u32 s7, s7, s3
    s_mul_i32 s93, s7, 25576
    s_lshr_b32 s93, s93, 20
    s_min_u32 s93, s93, 2
    s_mul_i32 s6, s93, 41
    s_sub_u32 s7, s7, s6
    s_lshl_b32 s46, s7, 2
    s_cmp_eq_u32 s93, 1
    s_cselect_b32 s72, s26, s24
    s_cselect_b32 s73, s27, s25
    s_cmp_eq_u32 s93, 2
    s_cselect_b32 s72, s28, s72
    s_cselect_b32 s73, s29, s73
    s_mov_b32 s92, 73728
    s_cmov_b32 s92, 9216
    s_mov_b32 s47, 1152
    s_cmov_b32 s47, 663552
    s_and_b32 s73, s73, 0xffff
    s_mov_b32 s74, 5308416
    s_mov_b32 s75, 0x20000
    s_mul_i32 s47, s47, s40
    s_add_u32 s7, s46, 0
    s_min_u32 s7, s7, 161
    s_mul_i32 s84, s7, 116509
    s_lshr_b32 s84, s84, 20
    s_mul_i32 s88, s84, 9
    s_sub_u32 s88, s7, s88
    s_mul_i32 s7, s84, s92
    s_lshl_b32 s7, s7, 2
    s_add_u32 s7, s7, s47
    s_lshl_b32 s6, s88, 7
    s_add_u32 s80, s7, s6
    s_add_u32 s7, s46, 1
    s_min_u32 s7, s7, 161
    s_mul_i32 s85, s7, 116509
    s_lshr_b32 s85, s85, 20
    s_mul_i32 s89, s85, 9
    s_sub_u32 s89, s7, s89
    s_mul_i32 s7, s85, s92
    s_lshl_b32 s7, s7, 2
    s_add_u32 s7, s7, s47
    s_lshl_b32 s6, s89, 7
    s_add_u32 s81, s7, s6
    s_add_u32 s7, s46, 2
    s_min_u32 s7, s7, 161
    s_mul_i32 s86, s7, 116509
    s_lshr_b32 s86, s86, 20
    s_mul_i32 s90, s86, 9
    s_sub_u32 s90, s7, s90
    s_mul_i32 s7, s86, s92
    s_lshl_b32 s7, s7, 2
    s_add_u32 s7, s7, s47
    s_lshl_b32 s6, s90, 7
    s_add_u32 s82, s7, s6
    s_add_u32 s7, s46, 3
    s_min_u32 s7, s7, 161
    s_mul_i32 s87, s7, 116509
    s_lshr_b32 s87, s87, 20
    s_mul_i32 s91, s87, 9
    s_sub_u32 s91, s7, s91
    s_mul_i32 s7, s87, s92
    s_lshl_b32 s7, s7, 2
    s_add_u32 s7, s7, s47
    s_lshl_b32 s6, s91, 7
    s_add_u32 s83, s7, s6
    s_lshr_b32 s7, s92, 3
    v_lshrrev_b32 v224, 3, v0
    v_mul_lo_u32 v224, v224, s7
    v_and_b32 v8, 7, v0
    v_lshl_add_u32 v224, v8, 4, v224
    s_waitcnt lgkmcnt(0)
    s_mul_i32 s76, s76, 0x9e3779b1
    s_add_u32 s76, s76, 0x7f4a7c15
    s_mov_b32 s77, s76
    v_lshrrev_b32 v8, 4, v0
    v_lshlrev_b32 v8, 3, v8
    v_bfe_u32 v9, v0, 2, 2
    v_add_u32 v8, v8, v9
    v_mul_u32_u24 v8, 48, v8
    v_and_b32 v9, 3, v0
    v_lshl_add_u32 v8, v9, 3, v8
    v_add_u32 v8, s79, v8
    v_and_b32 v9, 3, v0
    v_min_u32 v10, 2, v9
    v_mul_u32_u24 v10, 1536, v10
    v_lshlrev_b32 v9, 3, v9
    v_sub_u32 v10, v10, v9
    v_add3_u32 v10, v10, v8, 32
    v_and_b32 v9, 15, v0
    v_cmp_gt_u32 s[22:23], 6, v9
    v_lshrrev_b32 v11, 1, v9
    v_and_b32 v12, 0x31, v0
    v_lshl_add_u32 v11, v11, 2, v12
    v_lshlrev_b32 v11, 2, v11
    s_waitcnt vmcnt(0)
    s_cmp_ge_u32 s32, 72
    s_cbranch_scc1 L_noq_2
    ds_read_b64_tr_b16 v[44:45], v10
    ds_read_b64_tr_b16 v[46:47], v10 offset:192
    ds_read_b64_tr_b16 v[32:33], v8 offset:0
    ds_read_b64_tr_b16 v[34:35], v8 offset:192
    ds_read_b64_tr_b16 v[36:37], v8 offset:1536
    ds_read_b64_tr_b16 v[38:39], v8 offset:1728
    ds_read_b64_tr_b16 v[40:41], v8 offset:3072
    ds_read_b64_tr_b16 v[42:43], v8 offset:3264
    s_mul_i32 s33, s33, 18
    s_add_u32 s33, s33, s34
    s_lshl_b32 s33, s33, 12
    s_waitcnt lgkmcnt(6)
    ds_bpermute_b32 v44, v11, v44
    ds_bpermute_b32 v45, v11, v45
    ds_bpermute_b32 v46, v11, v46
    ds_bpermute_b32 v47, v11, v47
    s_waitcnt lgkmcnt(4)
    buffer_store_dwordx4 v[32:35], v253, s[8:11], s33 offen offset:0 sc1
    buffer_store_dwordx4 v[36:39], v253, s[8:11], s33 offen offset:1024 sc1
    buffer_store_dwordx4 v[40:43], v253, s[8:11], s33 offen offset:2048 sc1
    s_waitcnt lgkmcnt(0)
    v_cndmask_b32 v44, 0, v44, s[22:23]
    v_cndmask_b32 v45, 0, v45, s[22:23]
    v_cndmask_b32 v46, 0, v46, s[22:23]
    v_cndmask_b32 v47, 0, v47, s[22:23]
    buffer_store_dwordx4 v[44:47], v253, s[8:11], s33 offen offset:3072 sc1
L_noq_2:
    s_cmp_eq_u32 s3, 3
    s_cbranch_scc1 L_wbar_5
    s_cmp_ge_u32 s38, 162
    s_cbranch_scc1 L_p3_6
    v_lshrrev_b32 v8, 4, v0
    v_lshlrev_b32 v8, 3, v8
    v_bfe_u32 v9, v0, 2, 2
    v_add_u32 v8, v8, v9
    v_mul_u32_u24 v8, 32, v8
    v_and_b32 v9, 3, v0
    v_lshl_add_u32 v8, v9, 3, v8
    v_add_u32 v8, s79, v8
    ds_read_b64_tr_b16 v[28:29], v8 offset:6144
    ds_read_b64_tr_b16 v[30:31], v8 offset:6272
    s_mul_i32 s39, s39, 18
    s_add_u32 s39, s39, s45
    s_lshl_b32 s39, s39, 10
    s_add_u32 s39, s39, 2359296
    s_waitcnt lgkmcnt(0)
    buffer_store_dwordx4 v[28:31], v253, s[8:11], s39 offen sc1
    s_branch L_p3_6
L_wbar_5:
    s_cmp_ge_u32 s36, 36
    s_cbranch_scc1 L_p3_6
    v_mov_b32 v28, 0x3f803f80
    v_mov_b32 v29, 0x3f803f80
    v_mov_b32 v30, 0x3f803f80
    v_mov_b32 v31, 0x3f803f80
    v_and_b32 v9, 15, v0
    v_cmp_eq_u32 vcc, 0, v9
    v_cmp_eq_u32 s[22:23], 1, v9
    v_mfma_f32_16x16x32_bf16 v[32:35], v[64:67], v[28:31], 0
    v_mfma_f32_16x16x32_bf16 v[32:35], v[68:71], v[28:31], v[32:35]
    v_mfma_f32_16x16x32_bf16 v[32:35], v[72:75], v[28:31], v[32:35]
    v_mfma_f32_16x16x32_bf16 v[32:35], v[76:79], v[28:31], v[32:35]
    v_mfma_f32_16x16x32_bf16 v[32:35], v[80:83], v[28:31], v[32:35]
    v_mfma_f32_16x16x32_bf16 v[32:35], v[84:87], v[28:31], v[32:35]
    v_mfma_f32_16x16x32_bf16 v[32:35], v[88:91], v[28:31], v[32:35]
    v_mfma_f32_16x16x32_bf16 v[32:35], v[92:95], v[28:31], v[32:35]
    v_mfma_f32_16x16x32_bf16 v[32:35], v[96:99], v[28:31], v[32:35]
    v_mfma_f32_16x16x32_bf16 v[32:35], v[100:103], v[28:31], v[32:35]
    v_mfma_f32_16x16x32_bf16 v[32:35], v[104:107], v[28:31], v[32:35]
    v_mfma_f32_16x16x32_bf16 v[32:35], v[108:111], v[28:31], v[32:35]
    v_mfma_f32_16x16x32_bf16 v[32:35], v[112:115], v[28:31], v[32:35]
    v_mfma_f32_16x16x32_bf16 v[32:35], v[116:119], v[28:31], v[32:35]
    v_mfma_f32_16x16x32_bf16 v[32:35], v[120:123], v[28:31], v[32:35]
    v_mfma_f32_16x16x32_bf16 v[32:35], v[124:127], v[28:31], v[32:35]
    v_mfma_f32_16x16x32_bf16 v[32:35], v[128:131], v[28:31], v[32:35]
    v_mfma_f32_16x16x32_bf16 v[32:35], v[132:135], v[28:31], v[32:35]
    v_lshrrev_b32 v10, 5, v0
    v_lshlrev_b32 v10, 8, v10
    v_lshl_add_u32 v10, v9, 4, v10
    v_bfe_u32 v9, v0, 4, 1
    v_lshl_add_u32 v10, v9, 3, v10
    s_lshl_b32 s7, s36, 9
    s_mul_i32 s6, s37, 18432
    s_add_u32 s7, s7, s6
    s_add_u32 s7, s7, 3022848
    v_mul_f32 v32, 0x3ae38e39, v32
    v_mul_f32 v33, 0x3ae38e39, v33
    v_mul_f32 v34, 0x3ae38e39, v34
    v_mul_f32 v35, 0x3ae38e39, v35
    v_cvt_pk_bf16_f32 v36, v32, v33
    v_cvt_pk_bf16_f32 v37, v34, v35
    v_lshlrev_b32 v38, 16, v36
    v_and_b32 v39, s16, v36
    v_sub_f32 v38, v32, v38
    v_sub_f32 v39, v33, v39
    v_cvt_pk_bf16_f32 v28, v38, v39
    v_cndmask_b32 v28, 0, v28, s[22:23]
    v_cndmask_b32 v28, v28, v36, vcc
    v_lshlrev_b32 v38, 16, v37
    v_and_b32 v39, s16, v37
    v_sub_f32 v38, v34, v38
    v_sub_f32 v39, v35, v39
    v_cvt_pk_bf16_f32 v29, v38, v39
    v_cndmask_b32 v29, 0, v29, s[22:23]
    v_cndmask_b32 v29, v29, v37, vcc
    buffer_store_dwordx2 v[28:29], v10, s[8:11], s7 offen sc1
L_p3_6:
    s_add_u32 s19, s18, 27000832
    s_add_u32 s20, s18, 19922944
    s_lshl_b32 s22, s21, 7
    s_add_u32 s22, s22, 50593792
    buffer_store_dwordx4 v[16:19], v2, s[8:11], s19 offen sc1
    buffer_store_dwordx4 v[20:23], v3, s[8:11], s19 offen sc1
    buffer_store_dwordx4 v[24:27], v4, s[8:11], s19 offen sc1
    s_mov_b32 s17, 0x3f803f80
    v_mov_b32 v8, 0
    v_mov_b32 v9, 0
    v_mov_b32 v10, 0
    v_mov_b32 v11, 0
    v_dot2c_f32_bf16 v8, s17, v16
    v_dot2c_f32_bf16 v9, v16, v16
    v_dot2c_f32_bf16 v10, s17, v17
    v_dot2c_f32_bf16 v11, v17, v17
    v_dot2c_f32_bf16 v8, s17, v18
    v_dot2c_f32_bf16 v9, v18, v18
    v_dot2c_f32_bf16 v10, s17, v19
    v_dot2c_f32_bf16 v11, v19, v19
    v_dot2c_f32_bf16 v8, s17, v20
    v_dot2c_f32_bf16 v9, v20, v20
    v_dot2c_f32_bf16 v10, s17, v21
    v_dot2c_f32_bf16 v11, v21, v21
    v_dot2c_f32_bf16 v8, s17, v22
    v_dot2c_f32_bf16 v9, v22, v22
    v_dot2c_f32_bf16 v10, s17, v23
    v_dot2c_f32_bf16 v11, v23, v23
    v_dot2c_f32_bf16 v8, s17, v24
    v_dot2c_f32_bf16 v9, v24, v24
    v_dot2c_f32_bf16 v10, s17, v25
    v_dot2c_f32_bf16 v11, v25, v25
    v_dot2c_f32_bf16 v8, s17, v26
    v_dot2c_f32_bf16 v9, v26, v26
    v_dot2c_f32_bf16 v10, s17, v27
    v_dot2c_f32_bf16 v11, v27, v27
    v_and_b32 v12, 7, v0
    v_lshlrev_b32 v12, 3, v12
    s_lshl_b32 s7, s3, 6
    v_add_u32 v13, s7, v12
    v_pk_add_f32 v[8:9], v[8:9], v[10:11]
    s_nop 1
    v_add_f32_dpp v8, v8, v8 row_ror:8 row_mask:0xf bank_mask:0xf
    v_add_f32_dpp v9, v9, v9 row_ror:8 row_mask:0xf bank_mask:0xf
    v_mov_b32 v10, v8
    v_mov_b32 v11, v9
    s_nop 1
    v_permlane32_swap_b32 v10, v8
    v_permlane32_swap_b32 v11, v9
    v_add_f32 v8, v8, v10
    v_add_f32 v9, v9, v11
    v_mov_b32 v10, v8
    v_mov_b32 v11, v9
    s_nop 1
    v_permlane16_swap_b32 v10, v8
    v_permlane16_swap_b32 v11, v9
    v_add_f32 v8, v8, v10
    v_add_f32 v9, v9, v11
    ds_write_b64 v13, v[8:9]
    s_waitcnt lgkmcnt(0)
    s_barrier
    ds_read_b64 v[40:41], v12 offset:0
    ds_read_b64 v[42:43], v12 offset:64
    ds_read_b64 v[44:45], v12 offset:128
    ds_read_b64 v[46:47], v12 offset:192
    s_waitcnt lgkmcnt(0)
    v_pk_add_f32 v[40:41], v[40:41], v[42:43]
    v_pk_add_f32 v[44:45], v[44:45], v[46:47]
    v_pk_add_f32 v[8:9], v[40:41], v[44:45]
    v_mul_f32 v8, 0x3ae38e39, v8
    v_mul_f32 v9, 0x3ae38e39, v9
    v_fma_f32 v9, -v8, v8, v9
    v_max_f32 v9, 0, v9
    v_add_f32 v9, 0x3727c5ac, v9
    v_rsq_f32 v10, v9
    s_nop 0
    v_mul_f32 v12, v8, v10
    v_mov_b32 v11, v10
    v_sub_f32 v12, 0, v12
    v_mov_b32 v13, v12
    s_cmp_eq_u32 s3, 0
    s_cselect_b32 s7, 32, 0
    v_lshlrev_b32 v14, 2, v0
    v_cmp_gt_u32 vcc, s7, v0
    v_mov_b32 v9, 1073741824
    s_nop 0
    v_cndmask_b32 v14, v9, v14, vcc
    buffer_store_dword v8, v14, s[8:11], s22 offen sc1
    v_lshlrev_b32 v40, 16, v16
    v_and_b32 v41, s16, v16
    v_lshlrev_b32 v42, 16, v17
    v_and_b32 v43, s16, v17
    v_lshlrev_b32 v44, 16, v18
    v_and_b32 v45, s16, v18
    v_lshlrev_b32 v46, 16, v19
    v_and_b32 v47, s16, v19
    v_pk_fma_f32 v[40:41], v[40:41], v[10:11], v[12:13]
    v_pk_fma_f32 v[42:43], v[42:43], v[10:11], v[12:13]
    v_pk_fma_f32 v[44:45], v[44:45], v[10:11], v[12:13]
    v_pk_fma_f32 v[46:47], v[46:47], v[10:11], v[12:13]
    v_cvt_pk_bf16_f32 v48, v40, v41
    v_cvt_pk_bf16_f32 v49, v42, v43
    v_cvt_pk_bf16_f32 v50, v44, v45
    v_cvt_pk_bf16_f32 v51, v46, v47
    v_lshlrev_b32 v40, 16, v20
    v_and_b32 v41, s16, v20
    v_lshlrev_b32 v42, 16, v21
    v_and_b32 v43, s16, v21
    v_lshlrev_b32 v44, 16, v22
    v_and_b32 v45, s16, v22
    v_lshlrev_b32 v46, 16, v23
    v_and_b32 v47, s16, v23
    v_pk_fma_f32 v[40:41], v[40:41], v[10:11], v[12:13]
    v_pk_fma_f32 v[42:43], v[42:43], v[10:11], v[12:13]
    v_pk_fma_f32 v[44:45], v[44:45], v[10:11], v[12:13]
    v_pk_fma_f32 v[46:47], v[46:47], v[10:11], v[12:13]
    v_cvt_pk_bf16_f32 v52, v40, v41
    v_cvt_pk_bf16_f32 v53, v42, v43
    v_cvt_pk_bf16_f32 v54, v44, v45
    v_cvt_pk_bf16_f32 v55, v46, v47
    v_lshlrev_b32 v40, 16, v24
    v_and_b32 v41, s16, v24
    v_lshlrev_b32 v42, 16, v25
    v_and_b32 v43, s16, v25
    v_lshlrev_b32 v44, 16, v26
    v_and_b32 v45, s16, v26
    v_lshlrev_b32 v46, 16, v27
    v_and_b32 v47, s16, v27
    v_pk_fma_f32 v[40:41], v[40:41], v[10:11], v[12:13]
    v_pk_fma_f32 v[42:43], v[42:43], v[10:11], v[12:13]
    v_pk_fma_f32 v[44:45], v[44:45], v[10:11], v[12:13]
    v_pk_fma_f32 v[46:47], v[46:47], v[10:11], v[12:13]
    v_cvt_pk_bf16_f32 v56, v40, v41
    v_cvt_pk_bf16_f32 v57, v42, v43
    v_cvt_pk_bf16_f32 v58, v44, v45
    v_cvt_pk_bf16_f32 v59, v46, v47
    buffer_store_dwordx4 v[48:51], v2, s[8:11], s20 offen sc1
    buffer_store_dwordx4 v[52:55], v3, s[8:11], s20 offen sc1
    buffer_store_dwordx4 v[56:59], v4, s[8:11], s20 offen sc1
    v_lshlrev_b32 v15, 7, v0
    s_lshl_b32 s6, s40, 2
    s_add_u32 s6, s6, s44
    s_sub_u32 s6, s6, 32768
    v_mov_b32 v1, s76
    s_mov_b64 vcc, 0xff
    v_lshrrev_b32 v14, 3, v0
    v_lshl_add_u32 v15, v14, 3, v15
    s_cmp_ge_u32 s40, 6
    s_cselect_b32 s7, s41, 31
    s_cmp_lt_u32 s7, 31
    s_cmov_b64 vcc, 0xffff
    s_waitcnt vmcnt(0)
    s_barrier
    s_cmp_lg_u32 s3, 0
    s_cbranch_scc1 L_pub_7
    s_mov_b64 exec, vcc
    buffer_store_dword v1, v15, s[8:11], s6 offen sc1
    v_lshlrev_b32 v15, 10, v0
    s_lshl_b32 s6, s40, 7
    s_lshl_b32 s7, s41, 2
    s_add_u32 s6, s6, s7
    s_add_u32 s6, s6, 19431424
    s_mov_b64 exec, 0xffffffff
    v_lshlrev_b32 v15, 10, v0
    v_mov_b32 v1, s76
    buffer_store_dword v1, v15, s[8:11], s6 offen sc1
    s_lshl_b32 s6, s37, 8
    s_lshl_b32 s7, s36, 2
    s_add_u32 s6, s6, s7
    s_add_u32 s6, s6, 19496960
    s_mov_b64 exec, 1
    buffer_store_dword v1, off, s[8:11], s6 sc1
L_pub_7:
    s_mov_b64 exec, -1
    s_cmp_lg_u32 s3, 0
    s_cbranch_scc1 L_wq_ready_8
    v_and_b32 v15, 31, v0
    v_lshlrev_b32 v15, 2, v15
    s_lshl_b32 s7, s41, 3
    s_add_u32 s7, s7, s40
    s_lshl_b32 s7, s7, 7
    s_add_u32 s7, s7, 19431424
    s_mov_b32 s6, 0
L_spin_9:
    buffer_load_dword v1, v15, s[8:11], s7 offen sc1
    s_add_u32 s6, s6, 1
    s_waitcnt vmcnt(0)
    v_cmp_eq_u32 vcc, s76, v1
    s_cmp_eq_u64 vcc, exec
    s_cbranch_scc1 L_spun_10
    s_cmp_lt_u32 s6, 1048576
    s_cbranch_scc1 L_spin_9
    s_branch L_main_end
L_spun_10:
L_wq_ready_8:
    s_barrier
    s_lshl_b32 s28, s40, 2
    s_add_u32 s28, s28, s3
    s_mul_i32 s28, s28, 73728
    buffer_load_dwordx4 a[0:3], v253, s[8:11], s28 offen offset:0 sc1
    buffer_load_dwordx4 a[4:7], v253, s[8:11], s28 offen offset:1024 sc1
    buffer_load_dwordx4 a[8:11], v253, s[8:11], s28 offen offset:2048 sc1
    buffer_load_dwordx4 a[12:15], v253, s[8:11], s28 offen offset:3072 sc1
    s_add_u32 s28, s28, 4096
    buffer_load_dwordx4 a[16:19], v253, s[8:11], s28 offen offset:0 sc1
    buffer_load_dwordx4 a[20:23], v253, s[8:11], s28 offen offset:1024 sc1
    buffer_load_dwordx4 a[24:27], v253, s[8:11], s28 offen offset:2048 sc1
    buffer_load_dwordx4 a[28:31], v253, s[8:11], s28 offen offset:3072 sc1
    s_add_u32 s28, s28, 4096
    buffer_load_dwordx4 a[32:35], v253, s[8:11], s28 offen offset:0 sc1
    buffer_load_dwordx4 a[36:39], v253, s[8:11], s28 offen offset:1024 sc1
    buffer_load_dwordx4 a[40:43], v253, s[8:11], s28 offen offset:2048 sc1
    buffer_load_dwordx4 a[44:47], v253, s[8:11], s28 offen offset:3072 sc1
    s_add_u32 s28, s28, 4096
    buffer_load_dwordx4 a[48:51], v253, s[8:11], s28 offen offset:0 sc1
    buffer_load_dwordx4 a[52:55], v253, s[8:11], s28 offen offset:1024 sc1
    buffer_load_dwordx4 a[56:59], v253, s[8:11], s28 offen offset:2048 sc1
    buffer_load_dwordx4 a[60:63], v253, s[8:11], s28 offen offset:3072 sc1
    s_add_u32 s28, s28, 4096
    buffer_load_dwordx4 a[64:67], v253, s[8:11], s28 offen offset:0 sc1
    buffer_load_dwordx4 a[68:71], v253, s[8:11], s28 offen offset:1024 sc1
    buffer_load_dwordx4 a[72:75], v253, s[8:11], s28 offen offset:2048 sc1
    buffer_load_dwordx4 a[76:79], v253, s[8:11], s28 offen offset:3072 sc1
    s_add_u32 s28, s28, 4096
    buffer_load_dwordx4 a[80:83], v253, s[8:11], s28 offen offset:0 sc1
    buffer_load_dwordx4 a[84:87], v253, s[8:11], s28 offen offset:1024 sc1
    buffer_load_dwordx4 a[88:91], v253, s[8:11], s28 offen offset:2048 sc1
    buffer_load_dwordx4 a[92:95], v253, s[8:11], s28 offen offset:3072 sc1
    s_add_u32 s28, s28, 4096
L_main_layer:
    buffer_load_dwordx4 a[96:99], v253, s[8:11], s28 offen offset:0 sc1
    buffer_load_dwordx4 a[100:103], v253, s[8:11], s28 offen offset:1024 sc1
    buffer_load_dwordx4 a[104:107], v253, s[8:11], s28 offen offset:2048 sc1
    buffer_load_dwordx4 a[108:111], v253, s[8:11], s28 offen offset:3072 sc1
    s_add_u32 s28, s28, 4096
    buffer_load_dwordx4 a[112:115], v253, s[8:11], s28 offen offset:0 sc1
    buffer_load_dwordx4 a[116:119], v253, s[8:11], s28 offen offset:1024 sc1
    buffer_load_dwordx4 a[120:123], v253, s[8:11], s28 offen offset:2048 sc1
    buffer_load_dwordx4 a[124:127], v253, s[8:11], s28 offen offset:3072 sc1
    s_add_u32 s28, s28, 4096
    buffer_load_dwordx4 a[128:131], v253, s[8:11], s28 offen offset:0 sc1
    buffer_load_dwordx4 a[132:135], v253, s[8:11], s28 offen offset:1024 sc1
    buffer_load_dwordx4 a[136:139], v253, s[8:11], s28 offen offset:2048 sc1
    buffer_load_dwordx4 a[140:143], v253, s[8:11], s28 offen offset:3072 sc1
    s_add_u32 s28, s28, 4096
    v_bfe_u32 v3, v0, 3, 1
    v_mul_u32_u24 v2, 9216, v3
    v_lshrrev_b32 v3, 4, v0
    v_lshl_add_u32 v2, v3, 7, v2
    v_and_b32 v3, 7, v0
    v_lshl_add_u32 v2, v3, 4, v2
    v_bfe_u32 v3, v0, 3, 2
    s_mov_b32 s7, 9216
    v_mul_lo_u32 v9, v3, s7
    v_lshrrev_b32 v3, 5, v0
    v_lshl_add_u32 v9, v3, 7, v9
    v_and_b32 v3, 7, v0
    v_lshl_add_u32 v9, v3, 4, v9
    s_mul_i32 s22, s41, 73728
    s_add_u32 s22, s22, s43
    s_add_u32 s23, s22, 19922944
    s_mul_i32 s7, s3, 18432
    s_add_u32 s24, s23, s7
    s_cmp_eq_u32 s41, 0
    s_cselect_b32 s7, 0, 18432
    s_sub_u32 s23, s23, s7
    s_lshl_b32 s25, s3, 10
    s_add_u32 s25, s25, 1024
    s_mul_i32 s26, s3, 5120
    s_lshl_b32 s7, s3, 9
    s_add_u32 s27, s23, s7
    s_and_b32 s7, s3, 1
    s_add_u32 s7, s7, 4
    s_mul_i32 s29, s7, 5120
    s_lshl_b32 s7, s7, 9
    s_add_u32 s23, s23, s7
    s_cmp_lg_u32 s3, 0
    s_cbranch_scc1 L_pollout_13
    s_lshl_b32 s7, s40, 7
    s_add_u32 s7, s7, s44
    s_sub_u32 s7, s7, 32768
    s_add_u32 s52, s4, s7
    s_addc_u32 s53, s5, 0
    s_cmp_eq_u32 s41, 0
    s_cselect_b32 s7, 0, 32
    s_mov_b32 s6, 0
L_poll_11:
    s_load_dwordx8 s[56:63], s[52:53], 0 glc
    s_load_dwordx2 s[54:55], s[52:53], s7 glc
    s_add_u32 s6, s6, 1
    s_waitcnt lgkmcnt(0)
    s_xor_b64 s[54:55], s[54:55], s[76:77]
    s_xor_b64 s[56:57], s[56:57], s[76:77]
    s_xor_b64 s[58:59], s[58:59], s[76:77]
    s_xor_b64 s[60:61], s[60:61], s[76:77]
    s_xor_b64 s[62:63], s[62:63], s[76:77]
    s_or_b64 s[56:57], s[56:57], s[58:59]
    s_or_b64 s[60:61], s[60:61], s[62:63]
    s_or_b64 s[56:57], s[56:57], s[54:55]
    s_or_b64 s[56:57], s[56:57], s[60:61]
    s_cbranch_scc0 L_polled_12
    s_cmp_lt_u32 s6, 1048576
    s_cbranch_scc1 L_poll_11
    s_branch L_main_end
L_polled_12:
L_pollout_13:
    s_barrier
    s_add_u32 m0, s25, 0
    s_nop 0
    buffer_load_dwordx4 v2, s[8:11], s24 offen offset:0 sc1 lds
    s_add_u32 m0, s25, 4608
    s_nop 0
    buffer_load_dwordx4 v2, s[8:11], s24 offen offset:512 sc1 lds
    s_add_u32 m0, s25, 9216
    s_nop 0
    buffer_load_dwordx4 v2, s[8:11], s24 offen offset:1024 sc1 lds
    s_add_u32 m0, s25, 13824
    s_nop 0
    buffer_load_dwordx4 v2, s[8:11], s24 offen offset:1536 sc1 lds
    s_add_u32 m0, s25, 18432
    s_nop 0
    buffer_load_dwordx4 v2, s[8:11], s24 offen offset:2048 sc1 lds
    s_add_u32 m0, s25, 23040
    s_nop 0
    buffer_load_dwordx4 v2, s[8:11], s24 offen offset:2560 sc1 lds
    s_add_u32 m0, s26, 0
    s_add_u32 s7, s27, 0
    buffer_load_dwordx4 v2, s[8:11], s7 offen sc1 lds
    s_add_u32 m0, s29, 0
    s_add_u32 s7, s23, 0
    buffer_load_dwordx4 v2, s[8:11], s7 offen sc1 lds
    v_mov_b32 v132, 0
    v_mov_b32 v133, 0
    v_mov_b32 v192, 0
    v_mov_b32 v193, 0
    v_mov_b32 v195, 0
    v_mov_b32 v135, 0
    v_mov_b32 v139, 0
    v_mov_b32 v143, 0
    v_mov_b32 v147, 0
    v_mov_b32 v151, 0
    v_mov_b32 v155, 0
    v_mov_b32 v159, 0
    v_mov_b32 v163, 0
    v_mov_b32 v167, 0
    v_mov_b32 v171, 0
    v_cmp_eq_u32 vcc, 16, v0
    v_mov_b32 v10, 0x3f80
    v_cmp_eq_u32 s[20:21], 17, v0
    v_cndmask_b32 v194, 0, v10, vcc
    v_and_b32 v11, 3, v0
    v_cndmask_b32 v194, v194, 1.0, s[20:21]
    v_cmp_eq_u32 vcc, 2, v11
    v_and_b32 v10, 15, v0
    v_lshrrev_b32 v11, 4, v0
    v_cndmask_b32 v196, 0, 1.0, vcc
    v_cndmask_b32 v197, 0, 1.0, vcc
    v_cndmask_b32 v198, 0, 1.0, vcc
    v_cndmask_b32 v199, 0, 1.0, vcc
    v_lshlrev_b32 v11, 2, v11
    v_sub_u32 v10, v11, v10
    v_mov_b32 v12, 0xf149f2ca
    s_cmp_eq_u32 s41, 0
    s_cselect_b64 s[38:39], 0, -1
    v_add_u32 v11, 0, v10
    v_and_b32 v13, 1, v11
    v_cmp_eq_u32 s[20:21], 0, v13
    v_cmp_lt_i32 vcc, 1, v11
    v_cmp_gt_i32 s[18:19], 1, v11
    s_and_b64 vcc, vcc, s[20:21]
    s_and_b64 s[18:19], s[18:19], s[20:21]
    s_and_b64 s[20:21], vcc, s[38:39]
    v_cndmask_b32 v200, v12, 0, vcc
    v_cndmask_b32 v204, v12, 0, s[18:19]
    v_cndmask_b32 v208, v12, 0, s[20:21]
    v_add_u32 v11, 1, v10
    v_and_b32 v13, 1, v11
    v_cmp_eq_u32 s[20:21], 0, v13
    v_cmp_lt_i32 vcc, 1, v11
    v_cmp_gt_i32 s[18:19], 1, v11
    s_and_b64 vcc, vcc, s[20:21]
    s_and_b64 s[18:19], s[18:19], s[20:21]
    s_and_b64 s[20:21], vcc, s[38:39]
    v_cndmask_b32 v201, v12, 0, vcc
    v_cndmask_b32 v205, v12, 0, s[18:19]
    v_cndmask_b32 v209, v12, 0, s[20:21]
    v_add_u32 v11, 2, v10
    v_and_b32 v13, 1, v11
    v_cmp_eq_u32 s[20:21], 0, v13
    v_cmp_lt_i32 vcc, 1, v11
    v_cmp_gt_i32 s[18:19], 1, v11
    s_and_b64 vcc, vcc, s[20:21]
    s_and_b64 s[18:19], s[18:19], s[20:21]
    s_and_b64 s[20:21], vcc, s[38:39]
    v_cndmask_b32 v202, v12, 0, vcc
    v_cndmask_b32 v206, v12, 0, s[18:19]
    v_cndmask_b32 v210, v12, 0, s[20:21]
    v_add_u32 v11, 3, v10
    v_and_b32 v13, 1, v11
    v_cmp_eq_u32 s[20:21], 0, v13
    v_cmp_lt_i32 vcc, 1, v11
    v_cmp_gt_i32 s[18:19], 1, v11
    s_and_b64 vcc, vcc, s[20:21]
    s_and_b64 s[18:19], s[18:19], s[20:21]
    s_and_b64 s[20:21], vcc, s[38:39]
    v_cndmask_b32 v203, v12, 0, vcc
    v_cndmask_b32 v207, v12, 0, s[18:19]
    v_cndmask_b32 v211, v12, 0, s[20:21]
    s_lshl_b32 s45, s41, 1
    s_lshr_b32 s7, s40, 2
    s_add_u32 s45, s45, s7
    s_mul_i32 s30, s45, 36864
    s_add_u32 s30, s30, s43
    s_and_b32 s31, s40, 3
    s_mul_i32 s31, s31, 9
    s_add_u32 s31, s31, s3
    s_mul_i32 s32, s31, 18432
    s_add_u32 s32, s32, 2359296
    s_add_u32 s33, s32, 73728
    s_add_u32 s34, s32, 147456
    s_and_b32 s7, s40, 3
    s_mul_i32 s6, s7, 18432
    s_add_u32 s6, s6, 3022848
    s_lshl_b32 s39, s7, 8
    s_add_u32 s39, s39, 19496960
    v_lshlrev_b32 v226, 2, v0
    s_cmp_eq_u32 s3, 1
    s_cmov_b32 s34, s6
    s_cmp_lt_u32 s3, 2
    s_cselect_b32 s35, 0, 1073741824
    v_add_u32 v5, s35, v253
    s_cmp_eq_u32 s3, 0
    s_cselect_b32 s35, 0, 1073741824
    v_add_u32 v7, s35, v9
    s_lshl_b32 s7, s31, 8
    s_add_u32 s36, s30, s7
    s_add_u32 s37, s36, 27000832
    s_add_u32 s46, s36, 48234496
    s_lshl_b32 s36, s45, 7
    s_add_u32 s36, s36, s43
    s_add_u32 s36, s36, 24641536
    s_lshl_b32 s47, s45, 9
    s_add_u32 s47, s47, s43
    s_add_u32 s47, s47, 50593792
    v_bfe_u32 v10, v0, 3, 2
    v_and_b32 v8, 7, v0
    v_lshlrev_b32 v8, 2, v8
    v_lshl_add_u32 v8, v10, 7, v8
    v_add_u32 v6, 46080, v253
    s_waitcnt vmcnt(0)
    s_barrier
    ds_read_b128 v[16:19], v253 offset:0
    ds_read_b128 v[20:23], v253 offset:1024
    ds_read_b128 v[24:27], v253 offset:2048
    ds_read_b128 v[28:31], v253 offset:3072
    ds_read_b128 v[32:35], v253 offset:4096
    s_waitcnt lgkmcnt(0)
    v_mfma_f32_16x16x32_bf16 v[56:59], a[0:3], v[20:23], 0
    ds_read_b128 v[36:39], v253 offset:5120
    v_mfma_f32_16x16x32_bf16 v[60:63], a[0:3], v[24:27], 0
    ds_read_b128 v[40:43], v253 offset:6144
    v_mfma_f32_16x16x32_bf16 v[64:67], a[0:3], v[28:31], 0
    ds_read_b128 v[44:47], v253 offset:7168
    v_mfma_f32_16x16x32_bf16 v[68:71], a[0:3], v[32:35], 0
    ds_read_b128 v[48:51], v253 offset:8192
    v_mfma_f32_16x16x32_bf16 v[72:75], a[4:7], v[16:19], 0
    ds_read_b128 v[52:55], v253 offset:9216
    v_mfma_f32_16x16x32_bf16 v[76:79], a[4:7], v[20:23], 0
    s_add_u32 m0, s25, 27648
    s_nop 0
    buffer_load_dwordx4 v2, s[8:11], s24 offen offset:3072 sc1 lds
    v_mfma_f32_16x16x32_bf16 v[80:83], a[4:7], v[24:27], 0
    v_mfma_f32_16x16x32_bf16 v[84:87], a[4:7], v[28:31], 0
    s_add_u32 m0, s25, 32256
    s_nop 0
    buffer_load_dwordx4 v2, s[8:11], s24 offen offset:3584 sc1 lds
    v_mfma_f32_16x16x32_bf16 v[88:91], a[4:7], v[32:35], 0
    v_mfma_f32_16x16x32_bf16 v[92:95], v[16:19], a[8:11], 0
    buffer_load_dwordx4 a[144:147], v253, s[8:11], s28 offen offset:0 sc1
    v_mfma_f32_16x16x32_bf16 v[96:99], v[20:23], a[8:11], 0
    v_mfma_f32_16x16x32_bf16 v[100:103], v[24:27], a[8:11], 0
    buffer_load_dwordx4 a[148:151], v253, s[8:11], s28 offen offset:1024 sc1
    v_mfma_f32_16x16x32_bf16 v[104:107], v[28:31], a[8:11], 0
    v_mfma_f32_16x16x32_bf16 v[108:111], v[32:35], a[8:11], 0
    buffer_load_dwordx4 a[152:155], v253, s[8:11], s28 offen offset:2048 sc1
    v_mfma_f32_16x16x32_bf16 v[112:115], a[12:15], v[16:19], 0
    v_mfma_f32_16x16x32_bf16 v[116:119], a[12:15], v[20:23], 0
    buffer_load_dwordx4 a[156:159], v253, s[8:11], s28 offen offset:3072 sc1
    v_mfma_f32_16x16x32_bf16 v[120:123], a[12:15], v[24:27], 0
    v_mfma_f32_16x16x32_bf16 v[124:127], a[12:15], v[28:31], 0
    s_add_u32 s28, s28, 4096
    v_mfma_f32_16x16x32_bf16 v[128:131], a[12:15], v[32:35], 0
    s_waitcnt lgkmcnt(0)
    v_mfma_f32_16x16x32_bf16 v[56:59], a[16:19], v[40:43], v[56:59]
    ds_read_b128 v[16:19], v253 offset:10240
    v_mfma_f32_16x16x32_bf16 v[60:63], a[16:19], v[44:47], v[60:63]
    ds_read_b128 v[20:23], v253 offset:11264
    v_mfma_f32_16x16x32_bf16 v[64:67], a[16:19], v[48:51], v[64:67]
    ds_read_b128 v[24:27], v253 offset:12288
    v_mfma_f32_16x16x32_bf16 v[68:71], a[16:19], v[52:55], v[68:71]
    ds_read_b128 v[28:31], v253 offset:13312
    v_mfma_f32_16x16x32_bf16 v[72:75], a[20:23], v[36:39], v[72:75]
    ds_read_b128 v[32:35], v253 offset:14336
    v_mfma_f32_16x16x32_bf16 v[76:79], a[20:23], v[40:43], v[76:79]
    s_add_u32 m0, s25, 40960
    s_add_u32 s24, s24, 4096
    buffer_load_dwordx4 v2, s[8:11], s24 offen offset:0 sc1 lds
    v_mfma_f32_16x16x32_bf16 v[80:83], a[20:23], v[44:47], v[80:83]
    v_mfma_f32_16x16x32_bf16 v[84:87], a[20:23], v[48:51], v[84:87]
    s_add_u32 m0, s25, 45568
    s_nop 0
    buffer_load_dwordx4 v2, s[8:11], s24 offen offset:512 sc1 lds
    v_mfma_f32_16x16x32_bf16 v[88:91], a[20:23], v[52:55], v[88:91]
    v_mfma_f32_16x16x32_bf16 v[92:95], v[36:39], a[24:27], v[92:95]
    buffer_load_dwordx4 a[0:3], v253, s[8:11], s28 offen offset:0 sc1
    v_mfma_f32_16x16x32_bf16 v[96:99], v[40:43], a[24:27], v[96:99]
    v_mfma_f32_16x16x32_bf16 v[100:103], v[44:47], a[24:27], v[100:103]
    buffer_load_dwordx4 a[4:7], v253, s[8:11], s28 offen offset:1024 sc1
    v_mfma_f32_16x16x32_bf16 v[104:107], v[48:51], a[24:27], v[104:107]
    v_mfma_f32_16x16x32_bf16 v[108:111], v[52:55], a[24:27], v[108:111]
    buffer_load_dwordx4 a[8:11], v253, s[8:11], s28 offen offset:2048 sc1
    v_mfma_f32_16x16x32_bf16 v[112:115], a[28:31], v[36:39], v[112:115]
    v_mfma_f32_16x16x32_bf16 v[116:119], a[28:31], v[40:43], v[116:119]
    buffer_load_dwordx4 a[12:15], v253, s[8:11], s28 offen offset:3072 sc1
    v_mfma_f32_16x16x32_bf16 v[120:123], a[28:31], v[44:47], v[120:123]
    v_mfma_f32_16x16x32_bf16 v[124:127], a[28:31], v[48:51], v[124:127]
    s_add_u32 s28, s28, 4096
    v_mfma_f32_16x16x32_bf16 v[128:131], a[28:31], v[52:55], v[128:131]
    s_add_u32 m0, s79, 0
    s_mov_b32 s78, s80
    buffer_load_dwordx4 v224, s[72:75], s78 offen lds
    s_waitcnt lgkmcnt(0)
    v_mfma_f32_16x16x32_bf16 v[56:59], a[32:35], v[20:23], v[56:59]
    ds_read_b128 v[36:39], v253 offset:15360
    v_mfma_f32_16x16x32_bf16 v[60:63], a[32:35], v[24:27], v[60:63]
    ds_read_b128 v[40:43], v253 offset:16384
    v_mfma_f32_16x16x32_bf16 v[64:67], a[32:35], v[28:31], v[64:67]
    ds_read_b128 v[44:47], v253 offset:17408
    v_mfma_f32_16x16x32_bf16 v[68:71], a[32:35], v[32:35], v[68:71]
    ds_read_b128 v[48:51], v253 offset:18432
    v_mfma_f32_16x16x32_bf16 v[72:75], a[36:39], v[16:19], v[72:75]
    ds_read_b128 v[52:55], v253 offset:19456
    v_mfma_f32_16x16x32_bf16 v[76:79], a[36:39], v[20:23], v[76:79]
    s_add_u32 m0, s25, 50176
    s_nop 0
    buffer_load_dwordx4 v2, s[8:11], s24 offen offset:1024 sc1 lds
    v_mfma_f32_16x16x32_bf16 v[80:83], a[36:39], v[24:27], v[80:83]
    v_mfma_f32_16x16x32_bf16 v[84:87], a[36:39], v[28:31], v[84:87]
    s_add_u32 m0, s25, 54784
    s_nop 0
    buffer_load_dwordx4 v2, s[8:11], s24 offen offset:1536 sc1 lds
    v_mfma_f32_16x16x32_bf16 v[88:91], a[36:39], v[32:35], v[88:91]
    v_mfma_f32_16x16x32_bf16 v[92:95], v[16:19], a[40:43], v[92:95]
    buffer_load_dwordx4 a[16:19], v253, s[8:11], s28 offen offset:0 sc1
    v_mfma_f32_16x16x32_bf16 v[96:99], v[20:23], a[40:43], v[96:99]
    v_mfma_f32_16x16x32_bf16 v[100:103], v[24:27], a[40:43], v[100:103]
    buffer_load_dwordx4 a[20:23], v253, s[8:11], s28 offen offset:1024 sc1
    v_mfma_f32_16x16x32_bf16 v[104:107], v[28:31], a[40:43], v[104:107]
    v_mfma_f32_16x16x32_bf16 v[108:111], v[32:35], a[40:43], v[108:111]
    buffer_load_dwordx4 a[24:27], v253, s[8:11], s28 offen offset:2048 sc1
    v_mfma_f32_16x16x32_bf16 v[112:115], a[44:47], v[16:19], v[112:115]
    v_mfma_f32_16x16x32_bf16 v[116:119], a[44:47], v[20:23], v[116:119]
    buffer_load_dwordx4 a[28:31], v253, s[8:11], s28 offen offset:3072 sc1
    v_mfma_f32_16x16x32_bf16 v[120:123], a[44:47], v[24:27], v[120:123]
    v_mfma_f32_16x16x32_bf16 v[124:127], a[44:47], v[28:31], v[124:127]
    s_add_u32 s28, s28, 4096
    v_mfma_f32_16x16x32_bf16 v[128:131], a[44:47], v[32:35], v[128:131]
    s_add_u32 m0, s79, 1024
    s_add_u32 s78, s78, s92
    buffer_load_dwordx4 v224, s[72:75], s78 offen lds
    s_waitcnt lgkmcnt(0)
    v_mfma_f32_16x16x32_bf16 v[56:59], a[48:51], v[40:43], v[56:59]
    ds_read_b128 v[16:19], v253 offset:20480
    v_mfma_f32_16x16x32_bf16 v[60:63], a[48:51], v[44:47], v[60:63]
    ds_read_b128 v[20:23], v253 offset:21504
    v_mfma_f32_16x16x32_bf16 v[64:67], a[48:51], v[48:51], v[64:67]
    ds_read_b128 v[24:27], v253 offset:22528
    v_mfma_f32_16x16x32_bf16 v[68:71], a[48:51], v[52:55], v[68:71]
    ds_read_b128 v[28:31], v253 offset:23552
    v_mfma_f32_16x16x32_bf16 v[72:75], a[52:55], v[36:39], v[72:75]
    ds_read_b128 v[32:35], v253 offset:24576
    v_mfma_f32_16x16x32_bf16 v[76:79], a[52:55], v[40:43], v[76:79]
    s_add_u32 m0, s26, 30720
    s_add_u32 s7, s27, 3072
    buffer_load_dwordx4 v2, s[8:11], s7 offen sc1 lds
    v_mfma_f32_16x16x32_bf16 v[80:83], a[52:55], v[44:47], v[80:83]
    v_mfma_f32_16x16x32_bf16 v[84:87], a[52:55], v[48:51], v[84:87]
    s_add_u32 m0, s29, 30720
    s_add_u32 s7, s23, 3072
    buffer_load_dwordx4 v2, s[8:11], s7 offen sc1 lds
    v_mfma_f32_16x16x32_bf16 v[88:91], a[52:55], v[52:55], v[88:91]
    v_mfma_f32_16x16x32_bf16 v[92:95], v[36:39], a[56:59], v[92:95]
    buffer_load_dwordx4 a[32:35], v253, s[8:11], s28 offen offset:0 sc1
    v_mfma_f32_16x16x32_bf16 v[96:99], v[40:43], a[56:59], v[96:99]
    v_mfma_f32_16x16x32_bf16 v[100:103], v[44:47], a[56:59], v[100:103]
    buffer_load_dwordx4 a[36:39], v253, s[8:11], s28 offen offset:1024 sc1
    v_mfma_f32_16x16x32_bf16 v[104:107], v[48:51], a[56:59], v[104:107]
    v_mfma_f32_16x16x32_bf16 v[108:111], v[52:55], a[56:59], v[108:111]
    buffer_load_dwordx4 a[40:43], v253, s[8:11], s28 offen offset:2048 sc1
    v_mfma_f32_16x16x32_bf16 v[112:115], a[60:63], v[36:39], v[112:115]
    v_mfma_f32_16x16x32_bf16 v[116:119], a[60:63], v[40:43], v[116:119]
    buffer_load_dwordx4 a[44:47], v253, s[8:11], s28 offen offset:3072 sc1
    v_mfma_f32_16x16x32_bf16 v[120:123], a[60:63], v[44:47], v[120:123]
    v_mfma_f32_16x16x32_bf16 v[124:127], a[60:63], v[48:51], v[124:127]
    s_add_u32 s28, s28, 4096
    v_mfma_f32_16x16x32_bf16 v[128:131], a[60:63], v[52:55], v[128:131]
    s_add_u32 m0, s79, 2048
    s_add_u32 s78, s78, s92
    buffer_load_dwordx4 v224, s[72:75], s78 offen lds
    s_waitcnt lgkmcnt(0)
    v_mfma_f32_16x16x32_bf16 v[56:59], a[64:67], v[20:23], v[56:59]
    ds_read_b128 v[36:39], v253 offset:25600
    v_mfma_f32_16x16x32_bf16 v[60:63], a[64:67], v[24:27], v[60:63]
    ds_read_b128 v[40:43], v253 offset:26624
    v_mfma_f32_16x16x32_bf16 v[64:67], a[64:67], v[28:31], v[64:67]
    ds_read_b128 v[44:47], v253 offset:27648
    v_mfma_f32_16x16x32_bf16 v[68:71], a[64:67], v[32:35], v[68:71]
    ds_read_b128 v[48:51], v253 offset:28672
    v_mfma_f32_16x16x32_bf16 v[72:75], a[68:71], v[16:19], v[72:75]
    ds_read_b128 v[52:55], v253 offset:29696
    v_mfma_f32_16x16x32_bf16 v[76:79], a[68:71], v[20:23], v[76:79]
    buffer_load_dwordx4 a[48:51], v253, s[8:11], s28 offen offset:0 sc1
    v_mfma_f32_16x16x32_bf16 v[80:83], a[68:71], v[24:27], v[80:83]
    v_mfma_f32_16x16x32_bf16 v[84:87], a[68:71], v[28:31], v[84:87]
    buffer_load_dwordx4 a[52:55], v253, s[8:11], s28 offen offset:1024 sc1
    v_mfma_f32_16x16x32_bf16 v[88:91], a[68:71], v[32:35], v[88:91]
    v_mfma_f32_16x16x32_bf16 v[92:95], v[16:19], a[72:75], v[92:95]
    buffer_load_dwordx4 a[56:59], v253, s[8:11], s28 offen offset:2048 sc1
    v_mfma_f32_16x16x32_bf16 v[96:99], v[20:23], a[72:75], v[96:99]
    v_mfma_f32_16x16x32_bf16 v[100:103], v[24:27], a[72:75], v[100:103]
    buffer_load_dwordx4 a[60:63], v253, s[8:11], s28 offen offset:3072 sc1
    v_mfma_f32_16x16x32_bf16 v[104:107], v[28:31], a[72:75], v[104:107]
    v_mfma_f32_16x16x32_bf16 v[108:111], v[32:35], a[72:75], v[108:111]
    buffer_load_dword v225, v226, s[8:11], s39 offen sc1
    v_mfma_f32_16x16x32_bf16 v[112:115], a[76:79], v[16:19], v[112:115]
    v_mfma_f32_16x16x32_bf16 v[116:119], a[76:79], v[20:23], v[116:119]
    v_mfma_f32_16x16x32_bf16 v[120:123], a[76:79], v[24:27], v[120:123]
    v_mfma_f32_16x16x32_bf16 v[124:127], a[76:79], v[28:31], v[124:127]
    s_add_u32 s28, s28, 4096
    v_mfma_f32_16x16x32_bf16 v[128:131], a[76:79], v[32:35], v[128:131]
    s_add_u32 m0, s79, 3072
    s_add_u32 s78, s78, s92
    buffer_load_dwordx4 v224, s[72:75], s78 offen lds
    s_waitcnt vmcnt(11) lgkmcnt(0)
    s_barrier
    v_mfma_f32_16x16x32_bf16 v[56:59], a[80:83], v[40:43], v[56:59]
    ds_read_b128 v[16:19], v253 offset:30720
    v_mfma_f32_16x16x32_bf16 v[60:63], a[80:83], v[44:47], v[60:63]
    ds_read_b128 v[20:23], v253 offset:31744
    v_mfma_f32_16x16x32_bf16 v[64:67], a[80:83], v[48:51], v[64:67]
    ds_read_b128 v[24:27], v253 offset:32768
    v_mfma_f32_16x16x32_bf16 v[68:71], a[80:83], v[52:55], v[68:71]
    ds_read_b128 v[28:31], v253 offset:33792
    v_mfma_f32_16x16x32_bf16 v[72:75], a[84:87], v[36:39], v[72:75]
    ds_read_b128 v[32:35], v253 offset:34816
    v_mfma_f32_16x16x32_bf16 v[76:79], a[84:87], v[40:43], v[76:79]
    s_add_u32 m0, s25, 59392
    s_nop 0
    buffer_load_dwordx4 v2, s[8:11], s24 offen offset:2048 sc1 lds
    v_mfma_f32_16x16x32_bf16 v[80:83], a[84:87], v[44:47], v[80:83]
    v_mfma_f32_16x16x32_bf16 v[84:87], a[84:87], v[48:51], v[84:87]
    s_add_u32 m0, s25, 64000
    s_nop 0
    buffer_load_dwordx4 v2, s[8:11], s24 offen offset:2560 sc1 lds
    v_mfma_f32_16x16x32_bf16 v[88:91], a[84:87], v[52:55], v[88:91]
    v_mfma_f32_16x16x32_bf16 v[92:95], v[36:39], a[88:91], v[92:95]
    buffer_load_dwordx4 a[64:67], v253, s[8:11], s28 offen offset:0 sc1
    v_mfma_f32_16x16x32_bf16 v[96:99], v[40:43], a[88:91], v[96:99]
    v_mfma_f32_16x16x32_bf16 v[100:103], v[44:47], a[88:91], v[100:103]
    buffer_load_dwordx4 a[68:71], v253, s[8:11], s28 offen offset:1024 sc1
    v_mfma_f32_16x16x32_bf16 v[104:107], v[48:51], a[88:91], v[104:107]
    v_mfma_f32_16x16x32_bf16 v[108:111], v[52:55], a[88:91], v[108:111]
    buffer_load_dwordx4 a[72:75], v253, s[8:11], s28 offen offset:2048 sc1
    v_mfma_f32_16x16x32_bf16 v[112:115], a[92:95], v[36:39], v[112:115]
    v_mfma_f32_16x16x32_bf16 v[116:119], a[92:95], v[40:43], v[116:119]
    buffer_load_dwordx4 a[76:79], v253, s[8:11], s28 offen offset:3072 sc1
    v_mfma_f32_16x16x32_bf16 v[120:123], a[92:95], v[44:47], v[120:123]
    v_mfma_f32_16x16x32_bf16 v[124:127], a[92:95], v[48:51], v[124:127]
    s_add_u32 s28, s28, 4096
    v_mfma_f32_16x16x32_bf16 v[128:131], a[92:95], v[52:55], v[128:131]
    s_add_u32 m0, s79, 4096
    s_mov_b32 s78, s81
    buffer_load_dwordx4 v224, s[72:75], s78 offen lds
    s_waitcnt lgkmcnt(0)
    v_mfma_f32_16x16x32_bf16 v[56:59], a[96:99], v[20:23], v[56:59]
    ds_read_b128 v[36:39], v253 offset:35840
    v_mfma_f32_16x16x32_bf16 v[60:63], a[96:99], v[24:27], v[60:63]
    ds_read_b128 v[40:43], v253 offset:36864
    v_mfma_f32_16x16x32_bf16 v[64:67], a[96:99], v[28:31], v[64:67]
    ds_read_b128 v[44:47], v253 offset:37888
    v_mfma_f32_16x16x32_bf16 v[68:71], a[96:99], v[32:35], v[68:71]
    ds_read_b128 v[48:51], v253 offset:38912
    v_mfma_f32_16x16x32_bf16 v[72:75], a[100:103], v[16:19], v[72:75]
    ds_read_b128 v[52:55], v253 offset:39936
    v_mfma_f32_16x16x32_bf16 v[76:79], a[100:103], v[20:23], v[76:79]
    s_add_u32 m0, s25, 68608
    s_nop 0
    buffer_load_dwordx4 v2, s[8:11], s24 offen offset:3072 sc1 lds
    v_mfma_f32_16x16x32_bf16 v[80:83], a[100:103], v[24:27], v[80:83]
    v_mfma_f32_16x16x32_bf16 v[84:87], a[100:103], v[28:31], v[84:87]
    s_add_u32 m0, s25, 73216
    s_nop 0
    buffer_load_dwordx4 v2, s[8:11], s24 offen offset:3584 sc1 lds
    v_mfma_f32_16x16x32_bf16 v[88:91], a[100:103], v[32:35], v[88:91]
    v_mfma_f32_16x16x32_bf16 v[92:95], v[16:19], a[104:107], v[92:95]
    buffer_load_dwordx4 a[80:83], v253, s[8:11], s28 offen offset:0 sc1
    v_mfma_f32_16x16x32_bf16 v[96:99], v[20:23], a[104:107], v[96:99]
    v_mfma_f32_16x16x32_bf16 v[100:103], v[24:27], a[104:107], v[100:103]
    buffer_load_dwordx4 a[84:87], v253, s[8:11], s28 offen offset:1024 sc1
    v_mfma_f32_16x16x32_bf16 v[104:107], v[28:31], a[104:107], v[104:107]
    v_mfma_f32_16x16x32_bf16 v[108:111], v[32:35], a[104:107], v[108:111]
    buffer_load_dwordx4 a[88:91], v253, s[8:11], s28 offen offset:2048 sc1
    v_mfma_f32_16x16x32_bf16 v[112:115], a[108:111], v[16:19], v[112:115]
    v_mfma_f32_16x16x32_bf16 v[116:119], a[108:111], v[20:23], v[116:119]
    buffer_load_dwordx4 a[92:95], v253, s[8:11], s28 offen offset:3072 sc1
    v_mfma_f32_16x16x32_bf16 v[120:123], a[108:111], v[24:27], v[120:123]
    v_mfma_f32_16x16x32_bf16 v[124:127], a[108:111], v[28:31], v[124:127]
    s_add_u32 s28, s28, 4096
    v_mfma_f32_16x16x32_bf16 v[128:131], a[108:111], v[32:35], v[128:131]
    s_add_u32 m0, s79, 5120
    s_add_u32 s78, s78, s92
    buffer_load_dwordx4 v224, s[72:75], s78 offen lds
    s_waitcnt lgkmcnt(0)
    v_mfma_f32_16x16x32_bf16 v[56:59], a[112:115], v[40:43], v[56:59]
    ds_read_b128 v[16:19], v253 offset:40960
    v_mfma_f32_16x16x32_bf16 v[60:63], a[112:115], v[44:47], v[60:63]
    ds_read_b128 v[20:23], v253 offset:41984
    v_mfma_f32_16x16x32_bf16 v[64:67], a[112:115], v[48:51], v[64:67]
    ds_read_b128 v[24:27], v253 offset:43008
    v_mfma_f32_16x16x32_bf16 v[68:71], a[112:115], v[52:55], v[68:71]
    ds_read_b128 v[28:31], v253 offset:44032
    v_mfma_f32_16x16x32_bf16 v[72:75], a[116:119], v[36:39], v[72:75]
    ds_read_b128 v[32:35], v253 offset:45056
    v_mfma_f32_16x16x32_bf16 v[76:79], a[116:119], v[40:43], v[76:79]
    s_add_u32 m0, s25, 81920
    s_add_u32 s24, s24, 4096
    buffer_load_dwordx4 v2, s[8:11], s24 offen offset:0 sc1 lds
    v_mfma_f32_16x16x32_bf16 v[80:83], a[116:119], v[44:47], v[80:83]
    v_mfma_f32_16x16x32_bf16 v[84:87], a[116:119], v[48:51], v[84:87]
    s_add_u32 m0, s25, 86528
    s_nop 0
    buffer_load_dwordx4 v2, s[8:11], s24 offen offset:512 sc1 lds
    v_mfma_f32_16x16x32_bf16 v[88:91], a[116:119], v[52:55], v[88:91]
    v_mfma_f32_16x16x32_bf16 v[92:95], v[36:39], a[120:123], v[92:95]
    buffer_load_dwordx4 a[96:99], v253, s[8:11], s28 offen offset:0 sc1
    v_mfma_f32_16x16x32_bf16 v[96:99], v[40:43], a[120:123], v[96:99]
    v_mfma_f32_16x16x32_bf16 v[100:103], v[44:47], a[120:123], v[100:103]
    buffer_load_dwordx4 a[100:103], v253, s[8:11], s28 offen offset:1024 sc1
    v_mfma_f32_16x16x32_bf16 v[104:107], v[48:51], a[120:123], v[104:107]
    v_mfma_f32_16x16x32_bf16 v[108:111], v[52:55], a[120:123], v[108:111]
    buffer_load_dwordx4 a[104:107], v253, s[8:11], s28 offen offset:2048 sc1
    v_mfma_f32_16x16x32_bf16 v[112:115], a[124:127], v[36:39], v[112:115]
    v_mfma_f32_16x16x32_bf16 v[116:119], a[124:127], v[40:43], v[116:119]
    buffer_load_dwordx4 a[108:111], v253, s[8:11], s28 offen offset:3072 sc1
    v_mfma_f32_16x16x32_bf16 v[120:123], a[124:127], v[44:47], v[120:123]
    v_mfma_f32_16x16x32_bf16 v[124:127], a[124:127], v[48:51], v[124:127]
    s_add_u32 s28, s28, 4096
    v_mfma_f32_16x16x32_bf16 v[128:131], a[124:127], v[52:55], v[128:131]
    s_add_u32 m0, s79, 6144
    s_add_u32 s78, s78, s92
    buffer_load_dwordx4 v224, s[72:75], s78 offen lds
    s_waitcnt lgkmcnt(0)
    v_mfma_f32_16x16x32_bf16 v[56:59], a[128:131], v[20:23], v[56:59]
    ds_read_b128 v[36:39], v6 offset:0
    v_mfma_f32_16x16x32_bf16 v[60:63], a[128:131], v[24:27], v[60:63]
    ds_read_b128 v[40:43], v6 offset:1024
    v_mfma_f32_16x16x32_bf16 v[64:67], a[128:131], v[28:31], v[64:67]
    ds_read_b128 v[44:47], v6 offset:2048
    v_mfma_f32_16x16x32_bf16 v[68:71], a[128:131], v[32:35], v[68:71]
    ds_read_b128 v[48:51], v6 offset:3072
    v_mfma_f32_16x16x32_bf16 v[72:75], a[132:135], v[16:19], v[72:75]
    ds_read_b128 v[52:55], v6 offset:4096
    v_mfma_f32_16x16x32_bf16 v[76:79], a[132:135], v[20:23], v[76:79]
    s_add_u32 m0, s26, 61440
    s_add_u32 s7, s27, 6144
    buffer_load_dwordx4 v2, s[8:11], s7 offen sc1 lds
    v_mfma_f32_16x16x32_bf16 v[80:83], a[132:135], v[24:27], v[80:83]
    v_mfma_f32_16x16x32_bf16 v[84:87], a[132:135], v[28:31], v[84:87]
    s_add_u32 m0, s29, 61440
    s_add_u32 s7, s23, 6144
    buffer_load_dwordx4 v2, s[8:11], s7 offen sc1 lds
    v_mfma_f32_16x16x32_bf16 v[88:91], a[132:135], v[32:35], v[88:91]
    v_mfma_f32_16x16x32_bf16 v[92:95], v[16:19], a[136:139], v[92:95]
    buffer_load_dwordx4 a[112:115], v253, s[8:11], s28 offen offset:0 sc1
    v_mfma_f32_16x16x32_bf16 v[96:99], v[20:23], a[136:139], v[96:99]
    v_mfma_f32_16x16x32_bf16 v[100:103], v[24:27], a[136:139], v[100:103]
    buffer_load_dwordx4 a[116:119], v253, s[8:11], s28 offen offset:1024 sc1
    v_mfma_f32_16x16x32_bf16 v[104:107], v[28:31], a[136:139], v[104:107]
    v_mfma_f32_16x16x32_bf16 v[108:111], v[32:35], a[136:139], v[108:111]
    buffer_load_dwordx4 a[120:123], v253, s[8:11], s28 offen offset:2048 sc1
    v_mfma_f32_16x16x32_bf16 v[112:115], a[140:143], v[16:19], v[112:115]
    v_mfma_f32_16x16x32_bf16 v[116:119], a[140:143], v[20:23], v[116:119]
    buffer_load_dwordx4 a[124:127], v253, s[8:11], s28 offen offset:3072 sc1
    v_mfma_f32_16x16x32_bf16 v[120:123], a[140:143], v[24:27], v[120:123]
    v_mfma_f32_16x16x32_bf16 v[124:127], a[140:143], v[28:31], v[124:127]
    s_add_u32 s28, s28, 4096
    v_mfma_f32_16x16x32_bf16 v[128:131], a[140:143], v[32:35], v[128:131]
    s_add_u32 m0, s79, 7168
    s_add_u32 s78, s78, s92
    buffer_load_dwordx4 v224, s[72:75], s78 offen lds
    s_waitcnt vmcnt(29) lgkmcnt(0)
    v_cmp_eq_u32 vcc, s76, v225
    s_cmp_eq_u64 vcc, exec
    s_cbranch_scc1 L_wo_ready_14
    s_mov_b32 s6, 0
L_spin_15:
    buffer_load_dword v1, v226, s[8:11], s39 offen sc1
    s_add_u32 s6, s6, 1
    s_waitcnt vmcnt(0)
    v_cmp_eq_u32 vcc, s76, v1
    s_cmp_eq_u64 vcc, exec
    s_cbranch_scc1 L_spun_16
    s_cmp_lt_u32 s6, 1048576
    s_cbranch_scc1 L_spin_15
    s_branch L_main_end
L_spun_16:
L_wo_ready_14:
    v_mfma_f32_16x16x32_bf16 v[56:59], a[144:147], v[40:43], v[56:59]
    ds_read_b128 v[16:19], v6 offset:5120
    v_mfma_f32_16x16x32_bf16 v[60:63], a[144:147], v[44:47], v[60:63]
    ds_read_b128 v[20:23], v6 offset:6144
    v_mfma_f32_16x16x32_bf16 v[64:67], a[144:147], v[48:51], v[64:67]
    ds_read_b128 v[24:27], v6 offset:7168
    v_mfma_f32_16x16x32_bf16 v[68:71], a[144:147], v[52:55], v[68:71]
    ds_read_b128 v[28:31], v6 offset:8192
    v_mfma_f32_16x16x32_bf16 v[72:75], a[148:151], v[36:39], v[72:75]
    ds_read_b128 v[32:35], v6 offset:9216
    v_mfma_f32_16x16x32_bf16 v[76:79], a[148:151], v[40:43], v[76:79]
    buffer_load_dwordx4 a[160:163], v253, s[8:11], s32 offen offset:0 sc1
    v_mfma_f32_16x16x32_bf16 v[80:83], a[148:151], v[44:47], v[80:83]
    v_mfma_f32_16x16x32_bf16 v[84:87], a[148:151], v[48:51], v[84:87]
    buffer_load_dwordx4 a[164:167], v253, s[8:11], s33 offen offset:0 sc1
    v_mfma_f32_16x16x32_bf16 v[88:91], a[148:151], v[52:55], v[88:91]
    v_mfma_f32_16x16x32_bf16 v[92:95], v[36:39], a[152:155], v[92:95]
    buffer_load_dwordx4 a[168:171], v5, s[8:11], s34 offen offset:0 sc1
    v_mfma_f32_16x16x32_bf16 v[96:99], v[40:43], a[152:155], v[96:99]
    v_mfma_f32_16x16x32_bf16 v[100:103], v[44:47], a[152:155], v[100:103]
    buffer_load_dwordx4 a[172:175], v253, s[8:11], s32 offen offset:1024 sc1
    v_mfma_f32_16x16x32_bf16 v[104:107], v[48:51], a[152:155], v[104:107]
    v_mfma_f32_16x16x32_bf16 v[108:111], v[52:55], a[152:155], v[108:111]
    v_mfma_f32_16x16x32_bf16 v[112:115], a[156:159], v[36:39], v[112:115]
    v_mfma_f32_16x16x32_bf16 v[116:119], a[156:159], v[40:43], v[116:119]
    v_mfma_f32_16x16x32_bf16 v[120:123], a[156:159], v[44:47], v[120:123]
    v_mfma_f32_16x16x32_bf16 v[124:127], a[156:159], v[48:51], v[124:127]
    v_mfma_f32_16x16x32_bf16 v[128:131], a[156:159], v[52:55], v[128:131]
    s_add_u32 m0, s79, 8192
    s_mov_b32 s78, s82
    buffer_load_dwordx4 v224, s[72:75], s78 offen lds
    s_waitcnt vmcnt(54) lgkmcnt(0)
    v_mfma_f32_16x16x32_bf16 v[56:59], a[0:3], v[20:23], v[56:59]
    ds_read_b128 v[36:39], v6 offset:10240
    v_mfma_f32_16x16x32_bf16 v[60:63], a[0:3], v[24:27], v[60:63]
    ds_read_b128 v[40:43], v6 offset:11264
    v_mfma_f32_16x16x32_bf16 v[64:67], a[0:3], v[28:31], v[64:67]
    ds_read_b128 v[44:47], v6 offset:12288
    v_mfma_f32_16x16x32_bf16 v[68:71], a[0:3], v[32:35], v[68:71]
    ds_read_b128 v[48:51], v6 offset:13312
    v_mfma_f32_16x16x32_bf16 v[72:75], a[4:7], v[16:19], v[72:75]
    ds_read_b128 v[52:55], v6 offset:14336
    v_mfma_f32_16x16x32_bf16 v[76:79], a[4:7], v[20:23], v[76:79]
    buffer_load_dwordx4 a[176:179], v253, s[8:11], s33 offen offset:1024 sc1
    v_mfma_f32_16x16x32_bf16 v[80:83], a[4:7], v[24:27], v[80:83]
    v_mfma_f32_16x16x32_bf16 v[84:87], a[4:7], v[28:31], v[84:87]
    buffer_load_dwordx4 a[180:183], v5, s[8:11], s34 offen offset:1024 sc1
    v_mfma_f32_16x16x32_bf16 v[88:91], a[4:7], v[32:35], v[88:91]
    v_mfma_f32_16x16x32_bf16 v[92:95], v[16:19], a[8:11], v[92:95]
    buffer_load_dwordx4 a[184:187], v253, s[8:11], s32 offen offset:2048 sc1
    v_mfma_f32_16x16x32_bf16 v[96:99], v[20:23], a[8:11], v[96:99]
    v_mfma_f32_16x16x32_bf16 v[100:103], v[24:27], a[8:11], v[100:103]
    buffer_load_dwordx4 a[188:191], v253, s[8:11], s33 offen offset:2048 sc1
    v_mfma_f32_16x16x32_bf16 v[104:107], v[28:31], a[8:11], v[104:107]
    v_mfma_f32_16x16x32_bf16 v[108:111], v[32:35], a[8:11], v[108:111]
    v_mfma_f32_16x16x32_bf16 v[112:115], a[12:15], v[16:19], v[112:115]
    v_mfma_f32_16x16x32_bf16 v[116:119], a[12:15], v[20:23], v[116:119]
    v_mfma_f32_16x16x32_bf16 v[120:123], a[12:15], v[24:27], v[120:123]
    v_mfma_f32_16x16x32_bf16 v[124:127], a[12:15], v[28:31], v[124:127]
    v_mfma_f32_16x16x32_bf16 v[128:131], a[12:15], v[32:35], v[128:131]
    s_add_u32 m0, s79, 9216
    s_add_u32 s78, s78, s92
    buffer_load_dwordx4 v224, s[72:75], s78 offen lds
    s_waitcnt vmcnt(15) lgkmcnt(0)
    s_barrier
    v_mfma_f32_16x16x32_bf16 v[56:59], a[16:19], v[40:43], v[56:59]
    ds_read_b128 v[16:19], v6 offset:15360
    v_mfma_f32_16x16x32_bf16 v[60:63], a[16:19], v[44:47], v[60:63]
    ds_read_b128 v[20:23], v6 offset:16384
    v_mfma_f32_16x16x32_bf16 v[64:67], a[16:19], v[48:51], v[64:67]
    ds_read_b128 v[24:27], v6 offset:17408
    v_mfma_f32_16x16x32_bf16 v[68:71], a[16:19], v[52:55], v[68:71]
    ds_read_b128 v[28:31], v6 offset:18432
    v_mfma_f32_16x16x32_bf16 v[72:75], a[20:23], v[36:39], v[72:75]
    ds_read_b128 v[32:35], v6 offset:19456
    v_mfma_f32_16x16x32_bf16 v[76:79], a[20:23], v[40:43], v[76:79]
    buffer_load_dwordx4 a[192:195], v5, s[8:11], s34 offen offset:2048 sc1
    v_mfma_f32_16x16x32_bf16 v[80:83], a[20:23], v[44:47], v[80:83]
    v_mfma_f32_16x16x32_bf16 v[84:87], a[20:23], v[48:51], v[84:87]
    buffer_load_dwordx4 a[196:199], v253, s[8:11], s32 offen offset:3072 sc1
    s_add_u32 s32, s32, 4096
    v_mfma_f32_16x16x32_bf16 v[88:91], a[20:23], v[52:55], v[88:91]
    v_mfma_f32_16x16x32_bf16 v[92:95], v[36:39], a[24:27], v[92:95]
    buffer_load_dwordx4 a[200:203], v253, s[8:11], s33 offen offset:3072 sc1
    s_add_u32 s33, s33, 4096
    v_mfma_f32_16x16x32_bf16 v[96:99], v[40:43], a[24:27], v[96:99]
    v_mfma_f32_16x16x32_bf16 v[100:103], v[44:47], a[24:27], v[100:103]
    buffer_load_dwordx4 a[204:207], v5, s[8:11], s34 offen offset:3072 sc1
    s_add_u32 s34, s34, 4096
    v_mfma_f32_16x16x32_bf16 v[104:107], v[48:51], a[24:27], v[104:107]
    v_mfma_f32_16x16x32_bf16 v[108:111], v[52:55], a[24:27], v[108:111]
    v_mfma_f32_16x16x32_bf16 v[112:115], a[28:31], v[36:39], v[112:115]
    v_mfma_f32_16x16x32_bf16 v[116:119], a[28:31], v[40:43], v[116:119]
    v_mfma_f32_16x16x32_bf16 v[120:123], a[28:31], v[44:47], v[120:123]
    v_mfma_f32_16x16x32_bf16 v[124:127], a[28:31], v[48:51], v[124:127]
    v_mfma_f32_16x16x32_bf16 v[128:131], a[28:31], v[52:55], v[128:131]
    s_add_u32 m0, s79, 10240
    s_add_u32 s78, s78, s92
    buffer_load_dwordx4 v224, s[72:75], s78 offen lds
    s_waitcnt vmcnt(50) lgkmcnt(0)
    v_mfma_f32_16x16x32_bf16 v[56:59], a[32:35], v[20:23], v[56:59]
    ds_read_b128 v[36:39], v6 offset:20480
    v_mfma_f32_16x16x32_bf16 v[60:63], a[32:35], v[24:27], v[60:63]
    ds_read_b128 v[40:43], v6 offset:21504
    v_mfma_f32_16x16x32_bf16 v[64:67], a[32:35], v[28:31], v[64:67]
    ds_read_b128 v[44:47], v6 offset:22528
    v_mfma_f32_16x16x32_bf16 v[68:71], a[32:35], v[32:35], v[68:71]
    ds_read_b128 v[48:51], v6 offset:23552
    v_mfma_f32_16x16x32_bf16 v[72:75], a[36:39], v[16:19], v[72:75]
    ds_read_b128 v[52:55], v6 offset:24576
    v_mfma_f32_16x16x32_bf16 v[76:79], a[36:39], v[20:23], v[76:79]
    buffer_load_dwordx4 a[208:211], v253, s[8:11], s32 offen offset:0 sc1
    v_mfma_f32_16x16x32_bf16 v[80:83], a[36:39], v[24:27], v[80:83]
    v_mfma_f32_16x16x32_bf16 v[84:87], a[36:39], v[28:31], v[84:87]
    buffer_load_dwordx4 a[212:215], v253, s[8:11], s33 offen offset:0 sc1
    v_mfma_f32_16x16x32_bf16 v[88:91], a[36:39], v[32:35], v[88:91]
    v_mfma_f32_16x16x32_bf16 v[92:95], v[16:19], a[40:43], v[92:95]
    buffer_load_dwordx4 a[216:219], v5, s[8:11], s34 offen offset:0 sc1
    v_mfma_f32_16x16x32_bf16 v[96:99], v[20:23], a[40:43], v[96:99]
    v_mfma_f32_16x16x32_bf16 v[100:103], v[24:27], a[40:43], v[100:103]
    buffer_load_dwordx4 a[220:223], v253, s[8:11], s32 offen offset:1024 sc1
    v_mfma_f32_16x16x32_bf16 v[104:107], v[28:31], a[40:43], v[104:107]
    v_mfma_f32_16x16x32_bf16 v[108:111], v[32:35], a[40:43], v[108:111]
    v_mfma_f32_16x16x32_bf16 v[112:115], a[44:47], v[16:19], v[112:115]
    v_mfma_f32_16x16x32_bf16 v[116:119], a[44:47], v[20:23], v[116:119]
    v_mfma_f32_16x16x32_bf16 v[120:123], a[44:47], v[24:27], v[120:123]
    v_mfma_f32_16x16x32_bf16 v[124:127], a[44:47], v[28:31], v[124:127]
    v_mfma_f32_16x16x32_bf16 v[128:131], a[44:47], v[32:35], v[128:131]
    s_add_u32 m0, s79, 11264
    s_add_u32 s78, s78, s92
    buffer_load_dwordx4 v224, s[72:75], s78 offen lds
    s_waitcnt vmcnt(50) lgkmcnt(0)
    v_mfma_f32_16x16x32_bf16 v[56:59], a[48:51], v[40:43], v[56:59]
    ds_read_b128 v[16:19], v6 offset:25600
    v_mfma_f32_16x16x32_bf16 v[60:63], a[48:51], v[44:47], v[60:63]
    ds_read_b128 v[20:23], v6 offset:26624
    v_mfma_f32_16x16x32_bf16 v[64:67], a[48:51], v[48:51], v[64:67]
    ds_read_b128 v[24:27], v6 offset:27648
    v_mfma_f32_16x16x32_bf16 v[68:71], a[48:51], v[52:55], v[68:71]
    ds_read_b128 v[28:31], v6 offset:28672
    v_mfma_f32_16x16x32_bf16 v[72:75], a[52:55], v[36:39], v[72:75]
    ds_read_b128 v[32:35], v6 offset:29696
    v_mfma_f32_16x16x32_bf16 v[76:79], a[52:55], v[40:43], v[76:79]
    buffer_load_dwordx4 a[224:227], v253, s[8:11], s33 offen offset:1024 sc1
    v_mfma_f32_16x16x32_bf16 v[80:83], a[52:55], v[44:47], v[80:83]
    v_mfma_f32_16x16x32_bf16 v[84:87], a[52:55], v[48:51], v[84:87]
    buffer_load_dwordx4 a[228:231], v5, s[8:11], s34 offen offset:1024 sc1
    v_mfma_f32_16x16x32_bf16 v[88:91], a[52:55], v[52:55], v[88:91]
    v_mfma_f32_16x16x32_bf16 v[92:95], v[36:39], a[56:59], v[92:95]
    buffer_load_dwordx4 a[232:235], v253, s[8:11], s32 offen offset:2048 sc1
    v_mfma_f32_16x16x32_bf16 v[96:99], v[40:43], a[56:59], v[96:99]
    v_mfma_f32_16x16x32_bf16 v[100:103], v[44:47], a[56:59], v[100:103]
    buffer_load_dwordx4 a[236:239], v253, s[8:11], s33 offen offset:2048 sc1
    v_mfma_f32_16x16x32_bf16 v[104:107], v[48:51], a[56:59], v[104:107]
    v_mfma_f32_16x16x32_bf16 v[108:111], v[52:55], a[56:59], v[108:111]
    v_mfma_f32_16x16x32_bf16 v[112:115], a[60:63], v[36:39], v[112:115]
    v_mfma_f32_16x16x32_bf16 v[116:119], a[60:63], v[40:43], v[116:119]
    v_mfma_f32_16x16x32_bf16 v[120:123], a[60:63], v[44:47], v[120:123]
    v_mfma_f32_16x16x32_bf16 v[124:127], a[60:63], v[48:51], v[124:127]
    v_mfma_f32_16x16x32_bf16 v[128:131], a[60:63], v[52:55], v[128:131]
    s_add_u32 m0, s79, 12288
    s_mov_b32 s78, s83
    buffer_load_dwordx4 v224, s[72:75], s78 offen lds
    s_waitcnt vmcnt(47) lgkmcnt(0)
    v_mfma_f32_16x16x32_bf16 v[56:59], a[64:67], v[20:23], v[56:59]
    ds_read_b128 v[36:39], v6 offset:30720
    v_mfma_f32_16x16x32_bf16 v[60:63], a[64:67], v[24:27], v[60:63]
    ds_read_b128 v[40:43], v6 offset:31744
    v_mfma_f32_16x16x32_bf16 v[64:67], a[64:67], v[28:31], v[64:67]
    ds_read_b128 v[44:47], v6 offset:32768
    v_mfma_f32_16x16x32_bf16 v[68:71], a[64:67], v[32:35], v[68:71]
    ds_read_b128 v[48:51], v6 offset:33792
    v_mfma_f32_16x16x32_bf16 v[72:75], a[68:71], v[16:19], v[72:75]
    ds_read_b128 v[52:55], v6 offset:34816
    v_mfma_f32_16x16x32_bf16 v[76:79], a[68:71], v[20:23], v[76:79]
    buffer_load_dwordx4 a[240:243], v5, s[8:11], s34 offen offset:2048 sc1
    v_mfma_f32_16x16x32_bf16 v[80:83], a[68:71], v[24:27], v[80:83]
    v_mfma_f32_16x16x32_bf16 v[84:87], a[68:71], v[28:31], v[84:87]
    buffer_load_dwordx4 a[244:247], v253, s[8:11], s32 offen offset:3072 sc1
    s_add_u32 s32, s32, 4096
    v_mfma_f32_16x16x32_bf16 v[88:91], a[68:71], v[32:35], v[88:91]
    v_mfma_f32_16x16x32_bf16 v[92:95], v[16:19], a[72:75], v[92:95]
    buffer_load_dwordx4 a[248:251], v253, s[8:11], s33 offen offset:3072 sc1
    s_add_u32 s33, s33, 4096
    v_mfma_f32_16x16x32_bf16 v[96:99], v[20:23], a[72:75], v[96:99]
    v_mfma_f32_16x16x32_bf16 v[100:103], v[24:27], a[72:75], v[100:103]
    buffer_load_dwordx4 a[252:255], v5, s[8:11], s34 offen offset:3072 sc1
    s_add_u32 s34, s34, 4096
    v_mfma_f32_16x16x32_bf16 v[104:107], v[28:31], a[72:75], v[104:107]
    v_mfma_f32_16x16x32_bf16 v[108:111], v[32:35], a[72:75], v[108:111]
    v_mfma_f32_16x16x32_bf16 v[112:115], a[76:79], v[16:19], v[112:115]
    v_mfma_f32_16x16x32_bf16 v[116:119], a[76:79], v[20:23], v[116:119]
    v_mfma_f32_16x16x32_bf16 v[120:123], a[76:79], v[24:27], v[120:123]
    v_mfma_f32_16x16x32_bf16 v[124:127], a[76:79], v[28:31], v[124:127]
    v_mfma_f32_16x16x32_bf16 v[128:131], a[76:79], v[32:35], v[128:131]
    s_add_u32 m0, s79, 13312
    s_add_u32 s78, s78, s92
    buffer_load_dwordx4 v224, s[72:75], s78 offen lds
    s_waitcnt vmcnt(45) lgkmcnt(0)
    v_mfma_f32_16x16x32_bf16 v[56:59], a[80:83], v[40:43], v[56:59]
    ds_read_b128 v[16:19], v6 offset:35840
    v_mfma_f32_16x16x32_bf16 v[60:63], a[80:83], v[44:47], v[60:63]
    ds_read_b128 v[20:23], v6 offset:36864
    v_mfma_f32_16x16x32_bf16 v[64:67], a[80:83], v[48:51], v[64:67]
    ds_read_b128 v[24:27], v6 offset:37888
    v_mfma_f32_16x16x32_bf16 v[68:71], a[80:83], v[52:55], v[68:71]
    ds_read_b128 v[28:31], v6 offset:38912
    v_mfma_f32_16x16x32_bf16 v[72:75], a[84:87], v[36:39], v[72:75]
    ds_read_b128 v[32:35], v6 offset:39936
    v_mfma_f32_16x16x32_bf16 v[76:79], a[84:87], v[40:43], v[76:79]
    buffer_load_dwordx4 a[128:131], v253, s[8:11], s32 offen offset:0 sc1
    v_mfma_f32_16x16x32_bf16 v[80:83], a[84:87], v[44:47], v[80:83]
    v_mfma_f32_16x16x32_bf16 v[84:87], a[84:87], v[48:51], v[84:87]
    buffer_load_dwordx4 a[132:135], v253, s[8:11], s33 offen offset:0 sc1
    v_mfma_f32_16x16x32_bf16 v[88:91], a[84:87], v[52:55], v[88:91]
    v_mfma_f32_16x16x32_bf16 v[92:95], v[36:39], a[88:91], v[92:95]
    buffer_load_dwordx4 a[136:139], v5, s[8:11], s34 offen offset:0 sc1
    v_mfma_f32_16x16x32_bf16 v[96:99], v[40:43], a[88:91], v[96:99]
    v_mfma_f32_16x16x32_bf16 v[100:103], v[44:47], a[88:91], v[100:103]
    buffer_load_dwordx4 a[140:143], v253, s[8:11], s32 offen offset:1024 sc1
    v_mfma_f32_16x16x32_bf16 v[104:107], v[48:51], a[88:91], v[104:107]
    v_mfma_f32_16x16x32_bf16 v[108:111], v[52:55], a[88:91], v[108:111]
    v_mfma_f32_16x16x32_bf16 v[112:115], a[92:95], v[36:39], v[112:115]
    v_mfma_f32_16x16x32_bf16 v[116:119], a[92:95], v[40:43], v[116:119]
    v_mfma_f32_16x16x32_bf16 v[120:123], a[92:95], v[44:47], v[120:123]
    v_mfma_f32_16x16x32_bf16 v[124:127], a[92:95], v[48:51], v[124:127]
    v_mfma_f32_16x16x32_bf16 v[128:131], a[92:95], v[52:55], v[128:131]
    s_add_u32 m0, s79, 14336
    s_add_u32 s78, s78, s92
    buffer_load_dwordx4 v224, s[72:75], s78 offen lds
    s_waitcnt vmcnt(43) lgkmcnt(0)
    v_mfma_f32_16x16x32_bf16 v[56:59], a[96:99], v[20:23], v[56:59]
    ds_read_b128 v[36:39], v6 offset:40960
    v_mfma_f32_16x16x32_bf16 v[60:63], a[96:99], v[24:27], v[60:63]
    ds_read_b128 v[40:43], v6 offset:41984
    v_mfma_f32_16x16x32_bf16 v[64:67], a[96:99], v[28:31], v[64:67]
    ds_read_b128 v[44:47], v6 offset:43008
    v_mfma_f32_16x16x32_bf16 v[68:71], a[96:99], v[32:35], v[68:71]
    ds_read_b128 v[48:51], v6 offset:44032
    v_mfma_f32_16x16x32_bf16 v[72:75], a[100:103], v[16:19], v[72:75]
    ds_read_b128 v[52:55], v6 offset:45056
    v_mfma_f32_16x16x32_bf16 v[76:79], a[100:103], v[20:23], v[76:79]
    buffer_load_dwordx4 a[144:147], v253, s[8:11], s33 offen offset:1024 sc1
    v_mfma_f32_16x16x32_bf16 v[80:83], a[100:103], v[24:27], v[80:83]
    v_mfma_f32_16x16x32_bf16 v[84:87], a[100:103], v[28:31], v[84:87]
    buffer_load_dwordx4 a[148:151], v5, s[8:11], s34 offen offset:1024 sc1
    v_mfma_f32_16x16x32_bf16 v[88:91], a[100:103], v[32:35], v[88:91]
    v_mfma_f32_16x16x32_bf16 v[92:95], v[16:19], a[104:107], v[92:95]
    buffer_load_dwordx4 a[152:155], v253, s[8:11], s32 offen offset:2048 sc1
    v_mfma_f32_16x16x32_bf16 v[96:99], v[20:23], a[104:107], v[96:99]
    v_mfma_f32_16x16x32_bf16 v[100:103], v[24:27], a[104:107], v[100:103]
    buffer_load_dwordx4 a[156:159], v253, s[8:11], s33 offen offset:2048 sc1
    v_mfma_f32_16x16x32_bf16 v[104:107], v[28:31], a[104:107], v[104:107]
    v_mfma_f32_16x16x32_bf16 v[108:111], v[32:35], a[104:107], v[108:111]
    v_mfma_f32_16x16x32_bf16 v[112:115], a[108:111], v[16:19], v[112:115]
    v_mfma_f32_16x16x32_bf16 v[116:119], a[108:111], v[20:23], v[116:119]
    v_mfma_f32_16x16x32_bf16 v[120:123], a[108:111], v[24:27], v[120:123]
    v_mfma_f32_16x16x32_bf16 v[124:127], a[108:111], v[28:31], v[124:127]
    v_mfma_f32_16x16x32_bf16 v[128:131], a[108:111], v[32:35], v[128:131]
    s_add_u32 m0, s79, 15360
    s_add_u32 s78, s78, s92
    buffer_load_dwordx4 v224, s[72:75], s78 offen lds
    s_waitcnt vmcnt(41) lgkmcnt(0)
    v_mfma_f32_16x16x32_bf16 v[56:59], a[112:115], v[40:43], v[56:59]
    v_mfma_f32_16x16x32_bf16 v[60:63], a[112:115], v[44:47], v[60:63]
    v_mfma_f32_16x16x32_bf16 v[64:67], a[112:115], v[48:51], v[64:67]
    v_mfma_f32_16x16x32_bf16 v[68:71], a[112:115], v[52:55], v[68:71]
    v_mfma_f32_16x16x32_bf16 v[72:75], a[116:119], v[36:39], v[72:75]
    v_mfma_f32_16x16x32_bf16 v[76:79], a[116:119], v[40:43], v[76:79]
    buffer_load_dwordx4 a[0:3], v5, s[8:11], s34 offen offset:2048 sc1
    v_mfma_f32_16x16x32_bf16 v[80:83], a[116:119], v[44:47], v[80:83]
    v_mfma_f32_16x16x32_bf16 v[84:87], a[116:119], v[48:51], v[84:87]
    buffer_load_dwordx4 a[4:7], v253, s[8:11], s32 offen offset:3072 sc1
    s_add_u32 s32, s32, 4096
    v_mfma_f32_16x16x32_bf16 v[88:91], a[116:119], v[52:55], v[88:91]
    v_mfma_f32_16x16x32_bf16 v[92:95], v[36:39], a[120:123], v[92:95]
    buffer_load_dwordx4 a[8:11], v253, s[8:11], s33 offen offset:3072 sc1
    s_add_u32 s33, s33, 4096
    v_mfma_f32_16x16x32_bf16 v[96:99], v[40:43], a[120:123], v[96:99]
    v_mfma_f32_16x16x32_bf16 v[100:103], v[44:47], a[120:123], v[100:103]
    buffer_load_dwordx4 a[12:15], v5, s[8:11], s34 offen offset:3072 sc1
    s_add_u32 s34, s34, 4096
    v_mfma_f32_16x16x32_bf16 v[104:107], v[48:51], a[120:123], v[104:107]
    v_mfma_f32_16x16x32_bf16 v[108:111], v[52:55], a[120:123], v[108:111]
    v_mfma_f32_16x16x32_bf16 v[112:115], a[124:127], v[36:39], v[112:115]
    v_mfma_f32_16x16x32_bf16 v[116:119], a[124:127], v[40:43], v[116:119]
    v_mfma_f32_16x16x32_bf16 v[120:123], a[124:127], v[44:47], v[120:123]
    v_mfma_f32_16x16x32_bf16 v[124:127], a[124:127], v[48:51], v[124:127]
    v_mfma_f32_16x16x32_bf16 v[128:131], a[124:127], v[52:55], v[128:131]
    v_cvt_pk_bf16_f32 v136, v56, v57
    v_cvt_pk_bf16_f32 v137, v58, v59
    v_cvt_pk_bf16_f32 v140, v60, v61
    v_cvt_pk_bf16_f32 v141, v62, v63
    v_cvt_pk_bf16_f32 v144, v64, v65
    v_cvt_pk_bf16_f32 v145, v66, v67
    v_cvt_pk_bf16_f32 v148, v68, v69
    v_cvt_pk_bf16_f32 v149, v70, v71
    v_cvt_pk_bf16_f32 v152, v72, v73
    v_cvt_pk_bf16_f32 v153, v74, v75
    buffer_load_dwordx4 a[16:19], v253, s[8:11], s32 offen offset:0 sc1
    v_cvt_pk_bf16_f32 v156, v76, v77
    v_cvt_pk_bf16_f32 v157, v78, v79
    v_cvt_pk_bf16_f32 v160, v80, v81
    v_cvt_pk_bf16_f32 v161, v82, v83
    v_cvt_pk_bf16_f32 v164, v84, v85
    v_cvt_pk_bf16_f32 v165, v86, v87
    v_cvt_pk_bf16_f32 v168, v88, v89
    v_cvt_pk_bf16_f32 v169, v90, v91
    v_cvt_pk_bf16_f32 v134, v112, v113
    v_cvt_pk_bf16_f32 v154, v114, v115
    buffer_load_dwordx4 a[20:23], v253, s[8:11], s33 offen offset:0 sc1
    v_cvt_pk_bf16_f32 v138, v116, v117
    v_cvt_pk_bf16_f32 v158, v118, v119
    v_cvt_pk_bf16_f32 v142, v120, v121
    v_cvt_pk_bf16_f32 v162, v122, v123
    v_cvt_pk_bf16_f32 v146, v124, v125
    v_cvt_pk_bf16_f32 v166, v126, v127
    v_cvt_pk_bf16_f32 v150, v128, v129
    v_cvt_pk_bf16_f32 v170, v130, v131
    v_cvt_pk_bf16_f32 v172, v92, v93
    v_cvt_pk_bf16_f32 v173, v94, v95
    buffer_load_dwordx4 a[24:27], v5, s[8:11], s34 offen offset:0 sc1
    v_cvt_pk_bf16_f32 v174, v96, v97
    v_cvt_pk_bf16_f32 v175, v98, v99
    v_cvt_pk_bf16_f32 v176, v100, v101
    v_cvt_pk_bf16_f32 v177, v102, v103
    v_cvt_pk_bf16_f32 v178, v104, v105
    v_cvt_pk_bf16_f32 v179, v106, v107
    v_cvt_pk_bf16_f32 v180, v108, v109
    v_cvt_pk_bf16_f32 v181, v110, v111
    v_mfma_f32_16x16x32_bf16 v[16:19], v[152:155], v[136:139], v[208:211]
    v_mfma_f32_16x16x32_bf16 v[20:23], v[156:159], v[136:139], v[204:207]
    buffer_load_dwordx4 a[28:31], v253, s[8:11], s32 offen offset:1024 sc1
    v_mfma_f32_16x16x32_bf16 v[24:27], v[156:159], v[140:143], v[200:203]
    v_mfma_f32_16x16x32_bf16 v[28:31], v[160:163], v[140:143], v[204:207]
    v_mfma_f32_16x16x32_bf16 v[32:35], v[160:163], v[144:147], v[200:203]
    v_mfma_f32_16x16x32_bf16 v[36:39], v[164:167], v[144:147], v[204:207]
    v_mfma_f32_16x16x32_bf16 v[40:43], v[164:167], v[148:151], v[200:203]
    v_mfma_f32_16x16x32_bf16 v[44:47], v[168:171], v[148:151], v[204:207]
    v_mfma_f32_16x16x32_bf16 v[56:59], v[132:135], v[192:195], v[196:199]
    v_mfma_f32_16x16x32_bf16 v[60:63], v[136:139], v[192:195], v[196:199]
    v_mfma_f32_16x16x32_bf16 v[64:67], v[140:143], v[192:195], v[196:199]
    v_mfma_f32_16x16x32_bf16 v[68:71], v[144:147], v[192:195], v[196:199]
    buffer_load_dwordx4 a[32:35], v253, s[8:11], s33 offen offset:1024 sc1
    v_mfma_f32_16x16x32_bf16 v[72:75], v[148:151], v[192:195], v[196:199]
    v_max3_f32 v92, v16, v17, v18
    v_max3_f32 v96, v19, v20, v21
    v_max3_f32 v93, v24, v25, v26
    v_max3_f32 v97, v27, v28, v29
    v_max3_f32 v94, v32, v33, v34
    v_max3_f32 v98, v35, v36, v37
    v_max3_f32 v95, v40, v41, v42
    v_max3_f32 v99, v43, v44, v45
    v_max3_f32 v92, v92, v22, v23
    buffer_load_dwordx4 a[36:39], v5, s[8:11], s34 offen offset:1024 sc1
    v_max3_f32 v93, v93, v30, v31
    v_max3_f32 v94, v94, v38, v39
    v_max3_f32 v95, v95, v46, v47
    v_max_f32 v92, v92, v96
    v_max_f32 v93, v93, v97
    v_max_f32 v94, v94, v98
    v_max_f32 v95, v95, v99
    s_mov_b32 s18, 0x3eae1a93
    v_cvt_pk_bf16_f32 v182, v56, v57
    v_permlane32_swap_b32 v92, v93
    buffer_load_dwordx4 a[40:43], v253, s[8:11], s32 offen offset:2048 sc1
    v_permlane32_swap_b32 v94, v95
    v_max_f32 v92, v92, v93
    v_max_f32 v94, v94, v95
    v_cvt_pk_bf16_f32 v183, v58, v59
    v_cvt_pk_bf16_f32 v184, v60, v61
    v_permlane16_swap_b32 v92, v94
    v_max_f32 v92, v92, v94
    v_mul_f32 v92, 0xbeae1a93, v92
    v_mov_b32 v94, v92
    v_cvt_pk_bf16_f32 v185, v62, v63
    buffer_load_dwordx4 a[44:47], v253, s[8:11], s33 offen offset:2048 sc1
    v_cvt_pk_bf16_f32 v186, v64, v65
    v_permlane16_swap_b32 v92, v94
    v_mov_b32 v93, v92
    v_mov_b32 v95, v94
    v_cvt_pk_bf16_f32 v187, v66, v67
    v_cvt_pk_bf16_f32 v188, v68, v69
    v_permlane32_swap_b32 v92, v93
    v_permlane32_swap_b32 v94, v95
    v_cvt_pk_bf16_f32 v189, v70, v71
    v_cvt_pk_bf16_f32 v190, v72, v73
    buffer_load_dwordx4 a[48:51], v5, s[8:11], s34 offen offset:2048 sc1
    v_cvt_pk_bf16_f32 v191, v74, v75
    v_fma_f32 v16, v16, s18, v92
    v_fma_f32 v17, v17, s18, v92
    v_fma_f32 v18, v18, s18, v92
    v_fma_f32 v19, v19, s18, v92
    v_fma_f32 v20, v20, s18, v92
    v_fma_f32 v21, v21, s18, v92
    v_fma_f32 v22, v22, s18, v92
    v_fma_f32 v23, v23, s18, v92
    v_exp_f32 v16, v16
    buffer_load_dwordx4 a[52:55], v253, s[8:11], s32 offen offset:3072 sc1
    s_add_u32 s32, s32, 4096
    v_exp_f32 v17, v17
    v_exp_f32 v18, v18
    v_exp_f32 v19, v19
    v_exp_f32 v20, v20
    v_exp_f32 v21, v21
    v_exp_f32 v22, v22
    v_exp_f32 v23, v23
    s_nop 0
    v_cvt_pk_bf16_f32 v76, v16, v17
    v_cvt_pk_bf16_f32 v77, v18, v19
    buffer_load_dwordx4 a[56:59], v253, s[8:11], s33 offen offset:3072 sc1
    s_add_u32 s33, s33, 4096
    v_cvt_pk_bf16_f32 v78, v20, v21
    v_cvt_pk_bf16_f32 v79, v22, v23
    v_fma_f32 v24, v24, s18, v93
    v_fma_f32 v25, v25, s18, v93
    v_fma_f32 v26, v26, s18, v93
    v_fma_f32 v27, v27, s18, v93
    v_fma_f32 v28, v28, s18, v93
    v_fma_f32 v29, v29, s18, v93
    v_fma_f32 v30, v30, s18, v93
    v_fma_f32 v31, v31, s18, v93
    buffer_load_dwordx4 a[60:63], v5, s[8:11], s34 offen offset:3072 sc1
    s_add_u32 s34, s34, 4096
    v_exp_f32 v24, v24
    v_exp_f32 v25, v25
    v_exp_f32 v26, v26
    v_exp_f32 v27, v27
    v_exp_f32 v28, v28
    v_exp_f32 v29, v29
    v_exp_f32 v30, v30
    v_exp_f32 v31, v31
    v_mfma_f32_16x16x32_bf16 v[100:103], v[172:175], v[76:79], 0
    v_mfma_f32_16x16x32_bf16 v[116:119], v[182:185], v[76:79], 0
    buffer_load_dwordx4 a[64:67], v253, s[8:11], s32 offen offset:0 sc1
    v_cvt_pk_bf16_f32 v80, v24, v25
    v_cvt_pk_bf16_f32 v81, v26, v27
    v_cvt_pk_bf16_f32 v82, v28, v29
    v_cvt_pk_bf16_f32 v83, v30, v31
    v_fma_f32 v32, v32, s18, v94
    v_fma_f32 v33, v33, s18, v94
    v_fma_f32 v34, v34, s18, v94
    v_fma_f32 v35, v35, s18, v94
    v_fma_f32 v36, v36, s18, v94
    v_fma_f32 v37, v37, s18, v94
    buffer_load_dwordx4 a[68:71], v253, s[8:11], s33 offen offset:0 sc1
    v_fma_f32 v38, v38, s18, v94
    v_fma_f32 v39, v39, s18, v94
    v_exp_f32 v32, v32
    v_exp_f32 v33, v33
    v_exp_f32 v34, v34
    v_exp_f32 v35, v35
    v_exp_f32 v36, v36
    v_exp_f32 v37, v37
    v_exp_f32 v38, v38
    v_exp_f32 v39, v39
    buffer_load_dwordx4 a[72:75], v5, s[8:11], s34 offen offset:0 sc1
    v_mfma_f32_16x16x32_bf16 v[104:107], v[174:177], v[80:83], 0
    v_mfma_f32_16x16x32_bf16 v[120:123], v[184:187], v[80:83], 0
    v_cvt_pk_bf16_f32 v84, v32, v33
    v_cvt_pk_bf16_f32 v85, v34, v35
    v_cvt_pk_bf16_f32 v86, v36, v37
    v_cvt_pk_bf16_f32 v87, v38, v39
    v_fma_f32 v40, v40, s18, v95
    v_fma_f32 v41, v41, s18, v95
    v_fma_f32 v42, v42, s18, v95
    v_fma_f32 v43, v43, s18, v95
    buffer_load_dwordx4 a[76:79], v253, s[8:11], s32 offen offset:1024 sc1
    v_fma_f32 v44, v44, s18, v95
    v_fma_f32 v45, v45, s18, v95
    v_fma_f32 v46, v46, s18, v95
    v_fma_f32 v47, v47, s18, v95
    v_exp_f32 v40, v40
    v_exp_f32 v41, v41
    v_exp_f32 v42, v42
    v_exp_f32 v43, v43
    v_exp_f32 v44, v44
    v_exp_f32 v45, v45
    buffer_load_dwordx4 a[80:83], v253, s[8:11], s33 offen offset:1024 sc1
    v_exp_f32 v46, v46
    v_exp_f32 v47, v47
    v_mfma_f32_16x16x32_bf16 v[108:111], v[176:179], v[84:87], 0
    v_mfma_f32_16x16x32_bf16 v[124:127], v[186:189], v[84:87], 0
    v_cvt_pk_bf16_f32 v88, v40, v41
    v_cvt_pk_bf16_f32 v89, v42, v43
    v_cvt_pk_bf16_f32 v90, v44, v45
    v_cvt_pk_bf16_f32 v91, v46, v47
    v_rcp_f32 v96, v118
    v_rcp_f32 v97, v122
    buffer_load_dwordx4 a[84:87], v5, s[8:11], s34 offen offset:1024 sc1
    v_mfma_f32_16x16x32_bf16 v[112:115], v[178:181], v[88:91], 0
    v_mfma_f32_16x16x32_bf16 v[128:131], v[188:191], v[88:91], 0
    v_pk_mul_f32 v[100:101], v[96:97], v[100:101] op_sel:[0,0] op_sel_hi:[0,1]
    v_pk_mul_f32 v[102:103], v[96:97], v[102:103] op_sel:[0,0] op_sel_hi:[0,1]
    v_pk_mul_f32 v[116:117], v[96:97], v[116:117] op_sel:[0,0] op_sel_hi:[0,1]
    v_cvt_pk_bf16_f32 v212, v100, v101
    v_cvt_pk_bf16_f32 v213, v102, v103
    v_cvt_pk_bf16_f32 v220, v116, v117
    v_rcp_f32 v98, v126
    v_pk_mul_f32 v[104:105], v[96:97], v[104:105] op_sel:[1,0] op_sel_hi:[1,1]
    buffer_load_dwordx4 v[240:243], v9, s[8:11], s37 offen offset:0 sc1
    v_pk_mul_f32 v[106:107], v[96:97], v[106:107] op_sel:[1,0] op_sel_hi:[1,1]
    v_pk_mul_f32 v[120:121], v[96:97], v[120:121] op_sel:[1,0] op_sel_hi:[1,1]
    v_cvt_pk_bf16_f32 v214, v104, v105
    v_cvt_pk_bf16_f32 v215, v106, v107
    v_cvt_pk_bf16_f32 v221, v120, v121
    v_rcp_f32 v99, v130
    v_permlane16_swap_b32 v212, v214
    v_permlane16_swap_b32 v213, v215
    v_pk_mul_f32 v[108:109], v[98:99], v[108:109] op_sel:[0,0] op_sel_hi:[0,1]
    v_pk_mul_f32 v[110:111], v[98:99], v[110:111] op_sel:[0,0] op_sel_hi:[0,1]
    buffer_load_dwordx4 v[244:247], v9, s[8:11], s37 offen offset:1024 sc1
    v_pk_mul_f32 v[124:125], v[98:99], v[124:125] op_sel:[0,0] op_sel_hi:[0,1]
    v_cvt_pk_bf16_f32 v216, v108, v109
    v_cvt_pk_bf16_f32 v217, v110, v111
    v_cvt_pk_bf16_f32 v222, v124, v125
    v_pk_mul_f32 v[112:113], v[98:99], v[112:113] op_sel:[1,0] op_sel_hi:[1,1]
    v_pk_mul_f32 v[114:115], v[98:99], v[114:115] op_sel:[1,0] op_sel_hi:[1,1]
    v_pk_mul_f32 v[128:129], v[98:99], v[128:129] op_sel:[1,0] op_sel_hi:[1,1]
    v_cvt_pk_bf16_f32 v218, v112, v113
    v_cvt_pk_bf16_f32 v219, v114, v115
    v_cvt_pk_bf16_f32 v223, v128, v129
    buffer_load_dwordx4 v[248:251], v7, s[8:11], s37 offen offset:2048 sc1
    s_lshl_b32 s7, s3, 2
    s_add_u32 s7, s7, 94208
    v_permlane16_swap_b32 v220, v221
    v_permlane16_swap_b32 v222, v223
    v_add_u32 v11, s7, v253
    v_lshrrev_b32 v10, 3, v0
    v_permlane32_swap_b32 v220, v222
    v_mul_u32_u24 v10, 9216, v10
    ds_write_b32 v11, v220
    v_permlane16_swap_b32 v216, v218
    buffer_load_dword v252, v8, s[8:11], s47 offen sc1
    v_permlane16_swap_b32 v217, v219
    s_mul_i32 s7, s40, 1152
    s_add_u32 s22, s22, s7
    s_add_u32 s22, s22, 22282240
    s_lshl_b32 s7, s3, 8
    s_add_u32 s23, s22, s7
    s_add_u32 s24, s23, 36864
    buffer_store_dwordx4 v[212:215], v9, s[8:11], s23 offen sc1
    buffer_store_dwordx4 v[216:219], v9, s[8:11], s24 offen sc1
    v_and_b32 v11, 7, v0
    v_lshl_add_u32 v10, v11, 4, v10
    s_cmp_eq_u32 s3, 3
    s_cselect_b32 s7, 0, 1073741824
    v_add_u32 v10, s7, v10
    v_add_u32 v11, 94208, v253
    s_waitcnt lgkmcnt(0)
    s_barrier
    ds_read_b128 v[220:223], v11
    s_waitcnt lgkmcnt(0)
    buffer_store_dwordx4 v[220:223], v10, s[8:11], s22 offen offset:1024 sc1
    v_lshlrev_b32 v15, 7, v0
    s_lshl_b32 s6, s40, 2
    s_add_u32 s6, s6, s44
    v_mov_b32 v1, s76
    s_mov_b64 vcc, 0xff
    s_waitcnt vmcnt(0)
    s_barrier
    s_cmp_lg_u32 s3, 0
    s_cbranch_scc1 L_pub_17
    s_mov_b64 exec, vcc
    buffer_store_dword v1, v15, s[8:11], s6 offen sc1
L_pub_17:
    s_mov_b64 exec, -1
    s_cmp_lg_u32 s42, 0
    s_cbranch_scc1 L_swz_18
    s_cmp_eq_u32 s93, 2
    s_cselect_b32 s6, 2, 3
    s_mov_b32 s7, 512
    s_cmov_b32 s7, 2048
    v_lshrrev_b32 v14, 4, v0
    v_lshlrev_b32 v14, s6, v14
    v_bfe_u32 v15, v0, 2, 2
    v_add_u32 v14, v14, v15
    v_mul_u32_u24 v14, 128, v14
    v_and_b32 v15, 3, v0
    v_lshl_add_u32 v14, v15, 3, v14
    v_add_u32 v14, s79, v14
    v_add_u32 v15, s7, v14
    ds_read_b64_tr_b16 v[16:17], v14 offset:0
    ds_read_b64_tr_b16 v[18:19], v15 offset:0
    ds_read_b64_tr_b16 v[20:21], v14 offset:32
    ds_read_b64_tr_b16 v[22:23], v15 offset:32
    ds_read_b64_tr_b16 v[24:25], v14 offset:64
    ds_read_b64_tr_b16 v[26:27], v15 offset:64
    ds_read_b64_tr_b16 v[28:29], v14 offset:96
    ds_read_b64_tr_b16 v[30:31], v15 offset:96
    ds_read_b64_tr_b16 v[32:33], v14 offset:4096
    ds_read_b64_tr_b16 v[34:35], v15 offset:4096
    ds_read_b64_tr_b16 v[36:37], v14 offset:4128
    ds_read_b64_tr_b16 v[38:39], v15 offset:4128
    ds_read_b64_tr_b16 v[40:41], v14 offset:4160
    ds_read_b64_tr_b16 v[42:43], v15 offset:4160
    ds_read_b64_tr_b16 v[44:45], v14 offset:4192
    ds_read_b64_tr_b16 v[46:47], v15 offset:4192
    ds_read_b64_tr_b16 v[48:49], v14 offset:8192
    ds_read_b64_tr_b16 v[50:51], v15 offset:8192
    ds_read_b64_tr_b16 v[52:53], v14 offset:8224
    ds_read_b64_tr_b16 v[54:55], v15 offset:8224
    ds_read_b64_tr_b16 v[56:57], v14 offset:8256
    ds_read_b64_tr_b16 v[58:59], v15 offset:8256
    ds_read_b64_tr_b16 v[60:61], v14 offset:8288
    ds_read_b64_tr_b16 v[62:63], v15 offset:8288
    ds_read_b64_tr_b16 v[64:65], v14 offset:12288
    ds_read_b64_tr_b16 v[66:67], v15 offset:12288
    ds_read_b64_tr_b16 v[68:69], v14 offset:12320
    ds_read_b64_tr_b16 v[70:71], v15 offset:12320
    ds_read_b64_tr_b16 v[72:73], v14 offset:12352
    ds_read_b64_tr_b16 v[74:75], v15 offset:12352
    ds_read_b64_tr_b16 v[76:77], v14 offset:12384
    ds_read_b64_tr_b16 v[78:79], v15 offset:12384
    s_mul_i32 s68, s40, 1990656
    s_add_u32 s68, s68, 3145728
    s_cmp_eq_u32 s93, 2
    s_cbranch_scc1 L_swz_down_21
    s_mul_i32 s6, s84, 349526
    s_lshr_b32 s6, s6, 20
    s_mul_i32 s7, s6, 3
    s_sub_u32 s7, s84, s7
    s_mul_i32 s6, s6, 6
    s_add_u32 s7, s7, s6
    s_mul_i32 s6, s88, 36
    s_add_u32 s7, s7, s6
    s_mul_i32 s6, s93, 3
    s_add_u32 s7, s7, s6
    s_lshl_b32 s7, s7, 10
    s_add_u32 s7, s7, s68
    s_add_u32 s52, s7, 0
    s_add_u32 s53, s7, 497664
    s_add_u32 s54, s7, 995328
    s_add_u32 s55, s7, 1492992
    s_mul_i32 s6, s85, 349526
    s_lshr_b32 s6, s6, 20
    s_mul_i32 s7, s6, 3
    s_sub_u32 s7, s85, s7
    s_mul_i32 s6, s6, 6
    s_add_u32 s7, s7, s6
    s_mul_i32 s6, s89, 36
    s_add_u32 s7, s7, s6
    s_mul_i32 s6, s93, 3
    s_add_u32 s7, s7, s6
    s_lshl_b32 s7, s7, 10
    s_add_u32 s7, s7, s68
    s_add_u32 s56, s7, 0
    s_add_u32 s57, s7, 497664
    s_add_u32 s18, s7, 995328
    s_add_u32 s19, s7, 1492992
    s_mul_i32 s6, s86, 349526
    s_lshr_b32 s6, s6, 20
    s_mul_i32 s7, s6, 3
    s_sub_u32 s7, s86, s7
    s_mul_i32 s6, s6, 6
    s_add_u32 s7, s7, s6
    s_mul_i32 s6, s90, 36
    s_add_u32 s7, s7, s6
    s_mul_i32 s6, s93, 3
    s_add_u32 s7, s7, s6
    s_lshl_b32 s7, s7, 10
    s_add_u32 s7, s7, s68
    s_add_u32 s20, s7, 0
    s_add_u32 s21, s7, 497664
    s_add_u32 s22, s7, 995328
    s_add_u32 s25, s7, 1492992
    s_mul_i32 s6, s87, 349526
    s_lshr_b32 s6, s6, 20
    s_mul_i32 s7, s6, 3
    s_sub_u32 s7, s87, s7
    s_mul_i32 s6, s6, 6
    s_add_u32 s7, s7, s6
    s_mul_i32 s6, s91, 36
    s_add_u32 s7, s7, s6
    s_mul_i32 s6, s93, 3
    s_add_u32 s7, s7, s6
    s_lshl_b32 s7, s7, 10
    s_add_u32 s7, s7, s68
    s_add_u32 s26, s7, 0
    s_add_u32 s27, s7, 497664
    s_add_u32 s28, s7, 995328
    s_add_u32 s29, s7, 1492992
    s_branch L_swz_dest_22
L_swz_down_21:
    s_add_u32 s69, s84, 324
    s_lshl_b32 s69, s69, 10
    s_add_u32 s69, s69, s68
    s_lshl_b32 s70, s88, 2
    s_add_u32 s70, s70, 0
    s_mul_i32 s6, s70, 116509
    s_lshr_b32 s6, s6, 20
    s_mul_i32 s7, s6, 9
    s_sub_u32 s7, s70, s7
    s_mul_i32 s6, s6, 497664
    s_mul_i32 s7, s7, 18432
    s_add_u32 s6, s6, s7
    s_add_u32 s52, s69, s6
    s_lshl_b32 s70, s88, 2
    s_add_u32 s70, s70, 1
    s_mul_i32 s6, s70, 116509
    s_lshr_b32 s6, s6, 20
    s_mul_i32 s7, s6, 9
    s_sub_u32 s7, s70, s7
    s_mul_i32 s6, s6, 497664
    s_mul_i32 s7, s7, 18432
    s_add_u32 s6, s6, s7
    s_add_u32 s53, s69, s6
    s_lshl_b32 s70, s88, 2
    s_add_u32 s70, s70, 2
    s_mul_i32 s6, s70, 116509
    s_lshr_b32 s6, s6, 20
    s_mul_i32 s7, s6, 9
    s_sub_u32 s7, s70, s7
    s_mul_i32 s6, s6, 497664
    s_mul_i32 s7, s7, 18432
    s_add_u32 s6, s6, s7
    s_add_u32 s54, s69, s6
    s_lshl_b32 s70, s88, 2
    s_add_u32 s70, s70, 3
    s_mul_i32 s6, s70, 116509
    s_lshr_b32 s6, s6, 20
    s_mul_i32 s7, s6, 9
    s_sub_u32 s7, s70, s7
    s_mul_i32 s6, s6, 497664
    s_mul_i32 s7, s7, 18432
    s_add_u32 s6, s6, s7
    s_add_u32 s55, s69, s6
    s_add_u32 s69, s85, 324
    s_lshl_b32 s69, s69, 10
    s_add_u32 s69, s69, s68
    s_lshl_b32 s70, s89, 2
    s_add_u32 s70, s70, 0
    s_mul_i32 s6, s70, 116509
    s_lshr_b32 s6, s6, 20
    s_mul_i32 s7, s6, 9
    s_sub_u32 s7, s70, s7
    s_mul_i32 s6, s6, 497664
    s_mul_i32 s7, s7, 18432
    s_add_u32 s6, s6, s7
    s_add_u32 s56, s69, s6
    s_lshl_b32 s70, s89, 2
    s_add_u32 s70, s70, 1
    s_mul_i32 s6, s70, 116509
    s_lshr_b32 s6, s6, 20
    s_mul_i32 s7, s6, 9
    s_sub_u32 s7, s70, s7
    s_mul_i32 s6, s6, 497664
    s_mul_i32 s7, s7, 18432
    s_add_u32 s6, s6, s7
    s_add_u32 s57, s69, s6
    s_lshl_b32 s70, s89, 2
    s_add_u32 s70, s70, 2
    s_mul_i32 s6, s70, 116509
    s_lshr_b32 s6, s6, 20
    s_mul_i32 s7, s6, 9
    s_sub_u32 s7, s70, s7
    s_mul_i32 s6, s6, 497664
    s_mul_i32 s7, s7, 18432
    s_add_u32 s6, s6, s7
    s_add_u32 s18, s69, s6
    s_lshl_b32 s70, s89, 2
    s_add_u32 s70, s70, 3
    s_mul_i32 s6, s70, 116509
    s_lshr_b32 s6, s6, 20
    s_mul_i32 s7, s6, 9
    s_sub_u32 s7, s70, s7
    s_mul_i32 s6, s6, 497664
    s_mul_i32 s7, s7, 18432
    s_add_u32 s6, s6, s7
    s_add_u32 s19, s69, s6
    s_add_u32 s69, s86, 324
    s_lshl_b32 s69, s69, 10
    s_add_u32 s69, s69, s68
    s_lshl_b32 s70, s90, 2
    s_add_u32 s70, s70, 0
    s_mul_i32 s6, s70, 116509
    s_lshr_b32 s6, s6, 20
    s_mul_i32 s7, s6, 9
    s_sub_u32 s7, s70, s7
    s_mul_i32 s6, s6, 497664
    s_mul_i32 s7, s7, 18432
    s_add_u32 s6, s6, s7
    s_add_u32 s20, s69, s6
    s_lshl_b32 s70, s90, 2
    s_add_u32 s70, s70, 1
    s_mul_i32 s6, s70, 116509
    s_lshr_b32 s6, s6, 20
    s_mul_i32 s7, s6, 9
    s_sub_u32 s7, s70, s7
    s_mul_i32 s6, s6, 497664
    s_mul_i32 s7, s7, 18432
    s_add_u32 s6, s6, s7
    s_add_u32 s21, s69, s6
    s_lshl_b32 s70, s90, 2
    s_add_u32 s70, s70, 2
    s_mul_i32 s6, s70, 116509
    s_lshr_b32 s6, s6, 20
    s_mul_i32 s7, s6, 9
    s_sub_u32 s7, s70, s7
    s_mul_i32 s6, s6, 497664
    s_mul_i32 s7, s7, 18432
    s_add_u32 s6, s6, s7
    s_add_u32 s22, s69, s6
    s_lshl_b32 s70, s90, 2
    s_add_u32 s70, s70, 3
    s_mul_i32 s6, s70, 116509
    s_lshr_b32 s6, s6, 20
    s_mul_i32 s7, s6, 9
    s_sub_u32 s7, s70, s7
    s_mul_i32 s6, s6, 497664
    s_mul_i32 s7, s7, 18432
    s_add_u32 s6, s6, s7
    s_add_u32 s25, s69, s6
    s_add_u32 s69, s87, 324
    s_lshl_b32 s69, s69, 10
    s_add_u32 s69, s69, s68
    s_lshl_b32 s70, s91, 2
    s_add_u32 s70, s70, 0
    s_mul_i32 s6, s70, 116509
    s_lshr_b32 s6, s6, 20
    s_mul_i32 s7, s6, 9
    s_sub_u32 s7, s70, s7
    s_mul_i32 s6, s6, 497664
    s_mul_i32 s7, s7, 18432
    s_add_u32 s6, s6, s7
    s_add_u32 s26, s69, s6
    s_lshl_b32 s70, s91, 2
    s_add_u32 s70, s70, 1
    s_mul_i32 s6, s70, 116509
    s_lshr_b32 s6, s6, 20
    s_mul_i32 s7, s6, 9
    s_sub_u32 s7, s70, s7
    s_mul_i32 s6, s6, 497664
    s_mul_i32 s7, s7, 18432
    s_add_u32 s6, s6, s7
    s_add_u32 s27, s69, s6
    s_lshl_b32 s70, s91, 2
    s_add_u32 s70, s70, 2
    s_mul_i32 s6, s70, 116509
    s_lshr_b32 s6, s6, 20
    s_mul_i32 s7, s6, 9
    s_sub_u32 s7, s70, s7
    s_mul_i32 s6, s6, 497664
    s_mul_i32 s7, s7, 18432
    s_add_u32 s6, s6, s7
    s_add_u32 s28, s69, s6
    s_lshl_b32 s70, s91, 2
    s_add_u32 s70, s70, 3
    s_mul_i32 s6, s70, 116509
    s_lshr_b32 s6, s6, 20
    s_mul_i32 s7, s6, 9
    s_sub_u32 s7, s70, s7
    s_mul_i32 s6, s6, 497664
    s_mul_i32 s7, s7, 18432
    s_add_u32 s6, s6, s7
    s_add_u32 s29, s69, s6
L_swz_dest_22:
    s_waitcnt lgkmcnt(0)
    buffer_store_dwordx4 v[16:19], v253, s[8:11], s52 offen sc1
    buffer_store_dwordx4 v[20:23], v253, s[8:11], s53 offen sc1
    buffer_store_dwordx4 v[24:27], v253, s[8:11], s54 offen sc1
    buffer_store_dwordx4 v[28:31], v253, s[8:11], s55 offen sc1
    buffer_store_dwordx4 v[32:35], v253, s[8:11], s56 offen sc1
    buffer_store_dwordx4 v[36:39], v253, s[8:11], s57 offen sc1
L_swz_18:
    s_and_b32 s7, s3, 1
    s_mul_i32 s7, s7, 18432
    s_add_u32 s24, s30, s7
    s_lshr_b32 s7, s3, 1
    s_lshl_b32 s7, s7, 9
    s_add_u32 s24, s24, s7
    s_add_u32 s24, s24, 22282240
    s_mov_b32 s16, 0xffff0000
    v_lshlrev_b32 v124, 16, v240
    v_and_b32 v125, s16, v240
    v_lshlrev_b32 v126, 16, v241
    v_and_b32 v127, s16, v241
    v_lshlrev_b32 v128, 16, v242
    v_and_b32 v129, s16, v242
    v_lshlrev_b32 v130, 16, v243
    v_and_b32 v131, s16, v243
    v_lshlrev_b32 v132, 16, v244
    v_and_b32 v133, s16, v244
    v_lshlrev_b32 v134, 16, v245
    v_and_b32 v135, s16, v245
    v_lshlrev_b32 v136, 16, v246
    v_and_b32 v137, s16, v246
    v_lshlrev_b32 v138, 16, v247
    v_and_b32 v139, s16, v247
    v_lshlrev_b32 v140, 16, v248
    v_and_b32 v141, s16, v248
    v_lshlrev_b32 v142, 16, v249
    v_and_b32 v143, s16, v249
    v_lshlrev_b32 v144, 16, v250
    v_and_b32 v145, s16, v250
    v_lshlrev_b32 v146, 16, v251
    v_and_b32 v147, s16, v251
    s_cmp_eq_u32 s3, 1
    s_cselect_b32 s7, 16, 0
    v_lshlrev_b32 v12, 2, v0
    v_cmp_gt_u32 vcc, s7, v0
    v_add_u32 v10, 40960, v12
    v_add_u32 v11, 41472, v12
    v_cndmask_b32 v10, v11, v10, vcc
    v_and_b32 v11, 0x7c, v12
    v_cmp_gt_u32 vcc, 32, v0
    v_mov_b32 v13, 1073741824
    s_and_b32 s7, s40, 3
    s_lshl_b32 s45, s45, 2
    v_cndmask_b32 v8, v13, v12, vcc
    s_add_u32 s6, s7, s3
    s_cmp_eq_u32 s6, 0
    s_cselect_b32 s6, 0, 1073741824
    v_add_u32 v6, s6, v8
    s_add_u32 s45, s45, s7
    s_lshl_b32 s45, s45, 2
    s_add_u32 s45, s45, s3
    s_lshl_b32 s45, s45, 7
    s_add_u32 s45, s45, s43
    s_add_u32 s45, s45, 50659328
    s_cmp_eq_u32 s3, 0
    s_cselect_b32 s35, 1.0, 0
    s_lshl_b32 s7, s40, 2
    s_add_u32 s7, s7, s3
    s_mul_i32 s23, s7, 497664
    s_add_u32 s23, s23, 3145728
    s_add_u32 s50, s23, 497664
    s_mul_i32 s50, s50, s42
    v_mov_b32 v184, v253
    v_add_u32 v185, 4096, v253
    v_add_u32 v186, 8192, v253
    v_add_u32 v187, 12288, v253
    v_add_u32 v188, 16384, v253
    v_add_u32 v189, 20480, v253
    v_add_u32 v190, 24576, v253
    v_add_u32 v191, 28672, v253
    v_add_u32 v192, 32768, v253
    s_cmp_lg_u32 s3, 0
    s_cbranch_scc1 L_pollout_25
    s_lshl_b32 s7, s40, 7
    s_add_u32 s7, s7, s44
    s_add_u32 s52, s4, s7
    s_addc_u32 s53, s5, 0
    s_mov_b32 s6, 0
L_poll_23:
    s_load_dwordx8 s[56:63], s[52:53], 0 glc
    s_add_u32 s6, s6, 1
    s_waitcnt lgkmcnt(0)
    s_xor_b64 s[56:57], s[56:57], s[76:77]
    s_xor_b64 s[58:59], s[58:59], s[76:77]
    s_xor_b64 s[60:61], s[60:61], s[76:77]
    s_xor_b64 s[62:63], s[62:63], s[76:77]
    s_or_b64 s[56:57], s[56:57], s[58:59]
    s_or_b64 s[60:61], s[60:61], s[62:63]
    s_or_b64 s[56:57], s[56:57], s[60:61]
    s_cbranch_scc0 L_polled_24
    s_cmp_lt_u32 s6, 1048576
    s_cbranch_scc1 L_poll_23
    s_branch L_main_end
L_polled_24:
L_pollout_25:
    s_barrier
    s_lshl_b32 m0, s3, 10
    s_nop 0
    buffer_load_dwordx4 v2, s[8:11], s24 offen sc1 lds
    s_add_u32 m0, m0, 4096
    s_add_u32 s24, s24, 1024
    buffer_load_dwordx4 v2, s[8:11], s24 offen sc1 lds
    s_add_u32 m0, m0, 4096
    s_add_u32 s24, s24, 1024
    buffer_load_dwordx4 v2, s[8:11], s24 offen sc1 lds
    s_add_u32 m0, m0, 4096
    s_add_u32 s24, s24, 1024
    buffer_load_dwordx4 v2, s[8:11], s24 offen sc1 lds
    s_add_u32 m0, m0, 4096
    s_add_u32 s24, s24, 1024
    buffer_load_dwordx4 v2, s[8:11], s24 offen sc1 lds
    s_add_u32 m0, m0, 4096
    s_add_u32 s24, s24, 1024
    buffer_load_dwordx4 v2, s[8:11], s24 offen sc1 lds
    s_add_u32 m0, m0, 4096
    s_add_u32 s24, s24, 1024
    buffer_load_dwordx4 v2, s[8:11], s24 offen sc1 lds
    s_add_u32 m0, m0, 4096
    s_add_u32 s24, s24, 1024
    buffer_load_dwordx4 v2, s[8:11], s24 offen sc1 lds
    s_add_u32 m0, m0, 4096
    s_add_u32 s24, s24, 1024
    buffer_load_dwordx4 v2, s[8:11], s24 offen sc1 lds
    s_cmp_lg_u32 s42, 0
    s_cbranch_scc1 L_swz_19
    buffer_store_dwordx4 v[40:43], v253, s[8:11], s18 offen sc1
    buffer_store_dwordx4 v[44:47], v253, s[8:11], s19 offen sc1
    buffer_store_dwordx4 v[48:51], v253, s[8:11], s20 offen sc1
    buffer_store_dwordx4 v[52:55], v253, s[8:11], s21 offen sc1
    buffer_store_dwordx4 v[56:59], v253, s[8:11], s22 offen sc1
    buffer_store_dwordx4 v[60:63], v253, s[8:11], s25 offen sc1
    buffer_store_dwordx4 v[64:67], v253, s[8:11], s26 offen sc1
    buffer_store_dwordx4 v[68:71], v253, s[8:11], s27 offen sc1
    buffer_store_dwordx4 v[72:75], v253, s[8:11], s28 offen sc1
    buffer_store_dwordx4 v[76:79], v253, s[8:11], s29 offen sc1
    s_waitcnt vmcnt(10)
    s_branch L_swz_20
L_swz_19:
    s_waitcnt vmcnt(0)
L_swz_20:
    s_barrier
    ds_read_b128 v[160:163], v253 offset:0
    ds_read_b128 v[164:167], v253 offset:1024
    s_waitcnt lgkmcnt(0)
    v_mfma_f32_16x16x32_bf16 v[100:103], a[160:163], v[160:163], 0
    ds_read_b128 v[168:171], v253 offset:2048
    v_mfma_f32_16x16x32_bf16 v[104:107], a[160:163], v[164:167], 0
    ds_read_b128 v[172:175], v253 offset:3072
    v_mfma_f32_16x16x32_bf16 v[108:111], a[164:167], v[160:163], 0
    v_mfma_f32_16x16x32_bf16 v[112:115], a[164:167], v[164:167], 0
    buffer_load_dwordx4 v[16:19], v184, s[48:51], s23 offen offset:0 sc1
    v_mfma_f32_16x16x32_bf16 v[116:119], a[168:171], v[160:163], 0
    v_mfma_f32_16x16x32_bf16 v[120:123], a[168:171], v[164:167], 0
    s_waitcnt lgkmcnt(0)
    v_mfma_f32_16x16x32_bf16 v[100:103], a[172:175], v[168:171], v[100:103]
    ds_read_b128 v[160:163], v253 offset:4096
    v_mfma_f32_16x16x32_bf16 v[104:107], a[172:175], v[172:175], v[104:107]
    ds_read_b128 v[164:167], v253 offset:5120
    v_mfma_f32_16x16x32_bf16 v[108:111], a[176:179], v[168:171], v[108:111]
    v_mfma_f32_16x16x32_bf16 v[112:115], a[176:179], v[172:175], v[112:115]
    buffer_load_dwordx4 v[20:23], v184, s[48:51], s23 offen offset:1024 sc1
    v_mfma_f32_16x16x32_bf16 v[116:119], a[180:183], v[168:171], v[116:119]
    v_mfma_f32_16x16x32_bf16 v[120:123], a[180:183], v[172:175], v[120:123]
    s_waitcnt lgkmcnt(0)
    v_mfma_f32_16x16x32_bf16 v[100:103], a[184:187], v[160:163], v[100:103]
    ds_read_b128 v[168:171], v253 offset:6144
    v_mfma_f32_16x16x32_bf16 v[104:107], a[184:187], v[164:167], v[104:107]
    ds_read_b128 v[172:175], v253 offset:7168
    v_mfma_f32_16x16x32_bf16 v[108:111], a[188:191], v[160:163], v[108:111]
    v_mfma_f32_16x16x32_bf16 v[112:115], a[188:191], v[164:167], v[112:115]
    buffer_load_dwordx4 v[24:27], v184, s[48:51], s23 offen offset:2048 sc1
    v_mfma_f32_16x16x32_bf16 v[116:119], a[192:195], v[160:163], v[116:119]
    v_mfma_f32_16x16x32_bf16 v[120:123], a[192:195], v[164:167], v[120:123]
    s_waitcnt lgkmcnt(0)
    v_mfma_f32_16x16x32_bf16 v[100:103], a[196:199], v[168:171], v[100:103]
    ds_read_b128 v[160:163], v253 offset:8192
    v_mfma_f32_16x16x32_bf16 v[104:107], a[196:199], v[172:175], v[104:107]
    ds_read_b128 v[164:167], v253 offset:9216
    v_mfma_f32_16x16x32_bf16 v[108:111], a[200:203], v[168:171], v[108:111]
    v_mfma_f32_16x16x32_bf16 v[112:115], a[200:203], v[172:175], v[112:115]
    buffer_load_dwordx4 v[28:31], v184, s[48:51], s23 offen offset:3072 sc1
    v_mfma_f32_16x16x32_bf16 v[116:119], a[204:207], v[168:171], v[116:119]
    v_mfma_f32_16x16x32_bf16 v[120:123], a[204:207], v[172:175], v[120:123]
    s_waitcnt lgkmcnt(0)
    v_mfma_f32_16x16x32_bf16 v[100:103], a[208:211], v[160:163], v[100:103]
    ds_read_b128 v[168:171], v253 offset:10240
    v_mfma_f32_16x16x32_bf16 v[104:107], a[208:211], v[164:167], v[104:107]
    ds_read_b128 v[172:175], v253 offset:11264
    v_mfma_f32_16x16x32_bf16 v[108:111], a[212:215], v[160:163], v[108:111]
    v_mfma_f32_16x16x32_bf16 v[112:115], a[212:215], v[164:167], v[112:115]
    buffer_load_dwordx4 v[32:35], v185, s[48:51], s23 offen offset:0 sc1
    v_mfma_f32_16x16x32_bf16 v[116:119], a[216:219], v[160:163], v[116:119]
    v_mfma_f32_16x16x32_bf16 v[120:123], a[216:219], v[164:167], v[120:123]
    s_waitcnt lgkmcnt(0)
    v_mfma_f32_16x16x32_bf16 v[100:103], a[220:223], v[168:171], v[100:103]
    ds_read_b128 v[160:163], v253 offset:12288
    v_mfma_f32_16x16x32_bf16 v[104:107], a[220:223], v[172:175], v[104:107]
    ds_read_b128 v[164:167], v253 offset:13312
    v_mfma_f32_16x16x32_bf16 v[108:111], a[224:227], v[168:171], v[108:111]
    v_mfma_f32_16x16x32_bf16 v[112:115], a[224:227], v[172:175], v[112:115]
    buffer_load_dwordx4 v[36:39], v185, s[48:51], s23 offen offset:1024 sc1
    v_mfma_f32_16x16x32_bf16 v[116:119], a[228:231], v[168:171], v[116:119]
    v_mfma_f32_16x16x32_bf16 v[120:123], a[228:231], v[172:175], v[120:123]
    s_waitcnt lgkmcnt(0)
    v_mfma_f32_16x16x32_bf16 v[100:103], a[232:235], v[160:163], v[100:103]
    ds_read_b128 v[168:171], v253 offset:14336
    v_mfma_f32_16x16x32_bf16 v[104:107], a[232:235], v[164:167], v[104:107]
    ds_read_b128 v[172:175], v253 offset:15360
    v_mfma_f32_16x16x32_bf16 v[108:111], a[236:239], v[160:163], v[108:111]
    v_mfma_f32_16x16x32_bf16 v[112:115], a[236:239], v[164:167], v[112:115]
    buffer_load_dwordx4 v[40:43], v185, s[48:51], s23 offen offset:2048 sc1
    v_mfma_f32_16x16x32_bf16 v[116:119], a[240:243], v[160:163], v[116:119]
    v_mfma_f32_16x16x32_bf16 v[120:123], a[240:243], v[164:167], v[120:123]
    s_waitcnt lgkmcnt(0)
    v_mfma_f32_16x16x32_bf16 v[100:103], a[244:247], v[168:171], v[100:103]
    ds_read_b128 v[160:163], v253 offset:16384
    v_mfma_f32_16x16x32_bf16 v[104:107], a[244:247], v[172:175], v[104:107]
    ds_read_b128 v[164:167], v253 offset:17408
    v_mfma_f32_16x16x32_bf16 v[108:111], a[248:251], v[168:171], v[108:111]
    v_mfma_f32_16x16x32_bf16 v[112:115], a[248:251], v[172:175], v[112:115]
    buffer_load_dwordx4 v[44:47], v185, s[48:51], s23 offen offset:3072 sc1
    v_mfma_f32_16x16x32_bf16 v[116:119], a[252:255], v[168:171], v[116:119]
    v_mfma_f32_16x16x32_bf16 v[120:123], a[252:255], v[172:175], v[120:123]
    s_waitcnt lgkmcnt(0)
    v_mfma_f32_16x16x32_bf16 v[100:103], a[128:131], v[160:163], v[100:103]
    ds_read_b128 v[168:171], v253 offset:18432
    v_mfma_f32_16x16x32_bf16 v[104:107], a[128:131], v[164:167], v[104:107]
    ds_read_b128 v[172:175], v253 offset:19456
    v_mfma_f32_16x16x32_bf16 v[108:111], a[132:135], v[160:163], v[108:111]
    v_mfma_f32_16x16x32_bf16 v[112:115], a[132:135], v[164:167], v[112:115]
    buffer_load_dwordx4 v[48:51], v186, s[48:51], s23 offen offset:0 sc1
    v_mfma_f32_16x16x32_bf16 v[116:119], a[136:139], v[160:163], v[116:119]
    v_mfma_f32_16x16x32_bf16 v[120:123], a[136:139], v[164:167], v[120:123]
    s_waitcnt lgkmcnt(0)
    v_mfma_f32_16x16x32_bf16 v[100:103], a[140:143], v[168:171], v[100:103]
    ds_read_b128 v[160:163], v253 offset:20480
    v_mfma_f32_16x16x32_bf16 v[104:107], a[140:143], v[172:175], v[104:107]
    ds_read_b128 v[164:167], v253 offset:21504
    v_mfma_f32_16x16x32_bf16 v[108:111], a[144:147], v[168:171], v[108:111]
    v_mfma_f32_16x16x32_bf16 v[112:115], a[144:147], v[172:175], v[112:115]
    buffer_load_dwordx4 v[52:55], v186, s[48:51], s23 offen offset:1024 sc1
    v_mfma_f32_16x16x32_bf16 v[116:119], a[148:151], v[168:171], v[116:119]
    v_mfma_f32_16x16x32_bf16 v[120:123], a[148:151], v[172:175], v[120:123]
    s_waitcnt lgkmcnt(0)
    v_mfma_f32_16x16x32_bf16 v[100:103], a[152:155], v[160:163], v[100:103]
    ds_read_b128 v[168:171], v253 offset:22528
    v_mfma_f32_16x16x32_bf16 v[104:107], a[152:155], v[164:167], v[104:107]
    ds_read_b128 v[172:175], v253 offset:23552
    v_mfma_f32_16x16x32_bf16 v[108:111], a[156:159], v[160:163], v[108:111]
    v_mfma_f32_16x16x32_bf16 v[112:115], a[156:159], v[164:167], v[112:115]
    buffer_load_dwordx4 v[56:59], v186, s[48:51], s23 offen offset:2048 sc1
    v_mfma_f32_16x16x32_bf16 v[116:119], a[0:3], v[160:163], v[116:119]
    v_mfma_f32_16x16x32_bf16 v[120:123], a[0:3], v[164:167], v[120:123]
    s_waitcnt lgkmcnt(0)
    v_mfma_f32_16x16x32_bf16 v[100:103], a[4:7], v[168:171], v[100:103]
    ds_read_b128 v[160:163], v253 offset:24576
    v_mfma_f32_16x16x32_bf16 v[104:107], a[4:7], v[172:175], v[104:107]
    ds_read_b128 v[164:167], v253 offset:25600
    v_mfma_f32_16x16x32_bf16 v[108:111], a[8:11], v[168:171], v[108:111]
    v_mfma_f32_16x16x32_bf16 v[112:115], a[8:11], v[172:175], v[112:115]
    buffer_load_dwordx4 v[60:63], v186, s[48:51], s23 offen offset:3072 sc1
    v_mfma_f32_16x16x32_bf16 v[116:119], a[12:15], v[168:171], v[116:119]
    v_mfma_f32_16x16x32_bf16 v[120:123], a[12:15], v[172:175], v[120:123]
    s_waitcnt lgkmcnt(0)
    v_mfma_f32_16x16x32_bf16 v[100:103], a[16:19], v[160:163], v[100:103]
    ds_read_b128 v[168:171], v253 offset:26624
    v_mfma_f32_16x16x32_bf16 v[104:107], a[16:19], v[164:167], v[104:107]
    ds_read_b128 v[172:175], v253 offset:27648
    v_mfma_f32_16x16x32_bf16 v[108:111], a[20:23], v[160:163], v[108:111]
    v_mfma_f32_16x16x32_bf16 v[112:115], a[20:23], v[164:167], v[112:115]
    buffer_load_dwordx4 v[64:67], v187, s[48:51], s23 offen offset:0 sc1
    v_mfma_f32_16x16x32_bf16 v[116:119], a[24:27], v[160:163], v[116:119]
    v_mfma_f32_16x16x32_bf16 v[120:123], a[24:27], v[164:167], v[120:123]
    s_waitcnt lgkmcnt(0)
    v_mfma_f32_16x16x32_bf16 v[100:103], a[28:31], v[168:171], v[100:103]
    ds_read_b128 v[160:163], v253 offset:28672
    v_mfma_f32_16x16x32_bf16 v[104:107], a[28:31], v[172:175], v[104:107]
    ds_read_b128 v[164:167], v253 offset:29696
    v_mfma_f32_16x16x32_bf16 v[108:111], a[32:35], v[168:171], v[108:111]
    v_mfma_f32_16x16x32_bf16 v[112:115], a[32:35], v[172:175], v[112:115]
    buffer_load_dwordx4 v[68:71], v187, s[48:51], s23 offen offset:1024 sc1
    v_mfma_f32_16x16x32_bf16 v[116:119], a[36:39], v[168:171], v[116:119]
    v_mfma_f32_16x16x32_bf16 v[120:123], a[36:39], v[172:175], v[120:123]
    s_waitcnt lgkmcnt(0)
    v_mfma_f32_16x16x32_bf16 v[100:103], a[40:43], v[160:163], v[100:103]
    ds_read_b128 v[168:171], v253 offset:30720
    v_mfma_f32_16x16x32_bf16 v[104:107], a[40:43], v[164:167], v[104:107]
    ds_read_b128 v[172:175], v253 offset:31744
    v_mfma_f32_16x16x32_bf16 v[108:111], a[44:47], v[160:163], v[108:111]
    v_mfma_f32_16x16x32_bf16 v[112:115], a[44:47], v[164:167], v[112:115]
    buffer_load_dwordx4 v[72:75], v187, s[48:51], s23 offen offset:2048 sc1
    v_mfma_f32_16x16x32_bf16 v[116:119], a[48:51], v[160:163], v[116:119]
    v_mfma_f32_16x16x32_bf16 v[120:123], a[48:51], v[164:167], v[120:123]
    s_waitcnt lgkmcnt(0)
    v_mfma_f32_16x16x32_bf16 v[100:103], a[52:55], v[168:171], v[100:103]
    ds_read_b128 v[160:163], v253 offset:32768
    v_mfma_f32_16x16x32_bf16 v[104:107], a[52:55], v[172:175], v[104:107]
    ds_read_b128 v[164:167], v253 offset:33792
    v_mfma_f32_16x16x32_bf16 v[108:111], a[56:59], v[168:171], v[108:111]
    v_mfma_f32_16x16x32_bf16 v[112:115], a[56:59], v[172:175], v[112:115]
    v_mfma_f32_16x16x32_bf16 v[116:119], a[60:63], v[168:171], v[116:119]
    v_mfma_f32_16x16x32_bf16 v[120:123], a[60:63], v[172:175], v[120:123]
    s_waitcnt lgkmcnt(0)
    v_mfma_f32_16x16x32_bf16 v[100:103], a[64:67], v[160:163], v[100:103]
    ds_read_b128 v[168:171], v253 offset:34816
    v_mfma_f32_16x16x32_bf16 v[104:107], a[64:67], v[164:167], v[104:107]
    ds_read_b128 v[172:175], v253 offset:35840
    v_mfma_f32_16x16x32_bf16 v[108:111], a[68:71], v[160:163], v[108:111]
    v_mfma_f32_16x16x32_bf16 v[112:115], a[68:71], v[164:167], v[112:115]
    v_mfma_f32_16x16x32_bf16 v[116:119], a[72:75], v[160:163], v[116:119]
    v_mfma_f32_16x16x32_bf16 v[120:123], a[72:75], v[164:167], v[120:123]
    s_waitcnt lgkmcnt(0)
    v_mfma_f32_16x16x32_bf16 v[100:103], a[76:79], v[168:171], v[100:103]
    v_mfma_f32_16x16x32_bf16 v[104:107], a[76:79], v[172:175], v[104:107]
    v_mfma_f32_16x16x32_bf16 v[108:111], a[80:83], v[168:171], v[108:111]
    v_mfma_f32_16x16x32_bf16 v[112:115], a[80:83], v[172:175], v[112:115]
    v_mfma_f32_16x16x32_bf16 v[116:119], a[84:87], v[168:171], v[116:119]
    v_mfma_f32_16x16x32_bf16 v[120:123], a[84:87], v[172:175], v[120:123]
    s_nop 3
    v_permlane16_swap_b32 v100, v104
    v_permlane16_swap_b32 v101, v105
    v_permlane16_swap_b32 v102, v106
    v_permlane16_swap_b32 v103, v107
    v_add_f32 v12, v116, v117
    v_add_f32 v13, v120, v121
    ds_write_b32 v10, v12
    ds_write_b32 v10, v13 offset:64
    v_permlane16_swap_b32 v108, v112
    v_permlane16_swap_b32 v109, v113
    v_permlane16_swap_b32 v110, v114
    v_permlane16_swap_b32 v111, v115
    v_permlane16_swap_b32 v116, v120
    v_permlane16_swap_b32 v117, v121
    v_permlane16_swap_b32 v118, v122
    v_permlane16_swap_b32 v119, v123
    s_waitcnt lgkmcnt(0)
    s_barrier
    ds_read_b32 v12, v11 offset:40960
    v_pk_add_f32 v[124:125], v[124:125], v[100:101]
    v_pk_add_f32 v[126:127], v[126:127], v[102:103]
    v_pk_add_f32 v[128:129], v[128:129], v[104:105]
    v_pk_add_f32 v[130:131], v[130:131], v[106:107]
    v_pk_add_f32 v[132:133], v[132:133], v[108:109]
    v_pk_add_f32 v[134:135], v[134:135], v[110:111]
    v_pk_add_f32 v[136:137], v[136:137], v[112:113]
    v_pk_add_f32 v[138:139], v[138:139], v[114:115]
    v_pk_add_f32 v[140:141], v[140:141], v[116:117]
    v_pk_add_f32 v[142:143], v[142:143], v[118:119]
    v_pk_add_f32 v[144:145], v[144:145], v[120:121]
    v_pk_add_f32 v[146:147], v[146:147], v[122:123]
    v_mov_b32 v14, 0
    v_mov_b32 v15, 0
    s_waitcnt lgkmcnt(0)
    v_add_f32 v12, v12, v252
    v_pk_add_f32 v[100:101], v[124:125], v[12:13] op_sel_hi:[1,0] neg_lo:[0,1] neg_hi:[0,1]
    v_pk_add_f32 v[102:103], v[126:127], v[12:13] op_sel_hi:[1,0] neg_lo:[0,1] neg_hi:[0,1]
    v_pk_add_f32 v[104:105], v[128:129], v[12:13] op_sel_hi:[1,0] neg_lo:[0,1] neg_hi:[0,1]
    v_pk_add_f32 v[106:107], v[130:131], v[12:13] op_sel_hi:[1,0] neg_lo:[0,1] neg_hi:[0,1]
    v_cvt_pk_bf16_f32 v148, v100, v101
    v_cvt_pk_bf16_f32 v149, v102, v103
    v_cvt_pk_bf16_f32 v150, v104, v105
    v_cvt_pk_bf16_f32 v151, v106, v107
    buffer_store_dwordx4 v[148:151], v9, s[8:11], s46 offen offset:0 sc1
    v_pk_add_f32 v[108:109], v[132:133], v[12:13] op_sel_hi:[1,0] neg_lo:[0,1] neg_hi:[0,1]
    v_pk_add_f32 v[110:111], v[134:135], v[12:13] op_sel_hi:[1,0] neg_lo:[0,1] neg_hi:[0,1]
    v_pk_add_f32 v[112:113], v[136:137], v[12:13] op_sel_hi:[1,0] neg_lo:[0,1] neg_hi:[0,1]
    v_pk_add_f32 v[114:115], v[138:139], v[12:13] op_sel_hi:[1,0] neg_lo:[0,1] neg_hi:[0,1]
    v_cvt_pk_bf16_f32 v152, v108, v109
    v_cvt_pk_bf16_f32 v153, v110, v111
    v_cvt_pk_bf16_f32 v154, v112, v113
    v_cvt_pk_bf16_f32 v155, v114, v115
    buffer_store_dwordx4 v[152:155], v9, s[8:11], s46 offen offset:1024 sc1
    v_pk_add_f32 v[116:117], v[140:141], v[12:13] op_sel_hi:[1,0] neg_lo:[0,1] neg_hi:[0,1]
    v_pk_add_f32 v[118:119], v[142:143], v[12:13] op_sel_hi:[1,0] neg_lo:[0,1] neg_hi:[0,1]
    v_pk_add_f32 v[120:121], v[144:145], v[12:13] op_sel_hi:[1,0] neg_lo:[0,1] neg_hi:[0,1]
    v_pk_add_f32 v[122:123], v[146:147], v[12:13] op_sel_hi:[1,0] neg_lo:[0,1] neg_hi:[0,1]
    v_cvt_pk_bf16_f32 v156, v116, v117
    v_cvt_pk_bf16_f32 v157, v118, v119
    v_cvt_pk_bf16_f32 v158, v120, v121
    v_cvt_pk_bf16_f32 v159, v122, v123
    buffer_store_dwordx4 v[156:159], v7, s[8:11], s46 offen offset:2048 sc1
    v_dot2c_f32_bf16 v14, v148, v148
    v_dot2c_f32_bf16 v14, v149, v149
    v_dot2c_f32_bf16 v14, v150, v150
    v_dot2c_f32_bf16 v14, v151, v151
    v_dot2c_f32_bf16 v14, v152, v152
    v_dot2c_f32_bf16 v14, v153, v153
    v_dot2c_f32_bf16 v14, v154, v154
    v_dot2c_f32_bf16 v14, v155, v155
    v_dot2c_f32_bf16 v15, v156, v156
    v_dot2c_f32_bf16 v15, v157, v157
    v_dot2c_f32_bf16 v15, v158, v158
    v_dot2c_f32_bf16 v15, v159, v159
    buffer_store_dword v12, v6, s[8:11], s36 offen sc1
    s_nop 1
    v_fma_f32 v14, v15, s35, v14
    v_mov_b32 v15, v14
    s_nop 1
    v_permlane32_swap_b32 v14, v15
    v_add_f32 v14, v14, v15
    buffer_store_dword v14, v8, s[8:11], s45 offen sc1
    v_lshlrev_b32 v15, 7, v0
    s_lshl_b32 s6, s40, 2
    s_add_u32 s6, s6, s44
    s_add_u32 s6, s6, 32768
    v_mov_b32 v1, s76
    s_mov_b64 vcc, 0xff
    s_waitcnt vmcnt(0)
    s_barrier
    s_cmp_lg_u32 s3, 0
    s_cbranch_scc1 L_pub_26
    s_mov_b64 exec, vcc
    buffer_store_dword v1, v15, s[8:11], s6 offen sc1
    s_cmp_lg_u32 s42, 0
    s_cbranch_scc1 L_pub_26
    v_lshlrev_b32 v15, 10, v0
    s_lshl_b32 s6, s40, 7
    s_lshl_b32 s7, s41, 2
    s_add_u32 s6, s6, s7
    s_add_u32 s6, s6, 19464192
    s_mov_b64 exec, 0xffffffff
    v_lshlrev_b32 v15, 10, v0
    v_mov_b32 v1, s76
    buffer_store_dword v1, v15, s[8:11], s6 offen sc1
L_pub_26:
    s_mov_b64 exec, -1
    s_lshl_b32 s7, s41, 2
    s_add_u32 s7, s7, s3
    s_mul_i32 s22, s7, 18432
    s_add_u32 s22, s22, s43
    s_add_u32 s22, s22, 48234496
    s_mul_i32 s24, s3, 18432
    s_lshl_b32 s25, s41, 12
    s_add_u32 s25, s25, s43
    s_add_u32 s25, s25, 50659328
    v_lshrrev_b32 v3, 5, v0
    v_and_b32 v10, 31, v0
    v_lshlrev_b32 v10, 2, v10
    v_lshl_add_u32 v3, v3, 11, v10
    v_add_u32 v11, 36864, v184
    s_cmp_lg_u32 s3, 0
    s_cbranch_scc1 L_pollout_29
    s_lshl_b32 s7, s40, 7
    s_add_u32 s7, s7, s44
    s_add_u32 s7, s7, 32768
    s_add_u32 s52, s4, s7
    s_addc_u32 s53, s5, 0
    s_mov_b32 s6, 0
L_poll_27:
    s_load_dwordx8 s[56:63], s[52:53], 0 glc
    s_add_u32 s6, s6, 1
    s_waitcnt lgkmcnt(0)
    s_xor_b64 s[56:57], s[56:57], s[76:77]
    s_xor_b64 s[58:59], s[58:59], s[76:77]
    s_xor_b64 s[60:61], s[60:61], s[76:77]
    s_xor_b64 s[62:63], s[62:63], s[76:77]
    s_or_b64 s[56:57], s[56:57], s[58:59]
    s_or_b64 s[60:61], s[60:61], s[62:63]
    s_or_b64 s[56:57], s[56:57], s[60:61]
    s_cbranch_scc0 L_polled_28
    s_cmp_lt_u32 s6, 1048576
    s_cbranch_scc1 L_poll_27
    s_branch L_main_end
L_polled_28:
    s_cmp_lg_u32 s42, 0
    s_cbranch_scc1 L_pollout_29
    v_and_b32 v15, 31, v0
    v_lshlrev_b32 v15, 2, v15
    s_lshl_b32 s7, s41, 3
    s_add_u32 s7, s7, s40
    s_lshl_b32 s7, s7, 7
    s_add_u32 s7, s7, 19464192
    s_mov_b32 s6, 0
L_spin_30:
    buffer_load_dword v1, v15, s[8:11], s7 offen sc1
    s_add_u32 s6, s6, 1
    s_waitcnt vmcnt(0)
    v_cmp_eq_u32 vcc, s76, v1
    s_cmp_eq_u64 vcc, exec
    s_cbranch_scc1 L_spun_31
    s_cmp_lt_u32 s6, 1048576
    s_cbranch_scc1 L_spin_30
    s_branch L_main_end
L_spun_31:
L_pollout_29:
    s_barrier
    buffer_load_dword v88, v3, s[8:11], s25 offen offset:0 sc1
    buffer_load_dword v89, v3, s[8:11], s25 offen offset:128 sc1
    buffer_load_dword v90, v3, s[8:11], s25 offen offset:256 sc1
    buffer_load_dword v91, v3, s[8:11], s25 offen offset:384 sc1
    buffer_load_dword v92, v3, s[8:11], s25 offen offset:512 sc1
    buffer_load_dword v93, v3, s[8:11], s25 offen offset:640 sc1
    buffer_load_dword v94, v3, s[8:11], s25 offen offset:768 sc1
    buffer_load_dword v95, v3, s[8:11], s25 offen offset:896 sc1
    buffer_load_dword v96, v3, s[8:11], s25 offen offset:1024 sc1
    buffer_load_dword v97, v3, s[8:11], s25 offen offset:1152 sc1
    buffer_load_dword v98, v3, s[8:11], s25 offen offset:1280 sc1
    buffer_load_dword v99, v3, s[8:11], s25 offen offset:1408 sc1
    buffer_load_dword v100, v3, s[8:11], s25 offen offset:1536 sc1
    buffer_load_dword v101, v3, s[8:11], s25 offen offset:1664 sc1
    buffer_load_dword v102, v3, s[8:11], s25 offen offset:1792 sc1
    buffer_load_dword v103, v3, s[8:11], s25 offen offset:1920 sc1
    s_add_u32 m0, s24, 0
    s_nop 0
    buffer_load_dwordx4 v2, s[8:11], s22 offen offset:0 sc1 lds
    s_add_u32 m0, s24, 512
    s_nop 0
    buffer_load_dwordx4 v2, s[8:11], s22 offen offset:512 sc1 lds
    s_add_u32 m0, s24, 1024
    s_nop 0
    buffer_load_dwordx4 v2, s[8:11], s22 offen offset:1024 sc1 lds
    s_add_u32 m0, s24, 1536
    s_nop 0
    buffer_load_dwordx4 v2, s[8:11], s22 offen offset:1536 sc1 lds
    s_add_u32 m0, s24, 2048
    s_nop 0
    buffer_load_dwordx4 v2, s[8:11], s22 offen offset:2048 sc1 lds
    s_add_u32 m0, s24, 2560
    s_nop 0
    buffer_load_dwordx4 v2, s[8:11], s22 offen offset:2560 sc1 lds
    s_add_u32 m0, s24, 3072
    s_nop 0
    buffer_load_dwordx4 v2, s[8:11], s22 offen offset:3072 sc1 lds
    s_add_u32 m0, s24, 3584
    s_nop 0
    buffer_load_dwordx4 v2, s[8:11], s22 offen offset:3584 sc1 lds
    s_add_u32 m0, s24, 8192
    s_add_u32 s22, s22, 4096
    buffer_load_dwordx4 v2, s[8:11], s22 offen offset:0 sc1 lds
    s_add_u32 m0, s24, 8704
    s_nop 0
    buffer_load_dwordx4 v2, s[8:11], s22 offen offset:512 sc1 lds
    s_add_u32 m0, s24, 9216
    s_nop 0
    buffer_load_dwordx4 v2, s[8:11], s22 offen offset:1024 sc1 lds
    s_add_u32 m0, s24, 9728
    s_nop 0
    buffer_load_dwordx4 v2, s[8:11], s22 offen offset:1536 sc1 lds
    s_add_u32 m0, s24, 10240
    s_nop 0
    buffer_load_dwordx4 v2, s[8:11], s22 offen offset:2048 sc1 lds
    s_add_u32 m0, s24, 10752
    s_nop 0
    buffer_load_dwordx4 v2, s[8:11], s22 offen offset:2560 sc1 lds
    s_add_u32 m0, s24, 11264
    s_nop 0
    buffer_load_dwordx4 v2, s[8:11], s22 offen offset:3072 sc1 lds
    s_add_u32 m0, s24, 11776
    s_nop 0
    buffer_load_dwordx4 v2, s[8:11], s22 offen offset:3584 sc1 lds
    s_add_u32 m0, s24, 16384
    s_add_u32 s22, s22, 4096
    buffer_load_dwordx4 v2, s[8:11], s22 offen offset:0 sc1 lds
    s_add_u32 m0, s24, 16896
    s_nop 0
    buffer_load_dwordx4 v2, s[8:11], s22 offen offset:512 sc1 lds
    s_add_u32 s50, s23, 497664
    s_waitcnt vmcnt(18)
    v_pk_add_f32 v[88:89], v[88:89], v[96:97]
    v_pk_add_f32 v[90:91], v[90:91], v[98:99]
    v_pk_add_f32 v[92:93], v[92:93], v[100:101]
    v_pk_add_f32 v[94:95], v[94:95], v[102:103]
    v_pk_add_f32 v[88:89], v[88:89], v[92:93]
    v_pk_add_f32 v[90:91], v[90:91], v[94:95]
    v_pk_add_f32 v[88:89], v[88:89], v[90:91]
    v_add_f32 v88, v88, v89
    v_mov_b32 v89, 0x3727c5ac
    v_fmac_f32 v89, 0x3ae38e39, v88
    v_mov_b32 v193, v89
    s_nop 1
    v_permlane16_swap_b32 v193, v89
    v_mov_b32 v195, v193
    v_mov_b32 v194, v89
    v_mov_b32 v252, v89
    v_permlane32_swap_b32 v193, v195
    s_nop 0
    v_permlane32_swap_b32 v194, v252
    v_rsq_f32 v4, v193
    v_rsq_f32 v5, v194
    v_rsq_f32 v6, v195
    v_rsq_f32 v7, v252
    v_mul_f32 v8, v4, v4
    v_mul_f32 v9, v5, v5
    v_mul_f32 v13, v6, v6
    v_mul_f32 v14, v7, v7
    v_mul_f32 v4, 0xc0135761, v4
    v_mul_f32 v5, 0xc0135761, v5
    v_mul_f32 v6, 0xc0135761, v6
    v_mul_f32 v7, 0xc0135761, v7
    v_mul_f32 v8, 0x3d372713, v8
    v_mul_f32 v9, 0x3d372713, v9
    v_mul_f32 v13, 0x3d372713, v13
    v_mul_f32 v14, 0x3d372713, v14
    v_mul_f32 v8, v8, v4
    v_mul_f32 v9, v9, v5
    v_mul_f32 v13, v13, v6
    v_mul_f32 v14, v14, v7
    s_waitcnt vmcnt(12)
    s_barrier
    ds_read_b128 a[0:3], v184 offset:0
    ds_read_b128 a[72:75], v184 offset:18432
    ds_read_b128 a[144:147], v11 offset:0
    ds_read_b128 a[216:219], v11 offset:18432
    ds_read_b128 a[4:7], v184 offset:1024
    ds_read_b128 a[76:79], v184 offset:19456
    ds_read_b128 a[148:151], v11 offset:1024
    ds_read_b128 a[220:223], v11 offset:19456
    ds_read_b128 a[8:11], v184 offset:2048
    ds_read_b128 a[80:83], v184 offset:20480
    ds_read_b128 a[152:155], v11 offset:2048
    ds_read_b128 a[224:227], v11 offset:20480
    ds_read_b128 a[12:15], v184 offset:3072
    ds_read_b128 a[84:87], v184 offset:21504
    ds_read_b128 a[156:159], v11 offset:3072
    ds_read_b128 a[228:231], v11 offset:21504
    ds_read_b128 a[16:19], v184 offset:4096
    ds_read_b128 a[88:91], v184 offset:22528
    ds_read_b128 a[160:163], v11 offset:4096
    ds_read_b128 a[232:235], v11 offset:22528
    ds_read_b128 a[20:23], v184 offset:5120
    ds_read_b128 a[92:95], v184 offset:23552
    ds_read_b128 a[164:167], v11 offset:5120
    ds_read_b128 a[236:239], v11 offset:23552
    s_waitcnt vmcnt(6)
    s_barrier
    ds_read_b128 a[24:27], v184 offset:6144
    ds_read_b128 a[96:99], v184 offset:24576
    ds_read_b128 a[168:171], v11 offset:6144
    ds_read_b128 a[240:243], v11 offset:24576
    ds_read_b128 a[28:31], v184 offset:7168
    ds_read_b128 a[100:103], v184 offset:25600
    ds_read_b128 a[172:175], v11 offset:7168
    ds_read_b128 a[244:247], v11 offset:25600
    ds_read_b128 a[32:35], v184 offset:8192
    ds_read_b128 a[104:107], v184 offset:26624
    ds_read_b128 a[176:179], v11 offset:8192
    ds_read_b128 a[248:251], v11 offset:26624
    ds_read_b128 a[36:39], v184 offset:9216
    ds_read_b128 a[108:111], v184 offset:27648
    ds_read_b128 a[180:183], v11 offset:9216
    ds_read_b128 a[252:255], v11 offset:27648
    ds_read_b128 a[40:43], v184 offset:10240
    ds_read_b128 a[112:115], v184 offset:28672
    ds_read_b128 a[184:187], v11 offset:10240
    ds_read_b128 v[220:223], v11 offset:28672
    ds_read_b128 a[44:47], v184 offset:11264
    ds_read_b128 a[116:119], v184 offset:29696
    ds_read_b128 a[188:191], v11 offset:11264
    ds_read_b128 v[224:227], v11 offset:29696
    s_waitcnt vmcnt(0)
    s_barrier
    s_cmp_lg_u32 s42, 0
    s_cbranch_scc1 L_ring_32
    buffer_load_dwordx4 v[16:19], v184, s[48:51], s23 offen offset:0 sc1
    buffer_load_dwordx4 v[20:23], v184, s[48:51], s23 offen offset:1024 sc1
    buffer_load_dwordx4 v[24:27], v184, s[48:51], s23 offen offset:2048 sc1
    buffer_load_dwordx4 v[28:31], v184, s[48:51], s23 offen offset:3072 sc1
    buffer_load_dwordx4 v[32:35], v185, s[48:51], s23 offen offset:0 sc1
    buffer_load_dwordx4 v[36:39], v185, s[48:51], s23 offen offset:1024 sc1
    buffer_load_dwordx4 v[40:43], v185, s[48:51], s23 offen offset:2048 sc1
    buffer_load_dwordx4 v[44:47], v185, s[48:51], s23 offen offset:3072 sc1
    buffer_load_dwordx4 v[48:51], v186, s[48:51], s23 offen offset:0 sc1
    buffer_load_dwordx4 v[52:55], v186, s[48:51], s23 offen offset:1024 sc1
    buffer_load_dwordx4 v[56:59], v186, s[48:51], s23 offen offset:2048 sc1
    buffer_load_dwordx4 v[60:63], v186, s[48:51], s23 offen offset:3072 sc1
    buffer_load_dwordx4 v[64:67], v187, s[48:51], s23 offen offset:0 sc1
    buffer_load_dwordx4 v[68:71], v187, s[48:51], s23 offen offset:1024 sc1
    buffer_load_dwordx4 v[72:75], v187, s[48:51], s23 offen offset:2048 sc1
L_ring_32:
    s_add_u32 s23, s23, 15360
    ds_read_b128 a[48:51], v184 offset:12288
    ds_read_b128 a[120:123], v184 offset:30720
    ds_read_b128 a[192:195], v11 offset:12288
    ds_read_b128 v[228:231], v11 offset:30720
    ds_read_b128 a[52:55], v184 offset:13312
    ds_read_b128 a[124:127], v184 offset:31744
    ds_read_b128 a[196:199], v11 offset:13312
    ds_read_b128 v[232:235], v11 offset:31744
    ds_read_b128 a[56:59], v184 offset:14336
    ds_read_b128 a[128:131], v184 offset:32768
    ds_read_b128 a[200:203], v11 offset:14336
    ds_read_b128 v[236:239], v11 offset:32768
    ds_read_b128 a[60:63], v184 offset:15360
    ds_read_b128 a[132:135], v184 offset:33792
    ds_read_b128 a[204:207], v11 offset:15360
    ds_read_b128 v[240:243], v11 offset:33792
    ds_read_b128 a[64:67], v184 offset:16384
    ds_read_b128 a[136:139], v184 offset:34816
    ds_read_b128 a[208:211], v11 offset:16384
    ds_read_b128 v[244:247], v11 offset:34816
    ds_read_b128 a[68:71], v184 offset:17408
    ds_read_b128 a[140:143], v184 offset:35840
    ds_read_b128 a[212:215], v11 offset:17408
    ds_read_b128 v[248:251], v11 offset:35840
    s_lshr_b32 s7, s3, 1
    s_lshl_b32 s7, s7, 10
    s_and_b32 s6, s3, 1
    s_lshl_b32 s6, s6, 3
    s_add_u32 s24, s7, s6
    s_add_u32 s24, s24, 73728
    s_add_u32 s7, s24, 16384
    v_add_u32 v12, s7, v184
    s_mov_b32 s25, 0
    s_waitcnt lgkmcnt(0)
L_ffn_gu_33:
    s_waitcnt vmcnt(12)
    v_mfma_f32_16x16x32_bf16 v[88:91], v[16:19], a[0:3], 0
    v_mfma_f32_16x16x32_bf16 v[88:91], v[20:23], a[4:7], v[88:91]
    buffer_load_dwordx4 v[76:79], v184, s[48:51], s23 offen offset:0 sc1
    v_mfma_f32_16x16x32_bf16 v[88:91], v[24:27], a[8:11], v[88:91]
    v_mul_f32 v152, v120, v120
    v_mul_f32 v153, v121, v121
    v_mfma_f32_16x16x32_bf16 v[92:95], v[16:19], a[72:75], 0
    v_mul_f32 v154, v122, v122
    v_mul_f32 v155, v123, v123
    v_mfma_f32_16x16x32_bf16 v[92:95], v[20:23], a[76:79], v[92:95]
    v_fma_f32 v152, v152, v8, v4
    v_fma_f32 v153, v153, v8, v4
    v_mfma_f32_16x16x32_bf16 v[92:95], v[24:27], a[80:83], v[92:95]
    buffer_load_dwordx4 v[80:83], v184, s[48:51], s23 offen offset:1024 sc1
    v_mfma_f32_16x16x32_bf16 v[96:99], v[16:19], a[144:147], 0
    v_fma_f32 v154, v154, v8, v4
    v_fma_f32 v155, v155, v8, v4
    v_mfma_f32_16x16x32_bf16 v[96:99], v[20:23], a[148:151], v[96:99]
    v_mul_f32 v152, v120, v152
    v_mul_f32 v153, v121, v153
    v_mfma_f32_16x16x32_bf16 v[96:99], v[24:27], a[152:155], v[96:99]
    v_mul_f32 v154, v122, v154
    v_mul_f32 v155, v123, v155
    v_mfma_f32_16x16x32_bf16 v[100:103], v[16:19], a[216:219], 0
    buffer_load_dwordx4 v[84:87], v184, s[48:51], s23 offen offset:2048 sc1
    v_mfma_f32_16x16x32_bf16 v[100:103], v[20:23], a[220:223], v[100:103]
    v_exp_f32 v152, v152
    v_mfma_f32_16x16x32_bf16 v[100:103], v[24:27], a[224:227], v[100:103]
    v_exp_f32 v153, v153
    s_waitcnt vmcnt(12)
    v_mfma_f32_16x16x32_bf16 v[104:107], v[28:31], a[0:3], 0
    v_exp_f32 v154, v154
    v_mfma_f32_16x16x32_bf16 v[104:107], v[32:35], a[4:7], v[104:107]
    buffer_load_dwordx4 v[16:19], v184, s[48:51], s23 offen offset:3072 sc1
    v_mfma_f32_16x16x32_bf16 v[104:107], v[36:39], a[8:11], v[104:107]
    v_exp_f32 v155, v155
    v_mfma_f32_16x16x32_bf16 v[108:111], v[28:31], a[72:75], 0
    v_mul_f32 v156, v120, v136
    v_mul_f32 v157, v121, v137
    v_mfma_f32_16x16x32_bf16 v[108:111], v[32:35], a[76:79], v[108:111]
    v_mul_f32 v158, v122, v138
    v_mul_f32 v159, v123, v139
    v_mfma_f32_16x16x32_bf16 v[108:111], v[36:39], a[80:83], v[108:111]
    buffer_load_dwordx4 v[20:23], v185, s[48:51], s23 offen offset:0 sc1
    v_mfma_f32_16x16x32_bf16 v[112:115], v[28:31], a[144:147], 0
    v_fma_f32 v152, v152, v193, v193
    v_fma_f32 v153, v153, v193, v193
    v_mfma_f32_16x16x32_bf16 v[112:115], v[32:35], a[148:151], v[112:115]
    v_fma_f32 v154, v154, v193, v193
    v_fma_f32 v155, v155, v193, v193
    v_mfma_f32_16x16x32_bf16 v[112:115], v[36:39], a[152:155], v[112:115]
    v_rcp_f32 v152, v152
    v_mfma_f32_16x16x32_bf16 v[116:119], v[28:31], a[216:219], 0
    buffer_load_dwordx4 v[24:27], v185, s[48:51], s23 offen offset:1024 sc1
    v_mfma_f32_16x16x32_bf16 v[116:119], v[32:35], a[220:223], v[116:119]
    v_rcp_f32 v153, v153
    v_mfma_f32_16x16x32_bf16 v[116:119], v[36:39], a[224:227], v[116:119]
    v_rcp_f32 v154, v154
    s_waitcnt vmcnt(12)
    v_mfma_f32_16x16x32_bf16 v[88:91], v[40:43], a[12:15], v[88:91]
    v_rcp_f32 v155, v155
    v_mfma_f32_16x16x32_bf16 v[88:91], v[44:47], a[16:19], v[88:91]
    buffer_load_dwordx4 v[28:31], v185, s[48:51], s23 offen offset:2048 sc1
    v_mfma_f32_16x16x32_bf16 v[88:91], v[48:51], a[20:23], v[88:91]
    v_mul_f32 v156, v156, v152
    v_mul_f32 v157, v157, v153
    v_mfma_f32_16x16x32_bf16 v[92:95], v[40:43], a[84:87], v[92:95]
    v_mul_f32 v158, v158, v154
    v_mul_f32 v159, v159, v155
    v_mfma_f32_16x16x32_bf16 v[92:95], v[44:47], a[88:91], v[92:95]
    v_cvt_pk_bf16_f32 v160, v156, v157
    v_cvt_pk_bf16_f32 v161, v158, v159
    v_mfma_f32_16x16x32_bf16 v[92:95], v[48:51], a[92:95], v[92:95]
    buffer_load_dwordx4 v[32:35], v185, s[48:51], s23 offen offset:3072 sc1
    v_mfma_f32_16x16x32_bf16 v[96:99], v[40:43], a[156:159], v[96:99]
    ds_write_b64 v12, v[160:161] offset:0
    v_mfma_f32_16x16x32_bf16 v[96:99], v[44:47], a[160:163], v[96:99]
    v_mul_f32 v162, v124, v124
    v_mul_f32 v163, v125, v125
    v_mfma_f32_16x16x32_bf16 v[96:99], v[48:51], a[164:167], v[96:99]
    v_mul_f32 v164, v126, v126
    v_mul_f32 v165, v127, v127
    v_mfma_f32_16x16x32_bf16 v[100:103], v[40:43], a[228:231], v[100:103]
    buffer_load_dwordx4 v[36:39], v186, s[48:51], s23 offen offset:0 sc1
    v_mfma_f32_16x16x32_bf16 v[100:103], v[44:47], a[232:235], v[100:103]
    v_fma_f32 v162, v162, v9, v5
    v_fma_f32 v163, v163, v9, v5
    v_mfma_f32_16x16x32_bf16 v[100:103], v[48:51], a[236:239], v[100:103]
    v_fma_f32 v164, v164, v9, v5
    v_fma_f32 v165, v165, v9, v5
    s_waitcnt vmcnt(12)
    v_mfma_f32_16x16x32_bf16 v[104:107], v[52:55], a[12:15], v[104:107]
    v_mul_f32 v162, v124, v162
    v_mul_f32 v163, v125, v163
    v_mfma_f32_16x16x32_bf16 v[104:107], v[56:59], a[16:19], v[104:107]
    buffer_load_dwordx4 v[40:43], v186, s[48:51], s23 offen offset:1024 sc1
    v_mfma_f32_16x16x32_bf16 v[104:107], v[60:63], a[20:23], v[104:107]
    v_mul_f32 v164, v126, v164
    v_mul_f32 v165, v127, v165
    v_mfma_f32_16x16x32_bf16 v[108:111], v[52:55], a[84:87], v[108:111]
    v_exp_f32 v162, v162
    v_mfma_f32_16x16x32_bf16 v[108:111], v[56:59], a[88:91], v[108:111]
    v_exp_f32 v163, v163
    v_mfma_f32_16x16x32_bf16 v[108:111], v[60:63], a[92:95], v[108:111]
    buffer_load_dwordx4 v[44:47], v186, s[48:51], s23 offen offset:2048 sc1
    v_mfma_f32_16x16x32_bf16 v[112:115], v[52:55], a[156:159], v[112:115]
    v_exp_f32 v164, v164
    v_mfma_f32_16x16x32_bf16 v[112:115], v[56:59], a[160:163], v[112:115]
    v_exp_f32 v165, v165
    v_mfma_f32_16x16x32_bf16 v[112:115], v[60:63], a[164:167], v[112:115]
    v_mul_f32 v166, v124, v140
    v_mul_f32 v167, v125, v141
    v_mfma_f32_16x16x32_bf16 v[116:119], v[52:55], a[228:231], v[116:119]
    buffer_load_dwordx4 v[48:51], v186, s[48:51], s23 offen offset:3072 sc1
    v_mfma_f32_16x16x32_bf16 v[116:119], v[56:59], a[232:235], v[116:119]
    v_mul_f32 v168, v126, v142
    v_mul_f32 v169, v127, v143
    v_mfma_f32_16x16x32_bf16 v[116:119], v[60:63], a[236:239], v[116:119]
    v_fma_f32 v162, v162, v194, v194
    v_fma_f32 v163, v163, v194, v194
    s_waitcnt vmcnt(12)
    v_mfma_f32_16x16x32_bf16 v[88:91], v[64:67], a[24:27], v[88:91]
    v_fma_f32 v164, v164, v194, v194
    v_fma_f32 v165, v165, v194, v194
    v_mfma_f32_16x16x32_bf16 v[88:91], v[68:71], a[28:31], v[88:91]
    buffer_load_dwordx4 v[52:55], v187, s[48:51], s23 offen offset:0 sc1
    v_mfma_f32_16x16x32_bf16 v[88:91], v[72:75], a[32:35], v[88:91]
    v_rcp_f32 v162, v162
    v_mfma_f32_16x16x32_bf16 v[92:95], v[64:67], a[96:99], v[92:95]
    v_rcp_f32 v163, v163
    v_mfma_f32_16x16x32_bf16 v[92:95], v[68:71], a[100:103], v[92:95]
    v_rcp_f32 v164, v164
    v_mfma_f32_16x16x32_bf16 v[92:95], v[72:75], a[104:107], v[92:95]
    buffer_load_dwordx4 v[56:59], v187, s[48:51], s23 offen offset:1024 sc1
    v_mfma_f32_16x16x32_bf16 v[96:99], v[64:67], a[168:171], v[96:99]
    v_rcp_f32 v165, v165
    v_mfma_f32_16x16x32_bf16 v[96:99], v[68:71], a[172:175], v[96:99]
    v_mul_f32 v166, v166, v162
    v_mul_f32 v167, v167, v163
    v_mfma_f32_16x16x32_bf16 v[96:99], v[72:75], a[176:179], v[96:99]
    v_mul_f32 v168, v168, v164
    v_mul_f32 v169, v169, v165
    v_mfma_f32_16x16x32_bf16 v[100:103], v[64:67], a[240:243], v[100:103]
    buffer_load_dwordx4 v[60:63], v187, s[48:51], s23 offen offset:2048 sc1
    v_mfma_f32_16x16x32_bf16 v[100:103], v[68:71], a[244:247], v[100:103]
    v_cvt_pk_bf16_f32 v170, v166, v167
    v_cvt_pk_bf16_f32 v171, v168, v169
    v_mfma_f32_16x16x32_bf16 v[100:103], v[72:75], a[248:251], v[100:103]
    ds_write_b64 v12, v[170:171] offset:18432
    s_waitcnt vmcnt(12)
    v_mfma_f32_16x16x32_bf16 v[104:107], v[76:79], a[24:27], v[104:107]
    v_mul_f32 v152, v128, v128
    v_mul_f32 v153, v129, v129
    v_mfma_f32_16x16x32_bf16 v[104:107], v[80:83], a[28:31], v[104:107]
    buffer_load_dwordx4 v[64:67], v187, s[48:51], s23 offen offset:3072 sc1
    v_mfma_f32_16x16x32_bf16 v[104:107], v[84:87], a[32:35], v[104:107]
    v_mul_f32 v154, v130, v130
    v_mul_f32 v155, v131, v131
    v_mfma_f32_16x16x32_bf16 v[108:111], v[76:79], a[96:99], v[108:111]
    v_fma_f32 v152, v152, v13, v6
    v_fma_f32 v153, v153, v13, v6
    v_mfma_f32_16x16x32_bf16 v[108:111], v[80:83], a[100:103], v[108:111]
    v_fma_f32 v154, v154, v13, v6
    v_fma_f32 v155, v155, v13, v6
    v_mfma_f32_16x16x32_bf16 v[108:111], v[84:87], a[104:107], v[108:111]
    buffer_load_dwordx4 v[68:71], v188, s[48:51], s23 offen offset:0 sc1
    v_mfma_f32_16x16x32_bf16 v[112:115], v[76:79], a[168:171], v[112:115]
    v_mul_f32 v152, v128, v152
    v_mul_f32 v153, v129, v153
    v_mfma_f32_16x16x32_bf16 v[112:115], v[80:83], a[172:175], v[112:115]
    v_mul_f32 v154, v130, v154
    v_mul_f32 v155, v131, v155
    v_mfma_f32_16x16x32_bf16 v[112:115], v[84:87], a[176:179], v[112:115]
    v_exp_f32 v152, v152
    v_mfma_f32_16x16x32_bf16 v[116:119], v[76:79], a[240:243], v[116:119]
    buffer_load_dwordx4 v[72:75], v188, s[48:51], s23 offen offset:1024 sc1
    v_mfma_f32_16x16x32_bf16 v[116:119], v[80:83], a[244:247], v[116:119]
    v_exp_f32 v153, v153
    v_mfma_f32_16x16x32_bf16 v[116:119], v[84:87], a[248:251], v[116:119]
    v_exp_f32 v154, v154
    s_waitcnt vmcnt(12)
    v_mfma_f32_16x16x32_bf16 v[88:91], v[16:19], a[36:39], v[88:91]
    v_exp_f32 v155, v155
    v_mfma_f32_16x16x32_bf16 v[88:91], v[20:23], a[40:43], v[88:91]
    buffer_load_dwordx4 v[76:79], v188, s[48:51], s23 offen offset:2048 sc1
    v_mfma_f32_16x16x32_bf16 v[88:91], v[24:27], a[44:47], v[88:91]
    v_mul_f32 v156, v128, v144
    v_mul_f32 v157, v129, v145
    v_mfma_f32_16x16x32_bf16 v[92:95], v[16:19], a[108:111], v[92:95]
    v_mul_f32 v158, v130, v146
    v_mul_f32 v159, v131, v147
    v_mfma_f32_16x16x32_bf16 v[92:95], v[20:23], a[112:115], v[92:95]
    v_fma_f32 v152, v152, v195, v195
    v_fma_f32 v153, v153, v195, v195
    v_mfma_f32_16x16x32_bf16 v[92:95], v[24:27], a[116:119], v[92:95]
    buffer_load_dwordx4 v[80:83], v188, s[48:51], s23 offen offset:3072 sc1
    v_mfma_f32_16x16x32_bf16 v[96:99], v[16:19], a[180:183], v[96:99]
    v_fma_f32 v154, v154, v195, v195
    v_fma_f32 v155, v155, v195, v195
    v_mfma_f32_16x16x32_bf16 v[96:99], v[20:23], a[184:187], v[96:99]
    v_rcp_f32 v152, v152
    v_mfma_f32_16x16x32_bf16 v[96:99], v[24:27], a[188:191], v[96:99]
    v_rcp_f32 v153, v153
    v_mfma_f32_16x16x32_bf16 v[100:103], v[16:19], a[252:255], v[100:103]
    buffer_load_dwordx4 v[84:87], v189, s[48:51], s23 offen offset:0 sc1
    v_mfma_f32_16x16x32_bf16 v[100:103], v[20:23], v[220:223], v[100:103]
    v_rcp_f32 v154, v154
    v_mfma_f32_16x16x32_bf16 v[100:103], v[24:27], v[224:227], v[100:103]
    v_rcp_f32 v155, v155
    s_waitcnt vmcnt(12)
    v_mfma_f32_16x16x32_bf16 v[104:107], v[28:31], a[36:39], v[104:107]
    v_mul_f32 v156, v156, v152
    v_mul_f32 v157, v157, v153
    v_mfma_f32_16x16x32_bf16 v[104:107], v[32:35], a[40:43], v[104:107]
    buffer_load_dwordx4 v[16:19], v189, s[48:51], s23 offen offset:1024 sc1
    v_mfma_f32_16x16x32_bf16 v[104:107], v[36:39], a[44:47], v[104:107]
    v_mul_f32 v158, v158, v154
    v_mul_f32 v159, v159, v155
    v_mfma_f32_16x16x32_bf16 v[108:111], v[28:31], a[108:111], v[108:111]
    v_cvt_pk_bf16_f32 v160, v156, v157
    v_cvt_pk_bf16_f32 v161, v158, v159
    v_mfma_f32_16x16x32_bf16 v[108:111], v[32:35], a[112:115], v[108:111]
    ds_write_b64 v12, v[160:161] offset:36864
    v_mfma_f32_16x16x32_bf16 v[108:111], v[36:39], a[116:119], v[108:111]
    buffer_load_dwordx4 v[20:23], v189, s[48:51], s23 offen offset:2048 sc1
    v_mfma_f32_16x16x32_bf16 v[112:115], v[28:31], a[180:183], v[112:115]
    v_mul_f32 v162, v132, v132
    v_mul_f32 v163, v133, v133
    v_mfma_f32_16x16x32_bf16 v[112:115], v[32:35], a[184:187], v[112:115]
    v_mul_f32 v164, v134, v134
    v_mul_f32 v165, v135, v135
    v_mfma_f32_16x16x32_bf16 v[112:115], v[36:39], a[188:191], v[112:115]
    v_fma_f32 v162, v162, v14, v7
    v_fma_f32 v163, v163, v14, v7
    v_mfma_f32_16x16x32_bf16 v[116:119], v[28:31], a[252:255], v[116:119]
    buffer_load_dwordx4 v[24:27], v189, s[48:51], s23 offen offset:3072 sc1
    v_mfma_f32_16x16x32_bf16 v[116:119], v[32:35], v[220:223], v[116:119]
    v_fma_f32 v164, v164, v14, v7
    v_fma_f32 v165, v165, v14, v7
    v_mfma_f32_16x16x32_bf16 v[116:119], v[36:39], v[224:227], v[116:119]
    v_mul_f32 v162, v132, v162
    v_mul_f32 v163, v133, v163
    s_waitcnt vmcnt(12)
    v_mfma_f32_16x16x32_bf16 v[88:91], v[40:43], a[48:51], v[88:91]
    v_mul_f32 v164, v134, v164
    v_mul_f32 v165, v135, v165
    v_mfma_f32_16x16x32_bf16 v[88:91], v[44:47], a[52:55], v[88:91]
    buffer_load_dwordx4 v[28:31], v190, s[48:51], s23 offen offset:0 sc1
    v_mfma_f32_16x16x32_bf16 v[88:91], v[48:51], a[56:59], v[88:91]
    v_exp_f32 v162, v162
    v_mfma_f32_16x16x32_bf16 v[92:95], v[40:43], a[120:123], v[92:95]
    v_exp_f32 v163, v163
    v_mfma_f32_16x16x32_bf16 v[92:95], v[44:47], a[124:127], v[92:95]
    v_exp_f32 v164, v164
    v_mfma_f32_16x16x32_bf16 v[92:95], v[48:51], a[128:131], v[92:95]
    buffer_load_dwordx4 v[32:35], v190, s[48:51], s23 offen offset:1024 sc1
    v_mfma_f32_16x16x32_bf16 v[96:99], v[40:43], a[192:195], v[96:99]
    v_exp_f32 v165, v165
    v_mfma_f32_16x16x32_bf16 v[96:99], v[44:47], a[196:199], v[96:99]
    v_mul_f32 v166, v132, v148
    v_mul_f32 v167, v133, v149
    v_mfma_f32_16x16x32_bf16 v[96:99], v[48:51], a[200:203], v[96:99]
    v_mul_f32 v168, v134, v150
    v_mul_f32 v169, v135, v151
    v_mfma_f32_16x16x32_bf16 v[100:103], v[40:43], v[228:231], v[100:103]
    buffer_load_dwordx4 v[36:39], v190, s[48:51], s23 offen offset:2048 sc1
    v_mfma_f32_16x16x32_bf16 v[100:103], v[44:47], v[232:235], v[100:103]
    v_fma_f32 v162, v162, v252, v252
    v_fma_f32 v163, v163, v252, v252
    v_mfma_f32_16x16x32_bf16 v[100:103], v[48:51], v[236:239], v[100:103]
    v_fma_f32 v164, v164, v252, v252
    v_fma_f32 v165, v165, v252, v252
    s_waitcnt vmcnt(12)
    v_mfma_f32_16x16x32_bf16 v[104:107], v[52:55], a[48:51], v[104:107]
    v_rcp_f32 v162, v162
    v_mfma_f32_16x16x32_bf16 v[104:107], v[56:59], a[52:55], v[104:107]
    buffer_load_dwordx4 v[40:43], v190, s[48:51], s23 offen offset:3072 sc1
    v_mfma_f32_16x16x32_bf16 v[104:107], v[60:63], a[56:59], v[104:107]
    v_rcp_f32 v163, v163
    v_mfma_f32_16x16x32_bf16 v[108:111], v[52:55], a[120:123], v[108:111]
    v_rcp_f32 v164, v164
    v_mfma_f32_16x16x32_bf16 v[108:111], v[56:59], a[124:127], v[108:111]
    v_rcp_f32 v165, v165
    v_mfma_f32_16x16x32_bf16 v[108:111], v[60:63], a[128:131], v[108:111]
    buffer_load_dwordx4 v[44:47], v191, s[48:51], s23 offen offset:0 sc1
    v_mfma_f32_16x16x32_bf16 v[112:115], v[52:55], a[192:195], v[112:115]
    v_mul_f32 v166, v166, v162
    v_mul_f32 v167, v167, v163
    v_mfma_f32_16x16x32_bf16 v[112:115], v[56:59], a[196:199], v[112:115]
    v_mul_f32 v168, v168, v164
    v_mul_f32 v169, v169, v165
    v_mfma_f32_16x16x32_bf16 v[112:115], v[60:63], a[200:203], v[112:115]
    v_cvt_pk_bf16_f32 v170, v166, v167
    v_cvt_pk_bf16_f32 v171, v168, v169
    v_mfma_f32_16x16x32_bf16 v[116:119], v[52:55], v[228:231], v[116:119]
    buffer_load_dwordx4 v[48:51], v191, s[48:51], s23 offen offset:1024 sc1
    v_mfma_f32_16x16x32_bf16 v[116:119], v[56:59], v[232:235], v[116:119]
    ds_write_b64 v12, v[170:171] offset:55296
    v_mfma_f32_16x16x32_bf16 v[116:119], v[60:63], v[236:239], v[116:119]
    s_waitcnt vmcnt(12)
    v_mfma_f32_16x16x32_bf16 v[88:91], v[64:67], a[60:63], v[88:91]
    v_mfma_f32_16x16x32_bf16 v[88:91], v[68:71], a[64:67], v[88:91]
    buffer_load_dwordx4 v[52:55], v191, s[48:51], s23 offen offset:2048 sc1
    v_mfma_f32_16x16x32_bf16 v[120:123], v[72:75], a[68:71], v[88:91]
    v_mfma_f32_16x16x32_bf16 v[92:95], v[64:67], a[132:135], v[92:95]
    v_mfma_f32_16x16x32_bf16 v[92:95], v[68:71], a[136:139], v[92:95]
    v_mfma_f32_16x16x32_bf16 v[124:127], v[72:75], a[140:143], v[92:95]
    buffer_load_dwordx4 v[56:59], v191, s[48:51], s23 offen offset:3072 sc1
    v_mfma_f32_16x16x32_bf16 v[96:99], v[64:67], a[204:207], v[96:99]
    v_mfma_f32_16x16x32_bf16 v[96:99], v[68:71], a[208:211], v[96:99]
    v_mfma_f32_16x16x32_bf16 v[128:131], v[72:75], a[212:215], v[96:99]
    v_mfma_f32_16x16x32_bf16 v[100:103], v[64:67], v[240:243], v[100:103]
    buffer_load_dwordx4 v[60:63], v192, s[48:51], s23 offen offset:0 sc1
    v_mfma_f32_16x16x32_bf16 v[100:103], v[68:71], v[244:247], v[100:103]
    v_mfma_f32_16x16x32_bf16 v[132:135], v[72:75], v[248:251], v[100:103]
    s_waitcnt vmcnt(12)
    v_mfma_f32_16x16x32_bf16 v[104:107], v[76:79], a[60:63], v[104:107]
    v_mfma_f32_16x16x32_bf16 v[104:107], v[80:83], a[64:67], v[104:107]
    buffer_load_dwordx4 v[64:67], v192, s[48:51], s23 offen offset:1024 sc1
    v_mfma_f32_16x16x32_bf16 v[136:139], v[84:87], a[68:71], v[104:107]
    v_mfma_f32_16x16x32_bf16 v[108:111], v[76:79], a[132:135], v[108:111]
    v_mfma_f32_16x16x32_bf16 v[108:111], v[80:83], a[136:139], v[108:111]
    v_mfma_f32_16x16x32_bf16 v[140:143], v[84:87], a[140:143], v[108:111]
    buffer_load_dwordx4 v[68:71], v192, s[48:51], s23 offen offset:2048 sc1
    v_mfma_f32_16x16x32_bf16 v[112:115], v[76:79], a[204:207], v[112:115]
    v_mfma_f32_16x16x32_bf16 v[112:115], v[80:83], a[208:211], v[112:115]
    s_lshl_b32 s7, s25, 11
    v_mfma_f32_16x16x32_bf16 v[144:147], v[84:87], a[212:215], v[112:115]
    s_add_u32 s7, s7, s24
    v_mfma_f32_16x16x32_bf16 v[116:119], v[76:79], v[240:243], v[116:119]
    buffer_load_dwordx4 v[72:75], v192, s[48:51], s23 offen offset:3072 sc1
    v_mfma_f32_16x16x32_bf16 v[116:119], v[80:83], v[244:247], v[116:119]
    s_add_u32 s23, s23, 36864
    v_mfma_f32_16x16x32_bf16 v[148:151], v[84:87], v[248:251], v[116:119]
    v_add_u32 v12, s7, v184
    s_add_u32 s25, s25, 1
    s_cmp_lt_u32 s25, 9
    s_cbranch_scc1 L_ffn_gu_33
    v_add_u32 v10, 73728, v184
    v_add_u32 v11, 110592, v184
    s_waitcnt lgkmcnt(0)
    s_barrier
    v_pk_mul_f32 v[152:153], v[120:121], v[120:121]
    ds_read_b128 a[0:3], v10 offset:0
    v_pk_mul_f32 v[154:155], v[122:123], v[122:123]
    ds_read_b128 a[72:75], v10 offset:18432
    v_pk_fma_f32 v[152:153], v[152:153], v[8:9], v[4:5] op_sel:[0,0,0] op_sel_hi:[1,0,0]
    ds_read_b128 a[144:147], v11 offset:0
    v_pk_fma_f32 v[154:155], v[154:155], v[8:9], v[4:5] op_sel:[0,0,0] op_sel_hi:[1,0,0]
    v_pk_mul_f32 v[152:153], v[120:121], v[152:153]
    ds_read_b128 a[216:219], v11 offset:18432
    v_pk_mul_f32 v[154:155], v[122:123], v[154:155]
    ds_read_b128 a[4:7], v10 offset:1024
    buffer_load_dwordx4 v[76:79], v184, s[48:51], s23 offen offset:0 sc1
    v_exp_f32 v152, v152
    ds_read_b128 a[76:79], v10 offset:19456
    v_exp_f32 v153, v153
    v_exp_f32 v154, v154
    ds_read_b128 a[148:151], v11 offset:1024
    v_exp_f32 v155, v155
    ds_read_b128 a[220:223], v11 offset:19456
    v_pk_mul_f32 v[156:157], v[120:121], v[136:137]
    ds_read_b128 a[8:11], v10 offset:2048
    v_pk_mul_f32 v[158:159], v[122:123], v[138:139]
    buffer_load_dwordx4 v[80:83], v184, s[48:51], s23 offen offset:1024 sc1
    v_pk_fma_f32 v[152:153], v[152:153], v[192:193], v[192:193] op_sel:[0,1,1] op_sel_hi:[1,1,1]
    ds_read_b128 a[80:83], v10 offset:20480
    v_pk_fma_f32 v[154:155], v[154:155], v[192:193], v[192:193] op_sel:[0,1,1] op_sel_hi:[1,1,1]
    ds_read_b128 a[152:155], v11 offset:2048
    v_rcp_f32 v152, v152
    ds_read_b128 a[224:227], v11 offset:20480
    v_rcp_f32 v153, v153
    v_rcp_f32 v154, v154
    ds_read_b128 a[12:15], v10 offset:3072
    v_rcp_f32 v155, v155
    ds_read_b128 a[84:87], v10 offset:21504
    buffer_load_dwordx4 v[84:87], v184, s[48:51], s23 offen offset:2048 sc1
    s_nop 0
    ds_read_b128 a[156:159], v11 offset:3072
    v_pk_mul_f32 v[156:157], v[156:157], v[152:153]
    v_pk_mul_f32 v[158:159], v[158:159], v[154:155]
    ds_read_b128 a[228:231], v11 offset:21504
    v_cvt_pk_bf16_f32 v160, v156, v157
    ds_read_b128 a[16:19], v10 offset:4096
    v_cvt_pk_bf16_f32 v161, v158, v159
    ds_read_b128 a[88:91], v10 offset:22528
    ds_write_b64 v12, v[160:161] offset:0
    buffer_load_dwordx4 v[104:107], v184, s[48:51], s23 offen offset:3072 sc1
    v_pk_mul_f32 v[162:163], v[124:125], v[124:125]
    ds_read_b128 a[160:163], v11 offset:4096
    v_pk_mul_f32 v[164:165], v[126:127], v[126:127]
    ds_read_b128 a[232:235], v11 offset:22528
    v_pk_fma_f32 v[162:163], v[162:163], v[8:9], v[4:5] op_sel:[0,1,1] op_sel_hi:[1,1,1]
    ds_read_b128 a[20:23], v10 offset:5120
    v_pk_fma_f32 v[164:165], v[164:165], v[8:9], v[4:5] op_sel:[0,1,1] op_sel_hi:[1,1,1]
    v_pk_mul_f32 v[162:163], v[124:125], v[162:163]
    ds_read_b128 a[92:95], v10 offset:23552
    v_pk_mul_f32 v[164:165], v[126:127], v[164:165]
    ds_read_b128 a[164:167], v11 offset:5120
    buffer_load_dwordx4 v[108:111], v185, s[48:51], s23 offen offset:0 sc1
    v_exp_f32 v162, v162
    ds_read_b128 a[236:239], v11 offset:23552
    v_exp_f32 v163, v163
    v_exp_f32 v164, v164
    ds_read_b128 a[24:27], v10 offset:6144
    v_exp_f32 v165, v165
    ds_read_b128 a[96:99], v10 offset:24576
    v_pk_mul_f32 v[166:167], v[124:125], v[140:141]
    ds_read_b128 a[168:171], v11 offset:6144
    v_pk_mul_f32 v[168:169], v[126:127], v[142:143]
    buffer_load_dwordx4 v[112:115], v185, s[48:51], s23 offen offset:1024 sc1
    v_pk_fma_f32 v[162:163], v[162:163], v[194:195], v[194:195] op_sel:[0,0,0] op_sel_hi:[1,0,0]
    ds_read_b128 a[240:243], v11 offset:24576
    v_pk_fma_f32 v[164:165], v[164:165], v[194:195], v[194:195] op_sel:[0,0,0] op_sel_hi:[1,0,0]
    ds_read_b128 a[28:31], v10 offset:7168
    v_rcp_f32 v162, v162
    ds_read_b128 a[100:103], v10 offset:25600
    v_rcp_f32 v163, v163
    v_rcp_f32 v164, v164
    ds_read_b128 a[172:175], v11 offset:7168
    v_rcp_f32 v165, v165
    ds_read_b128 a[244:247], v11 offset:25600
    buffer_load_dwordx4 v[116:119], v185, s[48:51], s23 offen offset:2048 sc1
    s_nop 0
    ds_read_b128 a[32:35], v10 offset:8192
    v_pk_mul_f32 v[166:167], v[166:167], v[162:163]
    v_pk_mul_f32 v[168:169], v[168:169], v[164:165]
    ds_read_b128 a[104:107], v10 offset:26624
    v_cvt_pk_bf16_f32 v170, v166, v167
    ds_read_b128 a[176:179], v11 offset:8192
    v_cvt_pk_bf16_f32 v171, v168, v169
    ds_read_b128 a[248:251], v11 offset:26624
    ds_write_b64 v12, v[170:171] offset:18432
    buffer_load_dwordx4 v[172:175], v185, s[48:51], s23 offen offset:3072 sc1
    v_pk_mul_f32 v[152:153], v[128:129], v[128:129]
    ds_read_b128 a[36:39], v10 offset:9216
    v_pk_mul_f32 v[154:155], v[130:131], v[130:131]
    ds_read_b128 a[108:111], v10 offset:27648
    v_pk_fma_f32 v[152:153], v[152:153], v[12:13], v[6:7] op_sel:[0,1,0] op_sel_hi:[1,1,0]
    ds_read_b128 a[180:183], v11 offset:9216
    v_pk_fma_f32 v[154:155], v[154:155], v[12:13], v[6:7] op_sel:[0,1,0] op_sel_hi:[1,1,0]
    v_pk_mul_f32 v[152:153], v[128:129], v[152:153]
    ds_read_b128 a[252:255], v11 offset:27648
    v_pk_mul_f32 v[154:155], v[130:131], v[154:155]
    ds_read_b128 a[40:43], v10 offset:10240
    buffer_load_dwordx4 v[176:179], v186, s[48:51], s23 offen offset:0 sc1
    v_exp_f32 v152, v152
    ds_read_b128 a[112:115], v10 offset:28672
    v_exp_f32 v153, v153
    v_exp_f32 v154, v154
    ds_read_b128 a[184:187], v11 offset:10240
    v_exp_f32 v155, v155
    ds_read_b128 v[220:223], v11 offset:28672
    v_pk_mul_f32 v[156:157], v[128:129], v[144:145]
    ds_read_b128 a[44:47], v10 offset:11264
    v_pk_mul_f32 v[158:159], v[130:131], v[146:147]
    buffer_load_dwordx4 v[180:183], v186, s[48:51], s23 offen offset:1024 sc1
    v_pk_fma_f32 v[152:153], v[152:153], v[194:195], v[194:195] op_sel:[0,1,1] op_sel_hi:[1,1,1]
    ds_read_b128 a[116:119], v10 offset:29696
    v_pk_fma_f32 v[154:155], v[154:155], v[194:195], v[194:195] op_sel:[0,1,1] op_sel_hi:[1,1,1]
    ds_read_b128 a[188:191], v11 offset:11264
    v_rcp_f32 v152, v152
    ds_read_b128 v[224:227], v11 offset:29696
    v_rcp_f32 v153, v153
    v_rcp_f32 v154, v154
    ds_read_b128 a[48:51], v10 offset:12288
    v_rcp_f32 v155, v155
    ds_read_b128 a[120:123], v10 offset:30720
    buffer_load_dwordx4 v[196:199], v186, s[48:51], s23 offen offset:2048 sc1
    s_nop 0
    ds_read_b128 a[192:195], v11 offset:12288
    v_pk_mul_f32 v[156:157], v[156:157], v[152:153]
    v_pk_mul_f32 v[158:159], v[158:159], v[154:155]
    ds_read_b128 v[228:231], v11 offset:30720
    v_cvt_pk_bf16_f32 v160, v156, v157
    ds_read_b128 a[52:55], v10 offset:13312
    v_cvt_pk_bf16_f32 v161, v158, v159
    ds_read_b128 a[124:127], v10 offset:31744
    ds_write_b64 v12, v[160:161] offset:36864
    buffer_load_dwordx4 v[200:203], v186, s[48:51], s23 offen offset:3072 sc1
    v_pk_mul_f32 v[162:163], v[132:133], v[132:133]
    ds_read_b128 a[196:199], v11 offset:13312
    v_pk_mul_f32 v[164:165], v[134:135], v[134:135]
    ds_read_b128 v[232:235], v11 offset:31744
    v_pk_fma_f32 v[162:163], v[162:163], v[14:15], v[6:7] op_sel:[0,0,1] op_sel_hi:[1,0,1]
    ds_read_b128 a[56:59], v10 offset:14336
    v_pk_fma_f32 v[164:165], v[164:165], v[14:15], v[6:7] op_sel:[0,0,1] op_sel_hi:[1,0,1]
    v_pk_mul_f32 v[162:163], v[132:133], v[162:163]
    ds_read_b128 a[128:131], v10 offset:32768
    v_pk_mul_f32 v[164:165], v[134:135], v[164:165]
    ds_read_b128 a[200:203], v11 offset:14336
    buffer_load_dwordx4 v[204:207], v187, s[48:51], s23 offen offset:0 sc1
    v_exp_f32 v162, v162
    ds_read_b128 v[236:239], v11 offset:32768
    v_exp_f32 v163, v163
    v_exp_f32 v164, v164
    ds_read_b128 a[60:63], v10 offset:15360
    v_exp_f32 v165, v165
    ds_read_b128 a[132:135], v10 offset:33792
    v_pk_mul_f32 v[166:167], v[132:133], v[148:149]
    ds_read_b128 a[204:207], v11 offset:15360
    v_pk_mul_f32 v[168:169], v[134:135], v[150:151]
    buffer_load_dwordx4 v[208:211], v187, s[48:51], s23 offen offset:1024 sc1
    v_pk_fma_f32 v[162:163], v[162:163], v[252:253], v[252:253] op_sel:[0,0,0] op_sel_hi:[1,0,0]
    ds_read_b128 v[240:243], v11 offset:33792
    v_pk_fma_f32 v[164:165], v[164:165], v[252:253], v[252:253] op_sel:[0,0,0] op_sel_hi:[1,0,0]
    v_rcp_f32 v162, v162
    v_rcp_f32 v163, v163
    v_rcp_f32 v164, v164
    v_rcp_f32 v165, v165
    buffer_load_dwordx4 v[212:215], v187, s[48:51], s23 offen offset:2048 sc1
    s_nop 0
    v_pk_mul_f32 v[166:167], v[166:167], v[162:163]
    v_pk_mul_f32 v[168:169], v[168:169], v[164:165]
    v_cvt_pk_bf16_f32 v170, v166, v167
    v_cvt_pk_bf16_f32 v171, v168, v169
    ds_write_b64 v12, v[170:171] offset:55296
    buffer_load_dwordx4 v[216:219], v187, s[48:51], s23 offen offset:3072 sc1
    buffer_load_dwordx4 v[136:139], v188, s[48:51], s23 offen offset:0 sc1
    buffer_load_dwordx4 v[140:143], v188, s[48:51], s23 offen offset:1024 sc1
    s_add_u32 s23, s23, 18432
    v_bfe_u32 v1, v0, 3, 2
    s_mov_b32 s7, 73728
    v_mul_lo_u32 v2, v1, s7
    v_lshrrev_b32 v1, 5, v0
    v_lshl_add_u32 v2, v1, 7, v2
    v_and_b32 v1, 7, v0
    v_lshl_add_u32 v2, v1, 4, v2
    v_add_u32 v3, 294912, v2
    s_mul_i32 s26, s41, 589824
    s_add_u32 s26, s26, s43
    s_mul_i32 s7, s40, 9216
    s_add_u32 s26, s26, s7
    s_mul_i32 s7, s3, 2304
    s_add_u32 s26, s26, s7
    s_add_u32 s26, s26, 29360128
    s_add_u32 s27, s26, 2048
    s_waitcnt lgkmcnt(0)
    s_barrier
    ds_read_b128 a[64:67], v10 offset:16384
    ds_read_b128 a[136:139], v10 offset:34816
    ds_read_b128 a[208:211], v11 offset:16384
    ds_read_b128 v[244:247], v11 offset:34816
    ds_read_b128 a[68:71], v10 offset:17408
    ds_read_b128 a[140:143], v10 offset:35840
    ds_read_b128 a[212:215], v11 offset:17408
    ds_read_b128 v[248:251], v11 offset:35840
    s_mov_b32 s25, 0
    s_waitcnt lgkmcnt(0)
    s_branch L_ffn_dn_mid_35
L_ffn_dn_34:
    s_waitcnt vmcnt(32)
    v_mfma_f32_16x16x32_bf16 v[88:91], v[104:107], a[0:3], 0
    v_mfma_f32_16x16x32_bf16 v[88:91], v[108:111], a[4:7], v[88:91]
    buffer_load_dwordx4 v[76:79], v184, s[48:51], s23 offen offset:0 sc1
    v_mfma_f32_16x16x32_bf16 v[88:91], v[112:115], a[8:11], v[88:91]
    v_mfma_f32_16x16x32_bf16 v[92:95], v[104:107], a[72:75], 0
    v_mfma_f32_16x16x32_bf16 v[92:95], v[108:111], a[76:79], v[92:95]
    v_mfma_f32_16x16x32_bf16 v[92:95], v[112:115], a[80:83], v[92:95]
    buffer_load_dwordx4 v[80:83], v184, s[48:51], s23 offen offset:1024 sc1
    v_mfma_f32_16x16x32_bf16 v[96:99], v[104:107], a[144:147], 0
    v_cvt_pk_bf16_f32 v152, v120, v121
    v_cvt_pk_bf16_f32 v153, v122, v123
    v_mfma_f32_16x16x32_bf16 v[96:99], v[108:111], a[148:151], v[96:99]
    v_cvt_pk_bf16_f32 v154, v124, v125
    v_cvt_pk_bf16_f32 v155, v126, v127
    v_mfma_f32_16x16x32_bf16 v[96:99], v[112:115], a[152:155], v[96:99]
    v_cvt_pk_bf16_f32 v156, v128, v129
    v_cvt_pk_bf16_f32 v157, v130, v131
    v_mfma_f32_16x16x32_bf16 v[100:103], v[104:107], a[216:219], 0
    buffer_load_dwordx4 v[84:87], v184, s[48:51], s23 offen offset:2048 sc1
    v_mfma_f32_16x16x32_bf16 v[100:103], v[108:111], a[220:223], v[100:103]
    v_cvt_pk_bf16_f32 v158, v132, v133
    v_cvt_pk_bf16_f32 v159, v134, v135
    v_mfma_f32_16x16x32_bf16 v[100:103], v[112:115], a[224:227], v[100:103]
    v_permlane16_swap_b32 v152, v154
    s_waitcnt vmcnt(32)
    v_mfma_f32_16x16x32_bf16 v[88:91], v[116:119], a[12:15], v[88:91]
    v_permlane16_swap_b32 v153, v155
    v_mfma_f32_16x16x32_bf16 v[88:91], v[172:175], a[16:19], v[88:91]
    buffer_load_dwordx4 v[104:107], v184, s[48:51], s23 offen offset:3072 sc1
    v_mfma_f32_16x16x32_bf16 v[88:91], v[176:179], a[20:23], v[88:91]
    v_permlane16_swap_b32 v156, v158
    v_mfma_f32_16x16x32_bf16 v[92:95], v[116:119], a[84:87], v[92:95]
    v_permlane16_swap_b32 v157, v159
    v_mfma_f32_16x16x32_bf16 v[92:95], v[172:175], a[88:91], v[92:95]
    buffer_store_dwordx4 v[152:155], v2, s[8:11], s27 offen sc1
    v_mfma_f32_16x16x32_bf16 v[92:95], v[176:179], a[92:95], v[92:95]
    buffer_load_dwordx4 v[108:111], v185, s[48:51], s23 offen offset:0 sc1
    v_mfma_f32_16x16x32_bf16 v[96:99], v[116:119], a[156:159], v[96:99]
    buffer_store_dwordx4 v[156:159], v3, s[8:11], s27 offen sc1
    v_mfma_f32_16x16x32_bf16 v[96:99], v[172:175], a[160:163], v[96:99]
    v_mfma_f32_16x16x32_bf16 v[96:99], v[176:179], a[164:167], v[96:99]
    v_mfma_f32_16x16x32_bf16 v[100:103], v[116:119], a[228:231], v[100:103]
    buffer_load_dwordx4 v[112:115], v185, s[48:51], s23 offen offset:1024 sc1
    v_mfma_f32_16x16x32_bf16 v[100:103], v[172:175], a[232:235], v[100:103]
    v_mfma_f32_16x16x32_bf16 v[100:103], v[176:179], a[236:239], v[100:103]
    s_waitcnt vmcnt(34)
    v_mfma_f32_16x16x32_bf16 v[88:91], v[180:183], a[24:27], v[88:91]
    v_mfma_f32_16x16x32_bf16 v[88:91], v[196:199], a[28:31], v[88:91]
    buffer_load_dwordx4 v[116:119], v185, s[48:51], s23 offen offset:2048 sc1
    v_mfma_f32_16x16x32_bf16 v[88:91], v[200:203], a[32:35], v[88:91]
    v_mfma_f32_16x16x32_bf16 v[92:95], v[180:183], a[96:99], v[92:95]
    v_mfma_f32_16x16x32_bf16 v[92:95], v[196:199], a[100:103], v[92:95]
    v_mfma_f32_16x16x32_bf16 v[92:95], v[200:203], a[104:107], v[92:95]
    buffer_load_dwordx4 v[172:175], v185, s[48:51], s23 offen offset:3072 sc1
    v_mfma_f32_16x16x32_bf16 v[96:99], v[180:183], a[168:171], v[96:99]
    v_mfma_f32_16x16x32_bf16 v[96:99], v[196:199], a[172:175], v[96:99]
    v_mfma_f32_16x16x32_bf16 v[96:99], v[200:203], a[176:179], v[96:99]
    v_mfma_f32_16x16x32_bf16 v[100:103], v[180:183], a[240:243], v[100:103]
    buffer_load_dwordx4 v[176:179], v186, s[48:51], s23 offen offset:0 sc1
    v_mfma_f32_16x16x32_bf16 v[100:103], v[196:199], a[244:247], v[100:103]
    v_mfma_f32_16x16x32_bf16 v[100:103], v[200:203], a[248:251], v[100:103]
    s_waitcnt vmcnt(34)
    v_mfma_f32_16x16x32_bf16 v[88:91], v[204:207], a[36:39], v[88:91]
    v_mfma_f32_16x16x32_bf16 v[88:91], v[208:211], a[40:43], v[88:91]
    buffer_load_dwordx4 v[180:183], v186, s[48:51], s23 offen offset:1024 sc1
    v_mfma_f32_16x16x32_bf16 v[88:91], v[212:215], a[44:47], v[88:91]
    v_mfma_f32_16x16x32_bf16 v[92:95], v[204:207], a[108:111], v[92:95]
    v_mfma_f32_16x16x32_bf16 v[92:95], v[208:211], a[112:115], v[92:95]
    v_mfma_f32_16x16x32_bf16 v[92:95], v[212:215], a[116:119], v[92:95]
    buffer_load_dwordx4 v[196:199], v186, s[48:51], s23 offen offset:2048 sc1
    v_mfma_f32_16x16x32_bf16 v[96:99], v[204:207], a[180:183], v[96:99]
    v_mfma_f32_16x16x32_bf16 v[96:99], v[208:211], a[184:187], v[96:99]
    v_mfma_f32_16x16x32_bf16 v[96:99], v[212:215], a[188:191], v[96:99]
    v_mfma_f32_16x16x32_bf16 v[100:103], v[204:207], a[252:255], v[100:103]
    buffer_load_dwordx4 v[200:203], v186, s[48:51], s23 offen offset:3072 sc1
    v_mfma_f32_16x16x32_bf16 v[100:103], v[208:211], v[220:223], v[100:103]
    v_mfma_f32_16x16x32_bf16 v[100:103], v[212:215], v[224:227], v[100:103]
    s_waitcnt vmcnt(34)
    v_mfma_f32_16x16x32_bf16 v[88:91], v[216:219], a[48:51], v[88:91]
    v_mfma_f32_16x16x32_bf16 v[88:91], v[136:139], a[52:55], v[88:91]
    buffer_load_dwordx4 v[204:207], v187, s[48:51], s23 offen offset:0 sc1
    v_mfma_f32_16x16x32_bf16 v[88:91], v[140:143], a[56:59], v[88:91]
    v_mfma_f32_16x16x32_bf16 v[92:95], v[216:219], a[120:123], v[92:95]
    v_mfma_f32_16x16x32_bf16 v[92:95], v[136:139], a[124:127], v[92:95]
    v_mfma_f32_16x16x32_bf16 v[92:95], v[140:143], a[128:131], v[92:95]
    buffer_load_dwordx4 v[208:211], v187, s[48:51], s23 offen offset:1024 sc1
    v_mfma_f32_16x16x32_bf16 v[96:99], v[216:219], a[192:195], v[96:99]
    v_mfma_f32_16x16x32_bf16 v[96:99], v[136:139], a[196:199], v[96:99]
    v_mfma_f32_16x16x32_bf16 v[96:99], v[140:143], a[200:203], v[96:99]
    v_mfma_f32_16x16x32_bf16 v[100:103], v[216:219], v[228:231], v[100:103]
    buffer_load_dwordx4 v[212:215], v187, s[48:51], s23 offen offset:2048 sc1
    v_mfma_f32_16x16x32_bf16 v[100:103], v[136:139], v[232:235], v[100:103]
    v_mfma_f32_16x16x32_bf16 v[100:103], v[140:143], v[236:239], v[100:103]
    s_waitcnt vmcnt(34)
    v_mfma_f32_16x16x32_bf16 v[88:91], v[144:147], a[60:63], v[88:91]
    v_mfma_f32_16x16x32_bf16 v[88:91], v[148:151], a[64:67], v[88:91]
    buffer_load_dwordx4 v[216:219], v187, s[48:51], s23 offen offset:3072 sc1
    v_mfma_f32_16x16x32_bf16 v[120:123], v[160:163], a[68:71], v[88:91]
    v_mfma_f32_16x16x32_bf16 v[92:95], v[144:147], a[132:135], v[92:95]
    v_mfma_f32_16x16x32_bf16 v[92:95], v[148:151], a[136:139], v[92:95]
    v_mfma_f32_16x16x32_bf16 v[124:127], v[160:163], a[140:143], v[92:95]
    buffer_load_dwordx4 v[136:139], v188, s[48:51], s23 offen offset:0 sc1
    v_mfma_f32_16x16x32_bf16 v[96:99], v[144:147], a[204:207], v[96:99]
    s_lshl_b32 s7, s25, 8
    v_mfma_f32_16x16x32_bf16 v[96:99], v[148:151], a[208:211], v[96:99]
    s_add_u32 s27, s26, s7
    v_mfma_f32_16x16x32_bf16 v[128:131], v[160:163], a[212:215], v[96:99]
    s_add_u32 s25, s25, 1
    v_mfma_f32_16x16x32_bf16 v[100:103], v[144:147], v[240:243], v[100:103]
    buffer_load_dwordx4 v[140:143], v188, s[48:51], s23 offen offset:1024 sc1
    v_mfma_f32_16x16x32_bf16 v[100:103], v[148:151], v[244:247], v[100:103]
    s_add_u32 s23, s23, 18432
    v_mfma_f32_16x16x32_bf16 v[132:135], v[160:163], v[248:251], v[100:103]
L_ffn_dn_mid_35:
    s_waitcnt vmcnt(30)
    v_mfma_f32_16x16x32_bf16 v[88:91], v[16:19], a[0:3], 0
    v_mfma_f32_16x16x32_bf16 v[88:91], v[20:23], a[4:7], v[88:91]
    buffer_load_dwordx4 v[144:147], v184, s[48:51], s23 offen offset:0 sc1
    v_mfma_f32_16x16x32_bf16 v[88:91], v[24:27], a[8:11], v[88:91]
    v_mfma_f32_16x16x32_bf16 v[92:95], v[16:19], a[72:75], 0
    v_mfma_f32_16x16x32_bf16 v[92:95], v[20:23], a[76:79], v[92:95]
    v_mfma_f32_16x16x32_bf16 v[92:95], v[24:27], a[80:83], v[92:95]
    buffer_load_dwordx4 v[148:151], v184, s[48:51], s23 offen offset:1024 sc1
    v_mfma_f32_16x16x32_bf16 v[96:99], v[16:19], a[144:147], 0
    v_cvt_pk_bf16_f32 v152, v120, v121
    v_cvt_pk_bf16_f32 v153, v122, v123
    v_mfma_f32_16x16x32_bf16 v[96:99], v[20:23], a[148:151], v[96:99]
    v_cvt_pk_bf16_f32 v154, v124, v125
    v_cvt_pk_bf16_f32 v155, v126, v127
    v_mfma_f32_16x16x32_bf16 v[96:99], v[24:27], a[152:155], v[96:99]
    v_cvt_pk_bf16_f32 v156, v128, v129
    v_cvt_pk_bf16_f32 v157, v130, v131
    v_mfma_f32_16x16x32_bf16 v[100:103], v[16:19], a[216:219], 0
    buffer_load_dwordx4 v[160:163], v184, s[48:51], s23 offen offset:2048 sc1
    v_mfma_f32_16x16x32_bf16 v[100:103], v[20:23], a[220:223], v[100:103]
    v_cvt_pk_bf16_f32 v158, v132, v133
    v_cvt_pk_bf16_f32 v159, v134, v135
    v_mfma_f32_16x16x32_bf16 v[100:103], v[24:27], a[224:227], v[100:103]
    v_permlane16_swap_b32 v152, v154
    s_waitcnt vmcnt(30)
    v_mfma_f32_16x16x32_bf16 v[88:91], v[28:31], a[12:15], v[88:91]
    v_permlane16_swap_b32 v153, v155
    v_mfma_f32_16x16x32_bf16 v[88:91], v[32:35], a[16:19], v[88:91]
    buffer_load_dwordx4 v[16:19], v184, s[48:51], s23 offen offset:3072 sc1
    v_mfma_f32_16x16x32_bf16 v[88:91], v[36:39], a[20:23], v[88:91]
    v_permlane16_swap_b32 v156, v158
    v_mfma_f32_16x16x32_bf16 v[92:95], v[28:31], a[84:87], v[92:95]
    v_permlane16_swap_b32 v157, v159
    v_mfma_f32_16x16x32_bf16 v[92:95], v[32:35], a[88:91], v[92:95]
    buffer_store_dwordx4 v[152:155], v2, s[8:11], s27 offen sc1
    v_mfma_f32_16x16x32_bf16 v[92:95], v[36:39], a[92:95], v[92:95]
    buffer_load_dwordx4 v[20:23], v185, s[48:51], s23 offen offset:0 sc1
    v_mfma_f32_16x16x32_bf16 v[96:99], v[28:31], a[156:159], v[96:99]
    buffer_store_dwordx4 v[156:159], v3, s[8:11], s27 offen sc1
    v_mfma_f32_16x16x32_bf16 v[96:99], v[32:35], a[160:163], v[96:99]
    v_mfma_f32_16x16x32_bf16 v[96:99], v[36:39], a[164:167], v[96:99]
    v_mfma_f32_16x16x32_bf16 v[100:103], v[28:31], a[228:231], v[100:103]
    buffer_load_dwordx4 v[24:27], v185, s[48:51], s23 offen offset:1024 sc1
    v_mfma_f32_16x16x32_bf16 v[100:103], v[32:35], a[232:235], v[100:103]
    v_mfma_f32_16x16x32_bf16 v[100:103], v[36:39], a[236:239], v[100:103]
    s_waitcnt vmcnt(32)
    v_mfma_f32_16x16x32_bf16 v[88:91], v[40:43], a[24:27], v[88:91]
    v_mfma_f32_16x16x32_bf16 v[88:91], v[44:47], a[28:31], v[88:91]
    buffer_load_dwordx4 v[28:31], v185, s[48:51], s23 offen offset:2048 sc1
    v_mfma_f32_16x16x32_bf16 v[88:91], v[48:51], a[32:35], v[88:91]
    v_mfma_f32_16x16x32_bf16 v[92:95], v[40:43], a[96:99], v[92:95]
    v_mfma_f32_16x16x32_bf16 v[92:95], v[44:47], a[100:103], v[92:95]
    v_mfma_f32_16x16x32_bf16 v[92:95], v[48:51], a[104:107], v[92:95]
    buffer_load_dwordx4 v[32:35], v185, s[48:51], s23 offen offset:3072 sc1
    v_mfma_f32_16x16x32_bf16 v[96:99], v[40:43], a[168:171], v[96:99]
    v_mfma_f32_16x16x32_bf16 v[96:99], v[44:47], a[172:175], v[96:99]
    v_mfma_f32_16x16x32_bf16 v[96:99], v[48:51], a[176:179], v[96:99]
    v_mfma_f32_16x16x32_bf16 v[100:103], v[40:43], a[240:243], v[100:103]
    buffer_load_dwordx4 v[36:39], v186, s[48:51], s23 offen offset:0 sc1
    v_mfma_f32_16x16x32_bf16 v[100:103], v[44:47], a[244:247], v[100:103]
    v_mfma_f32_16x16x32_bf16 v[100:103], v[48:51], a[248:251], v[100:103]
    s_waitcnt vmcnt(32)
    v_mfma_f32_16x16x32_bf16 v[88:91], v[52:55], a[36:39], v[88:91]
    v_mfma_f32_16x16x32_bf16 v[88:91], v[56:59], a[40:43], v[88:91]
    buffer_load_dwordx4 v[40:43], v186, s[48:51], s23 offen offset:1024 sc1
    v_mfma_f32_16x16x32_bf16 v[88:91], v[60:63], a[44:47], v[88:91]
    v_mfma_f32_16x16x32_bf16 v[92:95], v[52:55], a[108:111], v[92:95]
    v_mfma_f32_16x16x32_bf16 v[92:95], v[56:59], a[112:115], v[92:95]
    v_mfma_f32_16x16x32_bf16 v[92:95], v[60:63], a[116:119], v[92:95]
    buffer_load_dwordx4 v[44:47], v186, s[48:51], s23 offen offset:2048 sc1
    v_mfma_f32_16x16x32_bf16 v[96:99], v[52:55], a[180:183], v[96:99]
    v_mfma_f32_16x16x32_bf16 v[96:99], v[56:59], a[184:187], v[96:99]
    v_mfma_f32_16x16x32_bf16 v[96:99], v[60:63], a[188:191], v[96:99]
    v_mfma_f32_16x16x32_bf16 v[100:103], v[52:55], a[252:255], v[100:103]
    buffer_load_dwordx4 v[48:51], v186, s[48:51], s23 offen offset:3072 sc1
    v_mfma_f32_16x16x32_bf16 v[100:103], v[56:59], v[220:223], v[100:103]
    v_mfma_f32_16x16x32_bf16 v[100:103], v[60:63], v[224:227], v[100:103]
    s_waitcnt vmcnt(32)
    v_mfma_f32_16x16x32_bf16 v[88:91], v[64:67], a[48:51], v[88:91]
    v_mfma_f32_16x16x32_bf16 v[88:91], v[68:71], a[52:55], v[88:91]
    buffer_load_dwordx4 v[52:55], v187, s[48:51], s23 offen offset:0 sc1
    v_mfma_f32_16x16x32_bf16 v[88:91], v[72:75], a[56:59], v[88:91]
    v_mfma_f32_16x16x32_bf16 v[92:95], v[64:67], a[120:123], v[92:95]
    v_mfma_f32_16x16x32_bf16 v[92:95], v[68:71], a[124:127], v[92:95]
    v_mfma_f32_16x16x32_bf16 v[92:95], v[72:75], a[128:131], v[92:95]
    buffer_load_dwordx4 v[56:59], v187, s[48:51], s23 offen offset:1024 sc1
    v_mfma_f32_16x16x32_bf16 v[96:99], v[64:67], a[192:195], v[96:99]
    v_mfma_f32_16x16x32_bf16 v[96:99], v[68:71], a[196:199], v[96:99]
    v_mfma_f32_16x16x32_bf16 v[96:99], v[72:75], a[200:203], v[96:99]
    v_mfma_f32_16x16x32_bf16 v[100:103], v[64:67], v[228:231], v[100:103]
    buffer_load_dwordx4 v[60:63], v187, s[48:51], s23 offen offset:2048 sc1
    v_mfma_f32_16x16x32_bf16 v[100:103], v[68:71], v[232:235], v[100:103]
    v_mfma_f32_16x16x32_bf16 v[100:103], v[72:75], v[236:239], v[100:103]
    s_waitcnt vmcnt(32)
    v_mfma_f32_16x16x32_bf16 v[88:91], v[76:79], a[60:63], v[88:91]
    v_mfma_f32_16x16x32_bf16 v[88:91], v[80:83], a[64:67], v[88:91]
    buffer_load_dwordx4 v[64:67], v187, s[48:51], s23 offen offset:3072 sc1
    v_mfma_f32_16x16x32_bf16 v[120:123], v[84:87], a[68:71], v[88:91]
    v_mfma_f32_16x16x32_bf16 v[92:95], v[76:79], a[132:135], v[92:95]
    v_mfma_f32_16x16x32_bf16 v[92:95], v[80:83], a[136:139], v[92:95]
    v_mfma_f32_16x16x32_bf16 v[124:127], v[84:87], a[140:143], v[92:95]
    buffer_load_dwordx4 v[68:71], v188, s[48:51], s23 offen offset:0 sc1
    v_mfma_f32_16x16x32_bf16 v[96:99], v[76:79], a[204:207], v[96:99]
    s_lshl_b32 s7, s25, 8
    v_mfma_f32_16x16x32_bf16 v[96:99], v[80:83], a[208:211], v[96:99]
    s_add_u32 s27, s26, s7
    v_mfma_f32_16x16x32_bf16 v[128:131], v[84:87], a[212:215], v[96:99]
    s_add_u32 s25, s25, 1
    v_mfma_f32_16x16x32_bf16 v[100:103], v[76:79], v[240:243], v[100:103]
    buffer_load_dwordx4 v[72:75], v188, s[48:51], s23 offen offset:1024 sc1
    v_mfma_f32_16x16x32_bf16 v[100:103], v[80:83], v[244:247], v[100:103]
    s_add_u32 s23, s23, 18432
    v_mfma_f32_16x16x32_bf16 v[132:135], v[84:87], v[248:251], v[100:103]
    s_cmp_lt_u32 s25, 9
    s_cbranch_scc1 L_ffn_dn_34
    s_nop 7
    v_cvt_pk_bf16_f32 v152, v120, v121
    v_cvt_pk_bf16_f32 v153, v122, v123
    v_cvt_pk_bf16_f32 v154, v124, v125
    v_cvt_pk_bf16_f32 v155, v126, v127
    v_cvt_pk_bf16_f32 v156, v128, v129
    v_cvt_pk_bf16_f32 v157, v130, v131
    v_cvt_pk_bf16_f32 v158, v132, v133
    v_cvt_pk_bf16_f32 v159, v134, v135
    s_nop 1
    v_permlane16_swap_b32 v152, v154
    v_permlane16_swap_b32 v153, v155
    v_permlane16_swap_b32 v156, v158
    v_permlane16_swap_b32 v157, v159
    buffer_store_dwordx4 v[152:155], v2, s[8:11], s27 offen sc1
    buffer_store_dwordx4 v[156:159], v3, s[8:11], s27 offen sc1
    v_lshlrev_b32 v15, 7, v0
    s_lshl_b32 s6, s40, 2
    s_add_u32 s6, s6, s44
    s_add_u32 s6, s6, 65536
    v_mov_b32 v1, s76
    s_mov_b64 vcc, 0xff
    s_waitcnt vmcnt(0)
    s_barrier
    s_cmp_lg_u32 s3, 0
    s_cbranch_scc1 L_pub_36
    s_mov_b64 exec, vcc
    buffer_store_dword v1, v15, s[8:11], s6 offen sc1
L_pub_36:
    s_mov_b64 exec, -1
    s_mov_b32 s16, 0xffff0000
    s_lshl_b32 s7, s3, 10
    v_lshl_add_u32 v2, v0, 4, s7
    v_add_u32 v3, 4096, v2
    v_and_b32 v8, 7, v0
    v_mul_u32_u24 v8, 1152, v8
    v_lshrrev_b32 v9, 3, v0
    v_lshl_add_u32 v8, v9, 4, v8
    s_lshl_b32 s7, s3, 7
    v_add_u32 v5, s7, v8
    v_add_u32 v6, 512, v5
    s_cmp_eq_u32 s3, 0
    s_mov_b32 s17, 1073741824
    s_cmov_b32 s17, 8192
    v_add_u32 v4, s17, v2
    s_mov_b32 s17, 1073741824
    s_cmov_b32 s17, 1024
    v_add_u32 v7, s17, v5
    s_lshl_b32 s21, s41, 3
    s_add_u32 s21, s21, s40
    s_mul_i32 s18, s21, 9216
    s_add_u32 s19, s18, s43
    s_add_u32 s22, s19, 48234496
    s_mul_i32 s20, s21, 73728
    s_add_u32 s20, s20, s43
    s_add_u32 s20, s20, 29360128
    s_lshl_b32 s23, s21, 5
    s_add_u32 s23, s23, s43
    s_add_u32 s23, s23, 24641536
    v_and_b32 v8, 7, v0
    v_lshlrev_b32 v8, 2, v8
    buffer_load_dword v10, v8, s[8:11], s23 offen sc1
    buffer_load_dwordx4 v[16:19], v2, s[8:11], s22 offen sc1
    buffer_load_dwordx4 v[20:23], v3, s[8:11], s22 offen sc1
    buffer_load_dwordx4 v[24:27], v4, s[8:11], s22 offen sc1
    s_cmp_eq_u32 s3, 0
    s_cselect_b32 s7, 1.0, 0
    s_waitcnt vmcnt(0)
    v_mul_f32 v11, s7, v10
    v_lshlrev_b32 v124, 16, v16
    v_and_b32 v125, s16, v16
    v_lshlrev_b32 v126, 16, v17
    v_and_b32 v127, s16, v17
    v_lshlrev_b32 v128, 16, v18
    v_and_b32 v129, s16, v18
    v_lshlrev_b32 v130, 16, v19
    v_and_b32 v131, s16, v19
    v_pk_add_f32 v[124:125], v[124:125], v[10:11] op_sel_hi:[1,0]
    v_pk_add_f32 v[126:127], v[126:127], v[10:11] op_sel_hi:[1,0]
    v_pk_add_f32 v[128:129], v[128:129], v[10:11] op_sel_hi:[1,0]
    v_pk_add_f32 v[130:131], v[130:131], v[10:11] op_sel_hi:[1,0]
    v_lshlrev_b32 v132, 16, v20
    v_and_b32 v133, s16, v20
    v_lshlrev_b32 v134, 16, v21
    v_and_b32 v135, s16, v21
    v_lshlrev_b32 v136, 16, v22
    v_and_b32 v137, s16, v22
    v_lshlrev_b32 v138, 16, v23
    v_and_b32 v139, s16, v23
    v_pk_add_f32 v[132:133], v[132:133], v[10:11] op_sel_hi:[1,0]
    v_pk_add_f32 v[134:135], v[134:135], v[10:11] op_sel_hi:[1,0]
    v_pk_add_f32 v[136:137], v[136:137], v[10:11] op_sel_hi:[1,0]
    v_pk_add_f32 v[138:139], v[138:139], v[10:11] op_sel_hi:[1,0]
    v_lshlrev_b32 v140, 16, v24
    v_and_b32 v141, s16, v24
    v_lshlrev_b32 v142, 16, v25
    v_and_b32 v143, s16, v25
    v_lshlrev_b32 v144, 16, v26
    v_and_b32 v145, s16, v26
    v_lshlrev_b32 v146, 16, v27
    v_and_b32 v147, s16, v27
    v_pk_add_f32 v[140:141], v[140:141], v[10:11] op_sel:[0,1] op_sel_hi:[1,1]
    v_pk_add_f32 v[142:143], v[142:143], v[10:11] op_sel:[0,1] op_sel_hi:[1,1]
    v_pk_add_f32 v[144:145], v[144:145], v[10:11] op_sel:[0,1] op_sel_hi:[1,1]
    v_pk_add_f32 v[146:147], v[146:147], v[10:11] op_sel:[0,1] op_sel_hi:[1,1]
    s_cmp_lg_u32 s3, 0
    s_cbranch_scc1 L_pollout_39
    s_lshl_b32 s7, s40, 7
    s_add_u32 s7, s7, s44
    s_add_u32 s7, s7, 65536
    s_add_u32 s52, s4, s7
    s_addc_u32 s53, s5, 0
    s_mov_b32 s6, 0
L_poll_37:
    s_load_dwordx8 s[56:63], s[52:53], 0 glc
    s_add_u32 s6, s6, 1
    s_waitcnt lgkmcnt(0)
    s_xor_b64 s[56:57], s[56:57], s[76:77]
    s_xor_b64 s[58:59], s[58:59], s[76:77]
    s_xor_b64 s[60:61], s[60:61], s[76:77]
    s_xor_b64 s[62:63], s[62:63], s[76:77]
    s_or_b64 s[56:57], s[56:57], s[58:59]
    s_or_b64 s[60:61], s[60:61], s[62:63]
    s_or_b64 s[56:57], s[56:57], s[60:61]
    s_cbranch_scc0 L_polled_38
    s_cmp_lt_u32 s6, 1048576
    s_cbranch_scc1 L_poll_37
    s_branch L_main_end
L_polled_38:
L_pollout_39:
    s_barrier
    buffer_load_dwordx4 v[28:31], v2, s[8:11], s20 offen sc1
    buffer_load_dwordx4 v[32:35], v3, s[8:11], s20 offen sc1
    buffer_load_dwordx4 v[36:39], v4, s[8:11], s20 offen sc1
    s_add_u32 s20, s20, 9216
    buffer_load_dwordx4 v[40:43], v2, s[8:11], s20 offen sc1
    buffer_load_dwordx4 v[44:47], v3, s[8:11], s20 offen sc1
    buffer_load_dwordx4 v[48:51], v4, s[8:11], s20 offen sc1
    s_add_u32 s20, s20, 9216
    buffer_load_dwordx4 v[52:55], v2, s[8:11], s20 offen sc1
    buffer_load_dwordx4 v[56:59], v3, s[8:11], s20 offen sc1
    s_waitcnt vmcnt(7)
    buffer_load_dwordx4 v[60:63], v4, s[8:11], s20 offen sc1
    s_add_u32 s20, s20, 9216
    v_lshlrev_b32 v148, 16, v28
    v_and_b32 v149, s16, v28
    v_lshlrev_b32 v150, 16, v29
    v_and_b32 v151, s16, v29
    v_lshlrev_b32 v152, 16, v30
    v_and_b32 v153, s16, v30
    v_lshlrev_b32 v154, 16, v31
    v_and_b32 v155, s16, v31
    v_pk_add_f32 v[124:125], v[124:125], v[148:149]
    v_pk_add_f32 v[126:127], v[126:127], v[150:151]
    v_pk_add_f32 v[128:129], v[128:129], v[152:153]
    v_pk_add_f32 v[130:131], v[130:131], v[154:155]
    s_waitcnt vmcnt(7)
    buffer_load_dwordx4 v[64:67], v2, s[8:11], s20 offen sc1
    v_lshlrev_b32 v148, 16, v32
    v_and_b32 v149, s16, v32
    v_lshlrev_b32 v150, 16, v33
    v_and_b32 v151, s16, v33
    v_lshlrev_b32 v152, 16, v34
    v_and_b32 v153, s16, v34
    v_lshlrev_b32 v154, 16, v35
    v_and_b32 v155, s16, v35
    v_pk_add_f32 v[132:133], v[132:133], v[148:149]
    v_pk_add_f32 v[134:135], v[134:135], v[150:151]
    v_pk_add_f32 v[136:137], v[136:137], v[152:153]
    v_pk_add_f32 v[138:139], v[138:139], v[154:155]
    s_waitcnt vmcnt(7)
    buffer_load_dwordx4 v[68:71], v3, s[8:11], s20 offen sc1
    v_lshlrev_b32 v148, 16, v36
    v_and_b32 v149, s16, v36
    v_lshlrev_b32 v150, 16, v37
    v_and_b32 v151, s16, v37
    v_lshlrev_b32 v152, 16, v38
    v_and_b32 v153, s16, v38
    v_lshlrev_b32 v154, 16, v39
    v_and_b32 v155, s16, v39
    v_pk_add_f32 v[140:141], v[140:141], v[148:149]
    v_pk_add_f32 v[142:143], v[142:143], v[150:151]
    v_pk_add_f32 v[144:145], v[144:145], v[152:153]
    v_pk_add_f32 v[146:147], v[146:147], v[154:155]
    s_waitcnt vmcnt(7)
    buffer_load_dwordx4 v[72:75], v4, s[8:11], s20 offen sc1
    s_add_u32 s20, s20, 9216
    v_lshlrev_b32 v148, 16, v40
    v_and_b32 v149, s16, v40
    v_lshlrev_b32 v150, 16, v41
    v_and_b32 v151, s16, v41
    v_lshlrev_b32 v152, 16, v42
    v_and_b32 v153, s16, v42
    v_lshlrev_b32 v154, 16, v43
    v_and_b32 v155, s16, v43
    v_pk_add_f32 v[124:125], v[124:125], v[148:149]
    v_pk_add_f32 v[126:127], v[126:127], v[150:151]
    v_pk_add_f32 v[128:129], v[128:129], v[152:153]
    v_pk_add_f32 v[130:131], v[130:131], v[154:155]
    s_waitcnt vmcnt(7)
    buffer_load_dwordx4 v[76:79], v2, s[8:11], s20 offen sc1
    v_lshlrev_b32 v148, 16, v44
    v_and_b32 v149, s16, v44
    v_lshlrev_b32 v150, 16, v45
    v_and_b32 v151, s16, v45
    v_lshlrev_b32 v152, 16, v46
    v_and_b32 v153, s16, v46
    v_lshlrev_b32 v154, 16, v47
    v_and_b32 v155, s16, v47
    v_pk_add_f32 v[132:133], v[132:133], v[148:149]
    v_pk_add_f32 v[134:135], v[134:135], v[150:151]
    v_pk_add_f32 v[136:137], v[136:137], v[152:153]
    v_pk_add_f32 v[138:139], v[138:139], v[154:155]
    s_waitcnt vmcnt(7)
    buffer_load_dwordx4 v[80:83], v3, s[8:11], s20 offen sc1
    v_lshlrev_b32 v148, 16, v48
    v_and_b32 v149, s16, v48
    v_lshlrev_b32 v150, 16, v49
    v_and_b32 v151, s16, v49
    v_lshlrev_b32 v152, 16, v50
    v_and_b32 v153, s16, v50
    v_lshlrev_b32 v154, 16, v51
    v_and_b32 v155, s16, v51
    v_pk_add_f32 v[140:141], v[140:141], v[148:149]
    v_pk_add_f32 v[142:143], v[142:143], v[150:151]
    v_pk_add_f32 v[144:145], v[144:145], v[152:153]
    v_pk_add_f32 v[146:147], v[146:147], v[154:155]
    s_waitcnt vmcnt(7)
    buffer_load_dwordx4 v[84:87], v4, s[8:11], s20 offen sc1
    s_add_u32 s20, s20, 9216
    v_lshlrev_b32 v148, 16, v52
    v_and_b32 v149, s16, v52
    v_lshlrev_b32 v150, 16, v53
    v_and_b32 v151, s16, v53
    v_lshlrev_b32 v152, 16, v54
    v_and_b32 v153, s16, v54
    v_lshlrev_b32 v154, 16, v55
    v_and_b32 v155, s16, v55
    v_pk_add_f32 v[124:125], v[124:125], v[148:149]
    v_pk_add_f32 v[126:127], v[126:127], v[150:151]
    v_pk_add_f32 v[128:129], v[128:129], v[152:153]
    v_pk_add_f32 v[130:131], v[130:131], v[154:155]
    s_waitcnt vmcnt(7)
    buffer_load_dwordx4 v[88:91], v2, s[8:11], s20 offen sc1
    v_lshlrev_b32 v148, 16, v56
    v_and_b32 v149, s16, v56
    v_lshlrev_b32 v150, 16, v57
    v_and_b32 v151, s16, v57
    v_lshlrev_b32 v152, 16, v58
    v_and_b32 v153, s16, v58
    v_lshlrev_b32 v154, 16, v59
    v_and_b32 v155, s16, v59
    v_pk_add_f32 v[132:133], v[132:133], v[148:149]
    v_pk_add_f32 v[134:135], v[134:135], v[150:151]
    v_pk_add_f32 v[136:137], v[136:137], v[152:153]
    v_pk_add_f32 v[138:139], v[138:139], v[154:155]
    s_waitcnt vmcnt(7)
    buffer_load_dwordx4 v[92:95], v3, s[8:11], s20 offen sc1
    v_lshlrev_b32 v148, 16, v60
    v_and_b32 v149, s16, v60
    v_lshlrev_b32 v150, 16, v61
    v_and_b32 v151, s16, v61
    v_lshlrev_b32 v152, 16, v62
    v_and_b32 v153, s16, v62
    v_lshlrev_b32 v154, 16, v63
    v_and_b32 v155, s16, v63
    v_pk_add_f32 v[140:141], v[140:141], v[148:149]
    v_pk_add_f32 v[142:143], v[142:143], v[150:151]
    v_pk_add_f32 v[144:145], v[144:145], v[152:153]
    v_pk_add_f32 v[146:147], v[146:147], v[154:155]
    s_waitcnt vmcnt(7)
    buffer_load_dwordx4 v[96:99], v4, s[8:11], s20 offen sc1
    s_add_u32 s20, s20, 9216
    v_lshlrev_b32 v148, 16, v64
    v_and_b32 v149, s16, v64
    v_lshlrev_b32 v150, 16, v65
    v_and_b32 v151, s16, v65
    v_lshlrev_b32 v152, 16, v66
    v_and_b32 v153, s16, v66
    v_lshlrev_b32 v154, 16, v67
    v_and_b32 v155, s16, v67
    v_pk_add_f32 v[124:125], v[124:125], v[148:149]
    v_pk_add_f32 v[126:127], v[126:127], v[150:151]
    v_pk_add_f32 v[128:129], v[128:129], v[152:153]
    v_pk_add_f32 v[130:131], v[130:131], v[154:155]
    s_waitcnt vmcnt(7)
    buffer_load_dwordx4 v[100:103], v2, s[8:11], s20 offen sc1
    v_lshlrev_b32 v148, 16, v68
    v_and_b32 v149, s16, v68
    v_lshlrev_b32 v150, 16, v69
    v_and_b32 v151, s16, v69
    v_lshlrev_b32 v152, 16, v70
    v_and_b32 v153, s16, v70
    v_lshlrev_b32 v154, 16, v71
    v_and_b32 v155, s16, v71
    v_pk_add_f32 v[132:133], v[132:133], v[148:149]
    v_pk_add_f32 v[134:135], v[134:135], v[150:151]
    v_pk_add_f32 v[136:137], v[136:137], v[152:153]
    v_pk_add_f32 v[138:139], v[138:139], v[154:155]
    s_waitcnt vmcnt(7)
    buffer_load_dwordx4 v[104:107], v3, s[8:11], s20 offen sc1
    v_lshlrev_b32 v148, 16, v72
    v_and_b32 v149, s16, v72
    v_lshlrev_b32 v150, 16, v73
    v_and_b32 v151, s16, v73
    v_lshlrev_b32 v152, 16, v74
    v_and_b32 v153, s16, v74
    v_lshlrev_b32 v154, 16, v75
    v_and_b32 v155, s16, v75
    v_pk_add_f32 v[140:141], v[140:141], v[148:149]
    v_pk_add_f32 v[142:143], v[142:143], v[150:151]
    v_pk_add_f32 v[144:145], v[144:145], v[152:153]
    v_pk_add_f32 v[146:147], v[146:147], v[154:155]
    s_waitcnt vmcnt(7)
    buffer_load_dwordx4 v[108:111], v4, s[8:11], s20 offen sc1
    s_add_u32 s20, s20, 9216
    v_lshlrev_b32 v148, 16, v76
    v_and_b32 v149, s16, v76
    v_lshlrev_b32 v150, 16, v77
    v_and_b32 v151, s16, v77
    v_lshlrev_b32 v152, 16, v78
    v_and_b32 v153, s16, v78
    v_lshlrev_b32 v154, 16, v79
    v_and_b32 v155, s16, v79
    v_pk_add_f32 v[124:125], v[124:125], v[148:149]
    v_pk_add_f32 v[126:127], v[126:127], v[150:151]
    v_pk_add_f32 v[128:129], v[128:129], v[152:153]
    v_pk_add_f32 v[130:131], v[130:131], v[154:155]
    s_waitcnt vmcnt(7)
    buffer_load_dwordx4 v[112:115], v2, s[8:11], s20 offen sc1
    v_lshlrev_b32 v148, 16, v80
    v_and_b32 v149, s16, v80
    v_lshlrev_b32 v150, 16, v81
    v_and_b32 v151, s16, v81
    v_lshlrev_b32 v152, 16, v82
    v_and_b32 v153, s16, v82
    v_lshlrev_b32 v154, 16, v83
    v_and_b32 v155, s16, v83
    v_pk_add_f32 v[132:133], v[132:133], v[148:149]
    v_pk_add_f32 v[134:135], v[134:135], v[150:151]
    v_pk_add_f32 v[136:137], v[136:137], v[152:153]
    v_pk_add_f32 v[138:139], v[138:139], v[154:155]
    s_waitcnt vmcnt(7)
    buffer_load_dwordx4 v[116:119], v3, s[8:11], s20 offen sc1
    v_lshlrev_b32 v148, 16, v84
    v_and_b32 v149, s16, v84
    v_lshlrev_b32 v150, 16, v85
    v_and_b32 v151, s16, v85
    v_lshlrev_b32 v152, 16, v86
    v_and_b32 v153, s16, v86
    v_lshlrev_b32 v154, 16, v87
    v_and_b32 v155, s16, v87
    v_pk_add_f32 v[140:141], v[140:141], v[148:149]
    v_pk_add_f32 v[142:143], v[142:143], v[150:151]
    v_pk_add_f32 v[144:145], v[144:145], v[152:153]
    v_pk_add_f32 v[146:147], v[146:147], v[154:155]
    s_waitcnt vmcnt(7)
    buffer_load_dwordx4 v[120:123], v4, s[8:11], s20 offen sc1
    v_lshlrev_b32 v148, 16, v88
    v_and_b32 v149, s16, v88
    v_lshlrev_b32 v150, 16, v89
    v_and_b32 v151, s16, v89
    v_lshlrev_b32 v152, 16, v90
    v_and_b32 v153, s16, v90
    v_lshlrev_b32 v154, 16, v91
    v_and_b32 v155, s16, v91
    s_lshl_b32 s28, s40, 2
    s_add_u32 s28, s28, s3
    s_mul_i32 s28, s28, 73728
    s_mul_i32 s7, s42, 1073741824
    v_add_u32 v1, s7, v253
    buffer_load_dwordx4 a[0:3], v1, s[8:11], s28 offen offset:0 sc1
    v_pk_add_f32 v[124:125], v[124:125], v[148:149]
    v_pk_add_f32 v[126:127], v[126:127], v[150:151]
    v_pk_add_f32 v[128:129], v[128:129], v[152:153]
    v_pk_add_f32 v[130:131], v[130:131], v[154:155]
    s_waitcnt vmcnt(8)
    buffer_load_dwordx4 a[4:7], v1, s[8:11], s28 offen offset:1024 sc1
    v_lshlrev_b32 v148, 16, v92
    v_and_b32 v149, s16, v92
    v_lshlrev_b32 v150, 16, v93
    v_and_b32 v151, s16, v93
    v_lshlrev_b32 v152, 16, v94
    v_and_b32 v153, s16, v94
    v_lshlrev_b32 v154, 16, v95
    v_and_b32 v155, s16, v95
    buffer_load_dwordx4 a[8:11], v1, s[8:11], s28 offen offset:2048 sc1
    v_pk_add_f32 v[132:133], v[132:133], v[148:149]
    v_pk_add_f32 v[134:135], v[134:135], v[150:151]
    v_pk_add_f32 v[136:137], v[136:137], v[152:153]
    v_pk_add_f32 v[138:139], v[138:139], v[154:155]
    s_waitcnt vmcnt(9)
    buffer_load_dwordx4 a[12:15], v1, s[8:11], s28 offen offset:3072 sc1
    v_lshlrev_b32 v148, 16, v96
    v_and_b32 v149, s16, v96
    v_lshlrev_b32 v150, 16, v97
    v_and_b32 v151, s16, v97
    v_lshlrev_b32 v152, 16, v98
    v_and_b32 v153, s16, v98
    v_lshlrev_b32 v154, 16, v99
    v_and_b32 v155, s16, v99
    s_add_u32 s28, s28, 4096
    buffer_load_dwordx4 a[16:19], v1, s[8:11], s28 offen offset:0 sc1
    v_pk_add_f32 v[140:141], v[140:141], v[148:149]
    v_pk_add_f32 v[142:143], v[142:143], v[150:151]
    v_pk_add_f32 v[144:145], v[144:145], v[152:153]
    v_pk_add_f32 v[146:147], v[146:147], v[154:155]
    s_waitcnt vmcnt(10)
    buffer_load_dwordx4 a[20:23], v1, s[8:11], s28 offen offset:1024 sc1
    v_lshlrev_b32 v148, 16, v100
    v_and_b32 v149, s16, v100
    v_lshlrev_b32 v150, 16, v101
    v_and_b32 v151, s16, v101
    v_lshlrev_b32 v152, 16, v102
    v_and_b32 v153, s16, v102
    v_lshlrev_b32 v154, 16, v103
    v_and_b32 v155, s16, v103
    buffer_load_dwordx4 a[24:27], v1, s[8:11], s28 offen offset:2048 sc1
    v_pk_add_f32 v[124:125], v[124:125], v[148:149]
    v_pk_add_f32 v[126:127], v[126:127], v[150:151]
    v_pk_add_f32 v[128:129], v[128:129], v[152:153]
    v_pk_add_f32 v[130:131], v[130:131], v[154:155]
    s_waitcnt vmcnt(11)
    buffer_load_dwordx4 a[28:31], v1, s[8:11], s28 offen offset:3072 sc1
    v_lshlrev_b32 v148, 16, v104
    v_and_b32 v149, s16, v104
    v_lshlrev_b32 v150, 16, v105
    v_and_b32 v151, s16, v105
    v_lshlrev_b32 v152, 16, v106
    v_and_b32 v153, s16, v106
    v_lshlrev_b32 v154, 16, v107
    v_and_b32 v155, s16, v107
    s_add_u32 s28, s28, 4096
    buffer_load_dwordx4 a[32:35], v1, s[8:11], s28 offen offset:0 sc1
    v_pk_add_f32 v[132:133], v[132:133], v[148:149]
    v_pk_add_f32 v[134:135], v[134:135], v[150:151]
    v_pk_add_f32 v[136:137], v[136:137], v[152:153]
    v_pk_add_f32 v[138:139], v[138:139], v[154:155]
    s_waitcnt vmcnt(12)
    buffer_load_dwordx4 a[36:39], v1, s[8:11], s28 offen offset:1024 sc1
    v_lshlrev_b32 v148, 16, v108
    v_and_b32 v149, s16, v108
    v_lshlrev_b32 v150, 16, v109
    v_and_b32 v151, s16, v109
    v_lshlrev_b32 v152, 16, v110
    v_and_b32 v153, s16, v110
    v_lshlrev_b32 v154, 16, v111
    v_and_b32 v155, s16, v111
    buffer_load_dwordx4 a[40:43], v1, s[8:11], s28 offen offset:2048 sc1
    v_pk_add_f32 v[140:141], v[140:141], v[148:149]
    v_pk_add_f32 v[142:143], v[142:143], v[150:151]
    v_pk_add_f32 v[144:145], v[144:145], v[152:153]
    v_pk_add_f32 v[146:147], v[146:147], v[154:155]
    s_waitcnt vmcnt(13)
    buffer_load_dwordx4 a[44:47], v1, s[8:11], s28 offen offset:3072 sc1
    v_lshlrev_b32 v148, 16, v112
    v_and_b32 v149, s16, v112
    v_lshlrev_b32 v150, 16, v113
    v_and_b32 v151, s16, v113
    v_lshlrev_b32 v152, 16, v114
    v_and_b32 v153, s16, v114
    v_lshlrev_b32 v154, 16, v115
    v_and_b32 v155, s16, v115
    s_add_u32 s28, s28, 4096
    buffer_load_dwordx4 a[48:51], v1, s[8:11], s28 offen offset:0 sc1
    v_pk_add_f32 v[124:125], v[124:125], v[148:149]
    v_pk_add_f32 v[126:127], v[126:127], v[150:151]
    v_pk_add_f32 v[128:129], v[128:129], v[152:153]
    v_pk_add_f32 v[130:131], v[130:131], v[154:155]
    s_waitcnt vmcnt(14)
    buffer_load_dwordx4 a[52:55], v1, s[8:11], s28 offen offset:1024 sc1
    v_lshlrev_b32 v148, 16, v116
    v_and_b32 v149, s16, v116
    v_lshlrev_b32 v150, 16, v117
    v_and_b32 v151, s16, v117
    v_lshlrev_b32 v152, 16, v118
    v_and_b32 v153, s16, v118
    v_lshlrev_b32 v154, 16, v119
    v_and_b32 v155, s16, v119
    buffer_load_dwordx4 a[56:59], v1, s[8:11], s28 offen offset:2048 sc1
    v_pk_add_f32 v[132:133], v[132:133], v[148:149]
    v_pk_add_f32 v[134:135], v[134:135], v[150:151]
    v_pk_add_f32 v[136:137], v[136:137], v[152:153]
    v_pk_add_f32 v[138:139], v[138:139], v[154:155]
    s_waitcnt vmcnt(15)
    buffer_load_dwordx4 a[60:63], v1, s[8:11], s28 offen offset:3072 sc1
    v_lshlrev_b32 v148, 16, v120
    v_and_b32 v149, s16, v120
    v_lshlrev_b32 v150, 16, v121
    v_and_b32 v151, s16, v121
    v_lshlrev_b32 v152, 16, v122
    v_and_b32 v153, s16, v122
    v_lshlrev_b32 v154, 16, v123
    v_and_b32 v155, s16, v123
    s_add_u32 s28, s28, 4096
    buffer_load_dwordx4 a[64:67], v1, s[8:11], s28 offen offset:0 sc1
    v_pk_add_f32 v[140:141], v[140:141], v[148:149]
    v_pk_add_f32 v[142:143], v[142:143], v[150:151]
    v_pk_add_f32 v[144:145], v[144:145], v[152:153]
    v_pk_add_f32 v[146:147], v[146:147], v[154:155]
    buffer_load_dwordx4 a[68:71], v1, s[8:11], s28 offen offset:1024 sc1
    buffer_load_dwordx4 a[72:75], v1, s[8:11], s28 offen offset:2048 sc1
    buffer_load_dwordx4 a[76:79], v1, s[8:11], s28 offen offset:3072 sc1
    s_add_u32 s28, s28, 4096
    buffer_load_dwordx4 a[80:83], v1, s[8:11], s28 offen offset:0 sc1
    buffer_load_dwordx4 a[84:87], v1, s[8:11], s28 offen offset:1024 sc1
    buffer_load_dwordx4 a[88:91], v1, s[8:11], s28 offen offset:2048 sc1
    buffer_load_dwordx4 a[92:95], v1, s[8:11], s28 offen offset:3072 sc1
    s_add_u32 s28, s28, 4096
    v_cvt_pk_bf16_f32 v156, v124, v125
    v_cvt_pk_bf16_f32 v157, v126, v127
    v_cvt_pk_bf16_f32 v158, v128, v129
    v_cvt_pk_bf16_f32 v159, v130, v131
    v_cvt_pk_bf16_f32 v160, v132, v133
    v_cvt_pk_bf16_f32 v161, v134, v135
    v_cvt_pk_bf16_f32 v162, v136, v137
    v_cvt_pk_bf16_f32 v163, v138, v139
    v_cvt_pk_bf16_f32 v164, v140, v141
    v_cvt_pk_bf16_f32 v165, v142, v143
    v_cvt_pk_bf16_f32 v166, v144, v145
    v_cvt_pk_bf16_f32 v167, v146, v147
    s_cmp_lg_u32 s42, 0
    s_cbranch_scc1 L_main_last
    s_add_u32 s19, s18, 60555264
    s_add_u32 s20, s18, 53477376
    s_lshl_b32 s22, s21, 7
    s_add_u32 s22, s22, 84148224
    buffer_store_dwordx4 v[156:159], v2, s[8:11], s19 offen sc1
    buffer_store_dwordx4 v[160:163], v3, s[8:11], s19 offen sc1
    buffer_store_dwordx4 v[164:167], v4, s[8:11], s19 offen sc1
    s_mov_b32 s17, 0x3f803f80
    v_mov_b32 v8, 0
    v_mov_b32 v9, 0
    v_mov_b32 v10, 0
    v_mov_b32 v11, 0
    v_dot2c_f32_bf16 v8, s17, v156
    v_dot2c_f32_bf16 v9, v156, v156
    v_dot2c_f32_bf16 v10, s17, v157
    v_dot2c_f32_bf16 v11, v157, v157
    v_dot2c_f32_bf16 v8, s17, v158
    v_dot2c_f32_bf16 v9, v158, v158
    v_dot2c_f32_bf16 v10, s17, v159
    v_dot2c_f32_bf16 v11, v159, v159
    v_dot2c_f32_bf16 v8, s17, v160
    v_dot2c_f32_bf16 v9, v160, v160
    v_dot2c_f32_bf16 v10, s17, v161
    v_dot2c_f32_bf16 v11, v161, v161
    v_dot2c_f32_bf16 v8, s17, v162
    v_dot2c_f32_bf16 v9, v162, v162
    v_dot2c_f32_bf16 v10, s17, v163
    v_dot2c_f32_bf16 v11, v163, v163
    v_dot2c_f32_bf16 v8, s17, v164
    v_dot2c_f32_bf16 v9, v164, v164
    v_dot2c_f32_bf16 v10, s17, v165
    v_dot2c_f32_bf16 v11, v165, v165
    v_dot2c_f32_bf16 v8, s17, v166
    v_dot2c_f32_bf16 v9, v166, v166
    v_dot2c_f32_bf16 v10, s17, v167
    v_dot2c_f32_bf16 v11, v167, v167
    v_and_b32 v12, 7, v0
    v_lshlrev_b32 v12, 3, v12
    s_lshl_b32 s7, s3, 6
    v_add_u32 v13, s7, v12
    v_pk_add_f32 v[8:9], v[8:9], v[10:11]
    s_nop 1
    v_add_f32_dpp v8, v8, v8 row_ror:8 row_mask:0xf bank_mask:0xf
    v_add_f32_dpp v9, v9, v9 row_ror:8 row_mask:0xf bank_mask:0xf
    v_mov_b32 v10, v8
    v_mov_b32 v11, v9
    s_nop 1
    v_permlane32_swap_b32 v10, v8
    v_permlane32_swap_b32 v11, v9
    v_add_f32 v8, v8, v10
    v_add_f32 v9, v9, v11
    v_mov_b32 v10, v8
    v_mov_b32 v11, v9
    s_nop 1
    v_permlane16_swap_b32 v10, v8
    v_permlane16_swap_b32 v11, v9
    v_add_f32 v8, v8, v10
    v_add_f32 v9, v9, v11
    ds_write_b64 v13, v[8:9]
    s_waitcnt lgkmcnt(0)
    s_barrier
    ds_read_b64 v[40:41], v12 offset:0
    ds_read_b64 v[42:43], v12 offset:64
    ds_read_b64 v[44:45], v12 offset:128
    ds_read_b64 v[46:47], v12 offset:192
    s_waitcnt lgkmcnt(0)
    v_pk_add_f32 v[40:41], v[40:41], v[42:43]
    v_pk_add_f32 v[44:45], v[44:45], v[46:47]
    v_pk_add_f32 v[8:9], v[40:41], v[44:45]
    v_mul_f32 v8, 0x3ae38e39, v8
    v_mul_f32 v9, 0x3ae38e39, v9
    v_fma_f32 v9, -v8, v8, v9
    v_max_f32 v9, 0, v9
    v_add_f32 v9, 0x3727c5ac, v9
    v_rsq_f32 v10, v9
    s_nop 0
    v_mul_f32 v12, v8, v10
    v_mov_b32 v11, v10
    v_sub_f32 v12, 0, v12
    v_mov_b32 v13, v12
    s_cmp_eq_u32 s3, 0
    s_cselect_b32 s7, 32, 0
    v_lshlrev_b32 v14, 2, v0
    v_cmp_gt_u32 vcc, s7, v0
    v_mov_b32 v9, 1073741824
    s_nop 0
    v_cndmask_b32 v14, v9, v14, vcc
    buffer_store_dword v8, v14, s[8:11], s22 offen sc1
    v_lshlrev_b32 v40, 16, v156
    v_and_b32 v41, s16, v156
    v_lshlrev_b32 v42, 16, v157
    v_and_b32 v43, s16, v157
    v_lshlrev_b32 v44, 16, v158
    v_and_b32 v45, s16, v158
    v_lshlrev_b32 v46, 16, v159
    v_and_b32 v47, s16, v159
    v_pk_fma_f32 v[40:41], v[40:41], v[10:11], v[12:13]
    v_pk_fma_f32 v[42:43], v[42:43], v[10:11], v[12:13]
    v_pk_fma_f32 v[44:45], v[44:45], v[10:11], v[12:13]
    v_pk_fma_f32 v[46:47], v[46:47], v[10:11], v[12:13]
    v_cvt_pk_bf16_f32 v48, v40, v41
    v_cvt_pk_bf16_f32 v49, v42, v43
    v_cvt_pk_bf16_f32 v50, v44, v45
    v_cvt_pk_bf16_f32 v51, v46, v47
    v_lshlrev_b32 v40, 16, v160
    v_and_b32 v41, s16, v160
    v_lshlrev_b32 v42, 16, v161
    v_and_b32 v43, s16, v161
    v_lshlrev_b32 v44, 16, v162
    v_and_b32 v45, s16, v162
    v_lshlrev_b32 v46, 16, v163
    v_and_b32 v47, s16, v163
    v_pk_fma_f32 v[40:41], v[40:41], v[10:11], v[12:13]
    v_pk_fma_f32 v[42:43], v[42:43], v[10:11], v[12:13]
    v_pk_fma_f32 v[44:45], v[44:45], v[10:11], v[12:13]
    v_pk_fma_f32 v[46:47], v[46:47], v[10:11], v[12:13]
    v_cvt_pk_bf16_f32 v52, v40, v41
    v_cvt_pk_bf16_f32 v53, v42, v43
    v_cvt_pk_bf16_f32 v54, v44, v45
    v_cvt_pk_bf16_f32 v55, v46, v47
    v_lshlrev_b32 v40, 16, v164
    v_and_b32 v41, s16, v164
    v_lshlrev_b32 v42, 16, v165
    v_and_b32 v43, s16, v165
    v_lshlrev_b32 v44, 16, v166
    v_and_b32 v45, s16, v166
    v_lshlrev_b32 v46, 16, v167
    v_and_b32 v47, s16, v167
    v_pk_fma_f32 v[40:41], v[40:41], v[10:11], v[12:13]
    v_pk_fma_f32 v[42:43], v[42:43], v[10:11], v[12:13]
    v_pk_fma_f32 v[44:45], v[44:45], v[10:11], v[12:13]
    v_pk_fma_f32 v[46:47], v[46:47], v[10:11], v[12:13]
    v_cvt_pk_bf16_f32 v56, v40, v41
    v_cvt_pk_bf16_f32 v57, v42, v43
    v_cvt_pk_bf16_f32 v58, v44, v45
    v_cvt_pk_bf16_f32 v59, v46, v47
    buffer_store_dwordx4 v[48:51], v2, s[8:11], s20 offen sc1
    buffer_store_dwordx4 v[52:55], v3, s[8:11], s20 offen sc1
    buffer_store_dwordx4 v[56:59], v4, s[8:11], s20 offen sc1
    v_lshlrev_b32 v15, 7, v0
    s_lshl_b32 s6, s40, 2
    s_add_u32 s6, s6, s44
    s_add_u32 s6, s6, 98304
    v_mov_b32 v1, s76
    s_mov_b64 vcc, 0xff
    v_lshrrev_b32 v14, 3, v0
    v_lshl_add_u32 v15, v14, 3, v15
    s_cmp_ge_u32 s40, 6
    s_cselect_b32 s7, s41, 31
    s_cmp_lt_u32 s7, 31
    s_cmov_b64 vcc, 0xffff
    s_waitcnt vmcnt(0)
    s_barrier
    s_cmp_lg_u32 s3, 0
    s_cbranch_scc1 L_pub_40
    s_mov_b64 exec, vcc
    buffer_store_dword v1, v15, s[8:11], s6 offen sc1
L_pub_40:
    s_mov_b64 exec, -1
    s_mov_b32 s42, 1
    s_mov_b32 s43, 33554432
    s_add_u32 s44, s44, 131072
    s_mov_b32 s74, 0
    s_branch L_main_layer
L_main_last:
    buffer_store_dwordx4 v[156:159], v5, s[12:15], s18 offen
    buffer_store_dwordx4 v[160:163], v6, s[12:15], s18 offen
    buffer_store_dwordx4 v[164:167], v7, s[12:15], s18 offen
    s_or_b32 s7, s40, s41
    s_or_b32 s7, s7, s3
    s_cbranch_scc1 L_done_41
    v_mov_b32 v1, s76
    s_mov_b32 s7, 19660800
    s_mov_b64 exec, 1
    buffer_store_dword v1, off, s[8:11], s7 sc1
    s_mov_b64 exec, -1
L_done_41:
L_main_end:
    s_endpgm
.section .rodata,"a"
.p2align 6
.amdhsa_kernel interleave_layers__sliding_local_dilated__glu_gated_geglu__prompt_kernel
.amdhsa_next_free_vgpr 512
.amdhsa_next_free_sgpr 100
.amdhsa_accum_offset 256
.amdhsa_group_segment_fixed_size 0
.amdhsa_kernarg_size 80
.amdhsa_user_sgpr_count 2
.amdhsa_user_sgpr_kernarg_segment_ptr 1
.amdhsa_system_sgpr_workgroup_id_x 1
.amdhsa_float_denorm_mode_32 3
.amdhsa_float_denorm_mode_16_64 3
.end_amdhsa_kernel
```

```asm
; @launch grid=(256,1,1) block=(256,1,1) lds=163840
.amdgcn_target "amdgcn-amd-amdhsa--gfx950"
.text
.globl interleave_layers__sliding_local_dilated__glu_gated_geglu__prompt_kernel
.p2align 8
.type interleave_layers__sliding_local_dilated__glu_gated_geglu__prompt_kernel,@function
interleave_layers__sliding_local_dilated__glu_gated_geglu__prompt_kernel:
    s_cmp_ge_u32 s2, 256
    s_cbranch_scc1 L_main_end
    s_load_dwordx2 s[4:5], s[0:1], 72
    s_load_dwordx4 s[16:19], s[0:1], 0
    s_load_dwordx2 s[22:23], s[0:1], 16
    s_load_dwordx8 s[24:31], s[0:1], 32
    v_lshrrev_b32 v1, 6, v0
    v_and_b32 v0, 63, v0
    v_readfirstlane_b32 s3, v1
    s_waitcnt lgkmcnt(0)
    s_mov_b32 s8, s4
    s_and_b32 s9, s5, 0xffff
    s_mov_b32 s10, 268435456
    s_mov_b32 s11, 0x20000
    s_mov_b32 s7, 19660800
    s_load_dword s76, s[4:5], s7
    s_mov_b64 s[20:21], s[18:19]
    s_mov_b64 s[18:19], s[16:17]
    s_mov_b32 s48, s4
    s_and_b32 s49, s5, 0xffff
    s_mov_b32 s50, 268435456
    s_mov_b32 s51, 0x20000
    s_and_b32 s40, s2, 1
    s_lshl_b32 s40, s40, 2
    s_bfe_u32 s7, s2, 131075
    s_add_u32 s40, s40, s7
    s_bfe_u32 s41, s2, 131073
    s_lshl_b32 s41, s41, 3
    s_lshr_b32 s7, s2, 5
    s_add_u32 s41, s41, s7
    s_mov_b32 s42, 0
    s_mov_b32 s43, 0
    s_lshl_b32 s44, s41, 10
    s_add_u32 s44, s44, 19169280
    v_lshlrev_b32 v253, 4, v0
    s_mov_b32 s12, s18
    s_and_b32 s13, s19, 0xffff
    s_mov_b32 s14, 2359296
    s_mov_b32 s15, 0x20000
    s_mov_b32 s64, s20
    s_and_b32 s65, s21, 0xffff
    s_mov_b32 s66, 1990656
    s_mov_b32 s67, 0x20000
    s_mov_b32 s68, s22
    s_and_b32 s69, s23, 0xffff
    s_mov_b32 s70, 663552
    s_mov_b32 s71, 0x20000
    s_mov_b32 s16, 0xffff0000
    s_lshl_b32 s7, s3, 10
    v_lshl_add_u32 v2, v0, 4, s7
    v_add_u32 v3, 4096, v2
    v_and_b32 v8, 7, v0
    v_mul_u32_u24 v8, 1152, v8
    v_lshrrev_b32 v9, 3, v0
    v_lshl_add_u32 v8, v9, 4, v8
    s_lshl_b32 s7, s3, 7
    v_add_u32 v5, s7, v8
    v_add_u32 v6, 512, v5
    s_cmp_eq_u32 s3, 0
    s_mov_b32 s17, 1073741824
    s_cmov_b32 s17, 8192
    v_add_u32 v4, s17, v2
    s_mov_b32 s17, 1073741824
    s_cmov_b32 s17, 1024
    v_add_u32 v7, s17, v5
    s_lshl_b32 s21, s41, 3
    s_add_u32 s21, s21, s40
    s_mul_i32 s18, s21, 9216
    buffer_load_dwordx4 v[16:19], v5, s[12:15], s18 offen
    buffer_load_dwordx4 v[20:23], v6, s[12:15], s18 offen
    buffer_load_dwordx4 v[24:27], v7, s[12:15], s18 offen
    s_mov_b32 s12, s30
    s_and_b32 s13, s31, 0xffff
    s_mov_b32 s14, 2359296
    s_mov_b32 s15, 0x20000
    s_lshl_b32 s79, s3, 14
    s_add_u32 s79, s79, 98304
    s_lshl_b32 s78, s3, 13
    s_add_u32 s78, s78, 8192
    s_lshl_b32 s32, s3, 5
    s_add_u32 s32, s32, s41
    s_cmp_ge_u32 s32, 72
    s_cbranch_scc1 L_noq_1
    s_mul_i32 s33, s32, 58255
    s_lshr_b32 s33, s33, 20
    s_mul_i32 s34, s33, 18
    s_sub_u32 s34, s32, s34
    s_lshl_b32 s7, s40, 2
    s_add_u32 s33, s33, s7
    s_mul_i32 s35, s34, 110592
    s_mul_i32 s7, s33, 36
    s_add_u32 s35, s35, s7
    v_mov_b32 v13, 1073741824
    v_add_u32 v8, 0, v0
    v_mul_u32_u24 v9, 21846, v8
    v_lshrrev_b32 v9, 16, v9
    v_mul_u32_u24 v10, 3, v9
    v_sub_u32 v10, v8, v10
    v_and_b32 v11, 31, v9
    v_mul_u32_u24 v11, 3456, v11
    v_lshl_add_u32 v11, v10, 4, v11
    v_lshrrev_b32 v9, 5, v9
    v_mul_u32_u24 v9, 1152, v9
    s_add_u32 m0, s78, 0
    v_add_u32 v11, v11, v9
    buffer_load_dwordx4 v11, s[64:67], s35 offen lds
    v_add_u32 v8, 64, v0
    v_mul_u32_u24 v9, 21846, v8
    v_lshrrev_b32 v9, 16, v9
    v_mul_u32_u24 v10, 3, v9
    v_sub_u32 v10, v8, v10
    v_and_b32 v11, 31, v9
    v_mul_u32_u24 v11, 3456, v11
    v_lshl_add_u32 v11, v10, 4, v11
    v_lshrrev_b32 v9, 5, v9
    v_mul_u32_u24 v9, 1152, v9
    s_add_u32 m0, s78, 1024
    v_add_u32 v11, v11, v9
    buffer_load_dwordx4 v11, s[64:67], s35 offen lds
    v_add_u32 v8, 128, v0
    v_mul_u32_u24 v9, 21846, v8
    v_lshrrev_b32 v9, 16, v9
    v_mul_u32_u24 v10, 3, v9
    v_sub_u32 v10, v8, v10
    v_and_b32 v11, 31, v9
    v_mul_u32_u24 v11, 3456, v11
    v_lshl_add_u32 v11, v10, 4, v11
    v_lshrrev_b32 v9, 5, v9
    v_mul_u32_u24 v9, 1152, v9
    s_add_u32 m0, s78, 2048
    v_add_u32 v11, v11, v9
    buffer_load_dwordx4 v11, s[64:67], s35 offen lds
    v_add_u32 v8, 192, v0
    v_mul_u32_u24 v9, 21846, v8
    v_lshrrev_b32 v9, 16, v9
    v_mul_u32_u24 v10, 3, v9
    v_sub_u32 v10, v8, v10
    v_and_b32 v11, 31, v9
    v_mul_u32_u24 v11, 3456, v11
    v_lshl_add_u32 v11, v10, 4, v11
    v_lshrrev_b32 v9, 5, v9
    v_mul_u32_u24 v9, 1152, v9
    s_add_u32 m0, s78, 3072
    v_add_u32 v11, v11, v9
    buffer_load_dwordx4 v11, s[64:67], s35 offen lds
    v_add_u32 v8, 256, v0
    v_mul_u32_u24 v9, 21846, v8
    v_lshrrev_b32 v9, 16, v9
    v_mul_u32_u24 v10, 3, v9
    v_sub_u32 v10, v8, v10
    v_and_b32 v11, 31, v9
    v_mul_u32_u24 v11, 3456, v11
    v_lshl_add_u32 v11, v10, 4, v11
    v_lshrrev_b32 v9, 5, v9
    v_mul_u32_u24 v9, 1152, v9
    s_add_u32 m0, s78, 4096
    v_add_u32 v11, v11, v9
    v_cmp_gt_u32 vcc, 32, v0
    s_nop 1
    v_cndmask_b32 v11, v13, v11, vcc
    buffer_load_dwordx4 v11, s[64:67], s35 offen lds
L_noq_1:
    s_lshl_b32 s36, s41, 1
    s_lshr_b32 s7, s40, 2
    s_add_u32 s36, s36, s7
    s_and_b32 s37, s40, 3
    s_cmp_eq_u32 s3, 3
    s_cbranch_scc1 L_wbar_3
    s_mul_i32 s38, s36, 3
    s_add_u32 s38, s38, s3
    s_cmp_ge_u32 s38, 162
    s_cbranch_scc1 L_p3_4
    s_mul_i32 s39, s38, 58255
    s_lshr_b32 s39, s39, 20
    s_mul_i32 s45, s39, 18
    s_sub_u32 s45, s38, s45
    s_mul_i32 s7, s37, 9
    s_add_u32 s39, s39, s7
    s_lshl_b32 s7, s45, 2
    v_lshrrev_b32 v8, 4, v0
    v_add_u32 v8, s7, v8
    v_bfe_u32 v9, v0, 1, 3
    v_mul_u32_u24 v11, 7282, v8
    v_lshrrev_b32 v11, 16, v11
    v_mul_u32_u24 v12, 9, v11
    v_sub_u32 v12, v8, v12
    v_mul_u32_u24 v11, 72, v11
    v_cmp_eq_u32 vcc, 8, v12
    v_lshrrev_b32 v10, 1, v12
    v_mad_u32_u24 v10, v10, 18, v11
    v_and_b32 v12, 1, v12
    v_lshl_add_u32 v10, v12, 3, v10
    v_add_u32 v10, v10, v9
    v_lshrrev_b32 v12, 1, v9
    v_mad_u32_u24 v11, v12, 18, v11
    v_and_b32 v12, 1, v9
    v_add3_u32 v11, v11, v12, 16
    v_cndmask_b32 v10, v10, v11, vcc
    v_mul_u32_u24 v10, 1152, v10
    v_and_b32 v9, 1, v0
    v_lshl_add_u32 v10, v9, 4, v10
    s_add_u32 m0, s78, 6144
    s_lshl_b32 s7, s39, 5
    buffer_load_dwordx4 v10, s[68:71], s7 offen lds
    s_branch L_p3_4
L_wbar_3:
    s_cmp_ge_u32 s36, 36
    s_cbranch_scc1 L_p3_4
    s_lshl_b32 s7, s36, 1
    v_bfe_u32 v8, v0, 3, 1
    v_add_u32 v8, s7, v8
    v_and_b32 v9, 7, v0
    v_mul_u32_u24 v11, 7282, v8
    v_lshrrev_b32 v11, 16, v11
    v_mul_u32_u24 v12, 9, v11
    v_sub_u32 v12, v8, v12
    v_mul_u32_u24 v11, 72, v11
    v_cmp_eq_u32 vcc, 8, v12
    v_lshrrev_b32 v10, 1, v12
    v_mad_u32_u24 v10, v10, 18, v11
    v_and_b32 v12, 1, v12
    v_lshl_add_u32 v10, v12, 3, v10
    v_add_u32 v10, v10, v9
    v_lshrrev_b32 v12, 1, v9
    v_mad_u32_u24 v11, v12, 18, v11
    v_and_b32 v12, 1, v9
    v_add3_u32 v11, v11, v12, 16
    v_cndmask_b32 v10, v10, v11, vcc
    v_mul_u32_u24 v10, 1152, v10
    v_lshrrev_b32 v9, 4, v0
    v_lshl_add_u32 v10, v9, 4, v10
    buffer_load_dwordx4 v[64:67], v10, s[68:71], 0 offen offset:0
    buffer_load_dwordx4 v[68:71], v10, s[68:71], 0 offen offset:64
    buffer_load_dwordx4 v[72:75], v10, s[68:71], 0 offen offset:128
    buffer_load_dwordx4 v[76:79], v10, s[68:71], 0 offen offset:192
    buffer_load_dwordx4 v[80:83], v10, s[68:71], 0 offen offset:256
    buffer_load_dwordx4 v[84:87], v10, s[68:71], 0 offen offset:320
    buffer_load_dwordx4 v[88:91], v10, s[68:71], 0 offen offset:384
    buffer_load_dwordx4 v[92:95], v10, s[68:71], 0 offen offset:448
    buffer_load_dwordx4 v[96:99], v10, s[68:71], 0 offen offset:512
    buffer_load_dwordx4 v[100:103], v10, s[68:71], 0 offen offset:576
    buffer_load_dwordx4 v[104:107], v10, s[68:71], 0 offen offset:640
    buffer_load_dwordx4 v[108:111], v10, s[68:71], 0 offen offset:704
    buffer_load_dwordx4 v[112:115], v10, s[68:71], 0 offen offset:768
    buffer_load_dwordx4 v[116:119], v10, s[68:71], 0 offen offset:832
    buffer_load_dwordx4 v[120:123], v10, s[68:71], 0 offen offset:896
    buffer_load_dwordx4 v[124:127], v10, s[68:71], 0 offen offset:960
    buffer_load_dwordx4 v[128:131], v10, s[68:71], 0 offen offset:1024
    buffer_load_dwordx4 v[132:135], v10, s[68:71], 0 offen offset:1088
L_p3_4:
    s_lshl_b32 s7, s41, 2
    s_add_u32 s7, s7, s3
    s_mul_i32 s93, s7, 25576
    s_lshr_b32 s93, s93, 20
    s_min_u32 s93, s93, 2
    s_mul_i32 s6, s93, 41
    s_sub_u32 s7, s7, s6
    s_lshl_b32 s46, s7, 2
    s_cmp_eq_u32 s93, 1
    s_cselect_b32 s72, s26, s24
    s_cselect_b32 s73, s27, s25
    s_cmp_eq_u32 s93, 2
    s_cselect_b32 s72, s28, s72
    s_cselect_b32 s73, s29, s73
    s_mov_b32 s92, 73728
    s_cmov_b32 s92, 9216
    s_mov_b32 s47, 1152
    s_cmov_b32 s47, 663552
    s_and_b32 s73, s73, 0xffff
    s_mov_b32 s74, 5308416
    s_mov_b32 s75, 0x20000
    s_mul_i32 s47, s47, s40
    s_add_u32 s7, s46, 0
    s_min_u32 s7, s7, 161
    s_mul_i32 s84, s7, 116509
    s_lshr_b32 s84, s84, 20
    s_mul_i32 s88, s84, 9
    s_sub_u32 s88, s7, s88
    s_mul_i32 s7, s84, s92
    s_lshl_b32 s7, s7, 2
    s_add_u32 s7, s7, s47
    s_lshl_b32 s6, s88, 7
    s_add_u32 s80, s7, s6
    s_add_u32 s7, s46, 1
    s_min_u32 s7, s7, 161
    s_mul_i32 s85, s7, 116509
    s_lshr_b32 s85, s85, 20
    s_mul_i32 s89, s85, 9
    s_sub_u32 s89, s7, s89
    s_mul_i32 s7, s85, s92
    s_lshl_b32 s7, s7, 2
    s_add_u32 s7, s7, s47
    s_lshl_b32 s6, s89, 7
    s_add_u32 s81, s7, s6
    s_add_u32 s7, s46, 2
    s_min_u32 s7, s7, 161
    s_mul_i32 s86, s7, 116509
    s_lshr_b32 s86, s86, 20
    s_mul_i32 s90, s86, 9
    s_sub_u32 s90, s7, s90
    s_mul_i32 s7, s86, s92
    s_lshl_b32 s7, s7, 2
    s_add_u32 s7, s7, s47
    s_lshl_b32 s6, s90, 7
    s_add_u32 s82, s7, s6
    s_add_u32 s7, s46, 3
    s_min_u32 s7, s7, 161
    s_mul_i32 s87, s7, 116509
    s_lshr_b32 s87, s87, 20
    s_mul_i32 s91, s87, 9
    s_sub_u32 s91, s7, s91
    s_mul_i32 s7, s87, s92
    s_lshl_b32 s7, s7, 2
    s_add_u32 s7, s7, s47
    s_lshl_b32 s6, s91, 7
    s_add_u32 s83, s7, s6
    s_lshr_b32 s7, s92, 3
    v_lshrrev_b32 v224, 3, v0
    v_mul_lo_u32 v224, v224, s7
    v_and_b32 v8, 7, v0
    v_lshl_add_u32 v224, v8, 4, v224
    s_waitcnt lgkmcnt(0)
    s_mul_i32 s76, s76, 0x9e3779b1
    s_add_u32 s76, s76, 0x7f4a7c15
    s_mov_b32 s77, s76
    v_lshrrev_b32 v8, 4, v0
    v_lshlrev_b32 v8, 3, v8
    v_bfe_u32 v9, v0, 2, 2
    v_add_u32 v8, v8, v9
    v_mul_u32_u24 v8, 48, v8
    v_and_b32 v9, 3, v0
    v_lshl_add_u32 v8, v9, 3, v8
    v_add_u32 v8, s78, v8
    v_and_b32 v9, 3, v0
    v_min_u32 v10, 2, v9
    v_mul_u32_u24 v10, 1536, v10
    v_lshlrev_b32 v9, 3, v9
    v_sub_u32 v10, v10, v9
    v_add3_u32 v10, v10, v8, 32
    v_and_b32 v9, 15, v0
    v_cmp_gt_u32 s[22:23], 6, v9
    v_lshrrev_b32 v11, 1, v9
    v_and_b32 v12, 0x31, v0
    v_lshl_add_u32 v11, v11, 2, v12
    v_lshlrev_b32 v11, 2, v11
    s_add_u32 m0, s79, 0
    s_mov_b32 s47, s80
    buffer_load_dwordx4 v224, s[72:75], s47 offen nt lds
    s_add_u32 m0, s79, 1024
    s_add_u32 s47, s47, s92
    buffer_load_dwordx4 v224, s[72:75], s47 offen nt lds
    s_add_u32 m0, s79, 2048
    s_add_u32 s47, s47, s92
    buffer_load_dwordx4 v224, s[72:75], s47 offen nt lds
    s_add_u32 m0, s79, 3072
    s_add_u32 s47, s47, s92
    buffer_load_dwordx4 v224, s[72:75], s47 offen nt lds
    s_add_u32 m0, s79, 4096
    s_mov_b32 s47, s81
    buffer_load_dwordx4 v224, s[72:75], s47 offen nt lds
    s_add_u32 m0, s79, 5120
    s_add_u32 s47, s47, s92
    buffer_load_dwordx4 v224, s[72:75], s47 offen nt lds
    s_waitcnt vmcnt(6)
    s_cmp_ge_u32 s32, 72
    s_cbranch_scc1 L_noq_2
    ds_read_b64_tr_b16 v[44:45], v10
    ds_read_b64_tr_b16 v[46:47], v10 offset:192
    ds_read_b64_tr_b16 v[32:33], v8 offset:0
    ds_read_b64_tr_b16 v[34:35], v8 offset:192
    ds_read_b64_tr_b16 v[36:37], v8 offset:1536
    ds_read_b64_tr_b16 v[38:39], v8 offset:1728
    ds_read_b64_tr_b16 v[40:41], v8 offset:3072
    ds_read_b64_tr_b16 v[42:43], v8 offset:3264
    s_mul_i32 s33, s33, 18
    s_add_u32 s33, s33, s34
    s_lshl_b32 s33, s33, 12
    s_waitcnt lgkmcnt(6)
    ds_bpermute_b32 v44, v11, v44
    ds_bpermute_b32 v45, v11, v45
    ds_bpermute_b32 v46, v11, v46
    ds_bpermute_b32 v47, v11, v47
    s_waitcnt lgkmcnt(4)
    buffer_store_dwordx4 v[32:35], v253, s[8:11], s33 offen offset:0 sc1
    buffer_store_dwordx4 v[36:39], v253, s[8:11], s33 offen offset:1024 sc1
    buffer_store_dwordx4 v[40:43], v253, s[8:11], s33 offen offset:2048 sc1
    s_waitcnt lgkmcnt(0)
    v_cndmask_b32 v44, 0, v44, s[22:23]
    v_cndmask_b32 v45, 0, v45, s[22:23]
    v_cndmask_b32 v46, 0, v46, s[22:23]
    v_cndmask_b32 v47, 0, v47, s[22:23]
    buffer_store_dwordx4 v[44:47], v253, s[8:11], s33 offen offset:3072 sc1
L_noq_2:
    s_cmp_eq_u32 s3, 3
    s_cbranch_scc1 L_wbar_5
    s_cmp_ge_u32 s38, 162
    s_cbranch_scc1 L_p3_6
    v_lshrrev_b32 v8, 4, v0
    v_lshlrev_b32 v8, 3, v8
    v_bfe_u32 v9, v0, 2, 2
    v_add_u32 v8, v8, v9
    v_mul_u32_u24 v8, 32, v8
    v_and_b32 v9, 3, v0
    v_lshl_add_u32 v8, v9, 3, v8
    v_add_u32 v8, s78, v8
    ds_read_b64_tr_b16 v[28:29], v8 offset:6144
    ds_read_b64_tr_b16 v[30:31], v8 offset:6272
    s_mul_i32 s39, s39, 18
    s_add_u32 s39, s39, s45
    s_lshl_b32 s39, s39, 10
    s_add_u32 s39, s39, 2359296
    s_waitcnt lgkmcnt(0)
    buffer_store_dwordx4 v[28:31], v253, s[8:11], s39 offen sc1
    s_branch L_p3_6
L_wbar_5:
    s_cmp_ge_u32 s36, 36
    s_cbranch_scc1 L_p3_6
    v_mov_b32 v28, 0x3f803f80
    v_mov_b32 v29, 0x3f803f80
    v_mov_b32 v30, 0x3f803f80
    v_mov_b32 v31, 0x3f803f80
    v_and_b32 v9, 15, v0
    v_cmp_eq_u32 vcc, 0, v9
    v_cmp_eq_u32 s[22:23], 1, v9
    v_mfma_f32_16x16x32_bf16 v[32:35], v[64:67], v[28:31], 0
    v_mfma_f32_16x16x32_bf16 v[32:35], v[68:71], v[28:31], v[32:35]
    v_mfma_f32_16x16x32_bf16 v[32:35], v[72:75], v[28:31], v[32:35]
    v_mfma_f32_16x16x32_bf16 v[32:35], v[76:79], v[28:31], v[32:35]
    v_mfma_f32_16x16x32_bf16 v[32:35], v[80:83], v[28:31], v[32:35]
    v_mfma_f32_16x16x32_bf16 v[32:35], v[84:87], v[28:31], v[32:35]
    v_mfma_f32_16x16x32_bf16 v[32:35], v[88:91], v[28:31], v[32:35]
    v_mfma_f32_16x16x32_bf16 v[32:35], v[92:95], v[28:31], v[32:35]
    v_mfma_f32_16x16x32_bf16 v[32:35], v[96:99], v[28:31], v[32:35]
    v_mfma_f32_16x16x32_bf16 v[32:35], v[100:103], v[28:31], v[32:35]
    v_mfma_f32_16x16x32_bf16 v[32:35], v[104:107], v[28:31], v[32:35]
    v_mfma_f32_16x16x32_bf16 v[32:35], v[108:111], v[28:31], v[32:35]
    v_mfma_f32_16x16x32_bf16 v[32:35], v[112:115], v[28:31], v[32:35]
    v_mfma_f32_16x16x32_bf16 v[32:35], v[116:119], v[28:31], v[32:35]
    v_mfma_f32_16x16x32_bf16 v[32:35], v[120:123], v[28:31], v[32:35]
    v_mfma_f32_16x16x32_bf16 v[32:35], v[124:127], v[28:31], v[32:35]
    v_mfma_f32_16x16x32_bf16 v[32:35], v[128:131], v[28:31], v[32:35]
    v_mfma_f32_16x16x32_bf16 v[32:35], v[132:135], v[28:31], v[32:35]
    v_lshrrev_b32 v10, 5, v0
    v_lshlrev_b32 v10, 8, v10
    v_lshl_add_u32 v10, v9, 4, v10
    v_bfe_u32 v9, v0, 4, 1
    v_lshl_add_u32 v10, v9, 3, v10
    s_lshl_b32 s7, s36, 9
    s_mul_i32 s6, s37, 18432
    s_add_u32 s7, s7, s6
    s_add_u32 s7, s7, 3022848
    v_mul_f32 v32, 0x3ae38e39, v32
    v_mul_f32 v33, 0x3ae38e39, v33
    v_mul_f32 v34, 0x3ae38e39, v34
    v_mul_f32 v35, 0x3ae38e39, v35
    v_cvt_pk_bf16_f32 v36, v32, v33
    v_cvt_pk_bf16_f32 v37, v34, v35
    v_lshlrev_b32 v38, 16, v36
    v_and_b32 v39, s16, v36
    v_sub_f32 v38, v32, v38
    v_sub_f32 v39, v33, v39
    v_cvt_pk_bf16_f32 v28, v38, v39
    v_cndmask_b32 v28, 0, v28, s[22:23]
    v_cndmask_b32 v28, v28, v36, vcc
    v_lshlrev_b32 v38, 16, v37
    v_and_b32 v39, s16, v37
    v_sub_f32 v38, v34, v38
    v_sub_f32 v39, v35, v39
    v_cvt_pk_bf16_f32 v29, v38, v39
    v_cndmask_b32 v29, 0, v29, s[22:23]
    v_cndmask_b32 v29, v29, v37, vcc
    buffer_store_dwordx2 v[28:29], v10, s[8:11], s7 offen sc1
L_p3_6:
    s_add_u32 s19, s18, 43515904
    s_add_u32 s20, s18, 38797312
    s_lshl_b32 s22, s21, 7
    s_add_u32 s22, s22, 48234496
    buffer_store_dwordx4 v[16:19], v2, s[8:11], s19 offen sc1
    buffer_store_dwordx4 v[20:23], v3, s[8:11], s19 offen sc1
    buffer_store_dwordx4 v[24:27], v4, s[8:11], s19 offen sc1
    s_mov_b32 s17, 0x3f803f80
    v_mov_b32 v8, 0
    v_mov_b32 v9, 0
    v_mov_b32 v10, 0
    v_mov_b32 v11, 0
    v_dot2c_f32_bf16 v8, s17, v16
    v_dot2c_f32_bf16 v9, v16, v16
    v_dot2c_f32_bf16 v10, s17, v17
    v_dot2c_f32_bf16 v11, v17, v17
    v_dot2c_f32_bf16 v8, s17, v18
    v_dot2c_f32_bf16 v9, v18, v18
    v_dot2c_f32_bf16 v10, s17, v19
    v_dot2c_f32_bf16 v11, v19, v19
    v_dot2c_f32_bf16 v8, s17, v20
    v_dot2c_f32_bf16 v9, v20, v20
    v_dot2c_f32_bf16 v10, s17, v21
    v_dot2c_f32_bf16 v11, v21, v21
    v_dot2c_f32_bf16 v8, s17, v22
    v_dot2c_f32_bf16 v9, v22, v22
    v_dot2c_f32_bf16 v10, s17, v23
    v_dot2c_f32_bf16 v11, v23, v23
    v_dot2c_f32_bf16 v8, s17, v24
    v_dot2c_f32_bf16 v9, v24, v24
    v_dot2c_f32_bf16 v10, s17, v25
    v_dot2c_f32_bf16 v11, v25, v25
    v_dot2c_f32_bf16 v8, s17, v26
    v_dot2c_f32_bf16 v9, v26, v26
    v_dot2c_f32_bf16 v10, s17, v27
    v_dot2c_f32_bf16 v11, v27, v27
    v_and_b32 v12, 7, v0
    v_lshlrev_b32 v12, 3, v12
    s_lshl_b32 s7, s3, 6
    v_add_u32 v13, s7, v12
    v_pk_add_f32 v[8:9], v[8:9], v[10:11]
    s_nop 1
    v_add_f32_dpp v8, v8, v8 row_ror:8 row_mask:0xf bank_mask:0xf
    v_add_f32_dpp v9, v9, v9 row_ror:8 row_mask:0xf bank_mask:0xf
    v_mov_b32 v10, v8
    v_mov_b32 v11, v9
    s_nop 1
    v_permlane32_swap_b32 v10, v8
    v_permlane32_swap_b32 v11, v9
    v_add_f32 v8, v8, v10
    v_add_f32 v9, v9, v11
    v_mov_b32 v10, v8
    v_mov_b32 v11, v9
    s_nop 1
    v_permlane16_swap_b32 v10, v8
    v_permlane16_swap_b32 v11, v9
    v_add_f32 v8, v8, v10
    v_add_f32 v9, v9, v11
    ds_write_b64 v13, v[8:9]
    s_waitcnt lgkmcnt(0)
    s_barrier
    ds_read_b64 v[40:41], v12 offset:0
    ds_read_b64 v[42:43], v12 offset:64
    ds_read_b64 v[44:45], v12 offset:128
    ds_read_b64 v[46:47], v12 offset:192
    s_waitcnt lgkmcnt(0)
    v_pk_add_f32 v[40:41], v[40:41], v[42:43]
    v_pk_add_f32 v[44:45], v[44:45], v[46:47]
    v_pk_add_f32 v[8:9], v[40:41], v[44:45]
    v_mul_f32 v8, 0x3ae38e39, v8
    v_mul_f32 v9, 0x3ae38e39, v9
    v_fma_f32 v9, -v8, v8, v9
    v_max_f32 v9, 0, v9
    v_add_f32 v9, 0x3727c5ac, v9
    v_rsq_f32 v10, v9
    s_nop 0
    v_mul_f32 v12, v8, v10
    v_mov_b32 v11, v10
    v_sub_f32 v12, 0, v12
    v_mov_b32 v13, v12
    s_cmp_eq_u32 s3, 0
    s_cselect_b32 s7, 32, 0
    v_lshlrev_b32 v14, 2, v0
    v_cmp_gt_u32 vcc, s7, v0
    v_mov_b32 v9, 1073741824
    s_nop 0
    v_cndmask_b32 v14, v9, v14, vcc
    buffer_store_dword v8, v14, s[8:11], s22 offen sc1
    v_lshlrev_b32 v40, 16, v16
    v_and_b32 v41, s16, v16
    v_lshlrev_b32 v42, 16, v17
    v_and_b32 v43, s16, v17
    v_lshlrev_b32 v44, 16, v18
    v_and_b32 v45, s16, v18
    v_lshlrev_b32 v46, 16, v19
    v_and_b32 v47, s16, v19
    v_pk_fma_f32 v[40:41], v[40:41], v[10:11], v[12:13]
    v_pk_fma_f32 v[42:43], v[42:43], v[10:11], v[12:13]
    v_pk_fma_f32 v[44:45], v[44:45], v[10:11], v[12:13]
    v_pk_fma_f32 v[46:47], v[46:47], v[10:11], v[12:13]
    v_cvt_pk_bf16_f32 v48, v40, v41
    v_cvt_pk_bf16_f32 v49, v42, v43
    v_cvt_pk_bf16_f32 v50, v44, v45
    v_cvt_pk_bf16_f32 v51, v46, v47
    v_lshlrev_b32 v40, 16, v20
    v_and_b32 v41, s16, v20
    v_lshlrev_b32 v42, 16, v21
    v_and_b32 v43, s16, v21
    v_lshlrev_b32 v44, 16, v22
    v_and_b32 v45, s16, v22
    v_lshlrev_b32 v46, 16, v23
    v_and_b32 v47, s16, v23
    v_pk_fma_f32 v[40:41], v[40:41], v[10:11], v[12:13]
    v_pk_fma_f32 v[42:43], v[42:43], v[10:11], v[12:13]
    v_pk_fma_f32 v[44:45], v[44:45], v[10:11], v[12:13]
    v_pk_fma_f32 v[46:47], v[46:47], v[10:11], v[12:13]
    v_cvt_pk_bf16_f32 v52, v40, v41
    v_cvt_pk_bf16_f32 v53, v42, v43
    v_cvt_pk_bf16_f32 v54, v44, v45
    v_cvt_pk_bf16_f32 v55, v46, v47
    v_lshlrev_b32 v40, 16, v24
    v_and_b32 v41, s16, v24
    v_lshlrev_b32 v42, 16, v25
    v_and_b32 v43, s16, v25
    v_lshlrev_b32 v44, 16, v26
    v_and_b32 v45, s16, v26
    v_lshlrev_b32 v46, 16, v27
    v_and_b32 v47, s16, v27
    v_pk_fma_f32 v[40:41], v[40:41], v[10:11], v[12:13]
    v_pk_fma_f32 v[42:43], v[42:43], v[10:11], v[12:13]
    v_pk_fma_f32 v[44:45], v[44:45], v[10:11], v[12:13]
    v_pk_fma_f32 v[46:47], v[46:47], v[10:11], v[12:13]
    v_cvt_pk_bf16_f32 v56, v40, v41
    v_cvt_pk_bf16_f32 v57, v42, v43
    v_cvt_pk_bf16_f32 v58, v44, v45
    v_cvt_pk_bf16_f32 v59, v46, v47
    buffer_store_dwordx4 v[48:51], v2, s[8:11], s20 offen sc1
    buffer_store_dwordx4 v[52:55], v3, s[8:11], s20 offen sc1
    buffer_store_dwordx4 v[56:59], v4, s[8:11], s20 offen sc1
    v_lshlrev_b32 v15, 7, v0
    s_lshl_b32 s6, s40, 2
    s_add_u32 s6, s6, s44
    s_sub_u32 s6, s6, 32768
    v_mov_b32 v1, s76
    s_mov_b64 vcc, 0xff
    v_lshrrev_b32 v14, 3, v0
    v_lshl_add_u32 v15, v14, 3, v15
    s_cmp_ge_u32 s40, 6
    s_cselect_b32 s7, s41, 31
    s_cmp_lt_u32 s7, 31
    s_cmov_b64 vcc, 0xffff
    s_waitcnt vmcnt(0)
    s_barrier
    s_cmp_lg_u32 s3, 0
    s_cbranch_scc1 L_pub_7
    s_mov_b64 exec, vcc
    buffer_store_dword v1, v15, s[8:11], s6 offen sc1
    v_lshlrev_b32 v15, 10, v0
    s_lshl_b32 s6, s40, 7
    s_lshl_b32 s7, s41, 2
    s_add_u32 s6, s6, s7
    s_add_u32 s6, s6, 19431424
    s_mov_b64 exec, 0xffffffff
    v_lshlrev_b32 v15, 10, v0
    v_mov_b32 v1, s76
    buffer_store_dword v1, v15, s[8:11], s6 offen sc1
    s_lshl_b32 s6, s37, 8
    s_lshl_b32 s7, s36, 2
    s_add_u32 s6, s6, s7
    s_add_u32 s6, s6, 19496960
    s_mov_b64 exec, 1
    buffer_store_dword v1, off, s[8:11], s6 sc1
L_pub_7:
    s_mov_b64 exec, -1
    s_add_u32 m0, s79, 6144
    s_add_u32 s47, s47, s92
    buffer_load_dwordx4 v224, s[72:75], s47 offen nt lds
    s_add_u32 m0, s79, 7168
    s_add_u32 s47, s47, s92
    buffer_load_dwordx4 v224, s[72:75], s47 offen nt lds
    s_add_u32 m0, s79, 8192
    s_mov_b32 s47, s82
    buffer_load_dwordx4 v224, s[72:75], s47 offen nt lds
    s_add_u32 m0, s79, 9216
    s_add_u32 s47, s47, s92
    buffer_load_dwordx4 v224, s[72:75], s47 offen nt lds
    s_add_u32 m0, s79, 10240
    s_add_u32 s47, s47, s92
    buffer_load_dwordx4 v224, s[72:75], s47 offen nt lds
    s_add_u32 m0, s79, 11264
    s_add_u32 s47, s47, s92
    buffer_load_dwordx4 v224, s[72:75], s47 offen nt lds
    s_add_u32 m0, s79, 12288
    s_mov_b32 s47, s83
    buffer_load_dwordx4 v224, s[72:75], s47 offen nt lds
    s_add_u32 m0, s79, 13312
    s_add_u32 s47, s47, s92
    buffer_load_dwordx4 v224, s[72:75], s47 offen nt lds
    s_add_u32 m0, s79, 14336
    s_add_u32 s47, s47, s92
    buffer_load_dwordx4 v224, s[72:75], s47 offen nt lds
    s_add_u32 m0, s79, 15360
    s_add_u32 s47, s47, s92
    buffer_load_dwordx4 v224, s[72:75], s47 offen nt lds
    s_cmp_lg_u32 s3, 0
    s_cbranch_scc1 L_wq_ready_8
    s_lshl_b32 s7, s41, 3
    s_add_u32 s7, s7, s40
    s_lshl_b32 s7, s7, 7
    s_add_u32 s7, s7, 19431424
    s_add_u32 s68, s4, s7
    s_addc_u32 s69, s5, 0
    s_mov_b32 s6, 0
    s_mov_b32 s7, 0
L_cpoll_9:
    s_load_dwordx16 s[52:67], s[68:69], s7 glc
    s_add_u32 s6, s6, 1
    s_waitcnt lgkmcnt(0)
    s_xor_b64 s[52:53], s[52:53], s[76:77]
    s_xor_b64 s[54:55], s[54:55], s[76:77]
    s_xor_b64 s[56:57], s[56:57], s[76:77]
    s_xor_b64 s[58:59], s[58:59], s[76:77]
    s_xor_b64 s[60:61], s[60:61], s[76:77]
    s_xor_b64 s[62:63], s[62:63], s[76:77]
    s_xor_b64 s[64:65], s[64:65], s[76:77]
    s_xor_b64 s[66:67], s[66:67], s[76:77]
    s_or_b64 s[52:53], s[52:53], s[60:61]
    s_or_b64 s[54:55], s[54:55], s[62:63]
    s_or_b64 s[56:57], s[56:57], s[64:65]
    s_or_b64 s[58:59], s[58:59], s[66:67]
    s_or_b64 s[52:53], s[52:53], s[56:57]
    s_or_b64 s[54:55], s[54:55], s[58:59]
    s_or_b64 s[52:53], s[52:53], s[54:55]
    s_cbranch_scc1 L_cpoll_10
    s_add_u32 s7, s7, 64
    s_cmp_eq_u32 s7, 128
    s_cbranch_scc1 L_cpolled_11
L_cpoll_10:
    s_cmp_lt_u32 s6, 1048576
    s_cbranch_scc1 L_cpoll_9
    s_branch L_main_end
L_cpolled_11:
L_wq_ready_8:
    s_barrier
L_main_layer:
    v_bfe_u32 v3, v0, 3, 1
    v_mul_u32_u24 v2, 9216, v3
    v_lshrrev_b32 v3, 4, v0
    v_lshl_add_u32 v2, v3, 7, v2
    v_and_b32 v3, 7, v0
    v_lshl_add_u32 v2, v3, 4, v2
    v_bfe_u32 v3, v0, 3, 2
    s_mov_b32 s7, 9216
    v_mul_lo_u32 v9, v3, s7
    v_lshrrev_b32 v3, 5, v0
    v_lshl_add_u32 v9, v3, 7, v9
    v_and_b32 v3, 7, v0
    v_lshl_add_u32 v9, v3, 4, v9
    s_mul_i32 s22, s41, 73728
    s_add_u32 s22, s22, s43
    s_add_u32 s23, s22, 38797312
    s_mul_i32 s7, s3, 18432
    s_add_u32 s24, s23, s7
    s_cmp_eq_u32 s41, 0
    s_cselect_b32 s7, 0, 18432
    s_sub_u32 s23, s23, s7
    s_lshl_b32 s25, s3, 10
    s_add_u32 s25, s25, 1024
    s_mul_i32 s26, s3, 5120
    s_lshl_b32 s7, s3, 9
    s_add_u32 s27, s23, s7
    s_and_b32 s7, s3, 1
    s_add_u32 s7, s7, 4
    s_mul_i32 s29, s7, 5120
    s_lshl_b32 s7, s7, 9
    s_add_u32 s23, s23, s7
    s_cmp_lg_u32 s3, 0
    s_cbranch_scc1 L_pollout_14
    s_lshl_b32 s7, s40, 7
    s_add_u32 s7, s7, s44
    s_sub_u32 s7, s7, 32768
    s_add_u32 s52, s4, s7
    s_addc_u32 s53, s5, 0
    s_cmp_eq_u32 s41, 0
    s_cselect_b32 s7, 0, 32
    s_mov_b32 s6, 0
L_poll_12:
    s_load_dwordx8 s[56:63], s[52:53], 0 glc
    s_load_dwordx2 s[54:55], s[52:53], s7 glc
    s_add_u32 s6, s6, 1
    s_waitcnt lgkmcnt(0)
    s_xor_b64 s[54:55], s[54:55], s[76:77]
    s_xor_b64 s[56:57], s[56:57], s[76:77]
    s_xor_b64 s[58:59], s[58:59], s[76:77]
    s_xor_b64 s[60:61], s[60:61], s[76:77]
    s_xor_b64 s[62:63], s[62:63], s[76:77]
    s_or_b64 s[56:57], s[56:57], s[58:59]
    s_or_b64 s[60:61], s[60:61], s[62:63]
    s_or_b64 s[56:57], s[56:57], s[54:55]
    s_or_b64 s[56:57], s[56:57], s[60:61]
    s_cbranch_scc0 L_polled_13
    s_cmp_lt_u32 s6, 1048576
    s_cbranch_scc1 L_poll_12
    s_branch L_main_end
L_polled_13:
L_pollout_14:
    s_barrier
    s_add_u32 m0, s25, 0
    s_nop 0
    buffer_load_dwordx4 v2, s[8:11], s24 offen offset:0 sc1 lds
    s_add_u32 m0, s25, 4608
    s_nop 0
    buffer_load_dwordx4 v2, s[8:11], s24 offen offset:512 sc1 lds
    s_add_u32 m0, s25, 9216
    s_nop 0
    buffer_load_dwordx4 v2, s[8:11], s24 offen offset:1024 sc1 lds
    s_add_u32 m0, s25, 13824
    s_nop 0
    buffer_load_dwordx4 v2, s[8:11], s24 offen offset:1536 sc1 lds
    s_add_u32 m0, s25, 18432
    s_nop 0
    buffer_load_dwordx4 v2, s[8:11], s24 offen offset:2048 sc1 lds
    s_add_u32 m0, s25, 23040
    s_nop 0
    buffer_load_dwordx4 v2, s[8:11], s24 offen offset:2560 sc1 lds
    s_add_u32 m0, s26, 0
    s_add_u32 s7, s27, 0
    buffer_load_dwordx4 v2, s[8:11], s7 offen sc1 lds
    s_add_u32 m0, s29, 0
    s_add_u32 s7, s23, 0
    buffer_load_dwordx4 v2, s[8:11], s7 offen sc1 lds
    s_cmp_lg_u32 s42, 0
    s_cbranch_scc1 L_qkv_have_15
    s_lshl_b32 s28, s40, 2
    s_add_u32 s28, s28, s3
    s_mul_i32 s28, s28, 73728
    buffer_load_dwordx4 a[0:3], v253, s[8:11], s28 offen offset:0 sc1
    buffer_load_dwordx4 a[4:7], v253, s[8:11], s28 offen offset:1024 sc1
    buffer_load_dwordx4 a[8:11], v253, s[8:11], s28 offen offset:2048 sc1
    buffer_load_dwordx4 a[12:15], v253, s[8:11], s28 offen offset:3072 sc1
    s_add_u32 s28, s28, 4096
    buffer_load_dwordx4 a[16:19], v253, s[8:11], s28 offen offset:0 sc1
    buffer_load_dwordx4 a[20:23], v253, s[8:11], s28 offen offset:1024 sc1
    buffer_load_dwordx4 a[24:27], v253, s[8:11], s28 offen offset:2048 sc1
    buffer_load_dwordx4 a[28:31], v253, s[8:11], s28 offen offset:3072 sc1
    s_add_u32 s28, s28, 4096
    buffer_load_dwordx4 a[32:35], v253, s[8:11], s28 offen offset:0 sc1
    buffer_load_dwordx4 a[36:39], v253, s[8:11], s28 offen offset:1024 sc1
    buffer_load_dwordx4 a[40:43], v253, s[8:11], s28 offen offset:2048 sc1
    buffer_load_dwordx4 a[44:47], v253, s[8:11], s28 offen offset:3072 sc1
    s_add_u32 s28, s28, 4096
    buffer_load_dwordx4 a[48:51], v253, s[8:11], s28 offen offset:0 sc1
    buffer_load_dwordx4 a[52:55], v253, s[8:11], s28 offen offset:1024 sc1
    buffer_load_dwordx4 a[56:59], v253, s[8:11], s28 offen offset:2048 sc1
    buffer_load_dwordx4 a[60:63], v253, s[8:11], s28 offen offset:3072 sc1
    s_add_u32 s28, s28, 4096
    buffer_load_dwordx4 a[64:67], v253, s[8:11], s28 offen offset:0 sc1
    buffer_load_dwordx4 a[68:71], v253, s[8:11], s28 offen offset:1024 sc1
    buffer_load_dwordx4 a[72:75], v253, s[8:11], s28 offen offset:2048 sc1
    buffer_load_dwordx4 a[76:79], v253, s[8:11], s28 offen offset:3072 sc1
    s_add_u32 s28, s28, 4096
    buffer_load_dwordx4 a[80:83], v253, s[8:11], s28 offen offset:0 sc1
    buffer_load_dwordx4 a[84:87], v253, s[8:11], s28 offen offset:1024 sc1
    buffer_load_dwordx4 a[88:91], v253, s[8:11], s28 offen offset:2048 sc1
    buffer_load_dwordx4 a[92:95], v253, s[8:11], s28 offen offset:3072 sc1
    s_add_u32 s28, s28, 4096
L_qkv_have_15:
    buffer_load_dwordx4 a[96:99], v253, s[8:11], s28 offen offset:0 sc1
    buffer_load_dwordx4 a[100:103], v253, s[8:11], s28 offen offset:1024 sc1
    buffer_load_dwordx4 a[104:107], v253, s[8:11], s28 offen offset:2048 sc1
    buffer_load_dwordx4 a[108:111], v253, s[8:11], s28 offen offset:3072 sc1
    s_add_u32 s28, s28, 4096
    buffer_load_dwordx4 a[112:115], v253, s[8:11], s28 offen offset:0 sc1
    buffer_load_dwordx4 a[116:119], v253, s[8:11], s28 offen offset:1024 sc1
    buffer_load_dwordx4 a[120:123], v253, s[8:11], s28 offen offset:2048 sc1
    buffer_load_dwordx4 a[124:127], v253, s[8:11], s28 offen offset:3072 sc1
    s_add_u32 s28, s28, 4096
    buffer_load_dwordx4 a[128:131], v253, s[8:11], s28 offen offset:0 sc1
    buffer_load_dwordx4 a[132:135], v253, s[8:11], s28 offen offset:1024 sc1
    buffer_load_dwordx4 a[136:139], v253, s[8:11], s28 offen offset:2048 sc1
    buffer_load_dwordx4 a[140:143], v253, s[8:11], s28 offen offset:3072 sc1
    s_add_u32 s28, s28, 4096
    v_mov_b32 v132, 0
    v_mov_b32 v133, 0
    v_mov_b32 v192, 0
    v_mov_b32 v193, 0
    v_mov_b32 v195, 0
    v_mov_b32 v135, 0
    v_mov_b32 v139, 0
    v_mov_b32 v143, 0
    v_mov_b32 v147, 0
    v_mov_b32 v151, 0
    v_mov_b32 v155, 0
    v_mov_b32 v159, 0
    v_mov_b32 v163, 0
    v_mov_b32 v167, 0
    v_mov_b32 v171, 0
    v_cmp_eq_u32 vcc, 16, v0
    v_mov_b32 v10, 0x3f80
    v_cmp_eq_u32 s[20:21], 17, v0
    v_cndmask_b32 v194, 0, v10, vcc
    v_and_b32 v11, 3, v0
    v_cndmask_b32 v194, v194, 1.0, s[20:21]
    v_cmp_eq_u32 vcc, 2, v11
    v_and_b32 v10, 15, v0
    v_lshrrev_b32 v11, 4, v0
    v_cndmask_b32 v196, 0, 1.0, vcc
    v_cndmask_b32 v197, 0, 1.0, vcc
    v_cndmask_b32 v198, 0, 1.0, vcc
    v_cndmask_b32 v199, 0, 1.0, vcc
    v_lshlrev_b32 v11, 2, v11
    v_sub_u32 v10, v11, v10
    v_mov_b32 v12, 0xf149f2ca
    s_cmp_eq_u32 s41, 0
    s_cselect_b64 s[38:39], 0, -1
    v_add_u32 v11, 0, v10
    v_and_b32 v13, 1, v11
    v_cmp_eq_u32 s[20:21], 0, v13
    v_cmp_lt_i32 vcc, 1, v11
    v_cmp_gt_i32 s[18:19], 1, v11
    s_and_b64 vcc, vcc, s[20:21]
    s_and_b64 s[18:19], s[18:19], s[20:21]
    s_and_b64 s[20:21], vcc, s[38:39]
    v_cndmask_b32 v200, v12, 0, vcc
    v_cndmask_b32 v204, v12, 0, s[18:19]
    v_cndmask_b32 v208, v12, 0, s[20:21]
    v_add_u32 v11, 1, v10
    v_and_b32 v13, 1, v11
    v_cmp_eq_u32 s[20:21], 0, v13
    v_cmp_lt_i32 vcc, 1, v11
    v_cmp_gt_i32 s[18:19], 1, v11
    s_and_b64 vcc, vcc, s[20:21]
    s_and_b64 s[18:19], s[18:19], s[20:21]
    s_and_b64 s[20:21], vcc, s[38:39]
    v_cndmask_b32 v201, v12, 0, vcc
    v_cndmask_b32 v205, v12, 0, s[18:19]
    v_cndmask_b32 v209, v12, 0, s[20:21]
    v_add_u32 v11, 2, v10
    v_and_b32 v13, 1, v11
    v_cmp_eq_u32 s[20:21], 0, v13
    v_cmp_lt_i32 vcc, 1, v11
    v_cmp_gt_i32 s[18:19], 1, v11
    s_and_b64 vcc, vcc, s[20:21]
    s_and_b64 s[18:19], s[18:19], s[20:21]
    s_and_b64 s[20:21], vcc, s[38:39]
    v_cndmask_b32 v202, v12, 0, vcc
    v_cndmask_b32 v206, v12, 0, s[18:19]
    v_cndmask_b32 v210, v12, 0, s[20:21]
    v_add_u32 v11, 3, v10
    v_and_b32 v13, 1, v11
    v_cmp_eq_u32 s[20:21], 0, v13
    v_cmp_lt_i32 vcc, 1, v11
    v_cmp_gt_i32 s[18:19], 1, v11
    s_and_b64 vcc, vcc, s[20:21]
    s_and_b64 s[18:19], s[18:19], s[20:21]
    s_and_b64 s[20:21], vcc, s[38:39]
    v_cndmask_b32 v203, v12, 0, vcc
    v_cndmask_b32 v207, v12, 0, s[18:19]
    v_cndmask_b32 v211, v12, 0, s[20:21]
    s_lshl_b32 s45, s41, 1
    s_lshr_b32 s7, s40, 2
    s_add_u32 s45, s45, s7
    s_mul_i32 s30, s45, 36864
    s_add_u32 s30, s30, s43
    s_and_b32 s31, s40, 3
    s_mul_i32 s31, s31, 9
    s_add_u32 s31, s31, s3
    s_mul_i32 s32, s31, 18432
    s_add_u32 s32, s32, 2359296
    s_add_u32 s33, s32, 73728
    s_add_u32 s34, s32, 147456
    s_and_b32 s7, s40, 3
    s_mul_i32 s6, s7, 18432
    s_add_u32 s6, s6, 3022848
    s_lshl_b32 s39, s7, 8
    s_add_u32 s39, s39, 19496960
    v_lshlrev_b32 v226, 2, v0
    s_cmp_eq_u32 s3, 1
    s_cmov_b32 s34, s6
    s_cmp_lt_u32 s3, 2
    s_cselect_b32 s35, 0, 1073741824
    v_add_u32 v5, s35, v253
    s_cmp_eq_u32 s3, 0
    s_cselect_b32 s35, 0, 1073741824
    v_add_u32 v7, s35, v9
    s_lshl_b32 s7, s31, 8
    s_add_u32 s36, s30, s7
    s_add_u32 s37, s36, 43515904
    s_add_u32 s46, s36, 45875200
    s_lshl_b32 s36, s45, 7
    s_add_u32 s36, s36, s43
    s_add_u32 s36, s36, 48431104
    s_lshl_b32 s47, s45, 9
    s_add_u32 s47, s47, s43
    s_add_u32 s47, s47, 48234496
    v_bfe_u32 v10, v0, 3, 2
    v_and_b32 v8, 7, v0
    v_lshlrev_b32 v8, 2, v8
    v_lshl_add_u32 v8, v10, 7, v8
    v_add_u32 v6, 46080, v253
    s_cmp_lg_u32 s42, 0
    s_cbranch_scc1 L_qkv_x_16
    s_waitcnt vmcnt(36)
    s_branch L_qkv_x_17
L_qkv_x_16:
    s_waitcnt vmcnt(12)
L_qkv_x_17:
    s_barrier
    ds_read_b128 v[16:19], v253 offset:0
    ds_read_b128 v[20:23], v253 offset:1024
    ds_read_b128 v[24:27], v253 offset:2048
    ds_read_b128 v[28:31], v253 offset:3072
    ds_read_b128 v[32:35], v253 offset:4096
    s_waitcnt vmcnt(32) lgkmcnt(0)
    v_mfma_f32_16x16x32_bf16 v[56:59], a[0:3], v[20:23], 0
    ds_read_b128 v[36:39], v253 offset:5120
    v_mfma_f32_16x16x32_bf16 v[60:63], a[0:3], v[24:27], 0
    ds_read_b128 v[40:43], v253 offset:6144
    v_mfma_f32_16x16x32_bf16 v[64:67], a[0:3], v[28:31], 0
    ds_read_b128 v[44:47], v253 offset:7168
    v_mfma_f32_16x16x32_bf16 v[68:71], a[0:3], v[32:35], 0
    ds_read_b128 v[48:51], v253 offset:8192
    v_mfma_f32_16x16x32_bf16 v[72:75], a[4:7], v[16:19], 0
    ds_read_b128 v[52:55], v253 offset:9216
    v_mfma_f32_16x16x32_bf16 v[76:79], a[4:7], v[20:23], 0
    s_add_u32 m0, s25, 27648
    s_nop 0
    buffer_load_dwordx4 v2, s[8:11], s24 offen offset:3072 sc1 lds
    v_mfma_f32_16x16x32_bf16 v[80:83], a[4:7], v[24:27], 0
    v_mfma_f32_16x16x32_bf16 v[84:87], a[4:7], v[28:31], 0
    s_add_u32 m0, s25, 32256
    s_nop 0
    buffer_load_dwordx4 v2, s[8:11], s24 offen offset:3584 sc1 lds
    v_mfma_f32_16x16x32_bf16 v[88:91], a[4:7], v[32:35], 0
    v_mfma_f32_16x16x32_bf16 v[92:95], v[16:19], a[8:11], 0
    buffer_load_dwordx4 a[144:147], v253, s[8:11], s28 offen offset:0 sc1
    v_mfma_f32_16x16x32_bf16 v[96:99], v[20:23], a[8:11], 0
    v_mfma_f32_16x16x32_bf16 v[100:103], v[24:27], a[8:11], 0
    buffer_load_dwordx4 a[148:151], v253, s[8:11], s28 offen offset:1024 sc1
    v_mfma_f32_16x16x32_bf16 v[104:107], v[28:31], a[8:11], 0
    v_mfma_f32_16x16x32_bf16 v[108:111], v[32:35], a[8:11], 0
    buffer_load_dwordx4 a[152:155], v253, s[8:11], s28 offen offset:2048 sc1
    v_mfma_f32_16x16x32_bf16 v[112:115], a[12:15], v[16:19], 0
    v_mfma_f32_16x16x32_bf16 v[116:119], a[12:15], v[20:23], 0
    buffer_load_dwordx4 a[156:159], v253, s[8:11], s28 offen offset:3072 sc1
    v_mfma_f32_16x16x32_bf16 v[120:123], a[12:15], v[24:27], 0
    v_mfma_f32_16x16x32_bf16 v[124:127], a[12:15], v[28:31], 0
    s_add_u32 s28, s28, 4096
    v_mfma_f32_16x16x32_bf16 v[128:131], a[12:15], v[32:35], 0
    s_waitcnt vmcnt(34) lgkmcnt(0)
    v_mfma_f32_16x16x32_bf16 v[56:59], a[16:19], v[40:43], v[56:59]
    ds_read_b128 v[16:19], v253 offset:10240
    v_mfma_f32_16x16x32_bf16 v[60:63], a[16:19], v[44:47], v[60:63]
    ds_read_b128 v[20:23], v253 offset:11264
    v_mfma_f32_16x16x32_bf16 v[64:67], a[16:19], v[48:51], v[64:67]
    ds_read_b128 v[24:27], v253 offset:12288
    v_mfma_f32_16x16x32_bf16 v[68:71], a[16:19], v[52:55], v[68:71]
    ds_read_b128 v[28:31], v253 offset:13312
    v_mfma_f32_16x16x32_bf16 v[72:75], a[20:23], v[36:39], v[72:75]
    ds_read_b128 v[32:35], v253 offset:14336
    v_mfma_f32_16x16x32_bf16 v[76:79], a[20:23], v[40:43], v[76:79]
    s_add_u32 m0, s25, 40960
    s_add_u32 s24, s24, 4096
    buffer_load_dwordx4 v2, s[8:11], s24 offen offset:0 sc1 lds
    v_mfma_f32_16x16x32_bf16 v[80:83], a[20:23], v[44:47], v[80:83]
    v_mfma_f32_16x16x32_bf16 v[84:87], a[20:23], v[48:51], v[84:87]
    s_add_u32 m0, s25, 45568
    s_nop 0
    buffer_load_dwordx4 v2, s[8:11], s24 offen offset:512 sc1 lds
    v_mfma_f32_16x16x32_bf16 v[88:91], a[20:23], v[52:55], v[88:91]
    v_mfma_f32_16x16x32_bf16 v[92:95], v[36:39], a[24:27], v[92:95]
    buffer_load_dwordx4 a[0:3], v253, s[8:11], s28 offen offset:0 sc1
    v_mfma_f32_16x16x32_bf16 v[96:99], v[40:43], a[24:27], v[96:99]
    v_mfma_f32_16x16x32_bf16 v[100:103], v[44:47], a[24:27], v[100:103]
    buffer_load_dwordx4 a[4:7], v253, s[8:11], s28 offen offset:1024 sc1
    v_mfma_f32_16x16x32_bf16 v[104:107], v[48:51], a[24:27], v[104:107]
    v_mfma_f32_16x16x32_bf16 v[108:111], v[52:55], a[24:27], v[108:111]
    buffer_load_dwordx4 a[8:11], v253, s[8:11], s28 offen offset:2048 sc1
    v_mfma_f32_16x16x32_bf16 v[112:115], a[28:31], v[36:39], v[112:115]
    v_mfma_f32_16x16x32_bf16 v[116:119], a[28:31], v[40:43], v[116:119]
    buffer_load_dwordx4 a[12:15], v253, s[8:11], s28 offen offset:3072 sc1
    v_mfma_f32_16x16x32_bf16 v[120:123], a[28:31], v[44:47], v[120:123]
    v_mfma_f32_16x16x32_bf16 v[124:127], a[28:31], v[48:51], v[124:127]
    s_add_u32 s28, s28, 4096
    v_mfma_f32_16x16x32_bf16 v[128:131], a[28:31], v[52:55], v[128:131]
    s_waitcnt vmcnt(36) lgkmcnt(0)
    v_mfma_f32_16x16x32_bf16 v[56:59], a[32:35], v[20:23], v[56:59]
    ds_read_b128 v[36:39], v253 offset:15360
    v_mfma_f32_16x16x32_bf16 v[60:63], a[32:35], v[24:27], v[60:63]
    ds_read_b128 v[40:43], v253 offset:16384
    v_mfma_f32_16x16x32_bf16 v[64:67], a[32:35], v[28:31], v[64:67]
    ds_read_b128 v[44:47], v253 offset:17408
    v_mfma_f32_16x16x32_bf16 v[68:71], a[32:35], v[32:35], v[68:71]
    ds_read_b128 v[48:51], v253 offset:18432
    v_mfma_f32_16x16x32_bf16 v[72:75], a[36:39], v[16:19], v[72:75]
    ds_read_b128 v[52:55], v253 offset:19456
    v_mfma_f32_16x16x32_bf16 v[76:79], a[36:39], v[20:23], v[76:79]
    s_add_u32 m0, s25, 50176
    s_nop 0
    buffer_load_dwordx4 v2, s[8:11], s24 offen offset:1024 sc1 lds
    v_mfma_f32_16x16x32_bf16 v[80:83], a[36:39], v[24:27], v[80:83]
    v_mfma_f32_16x16x32_bf16 v[84:87], a[36:39], v[28:31], v[84:87]
    s_add_u32 m0, s25, 54784
    s_nop 0
    buffer_load_dwordx4 v2, s[8:11], s24 offen offset:1536 sc1 lds
    v_mfma_f32_16x16x32_bf16 v[88:91], a[36:39], v[32:35], v[88:91]
    v_mfma_f32_16x16x32_bf16 v[92:95], v[16:19], a[40:43], v[92:95]
    buffer_load_dwordx4 a[16:19], v253, s[8:11], s28 offen offset:0 sc1
    v_mfma_f32_16x16x32_bf16 v[96:99], v[20:23], a[40:43], v[96:99]
    v_mfma_f32_16x16x32_bf16 v[100:103], v[24:27], a[40:43], v[100:103]
    buffer_load_dwordx4 a[20:23], v253, s[8:11], s28 offen offset:1024 sc1
    v_mfma_f32_16x16x32_bf16 v[104:107], v[28:31], a[40:43], v[104:107]
    v_mfma_f32_16x16x32_bf16 v[108:111], v[32:35], a[40:43], v[108:111]
    buffer_load_dwordx4 a[24:27], v253, s[8:11], s28 offen offset:2048 sc1
    v_mfma_f32_16x16x32_bf16 v[112:115], a[44:47], v[16:19], v[112:115]
    v_mfma_f32_16x16x32_bf16 v[116:119], a[44:47], v[20:23], v[116:119]
    buffer_load_dwordx4 a[28:31], v253, s[8:11], s28 offen offset:3072 sc1
    v_mfma_f32_16x16x32_bf16 v[120:123], a[44:47], v[24:27], v[120:123]
    v_mfma_f32_16x16x32_bf16 v[124:127], a[44:47], v[28:31], v[124:127]
    s_add_u32 s28, s28, 4096
    v_mfma_f32_16x16x32_bf16 v[128:131], a[44:47], v[32:35], v[128:131]
    s_waitcnt vmcnt(38) lgkmcnt(0)
    v_mfma_f32_16x16x32_bf16 v[56:59], a[48:51], v[40:43], v[56:59]
    ds_read_b128 v[16:19], v253 offset:20480
    v_mfma_f32_16x16x32_bf16 v[60:63], a[48:51], v[44:47], v[60:63]
    ds_read_b128 v[20:23], v253 offset:21504
    v_mfma_f32_16x16x32_bf16 v[64:67], a[48:51], v[48:51], v[64:67]
    ds_read_b128 v[24:27], v253 offset:22528
    v_mfma_f32_16x16x32_bf16 v[68:71], a[48:51], v[52:55], v[68:71]
    ds_read_b128 v[28:31], v253 offset:23552
    v_mfma_f32_16x16x32_bf16 v[72:75], a[52:55], v[36:39], v[72:75]
    ds_read_b128 v[32:35], v253 offset:24576
    v_mfma_f32_16x16x32_bf16 v[76:79], a[52:55], v[40:43], v[76:79]
    s_add_u32 m0, s26, 30720
    s_add_u32 s7, s27, 3072
    buffer_load_dwordx4 v2, s[8:11], s7 offen sc1 lds
    v_mfma_f32_16x16x32_bf16 v[80:83], a[52:55], v[44:47], v[80:83]
    v_mfma_f32_16x16x32_bf16 v[84:87], a[52:55], v[48:51], v[84:87]
    s_add_u32 m0, s29, 30720
    s_add_u32 s7, s23, 3072
    buffer_load_dwordx4 v2, s[8:11], s7 offen sc1 lds
    v_mfma_f32_16x16x32_bf16 v[88:91], a[52:55], v[52:55], v[88:91]
    v_mfma_f32_16x16x32_bf16 v[92:95], v[36:39], a[56:59], v[92:95]
    buffer_load_dwordx4 a[32:35], v253, s[8:11], s28 offen offset:0 sc1
    v_mfma_f32_16x16x32_bf16 v[96:99], v[40:43], a[56:59], v[96:99]
    v_mfma_f32_16x16x32_bf16 v[100:103], v[44:47], a[56:59], v[100:103]
    buffer_load_dwordx4 a[36:39], v253, s[8:11], s28 offen offset:1024 sc1
    v_mfma_f32_16x16x32_bf16 v[104:107], v[48:51], a[56:59], v[104:107]
    v_mfma_f32_16x16x32_bf16 v[108:111], v[52:55], a[56:59], v[108:111]
    buffer_load_dwordx4 a[40:43], v253, s[8:11], s28 offen offset:2048 sc1
    v_mfma_f32_16x16x32_bf16 v[112:115], a[60:63], v[36:39], v[112:115]
    v_mfma_f32_16x16x32_bf16 v[116:119], a[60:63], v[40:43], v[116:119]
    buffer_load_dwordx4 a[44:47], v253, s[8:11], s28 offen offset:3072 sc1
    v_mfma_f32_16x16x32_bf16 v[120:123], a[60:63], v[44:47], v[120:123]
    v_mfma_f32_16x16x32_bf16 v[124:127], a[60:63], v[48:51], v[124:127]
    s_add_u32 s28, s28, 4096
    v_mfma_f32_16x16x32_bf16 v[128:131], a[60:63], v[52:55], v[128:131]
    s_waitcnt vmcnt(40) lgkmcnt(0)
    v_mfma_f32_16x16x32_bf16 v[56:59], a[64:67], v[20:23], v[56:59]
    ds_read_b128 v[36:39], v253 offset:25600
    v_mfma_f32_16x16x32_bf16 v[60:63], a[64:67], v[24:27], v[60:63]
    ds_read_b128 v[40:43], v253 offset:26624
    v_mfma_f32_16x16x32_bf16 v[64:67], a[64:67], v[28:31], v[64:67]
    ds_read_b128 v[44:47], v253 offset:27648
    v_mfma_f32_16x16x32_bf16 v[68:71], a[64:67], v[32:35], v[68:71]
    ds_read_b128 v[48:51], v253 offset:28672
    v_mfma_f32_16x16x32_bf16 v[72:75], a[68:71], v[16:19], v[72:75]
    ds_read_b128 v[52:55], v253 offset:29696
    v_mfma_f32_16x16x32_bf16 v[76:79], a[68:71], v[20:23], v[76:79]
    buffer_load_dwordx4 a[48:51], v253, s[8:11], s28 offen offset:0 sc1
    v_mfma_f32_16x16x32_bf16 v[80:83], a[68:71], v[24:27], v[80:83]
    v_mfma_f32_16x16x32_bf16 v[84:87], a[68:71], v[28:31], v[84:87]
    buffer_load_dwordx4 a[52:55], v253, s[8:11], s28 offen offset:1024 sc1
    v_mfma_f32_16x16x32_bf16 v[88:91], a[68:71], v[32:35], v[88:91]
    v_mfma_f32_16x16x32_bf16 v[92:95], v[16:19], a[72:75], v[92:95]
    buffer_load_dwordx4 a[56:59], v253, s[8:11], s28 offen offset:2048 sc1
    v_mfma_f32_16x16x32_bf16 v[96:99], v[20:23], a[72:75], v[96:99]
    v_mfma_f32_16x16x32_bf16 v[100:103], v[24:27], a[72:75], v[100:103]
    buffer_load_dwordx4 a[60:63], v253, s[8:11], s28 offen offset:3072 sc1
    v_mfma_f32_16x16x32_bf16 v[104:107], v[28:31], a[72:75], v[104:107]
    v_mfma_f32_16x16x32_bf16 v[108:111], v[32:35], a[72:75], v[108:111]
    buffer_load_dword v225, v226, s[8:11], s39 offen sc1
    v_mfma_f32_16x16x32_bf16 v[112:115], a[76:79], v[16:19], v[112:115]
    v_mfma_f32_16x16x32_bf16 v[116:119], a[76:79], v[20:23], v[116:119]
    v_mfma_f32_16x16x32_bf16 v[120:123], a[76:79], v[24:27], v[120:123]
    v_mfma_f32_16x16x32_bf16 v[124:127], a[76:79], v[28:31], v[124:127]
    s_add_u32 s28, s28, 4096
    v_mfma_f32_16x16x32_bf16 v[128:131], a[76:79], v[32:35], v[128:131]
    s_waitcnt vmcnt(9) lgkmcnt(0)
    s_barrier
    v_mfma_f32_16x16x32_bf16 v[56:59], a[80:83], v[40:43], v[56:59]
    ds_read_b128 v[16:19], v253 offset:30720
    v_mfma_f32_16x16x32_bf16 v[60:63], a[80:83], v[44:47], v[60:63]
    ds_read_b128 v[20:23], v253 offset:31744
    v_mfma_f32_16x16x32_bf16 v[64:67], a[80:83], v[48:51], v[64:67]
    ds_read_b128 v[24:27], v253 offset:32768
    v_mfma_f32_16x16x32_bf16 v[68:71], a[80:83], v[52:55], v[68:71]
    ds_read_b128 v[28:31], v253 offset:33792
    v_mfma_f32_16x16x32_bf16 v[72:75], a[84:87], v[36:39], v[72:75]
    ds_read_b128 v[32:35], v253 offset:34816
    v_mfma_f32_16x16x32_bf16 v[76:79], a[84:87], v[40:43], v[76:79]
    s_add_u32 m0, s25, 59392
    s_nop 0
    buffer_load_dwordx4 v2, s[8:11], s24 offen offset:2048 sc1 lds
    v_mfma_f32_16x16x32_bf16 v[80:83], a[84:87], v[44:47], v[80:83]
    v_mfma_f32_16x16x32_bf16 v[84:87], a[84:87], v[48:51], v[84:87]
    s_add_u32 m0, s25, 64000
    s_nop 0
    buffer_load_dwordx4 v2, s[8:11], s24 offen offset:2560 sc1 lds
    v_mfma_f32_16x16x32_bf16 v[88:91], a[84:87], v[52:55], v[88:91]
    v_mfma_f32_16x16x32_bf16 v[92:95], v[36:39], a[88:91], v[92:95]
    buffer_load_dwordx4 a[64:67], v253, s[8:11], s28 offen offset:0 sc1
    v_mfma_f32_16x16x32_bf16 v[96:99], v[40:43], a[88:91], v[96:99]
    v_mfma_f32_16x16x32_bf16 v[100:103], v[44:47], a[88:91], v[100:103]
    buffer_load_dwordx4 a[68:71], v253, s[8:11], s28 offen offset:1024 sc1
    v_mfma_f32_16x16x32_bf16 v[104:107], v[48:51], a[88:91], v[104:107]
    v_mfma_f32_16x16x32_bf16 v[108:111], v[52:55], a[88:91], v[108:111]
    buffer_load_dwordx4 a[72:75], v253, s[8:11], s28 offen offset:2048 sc1
    v_mfma_f32_16x16x32_bf16 v[112:115], a[92:95], v[36:39], v[112:115]
    v_mfma_f32_16x16x32_bf16 v[116:119], a[92:95], v[40:43], v[116:119]
    buffer_load_dwordx4 a[76:79], v253, s[8:11], s28 offen offset:3072 sc1
    v_mfma_f32_16x16x32_bf16 v[120:123], a[92:95], v[44:47], v[120:123]
    v_mfma_f32_16x16x32_bf16 v[124:127], a[92:95], v[48:51], v[124:127]
    s_add_u32 s28, s28, 4096
    v_mfma_f32_16x16x32_bf16 v[128:131], a[92:95], v[52:55], v[128:131]
    s_waitcnt vmcnt(43) lgkmcnt(0)
    v_mfma_f32_16x16x32_bf16 v[56:59], a[96:99], v[20:23], v[56:59]
    ds_read_b128 v[36:39], v253 offset:35840
    v_mfma_f32_16x16x32_bf16 v[60:63], a[96:99], v[24:27], v[60:63]
    ds_read_b128 v[40:43], v253 offset:36864
    v_mfma_f32_16x16x32_bf16 v[64:67], a[96:99], v[28:31], v[64:67]
    ds_read_b128 v[44:47], v253 offset:37888
    v_mfma_f32_16x16x32_bf16 v[68:71], a[96:99], v[32:35], v[68:71]
    ds_read_b128 v[48:51], v253 offset:38912
    v_mfma_f32_16x16x32_bf16 v[72:75], a[100:103], v[16:19], v[72:75]
    ds_read_b128 v[52:55], v253 offset:39936
    v_mfma_f32_16x16x32_bf16 v[76:79], a[100:103], v[20:23], v[76:79]
    s_add_u32 m0, s25, 68608
    s_nop 0
    buffer_load_dwordx4 v2, s[8:11], s24 offen offset:3072 sc1 lds
    v_mfma_f32_16x16x32_bf16 v[80:83], a[100:103], v[24:27], v[80:83]
    v_mfma_f32_16x16x32_bf16 v[84:87], a[100:103], v[28:31], v[84:87]
    s_add_u32 m0, s25, 73216
    s_nop 0
    buffer_load_dwordx4 v2, s[8:11], s24 offen offset:3584 sc1 lds
    v_mfma_f32_16x16x32_bf16 v[88:91], a[100:103], v[32:35], v[88:91]
    v_mfma_f32_16x16x32_bf16 v[92:95], v[16:19], a[104:107], v[92:95]
    buffer_load_dwordx4 a[80:83], v253, s[8:11], s28 offen offset:0 sc1
    v_mfma_f32_16x16x32_bf16 v[96:99], v[20:23], a[104:107], v[96:99]
    v_mfma_f32_16x16x32_bf16 v[100:103], v[24:27], a[104:107], v[100:103]
    buffer_load_dwordx4 a[84:87], v253, s[8:11], s28 offen offset:1024 sc1
    v_mfma_f32_16x16x32_bf16 v[104:107], v[28:31], a[104:107], v[104:107]
    v_mfma_f32_16x16x32_bf16 v[108:111], v[32:35], a[104:107], v[108:111]
    buffer_load_dwordx4 a[88:91], v253, s[8:11], s28 offen offset:2048 sc1
    v_mfma_f32_16x16x32_bf16 v[112:115], a[108:111], v[16:19], v[112:115]
    v_mfma_f32_16x16x32_bf16 v[116:119], a[108:111], v[20:23], v[116:119]
    buffer_load_dwordx4 a[92:95], v253, s[8:11], s28 offen offset:3072 sc1
    v_mfma_f32_16x16x32_bf16 v[120:123], a[108:111], v[24:27], v[120:123]
    v_mfma_f32_16x16x32_bf16 v[124:127], a[108:111], v[28:31], v[124:127]
    s_add_u32 s28, s28, 4096
    v_mfma_f32_16x16x32_bf16 v[128:131], a[108:111], v[32:35], v[128:131]
    s_waitcnt vmcnt(45) lgkmcnt(0)
    v_mfma_f32_16x16x32_bf16 v[56:59], a[112:115], v[40:43], v[56:59]
    ds_read_b128 v[16:19], v253 offset:40960
    v_mfma_f32_16x16x32_bf16 v[60:63], a[112:115], v[44:47], v[60:63]
    ds_read_b128 v[20:23], v253 offset:41984
    v_mfma_f32_16x16x32_bf16 v[64:67], a[112:115], v[48:51], v[64:67]
    ds_read_b128 v[24:27], v253 offset:43008
    v_mfma_f32_16x16x32_bf16 v[68:71], a[112:115], v[52:55], v[68:71]
    ds_read_b128 v[28:31], v253 offset:44032
    v_mfma_f32_16x16x32_bf16 v[72:75], a[116:119], v[36:39], v[72:75]
    ds_read_b128 v[32:35], v253 offset:45056
    v_mfma_f32_16x16x32_bf16 v[76:79], a[116:119], v[40:43], v[76:79]
    s_add_u32 m0, s25, 81920
    s_add_u32 s24, s24, 4096
    buffer_load_dwordx4 v2, s[8:11], s24 offen offset:0 sc1 lds
    v_mfma_f32_16x16x32_bf16 v[80:83], a[116:119], v[44:47], v[80:83]
    v_mfma_f32_16x16x32_bf16 v[84:87], a[116:119], v[48:51], v[84:87]
    s_add_u32 m0, s25, 86528
    s_nop 0
    buffer_load_dwordx4 v2, s[8:11], s24 offen offset:512 sc1 lds
    v_mfma_f32_16x16x32_bf16 v[88:91], a[116:119], v[52:55], v[88:91]
    v_mfma_f32_16x16x32_bf16 v[92:95], v[36:39], a[120:123], v[92:95]
    buffer_load_dwordx4 a[96:99], v253, s[8:11], s28 offen offset:0 sc1
    v_mfma_f32_16x16x32_bf16 v[96:99], v[40:43], a[120:123], v[96:99]
    v_mfma_f32_16x16x32_bf16 v[100:103], v[44:47], a[120:123], v[100:103]
    buffer_load_dwordx4 a[100:103], v253, s[8:11], s28 offen offset:1024 sc1
    v_mfma_f32_16x16x32_bf16 v[104:107], v[48:51], a[120:123], v[104:107]
    v_mfma_f32_16x16x32_bf16 v[108:111], v[52:55], a[120:123], v[108:111]
    buffer_load_dwordx4 a[104:107], v253, s[8:11], s28 offen offset:2048 sc1
    v_mfma_f32_16x16x32_bf16 v[112:115], a[124:127], v[36:39], v[112:115]
    v_mfma_f32_16x16x32_bf16 v[116:119], a[124:127], v[40:43], v[116:119]
    buffer_load_dwordx4 a[108:111], v253, s[8:11], s28 offen offset:3072 sc1
    v_mfma_f32_16x16x32_bf16 v[120:123], a[124:127], v[44:47], v[120:123]
    v_mfma_f32_16x16x32_bf16 v[124:127], a[124:127], v[48:51], v[124:127]
    s_add_u32 s28, s28, 4096
    v_mfma_f32_16x16x32_bf16 v[128:131], a[124:127], v[52:55], v[128:131]
    s_waitcnt vmcnt(47) lgkmcnt(0)
    v_mfma_f32_16x16x32_bf16 v[56:59], a[128:131], v[20:23], v[56:59]
    ds_read_b128 v[36:39], v6 offset:0
    v_mfma_f32_16x16x32_bf16 v[60:63], a[128:131], v[24:27], v[60:63]
    ds_read_b128 v[40:43], v6 offset:1024
    v_mfma_f32_16x16x32_bf16 v[64:67], a[128:131], v[28:31], v[64:67]
    ds_read_b128 v[44:47], v6 offset:2048
    v_mfma_f32_16x16x32_bf16 v[68:71], a[128:131], v[32:35], v[68:71]
    ds_read_b128 v[48:51], v6 offset:3072
    v_mfma_f32_16x16x32_bf16 v[72:75], a[132:135], v[16:19], v[72:75]
    ds_read_b128 v[52:55], v6 offset:4096
    v_mfma_f32_16x16x32_bf16 v[76:79], a[132:135], v[20:23], v[76:79]
    s_add_u32 m0, s26, 61440
    s_add_u32 s7, s27, 6144
    buffer_load_dwordx4 v2, s[8:11], s7 offen sc1 lds
    v_mfma_f32_16x16x32_bf16 v[80:83], a[132:135], v[24:27], v[80:83]
    v_mfma_f32_16x16x32_bf16 v[84:87], a[132:135], v[28:31], v[84:87]
    s_add_u32 m0, s29, 61440
    s_add_u32 s7, s23, 6144
    buffer_load_dwordx4 v2, s[8:11], s7 offen sc1 lds
    v_mfma_f32_16x16x32_bf16 v[88:91], a[132:135], v[32:35], v[88:91]
    v_mfma_f32_16x16x32_bf16 v[92:95], v[16:19], a[136:139], v[92:95]
    buffer_load_dwordx4 a[112:115], v253, s[8:11], s28 offen offset:0 sc1
    v_mfma_f32_16x16x32_bf16 v[96:99], v[20:23], a[136:139], v[96:99]
    v_mfma_f32_16x16x32_bf16 v[100:103], v[24:27], a[136:139], v[100:103]
    buffer_load_dwordx4 a[116:119], v253, s[8:11], s28 offen offset:1024 sc1
    v_mfma_f32_16x16x32_bf16 v[104:107], v[28:31], a[136:139], v[104:107]
    v_mfma_f32_16x16x32_bf16 v[108:111], v[32:35], a[136:139], v[108:111]
    buffer_load_dwordx4 a[120:123], v253, s[8:11], s28 offen offset:2048 sc1
    v_mfma_f32_16x16x32_bf16 v[112:115], a[140:143], v[16:19], v[112:115]
    v_mfma_f32_16x16x32_bf16 v[116:119], a[140:143], v[20:23], v[116:119]
    buffer_load_dwordx4 a[124:127], v253, s[8:11], s28 offen offset:3072 sc1
    v_mfma_f32_16x16x32_bf16 v[120:123], a[140:143], v[24:27], v[120:123]
    v_mfma_f32_16x16x32_bf16 v[124:127], a[140:143], v[28:31], v[124:127]
    s_add_u32 s28, s28, 4096
    v_mfma_f32_16x16x32_bf16 v[128:131], a[140:143], v[32:35], v[128:131]
    s_waitcnt vmcnt(24) lgkmcnt(0)
    v_cmp_eq_u32 vcc, s76, v225
    s_cmp_eq_u64 vcc, exec
    s_cbranch_scc1 L_wo_ready_18
    s_mov_b32 s6, 0
L_spin_19:
    buffer_load_dword v1, v226, s[8:11], s39 offen sc1
    s_add_u32 s6, s6, 1
    s_waitcnt vmcnt(0)
    v_cmp_eq_u32 vcc, s76, v1
    s_cmp_eq_u64 vcc, exec
    s_cbranch_scc1 L_spun_20
    s_cmp_lt_u32 s6, 1048576
    s_cbranch_scc1 L_spin_19
    s_branch L_main_end
L_spun_20:
L_wo_ready_18:
    v_mfma_f32_16x16x32_bf16 v[56:59], a[144:147], v[40:43], v[56:59]
    ds_read_b128 v[16:19], v6 offset:5120
    v_mfma_f32_16x16x32_bf16 v[60:63], a[144:147], v[44:47], v[60:63]
    ds_read_b128 v[20:23], v6 offset:6144
    v_mfma_f32_16x16x32_bf16 v[64:67], a[144:147], v[48:51], v[64:67]
    ds_read_b128 v[24:27], v6 offset:7168
    v_mfma_f32_16x16x32_bf16 v[68:71], a[144:147], v[52:55], v[68:71]
    ds_read_b128 v[28:31], v6 offset:8192
    v_mfma_f32_16x16x32_bf16 v[72:75], a[148:151], v[36:39], v[72:75]
    ds_read_b128 v[32:35], v6 offset:9216
    v_mfma_f32_16x16x32_bf16 v[76:79], a[148:151], v[40:43], v[76:79]
    buffer_load_dwordx4 a[160:163], v253, s[8:11], s32 offen offset:0 sc1
    v_mfma_f32_16x16x32_bf16 v[80:83], a[148:151], v[44:47], v[80:83]
    v_mfma_f32_16x16x32_bf16 v[84:87], a[148:151], v[48:51], v[84:87]
    buffer_load_dwordx4 a[164:167], v253, s[8:11], s33 offen offset:0 sc1
    v_mfma_f32_16x16x32_bf16 v[88:91], a[148:151], v[52:55], v[88:91]
    v_mfma_f32_16x16x32_bf16 v[92:95], v[36:39], a[152:155], v[92:95]
    buffer_load_dwordx4 a[168:171], v5, s[8:11], s34 offen offset:0 sc1
    v_mfma_f32_16x16x32_bf16 v[96:99], v[40:43], a[152:155], v[96:99]
    v_mfma_f32_16x16x32_bf16 v[100:103], v[44:47], a[152:155], v[100:103]
    buffer_load_dwordx4 a[172:175], v253, s[8:11], s32 offen offset:1024 sc1
    v_mfma_f32_16x16x32_bf16 v[104:107], v[48:51], a[152:155], v[104:107]
    v_mfma_f32_16x16x32_bf16 v[108:111], v[52:55], a[152:155], v[108:111]
    v_mfma_f32_16x16x32_bf16 v[112:115], a[156:159], v[36:39], v[112:115]
    v_mfma_f32_16x16x32_bf16 v[116:119], a[156:159], v[40:43], v[116:119]
    v_mfma_f32_16x16x32_bf16 v[120:123], a[156:159], v[44:47], v[120:123]
    v_mfma_f32_16x16x32_bf16 v[124:127], a[156:159], v[48:51], v[124:127]
    v_mfma_f32_16x16x32_bf16 v[128:131], a[156:159], v[52:55], v[128:131]
    s_waitcnt vmcnt(45) lgkmcnt(0)
    v_mfma_f32_16x16x32_bf16 v[56:59], a[0:3], v[20:23], v[56:59]
    ds_read_b128 v[36:39], v6 offset:10240
    v_mfma_f32_16x16x32_bf16 v[60:63], a[0:3], v[24:27], v[60:63]
    ds_read_b128 v[40:43], v6 offset:11264
    v_mfma_f32_16x16x32_bf16 v[64:67], a[0:3], v[28:31], v[64:67]
    ds_read_b128 v[44:47], v6 offset:12288
    v_mfma_f32_16x16x32_bf16 v[68:71], a[0:3], v[32:35], v[68:71]
    ds_read_b128 v[48:51], v6 offset:13312
    v_mfma_f32_16x16x32_bf16 v[72:75], a[4:7], v[16:19], v[72:75]
    ds_read_b128 v[52:55], v6 offset:14336
    v_mfma_f32_16x16x32_bf16 v[76:79], a[4:7], v[20:23], v[76:79]
    buffer_load_dwordx4 a[176:179], v253, s[8:11], s33 offen offset:1024 sc1
    v_mfma_f32_16x16x32_bf16 v[80:83], a[4:7], v[24:27], v[80:83]
    v_mfma_f32_16x16x32_bf16 v[84:87], a[4:7], v[28:31], v[84:87]
    buffer_load_dwordx4 a[180:183], v5, s[8:11], s34 offen offset:1024 sc1
    v_mfma_f32_16x16x32_bf16 v[88:91], a[4:7], v[32:35], v[88:91]
    v_mfma_f32_16x16x32_bf16 v[92:95], v[16:19], a[8:11], v[92:95]
    buffer_load_dwordx4 a[184:187], v253, s[8:11], s32 offen offset:2048 sc1
    v_mfma_f32_16x16x32_bf16 v[96:99], v[20:23], a[8:11], v[96:99]
    v_mfma_f32_16x16x32_bf16 v[100:103], v[24:27], a[8:11], v[100:103]
    buffer_load_dwordx4 a[188:191], v253, s[8:11], s33 offen offset:2048 sc1
    v_mfma_f32_16x16x32_bf16 v[104:107], v[28:31], a[8:11], v[104:107]
    v_mfma_f32_16x16x32_bf16 v[108:111], v[32:35], a[8:11], v[108:111]
    v_mfma_f32_16x16x32_bf16 v[112:115], a[12:15], v[16:19], v[112:115]
    v_mfma_f32_16x16x32_bf16 v[116:119], a[12:15], v[20:23], v[116:119]
    v_mfma_f32_16x16x32_bf16 v[120:123], a[12:15], v[24:27], v[120:123]
    v_mfma_f32_16x16x32_bf16 v[124:127], a[12:15], v[28:31], v[124:127]
    v_mfma_f32_16x16x32_bf16 v[128:131], a[12:15], v[32:35], v[128:131]
    s_waitcnt vmcnt(12) lgkmcnt(0)
    s_barrier
    v_mfma_f32_16x16x32_bf16 v[56:59], a[16:19], v[40:43], v[56:59]
    ds_read_b128 v[16:19], v6 offset:15360
    v_mfma_f32_16x16x32_bf16 v[60:63], a[16:19], v[44:47], v[60:63]
    ds_read_b128 v[20:23], v6 offset:16384
    v_mfma_f32_16x16x32_bf16 v[64:67], a[16:19], v[48:51], v[64:67]
    ds_read_b128 v[24:27], v6 offset:17408
    v_mfma_f32_16x16x32_bf16 v[68:71], a[16:19], v[52:55], v[68:71]
    ds_read_b128 v[28:31], v6 offset:18432
    v_mfma_f32_16x16x32_bf16 v[72:75], a[20:23], v[36:39], v[72:75]
    ds_read_b128 v[32:35], v6 offset:19456
    v_mfma_f32_16x16x32_bf16 v[76:79], a[20:23], v[40:43], v[76:79]
    buffer_load_dwordx4 a[192:195], v5, s[8:11], s34 offen offset:2048 sc1
    v_mfma_f32_16x16x32_bf16 v[80:83], a[20:23], v[44:47], v[80:83]
    v_mfma_f32_16x16x32_bf16 v[84:87], a[20:23], v[48:51], v[84:87]
    buffer_load_dwordx4 a[196:199], v253, s[8:11], s32 offen offset:3072 sc1
    s_add_u32 s32, s32, 4096
    v_mfma_f32_16x16x32_bf16 v[88:91], a[20:23], v[52:55], v[88:91]
    v_mfma_f32_16x16x32_bf16 v[92:95], v[36:39], a[24:27], v[92:95]
    buffer_load_dwordx4 a[200:203], v253, s[8:11], s33 offen offset:3072 sc1
    s_add_u32 s33, s33, 4096
    v_mfma_f32_16x16x32_bf16 v[96:99], v[40:43], a[24:27], v[96:99]
    v_mfma_f32_16x16x32_bf16 v[100:103], v[44:47], a[24:27], v[100:103]
    buffer_load_dwordx4 a[204:207], v5, s[8:11], s34 offen offset:3072 sc1
    s_add_u32 s34, s34, 4096
    v_mfma_f32_16x16x32_bf16 v[104:107], v[48:51], a[24:27], v[104:107]
    v_mfma_f32_16x16x32_bf16 v[108:111], v[52:55], a[24:27], v[108:111]
    v_mfma_f32_16x16x32_bf16 v[112:115], a[28:31], v[36:39], v[112:115]
    v_mfma_f32_16x16x32_bf16 v[116:119], a[28:31], v[40:43], v[116:119]
    v_mfma_f32_16x16x32_bf16 v[120:123], a[28:31], v[44:47], v[120:123]
    v_mfma_f32_16x16x32_bf16 v[124:127], a[28:31], v[48:51], v[124:127]
    v_mfma_f32_16x16x32_bf16 v[128:131], a[28:31], v[52:55], v[128:131]
    s_waitcnt vmcnt(41) lgkmcnt(0)
    v_mfma_f32_16x16x32_bf16 v[56:59], a[32:35], v[20:23], v[56:59]
    ds_read_b128 v[36:39], v6 offset:20480
    v_mfma_f32_16x16x32_bf16 v[60:63], a[32:35], v[24:27], v[60:63]
    ds_read_b128 v[40:43], v6 offset:21504
    v_mfma_f32_16x16x32_bf16 v[64:67], a[32:35], v[28:31], v[64:67]
    ds_read_b128 v[44:47], v6 offset:22528
    v_mfma_f32_16x16x32_bf16 v[68:71], a[32:35], v[32:35], v[68:71]
    ds_read_b128 v[48:51], v6 offset:23552
    v_mfma_f32_16x16x32_bf16 v[72:75], a[36:39], v[16:19], v[72:75]
    ds_read_b128 v[52:55], v6 offset:24576
    v_mfma_f32_16x16x32_bf16 v[76:79], a[36:39], v[20:23], v[76:79]
    buffer_load_dwordx4 a[208:211], v253, s[8:11], s32 offen offset:0 sc1
    v_mfma_f32_16x16x32_bf16 v[80:83], a[36:39], v[24:27], v[80:83]
    v_mfma_f32_16x16x32_bf16 v[84:87], a[36:39], v[28:31], v[84:87]
    buffer_load_dwordx4 a[212:215], v253, s[8:11], s33 offen offset:0 sc1
    v_mfma_f32_16x16x32_bf16 v[88:91], a[36:39], v[32:35], v[88:91]
    v_mfma_f32_16x16x32_bf16 v[92:95], v[16:19], a[40:43], v[92:95]
    buffer_load_dwordx4 a[216:219], v5, s[8:11], s34 offen offset:0 sc1
    v_mfma_f32_16x16x32_bf16 v[96:99], v[20:23], a[40:43], v[96:99]
    v_mfma_f32_16x16x32_bf16 v[100:103], v[24:27], a[40:43], v[100:103]
    buffer_load_dwordx4 a[220:223], v253, s[8:11], s32 offen offset:1024 sc1
    v_mfma_f32_16x16x32_bf16 v[104:107], v[28:31], a[40:43], v[104:107]
    v_mfma_f32_16x16x32_bf16 v[108:111], v[32:35], a[40:43], v[108:111]
    v_mfma_f32_16x16x32_bf16 v[112:115], a[44:47], v[16:19], v[112:115]
    v_mfma_f32_16x16x32_bf16 v[116:119], a[44:47], v[20:23], v[116:119]
    v_mfma_f32_16x16x32_bf16 v[120:123], a[44:47], v[24:27], v[120:123]
    v_mfma_f32_16x16x32_bf16 v[124:127], a[44:47], v[28:31], v[124:127]
    v_mfma_f32_16x16x32_bf16 v[128:131], a[44:47], v[32:35], v[128:131]
    s_waitcnt vmcnt(41) lgkmcnt(0)
    v_mfma_f32_16x16x32_bf16 v[56:59], a[48:51], v[40:43], v[56:59]
    ds_read_b128 v[16:19], v6 offset:25600
    v_mfma_f32_16x16x32_bf16 v[60:63], a[48:51], v[44:47], v[60:63]
    ds_read_b128 v[20:23], v6 offset:26624
    v_mfma_f32_16x16x32_bf16 v[64:67], a[48:51], v[48:51], v[64:67]
    ds_read_b128 v[24:27], v6 offset:27648
    v_mfma_f32_16x16x32_bf16 v[68:71], a[48:51], v[52:55], v[68:71]
    ds_read_b128 v[28:31], v6 offset:28672
    v_mfma_f32_16x16x32_bf16 v[72:75], a[52:55], v[36:39], v[72:75]
    ds_read_b128 v[32:35], v6 offset:29696
    v_mfma_f32_16x16x32_bf16 v[76:79], a[52:55], v[40:43], v[76:79]
    buffer_load_dwordx4 a[224:227], v253, s[8:11], s33 offen offset:1024 sc1
    v_mfma_f32_16x16x32_bf16 v[80:83], a[52:55], v[44:47], v[80:83]
    v_mfma_f32_16x16x32_bf16 v[84:87], a[52:55], v[48:51], v[84:87]
    buffer_load_dwordx4 a[228:231], v5, s[8:11], s34 offen offset:1024 sc1
    v_mfma_f32_16x16x32_bf16 v[88:91], a[52:55], v[52:55], v[88:91]
    v_mfma_f32_16x16x32_bf16 v[92:95], v[36:39], a[56:59], v[92:95]
    buffer_load_dwordx4 a[232:235], v253, s[8:11], s32 offen offset:2048 sc1
    v_mfma_f32_16x16x32_bf16 v[96:99], v[40:43], a[56:59], v[96:99]
    v_mfma_f32_16x16x32_bf16 v[100:103], v[44:47], a[56:59], v[100:103]
    buffer_load_dwordx4 a[236:239], v253, s[8:11], s33 offen offset:2048 sc1
    v_mfma_f32_16x16x32_bf16 v[104:107], v[48:51], a[56:59], v[104:107]
    v_mfma_f32_16x16x32_bf16 v[108:111], v[52:55], a[56:59], v[108:111]
    v_mfma_f32_16x16x32_bf16 v[112:115], a[60:63], v[36:39], v[112:115]
    v_mfma_f32_16x16x32_bf16 v[116:119], a[60:63], v[40:43], v[116:119]
    v_mfma_f32_16x16x32_bf16 v[120:123], a[60:63], v[44:47], v[120:123]
    v_mfma_f32_16x16x32_bf16 v[124:127], a[60:63], v[48:51], v[124:127]
    v_mfma_f32_16x16x32_bf16 v[128:131], a[60:63], v[52:55], v[128:131]
    s_waitcnt vmcnt(38) lgkmcnt(0)
    v_mfma_f32_16x16x32_bf16 v[56:59], a[64:67], v[20:23], v[56:59]
    ds_read_b128 v[36:39], v6 offset:30720
    v_mfma_f32_16x16x32_bf16 v[60:63], a[64:67], v[24:27], v[60:63]
    ds_read_b128 v[40:43], v6 offset:31744
    v_mfma_f32_16x16x32_bf16 v[64:67], a[64:67], v[28:31], v[64:67]
    ds_read_b128 v[44:47], v6 offset:32768
    v_mfma_f32_16x16x32_bf16 v[68:71], a[64:67], v[32:35], v[68:71]
    ds_read_b128 v[48:51], v6 offset:33792
    v_mfma_f32_16x16x32_bf16 v[72:75], a[68:71], v[16:19], v[72:75]
    ds_read_b128 v[52:55], v6 offset:34816
    v_mfma_f32_16x16x32_bf16 v[76:79], a[68:71], v[20:23], v[76:79]
    buffer_load_dwordx4 a[240:243], v5, s[8:11], s34 offen offset:2048 sc1
    v_mfma_f32_16x16x32_bf16 v[80:83], a[68:71], v[24:27], v[80:83]
    v_mfma_f32_16x16x32_bf16 v[84:87], a[68:71], v[28:31], v[84:87]
    buffer_load_dwordx4 a[244:247], v253, s[8:11], s32 offen offset:3072 sc1
    s_add_u32 s32, s32, 4096
    v_mfma_f32_16x16x32_bf16 v[88:91], a[68:71], v[32:35], v[88:91]
    v_mfma_f32_16x16x32_bf16 v[92:95], v[16:19], a[72:75], v[92:95]
    buffer_load_dwordx4 a[248:251], v253, s[8:11], s33 offen offset:3072 sc1
    s_add_u32 s33, s33, 4096
    v_mfma_f32_16x16x32_bf16 v[96:99], v[20:23], a[72:75], v[96:99]
    v_mfma_f32_16x16x32_bf16 v[100:103], v[24:27], a[72:75], v[100:103]
    buffer_load_dwordx4 a[252:255], v5, s[8:11], s34 offen offset:3072 sc1
    s_add_u32 s34, s34, 4096
    v_mfma_f32_16x16x32_bf16 v[104:107], v[28:31], a[72:75], v[104:107]
    v_mfma_f32_16x16x32_bf16 v[108:111], v[32:35], a[72:75], v[108:111]
    v_mfma_f32_16x16x32_bf16 v[112:115], a[76:79], v[16:19], v[112:115]
    v_mfma_f32_16x16x32_bf16 v[116:119], a[76:79], v[20:23], v[116:119]
    v_mfma_f32_16x16x32_bf16 v[120:123], a[76:79], v[24:27], v[120:123]
    v_mfma_f32_16x16x32_bf16 v[124:127], a[76:79], v[28:31], v[124:127]
    v_mfma_f32_16x16x32_bf16 v[128:131], a[76:79], v[32:35], v[128:131]
    s_waitcnt vmcnt(36) lgkmcnt(0)
    v_mfma_f32_16x16x32_bf16 v[56:59], a[80:83], v[40:43], v[56:59]
    ds_read_b128 v[16:19], v6 offset:35840
    v_mfma_f32_16x16x32_bf16 v[60:63], a[80:83], v[44:47], v[60:63]
    ds_read_b128 v[20:23], v6 offset:36864
    v_mfma_f32_16x16x32_bf16 v[64:67], a[80:83], v[48:51], v[64:67]
    ds_read_b128 v[24:27], v6 offset:37888
    v_mfma_f32_16x16x32_bf16 v[68:71], a[80:83], v[52:55], v[68:71]
    ds_read_b128 v[28:31], v6 offset:38912
    v_mfma_f32_16x16x32_bf16 v[72:75], a[84:87], v[36:39], v[72:75]
    ds_read_b128 v[32:35], v6 offset:39936
    v_mfma_f32_16x16x32_bf16 v[76:79], a[84:87], v[40:43], v[76:79]
    buffer_load_dwordx4 a[128:131], v253, s[8:11], s32 offen offset:0 sc1
    v_mfma_f32_16x16x32_bf16 v[80:83], a[84:87], v[44:47], v[80:83]
    v_mfma_f32_16x16x32_bf16 v[84:87], a[84:87], v[48:51], v[84:87]
    buffer_load_dwordx4 a[132:135], v253, s[8:11], s33 offen offset:0 sc1
    v_mfma_f32_16x16x32_bf16 v[88:91], a[84:87], v[52:55], v[88:91]
    v_mfma_f32_16x16x32_bf16 v[92:95], v[36:39], a[88:91], v[92:95]
    buffer_load_dwordx4 a[136:139], v5, s[8:11], s34 offen offset:0 sc1
    v_mfma_f32_16x16x32_bf16 v[96:99], v[40:43], a[88:91], v[96:99]
    v_mfma_f32_16x16x32_bf16 v[100:103], v[44:47], a[88:91], v[100:103]
    buffer_load_dwordx4 a[140:143], v253, s[8:11], s32 offen offset:1024 sc1
    v_mfma_f32_16x16x32_bf16 v[104:107], v[48:51], a[88:91], v[104:107]
    v_mfma_f32_16x16x32_bf16 v[108:111], v[52:55], a[88:91], v[108:111]
    v_mfma_f32_16x16x32_bf16 v[112:115], a[92:95], v[36:39], v[112:115]
    v_mfma_f32_16x16x32_bf16 v[116:119], a[92:95], v[40:43], v[116:119]
    v_mfma_f32_16x16x32_bf16 v[120:123], a[92:95], v[44:47], v[120:123]
    v_mfma_f32_16x16x32_bf16 v[124:127], a[92:95], v[48:51], v[124:127]
    v_mfma_f32_16x16x32_bf16 v[128:131], a[92:95], v[52:55], v[128:131]
    s_waitcnt vmcnt(34) lgkmcnt(0)
    v_mfma_f32_16x16x32_bf16 v[56:59], a[96:99], v[20:23], v[56:59]
    ds_read_b128 v[36:39], v6 offset:40960
    v_mfma_f32_16x16x32_bf16 v[60:63], a[96:99], v[24:27], v[60:63]
    ds_read_b128 v[40:43], v6 offset:41984
    v_mfma_f32_16x16x32_bf16 v[64:67], a[96:99], v[28:31], v[64:67]
    ds_read_b128 v[44:47], v6 offset:43008
    v_mfma_f32_16x16x32_bf16 v[68:71], a[96:99], v[32:35], v[68:71]
    ds_read_b128 v[48:51], v6 offset:44032
    v_mfma_f32_16x16x32_bf16 v[72:75], a[100:103], v[16:19], v[72:75]
    ds_read_b128 v[52:55], v6 offset:45056
    v_mfma_f32_16x16x32_bf16 v[76:79], a[100:103], v[20:23], v[76:79]
    buffer_load_dwordx4 a[144:147], v253, s[8:11], s33 offen offset:1024 sc1
    v_mfma_f32_16x16x32_bf16 v[80:83], a[100:103], v[24:27], v[80:83]
    v_mfma_f32_16x16x32_bf16 v[84:87], a[100:103], v[28:31], v[84:87]
    buffer_load_dwordx4 a[148:151], v5, s[8:11], s34 offen offset:1024 sc1
    v_mfma_f32_16x16x32_bf16 v[88:91], a[100:103], v[32:35], v[88:91]
    v_mfma_f32_16x16x32_bf16 v[92:95], v[16:19], a[104:107], v[92:95]
    buffer_load_dwordx4 a[152:155], v253, s[8:11], s32 offen offset:2048 sc1
    v_mfma_f32_16x16x32_bf16 v[96:99], v[20:23], a[104:107], v[96:99]
    v_mfma_f32_16x16x32_bf16 v[100:103], v[24:27], a[104:107], v[100:103]
    buffer_load_dwordx4 a[156:159], v253, s[8:11], s33 offen offset:2048 sc1
    v_mfma_f32_16x16x32_bf16 v[104:107], v[28:31], a[104:107], v[104:107]
    v_mfma_f32_16x16x32_bf16 v[108:111], v[32:35], a[104:107], v[108:111]
    v_mfma_f32_16x16x32_bf16 v[112:115], a[108:111], v[16:19], v[112:115]
    v_mfma_f32_16x16x32_bf16 v[116:119], a[108:111], v[20:23], v[116:119]
    v_mfma_f32_16x16x32_bf16 v[120:123], a[108:111], v[24:27], v[120:123]
    v_mfma_f32_16x16x32_bf16 v[124:127], a[108:111], v[28:31], v[124:127]
    v_mfma_f32_16x16x32_bf16 v[128:131], a[108:111], v[32:35], v[128:131]
    s_waitcnt vmcnt(32) lgkmcnt(0)
    v_mfma_f32_16x16x32_bf16 v[56:59], a[112:115], v[40:43], v[56:59]
    v_mfma_f32_16x16x32_bf16 v[60:63], a[112:115], v[44:47], v[60:63]
    v_mfma_f32_16x16x32_bf16 v[64:67], a[112:115], v[48:51], v[64:67]
    v_mfma_f32_16x16x32_bf16 v[68:71], a[112:115], v[52:55], v[68:71]
    v_mfma_f32_16x16x32_bf16 v[72:75], a[116:119], v[36:39], v[72:75]
    v_mfma_f32_16x16x32_bf16 v[76:79], a[116:119], v[40:43], v[76:79]
    buffer_load_dwordx4 a[0:3], v5, s[8:11], s34 offen offset:2048 sc1
    v_mfma_f32_16x16x32_bf16 v[80:83], a[116:119], v[44:47], v[80:83]
    v_mfma_f32_16x16x32_bf16 v[84:87], a[116:119], v[48:51], v[84:87]
    buffer_load_dwordx4 a[4:7], v253, s[8:11], s32 offen offset:3072 sc1
    s_add_u32 s32, s32, 4096
    v_mfma_f32_16x16x32_bf16 v[88:91], a[116:119], v[52:55], v[88:91]
    v_mfma_f32_16x16x32_bf16 v[92:95], v[36:39], a[120:123], v[92:95]
    buffer_load_dwordx4 a[8:11], v253, s[8:11], s33 offen offset:3072 sc1
    s_add_u32 s33, s33, 4096
    v_mfma_f32_16x16x32_bf16 v[96:99], v[40:43], a[120:123], v[96:99]
    v_mfma_f32_16x16x32_bf16 v[100:103], v[44:47], a[120:123], v[100:103]
    buffer_load_dwordx4 a[12:15], v5, s[8:11], s34 offen offset:3072 sc1
    s_add_u32 s34, s34, 4096
    v_mfma_f32_16x16x32_bf16 v[104:107], v[48:51], a[120:123], v[104:107]
    v_mfma_f32_16x16x32_bf16 v[108:111], v[52:55], a[120:123], v[108:111]
    v_mfma_f32_16x16x32_bf16 v[112:115], a[124:127], v[36:39], v[112:115]
    v_mfma_f32_16x16x32_bf16 v[116:119], a[124:127], v[40:43], v[116:119]
    v_mfma_f32_16x16x32_bf16 v[120:123], a[124:127], v[44:47], v[120:123]
    v_mfma_f32_16x16x32_bf16 v[124:127], a[124:127], v[48:51], v[124:127]
    v_mfma_f32_16x16x32_bf16 v[128:131], a[124:127], v[52:55], v[128:131]
    v_cvt_pk_bf16_f32 v136, v56, v57
    v_cvt_pk_bf16_f32 v137, v58, v59
    v_cvt_pk_bf16_f32 v140, v60, v61
    v_cvt_pk_bf16_f32 v141, v62, v63
    v_cvt_pk_bf16_f32 v144, v64, v65
    v_cvt_pk_bf16_f32 v145, v66, v67
    v_cvt_pk_bf16_f32 v148, v68, v69
    v_cvt_pk_bf16_f32 v149, v70, v71
    v_cvt_pk_bf16_f32 v152, v72, v73
    v_cvt_pk_bf16_f32 v153, v74, v75
    buffer_load_dwordx4 a[16:19], v253, s[8:11], s32 offen offset:0 sc1
    v_cvt_pk_bf16_f32 v156, v76, v77
    v_cvt_pk_bf16_f32 v157, v78, v79
    v_cvt_pk_bf16_f32 v160, v80, v81
    v_cvt_pk_bf16_f32 v161, v82, v83
    v_cvt_pk_bf16_f32 v164, v84, v85
    v_cvt_pk_bf16_f32 v165, v86, v87
    v_cvt_pk_bf16_f32 v168, v88, v89
    v_cvt_pk_bf16_f32 v169, v90, v91
    v_cvt_pk_bf16_f32 v134, v112, v113
    v_cvt_pk_bf16_f32 v154, v114, v115
    buffer_load_dwordx4 a[20:23], v253, s[8:11], s33 offen offset:0 sc1
    v_cvt_pk_bf16_f32 v138, v116, v117
    v_cvt_pk_bf16_f32 v158, v118, v119
    v_cvt_pk_bf16_f32 v142, v120, v121
    v_cvt_pk_bf16_f32 v162, v122, v123
    v_cvt_pk_bf16_f32 v146, v124, v125
    v_cvt_pk_bf16_f32 v166, v126, v127
    v_cvt_pk_bf16_f32 v150, v128, v129
    v_cvt_pk_bf16_f32 v170, v130, v131
    v_cvt_pk_bf16_f32 v172, v92, v93
    v_cvt_pk_bf16_f32 v173, v94, v95
    buffer_load_dwordx4 a[24:27], v5, s[8:11], s34 offen offset:0 sc1
    v_cvt_pk_bf16_f32 v174, v96, v97
    v_cvt_pk_bf16_f32 v175, v98, v99
    v_cvt_pk_bf16_f32 v176, v100, v101
    v_cvt_pk_bf16_f32 v177, v102, v103
    v_cvt_pk_bf16_f32 v178, v104, v105
    v_cvt_pk_bf16_f32 v179, v106, v107
    v_cvt_pk_bf16_f32 v180, v108, v109
    v_cvt_pk_bf16_f32 v181, v110, v111
    v_mfma_f32_16x16x32_bf16 v[16:19], v[152:155], v[136:139], v[208:211]
    v_mfma_f32_16x16x32_bf16 v[20:23], v[156:159], v[136:139], v[204:207]
    buffer_load_dwordx4 a[28:31], v253, s[8:11], s32 offen offset:1024 sc1
    v_mfma_f32_16x16x32_bf16 v[24:27], v[156:159], v[140:143], v[200:203]
    v_mfma_f32_16x16x32_bf16 v[28:31], v[160:163], v[140:143], v[204:207]
    v_mfma_f32_16x16x32_bf16 v[32:35], v[160:163], v[144:147], v[200:203]
    v_mfma_f32_16x16x32_bf16 v[36:39], v[164:167], v[144:147], v[204:207]
    v_mfma_f32_16x16x32_bf16 v[40:43], v[164:167], v[148:151], v[200:203]
    v_mfma_f32_16x16x32_bf16 v[44:47], v[168:171], v[148:151], v[204:207]
    v_mfma_f32_16x16x32_bf16 v[56:59], v[132:135], v[192:195], v[196:199]
    v_mfma_f32_16x16x32_bf16 v[60:63], v[136:139], v[192:195], v[196:199]
    v_mfma_f32_16x16x32_bf16 v[64:67], v[140:143], v[192:195], v[196:199]
    v_mfma_f32_16x16x32_bf16 v[68:71], v[144:147], v[192:195], v[196:199]
    buffer_load_dwordx4 a[32:35], v253, s[8:11], s33 offen offset:1024 sc1
    v_mfma_f32_16x16x32_bf16 v[72:75], v[148:151], v[192:195], v[196:199]
    v_max3_f32 v92, v16, v17, v18
    v_max3_f32 v96, v19, v20, v21
    v_max3_f32 v93, v24, v25, v26
    v_max3_f32 v97, v27, v28, v29
    v_max3_f32 v94, v32, v33, v34
    v_max3_f32 v98, v35, v36, v37
    v_max3_f32 v95, v40, v41, v42
    v_max3_f32 v99, v43, v44, v45
    v_max3_f32 v92, v92, v22, v23
    buffer_load_dwordx4 a[36:39], v5, s[8:11], s34 offen offset:1024 sc1
    v_max3_f32 v93, v93, v30, v31
    v_max3_f32 v94, v94, v38, v39
    v_max3_f32 v95, v95, v46, v47
    v_max_f32 v92, v92, v96
    v_max_f32 v93, v93, v97
    v_max_f32 v94, v94, v98
    v_max_f32 v95, v95, v99
    s_mov_b32 s18, 0x3eae1a93
    v_cvt_pk_bf16_f32 v182, v56, v57
    v_permlane32_swap_b32 v92, v93
    buffer_load_dwordx4 a[40:43], v253, s[8:11], s32 offen offset:2048 sc1
    v_permlane32_swap_b32 v94, v95
    v_max_f32 v92, v92, v93
    v_max_f32 v94, v94, v95
    v_cvt_pk_bf16_f32 v183, v58, v59
    v_cvt_pk_bf16_f32 v184, v60, v61
    v_permlane16_swap_b32 v92, v94
    v_max_f32 v92, v92, v94
    v_mul_f32 v92, 0xbeae1a93, v92
    v_mov_b32 v94, v92
    v_cvt_pk_bf16_f32 v185, v62, v63
    buffer_load_dwordx4 a[44:47], v253, s[8:11], s33 offen offset:2048 sc1
    v_cvt_pk_bf16_f32 v186, v64, v65
    v_permlane16_swap_b32 v92, v94
    v_mov_b32 v93, v92
    v_mov_b32 v95, v94
    v_cvt_pk_bf16_f32 v187, v66, v67
    v_cvt_pk_bf16_f32 v188, v68, v69
    v_permlane32_swap_b32 v92, v93
    v_permlane32_swap_b32 v94, v95
    v_cvt_pk_bf16_f32 v189, v70, v71
    v_cvt_pk_bf16_f32 v190, v72, v73
    buffer_load_dwordx4 a[48:51], v5, s[8:11], s34 offen offset:2048 sc1
    v_cvt_pk_bf16_f32 v191, v74, v75
    v_fma_f32 v16, v16, s18, v92
    v_fma_f32 v17, v17, s18, v92
    v_fma_f32 v18, v18, s18, v92
    v_fma_f32 v19, v19, s18, v92
    v_fma_f32 v20, v20, s18, v92
    v_fma_f32 v21, v21, s18, v92
    v_fma_f32 v22, v22, s18, v92
    v_fma_f32 v23, v23, s18, v92
    v_exp_f32 v16, v16
    buffer_load_dwordx4 a[52:55], v253, s[8:11], s32 offen offset:3072 sc1
    s_add_u32 s32, s32, 4096
    v_exp_f32 v17, v17
    v_exp_f32 v18, v18
    v_exp_f32 v19, v19
    v_exp_f32 v20, v20
    v_exp_f32 v21, v21
    v_exp_f32 v22, v22
    v_exp_f32 v23, v23
    s_nop 0
    v_cvt_pk_bf16_f32 v76, v16, v17
    v_cvt_pk_bf16_f32 v77, v18, v19
    buffer_load_dwordx4 a[56:59], v253, s[8:11], s33 offen offset:3072 sc1
    s_add_u32 s33, s33, 4096
    v_cvt_pk_bf16_f32 v78, v20, v21
    v_cvt_pk_bf16_f32 v79, v22, v23
    v_fma_f32 v24, v24, s18, v93
    v_fma_f32 v25, v25, s18, v93
    v_fma_f32 v26, v26, s18, v93
    v_fma_f32 v27, v27, s18, v93
    v_fma_f32 v28, v28, s18, v93
    v_fma_f32 v29, v29, s18, v93
    v_fma_f32 v30, v30, s18, v93
    v_fma_f32 v31, v31, s18, v93
    buffer_load_dwordx4 a[60:63], v5, s[8:11], s34 offen offset:3072 sc1
    s_add_u32 s34, s34, 4096
    v_exp_f32 v24, v24
    v_exp_f32 v25, v25
    v_exp_f32 v26, v26
    v_exp_f32 v27, v27
    v_exp_f32 v28, v28
    v_exp_f32 v29, v29
    v_exp_f32 v30, v30
    v_exp_f32 v31, v31
    v_mfma_f32_16x16x32_bf16 v[100:103], v[172:175], v[76:79], 0
    v_mfma_f32_16x16x32_bf16 v[116:119], v[182:185], v[76:79], 0
    buffer_load_dwordx4 a[64:67], v253, s[8:11], s32 offen offset:0 sc1
    v_cvt_pk_bf16_f32 v80, v24, v25
    v_cvt_pk_bf16_f32 v81, v26, v27
    v_cvt_pk_bf16_f32 v82, v28, v29
    v_cvt_pk_bf16_f32 v83, v30, v31
    v_fma_f32 v32, v32, s18, v94
    v_fma_f32 v33, v33, s18, v94
    v_fma_f32 v34, v34, s18, v94
    v_fma_f32 v35, v35, s18, v94
    v_fma_f32 v36, v36, s18, v94
    v_fma_f32 v37, v37, s18, v94
    buffer_load_dwordx4 a[68:71], v253, s[8:11], s33 offen offset:0 sc1
    v_fma_f32 v38, v38, s18, v94
    v_fma_f32 v39, v39, s18, v94
    v_exp_f32 v32, v32
    v_exp_f32 v33, v33
    v_exp_f32 v34, v34
    v_exp_f32 v35, v35
    v_exp_f32 v36, v36
    v_exp_f32 v37, v37
    v_exp_f32 v38, v38
    v_exp_f32 v39, v39
    buffer_load_dwordx4 a[72:75], v5, s[8:11], s34 offen offset:0 sc1
    v_mfma_f32_16x16x32_bf16 v[104:107], v[174:177], v[80:83], 0
    v_mfma_f32_16x16x32_bf16 v[120:123], v[184:187], v[80:83], 0
    v_cvt_pk_bf16_f32 v84, v32, v33
    v_cvt_pk_bf16_f32 v85, v34, v35
    v_cvt_pk_bf16_f32 v86, v36, v37
    v_cvt_pk_bf16_f32 v87, v38, v39
    v_fma_f32 v40, v40, s18, v95
    v_fma_f32 v41, v41, s18, v95
    v_fma_f32 v42, v42, s18, v95
    v_fma_f32 v43, v43, s18, v95
    buffer_load_dwordx4 a[76:79], v253, s[8:11], s32 offen offset:1024 sc1
    v_fma_f32 v44, v44, s18, v95
    v_fma_f32 v45, v45, s18, v95
    v_fma_f32 v46, v46, s18, v95
    v_fma_f32 v47, v47, s18, v95
    v_exp_f32 v40, v40
    v_exp_f32 v41, v41
    v_exp_f32 v42, v42
    v_exp_f32 v43, v43
    v_exp_f32 v44, v44
    v_exp_f32 v45, v45
    buffer_load_dwordx4 a[80:83], v253, s[8:11], s33 offen offset:1024 sc1
    v_exp_f32 v46, v46
    v_exp_f32 v47, v47
    v_mfma_f32_16x16x32_bf16 v[108:111], v[176:179], v[84:87], 0
    v_mfma_f32_16x16x32_bf16 v[124:127], v[186:189], v[84:87], 0
    v_cvt_pk_bf16_f32 v88, v40, v41
    v_cvt_pk_bf16_f32 v89, v42, v43
    v_cvt_pk_bf16_f32 v90, v44, v45
    v_cvt_pk_bf16_f32 v91, v46, v47
    v_rcp_f32 v96, v118
    v_rcp_f32 v97, v122
    buffer_load_dwordx4 a[84:87], v5, s[8:11], s34 offen offset:1024 sc1
    v_mfma_f32_16x16x32_bf16 v[112:115], v[178:181], v[88:91], 0
    v_mfma_f32_16x16x32_bf16 v[128:131], v[188:191], v[88:91], 0
    v_pk_mul_f32 v[100:101], v[96:97], v[100:101] op_sel:[0,0] op_sel_hi:[0,1]
    v_pk_mul_f32 v[102:103], v[96:97], v[102:103] op_sel:[0,0] op_sel_hi:[0,1]
    v_pk_mul_f32 v[116:117], v[96:97], v[116:117] op_sel:[0,0] op_sel_hi:[0,1]
    v_cvt_pk_bf16_f32 v212, v100, v101
    v_cvt_pk_bf16_f32 v213, v102, v103
    v_cvt_pk_bf16_f32 v220, v116, v117
    v_rcp_f32 v98, v126
    v_pk_mul_f32 v[104:105], v[96:97], v[104:105] op_sel:[1,0] op_sel_hi:[1,1]
    buffer_load_dwordx4 v[240:243], v9, s[8:11], s37 offen offset:0 sc1
    v_pk_mul_f32 v[106:107], v[96:97], v[106:107] op_sel:[1,0] op_sel_hi:[1,1]
    v_pk_mul_f32 v[120:121], v[96:97], v[120:121] op_sel:[1,0] op_sel_hi:[1,1]
    v_cvt_pk_bf16_f32 v214, v104, v105
    v_cvt_pk_bf16_f32 v215, v106, v107
    v_cvt_pk_bf16_f32 v221, v120, v121
    v_rcp_f32 v99, v130
    v_permlane16_swap_b32 v212, v214
    v_permlane16_swap_b32 v213, v215
    v_pk_mul_f32 v[108:109], v[98:99], v[108:109] op_sel:[0,0] op_sel_hi:[0,1]
    v_pk_mul_f32 v[110:111], v[98:99], v[110:111] op_sel:[0,0] op_sel_hi:[0,1]
    buffer_load_dwordx4 v[244:247], v9, s[8:11], s37 offen offset:1024 sc1
    v_pk_mul_f32 v[124:125], v[98:99], v[124:125] op_sel:[0,0] op_sel_hi:[0,1]
    v_cvt_pk_bf16_f32 v216, v108, v109
    v_cvt_pk_bf16_f32 v217, v110, v111
    v_cvt_pk_bf16_f32 v222, v124, v125
    v_pk_mul_f32 v[112:113], v[98:99], v[112:113] op_sel:[1,0] op_sel_hi:[1,1]
    v_pk_mul_f32 v[114:115], v[98:99], v[114:115] op_sel:[1,0] op_sel_hi:[1,1]
    v_pk_mul_f32 v[128:129], v[98:99], v[128:129] op_sel:[1,0] op_sel_hi:[1,1]
    v_cvt_pk_bf16_f32 v218, v112, v113
    v_cvt_pk_bf16_f32 v219, v114, v115
    v_cvt_pk_bf16_f32 v223, v128, v129
    buffer_load_dwordx4 v[248:251], v7, s[8:11], s37 offen offset:2048 sc1
    s_lshl_b32 s7, s3, 2
    s_add_u32 s7, s7, 94208
    v_permlane16_swap_b32 v220, v221
    v_permlane16_swap_b32 v222, v223
    v_add_u32 v11, s7, v253
    v_lshrrev_b32 v10, 3, v0
    v_permlane32_swap_b32 v220, v222
    v_mul_u32_u24 v10, 9216, v10
    ds_write_b32 v11, v220
    v_permlane16_swap_b32 v216, v218
    buffer_load_dword v252, v8, s[8:11], s47 offen sc1
    v_permlane16_swap_b32 v217, v219
    s_mul_i32 s7, s40, 1152
    s_add_u32 s22, s22, s7
    s_add_u32 s22, s22, 41156608
    s_lshl_b32 s7, s3, 8
    s_add_u32 s23, s22, s7
    s_add_u32 s24, s23, 36864
    buffer_store_dwordx4 v[212:215], v9, s[8:11], s23 offen sc1
    buffer_store_dwordx4 v[216:219], v9, s[8:11], s24 offen sc1
    v_and_b32 v11, 7, v0
    v_lshl_add_u32 v10, v11, 4, v10
    s_cmp_eq_u32 s3, 3
    s_cselect_b32 s7, 0, 1073741824
    v_add_u32 v10, s7, v10
    v_add_u32 v11, 94208, v253
    s_waitcnt lgkmcnt(0)
    s_barrier
    ds_read_b128 v[220:223], v11
    s_waitcnt lgkmcnt(0)
    buffer_store_dwordx4 v[220:223], v10, s[8:11], s22 offen offset:1024 sc1
    v_lshlrev_b32 v15, 7, v0
    s_lshl_b32 s6, s40, 2
    s_add_u32 s6, s6, s44
    v_mov_b32 v1, s76
    s_mov_b64 vcc, 0xff
    s_waitcnt vmcnt(0)
    s_barrier
    s_cmp_lg_u32 s3, 0
    s_cbranch_scc1 L_pub_21
    s_mov_b64 exec, vcc
    buffer_store_dword v1, v15, s[8:11], s6 offen sc1
L_pub_21:
    s_mov_b64 exec, -1
    s_cmp_lg_u32 s42, 0
    s_cbranch_scc1 L_swz_22
    s_cmp_eq_u32 s93, 2
    s_cselect_b32 s6, 2, 3
    s_mov_b32 s7, 512
    s_cmov_b32 s7, 2048
    v_lshrrev_b32 v14, 4, v0
    v_lshlrev_b32 v14, s6, v14
    v_bfe_u32 v15, v0, 2, 2
    v_add_u32 v14, v14, v15
    v_mul_u32_u24 v14, 128, v14
    v_and_b32 v15, 3, v0
    v_lshl_add_u32 v14, v15, 3, v14
    v_add_u32 v14, s79, v14
    v_add_u32 v15, s7, v14
    ds_read_b64_tr_b16 v[76:77], v14 offset:0
    ds_read_b64_tr_b16 v[78:79], v15 offset:0
    ds_read_b64_tr_b16 v[80:81], v14 offset:32
    ds_read_b64_tr_b16 v[82:83], v15 offset:32
    ds_read_b64_tr_b16 v[84:85], v14 offset:64
    ds_read_b64_tr_b16 v[86:87], v15 offset:64
    ds_read_b64_tr_b16 v[88:89], v14 offset:96
    ds_read_b64_tr_b16 v[90:91], v15 offset:96
    ds_read_b64_tr_b16 v[92:93], v14 offset:4096
    ds_read_b64_tr_b16 v[94:95], v15 offset:4096
    ds_read_b64_tr_b16 v[96:97], v14 offset:4128
    ds_read_b64_tr_b16 v[98:99], v15 offset:4128
    ds_read_b64_tr_b16 v[176:177], v14 offset:4160
    ds_read_b64_tr_b16 v[178:179], v15 offset:4160
    ds_read_b64_tr_b16 v[180:181], v14 offset:4192
    ds_read_b64_tr_b16 v[182:183], v15 offset:4192
    ds_read_b64_tr_b16 v[196:197], v14 offset:8192
    ds_read_b64_tr_b16 v[198:199], v15 offset:8192
    ds_read_b64_tr_b16 v[200:201], v14 offset:8224
    ds_read_b64_tr_b16 v[202:203], v15 offset:8224
    ds_read_b64_tr_b16 v[204:205], v14 offset:8256
    ds_read_b64_tr_b16 v[206:207], v15 offset:8256
    ds_read_b64_tr_b16 v[208:209], v14 offset:8288
    ds_read_b64_tr_b16 v[210:211], v15 offset:8288
    ds_read_b64_tr_b16 v[212:213], v14 offset:12288
    ds_read_b64_tr_b16 v[214:215], v15 offset:12288
    ds_read_b64_tr_b16 v[216:217], v14 offset:12320
    ds_read_b64_tr_b16 v[218:219], v15 offset:12320
    ds_read_b64_tr_b16 v[220:221], v14 offset:12352
    ds_read_b64_tr_b16 v[222:223], v15 offset:12352
    ds_read_b64_tr_b16 v[228:229], v14 offset:12384
    ds_read_b64_tr_b16 v[230:231], v15 offset:12384
    s_mul_i32 s68, s40, 1990656
    s_add_u32 s68, s68, 3145728
    s_cmp_eq_u32 s93, 2
    s_cbranch_scc1 L_swz_down_23
    s_mul_i32 s6, s84, 349526
    s_lshr_b32 s6, s6, 20
    s_mul_i32 s7, s6, 3
    s_sub_u32 s7, s84, s7
    s_mul_i32 s6, s6, 6
    s_add_u32 s7, s7, s6
    s_mul_i32 s6, s88, 36
    s_add_u32 s7, s7, s6
    s_mul_i32 s6, s93, 3
    s_add_u32 s7, s7, s6
    s_lshl_b32 s7, s7, 10
    s_add_u32 s7, s7, s68
    s_add_u32 s80, s7, 0
    s_add_u32 s81, s7, 497664
    s_add_u32 s82, s7, 995328
    s_add_u32 s83, s7, 1492992
    s_mul_i32 s6, s85, 349526
    s_lshr_b32 s6, s6, 20
    s_mul_i32 s7, s6, 3
    s_sub_u32 s7, s85, s7
    s_mul_i32 s6, s6, 6
    s_add_u32 s7, s7, s6
    s_mul_i32 s6, s89, 36
    s_add_u32 s7, s7, s6
    s_mul_i32 s6, s93, 3
    s_add_u32 s7, s7, s6
    s_lshl_b32 s7, s7, 10
    s_add_u32 s7, s7, s68
    s_add_u32 s64, s7, 0
    s_add_u32 s65, s7, 497664
    s_add_u32 s18, s7, 995328
    s_add_u32 s19, s7, 1492992
    s_mul_i32 s6, s86, 349526
    s_lshr_b32 s6, s6, 20
    s_mul_i32 s7, s6, 3
    s_sub_u32 s7, s86, s7
    s_mul_i32 s6, s6, 6
    s_add_u32 s7, s7, s6
    s_mul_i32 s6, s90, 36
    s_add_u32 s7, s7, s6
    s_mul_i32 s6, s93, 3
    s_add_u32 s7, s7, s6
    s_lshl_b32 s7, s7, 10
    s_add_u32 s7, s7, s68
    s_add_u32 s20, s7, 0
    s_add_u32 s21, s7, 497664
    s_add_u32 s22, s7, 995328
    s_add_u32 s25, s7, 1492992
    s_mul_i32 s6, s87, 349526
    s_lshr_b32 s6, s6, 20
    s_mul_i32 s7, s6, 3
    s_sub_u32 s7, s87, s7
    s_mul_i32 s6, s6, 6
    s_add_u32 s7, s7, s6
    s_mul_i32 s6, s91, 36
    s_add_u32 s7, s7, s6
    s_mul_i32 s6, s93, 3
    s_add_u32 s7, s7, s6
    s_lshl_b32 s7, s7, 10
    s_add_u32 s7, s7, s68
    s_add_u32 s26, s7, 0
    s_add_u32 s27, s7, 497664
    s_add_u32 s28, s7, 995328
    s_add_u32 s29, s7, 1492992
    s_branch L_swz_dest_24
L_swz_down_23:
    s_add_u32 s69, s84, 324
    s_lshl_b32 s69, s69, 10
    s_add_u32 s69, s69, s68
    s_lshl_b32 s70, s88, 2
    s_add_u32 s70, s70, 0
    s_mul_i32 s6, s70, 116509
    s_lshr_b32 s6, s6, 20
    s_mul_i32 s7, s6, 9
    s_sub_u32 s7, s70, s7
    s_mul_i32 s6, s6, 497664
    s_mul_i32 s7, s7, 18432
    s_add_u32 s6, s6, s7
    s_add_u32 s80, s69, s6
    s_lshl_b32 s70, s88, 2
    s_add_u32 s70, s70, 1
    s_mul_i32 s6, s70, 116509
    s_lshr_b32 s6, s6, 20
    s_mul_i32 s7, s6, 9
    s_sub_u32 s7, s70, s7
    s_mul_i32 s6, s6, 497664
    s_mul_i32 s7, s7, 18432
    s_add_u32 s6, s6, s7
    s_add_u32 s81, s69, s6
    s_lshl_b32 s70, s88, 2
    s_add_u32 s70, s70, 2
    s_mul_i32 s6, s70, 116509
    s_lshr_b32 s6, s6, 20
    s_mul_i32 s7, s6, 9
    s_sub_u32 s7, s70, s7
    s_mul_i32 s6, s6, 497664
    s_mul_i32 s7, s7, 18432
    s_add_u32 s6, s6, s7
    s_add_u32 s82, s69, s6
    s_lshl_b32 s70, s88, 2
    s_add_u32 s70, s70, 3
    s_mul_i32 s6, s70, 116509
    s_lshr_b32 s6, s6, 20
    s_mul_i32 s7, s6, 9
    s_sub_u32 s7, s70, s7
    s_mul_i32 s6, s6, 497664
    s_mul_i32 s7, s7, 18432
    s_add_u32 s6, s6, s7
    s_add_u32 s83, s69, s6
    s_add_u32 s69, s85, 324
    s_lshl_b32 s69, s69, 10
    s_add_u32 s69, s69, s68
    s_lshl_b32 s70, s89, 2
    s_add_u32 s70, s70, 0
    s_mul_i32 s6, s70, 116509
    s_lshr_b32 s6, s6, 20
    s_mul_i32 s7, s6, 9
    s_sub_u32 s7, s70, s7
    s_mul_i32 s6, s6, 497664
    s_mul_i32 s7, s7, 18432
    s_add_u32 s6, s6, s7
    s_add_u32 s64, s69, s6
    s_lshl_b32 s70, s89, 2
    s_add_u32 s70, s70, 1
    s_mul_i32 s6, s70, 116509
    s_lshr_b32 s6, s6, 20
    s_mul_i32 s7, s6, 9
    s_sub_u32 s7, s70, s7
    s_mul_i32 s6, s6, 497664
    s_mul_i32 s7, s7, 18432
    s_add_u32 s6, s6, s7
    s_add_u32 s65, s69, s6
    s_lshl_b32 s70, s89, 2
    s_add_u32 s70, s70, 2
    s_mul_i32 s6, s70, 116509
    s_lshr_b32 s6, s6, 20
    s_mul_i32 s7, s6, 9
    s_sub_u32 s7, s70, s7
    s_mul_i32 s6, s6, 497664
    s_mul_i32 s7, s7, 18432
    s_add_u32 s6, s6, s7
    s_add_u32 s18, s69, s6
    s_lshl_b32 s70, s89, 2
    s_add_u32 s70, s70, 3
    s_mul_i32 s6, s70, 116509
    s_lshr_b32 s6, s6, 20
    s_mul_i32 s7, s6, 9
    s_sub_u32 s7, s70, s7
    s_mul_i32 s6, s6, 497664
    s_mul_i32 s7, s7, 18432
    s_add_u32 s6, s6, s7
    s_add_u32 s19, s69, s6
    s_add_u32 s69, s86, 324
    s_lshl_b32 s69, s69, 10
    s_add_u32 s69, s69, s68
    s_lshl_b32 s70, s90, 2
    s_add_u32 s70, s70, 0
    s_mul_i32 s6, s70, 116509
    s_lshr_b32 s6, s6, 20
    s_mul_i32 s7, s6, 9
    s_sub_u32 s7, s70, s7
    s_mul_i32 s6, s6, 497664
    s_mul_i32 s7, s7, 18432
    s_add_u32 s6, s6, s7
    s_add_u32 s20, s69, s6
    s_lshl_b32 s70, s90, 2
    s_add_u32 s70, s70, 1
    s_mul_i32 s6, s70, 116509
    s_lshr_b32 s6, s6, 20
    s_mul_i32 s7, s6, 9
    s_sub_u32 s7, s70, s7
    s_mul_i32 s6, s6, 497664
    s_mul_i32 s7, s7, 18432
    s_add_u32 s6, s6, s7
    s_add_u32 s21, s69, s6
    s_lshl_b32 s70, s90, 2
    s_add_u32 s70, s70, 2
    s_mul_i32 s6, s70, 116509
    s_lshr_b32 s6, s6, 20
    s_mul_i32 s7, s6, 9
    s_sub_u32 s7, s70, s7
    s_mul_i32 s6, s6, 497664
    s_mul_i32 s7, s7, 18432
    s_add_u32 s6, s6, s7
    s_add_u32 s22, s69, s6
    s_lshl_b32 s70, s90, 2
    s_add_u32 s70, s70, 3
    s_mul_i32 s6, s70, 116509
    s_lshr_b32 s6, s6, 20
    s_mul_i32 s7, s6, 9
    s_sub_u32 s7, s70, s7
    s_mul_i32 s6, s6, 497664
    s_mul_i32 s7, s7, 18432
    s_add_u32 s6, s6, s7
    s_add_u32 s25, s69, s6
    s_add_u32 s69, s87, 324
    s_lshl_b32 s69, s69, 10
    s_add_u32 s69, s69, s68
    s_lshl_b32 s70, s91, 2
    s_add_u32 s70, s70, 0
    s_mul_i32 s6, s70, 116509
    s_lshr_b32 s6, s6, 20
    s_mul_i32 s7, s6, 9
    s_sub_u32 s7, s70, s7
    s_mul_i32 s6, s6, 497664
    s_mul_i32 s7, s7, 18432
    s_add_u32 s6, s6, s7
    s_add_u32 s26, s69, s6
    s_lshl_b32 s70, s91, 2
    s_add_u32 s70, s70, 1
    s_mul_i32 s6, s70, 116509
    s_lshr_b32 s6, s6, 20
    s_mul_i32 s7, s6, 9
    s_sub_u32 s7, s70, s7
    s_mul_i32 s6, s6, 497664
    s_mul_i32 s7, s7, 18432
    s_add_u32 s6, s6, s7
    s_add_u32 s27, s69, s6
    s_lshl_b32 s70, s91, 2
    s_add_u32 s70, s70, 2
    s_mul_i32 s6, s70, 116509
    s_lshr_b32 s6, s6, 20
    s_mul_i32 s7, s6, 9
    s_sub_u32 s7, s70, s7
    s_mul_i32 s6, s6, 497664
    s_mul_i32 s7, s7, 18432
    s_add_u32 s6, s6, s7
    s_add_u32 s28, s69, s6
    s_lshl_b32 s70, s91, 2
    s_add_u32 s70, s70, 3
    s_mul_i32 s6, s70, 116509
    s_lshr_b32 s6, s6, 20
    s_mul_i32 s7, s6, 9
    s_sub_u32 s7, s70, s7
    s_mul_i32 s6, s6, 497664
    s_mul_i32 s7, s7, 18432
    s_add_u32 s6, s6, s7
    s_add_u32 s29, s69, s6
L_swz_dest_24:
    s_mov_b32 s72, s8
    s_mov_b32 s73, s9
    s_mov_b32 s74, 268435456
    s_waitcnt lgkmcnt(0)
    buffer_store_dwordx4 v[76:79], v253, s[72:75], s80 offen sc1
    buffer_store_dwordx4 v[80:83], v253, s[72:75], s81 offen sc1
    buffer_store_dwordx4 v[84:87], v253, s[72:75], s82 offen sc1
    buffer_store_dwordx4 v[88:91], v253, s[72:75], s83 offen sc1
    buffer_store_dwordx4 v[92:95], v253, s[72:75], s64 offen sc1
    buffer_store_dwordx4 v[96:99], v253, s[72:75], s65 offen sc1
L_swz_22:
    s_and_b32 s7, s3, 1
    s_mul_i32 s7, s7, 18432
    s_add_u32 s24, s30, s7
    s_lshr_b32 s7, s3, 1
    s_lshl_b32 s7, s7, 9
    s_add_u32 s24, s24, s7
    s_add_u32 s24, s24, 41156608
    s_mov_b32 s16, 0xffff0000
    v_lshlrev_b32 v124, 16, v240
    v_and_b32 v125, s16, v240
    v_lshlrev_b32 v126, 16, v241
    v_and_b32 v127, s16, v241
    v_lshlrev_b32 v128, 16, v242
    v_and_b32 v129, s16, v242
    v_lshlrev_b32 v130, 16, v243
    v_and_b32 v131, s16, v243
    v_lshlrev_b32 v132, 16, v244
    v_and_b32 v133, s16, v244
    v_lshlrev_b32 v134, 16, v245
    v_and_b32 v135, s16, v245
    v_lshlrev_b32 v136, 16, v246
    v_and_b32 v137, s16, v246
    v_lshlrev_b32 v138, 16, v247
    v_and_b32 v139, s16, v247
    v_lshlrev_b32 v140, 16, v248
    v_and_b32 v141, s16, v248
    v_lshlrev_b32 v142, 16, v249
    v_and_b32 v143, s16, v249
    v_lshlrev_b32 v144, 16, v250
    v_and_b32 v145, s16, v250
    v_lshlrev_b32 v146, 16, v251
    v_and_b32 v147, s16, v251
    s_cmp_eq_u32 s3, 1
    s_cselect_b32 s7, 16, 0
    v_lshlrev_b32 v12, 2, v0
    v_cmp_gt_u32 vcc, s7, v0
    v_add_u32 v10, 40960, v12
    v_add_u32 v11, 41472, v12
    v_cndmask_b32 v10, v11, v10, vcc
    v_and_b32 v11, 0x7c, v12
    v_cmp_gt_u32 vcc, 32, v0
    v_mov_b32 v13, 1073741824
    s_and_b32 s7, s40, 3
    s_lshl_b32 s45, s45, 2
    v_cndmask_b32 v8, v13, v12, vcc
    s_add_u32 s6, s7, s3
    s_cmp_eq_u32 s6, 0
    s_cselect_b32 s6, 0, 1073741824
    v_add_u32 v6, s6, v8
    s_add_u32 s45, s45, s7
    s_lshl_b32 s45, s45, 2
    s_add_u32 s45, s45, s3
    s_lshl_b32 s45, s45, 7
    s_add_u32 s45, s45, s43
    s_add_u32 s45, s45, 48300032
    s_cmp_eq_u32 s3, 0
    s_cselect_b32 s35, 1.0, 0
    s_lshl_b32 s7, s40, 2
    s_add_u32 s7, s7, s3
    s_mul_i32 s23, s7, 497664
    s_add_u32 s23, s23, 3145728
    s_add_u32 s50, s23, 497664
    s_mul_i32 s50, s50, s42
    v_mov_b32 v184, v253
    v_add_u32 v185, 4096, v253
    v_add_u32 v186, 8192, v253
    v_add_u32 v187, 12288, v253
    v_add_u32 v188, 16384, v253
    v_add_u32 v189, 20480, v253
    v_add_u32 v190, 24576, v253
    v_add_u32 v191, 28672, v253
    v_add_u32 v192, 32768, v253
    s_cmp_lg_u32 s3, 0
    s_cbranch_scc1 L_pollout_27
    s_lshl_b32 s7, s40, 7
    s_add_u32 s7, s7, s44
    s_add_u32 s52, s4, s7
    s_addc_u32 s53, s5, 0
    s_mov_b32 s6, 0
L_poll_25:
    s_load_dwordx8 s[56:63], s[52:53], 0 glc
    s_add_u32 s6, s6, 1
    s_waitcnt lgkmcnt(0)
    s_xor_b64 s[56:57], s[56:57], s[76:77]
    s_xor_b64 s[58:59], s[58:59], s[76:77]
    s_xor_b64 s[60:61], s[60:61], s[76:77]
    s_xor_b64 s[62:63], s[62:63], s[76:77]
    s_or_b64 s[56:57], s[56:57], s[58:59]
    s_or_b64 s[60:61], s[60:61], s[62:63]
    s_or_b64 s[56:57], s[56:57], s[60:61]
    s_cbranch_scc0 L_polled_26
    s_cmp_lt_u32 s6, 1048576
    s_cbranch_scc1 L_poll_25
    s_branch L_main_end
L_polled_26:
L_pollout_27:
    s_barrier
    s_lshl_b32 m0, s3, 10
    s_nop 0
    buffer_load_dwordx4 v2, s[8:11], s24 offen sc1 lds
    s_add_u32 m0, m0, 4096
    s_add_u32 s24, s24, 1024
    buffer_load_dwordx4 v2, s[8:11], s24 offen sc1 lds
    s_add_u32 m0, m0, 4096
    s_add_u32 s24, s24, 1024
    buffer_load_dwordx4 v2, s[8:11], s24 offen sc1 lds
    s_add_u32 m0, m0, 4096
    s_add_u32 s24, s24, 1024
    buffer_load_dwordx4 v2, s[8:11], s24 offen sc1 lds
    s_add_u32 m0, m0, 4096
    s_add_u32 s24, s24, 1024
    buffer_load_dwordx4 v2, s[8:11], s24 offen sc1 lds
    s_add_u32 m0, m0, 4096
    s_add_u32 s24, s24, 1024
    buffer_load_dwordx4 v2, s[8:11], s24 offen sc1 lds
    s_add_u32 m0, m0, 4096
    s_add_u32 s24, s24, 1024
    buffer_load_dwordx4 v2, s[8:11], s24 offen sc1 lds
    s_add_u32 m0, m0, 4096
    s_add_u32 s24, s24, 1024
    buffer_load_dwordx4 v2, s[8:11], s24 offen sc1 lds
    s_add_u32 m0, m0, 4096
    s_add_u32 s24, s24, 1024
    buffer_load_dwordx4 v2, s[8:11], s24 offen sc1 lds
    s_waitcnt vmcnt(0)
    s_barrier
    ds_read_b128 v[160:163], v253 offset:0
    ds_read_b128 v[164:167], v253 offset:1024
    s_waitcnt lgkmcnt(0)
    v_mfma_f32_16x16x32_bf16 v[100:103], a[160:163], v[160:163], 0
    ds_read_b128 v[168:171], v253 offset:2048
    v_mfma_f32_16x16x32_bf16 v[104:107], a[160:163], v[164:167], 0
    ds_read_b128 v[172:175], v253 offset:3072
    v_mfma_f32_16x16x32_bf16 v[108:111], a[164:167], v[160:163], 0
    v_mfma_f32_16x16x32_bf16 v[112:115], a[164:167], v[164:167], 0
    buffer_load_dwordx4 v[16:19], v184, s[48:51], s23 offen offset:0 sc1
    v_mfma_f32_16x16x32_bf16 v[116:119], a[168:171], v[160:163], 0
    v_mfma_f32_16x16x32_bf16 v[120:123], a[168:171], v[164:167], 0
    buffer_store_dwordx4 v[176:179], v253, s[72:75], s18 offen sc1
    s_waitcnt lgkmcnt(0)
    v_mfma_f32_16x16x32_bf16 v[100:103], a[172:175], v[168:171], v[100:103]
    ds_read_b128 v[160:163], v253 offset:4096
    v_mfma_f32_16x16x32_bf16 v[104:107], a[172:175], v[172:175], v[104:107]
    ds_read_b128 v[164:167], v253 offset:5120
    v_mfma_f32_16x16x32_bf16 v[108:111], a[176:179], v[168:171], v[108:111]
    v_mfma_f32_16x16x32_bf16 v[112:115], a[176:179], v[172:175], v[112:115]
    buffer_load_dwordx4 v[20:23], v184, s[48:51], s23 offen offset:1024 sc1
    v_mfma_f32_16x16x32_bf16 v[116:119], a[180:183], v[168:171], v[116:119]
    v_mfma_f32_16x16x32_bf16 v[120:123], a[180:183], v[172:175], v[120:123]
    buffer_store_dwordx4 v[180:183], v253, s[72:75], s19 offen sc1
    s_waitcnt lgkmcnt(0)
    v_mfma_f32_16x16x32_bf16 v[100:103], a[184:187], v[160:163], v[100:103]
    ds_read_b128 v[168:171], v253 offset:6144
    v_mfma_f32_16x16x32_bf16 v[104:107], a[184:187], v[164:167], v[104:107]
    ds_read_b128 v[172:175], v253 offset:7168
    v_mfma_f32_16x16x32_bf16 v[108:111], a[188:191], v[160:163], v[108:111]
    v_mfma_f32_16x16x32_bf16 v[112:115], a[188:191], v[164:167], v[112:115]
    buffer_load_dwordx4 v[24:27], v184, s[48:51], s23 offen offset:2048 sc1
    v_mfma_f32_16x16x32_bf16 v[116:119], a[192:195], v[160:163], v[116:119]
    v_mfma_f32_16x16x32_bf16 v[120:123], a[192:195], v[164:167], v[120:123]
    buffer_store_dwordx4 v[196:199], v253, s[72:75], s20 offen sc1
    s_waitcnt lgkmcnt(0)
    v_mfma_f32_16x16x32_bf16 v[100:103], a[196:199], v[168:171], v[100:103]
    ds_read_b128 v[160:163], v253 offset:8192
    v_mfma_f32_16x16x32_bf16 v[104:107], a[196:199], v[172:175], v[104:107]
    ds_read_b128 v[164:167], v253 offset:9216
    v_mfma_f32_16x16x32_bf16 v[108:111], a[200:203], v[168:171], v[108:111]
    v_mfma_f32_16x16x32_bf16 v[112:115], a[200:203], v[172:175], v[112:115]
    buffer_load_dwordx4 v[28:31], v184, s[48:51], s23 offen offset:3072 sc1
    v_mfma_f32_16x16x32_bf16 v[116:119], a[204:207], v[168:171], v[116:119]
    v_mfma_f32_16x16x32_bf16 v[120:123], a[204:207], v[172:175], v[120:123]
    buffer_store_dwordx4 v[200:203], v253, s[72:75], s21 offen sc1
    s_waitcnt lgkmcnt(0)
    v_mfma_f32_16x16x32_bf16 v[100:103], a[208:211], v[160:163], v[100:103]
    ds_read_b128 v[168:171], v253 offset:10240
    v_mfma_f32_16x16x32_bf16 v[104:107], a[208:211], v[164:167], v[104:107]
    ds_read_b128 v[172:175], v253 offset:11264
    v_mfma_f32_16x16x32_bf16 v[108:111], a[212:215], v[160:163], v[108:111]
    v_mfma_f32_16x16x32_bf16 v[112:115], a[212:215], v[164:167], v[112:115]
    buffer_load_dwordx4 v[32:35], v185, s[48:51], s23 offen offset:0 sc1
    v_mfma_f32_16x16x32_bf16 v[116:119], a[216:219], v[160:163], v[116:119]
    v_mfma_f32_16x16x32_bf16 v[120:123], a[216:219], v[164:167], v[120:123]
    buffer_store_dwordx4 v[204:207], v253, s[72:75], s22 offen sc1
    s_waitcnt lgkmcnt(0)
    v_mfma_f32_16x16x32_bf16 v[100:103], a[220:223], v[168:171], v[100:103]
    ds_read_b128 v[160:163], v253 offset:12288
    v_mfma_f32_16x16x32_bf16 v[104:107], a[220:223], v[172:175], v[104:107]
    ds_read_b128 v[164:167], v253 offset:13312
    v_mfma_f32_16x16x32_bf16 v[108:111], a[224:227], v[168:171], v[108:111]
    v_mfma_f32_16x16x32_bf16 v[112:115], a[224:227], v[172:175], v[112:115]
    buffer_load_dwordx4 v[36:39], v185, s[48:51], s23 offen offset:1024 sc1
    v_mfma_f32_16x16x32_bf16 v[116:119], a[228:231], v[168:171], v[116:119]
    v_mfma_f32_16x16x32_bf16 v[120:123], a[228:231], v[172:175], v[120:123]
    buffer_store_dwordx4 v[208:211], v253, s[72:75], s25 offen sc1
    s_waitcnt lgkmcnt(0)
    v_mfma_f32_16x16x32_bf16 v[100:103], a[232:235], v[160:163], v[100:103]
    ds_read_b128 v[168:171], v253 offset:14336
    v_mfma_f32_16x16x32_bf16 v[104:107], a[232:235], v[164:167], v[104:107]
    ds_read_b128 v[172:175], v253 offset:15360
    v_mfma_f32_16x16x32_bf16 v[108:111], a[236:239], v[160:163], v[108:111]
    v_mfma_f32_16x16x32_bf16 v[112:115], a[236:239], v[164:167], v[112:115]
    buffer_load_dwordx4 v[40:43], v185, s[48:51], s23 offen offset:2048 sc1
    v_mfma_f32_16x16x32_bf16 v[116:119], a[240:243], v[160:163], v[116:119]
    v_mfma_f32_16x16x32_bf16 v[120:123], a[240:243], v[164:167], v[120:123]
    buffer_store_dwordx4 v[212:215], v253, s[72:75], s26 offen sc1
    s_waitcnt lgkmcnt(0)
    v_mfma_f32_16x16x32_bf16 v[100:103], a[244:247], v[168:171], v[100:103]
    ds_read_b128 v[160:163], v253 offset:16384
    v_mfma_f32_16x16x32_bf16 v[104:107], a[244:247], v[172:175], v[104:107]
    ds_read_b128 v[164:167], v253 offset:17408
    v_mfma_f32_16x16x32_bf16 v[108:111], a[248:251], v[168:171], v[108:111]
    v_mfma_f32_16x16x32_bf16 v[112:115], a[248:251], v[172:175], v[112:115]
    buffer_load_dwordx4 v[44:47], v185, s[48:51], s23 offen offset:3072 sc1
    v_mfma_f32_16x16x32_bf16 v[116:119], a[252:255], v[168:171], v[116:119]
    v_mfma_f32_16x16x32_bf16 v[120:123], a[252:255], v[172:175], v[120:123]
    buffer_store_dwordx4 v[216:219], v253, s[72:75], s27 offen sc1
    s_waitcnt lgkmcnt(0)
    v_mfma_f32_16x16x32_bf16 v[100:103], a[128:131], v[160:163], v[100:103]
    ds_read_b128 v[168:171], v253 offset:18432
    v_mfma_f32_16x16x32_bf16 v[104:107], a[128:131], v[164:167], v[104:107]
    ds_read_b128 v[172:175], v253 offset:19456
    v_mfma_f32_16x16x32_bf16 v[108:111], a[132:135], v[160:163], v[108:111]
    v_mfma_f32_16x16x32_bf16 v[112:115], a[132:135], v[164:167], v[112:115]
    buffer_load_dwordx4 v[48:51], v186, s[48:51], s23 offen offset:0 sc1
    v_mfma_f32_16x16x32_bf16 v[116:119], a[136:139], v[160:163], v[116:119]
    v_mfma_f32_16x16x32_bf16 v[120:123], a[136:139], v[164:167], v[120:123]
    buffer_store_dwordx4 v[220:223], v253, s[72:75], s28 offen sc1
    s_waitcnt lgkmcnt(0)
    v_mfma_f32_16x16x32_bf16 v[100:103], a[140:143], v[168:171], v[100:103]
    ds_read_b128 v[160:163], v253 offset:20480
    v_mfma_f32_16x16x32_bf16 v[104:107], a[140:143], v[172:175], v[104:107]
    ds_read_b128 v[164:167], v253 offset:21504
    v_mfma_f32_16x16x32_bf16 v[108:111], a[144:147], v[168:171], v[108:111]
    v_mfma_f32_16x16x32_bf16 v[112:115], a[144:147], v[172:175], v[112:115]
    buffer_load_dwordx4 v[52:55], v186, s[48:51], s23 offen offset:1024 sc1
    v_mfma_f32_16x16x32_bf16 v[116:119], a[148:151], v[168:171], v[116:119]
    v_mfma_f32_16x16x32_bf16 v[120:123], a[148:151], v[172:175], v[120:123]
    buffer_store_dwordx4 v[228:231], v253, s[72:75], s29 offen sc1
    s_waitcnt lgkmcnt(0)
    v_mfma_f32_16x16x32_bf16 v[100:103], a[152:155], v[160:163], v[100:103]
    ds_read_b128 v[168:171], v253 offset:22528
    v_mfma_f32_16x16x32_bf16 v[104:107], a[152:155], v[164:167], v[104:107]
    ds_read_b128 v[172:175], v253 offset:23552
    v_mfma_f32_16x16x32_bf16 v[108:111], a[156:159], v[160:163], v[108:111]
    v_mfma_f32_16x16x32_bf16 v[112:115], a[156:159], v[164:167], v[112:115]
    buffer_load_dwordx4 v[56:59], v186, s[48:51], s23 offen offset:2048 sc1
    v_mfma_f32_16x16x32_bf16 v[116:119], a[0:3], v[160:163], v[116:119]
    v_mfma_f32_16x16x32_bf16 v[120:123], a[0:3], v[164:167], v[120:123]
    s_waitcnt lgkmcnt(0)
    v_mfma_f32_16x16x32_bf16 v[100:103], a[4:7], v[168:171], v[100:103]
    ds_read_b128 v[160:163], v253 offset:24576
    v_mfma_f32_16x16x32_bf16 v[104:107], a[4:7], v[172:175], v[104:107]
    ds_read_b128 v[164:167], v253 offset:25600
    v_mfma_f32_16x16x32_bf16 v[108:111], a[8:11], v[168:171], v[108:111]
    v_mfma_f32_16x16x32_bf16 v[112:115], a[8:11], v[172:175], v[112:115]
    buffer_load_dwordx4 v[60:63], v186, s[48:51], s23 offen offset:3072 sc1
    v_mfma_f32_16x16x32_bf16 v[116:119], a[12:15], v[168:171], v[116:119]
    v_mfma_f32_16x16x32_bf16 v[120:123], a[12:15], v[172:175], v[120:123]
    s_waitcnt lgkmcnt(0)
    v_mfma_f32_16x16x32_bf16 v[100:103], a[16:19], v[160:163], v[100:103]
    ds_read_b128 v[168:171], v253 offset:26624
    v_mfma_f32_16x16x32_bf16 v[104:107], a[16:19], v[164:167], v[104:107]
    ds_read_b128 v[172:175], v253 offset:27648
    v_mfma_f32_16x16x32_bf16 v[108:111], a[20:23], v[160:163], v[108:111]
    v_mfma_f32_16x16x32_bf16 v[112:115], a[20:23], v[164:167], v[112:115]
    buffer_load_dwordx4 v[64:67], v187, s[48:51], s23 offen offset:0 sc1
    v_mfma_f32_16x16x32_bf16 v[116:119], a[24:27], v[160:163], v[116:119]
    v_mfma_f32_16x16x32_bf16 v[120:123], a[24:27], v[164:167], v[120:123]
    s_waitcnt lgkmcnt(0)
    v_mfma_f32_16x16x32_bf16 v[100:103], a[28:31], v[168:171], v[100:103]
    ds_read_b128 v[160:163], v253 offset:28672
    v_mfma_f32_16x16x32_bf16 v[104:107], a[28:31], v[172:175], v[104:107]
    ds_read_b128 v[164:167], v253 offset:29696
    v_mfma_f32_16x16x32_bf16 v[108:111], a[32:35], v[168:171], v[108:111]
    v_mfma_f32_16x16x32_bf16 v[112:115], a[32:35], v[172:175], v[112:115]
    buffer_load_dwordx4 v[68:71], v187, s[48:51], s23 offen offset:1024 sc1
    v_mfma_f32_16x16x32_bf16 v[116:119], a[36:39], v[168:171], v[116:119]
    v_mfma_f32_16x16x32_bf16 v[120:123], a[36:39], v[172:175], v[120:123]
    s_waitcnt lgkmcnt(0)
    v_mfma_f32_16x16x32_bf16 v[100:103], a[40:43], v[160:163], v[100:103]
    ds_read_b128 v[168:171], v253 offset:30720
    v_mfma_f32_16x16x32_bf16 v[104:107], a[40:43], v[164:167], v[104:107]
    ds_read_b128 v[172:175], v253 offset:31744
    v_mfma_f32_16x16x32_bf16 v[108:111], a[44:47], v[160:163], v[108:111]
    v_mfma_f32_16x16x32_bf16 v[112:115], a[44:47], v[164:167], v[112:115]
    buffer_load_dwordx4 v[72:75], v187, s[48:51], s23 offen offset:2048 sc1
    v_mfma_f32_16x16x32_bf16 v[116:119], a[48:51], v[160:163], v[116:119]
    v_mfma_f32_16x16x32_bf16 v[120:123], a[48:51], v[164:167], v[120:123]
    s_waitcnt lgkmcnt(0)
    v_mfma_f32_16x16x32_bf16 v[100:103], a[52:55], v[168:171], v[100:103]
    ds_read_b128 v[160:163], v253 offset:32768
    v_mfma_f32_16x16x32_bf16 v[104:107], a[52:55], v[172:175], v[104:107]
    ds_read_b128 v[164:167], v253 offset:33792
    v_mfma_f32_16x16x32_bf16 v[108:111], a[56:59], v[168:171], v[108:111]
    v_mfma_f32_16x16x32_bf16 v[112:115], a[56:59], v[172:175], v[112:115]
    v_mfma_f32_16x16x32_bf16 v[116:119], a[60:63], v[168:171], v[116:119]
    v_mfma_f32_16x16x32_bf16 v[120:123], a[60:63], v[172:175], v[120:123]
    s_waitcnt lgkmcnt(0)
    v_mfma_f32_16x16x32_bf16 v[100:103], a[64:67], v[160:163], v[100:103]
    ds_read_b128 v[168:171], v253 offset:34816
    v_mfma_f32_16x16x32_bf16 v[104:107], a[64:67], v[164:167], v[104:107]
    ds_read_b128 v[172:175], v253 offset:35840
    v_mfma_f32_16x16x32_bf16 v[108:111], a[68:71], v[160:163], v[108:111]
    v_mfma_f32_16x16x32_bf16 v[112:115], a[68:71], v[164:167], v[112:115]
    v_mfma_f32_16x16x32_bf16 v[116:119], a[72:75], v[160:163], v[116:119]
    v_mfma_f32_16x16x32_bf16 v[120:123], a[72:75], v[164:167], v[120:123]
    s_waitcnt lgkmcnt(0)
    v_mfma_f32_16x16x32_bf16 v[100:103], a[76:79], v[168:171], v[100:103]
    v_mfma_f32_16x16x32_bf16 v[104:107], a[76:79], v[172:175], v[104:107]
    v_mfma_f32_16x16x32_bf16 v[108:111], a[80:83], v[168:171], v[108:111]
    v_mfma_f32_16x16x32_bf16 v[112:115], a[80:83], v[172:175], v[112:115]
    v_mfma_f32_16x16x32_bf16 v[116:119], a[84:87], v[168:171], v[116:119]
    v_mfma_f32_16x16x32_bf16 v[120:123], a[84:87], v[172:175], v[120:123]
    s_nop 3
    v_permlane16_swap_b32 v100, v104
    v_permlane16_swap_b32 v101, v105
    v_permlane16_swap_b32 v102, v106
    v_permlane16_swap_b32 v103, v107
    v_add_f32 v12, v116, v117
    v_add_f32 v13, v120, v121
    ds_write_b32 v10, v12
    ds_write_b32 v10, v13 offset:64
    v_permlane16_swap_b32 v108, v112
    v_permlane16_swap_b32 v109, v113
    v_permlane16_swap_b32 v110, v114
    v_permlane16_swap_b32 v111, v115
    v_permlane16_swap_b32 v116, v120
    v_permlane16_swap_b32 v117, v121
    v_permlane16_swap_b32 v118, v122
    v_permlane16_swap_b32 v119, v123
    s_waitcnt lgkmcnt(0)
    s_barrier
    ds_read_b32 v12, v11 offset:40960
    v_pk_add_f32 v[124:125], v[124:125], v[100:101]
    v_pk_add_f32 v[126:127], v[126:127], v[102:103]
    v_pk_add_f32 v[128:129], v[128:129], v[104:105]
    v_pk_add_f32 v[130:131], v[130:131], v[106:107]
    v_pk_add_f32 v[132:133], v[132:133], v[108:109]
    v_pk_add_f32 v[134:135], v[134:135], v[110:111]
    v_pk_add_f32 v[136:137], v[136:137], v[112:113]
    v_pk_add_f32 v[138:139], v[138:139], v[114:115]
    v_pk_add_f32 v[140:141], v[140:141], v[116:117]
    v_pk_add_f32 v[142:143], v[142:143], v[118:119]
    v_pk_add_f32 v[144:145], v[144:145], v[120:121]
    v_pk_add_f32 v[146:147], v[146:147], v[122:123]
    v_mov_b32 v14, 0
    v_mov_b32 v15, 0
    s_waitcnt lgkmcnt(0)
    v_add_f32 v12, v12, v252
    v_pk_add_f32 v[100:101], v[124:125], v[12:13] op_sel_hi:[1,0] neg_lo:[0,1] neg_hi:[0,1]
    v_pk_add_f32 v[102:103], v[126:127], v[12:13] op_sel_hi:[1,0] neg_lo:[0,1] neg_hi:[0,1]
    v_pk_add_f32 v[104:105], v[128:129], v[12:13] op_sel_hi:[1,0] neg_lo:[0,1] neg_hi:[0,1]
    v_pk_add_f32 v[106:107], v[130:131], v[12:13] op_sel_hi:[1,0] neg_lo:[0,1] neg_hi:[0,1]
    v_cvt_pk_bf16_f32 v148, v100, v101
    v_cvt_pk_bf16_f32 v149, v102, v103
    v_cvt_pk_bf16_f32 v150, v104, v105
    v_cvt_pk_bf16_f32 v151, v106, v107
    buffer_store_dwordx4 v[148:151], v9, s[8:11], s46 offen offset:0 sc1
    v_pk_add_f32 v[108:109], v[132:133], v[12:13] op_sel_hi:[1,0] neg_lo:[0,1] neg_hi:[0,1]
    v_pk_add_f32 v[110:111], v[134:135], v[12:13] op_sel_hi:[1,0] neg_lo:[0,1] neg_hi:[0,1]
    v_pk_add_f32 v[112:113], v[136:137], v[12:13] op_sel_hi:[1,0] neg_lo:[0,1] neg_hi:[0,1]
    v_pk_add_f32 v[114:115], v[138:139], v[12:13] op_sel_hi:[1,0] neg_lo:[0,1] neg_hi:[0,1]
    v_cvt_pk_bf16_f32 v152, v108, v109
    v_cvt_pk_bf16_f32 v153, v110, v111
    v_cvt_pk_bf16_f32 v154, v112, v113
    v_cvt_pk_bf16_f32 v155, v114, v115
    buffer_store_dwordx4 v[152:155], v9, s[8:11], s46 offen offset:1024 sc1
    v_pk_add_f32 v[116:117], v[140:141], v[12:13] op_sel_hi:[1,0] neg_lo:[0,1] neg_hi:[0,1]
    v_pk_add_f32 v[118:119], v[142:143], v[12:13] op_sel_hi:[1,0] neg_lo:[0,1] neg_hi:[0,1]
    v_pk_add_f32 v[120:121], v[144:145], v[12:13] op_sel_hi:[1,0] neg_lo:[0,1] neg_hi:[0,1]
    v_pk_add_f32 v[122:123], v[146:147], v[12:13] op_sel_hi:[1,0] neg_lo:[0,1] neg_hi:[0,1]
    v_cvt_pk_bf16_f32 v156, v116, v117
    v_cvt_pk_bf16_f32 v157, v118, v119
    v_cvt_pk_bf16_f32 v158, v120, v121
    v_cvt_pk_bf16_f32 v159, v122, v123
    buffer_store_dwordx4 v[156:159], v7, s[8:11], s46 offen offset:2048 sc1
    v_dot2c_f32_bf16 v14, v148, v148
    v_dot2c_f32_bf16 v14, v149, v149
    v_dot2c_f32_bf16 v14, v150, v150
    v_dot2c_f32_bf16 v14, v151, v151
    v_dot2c_f32_bf16 v14, v152, v152
    v_dot2c_f32_bf16 v14, v153, v153
    v_dot2c_f32_bf16 v14, v154, v154
    v_dot2c_f32_bf16 v14, v155, v155
    v_dot2c_f32_bf16 v15, v156, v156
    v_dot2c_f32_bf16 v15, v157, v157
    v_dot2c_f32_bf16 v15, v158, v158
    v_dot2c_f32_bf16 v15, v159, v159
    buffer_store_dword v12, v6, s[8:11], s36 offen sc1
    s_nop 1
    v_fma_f32 v14, v15, s35, v14
    v_mov_b32 v15, v14
    s_nop 1
    v_permlane32_swap_b32 v14, v15
    v_add_f32 v14, v14, v15
    buffer_store_dword v14, v8, s[8:11], s45 offen sc1
    v_lshlrev_b32 v15, 7, v0
    s_lshl_b32 s6, s40, 2
    s_add_u32 s6, s6, s44
    s_add_u32 s6, s6, 32768
    v_mov_b32 v1, s76
    s_mov_b64 vcc, 0xff
    s_waitcnt vmcnt(0)
    s_barrier
    s_cmp_lg_u32 s3, 0
    s_cbranch_scc1 L_pub_28
    s_mov_b64 exec, vcc
    buffer_store_dword v1, v15, s[8:11], s6 offen sc1
    s_cmp_lg_u32 s42, 0
    s_cbranch_scc1 L_pub_28
    v_lshlrev_b32 v15, 10, v0
    s_lshl_b32 s6, s40, 7
    s_lshl_b32 s7, s41, 2
    s_add_u32 s6, s6, s7
    s_add_u32 s6, s6, 19464192
    s_mov_b64 exec, 0xffffffff
    v_lshlrev_b32 v15, 10, v0
    v_mov_b32 v1, s76
    buffer_store_dword v1, v15, s[8:11], s6 offen sc1
L_pub_28:
    s_mov_b64 exec, -1
    s_lshl_b32 s7, s41, 2
    s_add_u32 s7, s7, s3
    s_mul_i32 s22, s7, 18432
    s_add_u32 s22, s22, s43
    s_add_u32 s22, s22, 45875200
    s_mul_i32 s24, s3, 18432
    s_lshl_b32 s25, s41, 12
    s_add_u32 s25, s25, s43
    s_add_u32 s25, s25, 48300032
    v_lshrrev_b32 v3, 5, v0
    v_and_b32 v10, 31, v0
    v_lshlrev_b32 v10, 2, v10
    v_lshl_add_u32 v3, v3, 11, v10
    v_add_u32 v11, 36864, v184
    s_cmp_lg_u32 s3, 0
    s_cbranch_scc1 L_pollout_31
    s_lshl_b32 s7, s40, 7
    s_add_u32 s7, s7, s44
    s_add_u32 s7, s7, 32768
    s_add_u32 s52, s4, s7
    s_addc_u32 s53, s5, 0
    s_mov_b32 s6, 0
L_poll_29:
    s_load_dwordx8 s[56:63], s[52:53], 0 glc
    s_add_u32 s6, s6, 1
    s_waitcnt lgkmcnt(0)
    s_xor_b64 s[56:57], s[56:57], s[76:77]
    s_xor_b64 s[58:59], s[58:59], s[76:77]
    s_xor_b64 s[60:61], s[60:61], s[76:77]
    s_xor_b64 s[62:63], s[62:63], s[76:77]
    s_or_b64 s[56:57], s[56:57], s[58:59]
    s_or_b64 s[60:61], s[60:61], s[62:63]
    s_or_b64 s[56:57], s[56:57], s[60:61]
    s_cbranch_scc0 L_polled_30
    s_cmp_lt_u32 s6, 1048576
    s_cbranch_scc1 L_poll_29
    s_branch L_main_end
L_polled_30:
    s_cmp_lg_u32 s42, 0
    s_cbranch_scc1 L_pollout_31
    s_lshl_b32 s7, s41, 3
    s_add_u32 s7, s7, s40
    s_lshl_b32 s7, s7, 7
    s_add_u32 s7, s7, 19464192
    s_add_u32 s68, s4, s7
    s_addc_u32 s69, s5, 0
    s_mov_b32 s6, 0
    s_mov_b32 s7, 0
L_cpoll_32:
    s_load_dwordx16 s[52:67], s[68:69], s7 glc
    s_add_u32 s6, s6, 1
    s_waitcnt lgkmcnt(0)
    s_xor_b64 s[52:53], s[52:53], s[76:77]
    s_xor_b64 s[54:55], s[54:55], s[76:77]
    s_xor_b64 s[56:57], s[56:57], s[76:77]
    s_xor_b64 s[58:59], s[58:59], s[76:77]
    s_xor_b64 s[60:61], s[60:61], s[76:77]
    s_xor_b64 s[62:63], s[62:63], s[76:77]
    s_xor_b64 s[64:65], s[64:65], s[76:77]
    s_xor_b64 s[66:67], s[66:67], s[76:77]
    s_or_b64 s[52:53], s[52:53], s[60:61]
    s_or_b64 s[54:55], s[54:55], s[62:63]
    s_or_b64 s[56:57], s[56:57], s[64:65]
    s_or_b64 s[58:59], s[58:59], s[66:67]
    s_or_b64 s[52:53], s[52:53], s[56:57]
    s_or_b64 s[54:55], s[54:55], s[58:59]
    s_or_b64 s[52:53], s[52:53], s[54:55]
    s_cbranch_scc1 L_cpoll_33
    s_add_u32 s7, s7, 64
    s_cmp_eq_u32 s7, 128
    s_cbranch_scc1 L_cpolled_34
L_cpoll_33:
    s_cmp_lt_u32 s6, 1048576
    s_cbranch_scc1 L_cpoll_32
    s_branch L_main_end
L_cpolled_34:
L_pollout_31:
    s_barrier
    buffer_load_dword v88, v3, s[8:11], s25 offen offset:0 sc1
    buffer_load_dword v89, v3, s[8:11], s25 offen offset:128 sc1
    buffer_load_dword v90, v3, s[8:11], s25 offen offset:256 sc1
    buffer_load_dword v91, v3, s[8:11], s25 offen offset:384 sc1
    buffer_load_dword v92, v3, s[8:11], s25 offen offset:512 sc1
    buffer_load_dword v93, v3, s[8:11], s25 offen offset:640 sc1
    buffer_load_dword v94, v3, s[8:11], s25 offen offset:768 sc1
    buffer_load_dword v95, v3, s[8:11], s25 offen offset:896 sc1
    buffer_load_dword v96, v3, s[8:11], s25 offen offset:1024 sc1
    buffer_load_dword v97, v3, s[8:11], s25 offen offset:1152 sc1
    buffer_load_dword v98, v3, s[8:11], s25 offen offset:1280 sc1
    buffer_load_dword v99, v3, s[8:11], s25 offen offset:1408 sc1
    buffer_load_dword v100, v3, s[8:11], s25 offen offset:1536 sc1
    buffer_load_dword v101, v3, s[8:11], s25 offen offset:1664 sc1
    buffer_load_dword v102, v3, s[8:11], s25 offen offset:1792 sc1
    buffer_load_dword v103, v3, s[8:11], s25 offen offset:1920 sc1
    s_add_u32 m0, s24, 0
    s_nop 0
    buffer_load_dwordx4 v2, s[8:11], s22 offen offset:0 sc1 lds
    s_add_u32 m0, s24, 512
    s_nop 0
    buffer_load_dwordx4 v2, s[8:11], s22 offen offset:512 sc1 lds
    s_add_u32 m0, s24, 1024
    s_nop 0
    buffer_load_dwordx4 v2, s[8:11], s22 offen offset:1024 sc1 lds
    s_add_u32 m0, s24, 1536
    s_nop 0
    buffer_load_dwordx4 v2, s[8:11], s22 offen offset:1536 sc1 lds
    s_add_u32 m0, s24, 2048
    s_nop 0
    buffer_load_dwordx4 v2, s[8:11], s22 offen offset:2048 sc1 lds
    s_add_u32 m0, s24, 2560
    s_nop 0
    buffer_load_dwordx4 v2, s[8:11], s22 offen offset:2560 sc1 lds
    s_add_u32 m0, s24, 3072
    s_nop 0
    buffer_load_dwordx4 v2, s[8:11], s22 offen offset:3072 sc1 lds
    s_add_u32 m0, s24, 3584
    s_nop 0
    buffer_load_dwordx4 v2, s[8:11], s22 offen offset:3584 sc1 lds
    s_add_u32 m0, s24, 8192
    s_add_u32 s22, s22, 4096
    buffer_load_dwordx4 v2, s[8:11], s22 offen offset:0 sc1 lds
    s_add_u32 m0, s24, 8704
    s_nop 0
    buffer_load_dwordx4 v2, s[8:11], s22 offen offset:512 sc1 lds
    s_add_u32 m0, s24, 9216
    s_nop 0
    buffer_load_dwordx4 v2, s[8:11], s22 offen offset:1024 sc1 lds
    s_add_u32 m0, s24, 9728
    s_nop 0
    buffer_load_dwordx4 v2, s[8:11], s22 offen offset:1536 sc1 lds
    s_add_u32 m0, s24, 10240
    s_nop 0
    buffer_load_dwordx4 v2, s[8:11], s22 offen offset:2048 sc1 lds
    s_add_u32 m0, s24, 10752
    s_nop 0
    buffer_load_dwordx4 v2, s[8:11], s22 offen offset:2560 sc1 lds
    s_add_u32 m0, s24, 11264
    s_nop 0
    buffer_load_dwordx4 v2, s[8:11], s22 offen offset:3072 sc1 lds
    s_add_u32 m0, s24, 11776
    s_nop 0
    buffer_load_dwordx4 v2, s[8:11], s22 offen offset:3584 sc1 lds
    s_add_u32 m0, s24, 16384
    s_add_u32 s22, s22, 4096
    buffer_load_dwordx4 v2, s[8:11], s22 offen offset:0 sc1 lds
    s_add_u32 m0, s24, 16896
    s_nop 0
    buffer_load_dwordx4 v2, s[8:11], s22 offen offset:512 sc1 lds
    s_add_u32 s50, s23, 497664
    s_waitcnt vmcnt(18)
    v_pk_add_f32 v[88:89], v[88:89], v[96:97]
    v_pk_add_f32 v[90:91], v[90:91], v[98:99]
    v_pk_add_f32 v[92:93], v[92:93], v[100:101]
    v_pk_add_f32 v[94:95], v[94:95], v[102:103]
    v_pk_add_f32 v[88:89], v[88:89], v[92:93]
    v_pk_add_f32 v[90:91], v[90:91], v[94:95]
    v_pk_add_f32 v[88:89], v[88:89], v[90:91]
    v_add_f32 v88, v88, v89
    v_mov_b32 v89, 0x3727c5ac
    v_fmac_f32 v89, 0x3ae38e39, v88
    v_mov_b32 v193, v89
    s_nop 1
    v_permlane16_swap_b32 v193, v89
    v_mov_b32 v195, v193
    v_mov_b32 v194, v89
    v_mov_b32 v252, v89
    v_permlane32_swap_b32 v193, v195
    s_nop 0
    v_permlane32_swap_b32 v194, v252
    v_rsq_f32 v4, v193
    v_rsq_f32 v5, v194
    v_rsq_f32 v6, v195
    v_rsq_f32 v7, v252
    v_mul_f32 v8, v4, v4
    v_mul_f32 v9, v5, v5
    v_mul_f32 v13, v6, v6
    v_mul_f32 v14, v7, v7
    v_mul_f32 v4, 0xc0135761, v4
    v_mul_f32 v5, 0xc0135761, v5
    v_mul_f32 v6, 0xc0135761, v6
    v_mul_f32 v7, 0xc0135761, v7
    v_mul_f32 v8, 0x3d372713, v8
    v_mul_f32 v9, 0x3d372713, v9
    v_mul_f32 v13, 0x3d372713, v13
    v_mul_f32 v14, 0x3d372713, v14
    v_mul_f32 v8, v8, v4
    v_mul_f32 v9, v9, v5
    v_mul_f32 v13, v13, v6
    v_mul_f32 v14, v14, v7
    s_waitcnt vmcnt(12)
    s_barrier
    ds_read_b128 a[0:3], v184 offset:0
    ds_read_b128 a[72:75], v184 offset:18432
    ds_read_b128 a[144:147], v11 offset:0
    ds_read_b128 a[216:219], v11 offset:18432
    ds_read_b128 a[4:7], v184 offset:1024
    ds_read_b128 a[76:79], v184 offset:19456
    ds_read_b128 a[148:151], v11 offset:1024
    ds_read_b128 a[220:223], v11 offset:19456
    ds_read_b128 a[8:11], v184 offset:2048
    ds_read_b128 a[80:83], v184 offset:20480
    ds_read_b128 a[152:155], v11 offset:2048
    ds_read_b128 a[224:227], v11 offset:20480
    ds_read_b128 a[12:15], v184 offset:3072
    ds_read_b128 a[84:87], v184 offset:21504
    ds_read_b128 a[156:159], v11 offset:3072
    ds_read_b128 a[228:231], v11 offset:21504
    ds_read_b128 a[16:19], v184 offset:4096
    ds_read_b128 a[88:91], v184 offset:22528
    ds_read_b128 a[160:163], v11 offset:4096
    ds_read_b128 a[232:235], v11 offset:22528
    ds_read_b128 a[20:23], v184 offset:5120
    ds_read_b128 a[92:95], v184 offset:23552
    ds_read_b128 a[164:167], v11 offset:5120
    ds_read_b128 a[236:239], v11 offset:23552
    s_waitcnt vmcnt(6)
    s_barrier
    ds_read_b128 a[24:27], v184 offset:6144
    ds_read_b128 a[96:99], v184 offset:24576
    ds_read_b128 a[168:171], v11 offset:6144
    ds_read_b128 a[240:243], v11 offset:24576
    ds_read_b128 a[28:31], v184 offset:7168
    ds_read_b128 a[100:103], v184 offset:25600
    ds_read_b128 a[172:175], v11 offset:7168
    ds_read_b128 a[244:247], v11 offset:25600
    ds_read_b128 a[32:35], v184 offset:8192
    ds_read_b128 a[104:107], v184 offset:26624
    ds_read_b128 a[176:179], v11 offset:8192
    ds_read_b128 a[248:251], v11 offset:26624
    ds_read_b128 a[36:39], v184 offset:9216
    ds_read_b128 a[108:111], v184 offset:27648
    ds_read_b128 a[180:183], v11 offset:9216
    ds_read_b128 a[252:255], v11 offset:27648
    ds_read_b128 a[40:43], v184 offset:10240
    ds_read_b128 a[112:115], v184 offset:28672
    ds_read_b128 a[184:187], v11 offset:10240
    ds_read_b128 v[220:223], v11 offset:28672
    ds_read_b128 a[44:47], v184 offset:11264
    ds_read_b128 a[116:119], v184 offset:29696
    ds_read_b128 a[188:191], v11 offset:11264
    ds_read_b128 v[224:227], v11 offset:29696
    s_waitcnt vmcnt(0)
    s_barrier
    s_cmp_lg_u32 s42, 0
    s_cbranch_scc1 L_ring_35
    buffer_load_dwordx4 v[16:19], v184, s[48:51], s23 offen offset:0 sc1
    buffer_load_dwordx4 v[20:23], v184, s[48:51], s23 offen offset:1024 sc1
    buffer_load_dwordx4 v[24:27], v184, s[48:51], s23 offen offset:2048 sc1
    buffer_load_dwordx4 v[28:31], v184, s[48:51], s23 offen offset:3072 sc1
    buffer_load_dwordx4 v[32:35], v185, s[48:51], s23 offen offset:0 sc1
    buffer_load_dwordx4 v[36:39], v185, s[48:51], s23 offen offset:1024 sc1
    buffer_load_dwordx4 v[40:43], v185, s[48:51], s23 offen offset:2048 sc1
    buffer_load_dwordx4 v[44:47], v185, s[48:51], s23 offen offset:3072 sc1
    buffer_load_dwordx4 v[48:51], v186, s[48:51], s23 offen offset:0 sc1
    buffer_load_dwordx4 v[52:55], v186, s[48:51], s23 offen offset:1024 sc1
    buffer_load_dwordx4 v[56:59], v186, s[48:51], s23 offen offset:2048 sc1
    buffer_load_dwordx4 v[60:63], v186, s[48:51], s23 offen offset:3072 sc1
    buffer_load_dwordx4 v[64:67], v187, s[48:51], s23 offen offset:0 sc1
    buffer_load_dwordx4 v[68:71], v187, s[48:51], s23 offen offset:1024 sc1
    buffer_load_dwordx4 v[72:75], v187, s[48:51], s23 offen offset:2048 sc1
L_ring_35:
    s_add_u32 s23, s23, 15360
    ds_read_b128 a[48:51], v184 offset:12288
    ds_read_b128 a[120:123], v184 offset:30720
    ds_read_b128 a[192:195], v11 offset:12288
    ds_read_b128 v[228:231], v11 offset:30720
    ds_read_b128 a[52:55], v184 offset:13312
    ds_read_b128 a[124:127], v184 offset:31744
    ds_read_b128 a[196:199], v11 offset:13312
    ds_read_b128 v[232:235], v11 offset:31744
    ds_read_b128 a[56:59], v184 offset:14336
    ds_read_b128 a[128:131], v184 offset:32768
    ds_read_b128 a[200:203], v11 offset:14336
    ds_read_b128 v[236:239], v11 offset:32768
    ds_read_b128 a[60:63], v184 offset:15360
    ds_read_b128 a[132:135], v184 offset:33792
    ds_read_b128 a[204:207], v11 offset:15360
    ds_read_b128 v[240:243], v11 offset:33792
    ds_read_b128 a[64:67], v184 offset:16384
    ds_read_b128 a[136:139], v184 offset:34816
    ds_read_b128 a[208:211], v11 offset:16384
    ds_read_b128 v[244:247], v11 offset:34816
    ds_read_b128 a[68:71], v184 offset:17408
    ds_read_b128 a[140:143], v184 offset:35840
    ds_read_b128 a[212:215], v11 offset:17408
    ds_read_b128 v[248:251], v11 offset:35840
    s_lshr_b32 s7, s3, 1
    s_lshl_b32 s7, s7, 10
    s_and_b32 s6, s3, 1
    s_lshl_b32 s6, s6, 3
    s_add_u32 s24, s7, s6
    s_add_u32 s24, s24, 73728
    s_add_u32 s7, s24, 16384
    v_add_u32 v12, s7, v184
    s_mov_b32 s25, 0
    s_waitcnt lgkmcnt(0)
L_ffn_gu_36:
    s_waitcnt vmcnt(12)
    v_mfma_f32_16x16x32_bf16 v[88:91], v[16:19], a[0:3], 0
    v_mfma_f32_16x16x32_bf16 v[88:91], v[20:23], a[4:7], v[88:91]
    buffer_load_dwordx4 v[76:79], v184, s[48:51], s23 offen offset:0 sc1
    v_mfma_f32_16x16x32_bf16 v[88:91], v[24:27], a[8:11], v[88:91]
    v_mul_f32 v152, v120, v120
    v_mul_f32 v153, v121, v121
    v_mfma_f32_16x16x32_bf16 v[92:95], v[16:19], a[72:75], 0
    v_mul_f32 v154, v122, v122
    v_mul_f32 v155, v123, v123
    v_mfma_f32_16x16x32_bf16 v[92:95], v[20:23], a[76:79], v[92:95]
    v_fma_f32 v152, v152, v8, v4
    v_fma_f32 v153, v153, v8, v4
    v_mfma_f32_16x16x32_bf16 v[92:95], v[24:27], a[80:83], v[92:95]
    buffer_load_dwordx4 v[80:83], v184, s[48:51], s23 offen offset:1024 sc1
    v_mfma_f32_16x16x32_bf16 v[96:99], v[16:19], a[144:147], 0
    v_fma_f32 v154, v154, v8, v4
    v_fma_f32 v155, v155, v8, v4
    v_mfma_f32_16x16x32_bf16 v[96:99], v[20:23], a[148:151], v[96:99]
    v_mul_f32 v152, v120, v152
    v_mul_f32 v153, v121, v153
    v_mfma_f32_16x16x32_bf16 v[96:99], v[24:27], a[152:155], v[96:99]
    v_mul_f32 v154, v122, v154
    v_mul_f32 v155, v123, v155
    v_mfma_f32_16x16x32_bf16 v[100:103], v[16:19], a[216:219], 0
    buffer_load_dwordx4 v[84:87], v184, s[48:51], s23 offen offset:2048 sc1
    v_mfma_f32_16x16x32_bf16 v[100:103], v[20:23], a[220:223], v[100:103]
    v_exp_f32 v152, v152
    v_mfma_f32_16x16x32_bf16 v[100:103], v[24:27], a[224:227], v[100:103]
    v_exp_f32 v153, v153
    s_waitcnt vmcnt(12)
    v_mfma_f32_16x16x32_bf16 v[104:107], v[28:31], a[0:3], 0
    v_exp_f32 v154, v154
    v_mfma_f32_16x16x32_bf16 v[104:107], v[32:35], a[4:7], v[104:107]
    buffer_load_dwordx4 v[16:19], v184, s[48:51], s23 offen offset:3072 sc1
    v_mfma_f32_16x16x32_bf16 v[104:107], v[36:39], a[8:11], v[104:107]
    v_exp_f32 v155, v155
    v_mfma_f32_16x16x32_bf16 v[108:111], v[28:31], a[72:75], 0
    v_mul_f32 v156, v120, v136
    v_mul_f32 v157, v121, v137
    v_mfma_f32_16x16x32_bf16 v[108:111], v[32:35], a[76:79], v[108:111]
    v_mul_f32 v158, v122, v138
    v_mul_f32 v159, v123, v139
    v_mfma_f32_16x16x32_bf16 v[108:111], v[36:39], a[80:83], v[108:111]
    buffer_load_dwordx4 v[20:23], v185, s[48:51], s23 offen offset:0 sc1
    v_mfma_f32_16x16x32_bf16 v[112:115], v[28:31], a[144:147], 0
    v_fma_f32 v152, v152, v193, v193
    v_fma_f32 v153, v153, v193, v193
    v_mfma_f32_16x16x32_bf16 v[112:115], v[32:35], a[148:151], v[112:115]
    v_fma_f32 v154, v154, v193, v193
    v_fma_f32 v155, v155, v193, v193
    v_mfma_f32_16x16x32_bf16 v[112:115], v[36:39], a[152:155], v[112:115]
    v_rcp_f32 v152, v152
    v_mfma_f32_16x16x32_bf16 v[116:119], v[28:31], a[216:219], 0
    buffer_load_dwordx4 v[24:27], v185, s[48:51], s23 offen offset:1024 sc1
    v_mfma_f32_16x16x32_bf16 v[116:119], v[32:35], a[220:223], v[116:119]
    v_rcp_f32 v153, v153
    v_mfma_f32_16x16x32_bf16 v[116:119], v[36:39], a[224:227], v[116:119]
    v_rcp_f32 v154, v154
    s_waitcnt vmcnt(12)
    v_mfma_f32_16x16x32_bf16 v[88:91], v[40:43], a[12:15], v[88:91]
    v_rcp_f32 v155, v155
    v_mfma_f32_16x16x32_bf16 v[88:91], v[44:47], a[16:19], v[88:91]
    buffer_load_dwordx4 v[28:31], v185, s[48:51], s23 offen offset:2048 sc1
    v_mfma_f32_16x16x32_bf16 v[88:91], v[48:51], a[20:23], v[88:91]
    v_mul_f32 v156, v156, v152
    v_mul_f32 v157, v157, v153
    v_mfma_f32_16x16x32_bf16 v[92:95], v[40:43], a[84:87], v[92:95]
    v_mul_f32 v158, v158, v154
    v_mul_f32 v159, v159, v155
    v_mfma_f32_16x16x32_bf16 v[92:95], v[44:47], a[88:91], v[92:95]
    v_cvt_pk_bf16_f32 v160, v156, v157
    v_cvt_pk_bf16_f32 v161, v158, v159
    v_mfma_f32_16x16x32_bf16 v[92:95], v[48:51], a[92:95], v[92:95]
    buffer_load_dwordx4 v[32:35], v185, s[48:51], s23 offen offset:3072 sc1
    v_mfma_f32_16x16x32_bf16 v[96:99], v[40:43], a[156:159], v[96:99]
    ds_write_b64 v12, v[160:161] offset:0
    v_mfma_f32_16x16x32_bf16 v[96:99], v[44:47], a[160:163], v[96:99]
    v_mul_f32 v162, v124, v124
    v_mul_f32 v163, v125, v125
    v_mfma_f32_16x16x32_bf16 v[96:99], v[48:51], a[164:167], v[96:99]
    v_mul_f32 v164, v126, v126
    v_mul_f32 v165, v127, v127
    v_mfma_f32_16x16x32_bf16 v[100:103], v[40:43], a[228:231], v[100:103]
    buffer_load_dwordx4 v[36:39], v186, s[48:51], s23 offen offset:0 sc1
    v_mfma_f32_16x16x32_bf16 v[100:103], v[44:47], a[232:235], v[100:103]
    v_fma_f32 v162, v162, v9, v5
    v_fma_f32 v163, v163, v9, v5
    v_mfma_f32_16x16x32_bf16 v[100:103], v[48:51], a[236:239], v[100:103]
    v_fma_f32 v164, v164, v9, v5
    v_fma_f32 v165, v165, v9, v5
    s_waitcnt vmcnt(12)
    v_mfma_f32_16x16x32_bf16 v[104:107], v[52:55], a[12:15], v[104:107]
    v_mul_f32 v162, v124, v162
    v_mul_f32 v163, v125, v163
    v_mfma_f32_16x16x32_bf16 v[104:107], v[56:59], a[16:19], v[104:107]
    buffer_load_dwordx4 v[40:43], v186, s[48:51], s23 offen offset:1024 sc1
    v_mfma_f32_16x16x32_bf16 v[104:107], v[60:63], a[20:23], v[104:107]
    v_mul_f32 v164, v126, v164
    v_mul_f32 v165, v127, v165
    v_mfma_f32_16x16x32_bf16 v[108:111], v[52:55], a[84:87], v[108:111]
    v_exp_f32 v162, v162
    v_mfma_f32_16x16x32_bf16 v[108:111], v[56:59], a[88:91], v[108:111]
    v_exp_f32 v163, v163
    v_mfma_f32_16x16x32_bf16 v[108:111], v[60:63], a[92:95], v[108:111]
    buffer_load_dwordx4 v[44:47], v186, s[48:51], s23 offen offset:2048 sc1
    v_mfma_f32_16x16x32_bf16 v[112:115], v[52:55], a[156:159], v[112:115]
    v_exp_f32 v164, v164
    v_mfma_f32_16x16x32_bf16 v[112:115], v[56:59], a[160:163], v[112:115]
    v_exp_f32 v165, v165
    v_mfma_f32_16x16x32_bf16 v[112:115], v[60:63], a[164:167], v[112:115]
    v_mul_f32 v166, v124, v140
    v_mul_f32 v167, v125, v141
    v_mfma_f32_16x16x32_bf16 v[116:119], v[52:55], a[228:231], v[116:119]
    buffer_load_dwordx4 v[48:51], v186, s[48:51], s23 offen offset:3072 sc1
    v_mfma_f32_16x16x32_bf16 v[116:119], v[56:59], a[232:235], v[116:119]
    v_mul_f32 v168, v126, v142
    v_mul_f32 v169, v127, v143
    v_mfma_f32_16x16x32_bf16 v[116:119], v[60:63], a[236:239], v[116:119]
    v_fma_f32 v162, v162, v194, v194
    v_fma_f32 v163, v163, v194, v194
    s_waitcnt vmcnt(12)
    v_mfma_f32_16x16x32_bf16 v[88:91], v[64:67], a[24:27], v[88:91]
    v_fma_f32 v164, v164, v194, v194
    v_fma_f32 v165, v165, v194, v194
    v_mfma_f32_16x16x32_bf16 v[88:91], v[68:71], a[28:31], v[88:91]
    buffer_load_dwordx4 v[52:55], v187, s[48:51], s23 offen offset:0 sc1
    v_mfma_f32_16x16x32_bf16 v[88:91], v[72:75], a[32:35], v[88:91]
    v_rcp_f32 v162, v162
    v_mfma_f32_16x16x32_bf16 v[92:95], v[64:67], a[96:99], v[92:95]
    v_rcp_f32 v163, v163
    v_mfma_f32_16x16x32_bf16 v[92:95], v[68:71], a[100:103], v[92:95]
    v_rcp_f32 v164, v164
    v_mfma_f32_16x16x32_bf16 v[92:95], v[72:75], a[104:107], v[92:95]
    buffer_load_dwordx4 v[56:59], v187, s[48:51], s23 offen offset:1024 sc1
    v_mfma_f32_16x16x32_bf16 v[96:99], v[64:67], a[168:171], v[96:99]
    v_rcp_f32 v165, v165
    v_mfma_f32_16x16x32_bf16 v[96:99], v[68:71], a[172:175], v[96:99]
    v_mul_f32 v166, v166, v162
    v_mul_f32 v167, v167, v163
    v_mfma_f32_16x16x32_bf16 v[96:99], v[72:75], a[176:179], v[96:99]
    v_mul_f32 v168, v168, v164
    v_mul_f32 v169, v169, v165
    v_mfma_f32_16x16x32_bf16 v[100:103], v[64:67], a[240:243], v[100:103]
    buffer_load_dwordx4 v[60:63], v187, s[48:51], s23 offen offset:2048 sc1
    v_mfma_f32_16x16x32_bf16 v[100:103], v[68:71], a[244:247], v[100:103]
    v_cvt_pk_bf16_f32 v170, v166, v167
    v_cvt_pk_bf16_f32 v171, v168, v169
    v_mfma_f32_16x16x32_bf16 v[100:103], v[72:75], a[248:251], v[100:103]
    ds_write_b64 v12, v[170:171] offset:18432
    s_waitcnt vmcnt(12)
    v_mfma_f32_16x16x32_bf16 v[104:107], v[76:79], a[24:27], v[104:107]
    v_mul_f32 v152, v128, v128
    v_mul_f32 v153, v129, v129
    v_mfma_f32_16x16x32_bf16 v[104:107], v[80:83], a[28:31], v[104:107]
    buffer_load_dwordx4 v[64:67], v187, s[48:51], s23 offen offset:3072 sc1
    v_mfma_f32_16x16x32_bf16 v[104:107], v[84:87], a[32:35], v[104:107]
    v_mul_f32 v154, v130, v130
    v_mul_f32 v155, v131, v131
    v_mfma_f32_16x16x32_bf16 v[108:111], v[76:79], a[96:99], v[108:111]
    v_fma_f32 v152, v152, v13, v6
    v_fma_f32 v153, v153, v13, v6
    v_mfma_f32_16x16x32_bf16 v[108:111], v[80:83], a[100:103], v[108:111]
    v_fma_f32 v154, v154, v13, v6
    v_fma_f32 v155, v155, v13, v6
    v_mfma_f32_16x16x32_bf16 v[108:111], v[84:87], a[104:107], v[108:111]
    buffer_load_dwordx4 v[68:71], v188, s[48:51], s23 offen offset:0 sc1
    v_mfma_f32_16x16x32_bf16 v[112:115], v[76:79], a[168:171], v[112:115]
    v_mul_f32 v152, v128, v152
    v_mul_f32 v153, v129, v153
    v_mfma_f32_16x16x32_bf16 v[112:115], v[80:83], a[172:175], v[112:115]
    v_mul_f32 v154, v130, v154
    v_mul_f32 v155, v131, v155
    v_mfma_f32_16x16x32_bf16 v[112:115], v[84:87], a[176:179], v[112:115]
    v_exp_f32 v152, v152
    v_mfma_f32_16x16x32_bf16 v[116:119], v[76:79], a[240:243], v[116:119]
    buffer_load_dwordx4 v[72:75], v188, s[48:51], s23 offen offset:1024 sc1
    v_mfma_f32_16x16x32_bf16 v[116:119], v[80:83], a[244:247], v[116:119]
    v_exp_f32 v153, v153
    v_mfma_f32_16x16x32_bf16 v[116:119], v[84:87], a[248:251], v[116:119]
    v_exp_f32 v154, v154
    s_waitcnt vmcnt(12)
    v_mfma_f32_16x16x32_bf16 v[88:91], v[16:19], a[36:39], v[88:91]
    v_exp_f32 v155, v155
    v_mfma_f32_16x16x32_bf16 v[88:91], v[20:23], a[40:43], v[88:91]
    buffer_load_dwordx4 v[76:79], v188, s[48:51], s23 offen offset:2048 sc1
    v_mfma_f32_16x16x32_bf16 v[88:91], v[24:27], a[44:47], v[88:91]
    v_mul_f32 v156, v128, v144
    v_mul_f32 v157, v129, v145
    v_mfma_f32_16x16x32_bf16 v[92:95], v[16:19], a[108:111], v[92:95]
    v_mul_f32 v158, v130, v146
    v_mul_f32 v159, v131, v147
    v_mfma_f32_16x16x32_bf16 v[92:95], v[20:23], a[112:115], v[92:95]
    v_fma_f32 v152, v152, v195, v195
    v_fma_f32 v153, v153, v195, v195
    v_mfma_f32_16x16x32_bf16 v[92:95], v[24:27], a[116:119], v[92:95]
    buffer_load_dwordx4 v[80:83], v188, s[48:51], s23 offen offset:3072 sc1
    v_mfma_f32_16x16x32_bf16 v[96:99], v[16:19], a[180:183], v[96:99]
    v_fma_f32 v154, v154, v195, v195
    v_fma_f32 v155, v155, v195, v195
    v_mfma_f32_16x16x32_bf16 v[96:99], v[20:23], a[184:187], v[96:99]
    v_rcp_f32 v152, v152
    v_mfma_f32_16x16x32_bf16 v[96:99], v[24:27], a[188:191], v[96:99]
    v_rcp_f32 v153, v153
    v_mfma_f32_16x16x32_bf16 v[100:103], v[16:19], a[252:255], v[100:103]
    buffer_load_dwordx4 v[84:87], v189, s[48:51], s23 offen offset:0 sc1
    v_mfma_f32_16x16x32_bf16 v[100:103], v[20:23], v[220:223], v[100:103]
    v_rcp_f32 v154, v154
    v_mfma_f32_16x16x32_bf16 v[100:103], v[24:27], v[224:227], v[100:103]
    v_rcp_f32 v155, v155
    s_waitcnt vmcnt(12)
    v_mfma_f32_16x16x32_bf16 v[104:107], v[28:31], a[36:39], v[104:107]
    v_mul_f32 v156, v156, v152
    v_mul_f32 v157, v157, v153
    v_mfma_f32_16x16x32_bf16 v[104:107], v[32:35], a[40:43], v[104:107]
    buffer_load_dwordx4 v[16:19], v189, s[48:51], s23 offen offset:1024 sc1
    v_mfma_f32_16x16x32_bf16 v[104:107], v[36:39], a[44:47], v[104:107]
    v_mul_f32 v158, v158, v154
    v_mul_f32 v159, v159, v155
    v_mfma_f32_16x16x32_bf16 v[108:111], v[28:31], a[108:111], v[108:111]
    v_cvt_pk_bf16_f32 v160, v156, v157
    v_cvt_pk_bf16_f32 v161, v158, v159
    v_mfma_f32_16x16x32_bf16 v[108:111], v[32:35], a[112:115], v[108:111]
    ds_write_b64 v12, v[160:161] offset:36864
    v_mfma_f32_16x16x32_bf16 v[108:111], v[36:39], a[116:119], v[108:111]
    buffer_load_dwordx4 v[20:23], v189, s[48:51], s23 offen offset:2048 sc1
    v_mfma_f32_16x16x32_bf16 v[112:115], v[28:31], a[180:183], v[112:115]
    v_mul_f32 v162, v132, v132
    v_mul_f32 v163, v133, v133
    v_mfma_f32_16x16x32_bf16 v[112:115], v[32:35], a[184:187], v[112:115]
    v_mul_f32 v164, v134, v134
    v_mul_f32 v165, v135, v135
    v_mfma_f32_16x16x32_bf16 v[112:115], v[36:39], a[188:191], v[112:115]
    v_fma_f32 v162, v162, v14, v7
    v_fma_f32 v163, v163, v14, v7
    v_mfma_f32_16x16x32_bf16 v[116:119], v[28:31], a[252:255], v[116:119]
    buffer_load_dwordx4 v[24:27], v189, s[48:51], s23 offen offset:3072 sc1
    v_mfma_f32_16x16x32_bf16 v[116:119], v[32:35], v[220:223], v[116:119]
    v_fma_f32 v164, v164, v14, v7
    v_fma_f32 v165, v165, v14, v7
    v_mfma_f32_16x16x32_bf16 v[116:119], v[36:39], v[224:227], v[116:119]
    v_mul_f32 v162, v132, v162
    v_mul_f32 v163, v133, v163
    s_waitcnt vmcnt(12)
    v_mfma_f32_16x16x32_bf16 v[88:91], v[40:43], a[48:51], v[88:91]
    v_mul_f32 v164, v134, v164
    v_mul_f32 v165, v135, v165
    v_mfma_f32_16x16x32_bf16 v[88:91], v[44:47], a[52:55], v[88:91]
    buffer_load_dwordx4 v[28:31], v190, s[48:51], s23 offen offset:0 sc1
    v_mfma_f32_16x16x32_bf16 v[88:91], v[48:51], a[56:59], v[88:91]
    v_exp_f32 v162, v162
    v_mfma_f32_16x16x32_bf16 v[92:95], v[40:43], a[120:123], v[92:95]
    v_exp_f32 v163, v163
    v_mfma_f32_16x16x32_bf16 v[92:95], v[44:47], a[124:127], v[92:95]
    v_exp_f32 v164, v164
    v_mfma_f32_16x16x32_bf16 v[92:95], v[48:51], a[128:131], v[92:95]
    buffer_load_dwordx4 v[32:35], v190, s[48:51], s23 offen offset:1024 sc1
    v_mfma_f32_16x16x32_bf16 v[96:99], v[40:43], a[192:195], v[96:99]
    v_exp_f32 v165, v165
    v_mfma_f32_16x16x32_bf16 v[96:99], v[44:47], a[196:199], v[96:99]
    v_mul_f32 v166, v132, v148
    v_mul_f32 v167, v133, v149
    v_mfma_f32_16x16x32_bf16 v[96:99], v[48:51], a[200:203], v[96:99]
    v_mul_f32 v168, v134, v150
    v_mul_f32 v169, v135, v151
    v_mfma_f32_16x16x32_bf16 v[100:103], v[40:43], v[228:231], v[100:103]
    buffer_load_dwordx4 v[36:39], v190, s[48:51], s23 offen offset:2048 sc1
    v_mfma_f32_16x16x32_bf16 v[100:103], v[44:47], v[232:235], v[100:103]
    v_fma_f32 v162, v162, v252, v252
    v_fma_f32 v163, v163, v252, v252
    v_mfma_f32_16x16x32_bf16 v[100:103], v[48:51], v[236:239], v[100:103]
    v_fma_f32 v164, v164, v252, v252
    v_fma_f32 v165, v165, v252, v252
    s_waitcnt vmcnt(12)
    v_mfma_f32_16x16x32_bf16 v[104:107], v[52:55], a[48:51], v[104:107]
    v_rcp_f32 v162, v162
    v_mfma_f32_16x16x32_bf16 v[104:107], v[56:59], a[52:55], v[104:107]
    buffer_load_dwordx4 v[40:43], v190, s[48:51], s23 offen offset:3072 sc1
    v_mfma_f32_16x16x32_bf16 v[104:107], v[60:63], a[56:59], v[104:107]
    v_rcp_f32 v163, v163
    v_mfma_f32_16x16x32_bf16 v[108:111], v[52:55], a[120:123], v[108:111]
    v_rcp_f32 v164, v164
    v_mfma_f32_16x16x32_bf16 v[108:111], v[56:59], a[124:127], v[108:111]
    v_rcp_f32 v165, v165
    v_mfma_f32_16x16x32_bf16 v[108:111], v[60:63], a[128:131], v[108:111]
    buffer_load_dwordx4 v[44:47], v191, s[48:51], s23 offen offset:0 sc1
    v_mfma_f32_16x16x32_bf16 v[112:115], v[52:55], a[192:195], v[112:115]
    v_mul_f32 v166, v166, v162
    v_mul_f32 v167, v167, v163
    v_mfma_f32_16x16x32_bf16 v[112:115], v[56:59], a[196:199], v[112:115]
    v_mul_f32 v168, v168, v164
    v_mul_f32 v169, v169, v165
    v_mfma_f32_16x16x32_bf16 v[112:115], v[60:63], a[200:203], v[112:115]
    v_cvt_pk_bf16_f32 v170, v166, v167
    v_cvt_pk_bf16_f32 v171, v168, v169
    v_mfma_f32_16x16x32_bf16 v[116:119], v[52:55], v[228:231], v[116:119]
    buffer_load_dwordx4 v[48:51], v191, s[48:51], s23 offen offset:1024 sc1
    v_mfma_f32_16x16x32_bf16 v[116:119], v[56:59], v[232:235], v[116:119]
    ds_write_b64 v12, v[170:171] offset:55296
    v_mfma_f32_16x16x32_bf16 v[116:119], v[60:63], v[236:239], v[116:119]
    s_waitcnt vmcnt(12)
    v_mfma_f32_16x16x32_bf16 v[88:91], v[64:67], a[60:63], v[88:91]
    v_mfma_f32_16x16x32_bf16 v[88:91], v[68:71], a[64:67], v[88:91]
    buffer_load_dwordx4 v[52:55], v191, s[48:51], s23 offen offset:2048 sc1
    v_mfma_f32_16x16x32_bf16 v[120:123], v[72:75], a[68:71], v[88:91]
    v_mfma_f32_16x16x32_bf16 v[92:95], v[64:67], a[132:135], v[92:95]
    v_mfma_f32_16x16x32_bf16 v[92:95], v[68:71], a[136:139], v[92:95]
    v_mfma_f32_16x16x32_bf16 v[124:127], v[72:75], a[140:143], v[92:95]
    buffer_load_dwordx4 v[56:59], v191, s[48:51], s23 offen offset:3072 sc1
    v_mfma_f32_16x16x32_bf16 v[96:99], v[64:67], a[204:207], v[96:99]
    v_mfma_f32_16x16x32_bf16 v[96:99], v[68:71], a[208:211], v[96:99]
    v_mfma_f32_16x16x32_bf16 v[128:131], v[72:75], a[212:215], v[96:99]
    v_mfma_f32_16x16x32_bf16 v[100:103], v[64:67], v[240:243], v[100:103]
    buffer_load_dwordx4 v[60:63], v192, s[48:51], s23 offen offset:0 sc1
    v_mfma_f32_16x16x32_bf16 v[100:103], v[68:71], v[244:247], v[100:103]
    v_mfma_f32_16x16x32_bf16 v[132:135], v[72:75], v[248:251], v[100:103]
    s_waitcnt vmcnt(12)
    v_mfma_f32_16x16x32_bf16 v[104:107], v[76:79], a[60:63], v[104:107]
    v_mfma_f32_16x16x32_bf16 v[104:107], v[80:83], a[64:67], v[104:107]
    buffer_load_dwordx4 v[64:67], v192, s[48:51], s23 offen offset:1024 sc1
    v_mfma_f32_16x16x32_bf16 v[136:139], v[84:87], a[68:71], v[104:107]
    v_mfma_f32_16x16x32_bf16 v[108:111], v[76:79], a[132:135], v[108:111]
    v_mfma_f32_16x16x32_bf16 v[108:111], v[80:83], a[136:139], v[108:111]
    v_mfma_f32_16x16x32_bf16 v[140:143], v[84:87], a[140:143], v[108:111]
    buffer_load_dwordx4 v[68:71], v192, s[48:51], s23 offen offset:2048 sc1
    v_mfma_f32_16x16x32_bf16 v[112:115], v[76:79], a[204:207], v[112:115]
    v_mfma_f32_16x16x32_bf16 v[112:115], v[80:83], a[208:211], v[112:115]
    s_lshl_b32 s7, s25, 11
    v_mfma_f32_16x16x32_bf16 v[144:147], v[84:87], a[212:215], v[112:115]
    s_add_u32 s7, s7, s24
    v_mfma_f32_16x16x32_bf16 v[116:119], v[76:79], v[240:243], v[116:119]
    buffer_load_dwordx4 v[72:75], v192, s[48:51], s23 offen offset:3072 sc1
    v_mfma_f32_16x16x32_bf16 v[116:119], v[80:83], v[244:247], v[116:119]
    s_add_u32 s23, s23, 36864
    v_mfma_f32_16x16x32_bf16 v[148:151], v[84:87], v[248:251], v[116:119]
    v_add_u32 v12, s7, v184
    s_add_u32 s25, s25, 1
    s_cmp_lt_u32 s25, 9
    s_cbranch_scc1 L_ffn_gu_36
    v_add_u32 v10, 73728, v184
    v_add_u32 v11, 110592, v184
    s_waitcnt lgkmcnt(0)
    s_barrier
    v_pk_mul_f32 v[152:153], v[120:121], v[120:121]
    ds_read_b128 a[0:3], v10 offset:0
    v_pk_mul_f32 v[154:155], v[122:123], v[122:123]
    ds_read_b128 a[72:75], v10 offset:18432
    v_pk_fma_f32 v[152:153], v[152:153], v[8:9], v[4:5] op_sel:[0,0,0] op_sel_hi:[1,0,0]
    ds_read_b128 a[144:147], v11 offset:0
    v_pk_fma_f32 v[154:155], v[154:155], v[8:9], v[4:5] op_sel:[0,0,0] op_sel_hi:[1,0,0]
    v_pk_mul_f32 v[152:153], v[120:121], v[152:153]
    ds_read_b128 a[216:219], v11 offset:18432
    v_pk_mul_f32 v[154:155], v[122:123], v[154:155]
    ds_read_b128 a[4:7], v10 offset:1024
    buffer_load_dwordx4 v[76:79], v184, s[48:51], s23 offen offset:0 sc1
    v_exp_f32 v152, v152
    ds_read_b128 a[76:79], v10 offset:19456
    v_exp_f32 v153, v153
    v_exp_f32 v154, v154
    ds_read_b128 a[148:151], v11 offset:1024
    v_exp_f32 v155, v155
    ds_read_b128 a[220:223], v11 offset:19456
    v_pk_mul_f32 v[156:157], v[120:121], v[136:137]
    ds_read_b128 a[8:11], v10 offset:2048
    v_pk_mul_f32 v[158:159], v[122:123], v[138:139]
    buffer_load_dwordx4 v[80:83], v184, s[48:51], s23 offen offset:1024 sc1
    v_pk_fma_f32 v[152:153], v[152:153], v[192:193], v[192:193] op_sel:[0,1,1] op_sel_hi:[1,1,1]
    ds_read_b128 a[80:83], v10 offset:20480
    v_pk_fma_f32 v[154:155], v[154:155], v[192:193], v[192:193] op_sel:[0,1,1] op_sel_hi:[1,1,1]
    ds_read_b128 a[152:155], v11 offset:2048
    v_rcp_f32 v152, v152
    ds_read_b128 a[224:227], v11 offset:20480
    v_rcp_f32 v153, v153
    v_rcp_f32 v154, v154
    ds_read_b128 a[12:15], v10 offset:3072
    v_rcp_f32 v155, v155
    ds_read_b128 a[84:87], v10 offset:21504
    buffer_load_dwordx4 v[84:87], v184, s[48:51], s23 offen offset:2048 sc1
    s_nop 0
    ds_read_b128 a[156:159], v11 offset:3072
    v_pk_mul_f32 v[156:157], v[156:157], v[152:153]
    v_pk_mul_f32 v[158:159], v[158:159], v[154:155]
    ds_read_b128 a[228:231], v11 offset:21504
    v_cvt_pk_bf16_f32 v160, v156, v157
    ds_read_b128 a[16:19], v10 offset:4096
    v_cvt_pk_bf16_f32 v161, v158, v159
    ds_read_b128 a[88:91], v10 offset:22528
    ds_write_b64 v12, v[160:161] offset:0
    buffer_load_dwordx4 v[104:107], v184, s[48:51], s23 offen offset:3072 sc1
    v_pk_mul_f32 v[162:163], v[124:125], v[124:125]
    ds_read_b128 a[160:163], v11 offset:4096
    v_pk_mul_f32 v[164:165], v[126:127], v[126:127]
    ds_read_b128 a[232:235], v11 offset:22528
    v_pk_fma_f32 v[162:163], v[162:163], v[8:9], v[4:5] op_sel:[0,1,1] op_sel_hi:[1,1,1]
    ds_read_b128 a[20:23], v10 offset:5120
    v_pk_fma_f32 v[164:165], v[164:165], v[8:9], v[4:5] op_sel:[0,1,1] op_sel_hi:[1,1,1]
    v_pk_mul_f32 v[162:163], v[124:125], v[162:163]
    ds_read_b128 a[92:95], v10 offset:23552
    v_pk_mul_f32 v[164:165], v[126:127], v[164:165]
    ds_read_b128 a[164:167], v11 offset:5120
    buffer_load_dwordx4 v[108:111], v185, s[48:51], s23 offen offset:0 sc1
    v_exp_f32 v162, v162
    ds_read_b128 a[236:239], v11 offset:23552
    v_exp_f32 v163, v163
    v_exp_f32 v164, v164
    ds_read_b128 a[24:27], v10 offset:6144
    v_exp_f32 v165, v165
    ds_read_b128 a[96:99], v10 offset:24576
    v_pk_mul_f32 v[166:167], v[124:125], v[140:141]
    ds_read_b128 a[168:171], v11 offset:6144
    v_pk_mul_f32 v[168:169], v[126:127], v[142:143]
    buffer_load_dwordx4 v[112:115], v185, s[48:51], s23 offen offset:1024 sc1
    v_pk_fma_f32 v[162:163], v[162:163], v[194:195], v[194:195] op_sel:[0,0,0] op_sel_hi:[1,0,0]
    ds_read_b128 a[240:243], v11 offset:24576
    v_pk_fma_f32 v[164:165], v[164:165], v[194:195], v[194:195] op_sel:[0,0,0] op_sel_hi:[1,0,0]
    ds_read_b128 a[28:31], v10 offset:7168
    v_rcp_f32 v162, v162
    ds_read_b128 a[100:103], v10 offset:25600
    v_rcp_f32 v163, v163
    v_rcp_f32 v164, v164
    ds_read_b128 a[172:175], v11 offset:7168
    v_rcp_f32 v165, v165
    ds_read_b128 a[244:247], v11 offset:25600
    buffer_load_dwordx4 v[116:119], v185, s[48:51], s23 offen offset:2048 sc1
    s_nop 0
    ds_read_b128 a[32:35], v10 offset:8192
    v_pk_mul_f32 v[166:167], v[166:167], v[162:163]
    v_pk_mul_f32 v[168:169], v[168:169], v[164:165]
    ds_read_b128 a[104:107], v10 offset:26624
    v_cvt_pk_bf16_f32 v170, v166, v167
    ds_read_b128 a[176:179], v11 offset:8192
    v_cvt_pk_bf16_f32 v171, v168, v169
    ds_read_b128 a[248:251], v11 offset:26624
    ds_write_b64 v12, v[170:171] offset:18432
    buffer_load_dwordx4 v[172:175], v185, s[48:51], s23 offen offset:3072 sc1
    v_pk_mul_f32 v[152:153], v[128:129], v[128:129]
    ds_read_b128 a[36:39], v10 offset:9216
    v_pk_mul_f32 v[154:155], v[130:131], v[130:131]
    ds_read_b128 a[108:111], v10 offset:27648
    v_pk_fma_f32 v[152:153], v[152:153], v[12:13], v[6:7] op_sel:[0,1,0] op_sel_hi:[1,1,0]
    ds_read_b128 a[180:183], v11 offset:9216
    v_pk_fma_f32 v[154:155], v[154:155], v[12:13], v[6:7] op_sel:[0,1,0] op_sel_hi:[1,1,0]
    v_pk_mul_f32 v[152:153], v[128:129], v[152:153]
    ds_read_b128 a[252:255], v11 offset:27648
    v_pk_mul_f32 v[154:155], v[130:131], v[154:155]
    ds_read_b128 a[40:43], v10 offset:10240
    buffer_load_dwordx4 v[176:179], v186, s[48:51], s23 offen offset:0 sc1
    v_exp_f32 v152, v152
    ds_read_b128 a[112:115], v10 offset:28672
    v_exp_f32 v153, v153
    v_exp_f32 v154, v154
    ds_read_b128 a[184:187], v11 offset:10240
    v_exp_f32 v155, v155
    ds_read_b128 v[220:223], v11 offset:28672
    v_pk_mul_f32 v[156:157], v[128:129], v[144:145]
    ds_read_b128 a[44:47], v10 offset:11264
    v_pk_mul_f32 v[158:159], v[130:131], v[146:147]
    buffer_load_dwordx4 v[180:183], v186, s[48:51], s23 offen offset:1024 sc1
    v_pk_fma_f32 v[152:153], v[152:153], v[194:195], v[194:195] op_sel:[0,1,1] op_sel_hi:[1,1,1]
    ds_read_b128 a[116:119], v10 offset:29696
    v_pk_fma_f32 v[154:155], v[154:155], v[194:195], v[194:195] op_sel:[0,1,1] op_sel_hi:[1,1,1]
    ds_read_b128 a[188:191], v11 offset:11264
    v_rcp_f32 v152, v152
    ds_read_b128 v[224:227], v11 offset:29696
    v_rcp_f32 v153, v153
    v_rcp_f32 v154, v154
    ds_read_b128 a[48:51], v10 offset:12288
    v_rcp_f32 v155, v155
    ds_read_b128 a[120:123], v10 offset:30720
    buffer_load_dwordx4 v[196:199], v186, s[48:51], s23 offen offset:2048 sc1
    s_nop 0
    ds_read_b128 a[192:195], v11 offset:12288
    v_pk_mul_f32 v[156:157], v[156:157], v[152:153]
    v_pk_mul_f32 v[158:159], v[158:159], v[154:155]
    ds_read_b128 v[228:231], v11 offset:30720
    v_cvt_pk_bf16_f32 v160, v156, v157
    ds_read_b128 a[52:55], v10 offset:13312
    v_cvt_pk_bf16_f32 v161, v158, v159
    ds_read_b128 a[124:127], v10 offset:31744
    ds_write_b64 v12, v[160:161] offset:36864
    buffer_load_dwordx4 v[200:203], v186, s[48:51], s23 offen offset:3072 sc1
    v_pk_mul_f32 v[162:163], v[132:133], v[132:133]
    ds_read_b128 a[196:199], v11 offset:13312
    v_pk_mul_f32 v[164:165], v[134:135], v[134:135]
    ds_read_b128 v[232:235], v11 offset:31744
    v_pk_fma_f32 v[162:163], v[162:163], v[14:15], v[6:7] op_sel:[0,0,1] op_sel_hi:[1,0,1]
    ds_read_b128 a[56:59], v10 offset:14336
    v_pk_fma_f32 v[164:165], v[164:165], v[14:15], v[6:7] op_sel:[0,0,1] op_sel_hi:[1,0,1]
    v_pk_mul_f32 v[162:163], v[132:133], v[162:163]
    ds_read_b128 a[128:131], v10 offset:32768
    v_pk_mul_f32 v[164:165], v[134:135], v[164:165]
    ds_read_b128 a[200:203], v11 offset:14336
    buffer_load_dwordx4 v[204:207], v187, s[48:51], s23 offen offset:0 sc1
    v_exp_f32 v162, v162
    ds_read_b128 v[236:239], v11 offset:32768
    v_exp_f32 v163, v163
    v_exp_f32 v164, v164
    ds_read_b128 a[60:63], v10 offset:15360
    v_exp_f32 v165, v165
    ds_read_b128 a[132:135], v10 offset:33792
    v_pk_mul_f32 v[166:167], v[132:133], v[148:149]
    ds_read_b128 a[204:207], v11 offset:15360
    v_pk_mul_f32 v[168:169], v[134:135], v[150:151]
    buffer_load_dwordx4 v[208:211], v187, s[48:51], s23 offen offset:1024 sc1
    v_pk_fma_f32 v[162:163], v[162:163], v[252:253], v[252:253] op_sel:[0,0,0] op_sel_hi:[1,0,0]
    ds_read_b128 v[240:243], v11 offset:33792
    v_pk_fma_f32 v[164:165], v[164:165], v[252:253], v[252:253] op_sel:[0,0,0] op_sel_hi:[1,0,0]
    v_rcp_f32 v162, v162
    v_rcp_f32 v163, v163
    v_rcp_f32 v164, v164
    v_rcp_f32 v165, v165
    buffer_load_dwordx4 v[212:215], v187, s[48:51], s23 offen offset:2048 sc1
    s_nop 0
    v_pk_mul_f32 v[166:167], v[166:167], v[162:163]
    v_pk_mul_f32 v[168:169], v[168:169], v[164:165]
    v_cvt_pk_bf16_f32 v170, v166, v167
    v_cvt_pk_bf16_f32 v171, v168, v169
    ds_write_b64 v12, v[170:171] offset:55296
    buffer_load_dwordx4 v[216:219], v187, s[48:51], s23 offen offset:3072 sc1
    buffer_load_dwordx4 v[136:139], v188, s[48:51], s23 offen offset:0 sc1
    buffer_load_dwordx4 v[140:143], v188, s[48:51], s23 offen offset:1024 sc1
    s_add_u32 s23, s23, 18432
    v_bfe_u32 v1, v0, 3, 2
    s_mov_b32 s7, 73728
    v_mul_lo_u32 v2, v1, s7
    v_lshrrev_b32 v1, 5, v0
    v_lshl_add_u32 v2, v1, 7, v2
    v_and_b32 v1, 7, v0
    v_lshl_add_u32 v2, v1, 4, v2
    v_add_u32 v3, 294912, v2
    s_mul_i32 s26, s41, 589824
    s_mul_i32 s7, s40, 9216
    s_add_u32 s26, s26, s7
    s_mul_i32 s7, s3, 2304
    s_add_u32 s26, s26, s7
    s_add_u32 s26, s26, 19922944
    s_add_u32 s27, s26, 2048
    s_waitcnt lgkmcnt(0)
    s_barrier
    ds_read_b128 a[64:67], v10 offset:16384
    ds_read_b128 a[136:139], v10 offset:34816
    ds_read_b128 a[208:211], v11 offset:16384
    ds_read_b128 v[244:247], v11 offset:34816
    ds_read_b128 a[68:71], v10 offset:17408
    ds_read_b128 a[140:143], v10 offset:35840
    ds_read_b128 a[212:215], v11 offset:17408
    ds_read_b128 v[248:251], v11 offset:35840
    s_mov_b32 s25, 0
    s_waitcnt lgkmcnt(0)
    s_branch L_ffn_dn_mid_38
L_ffn_dn_37:
    s_waitcnt vmcnt(32)
    v_mfma_f32_16x16x32_bf16 v[88:91], v[104:107], a[0:3], 0
    v_mfma_f32_16x16x32_bf16 v[88:91], v[108:111], a[4:7], v[88:91]
    buffer_load_dwordx4 v[76:79], v184, s[48:51], s23 offen offset:0 sc1
    v_mfma_f32_16x16x32_bf16 v[88:91], v[112:115], a[8:11], v[88:91]
    v_mfma_f32_16x16x32_bf16 v[92:95], v[104:107], a[72:75], 0
    v_mfma_f32_16x16x32_bf16 v[92:95], v[108:111], a[76:79], v[92:95]
    v_mfma_f32_16x16x32_bf16 v[92:95], v[112:115], a[80:83], v[92:95]
    buffer_load_dwordx4 v[80:83], v184, s[48:51], s23 offen offset:1024 sc1
    v_mfma_f32_16x16x32_bf16 v[96:99], v[104:107], a[144:147], 0
    v_cvt_pk_bf16_f32 v152, v120, v121
    v_cvt_pk_bf16_f32 v153, v122, v123
    v_mfma_f32_16x16x32_bf16 v[96:99], v[108:111], a[148:151], v[96:99]
    v_cvt_pk_bf16_f32 v154, v124, v125
    v_cvt_pk_bf16_f32 v155, v126, v127
    v_mfma_f32_16x16x32_bf16 v[96:99], v[112:115], a[152:155], v[96:99]
    v_cvt_pk_bf16_f32 v156, v128, v129
    v_cvt_pk_bf16_f32 v157, v130, v131
    v_mfma_f32_16x16x32_bf16 v[100:103], v[104:107], a[216:219], 0
    buffer_load_dwordx4 v[84:87], v184, s[48:51], s23 offen offset:2048 sc1
    v_mfma_f32_16x16x32_bf16 v[100:103], v[108:111], a[220:223], v[100:103]
    v_cvt_pk_bf16_f32 v158, v132, v133
    v_cvt_pk_bf16_f32 v159, v134, v135
    v_mfma_f32_16x16x32_bf16 v[100:103], v[112:115], a[224:227], v[100:103]
    v_permlane16_swap_b32 v152, v154
    s_waitcnt vmcnt(32)
    v_mfma_f32_16x16x32_bf16 v[88:91], v[116:119], a[12:15], v[88:91]
    v_permlane16_swap_b32 v153, v155
    v_mfma_f32_16x16x32_bf16 v[88:91], v[172:175], a[16:19], v[88:91]
    buffer_load_dwordx4 v[104:107], v184, s[48:51], s23 offen offset:3072 sc1
    v_mfma_f32_16x16x32_bf16 v[88:91], v[176:179], a[20:23], v[88:91]
    v_permlane16_swap_b32 v156, v158
    v_mfma_f32_16x16x32_bf16 v[92:95], v[116:119], a[84:87], v[92:95]
    v_permlane16_swap_b32 v157, v159
    v_mfma_f32_16x16x32_bf16 v[92:95], v[172:175], a[88:91], v[92:95]
    buffer_store_dwordx4 v[152:155], v2, s[8:11], s27 offen sc1
    v_mfma_f32_16x16x32_bf16 v[92:95], v[176:179], a[92:95], v[92:95]
    buffer_load_dwordx4 v[108:111], v185, s[48:51], s23 offen offset:0 sc1
    v_mfma_f32_16x16x32_bf16 v[96:99], v[116:119], a[156:159], v[96:99]
    buffer_store_dwordx4 v[156:159], v3, s[8:11], s27 offen sc1
    v_mfma_f32_16x16x32_bf16 v[96:99], v[172:175], a[160:163], v[96:99]
    v_mfma_f32_16x16x32_bf16 v[96:99], v[176:179], a[164:167], v[96:99]
    v_mfma_f32_16x16x32_bf16 v[100:103], v[116:119], a[228:231], v[100:103]
    buffer_load_dwordx4 v[112:115], v185, s[48:51], s23 offen offset:1024 sc1
    v_mfma_f32_16x16x32_bf16 v[100:103], v[172:175], a[232:235], v[100:103]
    v_mfma_f32_16x16x32_bf16 v[100:103], v[176:179], a[236:239], v[100:103]
    s_waitcnt vmcnt(34)
    v_mfma_f32_16x16x32_bf16 v[88:91], v[180:183], a[24:27], v[88:91]
    v_mfma_f32_16x16x32_bf16 v[88:91], v[196:199], a[28:31], v[88:91]
    buffer_load_dwordx4 v[116:119], v185, s[48:51], s23 offen offset:2048 sc1
    v_mfma_f32_16x16x32_bf16 v[88:91], v[200:203], a[32:35], v[88:91]
    v_mfma_f32_16x16x32_bf16 v[92:95], v[180:183], a[96:99], v[92:95]
    v_mfma_f32_16x16x32_bf16 v[92:95], v[196:199], a[100:103], v[92:95]
    v_mfma_f32_16x16x32_bf16 v[92:95], v[200:203], a[104:107], v[92:95]
    buffer_load_dwordx4 v[172:175], v185, s[48:51], s23 offen offset:3072 sc1
    v_mfma_f32_16x16x32_bf16 v[96:99], v[180:183], a[168:171], v[96:99]
    v_mfma_f32_16x16x32_bf16 v[96:99], v[196:199], a[172:175], v[96:99]
    v_mfma_f32_16x16x32_bf16 v[96:99], v[200:203], a[176:179], v[96:99]
    v_mfma_f32_16x16x32_bf16 v[100:103], v[180:183], a[240:243], v[100:103]
    buffer_load_dwordx4 v[176:179], v186, s[48:51], s23 offen offset:0 sc1
    v_mfma_f32_16x16x32_bf16 v[100:103], v[196:199], a[244:247], v[100:103]
    v_mfma_f32_16x16x32_bf16 v[100:103], v[200:203], a[248:251], v[100:103]
    s_waitcnt vmcnt(34)
    v_mfma_f32_16x16x32_bf16 v[88:91], v[204:207], a[36:39], v[88:91]
    v_mfma_f32_16x16x32_bf16 v[88:91], v[208:211], a[40:43], v[88:91]
    buffer_load_dwordx4 v[180:183], v186, s[48:51], s23 offen offset:1024 sc1
    v_mfma_f32_16x16x32_bf16 v[88:91], v[212:215], a[44:47], v[88:91]
    v_mfma_f32_16x16x32_bf16 v[92:95], v[204:207], a[108:111], v[92:95]
    v_mfma_f32_16x16x32_bf16 v[92:95], v[208:211], a[112:115], v[92:95]
    v_mfma_f32_16x16x32_bf16 v[92:95], v[212:215], a[116:119], v[92:95]
    buffer_load_dwordx4 v[196:199], v186, s[48:51], s23 offen offset:2048 sc1
    v_mfma_f32_16x16x32_bf16 v[96:99], v[204:207], a[180:183], v[96:99]
    v_mfma_f32_16x16x32_bf16 v[96:99], v[208:211], a[184:187], v[96:99]
    v_mfma_f32_16x16x32_bf16 v[96:99], v[212:215], a[188:191], v[96:99]
    v_mfma_f32_16x16x32_bf16 v[100:103], v[204:207], a[252:255], v[100:103]
    buffer_load_dwordx4 v[200:203], v186, s[48:51], s23 offen offset:3072 sc1
    v_mfma_f32_16x16x32_bf16 v[100:103], v[208:211], v[220:223], v[100:103]
    v_mfma_f32_16x16x32_bf16 v[100:103], v[212:215], v[224:227], v[100:103]
    s_waitcnt vmcnt(34)
    v_mfma_f32_16x16x32_bf16 v[88:91], v[216:219], a[48:51], v[88:91]
    v_mfma_f32_16x16x32_bf16 v[88:91], v[136:139], a[52:55], v[88:91]
    buffer_load_dwordx4 v[204:207], v187, s[48:51], s23 offen offset:0 sc1
    v_mfma_f32_16x16x32_bf16 v[88:91], v[140:143], a[56:59], v[88:91]
    v_mfma_f32_16x16x32_bf16 v[92:95], v[216:219], a[120:123], v[92:95]
    v_mfma_f32_16x16x32_bf16 v[92:95], v[136:139], a[124:127], v[92:95]
    v_mfma_f32_16x16x32_bf16 v[92:95], v[140:143], a[128:131], v[92:95]
    buffer_load_dwordx4 v[208:211], v187, s[48:51], s23 offen offset:1024 sc1
    v_mfma_f32_16x16x32_bf16 v[96:99], v[216:219], a[192:195], v[96:99]
    v_mfma_f32_16x16x32_bf16 v[96:99], v[136:139], a[196:199], v[96:99]
    v_mfma_f32_16x16x32_bf16 v[96:99], v[140:143], a[200:203], v[96:99]
    v_mfma_f32_16x16x32_bf16 v[100:103], v[216:219], v[228:231], v[100:103]
    buffer_load_dwordx4 v[212:215], v187, s[48:51], s23 offen offset:2048 sc1
    v_mfma_f32_16x16x32_bf16 v[100:103], v[136:139], v[232:235], v[100:103]
    v_mfma_f32_16x16x32_bf16 v[100:103], v[140:143], v[236:239], v[100:103]
    s_waitcnt vmcnt(34)
    v_mfma_f32_16x16x32_bf16 v[88:91], v[144:147], a[60:63], v[88:91]
    v_mfma_f32_16x16x32_bf16 v[88:91], v[148:151], a[64:67], v[88:91]
    buffer_load_dwordx4 v[216:219], v187, s[48:51], s23 offen offset:3072 sc1
    v_mfma_f32_16x16x32_bf16 v[120:123], v[160:163], a[68:71], v[88:91]
    v_mfma_f32_16x16x32_bf16 v[92:95], v[144:147], a[132:135], v[92:95]
    v_mfma_f32_16x16x32_bf16 v[92:95], v[148:151], a[136:139], v[92:95]
    v_mfma_f32_16x16x32_bf16 v[124:127], v[160:163], a[140:143], v[92:95]
    buffer_load_dwordx4 v[136:139], v188, s[48:51], s23 offen offset:0 sc1
    v_mfma_f32_16x16x32_bf16 v[96:99], v[144:147], a[204:207], v[96:99]
    s_lshl_b32 s7, s25, 8
    v_mfma_f32_16x16x32_bf16 v[96:99], v[148:151], a[208:211], v[96:99]
    s_add_u32 s27, s26, s7
    v_mfma_f32_16x16x32_bf16 v[128:131], v[160:163], a[212:215], v[96:99]
    s_add_u32 s25, s25, 1
    v_mfma_f32_16x16x32_bf16 v[100:103], v[144:147], v[240:243], v[100:103]
    buffer_load_dwordx4 v[140:143], v188, s[48:51], s23 offen offset:1024 sc1
    v_mfma_f32_16x16x32_bf16 v[100:103], v[148:151], v[244:247], v[100:103]
    s_add_u32 s23, s23, 18432
    v_mfma_f32_16x16x32_bf16 v[132:135], v[160:163], v[248:251], v[100:103]
L_ffn_dn_mid_38:
    s_waitcnt vmcnt(30)
    v_mfma_f32_16x16x32_bf16 v[88:91], v[16:19], a[0:3], 0
    v_mfma_f32_16x16x32_bf16 v[88:91], v[20:23], a[4:7], v[88:91]
    buffer_load_dwordx4 v[144:147], v184, s[48:51], s23 offen offset:0 sc1
    v_mfma_f32_16x16x32_bf16 v[88:91], v[24:27], a[8:11], v[88:91]
    v_mfma_f32_16x16x32_bf16 v[92:95], v[16:19], a[72:75], 0
    v_mfma_f32_16x16x32_bf16 v[92:95], v[20:23], a[76:79], v[92:95]
    v_mfma_f32_16x16x32_bf16 v[92:95], v[24:27], a[80:83], v[92:95]
    buffer_load_dwordx4 v[148:151], v184, s[48:51], s23 offen offset:1024 sc1
    v_mfma_f32_16x16x32_bf16 v[96:99], v[16:19], a[144:147], 0
    v_cvt_pk_bf16_f32 v152, v120, v121
    v_cvt_pk_bf16_f32 v153, v122, v123
    v_mfma_f32_16x16x32_bf16 v[96:99], v[20:23], a[148:151], v[96:99]
    v_cvt_pk_bf16_f32 v154, v124, v125
    v_cvt_pk_bf16_f32 v155, v126, v127
    v_mfma_f32_16x16x32_bf16 v[96:99], v[24:27], a[152:155], v[96:99]
    v_cvt_pk_bf16_f32 v156, v128, v129
    v_cvt_pk_bf16_f32 v157, v130, v131
    v_mfma_f32_16x16x32_bf16 v[100:103], v[16:19], a[216:219], 0
    buffer_load_dwordx4 v[160:163], v184, s[48:51], s23 offen offset:2048 sc1
    v_mfma_f32_16x16x32_bf16 v[100:103], v[20:23], a[220:223], v[100:103]
    v_cvt_pk_bf16_f32 v158, v132, v133
    v_cvt_pk_bf16_f32 v159, v134, v135
    v_mfma_f32_16x16x32_bf16 v[100:103], v[24:27], a[224:227], v[100:103]
    v_permlane16_swap_b32 v152, v154
    s_waitcnt vmcnt(30)
    v_mfma_f32_16x16x32_bf16 v[88:91], v[28:31], a[12:15], v[88:91]
    v_permlane16_swap_b32 v153, v155
    v_mfma_f32_16x16x32_bf16 v[88:91], v[32:35], a[16:19], v[88:91]
    buffer_load_dwordx4 v[16:19], v184, s[48:51], s23 offen offset:3072 sc1
    v_mfma_f32_16x16x32_bf16 v[88:91], v[36:39], a[20:23], v[88:91]
    v_permlane16_swap_b32 v156, v158
    v_mfma_f32_16x16x32_bf16 v[92:95], v[28:31], a[84:87], v[92:95]
    v_permlane16_swap_b32 v157, v159
    v_mfma_f32_16x16x32_bf16 v[92:95], v[32:35], a[88:91], v[92:95]
    buffer_store_dwordx4 v[152:155], v2, s[8:11], s27 offen sc1
    v_mfma_f32_16x16x32_bf16 v[92:95], v[36:39], a[92:95], v[92:95]
    buffer_load_dwordx4 v[20:23], v185, s[48:51], s23 offen offset:0 sc1
    v_mfma_f32_16x16x32_bf16 v[96:99], v[28:31], a[156:159], v[96:99]
    buffer_store_dwordx4 v[156:159], v3, s[8:11], s27 offen sc1
    v_mfma_f32_16x16x32_bf16 v[96:99], v[32:35], a[160:163], v[96:99]
    v_mfma_f32_16x16x32_bf16 v[96:99], v[36:39], a[164:167], v[96:99]
    v_mfma_f32_16x16x32_bf16 v[100:103], v[28:31], a[228:231], v[100:103]
    buffer_load_dwordx4 v[24:27], v185, s[48:51], s23 offen offset:1024 sc1
    v_mfma_f32_16x16x32_bf16 v[100:103], v[32:35], a[232:235], v[100:103]
    v_mfma_f32_16x16x32_bf16 v[100:103], v[36:39], a[236:239], v[100:103]
    s_waitcnt vmcnt(32)
    v_mfma_f32_16x16x32_bf16 v[88:91], v[40:43], a[24:27], v[88:91]
    v_mfma_f32_16x16x32_bf16 v[88:91], v[44:47], a[28:31], v[88:91]
    buffer_load_dwordx4 v[28:31], v185, s[48:51], s23 offen offset:2048 sc1
    v_mfma_f32_16x16x32_bf16 v[88:91], v[48:51], a[32:35], v[88:91]
    v_mfma_f32_16x16x32_bf16 v[92:95], v[40:43], a[96:99], v[92:95]
    v_mfma_f32_16x16x32_bf16 v[92:95], v[44:47], a[100:103], v[92:95]
    v_mfma_f32_16x16x32_bf16 v[92:95], v[48:51], a[104:107], v[92:95]
    buffer_load_dwordx4 v[32:35], v185, s[48:51], s23 offen offset:3072 sc1
    v_mfma_f32_16x16x32_bf16 v[96:99], v[40:43], a[168:171], v[96:99]
    v_mfma_f32_16x16x32_bf16 v[96:99], v[44:47], a[172:175], v[96:99]
    v_mfma_f32_16x16x32_bf16 v[96:99], v[48:51], a[176:179], v[96:99]
    v_mfma_f32_16x16x32_bf16 v[100:103], v[40:43], a[240:243], v[100:103]
    buffer_load_dwordx4 v[36:39], v186, s[48:51], s23 offen offset:0 sc1
    v_mfma_f32_16x16x32_bf16 v[100:103], v[44:47], a[244:247], v[100:103]
    v_mfma_f32_16x16x32_bf16 v[100:103], v[48:51], a[248:251], v[100:103]
    s_waitcnt vmcnt(32)
    v_mfma_f32_16x16x32_bf16 v[88:91], v[52:55], a[36:39], v[88:91]
    v_mfma_f32_16x16x32_bf16 v[88:91], v[56:59], a[40:43], v[88:91]
    buffer_load_dwordx4 v[40:43], v186, s[48:51], s23 offen offset:1024 sc1
    v_mfma_f32_16x16x32_bf16 v[88:91], v[60:63], a[44:47], v[88:91]
    v_mfma_f32_16x16x32_bf16 v[92:95], v[52:55], a[108:111], v[92:95]
    v_mfma_f32_16x16x32_bf16 v[92:95], v[56:59], a[112:115], v[92:95]
    v_mfma_f32_16x16x32_bf16 v[92:95], v[60:63], a[116:119], v[92:95]
    buffer_load_dwordx4 v[44:47], v186, s[48:51], s23 offen offset:2048 sc1
    v_mfma_f32_16x16x32_bf16 v[96:99], v[52:55], a[180:183], v[96:99]
    v_mfma_f32_16x16x32_bf16 v[96:99], v[56:59], a[184:187], v[96:99]
    v_mfma_f32_16x16x32_bf16 v[96:99], v[60:63], a[188:191], v[96:99]
    v_mfma_f32_16x16x32_bf16 v[100:103], v[52:55], a[252:255], v[100:103]
    buffer_load_dwordx4 v[48:51], v186, s[48:51], s23 offen offset:3072 sc1
    v_mfma_f32_16x16x32_bf16 v[100:103], v[56:59], v[220:223], v[100:103]
    v_mfma_f32_16x16x32_bf16 v[100:103], v[60:63], v[224:227], v[100:103]
    s_waitcnt vmcnt(32)
    v_mfma_f32_16x16x32_bf16 v[88:91], v[64:67], a[48:51], v[88:91]
    v_mfma_f32_16x16x32_bf16 v[88:91], v[68:71], a[52:55], v[88:91]
    buffer_load_dwordx4 v[52:55], v187, s[48:51], s23 offen offset:0 sc1
    v_mfma_f32_16x16x32_bf16 v[88:91], v[72:75], a[56:59], v[88:91]
    v_mfma_f32_16x16x32_bf16 v[92:95], v[64:67], a[120:123], v[92:95]
    v_mfma_f32_16x16x32_bf16 v[92:95], v[68:71], a[124:127], v[92:95]
    v_mfma_f32_16x16x32_bf16 v[92:95], v[72:75], a[128:131], v[92:95]
    buffer_load_dwordx4 v[56:59], v187, s[48:51], s23 offen offset:1024 sc1
    v_mfma_f32_16x16x32_bf16 v[96:99], v[64:67], a[192:195], v[96:99]
    v_mfma_f32_16x16x32_bf16 v[96:99], v[68:71], a[196:199], v[96:99]
    v_mfma_f32_16x16x32_bf16 v[96:99], v[72:75], a[200:203], v[96:99]
    v_mfma_f32_16x16x32_bf16 v[100:103], v[64:67], v[228:231], v[100:103]
    buffer_load_dwordx4 v[60:63], v187, s[48:51], s23 offen offset:2048 sc1
    v_mfma_f32_16x16x32_bf16 v[100:103], v[68:71], v[232:235], v[100:103]
    v_mfma_f32_16x16x32_bf16 v[100:103], v[72:75], v[236:239], v[100:103]
    s_waitcnt vmcnt(32)
    v_mfma_f32_16x16x32_bf16 v[88:91], v[76:79], a[60:63], v[88:91]
    v_mfma_f32_16x16x32_bf16 v[88:91], v[80:83], a[64:67], v[88:91]
    buffer_load_dwordx4 v[64:67], v187, s[48:51], s23 offen offset:3072 sc1
    v_mfma_f32_16x16x32_bf16 v[120:123], v[84:87], a[68:71], v[88:91]
    v_mfma_f32_16x16x32_bf16 v[92:95], v[76:79], a[132:135], v[92:95]
    v_mfma_f32_16x16x32_bf16 v[92:95], v[80:83], a[136:139], v[92:95]
    v_mfma_f32_16x16x32_bf16 v[124:127], v[84:87], a[140:143], v[92:95]
    buffer_load_dwordx4 v[68:71], v188, s[48:51], s23 offen offset:0 sc1
    v_mfma_f32_16x16x32_bf16 v[96:99], v[76:79], a[204:207], v[96:99]
    s_lshl_b32 s7, s25, 8
    v_mfma_f32_16x16x32_bf16 v[96:99], v[80:83], a[208:211], v[96:99]
    s_add_u32 s27, s26, s7
    v_mfma_f32_16x16x32_bf16 v[128:131], v[84:87], a[212:215], v[96:99]
    s_add_u32 s25, s25, 1
    v_mfma_f32_16x16x32_bf16 v[100:103], v[76:79], v[240:243], v[100:103]
    buffer_load_dwordx4 v[72:75], v188, s[48:51], s23 offen offset:1024 sc1
    v_mfma_f32_16x16x32_bf16 v[100:103], v[80:83], v[244:247], v[100:103]
    s_add_u32 s23, s23, 18432
    v_mfma_f32_16x16x32_bf16 v[132:135], v[84:87], v[248:251], v[100:103]
    s_cmp_lt_u32 s25, 9
    s_cbranch_scc1 L_ffn_dn_37
    s_nop 7
    v_cvt_pk_bf16_f32 v152, v120, v121
    v_cvt_pk_bf16_f32 v153, v122, v123
    v_cvt_pk_bf16_f32 v154, v124, v125
    v_cvt_pk_bf16_f32 v155, v126, v127
    v_cvt_pk_bf16_f32 v156, v128, v129
    v_cvt_pk_bf16_f32 v157, v130, v131
    v_cvt_pk_bf16_f32 v158, v132, v133
    v_cvt_pk_bf16_f32 v159, v134, v135
    s_nop 1
    v_permlane16_swap_b32 v152, v154
    v_permlane16_swap_b32 v153, v155
    v_permlane16_swap_b32 v156, v158
    v_permlane16_swap_b32 v157, v159
    buffer_store_dwordx4 v[152:155], v2, s[8:11], s27 offen sc1
    buffer_store_dwordx4 v[156:159], v3, s[8:11], s27 offen sc1
    v_lshlrev_b32 v15, 7, v0
    s_lshl_b32 s6, s40, 2
    s_add_u32 s6, s6, s44
    s_add_u32 s6, s6, 65536
    v_mov_b32 v1, s76
    s_mov_b64 vcc, 0xff
    s_waitcnt vmcnt(0)
    s_barrier
    s_cmp_lg_u32 s3, 0
    s_cbranch_scc1 L_pub_39
    s_mov_b64 exec, vcc
    buffer_store_dword v1, v15, s[8:11], s6 offen sc1
L_pub_39:
    s_mov_b64 exec, -1
    s_mov_b32 s16, 0xffff0000
    s_lshl_b32 s7, s3, 10
    v_lshl_add_u32 v2, v0, 4, s7
    v_add_u32 v3, 4096, v2
    v_and_b32 v8, 7, v0
    v_mul_u32_u24 v8, 1152, v8
    v_lshrrev_b32 v9, 3, v0
    v_lshl_add_u32 v8, v9, 4, v8
    s_lshl_b32 s7, s3, 7
    v_add_u32 v5, s7, v8
    v_add_u32 v6, 512, v5
    s_cmp_eq_u32 s3, 0
    s_mov_b32 s17, 1073741824
    s_cmov_b32 s17, 8192
    v_add_u32 v4, s17, v2
    s_mov_b32 s17, 1073741824
    s_cmov_b32 s17, 1024
    v_add_u32 v7, s17, v5
    s_lshl_b32 s21, s41, 3
    s_add_u32 s21, s21, s40
    s_mul_i32 s18, s21, 9216
    s_add_u32 s19, s18, s43
    s_add_u32 s22, s19, 45875200
    s_mul_i32 s20, s21, 73728
    s_add_u32 s20, s20, 19922944
    s_lshl_b32 s23, s21, 5
    s_add_u32 s23, s23, s43
    s_add_u32 s23, s23, 48431104
    v_and_b32 v8, 7, v0
    v_lshlrev_b32 v8, 2, v8
    buffer_load_dword v10, v8, s[8:11], s23 offen sc1
    buffer_load_dwordx4 v[16:19], v2, s[8:11], s22 offen sc1
    buffer_load_dwordx4 v[20:23], v3, s[8:11], s22 offen sc1
    buffer_load_dwordx4 v[24:27], v4, s[8:11], s22 offen sc1
    s_cmp_lg_u32 s3, 0
    s_cbranch_scc1 L_pollout_42
    s_lshl_b32 s7, s40, 7
    s_add_u32 s7, s7, s44
    s_add_u32 s7, s7, 65536
    s_add_u32 s52, s4, s7
    s_addc_u32 s53, s5, 0
    s_mov_b32 s6, 0
L_poll_40:
    s_load_dwordx8 s[56:63], s[52:53], 0 glc
    s_add_u32 s6, s6, 1
    s_waitcnt lgkmcnt(0)
    s_xor_b64 s[56:57], s[56:57], s[76:77]
    s_xor_b64 s[58:59], s[58:59], s[76:77]
    s_xor_b64 s[60:61], s[60:61], s[76:77]
    s_xor_b64 s[62:63], s[62:63], s[76:77]
    s_or_b64 s[56:57], s[56:57], s[58:59]
    s_or_b64 s[60:61], s[60:61], s[62:63]
    s_or_b64 s[56:57], s[56:57], s[60:61]
    s_cbranch_scc0 L_polled_41
    s_cmp_lt_u32 s6, 1048576
    s_cbranch_scc1 L_poll_40
    s_branch L_main_end
L_polled_41:
L_pollout_42:
    s_barrier
    buffer_load_dwordx4 v[28:31], v2, s[8:11], s20 offen sc1
    buffer_load_dwordx4 v[32:35], v3, s[8:11], s20 offen sc1
    buffer_load_dwordx4 v[36:39], v4, s[8:11], s20 offen sc1
    s_add_u32 s20, s20, 9216
    buffer_load_dwordx4 v[40:43], v2, s[8:11], s20 offen sc1
    buffer_load_dwordx4 v[44:47], v3, s[8:11], s20 offen sc1
    buffer_load_dwordx4 v[48:51], v4, s[8:11], s20 offen sc1
    s_add_u32 s20, s20, 9216
    buffer_load_dwordx4 v[52:55], v2, s[8:11], s20 offen sc1
    buffer_load_dwordx4 v[56:59], v3, s[8:11], s20 offen sc1
    s_cmp_eq_u32 s3, 0
    s_cselect_b32 s7, 1.0, 0
    s_waitcnt vmcnt(8)
    v_mul_f32 v11, s7, v10
    v_lshlrev_b32 v124, 16, v16
    v_and_b32 v125, s16, v16
    v_lshlrev_b32 v126, 16, v17
    v_and_b32 v127, s16, v17
    v_lshlrev_b32 v128, 16, v18
    v_and_b32 v129, s16, v18
    v_lshlrev_b32 v130, 16, v19
    v_and_b32 v131, s16, v19
    v_pk_add_f32 v[124:125], v[124:125], v[10:11] op_sel_hi:[1,0]
    v_pk_add_f32 v[126:127], v[126:127], v[10:11] op_sel_hi:[1,0]
    v_pk_add_f32 v[128:129], v[128:129], v[10:11] op_sel_hi:[1,0]
    v_pk_add_f32 v[130:131], v[130:131], v[10:11] op_sel_hi:[1,0]
    v_lshlrev_b32 v132, 16, v20
    v_and_b32 v133, s16, v20
    v_lshlrev_b32 v134, 16, v21
    v_and_b32 v135, s16, v21
    v_lshlrev_b32 v136, 16, v22
    v_and_b32 v137, s16, v22
    v_lshlrev_b32 v138, 16, v23
    v_and_b32 v139, s16, v23
    v_pk_add_f32 v[132:133], v[132:133], v[10:11] op_sel_hi:[1,0]
    v_pk_add_f32 v[134:135], v[134:135], v[10:11] op_sel_hi:[1,0]
    v_pk_add_f32 v[136:137], v[136:137], v[10:11] op_sel_hi:[1,0]
    v_pk_add_f32 v[138:139], v[138:139], v[10:11] op_sel_hi:[1,0]
    v_lshlrev_b32 v140, 16, v24
    v_and_b32 v141, s16, v24
    v_lshlrev_b32 v142, 16, v25
    v_and_b32 v143, s16, v25
    v_lshlrev_b32 v144, 16, v26
    v_and_b32 v145, s16, v26
    v_lshlrev_b32 v146, 16, v27
    v_and_b32 v147, s16, v27
    v_pk_add_f32 v[140:141], v[140:141], v[10:11] op_sel:[0,1] op_sel_hi:[1,1]
    v_pk_add_f32 v[142:143], v[142:143], v[10:11] op_sel:[0,1] op_sel_hi:[1,1]
    v_pk_add_f32 v[144:145], v[144:145], v[10:11] op_sel:[0,1] op_sel_hi:[1,1]
    v_pk_add_f32 v[146:147], v[146:147], v[10:11] op_sel:[0,1] op_sel_hi:[1,1]
    s_waitcnt vmcnt(7)
    buffer_load_dwordx4 v[60:63], v4, s[8:11], s20 offen sc1
    s_add_u32 s20, s20, 9216
    v_lshlrev_b32 v148, 16, v28
    v_and_b32 v149, s16, v28
    v_lshlrev_b32 v150, 16, v29
    v_and_b32 v151, s16, v29
    v_lshlrev_b32 v152, 16, v30
    v_and_b32 v153, s16, v30
    v_lshlrev_b32 v154, 16, v31
    v_and_b32 v155, s16, v31
    v_pk_add_f32 v[124:125], v[124:125], v[148:149]
    v_pk_add_f32 v[126:127], v[126:127], v[150:151]
    v_pk_add_f32 v[128:129], v[128:129], v[152:153]
    v_pk_add_f32 v[130:131], v[130:131], v[154:155]
    s_waitcnt vmcnt(7)
    buffer_load_dwordx4 v[64:67], v2, s[8:11], s20 offen sc1
    v_lshlrev_b32 v148, 16, v32
    v_and_b32 v149, s16, v32
    v_lshlrev_b32 v150, 16, v33
    v_and_b32 v151, s16, v33
    v_lshlrev_b32 v152, 16, v34
    v_and_b32 v153, s16, v34
    v_lshlrev_b32 v154, 16, v35
    v_and_b32 v155, s16, v35
    v_pk_add_f32 v[132:133], v[132:133], v[148:149]
    v_pk_add_f32 v[134:135], v[134:135], v[150:151]
    v_pk_add_f32 v[136:137], v[136:137], v[152:153]
    v_pk_add_f32 v[138:139], v[138:139], v[154:155]
    s_waitcnt vmcnt(7)
    buffer_load_dwordx4 v[68:71], v3, s[8:11], s20 offen sc1
    v_lshlrev_b32 v148, 16, v36
    v_and_b32 v149, s16, v36
    v_lshlrev_b32 v150, 16, v37
    v_and_b32 v151, s16, v37
    v_lshlrev_b32 v152, 16, v38
    v_and_b32 v153, s16, v38
    v_lshlrev_b32 v154, 16, v39
    v_and_b32 v155, s16, v39
    v_pk_add_f32 v[140:141], v[140:141], v[148:149]
    v_pk_add_f32 v[142:143], v[142:143], v[150:151]
    v_pk_add_f32 v[144:145], v[144:145], v[152:153]
    v_pk_add_f32 v[146:147], v[146:147], v[154:155]
    s_waitcnt vmcnt(7)
    buffer_load_dwordx4 v[72:75], v4, s[8:11], s20 offen sc1
    s_add_u32 s20, s20, 9216
    v_lshlrev_b32 v148, 16, v40
    v_and_b32 v149, s16, v40
    v_lshlrev_b32 v150, 16, v41
    v_and_b32 v151, s16, v41
    v_lshlrev_b32 v152, 16, v42
    v_and_b32 v153, s16, v42
    v_lshlrev_b32 v154, 16, v43
    v_and_b32 v155, s16, v43
    v_pk_add_f32 v[124:125], v[124:125], v[148:149]
    v_pk_add_f32 v[126:127], v[126:127], v[150:151]
    v_pk_add_f32 v[128:129], v[128:129], v[152:153]
    v_pk_add_f32 v[130:131], v[130:131], v[154:155]
    s_waitcnt vmcnt(7)
    buffer_load_dwordx4 v[76:79], v2, s[8:11], s20 offen sc1
    v_lshlrev_b32 v148, 16, v44
    v_and_b32 v149, s16, v44
    v_lshlrev_b32 v150, 16, v45
    v_and_b32 v151, s16, v45
    v_lshlrev_b32 v152, 16, v46
    v_and_b32 v153, s16, v46
    v_lshlrev_b32 v154, 16, v47
    v_and_b32 v155, s16, v47
    v_pk_add_f32 v[132:133], v[132:133], v[148:149]
    v_pk_add_f32 v[134:135], v[134:135], v[150:151]
    v_pk_add_f32 v[136:137], v[136:137], v[152:153]
    v_pk_add_f32 v[138:139], v[138:139], v[154:155]
    s_waitcnt vmcnt(7)
    buffer_load_dwordx4 v[80:83], v3, s[8:11], s20 offen sc1
    v_lshlrev_b32 v148, 16, v48
    v_and_b32 v149, s16, v48
    v_lshlrev_b32 v150, 16, v49
    v_and_b32 v151, s16, v49
    v_lshlrev_b32 v152, 16, v50
    v_and_b32 v153, s16, v50
    v_lshlrev_b32 v154, 16, v51
    v_and_b32 v155, s16, v51
    v_pk_add_f32 v[140:141], v[140:141], v[148:149]
    v_pk_add_f32 v[142:143], v[142:143], v[150:151]
    v_pk_add_f32 v[144:145], v[144:145], v[152:153]
    v_pk_add_f32 v[146:147], v[146:147], v[154:155]
    s_waitcnt vmcnt(7)
    buffer_load_dwordx4 v[84:87], v4, s[8:11], s20 offen sc1
    s_add_u32 s20, s20, 9216
    v_lshlrev_b32 v148, 16, v52
    v_and_b32 v149, s16, v52
    v_lshlrev_b32 v150, 16, v53
    v_and_b32 v151, s16, v53
    v_lshlrev_b32 v152, 16, v54
    v_and_b32 v153, s16, v54
    v_lshlrev_b32 v154, 16, v55
    v_and_b32 v155, s16, v55
    v_pk_add_f32 v[124:125], v[124:125], v[148:149]
    v_pk_add_f32 v[126:127], v[126:127], v[150:151]
    v_pk_add_f32 v[128:129], v[128:129], v[152:153]
    v_pk_add_f32 v[130:131], v[130:131], v[154:155]
    s_waitcnt vmcnt(7)
    buffer_load_dwordx4 v[88:91], v2, s[8:11], s20 offen sc1
    v_lshlrev_b32 v148, 16, v56
    v_and_b32 v149, s16, v56
    v_lshlrev_b32 v150, 16, v57
    v_and_b32 v151, s16, v57
    v_lshlrev_b32 v152, 16, v58
    v_and_b32 v153, s16, v58
    v_lshlrev_b32 v154, 16, v59
    v_and_b32 v155, s16, v59
    v_pk_add_f32 v[132:133], v[132:133], v[148:149]
    v_pk_add_f32 v[134:135], v[134:135], v[150:151]
    v_pk_add_f32 v[136:137], v[136:137], v[152:153]
    v_pk_add_f32 v[138:139], v[138:139], v[154:155]
    s_waitcnt vmcnt(7)
    buffer_load_dwordx4 v[92:95], v3, s[8:11], s20 offen sc1
    v_lshlrev_b32 v148, 16, v60
    v_and_b32 v149, s16, v60
    v_lshlrev_b32 v150, 16, v61
    v_and_b32 v151, s16, v61
    v_lshlrev_b32 v152, 16, v62
    v_and_b32 v153, s16, v62
    v_lshlrev_b32 v154, 16, v63
    v_and_b32 v155, s16, v63
    v_pk_add_f32 v[140:141], v[140:141], v[148:149]
    v_pk_add_f32 v[142:143], v[142:143], v[150:151]
    v_pk_add_f32 v[144:145], v[144:145], v[152:153]
    v_pk_add_f32 v[146:147], v[146:147], v[154:155]
    s_waitcnt vmcnt(7)
    buffer_load_dwordx4 v[96:99], v4, s[8:11], s20 offen sc1
    s_add_u32 s20, s20, 9216
    v_lshlrev_b32 v148, 16, v64
    v_and_b32 v149, s16, v64
    v_lshlrev_b32 v150, 16, v65
    v_and_b32 v151, s16, v65
    v_lshlrev_b32 v152, 16, v66
    v_and_b32 v153, s16, v66
    v_lshlrev_b32 v154, 16, v67
    v_and_b32 v155, s16, v67
    v_pk_add_f32 v[124:125], v[124:125], v[148:149]
    v_pk_add_f32 v[126:127], v[126:127], v[150:151]
    v_pk_add_f32 v[128:129], v[128:129], v[152:153]
    v_pk_add_f32 v[130:131], v[130:131], v[154:155]
    s_waitcnt vmcnt(7)
    buffer_load_dwordx4 v[100:103], v2, s[8:11], s20 offen sc1
    v_lshlrev_b32 v148, 16, v68
    v_and_b32 v149, s16, v68
    v_lshlrev_b32 v150, 16, v69
    v_and_b32 v151, s16, v69
    v_lshlrev_b32 v152, 16, v70
    v_and_b32 v153, s16, v70
    v_lshlrev_b32 v154, 16, v71
    v_and_b32 v155, s16, v71
    v_pk_add_f32 v[132:133], v[132:133], v[148:149]
    v_pk_add_f32 v[134:135], v[134:135], v[150:151]
    v_pk_add_f32 v[136:137], v[136:137], v[152:153]
    v_pk_add_f32 v[138:139], v[138:139], v[154:155]
    s_waitcnt vmcnt(7)
    buffer_load_dwordx4 v[104:107], v3, s[8:11], s20 offen sc1
    v_lshlrev_b32 v148, 16, v72
    v_and_b32 v149, s16, v72
    v_lshlrev_b32 v150, 16, v73
    v_and_b32 v151, s16, v73
    v_lshlrev_b32 v152, 16, v74
    v_and_b32 v153, s16, v74
    v_lshlrev_b32 v154, 16, v75
    v_and_b32 v155, s16, v75
    v_pk_add_f32 v[140:141], v[140:141], v[148:149]
    v_pk_add_f32 v[142:143], v[142:143], v[150:151]
    v_pk_add_f32 v[144:145], v[144:145], v[152:153]
    v_pk_add_f32 v[146:147], v[146:147], v[154:155]
    s_waitcnt vmcnt(7)
    buffer_load_dwordx4 v[108:111], v4, s[8:11], s20 offen sc1
    s_add_u32 s20, s20, 9216
    v_lshlrev_b32 v148, 16, v76
    v_and_b32 v149, s16, v76
    v_lshlrev_b32 v150, 16, v77
    v_and_b32 v151, s16, v77
    v_lshlrev_b32 v152, 16, v78
    v_and_b32 v153, s16, v78
    v_lshlrev_b32 v154, 16, v79
    v_and_b32 v155, s16, v79
    v_pk_add_f32 v[124:125], v[124:125], v[148:149]
    v_pk_add_f32 v[126:127], v[126:127], v[150:151]
    v_pk_add_f32 v[128:129], v[128:129], v[152:153]
    v_pk_add_f32 v[130:131], v[130:131], v[154:155]
    s_waitcnt vmcnt(7)
    buffer_load_dwordx4 v[112:115], v2, s[8:11], s20 offen sc1
    v_lshlrev_b32 v148, 16, v80
    v_and_b32 v149, s16, v80
    v_lshlrev_b32 v150, 16, v81
    v_and_b32 v151, s16, v81
    v_lshlrev_b32 v152, 16, v82
    v_and_b32 v153, s16, v82
    v_lshlrev_b32 v154, 16, v83
    v_and_b32 v155, s16, v83
    v_pk_add_f32 v[132:133], v[132:133], v[148:149]
    v_pk_add_f32 v[134:135], v[134:135], v[150:151]
    v_pk_add_f32 v[136:137], v[136:137], v[152:153]
    v_pk_add_f32 v[138:139], v[138:139], v[154:155]
    s_waitcnt vmcnt(7)
    buffer_load_dwordx4 v[116:119], v3, s[8:11], s20 offen sc1
    v_lshlrev_b32 v148, 16, v84
    v_and_b32 v149, s16, v84
    v_lshlrev_b32 v150, 16, v85
    v_and_b32 v151, s16, v85
    v_lshlrev_b32 v152, 16, v86
    v_and_b32 v153, s16, v86
    v_lshlrev_b32 v154, 16, v87
    v_and_b32 v155, s16, v87
    v_pk_add_f32 v[140:141], v[140:141], v[148:149]
    v_pk_add_f32 v[142:143], v[142:143], v[150:151]
    v_pk_add_f32 v[144:145], v[144:145], v[152:153]
    v_pk_add_f32 v[146:147], v[146:147], v[154:155]
    s_waitcnt vmcnt(7)
    buffer_load_dwordx4 v[120:123], v4, s[8:11], s20 offen sc1
    v_lshlrev_b32 v148, 16, v88
    v_and_b32 v149, s16, v88
    v_lshlrev_b32 v150, 16, v89
    v_and_b32 v151, s16, v89
    v_lshlrev_b32 v152, 16, v90
    v_and_b32 v153, s16, v90
    v_lshlrev_b32 v154, 16, v91
    v_and_b32 v155, s16, v91
    s_lshl_b32 s28, s40, 2
    s_add_u32 s28, s28, s3
    s_mul_i32 s28, s28, 73728
    s_mul_i32 s7, s42, 1073741824
    v_add_u32 v1, s7, v253
    buffer_load_dwordx4 a[0:3], v1, s[8:11], s28 offen offset:0 sc1
    v_pk_add_f32 v[124:125], v[124:125], v[148:149]
    v_pk_add_f32 v[126:127], v[126:127], v[150:151]
    v_pk_add_f32 v[128:129], v[128:129], v[152:153]
    v_pk_add_f32 v[130:131], v[130:131], v[154:155]
    s_waitcnt vmcnt(8)
    buffer_load_dwordx4 a[4:7], v1, s[8:11], s28 offen offset:1024 sc1
    v_lshlrev_b32 v148, 16, v92
    v_and_b32 v149, s16, v92
    v_lshlrev_b32 v150, 16, v93
    v_and_b32 v151, s16, v93
    v_lshlrev_b32 v152, 16, v94
    v_and_b32 v153, s16, v94
    v_lshlrev_b32 v154, 16, v95
    v_and_b32 v155, s16, v95
    buffer_load_dwordx4 a[8:11], v1, s[8:11], s28 offen offset:2048 sc1
    v_pk_add_f32 v[132:133], v[132:133], v[148:149]
    v_pk_add_f32 v[134:135], v[134:135], v[150:151]
    v_pk_add_f32 v[136:137], v[136:137], v[152:153]
    v_pk_add_f32 v[138:139], v[138:139], v[154:155]
    s_waitcnt vmcnt(9)
    buffer_load_dwordx4 a[12:15], v1, s[8:11], s28 offen offset:3072 sc1
    v_lshlrev_b32 v148, 16, v96
    v_and_b32 v149, s16, v96
    v_lshlrev_b32 v150, 16, v97
    v_and_b32 v151, s16, v97
    v_lshlrev_b32 v152, 16, v98
    v_and_b32 v153, s16, v98
    v_lshlrev_b32 v154, 16, v99
    v_and_b32 v155, s16, v99
    s_add_u32 s28, s28, 4096
    buffer_load_dwordx4 a[16:19], v1, s[8:11], s28 offen offset:0 sc1
    v_pk_add_f32 v[140:141], v[140:141], v[148:149]
    v_pk_add_f32 v[142:143], v[142:143], v[150:151]
    v_pk_add_f32 v[144:145], v[144:145], v[152:153]
    v_pk_add_f32 v[146:147], v[146:147], v[154:155]
    s_waitcnt vmcnt(10)
    buffer_load_dwordx4 a[20:23], v1, s[8:11], s28 offen offset:1024 sc1
    v_lshlrev_b32 v148, 16, v100
    v_and_b32 v149, s16, v100
    v_lshlrev_b32 v150, 16, v101
    v_and_b32 v151, s16, v101
    v_lshlrev_b32 v152, 16, v102
    v_and_b32 v153, s16, v102
    v_lshlrev_b32 v154, 16, v103
    v_and_b32 v155, s16, v103
    buffer_load_dwordx4 a[24:27], v1, s[8:11], s28 offen offset:2048 sc1
    v_pk_add_f32 v[124:125], v[124:125], v[148:149]
    v_pk_add_f32 v[126:127], v[126:127], v[150:151]
    v_pk_add_f32 v[128:129], v[128:129], v[152:153]
    v_pk_add_f32 v[130:131], v[130:131], v[154:155]
    s_waitcnt vmcnt(11)
    buffer_load_dwordx4 a[28:31], v1, s[8:11], s28 offen offset:3072 sc1
    v_lshlrev_b32 v148, 16, v104
    v_and_b32 v149, s16, v104
    v_lshlrev_b32 v150, 16, v105
    v_and_b32 v151, s16, v105
    v_lshlrev_b32 v152, 16, v106
    v_and_b32 v153, s16, v106
    v_lshlrev_b32 v154, 16, v107
    v_and_b32 v155, s16, v107
    s_add_u32 s28, s28, 4096
    buffer_load_dwordx4 a[32:35], v1, s[8:11], s28 offen offset:0 sc1
    v_pk_add_f32 v[132:133], v[132:133], v[148:149]
    v_pk_add_f32 v[134:135], v[134:135], v[150:151]
    v_pk_add_f32 v[136:137], v[136:137], v[152:153]
    v_pk_add_f32 v[138:139], v[138:139], v[154:155]
    s_waitcnt vmcnt(12)
    buffer_load_dwordx4 a[36:39], v1, s[8:11], s28 offen offset:1024 sc1
    v_lshlrev_b32 v148, 16, v108
    v_and_b32 v149, s16, v108
    v_lshlrev_b32 v150, 16, v109
    v_and_b32 v151, s16, v109
    v_lshlrev_b32 v152, 16, v110
    v_and_b32 v153, s16, v110
    v_lshlrev_b32 v154, 16, v111
    v_and_b32 v155, s16, v111
    buffer_load_dwordx4 a[40:43], v1, s[8:11], s28 offen offset:2048 sc1
    v_pk_add_f32 v[140:141], v[140:141], v[148:149]
    v_pk_add_f32 v[142:143], v[142:143], v[150:151]
    v_pk_add_f32 v[144:145], v[144:145], v[152:153]
    v_pk_add_f32 v[146:147], v[146:147], v[154:155]
    s_waitcnt vmcnt(13)
    buffer_load_dwordx4 a[44:47], v1, s[8:11], s28 offen offset:3072 sc1
    v_lshlrev_b32 v148, 16, v112
    v_and_b32 v149, s16, v112
    v_lshlrev_b32 v150, 16, v113
    v_and_b32 v151, s16, v113
    v_lshlrev_b32 v152, 16, v114
    v_and_b32 v153, s16, v114
    v_lshlrev_b32 v154, 16, v115
    v_and_b32 v155, s16, v115
    s_add_u32 s28, s28, 4096
    buffer_load_dwordx4 a[48:51], v1, s[8:11], s28 offen offset:0 sc1
    v_pk_add_f32 v[124:125], v[124:125], v[148:149]
    v_pk_add_f32 v[126:127], v[126:127], v[150:151]
    v_pk_add_f32 v[128:129], v[128:129], v[152:153]
    v_pk_add_f32 v[130:131], v[130:131], v[154:155]
    s_waitcnt vmcnt(14)
    buffer_load_dwordx4 a[52:55], v1, s[8:11], s28 offen offset:1024 sc1
    v_lshlrev_b32 v148, 16, v116
    v_and_b32 v149, s16, v116
    v_lshlrev_b32 v150, 16, v117
    v_and_b32 v151, s16, v117
    v_lshlrev_b32 v152, 16, v118
    v_and_b32 v153, s16, v118
    v_lshlrev_b32 v154, 16, v119
    v_and_b32 v155, s16, v119
    buffer_load_dwordx4 a[56:59], v1, s[8:11], s28 offen offset:2048 sc1
    v_pk_add_f32 v[132:133], v[132:133], v[148:149]
    v_pk_add_f32 v[134:135], v[134:135], v[150:151]
    v_pk_add_f32 v[136:137], v[136:137], v[152:153]
    v_pk_add_f32 v[138:139], v[138:139], v[154:155]
    s_waitcnt vmcnt(15)
    buffer_load_dwordx4 a[60:63], v1, s[8:11], s28 offen offset:3072 sc1
    v_lshlrev_b32 v148, 16, v120
    v_and_b32 v149, s16, v120
    v_lshlrev_b32 v150, 16, v121
    v_and_b32 v151, s16, v121
    v_lshlrev_b32 v152, 16, v122
    v_and_b32 v153, s16, v122
    v_lshlrev_b32 v154, 16, v123
    v_and_b32 v155, s16, v123
    s_add_u32 s28, s28, 4096
    buffer_load_dwordx4 a[64:67], v1, s[8:11], s28 offen offset:0 sc1
    v_pk_add_f32 v[140:141], v[140:141], v[148:149]
    v_pk_add_f32 v[142:143], v[142:143], v[150:151]
    v_pk_add_f32 v[144:145], v[144:145], v[152:153]
    v_pk_add_f32 v[146:147], v[146:147], v[154:155]
    buffer_load_dwordx4 a[68:71], v1, s[8:11], s28 offen offset:1024 sc1
    buffer_load_dwordx4 a[72:75], v1, s[8:11], s28 offen offset:2048 sc1
    buffer_load_dwordx4 a[76:79], v1, s[8:11], s28 offen offset:3072 sc1
    s_add_u32 s28, s28, 4096
    buffer_load_dwordx4 a[80:83], v1, s[8:11], s28 offen offset:0 sc1
    buffer_load_dwordx4 a[84:87], v1, s[8:11], s28 offen offset:1024 sc1
    buffer_load_dwordx4 a[88:91], v1, s[8:11], s28 offen offset:2048 sc1
    buffer_load_dwordx4 a[92:95], v1, s[8:11], s28 offen offset:3072 sc1
    s_add_u32 s28, s28, 4096
    v_cvt_pk_bf16_f32 v156, v124, v125
    v_cvt_pk_bf16_f32 v157, v126, v127
    v_cvt_pk_bf16_f32 v158, v128, v129
    v_cvt_pk_bf16_f32 v159, v130, v131
    v_cvt_pk_bf16_f32 v160, v132, v133
    v_cvt_pk_bf16_f32 v161, v134, v135
    v_cvt_pk_bf16_f32 v162, v136, v137
    v_cvt_pk_bf16_f32 v163, v138, v139
    v_cvt_pk_bf16_f32 v164, v140, v141
    v_cvt_pk_bf16_f32 v165, v142, v143
    v_cvt_pk_bf16_f32 v166, v144, v145
    v_cvt_pk_bf16_f32 v167, v146, v147
    s_cmp_lg_u32 s42, 0
    s_cbranch_scc1 L_main_last
    s_add_u32 s19, s18, 53215232
    s_add_u32 s20, s18, 48496640
    s_lshl_b32 s22, s21, 7
    s_add_u32 s22, s22, 57933824
    buffer_store_dwordx4 v[156:159], v2, s[8:11], s19 offen sc1
    buffer_store_dwordx4 v[160:163], v3, s[8:11], s19 offen sc1
    buffer_store_dwordx4 v[164:167], v4, s[8:11], s19 offen sc1
    s_mov_b32 s17, 0x3f803f80
    v_mov_b32 v8, 0
    v_mov_b32 v9, 0
    v_mov_b32 v10, 0
    v_mov_b32 v11, 0
    v_dot2c_f32_bf16 v8, s17, v156
    v_dot2c_f32_bf16 v9, v156, v156
    v_dot2c_f32_bf16 v10, s17, v157
    v_dot2c_f32_bf16 v11, v157, v157
    v_dot2c_f32_bf16 v8, s17, v158
    v_dot2c_f32_bf16 v9, v158, v158
    v_dot2c_f32_bf16 v10, s17, v159
    v_dot2c_f32_bf16 v11, v159, v159
    v_dot2c_f32_bf16 v8, s17, v160
    v_dot2c_f32_bf16 v9, v160, v160
    v_dot2c_f32_bf16 v10, s17, v161
    v_dot2c_f32_bf16 v11, v161, v161
    v_dot2c_f32_bf16 v8, s17, v162
    v_dot2c_f32_bf16 v9, v162, v162
    v_dot2c_f32_bf16 v10, s17, v163
    v_dot2c_f32_bf16 v11, v163, v163
    v_dot2c_f32_bf16 v8, s17, v164
    v_dot2c_f32_bf16 v9, v164, v164
    v_dot2c_f32_bf16 v10, s17, v165
    v_dot2c_f32_bf16 v11, v165, v165
    v_dot2c_f32_bf16 v8, s17, v166
    v_dot2c_f32_bf16 v9, v166, v166
    v_dot2c_f32_bf16 v10, s17, v167
    v_dot2c_f32_bf16 v11, v167, v167
    v_and_b32 v12, 7, v0
    v_lshlrev_b32 v12, 3, v12
    s_lshl_b32 s7, s3, 6
    v_add_u32 v13, s7, v12
    v_pk_add_f32 v[8:9], v[8:9], v[10:11]
    s_nop 1
    v_add_f32_dpp v8, v8, v8 row_ror:8 row_mask:0xf bank_mask:0xf
    v_add_f32_dpp v9, v9, v9 row_ror:8 row_mask:0xf bank_mask:0xf
    v_mov_b32 v10, v8
    v_mov_b32 v11, v9
    s_nop 1
    v_permlane32_swap_b32 v10, v8
    v_permlane32_swap_b32 v11, v9
    v_add_f32 v8, v8, v10
    v_add_f32 v9, v9, v11
    v_mov_b32 v10, v8
    v_mov_b32 v11, v9
    s_nop 1
    v_permlane16_swap_b32 v10, v8
    v_permlane16_swap_b32 v11, v9
    v_add_f32 v8, v8, v10
    v_add_f32 v9, v9, v11
    ds_write_b64 v13, v[8:9]
    s_waitcnt lgkmcnt(0)
    s_barrier
    ds_read_b64 v[40:41], v12 offset:0
    ds_read_b64 v[42:43], v12 offset:64
    ds_read_b64 v[44:45], v12 offset:128
    ds_read_b64 v[46:47], v12 offset:192
    s_waitcnt lgkmcnt(0)
    v_pk_add_f32 v[40:41], v[40:41], v[42:43]
    v_pk_add_f32 v[44:45], v[44:45], v[46:47]
    v_pk_add_f32 v[8:9], v[40:41], v[44:45]
    v_mul_f32 v8, 0x3ae38e39, v8
    v_mul_f32 v9, 0x3ae38e39, v9
    v_fma_f32 v9, -v8, v8, v9
    v_max_f32 v9, 0, v9
    v_add_f32 v9, 0x3727c5ac, v9
    v_rsq_f32 v10, v9
    s_nop 0
    v_mul_f32 v12, v8, v10
    v_mov_b32 v11, v10
    v_sub_f32 v12, 0, v12
    v_mov_b32 v13, v12
    s_cmp_eq_u32 s3, 0
    s_cselect_b32 s7, 32, 0
    v_lshlrev_b32 v14, 2, v0
    v_cmp_gt_u32 vcc, s7, v0
    v_mov_b32 v9, 1073741824
    s_nop 0
    v_cndmask_b32 v14, v9, v14, vcc
    buffer_store_dword v8, v14, s[8:11], s22 offen sc1
    v_lshlrev_b32 v40, 16, v156
    v_and_b32 v41, s16, v156
    v_lshlrev_b32 v42, 16, v157
    v_and_b32 v43, s16, v157
    v_lshlrev_b32 v44, 16, v158
    v_and_b32 v45, s16, v158
    v_lshlrev_b32 v46, 16, v159
    v_and_b32 v47, s16, v159
    v_pk_fma_f32 v[40:41], v[40:41], v[10:11], v[12:13]
    v_pk_fma_f32 v[42:43], v[42:43], v[10:11], v[12:13]
    v_pk_fma_f32 v[44:45], v[44:45], v[10:11], v[12:13]
    v_pk_fma_f32 v[46:47], v[46:47], v[10:11], v[12:13]
    v_cvt_pk_bf16_f32 v48, v40, v41
    v_cvt_pk_bf16_f32 v49, v42, v43
    v_cvt_pk_bf16_f32 v50, v44, v45
    v_cvt_pk_bf16_f32 v51, v46, v47
    v_lshlrev_b32 v40, 16, v160
    v_and_b32 v41, s16, v160
    v_lshlrev_b32 v42, 16, v161
    v_and_b32 v43, s16, v161
    v_lshlrev_b32 v44, 16, v162
    v_and_b32 v45, s16, v162
    v_lshlrev_b32 v46, 16, v163
    v_and_b32 v47, s16, v163
    v_pk_fma_f32 v[40:41], v[40:41], v[10:11], v[12:13]
    v_pk_fma_f32 v[42:43], v[42:43], v[10:11], v[12:13]
    v_pk_fma_f32 v[44:45], v[44:45], v[10:11], v[12:13]
    v_pk_fma_f32 v[46:47], v[46:47], v[10:11], v[12:13]
    v_cvt_pk_bf16_f32 v52, v40, v41
    v_cvt_pk_bf16_f32 v53, v42, v43
    v_cvt_pk_bf16_f32 v54, v44, v45
    v_cvt_pk_bf16_f32 v55, v46, v47
    v_lshlrev_b32 v40, 16, v164
    v_and_b32 v41, s16, v164
    v_lshlrev_b32 v42, 16, v165
    v_and_b32 v43, s16, v165
    v_lshlrev_b32 v44, 16, v166
    v_and_b32 v45, s16, v166
    v_lshlrev_b32 v46, 16, v167
    v_and_b32 v47, s16, v167
    v_pk_fma_f32 v[40:41], v[40:41], v[10:11], v[12:13]
    v_pk_fma_f32 v[42:43], v[42:43], v[10:11], v[12:13]
    v_pk_fma_f32 v[44:45], v[44:45], v[10:11], v[12:13]
    v_pk_fma_f32 v[46:47], v[46:47], v[10:11], v[12:13]
    v_cvt_pk_bf16_f32 v56, v40, v41
    v_cvt_pk_bf16_f32 v57, v42, v43
    v_cvt_pk_bf16_f32 v58, v44, v45
    v_cvt_pk_bf16_f32 v59, v46, v47
    buffer_store_dwordx4 v[48:51], v2, s[8:11], s20 offen sc1
    buffer_store_dwordx4 v[52:55], v3, s[8:11], s20 offen sc1
    buffer_store_dwordx4 v[56:59], v4, s[8:11], s20 offen sc1
    v_lshlrev_b32 v15, 7, v0
    s_lshl_b32 s6, s40, 2
    s_add_u32 s6, s6, s44
    s_add_u32 s6, s6, 98304
    v_mov_b32 v1, s76
    s_mov_b64 vcc, 0xff
    v_lshrrev_b32 v14, 3, v0
    v_lshl_add_u32 v15, v14, 3, v15
    s_cmp_ge_u32 s40, 6
    s_cselect_b32 s7, s41, 31
    s_cmp_lt_u32 s7, 31
    s_cmov_b64 vcc, 0xffff
    s_waitcnt vmcnt(0)
    s_barrier
    s_cmp_lg_u32 s3, 0
    s_cbranch_scc1 L_pub_43
    s_mov_b64 exec, vcc
    buffer_store_dword v1, v15, s[8:11], s6 offen sc1
L_pub_43:
    s_mov_b64 exec, -1
    s_mov_b32 s42, 1
    s_mov_b32 s43, 9699328
    s_add_u32 s44, s44, 131072
    s_mov_b32 s74, 0
    s_branch L_main_layer
L_main_last:
    buffer_store_dwordx4 v[156:159], v5, s[12:15], s18 offen
    buffer_store_dwordx4 v[160:163], v6, s[12:15], s18 offen
    buffer_store_dwordx4 v[164:167], v7, s[12:15], s18 offen
    s_or_b32 s7, s40, s41
    s_or_b32 s7, s7, s3
    s_cbranch_scc1 L_done_44
    v_mov_b32 v1, s76
    s_mov_b32 s7, 19660800
    s_mov_b64 exec, 1
    buffer_store_dword v1, off, s[8:11], s7 sc1
    s_mov_b64 exec, -1
L_done_44:
L_main_end:
    s_endpgm
.section .rodata,"a"
.p2align 6
.amdhsa_kernel interleave_layers__sliding_local_dilated__glu_gated_geglu__prompt_kernel
.amdhsa_next_free_vgpr 512
.amdhsa_next_free_sgpr 102
.amdhsa_accum_offset 256
.amdhsa_group_segment_fixed_size 0
.amdhsa_kernarg_size 80
.amdhsa_user_sgpr_count 2
.amdhsa_user_sgpr_kernarg_segment_ptr 1
.amdhsa_system_sgpr_workgroup_id_x 1
.amdhsa_float_denorm_mode_32 3
.amdhsa_float_denorm_mode_16_64 3
.end_amdhsa_kernel
```

```asm
; @launch grid=(256,1,1) block=(256,1,1) lds=163840
.amdgcn_target "amdgcn-amd-amdhsa--gfx950"
.text
.globl interleave_layers__sliding_local_dilated__glu_gated_geglu__prompt_kernel
.p2align 8
.type interleave_layers__sliding_local_dilated__glu_gated_geglu__prompt_kernel,@function
interleave_layers__sliding_local_dilated__glu_gated_geglu__prompt_kernel:
    s_cmp_ge_u32 s2, 256
    s_cbranch_scc1 L_main_end
    s_load_dwordx2 s[4:5], s[0:1], 72
    s_load_dwordx4 s[16:19], s[0:1], 0
    s_load_dwordx2 s[22:23], s[0:1], 16
    s_load_dwordx8 s[24:31], s[0:1], 32
    v_lshrrev_b32 v1, 6, v0
    v_and_b32 v0, 63, v0
    v_readfirstlane_b32 s3, v1
    s_waitcnt lgkmcnt(0)
    s_mov_b32 s8, s4
    s_and_b32 s9, s5, 0xffff
    s_mov_b32 s10, 268435456
    s_mov_b32 s11, 0x20000
    s_mov_b32 s7, 19660800
    s_load_dword s76, s[4:5], s7
    s_mov_b64 s[20:21], s[18:19]
    s_mov_b64 s[18:19], s[16:17]
    s_mov_b32 s48, s4
    s_and_b32 s49, s5, 0xffff
    s_mov_b32 s50, 268435456
    s_mov_b32 s51, 0x20000
    s_and_b32 s40, s2, 1
    s_lshl_b32 s40, s40, 2
    s_bfe_u32 s7, s2, 131075
    s_add_u32 s40, s40, s7
    s_bfe_u32 s41, s2, 131073
    s_lshl_b32 s41, s41, 3
    s_lshr_b32 s7, s2, 5
    s_add_u32 s41, s41, s7
    s_mov_b32 s42, 0
    s_mov_b32 s43, 0
    s_lshl_b32 s44, s41, 10
    s_add_u32 s44, s44, 19169280
    v_lshlrev_b32 v253, 4, v0
    s_getpc_b64 s[52:53]
L_main_pc:
    s_sub_u32 s52, s52, L_main_pc-interleave_layers__sliding_local_dilated__glu_gated_geglu__prompt_kernel
    s_subb_u32 s53, s53, 0
    s_and_b32 s53, s53, 0xffff
    s_mov_b32 s54, L_main_code_end-interleave_layers__sliding_local_dilated__glu_gated_geglu__prompt_kernel
    s_mov_b32 s55, 0x20000
    s_lshr_b32 s7, s2, 3
    s_lshl_b32 s7, s7, 2
    s_add_u32 s7, s7, s3
    s_lshl_b32 s7, s7, 9
    v_lshrrev_b32 v1, 1, v253
    v_add_u32 v1, s7, v1
    buffer_load_dwordx2 v[2:3], v1, s[52:55], 0 offen
    s_mov_b32 s12, s18
    s_and_b32 s13, s19, 0xffff
    s_mov_b32 s14, 2359296
    s_mov_b32 s15, 0x20000
    s_mov_b32 s64, s20
    s_and_b32 s65, s21, 0xffff
    s_mov_b32 s66, 1990656
    s_mov_b32 s67, 0x20000
    s_mov_b32 s68, s22
    s_and_b32 s69, s23, 0xffff
    s_mov_b32 s70, 663552
    s_mov_b32 s71, 0x20000
    s_mov_b32 s16, 0xffff0000
    s_lshl_b32 s7, s3, 10
    v_add_u32 v172, s7, v253
    v_add_u32 v174, 5120, v172
    v_and_b32 v178, 7, v0
    v_mul_u32_u24 v178, 1152, v178
    v_lshrrev_b32 v179, 3, v0
    v_lshl_add_u32 v178, v179, 4, v178
    s_lshl_b32 s7, s3, 7
    v_add_u32 v175, s7, v178
    v_add_u32 v177, 640, v175
    s_cmp_eq_u32 s3, 0
    s_mov_b32 s17, 1073741824
    s_cmov_b32 s17, 4096
    v_add_u32 v173, s17, v172
    s_mov_b32 s17, 1073741824
    s_cmov_b32 s17, 512
    v_add_u32 v176, s17, v175
    s_lshl_b32 s21, s41, 3
    s_add_u32 s21, s21, s40
    s_mul_i32 s18, s21, 9216
    buffer_load_dwordx4 v[16:19], v175, s[12:15], s18 offen
    buffer_load_dwordx4 v[20:23], v176, s[12:15], s18 offen
    buffer_load_dwordx4 v[24:27], v177, s[12:15], s18 offen
    s_mov_b32 s12, s30
    s_and_b32 s13, s31, 0xffff
    s_mov_b32 s14, 2359296
    s_mov_b32 s15, 0x20000
    s_lshl_b32 s79, s3, 14
    s_add_u32 s79, s79, 98304
    s_lshl_b32 s78, s3, 13
    s_add_u32 s78, s78, 8192
    s_lshl_b32 s32, s3, 5
    s_add_u32 s32, s32, s41
    s_cmp_ge_u32 s32, 72
    s_cbranch_scc1 L_noq_1
    s_mul_i32 s33, s32, 58255
    s_lshr_b32 s33, s33, 20
    s_mul_i32 s34, s33, 18
    s_sub_u32 s34, s32, s34
    s_lshl_b32 s7, s40, 2
    s_add_u32 s33, s33, s7
    s_mul_i32 s35, s34, 110592
    s_mul_i32 s7, s33, 36
    s_add_u32 s35, s35, s7
    v_mov_b32 v13, 1073741824
    v_add_u32 v8, 0, v0
    v_mul_u32_u24 v9, 21846, v8
    v_lshrrev_b32 v9, 16, v9
    v_mul_u32_u24 v10, 3, v9
    v_sub_u32 v10, v8, v10
    v_and_b32 v11, 31, v9
    v_mul_u32_u24 v11, 3456, v11
    v_lshl_add_u32 v11, v10, 4, v11
    v_lshrrev_b32 v9, 5, v9
    v_mul_u32_u24 v9, 1152, v9
    s_add_u32 m0, s78, 0
    v_add_u32 v11, v11, v9
    buffer_load_dwordx4 v11, s[64:67], s35 offen lds
    v_add_u32 v8, 64, v0
    v_mul_u32_u24 v9, 21846, v8
    v_lshrrev_b32 v9, 16, v9
    v_mul_u32_u24 v10, 3, v9
    v_sub_u32 v10, v8, v10
    v_and_b32 v11, 31, v9
    v_mul_u32_u24 v11, 3456, v11
    v_lshl_add_u32 v11, v10, 4, v11
    v_lshrrev_b32 v9, 5, v9
    v_mul_u32_u24 v9, 1152, v9
    s_add_u32 m0, s78, 1024
    v_add_u32 v11, v11, v9
    buffer_load_dwordx4 v11, s[64:67], s35 offen lds
    v_add_u32 v8, 128, v0
    v_mul_u32_u24 v9, 21846, v8
    v_lshrrev_b32 v9, 16, v9
    v_mul_u32_u24 v10, 3, v9
    v_sub_u32 v10, v8, v10
    v_and_b32 v11, 31, v9
    v_mul_u32_u24 v11, 3456, v11
    v_lshl_add_u32 v11, v10, 4, v11
    v_lshrrev_b32 v9, 5, v9
    v_mul_u32_u24 v9, 1152, v9
    s_add_u32 m0, s78, 2048
    v_add_u32 v11, v11, v9
    buffer_load_dwordx4 v11, s[64:67], s35 offen lds
    v_add_u32 v8, 192, v0
    v_mul_u32_u24 v9, 21846, v8
    v_lshrrev_b32 v9, 16, v9
    v_mul_u32_u24 v10, 3, v9
    v_sub_u32 v10, v8, v10
    v_and_b32 v11, 31, v9
    v_mul_u32_u24 v11, 3456, v11
    v_lshl_add_u32 v11, v10, 4, v11
    v_lshrrev_b32 v9, 5, v9
    v_mul_u32_u24 v9, 1152, v9
    s_add_u32 m0, s78, 3072
    v_add_u32 v11, v11, v9
    buffer_load_dwordx4 v11, s[64:67], s35 offen lds
    v_add_u32 v8, 256, v0
    v_mul_u32_u24 v9, 21846, v8
    v_lshrrev_b32 v9, 16, v9
    v_mul_u32_u24 v10, 3, v9
    v_sub_u32 v10, v8, v10
    v_and_b32 v11, 31, v9
    v_mul_u32_u24 v11, 3456, v11
    v_lshl_add_u32 v11, v10, 4, v11
    v_lshrrev_b32 v9, 5, v9
    v_mul_u32_u24 v9, 1152, v9
    s_add_u32 m0, s78, 4096
    v_add_u32 v11, v11, v9
    v_cmp_gt_u32 vcc, 32, v0
    s_nop 1
    v_cndmask_b32 v11, v13, v11, vcc
    buffer_load_dwordx4 v11, s[64:67], s35 offen lds
L_noq_1:
    s_lshl_b32 s36, s41, 1
    s_lshr_b32 s7, s40, 2
    s_add_u32 s36, s36, s7
    s_and_b32 s37, s40, 3
    s_cmp_eq_u32 s3, 3
    s_cbranch_scc1 L_wbar_3
    s_mul_i32 s38, s36, 3
    s_add_u32 s38, s38, s3
    s_cmp_ge_u32 s38, 162
    s_cbranch_scc1 L_p3_4
    s_mul_i32 s39, s38, 58255
    s_lshr_b32 s39, s39, 20
    s_mul_i32 s45, s39, 18
    s_sub_u32 s45, s38, s45
    s_mul_i32 s7, s37, 9
    s_add_u32 s39, s39, s7
    s_lshl_b32 s7, s45, 2
    v_lshrrev_b32 v8, 4, v0
    v_add_u32 v8, s7, v8
    v_bfe_u32 v9, v0, 1, 3
    v_mul_u32_u24 v11, 7282, v8
    v_lshrrev_b32 v11, 16, v11
    v_mul_u32_u24 v12, 9, v11
    v_sub_u32 v12, v8, v12
    v_mul_u32_u24 v11, 72, v11
    v_cmp_eq_u32 vcc, 8, v12
    v_lshrrev_b32 v10, 1, v12
    v_mad_u32_u24 v10, v10, 18, v11
    v_and_b32 v12, 1, v12
    v_lshl_add_u32 v10, v12, 3, v10
    v_add_u32 v10, v10, v9
    v_lshrrev_b32 v12, 1, v9
    v_mad_u32_u24 v11, v12, 18, v11
    v_and_b32 v12, 1, v9
    v_add3_u32 v11, v11, v12, 16
    v_cndmask_b32 v10, v10, v11, vcc
    v_mul_u32_u24 v10, 1152, v10
    v_and_b32 v9, 1, v0
    v_lshl_add_u32 v10, v9, 4, v10
    s_add_u32 m0, s78, 6144
    s_lshl_b32 s7, s39, 5
    buffer_load_dwordx4 v10, s[68:71], s7 offen lds
    s_branch L_p3_4
L_wbar_3:
    s_cmp_ge_u32 s36, 36
    s_cbranch_scc1 L_p3_4
    s_lshl_b32 s7, s36, 1
    v_bfe_u32 v8, v0, 3, 1
    v_add_u32 v8, s7, v8
    v_and_b32 v9, 7, v0
    v_mul_u32_u24 v11, 7282, v8
    v_lshrrev_b32 v11, 16, v11
    v_mul_u32_u24 v12, 9, v11
    v_sub_u32 v12, v8, v12
    v_mul_u32_u24 v11, 72, v11
    v_cmp_eq_u32 vcc, 8, v12
    v_lshrrev_b32 v10, 1, v12
    v_mad_u32_u24 v10, v10, 18, v11
    v_and_b32 v12, 1, v12
    v_lshl_add_u32 v10, v12, 3, v10
    v_add_u32 v10, v10, v9
    v_lshrrev_b32 v12, 1, v9
    v_mad_u32_u24 v11, v12, 18, v11
    v_and_b32 v12, 1, v9
    v_add3_u32 v11, v11, v12, 16
    v_cndmask_b32 v10, v10, v11, vcc
    v_mul_u32_u24 v10, 1152, v10
    v_lshrrev_b32 v9, 4, v0
    v_lshl_add_u32 v10, v9, 4, v10
    buffer_load_dwordx4 v[64:67], v10, s[68:71], 0 offen offset:0
    buffer_load_dwordx4 v[68:71], v10, s[68:71], 0 offen offset:64
    buffer_load_dwordx4 v[72:75], v10, s[68:71], 0 offen offset:128
    buffer_load_dwordx4 v[76:79], v10, s[68:71], 0 offen offset:192
    buffer_load_dwordx4 v[80:83], v10, s[68:71], 0 offen offset:256
    buffer_load_dwordx4 v[84:87], v10, s[68:71], 0 offen offset:320
    buffer_load_dwordx4 v[88:91], v10, s[68:71], 0 offen offset:384
    buffer_load_dwordx4 v[92:95], v10, s[68:71], 0 offen offset:448
    buffer_load_dwordx4 v[96:99], v10, s[68:71], 0 offen offset:512
    buffer_load_dwordx4 v[100:103], v10, s[68:71], 0 offen offset:576
    buffer_load_dwordx4 v[104:107], v10, s[68:71], 0 offen offset:640
    buffer_load_dwordx4 v[108:111], v10, s[68:71], 0 offen offset:704
    buffer_load_dwordx4 v[112:115], v10, s[68:71], 0 offen offset:768
    buffer_load_dwordx4 v[116:119], v10, s[68:71], 0 offen offset:832
    buffer_load_dwordx4 v[120:123], v10, s[68:71], 0 offen offset:896
    buffer_load_dwordx4 v[124:127], v10, s[68:71], 0 offen offset:960
    buffer_load_dwordx4 v[128:131], v10, s[68:71], 0 offen offset:1024
    buffer_load_dwordx4 v[132:135], v10, s[68:71], 0 offen offset:1088
L_p3_4:
    s_lshl_b32 s7, s41, 2
    s_add_u32 s7, s7, s3
    s_mul_i32 s93, s7, 25576
    s_lshr_b32 s93, s93, 20
    s_min_u32 s93, s93, 2
    s_mul_i32 s6, s93, 41
    s_sub_u32 s7, s7, s6
    s_lshl_b32 s46, s7, 2
    s_cmp_eq_u32 s93, 1
    s_cselect_b32 s72, s26, s24
    s_cselect_b32 s73, s27, s25
    s_cmp_eq_u32 s93, 2
    s_cselect_b32 s72, s28, s72
    s_cselect_b32 s73, s29, s73
    s_mov_b32 s92, 73728
    s_cmov_b32 s92, 9216
    s_mov_b32 s47, 1152
    s_cmov_b32 s47, 663552
    s_and_b32 s73, s73, 0xffff
    s_mov_b32 s74, 5308416
    s_mov_b32 s75, 0x20000
    s_mul_i32 s47, s47, s40
    s_add_u32 s7, s46, 0
    s_min_u32 s7, s7, 161
    s_mul_i32 s84, s7, 116509
    s_lshr_b32 s84, s84, 20
    s_mul_i32 s88, s84, 9
    s_sub_u32 s88, s7, s88
    s_mul_i32 s7, s84, s92
    s_lshl_b32 s7, s7, 2
    s_add_u32 s7, s7, s47
    s_lshl_b32 s6, s88, 7
    s_add_u32 s80, s7, s6
    s_add_u32 s7, s46, 1
    s_min_u32 s7, s7, 161
    s_mul_i32 s85, s7, 116509
    s_lshr_b32 s85, s85, 20
    s_mul_i32 s89, s85, 9
    s_sub_u32 s89, s7, s89
    s_mul_i32 s7, s85, s92
    s_lshl_b32 s7, s7, 2
    s_add_u32 s7, s7, s47
    s_lshl_b32 s6, s89, 7
    s_add_u32 s81, s7, s6
    s_add_u32 s7, s46, 2
    s_min_u32 s7, s7, 161
    s_mul_i32 s86, s7, 116509
    s_lshr_b32 s86, s86, 20
    s_mul_i32 s90, s86, 9
    s_sub_u32 s90, s7, s90
    s_mul_i32 s7, s86, s92
    s_lshl_b32 s7, s7, 2
    s_add_u32 s7, s7, s47
    s_lshl_b32 s6, s90, 7
    s_add_u32 s82, s7, s6
    s_add_u32 s7, s46, 3
    s_min_u32 s7, s7, 161
    s_mul_i32 s87, s7, 116509
    s_lshr_b32 s87, s87, 20
    s_mul_i32 s91, s87, 9
    s_sub_u32 s91, s7, s91
    s_mul_i32 s7, s87, s92
    s_lshl_b32 s7, s7, 2
    s_add_u32 s7, s7, s47
    s_lshl_b32 s6, s91, 7
    s_add_u32 s83, s7, s6
    s_lshr_b32 s7, s92, 3
    v_lshrrev_b32 v224, 3, v0
    v_mul_lo_u32 v224, v224, s7
    v_and_b32 v8, 7, v0
    v_lshl_add_u32 v224, v8, 4, v224
    s_waitcnt lgkmcnt(0)
    s_mul_i32 s76, s76, 0x9e3779b1
    s_add_u32 s76, s76, 0x7f4a7c15
    s_mov_b32 s77, s76
    v_lshrrev_b32 v8, 4, v0
    v_lshlrev_b32 v8, 3, v8
    v_bfe_u32 v9, v0, 2, 2
    v_add_u32 v8, v8, v9
    v_mul_u32_u24 v8, 48, v8
    v_and_b32 v9, 3, v0
    v_lshl_add_u32 v8, v9, 3, v8
    v_add_u32 v8, s78, v8
    v_and_b32 v9, 3, v0
    v_min_u32 v10, 2, v9
    v_mul_u32_u24 v10, 1536, v10
    v_lshlrev_b32 v9, 3, v9
    v_sub_u32 v10, v10, v9
    v_add3_u32 v10, v10, v8, 32
    v_and_b32 v9, 15, v0
    v_cmp_gt_u32 s[22:23], 6, v9
    v_lshrrev_b32 v11, 1, v9
    v_and_b32 v12, 0x31, v0
    v_lshl_add_u32 v11, v11, 2, v12
    v_lshlrev_b32 v11, 2, v11
    s_add_u32 m0, s79, 0
    s_mov_b32 s47, s80
    buffer_load_dwordx4 v224, s[72:75], s47 offen nt lds
    s_add_u32 m0, s79, 1024
    s_add_u32 s47, s47, s92
    buffer_load_dwordx4 v224, s[72:75], s47 offen nt lds
    s_add_u32 m0, s79, 2048
    s_add_u32 s47, s47, s92
    buffer_load_dwordx4 v224, s[72:75], s47 offen nt lds
    s_add_u32 m0, s79, 3072
    s_add_u32 s47, s47, s92
    buffer_load_dwordx4 v224, s[72:75], s47 offen nt lds
    s_add_u32 m0, s79, 4096
    s_mov_b32 s47, s81
    buffer_load_dwordx4 v224, s[72:75], s47 offen nt lds
    s_add_u32 m0, s79, 5120
    s_add_u32 s47, s47, s92
    buffer_load_dwordx4 v224, s[72:75], s47 offen nt lds
    s_waitcnt vmcnt(6)
    s_cmp_ge_u32 s32, 72
    s_cbranch_scc1 L_noq_2
    ds_read_b64_tr_b16 v[44:45], v10
    ds_read_b64_tr_b16 v[46:47], v10 offset:192
    ds_read_b64_tr_b16 v[32:33], v8 offset:0
    ds_read_b64_tr_b16 v[34:35], v8 offset:192
    ds_read_b64_tr_b16 v[36:37], v8 offset:1536
    ds_read_b64_tr_b16 v[38:39], v8 offset:1728
    ds_read_b64_tr_b16 v[40:41], v8 offset:3072
    ds_read_b64_tr_b16 v[42:43], v8 offset:3264
    s_mul_i32 s33, s33, 18
    s_add_u32 s33, s33, s34
    s_lshl_b32 s33, s33, 12
    s_waitcnt lgkmcnt(6)
    ds_bpermute_b32 v44, v11, v44
    ds_bpermute_b32 v45, v11, v45
    ds_bpermute_b32 v46, v11, v46
    ds_bpermute_b32 v47, v11, v47
    s_waitcnt lgkmcnt(4)
    buffer_store_dwordx4 v[32:35], v253, s[8:11], s33 offen offset:0 sc1
    buffer_store_dwordx4 v[36:39], v253, s[8:11], s33 offen offset:1024 sc1
    buffer_store_dwordx4 v[40:43], v253, s[8:11], s33 offen offset:2048 sc1
    s_waitcnt lgkmcnt(0)
    v_cndmask_b32 v44, 0, v44, s[22:23]
    v_cndmask_b32 v45, 0, v45, s[22:23]
    v_cndmask_b32 v46, 0, v46, s[22:23]
    v_cndmask_b32 v47, 0, v47, s[22:23]
    buffer_store_dwordx4 v[44:47], v253, s[8:11], s33 offen offset:3072 sc1
L_noq_2:
    s_cmp_eq_u32 s3, 3
    s_cbranch_scc1 L_wbar_5
    s_cmp_ge_u32 s38, 162
    s_cbranch_scc1 L_p3_6
    v_lshrrev_b32 v8, 4, v0
    v_lshlrev_b32 v8, 3, v8
    v_bfe_u32 v9, v0, 2, 2
    v_add_u32 v8, v8, v9
    v_mul_u32_u24 v8, 32, v8
    v_and_b32 v9, 3, v0
    v_lshl_add_u32 v8, v9, 3, v8
    v_add_u32 v8, s78, v8
    ds_read_b64_tr_b16 v[28:29], v8 offset:6144
    ds_read_b64_tr_b16 v[30:31], v8 offset:6272
    s_mul_i32 s39, s39, 18
    s_add_u32 s39, s39, s45
    s_lshl_b32 s39, s39, 10
    s_add_u32 s39, s39, 2359296
    s_waitcnt lgkmcnt(0)
    buffer_store_dwordx4 v[28:31], v253, s[8:11], s39 offen sc1
    s_branch L_p3_6
L_wbar_5:
    s_cmp_ge_u32 s36, 36
    s_cbranch_scc1 L_p3_6
    v_mov_b32 v28, 0x3f803f80
    v_mov_b32 v29, 0x3f803f80
    v_mov_b32 v30, 0x3f803f80
    v_mov_b32 v31, 0x3f803f80
    v_and_b32 v9, 15, v0
    v_cmp_eq_u32 vcc, 0, v9
    v_cmp_eq_u32 s[22:23], 1, v9
    v_mfma_f32_16x16x32_bf16 v[32:35], v[64:67], v[28:31], 0
    v_mfma_f32_16x16x32_bf16 v[32:35], v[68:71], v[28:31], v[32:35]
    v_mfma_f32_16x16x32_bf16 v[32:35], v[72:75], v[28:31], v[32:35]
    v_mfma_f32_16x16x32_bf16 v[32:35], v[76:79], v[28:31], v[32:35]
    v_mfma_f32_16x16x32_bf16 v[32:35], v[80:83], v[28:31], v[32:35]
    v_mfma_f32_16x16x32_bf16 v[32:35], v[84:87], v[28:31], v[32:35]
    v_mfma_f32_16x16x32_bf16 v[32:35], v[88:91], v[28:31], v[32:35]
    v_mfma_f32_16x16x32_bf16 v[32:35], v[92:95], v[28:31], v[32:35]
    v_mfma_f32_16x16x32_bf16 v[32:35], v[96:99], v[28:31], v[32:35]
    v_mfma_f32_16x16x32_bf16 v[32:35], v[100:103], v[28:31], v[32:35]
    v_mfma_f32_16x16x32_bf16 v[32:35], v[104:107], v[28:31], v[32:35]
    v_mfma_f32_16x16x32_bf16 v[32:35], v[108:111], v[28:31], v[32:35]
    v_mfma_f32_16x16x32_bf16 v[32:35], v[112:115], v[28:31], v[32:35]
    v_mfma_f32_16x16x32_bf16 v[32:35], v[116:119], v[28:31], v[32:35]
    v_mfma_f32_16x16x32_bf16 v[32:35], v[120:123], v[28:31], v[32:35]
    v_mfma_f32_16x16x32_bf16 v[32:35], v[124:127], v[28:31], v[32:35]
    v_mfma_f32_16x16x32_bf16 v[32:35], v[128:131], v[28:31], v[32:35]
    v_mfma_f32_16x16x32_bf16 v[32:35], v[132:135], v[28:31], v[32:35]
    v_lshrrev_b32 v10, 5, v0
    v_lshlrev_b32 v10, 8, v10
    v_lshl_add_u32 v10, v9, 4, v10
    v_bfe_u32 v9, v0, 4, 1
    v_lshl_add_u32 v10, v9, 3, v10
    s_lshl_b32 s7, s36, 9
    s_mul_i32 s6, s37, 18432
    s_add_u32 s7, s7, s6
    s_add_u32 s7, s7, 3022848
    v_mul_f32 v32, 0x3ae38e39, v32
    v_mul_f32 v33, 0x3ae38e39, v33
    v_mul_f32 v34, 0x3ae38e39, v34
    v_mul_f32 v35, 0x3ae38e39, v35
    v_cvt_pk_bf16_f32 v36, v32, v33
    v_cvt_pk_bf16_f32 v37, v34, v35
    v_lshlrev_b32 v38, 16, v36
    v_and_b32 v39, s16, v36
    v_sub_f32 v38, v32, v38
    v_sub_f32 v39, v33, v39
    v_cvt_pk_bf16_f32 v28, v38, v39
    v_cndmask_b32 v28, 0, v28, s[22:23]
    v_cndmask_b32 v28, v28, v36, vcc
    v_lshlrev_b32 v38, 16, v37
    v_and_b32 v39, s16, v37
    v_sub_f32 v38, v34, v38
    v_sub_f32 v39, v35, v39
    v_cvt_pk_bf16_f32 v29, v38, v39
    v_cndmask_b32 v29, 0, v29, s[22:23]
    v_cndmask_b32 v29, v29, v37, vcc
    buffer_store_dwordx2 v[28:29], v10, s[8:11], s7 offen sc1
L_p3_6:
    s_add_u32 s19, s18, 43515904
    s_add_u32 s20, s18, 38797312
    s_lshl_b32 s22, s21, 7
    s_add_u32 s22, s22, 48234496
    buffer_store_dwordx4 v[16:19], v172, s[8:11], s19 offen sc1
    buffer_store_dwordx4 v[20:23], v173, s[8:11], s19 offen sc1
    buffer_store_dwordx4 v[24:27], v174, s[8:11], s19 offen sc1
    s_mov_b32 s17, 0x3f803f80
    v_mov_b32 v8, 0
    v_mov_b32 v9, 0
    v_mov_b32 v10, 0
    v_mov_b32 v11, 0
    v_dot2c_f32_bf16 v8, s17, v16
    v_dot2c_f32_bf16 v9, v16, v16
    v_dot2c_f32_bf16 v10, s17, v17
    v_dot2c_f32_bf16 v11, v17, v17
    v_dot2c_f32_bf16 v8, s17, v18
    v_dot2c_f32_bf16 v9, v18, v18
    v_dot2c_f32_bf16 v10, s17, v19
    v_dot2c_f32_bf16 v11, v19, v19
    v_dot2c_f32_bf16 v8, s17, v20
    v_dot2c_f32_bf16 v9, v20, v20
    v_dot2c_f32_bf16 v10, s17, v21
    v_dot2c_f32_bf16 v11, v21, v21
    v_dot2c_f32_bf16 v8, s17, v22
    v_dot2c_f32_bf16 v9, v22, v22
    v_dot2c_f32_bf16 v10, s17, v23
    v_dot2c_f32_bf16 v11, v23, v23
    v_dot2c_f32_bf16 v8, s17, v24
    v_dot2c_f32_bf16 v9, v24, v24
    v_dot2c_f32_bf16 v10, s17, v25
    v_dot2c_f32_bf16 v11, v25, v25
    v_dot2c_f32_bf16 v8, s17, v26
    v_dot2c_f32_bf16 v9, v26, v26
    v_dot2c_f32_bf16 v10, s17, v27
    v_dot2c_f32_bf16 v11, v27, v27
    v_and_b32 v12, 7, v0
    v_lshlrev_b32 v12, 3, v12
    s_lshl_b32 s7, s3, 6
    v_add_u32 v13, s7, v12
    v_pk_add_f32 v[8:9], v[8:9], v[10:11]
    s_nop 1
    v_add_f32_dpp v8, v8, v8 row_ror:8 row_mask:0xf bank_mask:0xf
    v_add_f32_dpp v9, v9, v9 row_ror:8 row_mask:0xf bank_mask:0xf
    v_mov_b32 v10, v8
    v_mov_b32 v11, v9
    s_nop 1
    v_permlane32_swap_b32 v10, v8
    v_permlane32_swap_b32 v11, v9
    v_add_f32 v8, v8, v10
    v_add_f32 v9, v9, v11
    v_mov_b32 v10, v8
    v_mov_b32 v11, v9
    s_nop 1
    v_permlane16_swap_b32 v10, v8
    v_permlane16_swap_b32 v11, v9
    v_add_f32 v8, v8, v10
    v_add_f32 v9, v9, v11
    ds_write_b64 v13, v[8:9]
    s_waitcnt lgkmcnt(0)
    s_barrier
    ds_read_b64 v[40:41], v12 offset:0
    ds_read_b64 v[42:43], v12 offset:64
    ds_read_b64 v[44:45], v12 offset:128
    ds_read_b64 v[46:47], v12 offset:192
    s_waitcnt lgkmcnt(0)
    v_pk_add_f32 v[40:41], v[40:41], v[42:43]
    v_pk_add_f32 v[44:45], v[44:45], v[46:47]
    v_pk_add_f32 v[8:9], v[40:41], v[44:45]
    v_mul_f32 v8, 0x3ae38e39, v8
    v_mul_f32 v9, 0x3ae38e39, v9
    v_fma_f32 v9, -v8, v8, v9
    v_max_f32 v9, 0, v9
    v_add_f32 v9, 0x3727c5ac, v9
    v_rsq_f32 v10, v9
    s_nop 0
    v_mul_f32 v12, v8, v10
    v_mov_b32 v11, v10
    v_sub_f32 v12, 0, v12
    v_mov_b32 v13, v12
    s_cmp_eq_u32 s3, 0
    s_cselect_b32 s7, 32, 0
    v_lshlrev_b32 v14, 2, v0
    v_cmp_gt_u32 vcc, s7, v0
    v_mov_b32 v9, 1073741824
    s_nop 0
    v_cndmask_b32 v14, v9, v14, vcc
    buffer_store_dword v8, v14, s[8:11], s22 offen sc1
    v_lshlrev_b32 v40, 16, v16
    v_and_b32 v41, s16, v16
    v_lshlrev_b32 v42, 16, v17
    v_and_b32 v43, s16, v17
    v_lshlrev_b32 v44, 16, v18
    v_and_b32 v45, s16, v18
    v_lshlrev_b32 v46, 16, v19
    v_and_b32 v47, s16, v19
    v_pk_fma_f32 v[40:41], v[40:41], v[10:11], v[12:13]
    v_pk_fma_f32 v[42:43], v[42:43], v[10:11], v[12:13]
    v_pk_fma_f32 v[44:45], v[44:45], v[10:11], v[12:13]
    v_pk_fma_f32 v[46:47], v[46:47], v[10:11], v[12:13]
    v_cvt_pk_bf16_f32 v48, v40, v41
    v_cvt_pk_bf16_f32 v49, v42, v43
    v_cvt_pk_bf16_f32 v50, v44, v45
    v_cvt_pk_bf16_f32 v51, v46, v47
    v_lshlrev_b32 v40, 16, v20
    v_and_b32 v41, s16, v20
    v_lshlrev_b32 v42, 16, v21
    v_and_b32 v43, s16, v21
    v_lshlrev_b32 v44, 16, v22
    v_and_b32 v45, s16, v22
    v_lshlrev_b32 v46, 16, v23
    v_and_b32 v47, s16, v23
    v_pk_fma_f32 v[40:41], v[40:41], v[10:11], v[12:13]
    v_pk_fma_f32 v[42:43], v[42:43], v[10:11], v[12:13]
    v_pk_fma_f32 v[44:45], v[44:45], v[10:11], v[12:13]
    v_pk_fma_f32 v[46:47], v[46:47], v[10:11], v[12:13]
    v_cvt_pk_bf16_f32 v52, v40, v41
    v_cvt_pk_bf16_f32 v53, v42, v43
    v_cvt_pk_bf16_f32 v54, v44, v45
    v_cvt_pk_bf16_f32 v55, v46, v47
    v_lshlrev_b32 v40, 16, v24
    v_and_b32 v41, s16, v24
    v_lshlrev_b32 v42, 16, v25
    v_and_b32 v43, s16, v25
    v_lshlrev_b32 v44, 16, v26
    v_and_b32 v45, s16, v26
    v_lshlrev_b32 v46, 16, v27
    v_and_b32 v47, s16, v27
    v_pk_fma_f32 v[40:41], v[40:41], v[10:11], v[12:13]
    v_pk_fma_f32 v[42:43], v[42:43], v[10:11], v[12:13]
    v_pk_fma_f32 v[44:45], v[44:45], v[10:11], v[12:13]
    v_pk_fma_f32 v[46:47], v[46:47], v[10:11], v[12:13]
    v_cvt_pk_bf16_f32 v56, v40, v41
    v_cvt_pk_bf16_f32 v57, v42, v43
    v_cvt_pk_bf16_f32 v58, v44, v45
    v_cvt_pk_bf16_f32 v59, v46, v47
    buffer_store_dwordx4 v[48:51], v172, s[8:11], s20 offen sc1
    buffer_store_dwordx4 v[52:55], v173, s[8:11], s20 offen sc1
    buffer_store_dwordx4 v[56:59], v174, s[8:11], s20 offen sc1
    v_lshlrev_b32 v15, 7, v0
    s_lshl_b32 s6, s40, 2
    s_add_u32 s6, s6, s44
    s_sub_u32 s6, s6, 32768
    v_mov_b32 v1, s76
    s_mov_b64 vcc, 0xff
    v_lshrrev_b32 v14, 3, v0
    v_lshl_add_u32 v15, v14, 3, v15
    s_cmp_ge_u32 s40, 6
    s_cselect_b32 s7, s41, 31
    s_cmp_lt_u32 s7, 31
    s_cmov_b64 vcc, 0xffff
    s_waitcnt vmcnt(0)
    s_barrier
    s_cmp_lg_u32 s3, 0
    s_cbranch_scc1 L_pub_7
    s_mov_b64 exec, vcc
    buffer_store_dword v1, v15, s[8:11], s6 offen sc1
    v_lshlrev_b32 v15, 10, v0
    s_lshl_b32 s6, s40, 7
    s_lshl_b32 s7, s41, 2
    s_add_u32 s6, s6, s7
    s_add_u32 s6, s6, 19431424
    s_mov_b64 exec, 0xffffffff
    v_lshlrev_b32 v15, 10, v0
    v_mov_b32 v1, s76
    buffer_store_dword v1, v15, s[8:11], s6 offen sc1
    s_lshl_b32 s6, s37, 8
    s_lshl_b32 s7, s36, 2
    s_add_u32 s6, s6, s7
    s_add_u32 s6, s6, 19496960
    s_mov_b64 exec, 1
    buffer_store_dword v1, off, s[8:11], s6 sc1
L_pub_7:
    s_mov_b64 exec, -1
    s_add_u32 m0, s79, 6144
    s_add_u32 s47, s47, s92
    buffer_load_dwordx4 v224, s[72:75], s47 offen nt lds
    s_add_u32 m0, s79, 7168
    s_add_u32 s47, s47, s92
    buffer_load_dwordx4 v224, s[72:75], s47 offen nt lds
    s_add_u32 m0, s79, 8192
    s_mov_b32 s47, s82
    buffer_load_dwordx4 v224, s[72:75], s47 offen nt lds
    s_add_u32 m0, s79, 9216
    s_add_u32 s47, s47, s92
    buffer_load_dwordx4 v224, s[72:75], s47 offen nt lds
    s_add_u32 m0, s79, 10240
    s_add_u32 s47, s47, s92
    buffer_load_dwordx4 v224, s[72:75], s47 offen nt lds
    s_add_u32 m0, s79, 11264
    s_add_u32 s47, s47, s92
    buffer_load_dwordx4 v224, s[72:75], s47 offen nt lds
    s_add_u32 m0, s79, 12288
    s_mov_b32 s47, s83
    buffer_load_dwordx4 v224, s[72:75], s47 offen nt lds
    s_add_u32 m0, s79, 13312
    s_add_u32 s47, s47, s92
    buffer_load_dwordx4 v224, s[72:75], s47 offen nt lds
    s_add_u32 m0, s79, 14336
    s_add_u32 s47, s47, s92
    buffer_load_dwordx4 v224, s[72:75], s47 offen nt lds
    s_add_u32 m0, s79, 15360
    s_add_u32 s47, s47, s92
    buffer_load_dwordx4 v224, s[72:75], s47 offen nt lds
    s_cmp_lg_u32 s3, 0
    s_cbranch_scc1 L_wq_ready_8
    s_lshl_b32 s7, s41, 3
    s_add_u32 s7, s7, s40
    s_lshl_b32 s7, s7, 7
    s_add_u32 s7, s7, 19431424
    s_add_u32 s68, s4, s7
    s_addc_u32 s69, s5, 0
    s_mov_b32 s6, 0
    s_mov_b32 s7, 0
L_cpoll_9:
    s_load_dwordx16 s[52:67], s[68:69], s7 glc
    s_add_u32 s6, s6, 1
    s_waitcnt lgkmcnt(0)
    s_xor_b64 s[52:53], s[52:53], s[76:77]
    s_xor_b64 s[54:55], s[54:55], s[76:77]
    s_xor_b64 s[56:57], s[56:57], s[76:77]
    s_xor_b64 s[58:59], s[58:59], s[76:77]
    s_xor_b64 s[60:61], s[60:61], s[76:77]
    s_xor_b64 s[62:63], s[62:63], s[76:77]
    s_xor_b64 s[64:65], s[64:65], s[76:77]
    s_xor_b64 s[66:67], s[66:67], s[76:77]
    s_or_b64 s[52:53], s[52:53], s[60:61]
    s_or_b64 s[54:55], s[54:55], s[62:63]
    s_or_b64 s[56:57], s[56:57], s[64:65]
    s_or_b64 s[58:59], s[58:59], s[66:67]
    s_or_b64 s[52:53], s[52:53], s[56:57]
    s_or_b64 s[54:55], s[54:55], s[58:59]
    s_or_b64 s[52:53], s[52:53], s[54:55]
    s_cbranch_scc1 L_cpoll_10
    s_add_u32 s7, s7, 64
    s_cmp_eq_u32 s7, 128
    s_cbranch_scc1 L_cpolled_11
L_cpoll_10:
    s_cmp_lt_u32 s6, 1048576
    s_cbranch_scc1 L_cpoll_9
    s_branch L_main_end
L_cpolled_11:
L_wq_ready_8:
    s_barrier
    s_lshl_b32 s28, s40, 2
    s_add_u32 s28, s28, s3
    s_mul_i32 s28, s28, 73728
    buffer_load_dwordx4 a[0:3], v253, s[8:11], s28 offen offset:0 sc1
    buffer_load_dwordx4 a[4:7], v253, s[8:11], s28 offen offset:1024 sc1
    buffer_load_dwordx4 a[8:11], v253, s[8:11], s28 offen offset:2048 sc1
    buffer_load_dwordx4 a[12:15], v253, s[8:11], s28 offen offset:3072 sc1
    s_add_u32 s28, s28, 4096
    buffer_load_dwordx4 a[16:19], v253, s[8:11], s28 offen offset:0 sc1
    buffer_load_dwordx4 a[20:23], v253, s[8:11], s28 offen offset:1024 sc1
    buffer_load_dwordx4 a[24:27], v253, s[8:11], s28 offen offset:2048 sc1
    buffer_load_dwordx4 a[28:31], v253, s[8:11], s28 offen offset:3072 sc1
    s_add_u32 s28, s28, 4096
    buffer_load_dwordx4 a[32:35], v253, s[8:11], s28 offen offset:0 sc1
    buffer_load_dwordx4 a[36:39], v253, s[8:11], s28 offen offset:1024 sc1
    buffer_load_dwordx4 a[40:43], v253, s[8:11], s28 offen offset:2048 sc1
    buffer_load_dwordx4 a[44:47], v253, s[8:11], s28 offen offset:3072 sc1
    s_add_u32 s28, s28, 4096
    buffer_load_dwordx4 a[48:51], v253, s[8:11], s28 offen offset:0 sc1
    buffer_load_dwordx4 a[52:55], v253, s[8:11], s28 offen offset:1024 sc1
    buffer_load_dwordx4 a[56:59], v253, s[8:11], s28 offen offset:2048 sc1
    buffer_load_dwordx4 a[60:63], v253, s[8:11], s28 offen offset:3072 sc1
    s_add_u32 s28, s28, 4096
    buffer_load_dwordx4 a[64:67], v253, s[8:11], s28 offen offset:0 sc1
    buffer_load_dwordx4 a[68:71], v253, s[8:11], s28 offen offset:1024 sc1
    buffer_load_dwordx4 a[72:75], v253, s[8:11], s28 offen offset:2048 sc1
    buffer_load_dwordx4 a[76:79], v253, s[8:11], s28 offen offset:3072 sc1
    s_add_u32 s28, s28, 4096
    buffer_load_dwordx4 a[80:83], v253, s[8:11], s28 offen offset:0 sc1
    buffer_load_dwordx4 a[84:87], v253, s[8:11], s28 offen offset:1024 sc1
    buffer_load_dwordx4 a[88:91], v253, s[8:11], s28 offen offset:2048 sc1
    buffer_load_dwordx4 a[92:95], v253, s[8:11], s28 offen offset:3072 sc1
    s_add_u32 s28, s28, 4096
L_main_layer:
    buffer_load_dwordx4 a[96:99], v253, s[8:11], s28 offen offset:0 sc1
    buffer_load_dwordx4 a[100:103], v253, s[8:11], s28 offen offset:1024 sc1
    buffer_load_dwordx4 a[104:107], v253, s[8:11], s28 offen offset:2048 sc1
    buffer_load_dwordx4 a[108:111], v253, s[8:11], s28 offen offset:3072 sc1
    s_add_u32 s28, s28, 4096
    buffer_load_dwordx4 a[112:115], v253, s[8:11], s28 offen offset:0 sc1
    buffer_load_dwordx4 a[116:119], v253, s[8:11], s28 offen offset:1024 sc1
    buffer_load_dwordx4 a[120:123], v253, s[8:11], s28 offen offset:2048 sc1
    buffer_load_dwordx4 a[124:127], v253, s[8:11], s28 offen offset:3072 sc1
    s_add_u32 s28, s28, 4096
    buffer_load_dwordx4 a[128:131], v253, s[8:11], s28 offen offset:0 sc1
    buffer_load_dwordx4 a[132:135], v253, s[8:11], s28 offen offset:1024 sc1
    buffer_load_dwordx4 a[136:139], v253, s[8:11], s28 offen offset:2048 sc1
    buffer_load_dwordx4 a[140:143], v253, s[8:11], s28 offen offset:3072 sc1
    s_add_u32 s28, s28, 4096
    v_bfe_u32 v3, v0, 3, 1
    v_mul_u32_u24 v2, 9216, v3
    v_lshrrev_b32 v3, 4, v0
    v_lshl_add_u32 v2, v3, 7, v2
    v_and_b32 v3, 7, v0
    v_lshl_add_u32 v2, v3, 4, v2
    v_bfe_u32 v3, v0, 3, 2
    s_mov_b32 s7, 9216
    v_mul_lo_u32 v9, v3, s7
    v_lshrrev_b32 v3, 5, v0
    v_lshl_add_u32 v9, v3, 7, v9
    v_and_b32 v3, 7, v0
    v_lshl_add_u32 v9, v3, 4, v9
    s_mul_i32 s22, s41, 73728
    s_add_u32 s22, s22, s43
    s_add_u32 s23, s22, 38797312
    s_mul_i32 s7, s3, 18432
    s_add_u32 s24, s23, s7
    s_cmp_eq_u32 s41, 0
    s_cselect_b32 s7, 0, 18432
    s_sub_u32 s23, s23, s7
    s_lshl_b32 s25, s3, 10
    s_add_u32 s25, s25, 1024
    s_mul_i32 s26, s3, 5120
    s_lshl_b32 s7, s3, 9
    s_add_u32 s27, s23, s7
    s_and_b32 s7, s3, 1
    s_add_u32 s7, s7, 4
    s_mul_i32 s29, s7, 5120
    s_lshl_b32 s7, s7, 9
    s_add_u32 s23, s23, s7
    s_cmp_lg_u32 s3, 0
    s_cbranch_scc1 L_pollout_14
    s_lshl_b32 s7, s40, 7
    s_add_u32 s7, s7, s44
    s_sub_u32 s7, s7, 32768
    s_add_u32 s52, s4, s7
    s_addc_u32 s53, s5, 0
    s_cmp_eq_u32 s41, 0
    s_cselect_b32 s7, 0, 32
    s_mov_b32 s6, 0
L_poll_12:
    s_load_dwordx8 s[56:63], s[52:53], 0 glc
    s_load_dwordx2 s[54:55], s[52:53], s7 glc
    s_add_u32 s6, s6, 1
    s_waitcnt lgkmcnt(0)
    s_xor_b64 s[54:55], s[54:55], s[76:77]
    s_xor_b64 s[56:57], s[56:57], s[76:77]
    s_xor_b64 s[58:59], s[58:59], s[76:77]
    s_xor_b64 s[60:61], s[60:61], s[76:77]
    s_xor_b64 s[62:63], s[62:63], s[76:77]
    s_or_b64 s[56:57], s[56:57], s[58:59]
    s_or_b64 s[60:61], s[60:61], s[62:63]
    s_or_b64 s[56:57], s[56:57], s[54:55]
    s_or_b64 s[56:57], s[56:57], s[60:61]
    s_cbranch_scc0 L_polled_13
    s_cmp_lt_u32 s6, 1048576
    s_cbranch_scc1 L_poll_12
    s_branch L_main_end
L_polled_13:
L_pollout_14:
    s_barrier
    s_add_u32 m0, s25, 0
    s_nop 0
    buffer_load_dwordx4 v2, s[8:11], s24 offen offset:0 sc1 lds
    s_add_u32 m0, s25, 4608
    s_nop 0
    buffer_load_dwordx4 v2, s[8:11], s24 offen offset:512 sc1 lds
    s_add_u32 m0, s25, 9216
    s_nop 0
    buffer_load_dwordx4 v2, s[8:11], s24 offen offset:1024 sc1 lds
    s_add_u32 m0, s25, 13824
    s_nop 0
    buffer_load_dwordx4 v2, s[8:11], s24 offen offset:1536 sc1 lds
    s_add_u32 m0, s25, 18432
    s_nop 0
    buffer_load_dwordx4 v2, s[8:11], s24 offen offset:2048 sc1 lds
    s_add_u32 m0, s25, 23040
    s_nop 0
    buffer_load_dwordx4 v2, s[8:11], s24 offen offset:2560 sc1 lds
    s_add_u32 m0, s26, 0
    s_add_u32 s7, s27, 0
    buffer_load_dwordx4 v2, s[8:11], s7 offen sc1 lds
    s_add_u32 m0, s29, 0
    s_add_u32 s7, s23, 0
    buffer_load_dwordx4 v2, s[8:11], s7 offen sc1 lds
    v_mov_b32 v132, 0
    v_mov_b32 v133, 0
    v_mov_b32 v192, 0
    v_mov_b32 v193, 0
    v_mov_b32 v195, 0
    v_mov_b32 v135, 0
    v_mov_b32 v139, 0
    v_mov_b32 v143, 0
    v_mov_b32 v147, 0
    v_mov_b32 v151, 0
    v_mov_b32 v155, 0
    v_mov_b32 v159, 0
    v_mov_b32 v163, 0
    v_mov_b32 v167, 0
    v_mov_b32 v171, 0
    v_cmp_eq_u32 vcc, 16, v0
    v_mov_b32 v10, 0x3f80
    v_cmp_eq_u32 s[20:21], 17, v0
    v_cndmask_b32 v194, 0, v10, vcc
    v_and_b32 v11, 3, v0
    v_cndmask_b32 v194, v194, 1.0, s[20:21]
    v_cmp_eq_u32 vcc, 2, v11
    v_and_b32 v10, 15, v0
    v_lshrrev_b32 v11, 4, v0
    v_cndmask_b32 v196, 0, 1.0, vcc
    v_cndmask_b32 v197, 0, 1.0, vcc
    v_cndmask_b32 v198, 0, 1.0, vcc
    v_cndmask_b32 v199, 0, 1.0, vcc
    v_lshlrev_b32 v11, 2, v11
    v_sub_u32 v10, v11, v10
    v_mov_b32 v12, 0xf149f2ca
    s_cmp_eq_u32 s41, 0
    s_cselect_b64 s[38:39], 0, -1
    v_add_u32 v11, 0, v10
    v_and_b32 v13, 1, v11
    v_cmp_eq_u32 s[20:21], 0, v13
    v_cmp_lt_i32 vcc, 1, v11
    v_cmp_gt_i32 s[18:19], 1, v11
    s_and_b64 vcc, vcc, s[20:21]
    s_and_b64 s[18:19], s[18:19], s[20:21]
    s_and_b64 s[20:21], vcc, s[38:39]
    v_cndmask_b32 v200, v12, 0, vcc
    v_cndmask_b32 v204, v12, 0, s[18:19]
    v_cndmask_b32 v208, v12, 0, s[20:21]
    v_add_u32 v11, 1, v10
    v_and_b32 v13, 1, v11
    v_cmp_eq_u32 s[20:21], 0, v13
    v_cmp_lt_i32 vcc, 1, v11
    v_cmp_gt_i32 s[18:19], 1, v11
    s_and_b64 vcc, vcc, s[20:21]
    s_and_b64 s[18:19], s[18:19], s[20:21]
    s_and_b64 s[20:21], vcc, s[38:39]
    v_cndmask_b32 v201, v12, 0, vcc
    v_cndmask_b32 v205, v12, 0, s[18:19]
    v_cndmask_b32 v209, v12, 0, s[20:21]
    v_add_u32 v11, 2, v10
    v_and_b32 v13, 1, v11
    v_cmp_eq_u32 s[20:21], 0, v13
    v_cmp_lt_i32 vcc, 1, v11
    v_cmp_gt_i32 s[18:19], 1, v11
    s_and_b64 vcc, vcc, s[20:21]
    s_and_b64 s[18:19], s[18:19], s[20:21]
    s_and_b64 s[20:21], vcc, s[38:39]
    v_cndmask_b32 v202, v12, 0, vcc
    v_cndmask_b32 v206, v12, 0, s[18:19]
    v_cndmask_b32 v210, v12, 0, s[20:21]
    v_add_u32 v11, 3, v10
    v_and_b32 v13, 1, v11
    v_cmp_eq_u32 s[20:21], 0, v13
    v_cmp_lt_i32 vcc, 1, v11
    v_cmp_gt_i32 s[18:19], 1, v11
    s_and_b64 vcc, vcc, s[20:21]
    s_and_b64 s[18:19], s[18:19], s[20:21]
    s_and_b64 s[20:21], vcc, s[38:39]
    v_cndmask_b32 v203, v12, 0, vcc
    v_cndmask_b32 v207, v12, 0, s[18:19]
    v_cndmask_b32 v211, v12, 0, s[20:21]
    s_lshl_b32 s45, s41, 1
    s_lshr_b32 s7, s40, 2
    s_add_u32 s45, s45, s7
    s_mul_i32 s30, s45, 36864
    s_add_u32 s30, s30, s43
    s_and_b32 s31, s40, 3
    s_mul_i32 s31, s31, 9
    s_add_u32 s31, s31, s3
    s_mul_i32 s32, s31, 18432
    s_add_u32 s32, s32, 2359296
    s_add_u32 s33, s32, 73728
    s_add_u32 s34, s32, 147456
    s_and_b32 s7, s40, 3
    s_mul_i32 s6, s7, 18432
    s_add_u32 s6, s6, 3022848
    s_lshl_b32 s39, s7, 8
    s_add_u32 s39, s39, 19496960
    v_lshlrev_b32 v226, 2, v0
    s_cmp_eq_u32 s3, 1
    s_cmov_b32 s34, s6
    s_cmp_lt_u32 s3, 2
    s_cselect_b32 s35, 0, 1073741824
    v_add_u32 v5, s35, v253
    s_cmp_eq_u32 s3, 0
    s_cselect_b32 s35, 0, 1073741824
    v_add_u32 v7, s35, v9
    s_lshl_b32 s7, s31, 8
    s_add_u32 s36, s30, s7
    s_add_u32 s37, s36, 43515904
    s_add_u32 s46, s36, 45875200
    s_lshl_b32 s36, s45, 7
    s_add_u32 s36, s36, s43
    s_add_u32 s36, s36, 48431104
    s_lshl_b32 s47, s45, 9
    s_add_u32 s47, s47, s43
    s_add_u32 s47, s47, 48234496
    v_bfe_u32 v10, v0, 3, 2
    v_and_b32 v8, 7, v0
    v_lshlrev_b32 v8, 2, v8
    v_lshl_add_u32 v8, v10, 7, v8
    v_add_u32 v6, 46080, v253
    s_waitcnt vmcnt(0)
    s_barrier
    ds_read_b128 v[16:19], v253 offset:0
    ds_read_b128 v[20:23], v253 offset:1024
    ds_read_b128 v[24:27], v253 offset:2048
    ds_read_b128 v[28:31], v253 offset:3072
    ds_read_b128 v[32:35], v253 offset:4096
    s_waitcnt lgkmcnt(0)
    v_mfma_f32_16x16x32_bf16 v[56:59], a[0:3], v[20:23], 0
    ds_read_b128 v[36:39], v253 offset:5120
    v_mfma_f32_16x16x32_bf16 v[60:63], a[0:3], v[24:27], 0
    ds_read_b128 v[40:43], v253 offset:6144
    v_mfma_f32_16x16x32_bf16 v[64:67], a[0:3], v[28:31], 0
    ds_read_b128 v[44:47], v253 offset:7168
    v_mfma_f32_16x16x32_bf16 v[68:71], a[0:3], v[32:35], 0
    ds_read_b128 v[48:51], v253 offset:8192
    v_mfma_f32_16x16x32_bf16 v[72:75], a[4:7], v[16:19], 0
    ds_read_b128 v[52:55], v253 offset:9216
    v_mfma_f32_16x16x32_bf16 v[76:79], a[4:7], v[20:23], 0
    s_add_u32 m0, s25, 27648
    s_nop 0
    buffer_load_dwordx4 v2, s[8:11], s24 offen offset:3072 sc1 lds
    v_mfma_f32_16x16x32_bf16 v[80:83], a[4:7], v[24:27], 0
    v_mfma_f32_16x16x32_bf16 v[84:87], a[4:7], v[28:31], 0
    s_add_u32 m0, s25, 32256
    s_nop 0
    buffer_load_dwordx4 v2, s[8:11], s24 offen offset:3584 sc1 lds
    v_mfma_f32_16x16x32_bf16 v[88:91], a[4:7], v[32:35], 0
    v_mfma_f32_16x16x32_bf16 v[92:95], v[16:19], a[8:11], 0
    buffer_load_dwordx4 a[144:147], v253, s[8:11], s28 offen offset:0 sc1
    v_mfma_f32_16x16x32_bf16 v[96:99], v[20:23], a[8:11], 0
    v_mfma_f32_16x16x32_bf16 v[100:103], v[24:27], a[8:11], 0
    buffer_load_dwordx4 a[148:151], v253, s[8:11], s28 offen offset:1024 sc1
    v_mfma_f32_16x16x32_bf16 v[104:107], v[28:31], a[8:11], 0
    v_mfma_f32_16x16x32_bf16 v[108:111], v[32:35], a[8:11], 0
    buffer_load_dwordx4 a[152:155], v253, s[8:11], s28 offen offset:2048 sc1
    v_mfma_f32_16x16x32_bf16 v[112:115], a[12:15], v[16:19], 0
    v_mfma_f32_16x16x32_bf16 v[116:119], a[12:15], v[20:23], 0
    v_mfma_f32_16x16x32_bf16 v[120:123], a[12:15], v[24:27], 0
    v_mfma_f32_16x16x32_bf16 v[124:127], a[12:15], v[28:31], 0
    v_mfma_f32_16x16x32_bf16 v[128:131], a[12:15], v[32:35], 0
    s_waitcnt lgkmcnt(0)
    v_mfma_f32_16x16x32_bf16 v[56:59], a[16:19], v[40:43], v[56:59]
    ds_read_b128 v[16:19], v253 offset:10240
    v_mfma_f32_16x16x32_bf16 v[60:63], a[16:19], v[44:47], v[60:63]
    ds_read_b128 v[20:23], v253 offset:11264
    v_mfma_f32_16x16x32_bf16 v[64:67], a[16:19], v[48:51], v[64:67]
    ds_read_b128 v[24:27], v253 offset:12288
    v_mfma_f32_16x16x32_bf16 v[68:71], a[16:19], v[52:55], v[68:71]
    ds_read_b128 v[28:31], v253 offset:13312
    v_mfma_f32_16x16x32_bf16 v[72:75], a[20:23], v[36:39], v[72:75]
    ds_read_b128 v[32:35], v253 offset:14336
    v_mfma_f32_16x16x32_bf16 v[76:79], a[20:23], v[40:43], v[76:79]
    s_add_u32 m0, s25, 40960
    s_add_u32 s24, s24, 4096
    buffer_load_dwordx4 v2, s[8:11], s24 offen offset:0 sc1 lds
    v_mfma_f32_16x16x32_bf16 v[80:83], a[20:23], v[44:47], v[80:83]
    v_mfma_f32_16x16x32_bf16 v[84:87], a[20:23], v[48:51], v[84:87]
    s_add_u32 m0, s25, 45568
    s_nop 0
    buffer_load_dwordx4 v2, s[8:11], s24 offen offset:512 sc1 lds
    v_mfma_f32_16x16x32_bf16 v[88:91], a[20:23], v[52:55], v[88:91]
    v_mfma_f32_16x16x32_bf16 v[92:95], v[36:39], a[24:27], v[92:95]
    buffer_load_dwordx4 a[156:159], v253, s[8:11], s28 offen offset:3072 sc1
    s_add_u32 s28, s28, 4096
    v_mfma_f32_16x16x32_bf16 v[96:99], v[40:43], a[24:27], v[96:99]
    v_mfma_f32_16x16x32_bf16 v[100:103], v[44:47], a[24:27], v[100:103]
    buffer_load_dwordx4 a[0:3], v253, s[8:11], s28 offen offset:0 sc1
    v_mfma_f32_16x16x32_bf16 v[104:107], v[48:51], a[24:27], v[104:107]
    v_mfma_f32_16x16x32_bf16 v[108:111], v[52:55], a[24:27], v[108:111]
    buffer_load_dwordx4 a[4:7], v253, s[8:11], s28 offen offset:1024 sc1
    v_mfma_f32_16x16x32_bf16 v[112:115], a[28:31], v[36:39], v[112:115]
    v_mfma_f32_16x16x32_bf16 v[116:119], a[28:31], v[40:43], v[116:119]
    v_mfma_f32_16x16x32_bf16 v[120:123], a[28:31], v[44:47], v[120:123]
    v_mfma_f32_16x16x32_bf16 v[124:127], a[28:31], v[48:51], v[124:127]
    v_mfma_f32_16x16x32_bf16 v[128:131], a[28:31], v[52:55], v[128:131]
    s_waitcnt lgkmcnt(0)
    v_mfma_f32_16x16x32_bf16 v[56:59], a[32:35], v[20:23], v[56:59]
    ds_read_b128 v[36:39], v253 offset:15360
    v_mfma_f32_16x16x32_bf16 v[60:63], a[32:35], v[24:27], v[60:63]
    ds_read_b128 v[40:43], v253 offset:16384
    v_mfma_f32_16x16x32_bf16 v[64:67], a[32:35], v[28:31], v[64:67]
    ds_read_b128 v[44:47], v253 offset:17408
    v_mfma_f32_16x16x32_bf16 v[68:71], a[32:35], v[32:35], v[68:71]
    ds_read_b128 v[48:51], v253 offset:18432
    v_mfma_f32_16x16x32_bf16 v[72:75], a[36:39], v[16:19], v[72:75]
    ds_read_b128 v[52:55], v253 offset:19456
    v_mfma_f32_16x16x32_bf16 v[76:79], a[36:39], v[20:23], v[76:79]
    s_add_u32 m0, s25, 50176
    s_nop 0
    buffer_load_dwordx4 v2, s[8:11], s24 offen offset:1024 sc1 lds
    v_mfma_f32_16x16x32_bf16 v[80:83], a[36:39], v[24:27], v[80:83]
    v_mfma_f32_16x16x32_bf16 v[84:87], a[36:39], v[28:31], v[84:87]
    s_add_u32 m0, s25, 54784
    s_nop 0
    buffer_load_dwordx4 v2, s[8:11], s24 offen offset:1536 sc1 lds
    v_mfma_f32_16x16x32_bf16 v[88:91], a[36:39], v[32:35], v[88:91]
    v_mfma_f32_16x16x32_bf16 v[92:95], v[16:19], a[40:43], v[92:95]
    buffer_load_dwordx4 a[8:11], v253, s[8:11], s28 offen offset:2048 sc1
    v_mfma_f32_16x16x32_bf16 v[96:99], v[20:23], a[40:43], v[96:99]
    v_mfma_f32_16x16x32_bf16 v[100:103], v[24:27], a[40:43], v[100:103]
    buffer_load_dwordx4 a[12:15], v253, s[8:11], s28 offen offset:3072 sc1
    s_add_u32 s28, s28, 4096
    v_mfma_f32_16x16x32_bf16 v[104:107], v[28:31], a[40:43], v[104:107]
    v_mfma_f32_16x16x32_bf16 v[108:111], v[32:35], a[40:43], v[108:111]
    buffer_load_dwordx4 a[16:19], v253, s[8:11], s28 offen offset:0 sc1
    v_mfma_f32_16x16x32_bf16 v[112:115], a[44:47], v[16:19], v[112:115]
    v_mfma_f32_16x16x32_bf16 v[116:119], a[44:47], v[20:23], v[116:119]
    v_mfma_f32_16x16x32_bf16 v[120:123], a[44:47], v[24:27], v[120:123]
    v_mfma_f32_16x16x32_bf16 v[124:127], a[44:47], v[28:31], v[124:127]
    v_mfma_f32_16x16x32_bf16 v[128:131], a[44:47], v[32:35], v[128:131]
    s_waitcnt lgkmcnt(0)
    v_mfma_f32_16x16x32_bf16 v[56:59], a[48:51], v[40:43], v[56:59]
    ds_read_b128 v[16:19], v253 offset:20480
    v_mfma_f32_16x16x32_bf16 v[60:63], a[48:51], v[44:47], v[60:63]
    ds_read_b128 v[20:23], v253 offset:21504
    v_mfma_f32_16x16x32_bf16 v[64:67], a[48:51], v[48:51], v[64:67]
    ds_read_b128 v[24:27], v253 offset:22528
    v_mfma_f32_16x16x32_bf16 v[68:71], a[48:51], v[52:55], v[68:71]
    ds_read_b128 v[28:31], v253 offset:23552
    v_mfma_f32_16x16x32_bf16 v[72:75], a[52:55], v[36:39], v[72:75]
    ds_read_b128 v[32:35], v253 offset:24576
    v_mfma_f32_16x16x32_bf16 v[76:79], a[52:55], v[40:43], v[76:79]
    s_add_u32 m0, s26, 30720
    s_add_u32 s7, s27, 3072
    buffer_load_dwordx4 v2, s[8:11], s7 offen sc1 lds
    v_mfma_f32_16x16x32_bf16 v[80:83], a[52:55], v[44:47], v[80:83]
    v_mfma_f32_16x16x32_bf16 v[84:87], a[52:55], v[48:51], v[84:87]
    s_add_u32 m0, s29, 30720
    s_add_u32 s7, s23, 3072
    buffer_load_dwordx4 v2, s[8:11], s7 offen sc1 lds
    v_mfma_f32_16x16x32_bf16 v[88:91], a[52:55], v[52:55], v[88:91]
    v_mfma_f32_16x16x32_bf16 v[92:95], v[36:39], a[56:59], v[92:95]
    buffer_load_dwordx4 a[20:23], v253, s[8:11], s28 offen offset:1024 sc1
    v_mfma_f32_16x16x32_bf16 v[96:99], v[40:43], a[56:59], v[96:99]
    v_mfma_f32_16x16x32_bf16 v[100:103], v[44:47], a[56:59], v[100:103]
    buffer_load_dwordx4 a[24:27], v253, s[8:11], s28 offen offset:2048 sc1
    v_mfma_f32_16x16x32_bf16 v[104:107], v[48:51], a[56:59], v[104:107]
    v_mfma_f32_16x16x32_bf16 v[108:111], v[52:55], a[56:59], v[108:111]
    buffer_load_dwordx4 a[28:31], v253, s[8:11], s28 offen offset:3072 sc1
    s_add_u32 s28, s28, 4096
    v_mfma_f32_16x16x32_bf16 v[112:115], a[60:63], v[36:39], v[112:115]
    v_mfma_f32_16x16x32_bf16 v[116:119], a[60:63], v[40:43], v[116:119]
    v_mfma_f32_16x16x32_bf16 v[120:123], a[60:63], v[44:47], v[120:123]
    v_mfma_f32_16x16x32_bf16 v[124:127], a[60:63], v[48:51], v[124:127]
    v_mfma_f32_16x16x32_bf16 v[128:131], a[60:63], v[52:55], v[128:131]
    s_waitcnt lgkmcnt(0)
    v_mfma_f32_16x16x32_bf16 v[56:59], a[64:67], v[20:23], v[56:59]
    ds_read_b128 v[36:39], v253 offset:25600
    v_mfma_f32_16x16x32_bf16 v[60:63], a[64:67], v[24:27], v[60:63]
    ds_read_b128 v[40:43], v253 offset:26624
    v_mfma_f32_16x16x32_bf16 v[64:67], a[64:67], v[28:31], v[64:67]
    ds_read_b128 v[44:47], v253 offset:27648
    v_mfma_f32_16x16x32_bf16 v[68:71], a[64:67], v[32:35], v[68:71]
    ds_read_b128 v[48:51], v253 offset:28672
    v_mfma_f32_16x16x32_bf16 v[72:75], a[68:71], v[16:19], v[72:75]
    ds_read_b128 v[52:55], v253 offset:29696
    v_mfma_f32_16x16x32_bf16 v[76:79], a[68:71], v[20:23], v[76:79]
    buffer_load_dwordx4 a[32:35], v253, s[8:11], s28 offen offset:0 sc1
    v_mfma_f32_16x16x32_bf16 v[80:83], a[68:71], v[24:27], v[80:83]
    v_mfma_f32_16x16x32_bf16 v[84:87], a[68:71], v[28:31], v[84:87]
    buffer_load_dwordx4 a[36:39], v253, s[8:11], s28 offen offset:1024 sc1
    v_mfma_f32_16x16x32_bf16 v[88:91], a[68:71], v[32:35], v[88:91]
    v_mfma_f32_16x16x32_bf16 v[92:95], v[16:19], a[72:75], v[92:95]
    buffer_load_dwordx4 a[40:43], v253, s[8:11], s28 offen offset:2048 sc1
    v_mfma_f32_16x16x32_bf16 v[96:99], v[20:23], a[72:75], v[96:99]
    v_mfma_f32_16x16x32_bf16 v[100:103], v[24:27], a[72:75], v[100:103]
    buffer_load_dword v225, v226, s[8:11], s39 offen sc1
    v_mfma_f32_16x16x32_bf16 v[104:107], v[28:31], a[72:75], v[104:107]
    v_mfma_f32_16x16x32_bf16 v[108:111], v[32:35], a[72:75], v[108:111]
    v_mfma_f32_16x16x32_bf16 v[112:115], a[76:79], v[16:19], v[112:115]
    v_mfma_f32_16x16x32_bf16 v[116:119], a[76:79], v[20:23], v[116:119]
    v_mfma_f32_16x16x32_bf16 v[120:123], a[76:79], v[24:27], v[120:123]
    v_mfma_f32_16x16x32_bf16 v[124:127], a[76:79], v[28:31], v[124:127]
    v_mfma_f32_16x16x32_bf16 v[128:131], a[76:79], v[32:35], v[128:131]
    s_waitcnt vmcnt(7) lgkmcnt(0)
    s_barrier
    v_mfma_f32_16x16x32_bf16 v[56:59], a[80:83], v[40:43], v[56:59]
    ds_read_b128 v[16:19], v253 offset:30720
    v_mfma_f32_16x16x32_bf16 v[60:63], a[80:83], v[44:47], v[60:63]
    ds_read_b128 v[20:23], v253 offset:31744
    v_mfma_f32_16x16x32_bf16 v[64:67], a[80:83], v[48:51], v[64:67]
    ds_read_b128 v[24:27], v253 offset:32768
    v_mfma_f32_16x16x32_bf16 v[68:71], a[80:83], v[52:55], v[68:71]
    ds_read_b128 v[28:31], v253 offset:33792
    v_mfma_f32_16x16x32_bf16 v[72:75], a[84:87], v[36:39], v[72:75]
    ds_read_b128 v[32:35], v253 offset:34816
    v_mfma_f32_16x16x32_bf16 v[76:79], a[84:87], v[40:43], v[76:79]
    s_add_u32 m0, s25, 59392
    s_nop 0
    buffer_load_dwordx4 v2, s[8:11], s24 offen offset:2048 sc1 lds
    v_mfma_f32_16x16x32_bf16 v[80:83], a[84:87], v[44:47], v[80:83]
    v_mfma_f32_16x16x32_bf16 v[84:87], a[84:87], v[48:51], v[84:87]
    s_add_u32 m0, s25, 64000
    s_nop 0
    buffer_load_dwordx4 v2, s[8:11], s24 offen offset:2560 sc1 lds
    v_mfma_f32_16x16x32_bf16 v[88:91], a[84:87], v[52:55], v[88:91]
    v_mfma_f32_16x16x32_bf16 v[92:95], v[36:39], a[88:91], v[92:95]
    buffer_load_dwordx4 a[44:47], v253, s[8:11], s28 offen offset:3072 sc1
    s_add_u32 s28, s28, 4096
    v_mfma_f32_16x16x32_bf16 v[96:99], v[40:43], a[88:91], v[96:99]
    v_mfma_f32_16x16x32_bf16 v[100:103], v[44:47], a[88:91], v[100:103]
    buffer_load_dwordx4 a[48:51], v253, s[8:11], s28 offen offset:0 sc1
    v_mfma_f32_16x16x32_bf16 v[104:107], v[48:51], a[88:91], v[104:107]
    v_mfma_f32_16x16x32_bf16 v[108:111], v[52:55], a[88:91], v[108:111]
    buffer_load_dwordx4 a[52:55], v253, s[8:11], s28 offen offset:1024 sc1
    v_mfma_f32_16x16x32_bf16 v[112:115], a[92:95], v[36:39], v[112:115]
    v_mfma_f32_16x16x32_bf16 v[116:119], a[92:95], v[40:43], v[116:119]
    v_mfma_f32_16x16x32_bf16 v[120:123], a[92:95], v[44:47], v[120:123]
    v_mfma_f32_16x16x32_bf16 v[124:127], a[92:95], v[48:51], v[124:127]
    v_mfma_f32_16x16x32_bf16 v[128:131], a[92:95], v[52:55], v[128:131]
    s_waitcnt lgkmcnt(0)
    v_mfma_f32_16x16x32_bf16 v[56:59], a[96:99], v[20:23], v[56:59]
    ds_read_b128 v[36:39], v253 offset:35840
    v_mfma_f32_16x16x32_bf16 v[60:63], a[96:99], v[24:27], v[60:63]
    ds_read_b128 v[40:43], v253 offset:36864
    v_mfma_f32_16x16x32_bf16 v[64:67], a[96:99], v[28:31], v[64:67]
    ds_read_b128 v[44:47], v253 offset:37888
    v_mfma_f32_16x16x32_bf16 v[68:71], a[96:99], v[32:35], v[68:71]
    ds_read_b128 v[48:51], v253 offset:38912
    v_mfma_f32_16x16x32_bf16 v[72:75], a[100:103], v[16:19], v[72:75]
    ds_read_b128 v[52:55], v253 offset:39936
    v_mfma_f32_16x16x32_bf16 v[76:79], a[100:103], v[20:23], v[76:79]
    s_add_u32 m0, s25, 68608
    s_nop 0
    buffer_load_dwordx4 v2, s[8:11], s24 offen offset:3072 sc1 lds
    v_mfma_f32_16x16x32_bf16 v[80:83], a[100:103], v[24:27], v[80:83]
    v_mfma_f32_16x16x32_bf16 v[84:87], a[100:103], v[28:31], v[84:87]
    s_add_u32 m0, s25, 73216
    s_nop 0
    buffer_load_dwordx4 v2, s[8:11], s24 offen offset:3584 sc1 lds
    v_mfma_f32_16x16x32_bf16 v[88:91], a[100:103], v[32:35], v[88:91]
    v_mfma_f32_16x16x32_bf16 v[92:95], v[16:19], a[104:107], v[92:95]
    buffer_load_dwordx4 a[56:59], v253, s[8:11], s28 offen offset:2048 sc1
    v_mfma_f32_16x16x32_bf16 v[96:99], v[20:23], a[104:107], v[96:99]
    v_mfma_f32_16x16x32_bf16 v[100:103], v[24:27], a[104:107], v[100:103]
    buffer_load_dwordx4 a[60:63], v253, s[8:11], s28 offen offset:3072 sc1
    s_add_u32 s28, s28, 4096
    v_mfma_f32_16x16x32_bf16 v[104:107], v[28:31], a[104:107], v[104:107]
    v_mfma_f32_16x16x32_bf16 v[108:111], v[32:35], a[104:107], v[108:111]
    buffer_load_dwordx4 a[64:67], v253, s[8:11], s28 offen offset:0 sc1
    v_mfma_f32_16x16x32_bf16 v[112:115], a[108:111], v[16:19], v[112:115]
    v_mfma_f32_16x16x32_bf16 v[116:119], a[108:111], v[20:23], v[116:119]
    v_mfma_f32_16x16x32_bf16 v[120:123], a[108:111], v[24:27], v[120:123]
    v_mfma_f32_16x16x32_bf16 v[124:127], a[108:111], v[28:31], v[124:127]
    v_mfma_f32_16x16x32_bf16 v[128:131], a[108:111], v[32:35], v[128:131]
    s_waitcnt lgkmcnt(0)
    v_mfma_f32_16x16x32_bf16 v[56:59], a[112:115], v[40:43], v[56:59]
    ds_read_b128 v[16:19], v253 offset:40960
    v_mfma_f32_16x16x32_bf16 v[60:63], a[112:115], v[44:47], v[60:63]
    ds_read_b128 v[20:23], v253 offset:41984
    v_mfma_f32_16x16x32_bf16 v[64:67], a[112:115], v[48:51], v[64:67]
    ds_read_b128 v[24:27], v253 offset:43008
    v_mfma_f32_16x16x32_bf16 v[68:71], a[112:115], v[52:55], v[68:71]
    ds_read_b128 v[28:31], v253 offset:44032
    v_mfma_f32_16x16x32_bf16 v[72:75], a[116:119], v[36:39], v[72:75]
    ds_read_b128 v[32:35], v253 offset:45056
    v_mfma_f32_16x16x32_bf16 v[76:79], a[116:119], v[40:43], v[76:79]
    s_add_u32 m0, s25, 81920
    s_add_u32 s24, s24, 4096
    buffer_load_dwordx4 v2, s[8:11], s24 offen offset:0 sc1 lds
    v_mfma_f32_16x16x32_bf16 v[80:83], a[116:119], v[44:47], v[80:83]
    v_mfma_f32_16x16x32_bf16 v[84:87], a[116:119], v[48:51], v[84:87]
    s_add_u32 m0, s25, 86528
    s_nop 0
    buffer_load_dwordx4 v2, s[8:11], s24 offen offset:512 sc1 lds
    v_mfma_f32_16x16x32_bf16 v[88:91], a[116:119], v[52:55], v[88:91]
    v_mfma_f32_16x16x32_bf16 v[92:95], v[36:39], a[120:123], v[92:95]
    buffer_load_dwordx4 a[68:71], v253, s[8:11], s28 offen offset:1024 sc1
    v_mfma_f32_16x16x32_bf16 v[96:99], v[40:43], a[120:123], v[96:99]
    v_mfma_f32_16x16x32_bf16 v[100:103], v[44:47], a[120:123], v[100:103]
    buffer_load_dwordx4 a[72:75], v253, s[8:11], s28 offen offset:2048 sc1
    v_mfma_f32_16x16x32_bf16 v[104:107], v[48:51], a[120:123], v[104:107]
    v_mfma_f32_16x16x32_bf16 v[108:111], v[52:55], a[120:123], v[108:111]
    buffer_load_dwordx4 a[76:79], v253, s[8:11], s28 offen offset:3072 sc1
    s_add_u32 s28, s28, 4096
    v_mfma_f32_16x16x32_bf16 v[112:115], a[124:127], v[36:39], v[112:115]
    v_mfma_f32_16x16x32_bf16 v[116:119], a[124:127], v[40:43], v[116:119]
    v_mfma_f32_16x16x32_bf16 v[120:123], a[124:127], v[44:47], v[120:123]
    v_mfma_f32_16x16x32_bf16 v[124:127], a[124:127], v[48:51], v[124:127]
    v_mfma_f32_16x16x32_bf16 v[128:131], a[124:127], v[52:55], v[128:131]
    s_waitcnt lgkmcnt(0)
    v_mfma_f32_16x16x32_bf16 v[56:59], a[128:131], v[20:23], v[56:59]
    ds_read_b128 v[36:39], v6 offset:0
    v_mfma_f32_16x16x32_bf16 v[60:63], a[128:131], v[24:27], v[60:63]
    ds_read_b128 v[40:43], v6 offset:1024
    v_mfma_f32_16x16x32_bf16 v[64:67], a[128:131], v[28:31], v[64:67]
    ds_read_b128 v[44:47], v6 offset:2048
    v_mfma_f32_16x16x32_bf16 v[68:71], a[128:131], v[32:35], v[68:71]
    ds_read_b128 v[48:51], v6 offset:3072
    v_mfma_f32_16x16x32_bf16 v[72:75], a[132:135], v[16:19], v[72:75]
    ds_read_b128 v[52:55], v6 offset:4096
    v_mfma_f32_16x16x32_bf16 v[76:79], a[132:135], v[20:23], v[76:79]
    s_add_u32 m0, s26, 61440
    s_add_u32 s7, s27, 6144
    buffer_load_dwordx4 v2, s[8:11], s7 offen sc1 lds
    v_mfma_f32_16x16x32_bf16 v[80:83], a[132:135], v[24:27], v[80:83]
    v_mfma_f32_16x16x32_bf16 v[84:87], a[132:135], v[28:31], v[84:87]
    s_add_u32 m0, s29, 61440
    s_add_u32 s7, s23, 6144
    buffer_load_dwordx4 v2, s[8:11], s7 offen sc1 lds
    v_mfma_f32_16x16x32_bf16 v[88:91], a[132:135], v[32:35], v[88:91]
    v_mfma_f32_16x16x32_bf16 v[92:95], v[16:19], a[136:139], v[92:95]
    buffer_load_dwordx4 a[80:83], v253, s[8:11], s28 offen offset:0 sc1
    v_mfma_f32_16x16x32_bf16 v[96:99], v[20:23], a[136:139], v[96:99]
    v_mfma_f32_16x16x32_bf16 v[100:103], v[24:27], a[136:139], v[100:103]
    buffer_load_dwordx4 a[84:87], v253, s[8:11], s28 offen offset:1024 sc1
    v_mfma_f32_16x16x32_bf16 v[104:107], v[28:31], a[136:139], v[104:107]
    v_mfma_f32_16x16x32_bf16 v[108:111], v[32:35], a[136:139], v[108:111]
    buffer_load_dwordx4 a[88:91], v253, s[8:11], s28 offen offset:2048 sc1
    v_mfma_f32_16x16x32_bf16 v[112:115], a[140:143], v[16:19], v[112:115]
    v_mfma_f32_16x16x32_bf16 v[116:119], a[140:143], v[20:23], v[116:119]
    v_mfma_f32_16x16x32_bf16 v[120:123], a[140:143], v[24:27], v[120:123]
    v_mfma_f32_16x16x32_bf16 v[124:127], a[140:143], v[28:31], v[124:127]
    v_mfma_f32_16x16x32_bf16 v[128:131], a[140:143], v[32:35], v[128:131]
    s_waitcnt vmcnt(20) lgkmcnt(0)
    v_cmp_eq_u32 vcc, s76, v225
    s_cmp_eq_u64 vcc, exec
    s_cbranch_scc1 L_wo_ready_15
    s_mov_b32 s6, 0
L_spin_16:
    buffer_load_dword v1, v226, s[8:11], s39 offen sc1
    s_add_u32 s6, s6, 1
    s_waitcnt vmcnt(0)
    v_cmp_eq_u32 vcc, s76, v1
    s_cmp_eq_u64 vcc, exec
    s_cbranch_scc1 L_spun_17
    s_cmp_lt_u32 s6, 1048576
    s_cbranch_scc1 L_spin_16
    s_branch L_main_end
L_spun_17:
L_wo_ready_15:
    v_mfma_f32_16x16x32_bf16 v[56:59], a[144:147], v[40:43], v[56:59]
    ds_read_b128 v[16:19], v6 offset:5120
    v_mfma_f32_16x16x32_bf16 v[60:63], a[144:147], v[44:47], v[60:63]
    ds_read_b128 v[20:23], v6 offset:6144
    v_mfma_f32_16x16x32_bf16 v[64:67], a[144:147], v[48:51], v[64:67]
    ds_read_b128 v[24:27], v6 offset:7168
    v_mfma_f32_16x16x32_bf16 v[68:71], a[144:147], v[52:55], v[68:71]
    ds_read_b128 v[28:31], v6 offset:8192
    v_mfma_f32_16x16x32_bf16 v[72:75], a[148:151], v[36:39], v[72:75]
    ds_read_b128 v[32:35], v6 offset:9216
    v_mfma_f32_16x16x32_bf16 v[76:79], a[148:151], v[40:43], v[76:79]
    buffer_load_dwordx4 a[92:95], v253, s[8:11], s28 offen offset:3072 sc1
    s_add_u32 s28, s28, 4096
    v_mfma_f32_16x16x32_bf16 v[80:83], a[148:151], v[44:47], v[80:83]
    v_mfma_f32_16x16x32_bf16 v[84:87], a[148:151], v[48:51], v[84:87]
    buffer_load_dwordx4 a[96:99], v253, s[8:11], s28 offen offset:0 sc1
    v_mfma_f32_16x16x32_bf16 v[88:91], a[148:151], v[52:55], v[88:91]
    v_mfma_f32_16x16x32_bf16 v[92:95], v[36:39], a[152:155], v[92:95]
    buffer_load_dwordx4 a[100:103], v253, s[8:11], s28 offen offset:1024 sc1
    v_mfma_f32_16x16x32_bf16 v[96:99], v[40:43], a[152:155], v[96:99]
    v_mfma_f32_16x16x32_bf16 v[100:103], v[44:47], a[152:155], v[100:103]
    buffer_load_dwordx4 a[160:163], v253, s[8:11], s32 offen offset:0 sc1
    v_mfma_f32_16x16x32_bf16 v[104:107], v[48:51], a[152:155], v[104:107]
    v_mfma_f32_16x16x32_bf16 v[108:111], v[52:55], a[152:155], v[108:111]
    v_mfma_f32_16x16x32_bf16 v[112:115], a[156:159], v[36:39], v[112:115]
    v_mfma_f32_16x16x32_bf16 v[116:119], a[156:159], v[40:43], v[116:119]
    v_mfma_f32_16x16x32_bf16 v[120:123], a[156:159], v[44:47], v[120:123]
    v_mfma_f32_16x16x32_bf16 v[124:127], a[156:159], v[48:51], v[124:127]
    v_mfma_f32_16x16x32_bf16 v[128:131], a[156:159], v[52:55], v[128:131]
    s_waitcnt vmcnt(34) lgkmcnt(0)
    v_mfma_f32_16x16x32_bf16 v[56:59], a[0:3], v[20:23], v[56:59]
    ds_read_b128 v[36:39], v6 offset:10240
    v_mfma_f32_16x16x32_bf16 v[60:63], a[0:3], v[24:27], v[60:63]
    ds_read_b128 v[40:43], v6 offset:11264
    v_mfma_f32_16x16x32_bf16 v[64:67], a[0:3], v[28:31], v[64:67]
    ds_read_b128 v[44:47], v6 offset:12288
    v_mfma_f32_16x16x32_bf16 v[68:71], a[0:3], v[32:35], v[68:71]
    ds_read_b128 v[48:51], v6 offset:13312
    v_mfma_f32_16x16x32_bf16 v[72:75], a[4:7], v[16:19], v[72:75]
    ds_read_b128 v[52:55], v6 offset:14336
    v_mfma_f32_16x16x32_bf16 v[76:79], a[4:7], v[20:23], v[76:79]
    buffer_load_dwordx4 a[104:107], v253, s[8:11], s28 offen offset:2048 sc1
    v_mfma_f32_16x16x32_bf16 v[80:83], a[4:7], v[24:27], v[80:83]
    v_mfma_f32_16x16x32_bf16 v[84:87], a[4:7], v[28:31], v[84:87]
    buffer_load_dwordx4 a[108:111], v253, s[8:11], s28 offen offset:3072 sc1
    s_add_u32 s28, s28, 4096
    v_mfma_f32_16x16x32_bf16 v[88:91], a[4:7], v[32:35], v[88:91]
    v_mfma_f32_16x16x32_bf16 v[92:95], v[16:19], a[8:11], v[92:95]
    buffer_load_dwordx4 a[112:115], v253, s[8:11], s28 offen offset:0 sc1
    v_mfma_f32_16x16x32_bf16 v[96:99], v[20:23], a[8:11], v[96:99]
    v_mfma_f32_16x16x32_bf16 v[100:103], v[24:27], a[8:11], v[100:103]
    buffer_load_dwordx4 a[164:167], v253, s[8:11], s33 offen offset:0 sc1
    v_mfma_f32_16x16x32_bf16 v[104:107], v[28:31], a[8:11], v[104:107]
    v_mfma_f32_16x16x32_bf16 v[108:111], v[32:35], a[8:11], v[108:111]
    v_mfma_f32_16x16x32_bf16 v[112:115], a[12:15], v[16:19], v[112:115]
    v_mfma_f32_16x16x32_bf16 v[116:119], a[12:15], v[20:23], v[116:119]
    v_mfma_f32_16x16x32_bf16 v[120:123], a[12:15], v[24:27], v[120:123]
    v_mfma_f32_16x16x32_bf16 v[124:127], a[12:15], v[28:31], v[124:127]
    v_mfma_f32_16x16x32_bf16 v[128:131], a[12:15], v[32:35], v[128:131]
    s_waitcnt vmcnt(11) lgkmcnt(0)
    s_barrier
    v_mfma_f32_16x16x32_bf16 v[56:59], a[16:19], v[40:43], v[56:59]
    ds_read_b128 v[16:19], v6 offset:15360
    v_mfma_f32_16x16x32_bf16 v[60:63], a[16:19], v[44:47], v[60:63]
    ds_read_b128 v[20:23], v6 offset:16384
    v_mfma_f32_16x16x32_bf16 v[64:67], a[16:19], v[48:51], v[64:67]
    ds_read_b128 v[24:27], v6 offset:17408
    v_mfma_f32_16x16x32_bf16 v[68:71], a[16:19], v[52:55], v[68:71]
    ds_read_b128 v[28:31], v6 offset:18432
    v_mfma_f32_16x16x32_bf16 v[72:75], a[20:23], v[36:39], v[72:75]
    ds_read_b128 v[32:35], v6 offset:19456
    v_mfma_f32_16x16x32_bf16 v[76:79], a[20:23], v[40:43], v[76:79]
    buffer_load_dwordx4 a[116:119], v253, s[8:11], s28 offen offset:1024 sc1
    v_mfma_f32_16x16x32_bf16 v[80:83], a[20:23], v[44:47], v[80:83]
    v_mfma_f32_16x16x32_bf16 v[84:87], a[20:23], v[48:51], v[84:87]
    buffer_load_dwordx4 a[120:123], v253, s[8:11], s28 offen offset:2048 sc1
    v_mfma_f32_16x16x32_bf16 v[88:91], a[20:23], v[52:55], v[88:91]
    v_mfma_f32_16x16x32_bf16 v[92:95], v[36:39], a[24:27], v[92:95]
    buffer_load_dwordx4 a[124:127], v253, s[8:11], s28 offen offset:3072 sc1
    s_add_u32 s28, s28, 4096
    v_mfma_f32_16x16x32_bf16 v[96:99], v[40:43], a[24:27], v[96:99]
    v_mfma_f32_16x16x32_bf16 v[100:103], v[44:47], a[24:27], v[100:103]
    buffer_load_dwordx4 a[168:171], v5, s[8:11], s34 offen offset:0 sc1
    v_mfma_f32_16x16x32_bf16 v[104:107], v[48:51], a[24:27], v[104:107]
    v_mfma_f32_16x16x32_bf16 v[108:111], v[52:55], a[24:27], v[108:111]
    v_mfma_f32_16x16x32_bf16 v[112:115], a[28:31], v[36:39], v[112:115]
    v_mfma_f32_16x16x32_bf16 v[116:119], a[28:31], v[40:43], v[116:119]
    v_mfma_f32_16x16x32_bf16 v[120:123], a[28:31], v[44:47], v[120:123]
    v_mfma_f32_16x16x32_bf16 v[124:127], a[28:31], v[48:51], v[124:127]
    v_mfma_f32_16x16x32_bf16 v[128:131], a[28:31], v[52:55], v[128:131]
    s_waitcnt vmcnt(29) lgkmcnt(0)
    v_mfma_f32_16x16x32_bf16 v[56:59], a[32:35], v[20:23], v[56:59]
    ds_read_b128 v[36:39], v6 offset:20480
    v_mfma_f32_16x16x32_bf16 v[60:63], a[32:35], v[24:27], v[60:63]
    ds_read_b128 v[40:43], v6 offset:21504
    v_mfma_f32_16x16x32_bf16 v[64:67], a[32:35], v[28:31], v[64:67]
    ds_read_b128 v[44:47], v6 offset:22528
    v_mfma_f32_16x16x32_bf16 v[68:71], a[32:35], v[32:35], v[68:71]
    ds_read_b128 v[48:51], v6 offset:23552
    v_mfma_f32_16x16x32_bf16 v[72:75], a[36:39], v[16:19], v[72:75]
    ds_read_b128 v[52:55], v6 offset:24576
    v_mfma_f32_16x16x32_bf16 v[76:79], a[36:39], v[20:23], v[76:79]
    buffer_load_dwordx4 a[172:175], v253, s[8:11], s32 offen offset:1024 sc1
    v_mfma_f32_16x16x32_bf16 v[80:83], a[36:39], v[24:27], v[80:83]
    v_mfma_f32_16x16x32_bf16 v[84:87], a[36:39], v[28:31], v[84:87]
    buffer_load_dwordx4 a[176:179], v253, s[8:11], s33 offen offset:1024 sc1
    v_mfma_f32_16x16x32_bf16 v[88:91], a[36:39], v[32:35], v[88:91]
    v_mfma_f32_16x16x32_bf16 v[92:95], v[16:19], a[40:43], v[92:95]
    buffer_load_dwordx4 a[180:183], v5, s[8:11], s34 offen offset:1024 sc1
    v_mfma_f32_16x16x32_bf16 v[96:99], v[20:23], a[40:43], v[96:99]
    v_mfma_f32_16x16x32_bf16 v[100:103], v[24:27], a[40:43], v[100:103]
    buffer_load_dwordx4 a[184:187], v253, s[8:11], s32 offen offset:2048 sc1
    v_mfma_f32_16x16x32_bf16 v[104:107], v[28:31], a[40:43], v[104:107]
    v_mfma_f32_16x16x32_bf16 v[108:111], v[32:35], a[40:43], v[108:111]
    v_mfma_f32_16x16x32_bf16 v[112:115], a[44:47], v[16:19], v[112:115]
    v_mfma_f32_16x16x32_bf16 v[116:119], a[44:47], v[20:23], v[116:119]
    v_mfma_f32_16x16x32_bf16 v[120:123], a[44:47], v[24:27], v[120:123]
    v_mfma_f32_16x16x32_bf16 v[124:127], a[44:47], v[28:31], v[124:127]
    v_mfma_f32_16x16x32_bf16 v[128:131], a[44:47], v[32:35], v[128:131]
    s_waitcnt vmcnt(27) lgkmcnt(0)
    v_mfma_f32_16x16x32_bf16 v[56:59], a[48:51], v[40:43], v[56:59]
    ds_read_b128 v[16:19], v6 offset:25600
    v_mfma_f32_16x16x32_bf16 v[60:63], a[48:51], v[44:47], v[60:63]
    ds_read_b128 v[20:23], v6 offset:26624
    v_mfma_f32_16x16x32_bf16 v[64:67], a[48:51], v[48:51], v[64:67]
    ds_read_b128 v[24:27], v6 offset:27648
    v_mfma_f32_16x16x32_bf16 v[68:71], a[48:51], v[52:55], v[68:71]
    ds_read_b128 v[28:31], v6 offset:28672
    v_mfma_f32_16x16x32_bf16 v[72:75], a[52:55], v[36:39], v[72:75]
    ds_read_b128 v[32:35], v6 offset:29696
    v_mfma_f32_16x16x32_bf16 v[76:79], a[52:55], v[40:43], v[76:79]
    buffer_load_dwordx4 a[188:191], v253, s[8:11], s33 offen offset:2048 sc1
    v_mfma_f32_16x16x32_bf16 v[80:83], a[52:55], v[44:47], v[80:83]
    v_mfma_f32_16x16x32_bf16 v[84:87], a[52:55], v[48:51], v[84:87]
    buffer_load_dwordx4 a[192:195], v5, s[8:11], s34 offen offset:2048 sc1
    v_mfma_f32_16x16x32_bf16 v[88:91], a[52:55], v[52:55], v[88:91]
    v_mfma_f32_16x16x32_bf16 v[92:95], v[36:39], a[56:59], v[92:95]
    buffer_load_dwordx4 a[196:199], v253, s[8:11], s32 offen offset:3072 sc1
    s_add_u32 s32, s32, 4096
    v_mfma_f32_16x16x32_bf16 v[96:99], v[40:43], a[56:59], v[96:99]
    v_mfma_f32_16x16x32_bf16 v[100:103], v[44:47], a[56:59], v[100:103]
    buffer_load_dwordx4 a[200:203], v253, s[8:11], s33 offen offset:3072 sc1
    s_add_u32 s33, s33, 4096
    v_mfma_f32_16x16x32_bf16 v[104:107], v[48:51], a[56:59], v[104:107]
    v_mfma_f32_16x16x32_bf16 v[108:111], v[52:55], a[56:59], v[108:111]
    v_mfma_f32_16x16x32_bf16 v[112:115], a[60:63], v[36:39], v[112:115]
    v_mfma_f32_16x16x32_bf16 v[116:119], a[60:63], v[40:43], v[116:119]
    v_mfma_f32_16x16x32_bf16 v[120:123], a[60:63], v[44:47], v[120:123]
    v_mfma_f32_16x16x32_bf16 v[124:127], a[60:63], v[48:51], v[124:127]
    v_mfma_f32_16x16x32_bf16 v[128:131], a[60:63], v[52:55], v[128:131]
    s_waitcnt vmcnt(25) lgkmcnt(0)
    v_mfma_f32_16x16x32_bf16 v[56:59], a[64:67], v[20:23], v[56:59]
    ds_read_b128 v[36:39], v6 offset:30720
    v_mfma_f32_16x16x32_bf16 v[60:63], a[64:67], v[24:27], v[60:63]
    ds_read_b128 v[40:43], v6 offset:31744
    v_mfma_f32_16x16x32_bf16 v[64:67], a[64:67], v[28:31], v[64:67]
    ds_read_b128 v[44:47], v6 offset:32768
    v_mfma_f32_16x16x32_bf16 v[68:71], a[64:67], v[32:35], v[68:71]
    ds_read_b128 v[48:51], v6 offset:33792
    v_mfma_f32_16x16x32_bf16 v[72:75], a[68:71], v[16:19], v[72:75]
    ds_read_b128 v[52:55], v6 offset:34816
    v_mfma_f32_16x16x32_bf16 v[76:79], a[68:71], v[20:23], v[76:79]
    buffer_load_dwordx4 a[204:207], v5, s[8:11], s34 offen offset:3072 sc1
    s_add_u32 s34, s34, 4096
    v_mfma_f32_16x16x32_bf16 v[80:83], a[68:71], v[24:27], v[80:83]
    v_mfma_f32_16x16x32_bf16 v[84:87], a[68:71], v[28:31], v[84:87]
    buffer_load_dwordx4 a[208:211], v253, s[8:11], s32 offen offset:0 sc1
    v_mfma_f32_16x16x32_bf16 v[88:91], a[68:71], v[32:35], v[88:91]
    v_mfma_f32_16x16x32_bf16 v[92:95], v[16:19], a[72:75], v[92:95]
    buffer_load_dwordx4 a[212:215], v253, s[8:11], s33 offen offset:0 sc1
    v_mfma_f32_16x16x32_bf16 v[96:99], v[20:23], a[72:75], v[96:99]
    v_mfma_f32_16x16x32_bf16 v[100:103], v[24:27], a[72:75], v[100:103]
    buffer_load_dwordx4 a[216:219], v5, s[8:11], s34 offen offset:0 sc1
    v_mfma_f32_16x16x32_bf16 v[104:107], v[28:31], a[72:75], v[104:107]
    v_mfma_f32_16x16x32_bf16 v[108:111], v[32:35], a[72:75], v[108:111]
    v_mfma_f32_16x16x32_bf16 v[112:115], a[76:79], v[16:19], v[112:115]
    v_mfma_f32_16x16x32_bf16 v[116:119], a[76:79], v[20:23], v[116:119]
    v_mfma_f32_16x16x32_bf16 v[120:123], a[76:79], v[24:27], v[120:123]
    v_mfma_f32_16x16x32_bf16 v[124:127], a[76:79], v[28:31], v[124:127]
    v_mfma_f32_16x16x32_bf16 v[128:131], a[76:79], v[32:35], v[128:131]
    s_waitcnt vmcnt(23) lgkmcnt(0)
    v_mfma_f32_16x16x32_bf16 v[56:59], a[80:83], v[40:43], v[56:59]
    ds_read_b128 v[16:19], v6 offset:35840
    v_mfma_f32_16x16x32_bf16 v[60:63], a[80:83], v[44:47], v[60:63]
    ds_read_b128 v[20:23], v6 offset:36864
    v_mfma_f32_16x16x32_bf16 v[64:67], a[80:83], v[48:51], v[64:67]
    ds_read_b128 v[24:27], v6 offset:37888
    v_mfma_f32_16x16x32_bf16 v[68:71], a[80:83], v[52:55], v[68:71]
    ds_read_b128 v[28:31], v6 offset:38912
    v_mfma_f32_16x16x32_bf16 v[72:75], a[84:87], v[36:39], v[72:75]
    ds_read_b128 v[32:35], v6 offset:39936
    v_mfma_f32_16x16x32_bf16 v[76:79], a[84:87], v[40:43], v[76:79]
    buffer_load_dwordx4 a[220:223], v253, s[8:11], s32 offen offset:1024 sc1
    v_mfma_f32_16x16x32_bf16 v[80:83], a[84:87], v[44:47], v[80:83]
    v_mfma_f32_16x16x32_bf16 v[84:87], a[84:87], v[48:51], v[84:87]
    buffer_load_dwordx4 a[224:227], v253, s[8:11], s33 offen offset:1024 sc1
    v_mfma_f32_16x16x32_bf16 v[88:91], a[84:87], v[52:55], v[88:91]
    v_mfma_f32_16x16x32_bf16 v[92:95], v[36:39], a[88:91], v[92:95]
    buffer_load_dwordx4 a[228:231], v5, s[8:11], s34 offen offset:1024 sc1
    v_mfma_f32_16x16x32_bf16 v[96:99], v[40:43], a[88:91], v[96:99]
    v_mfma_f32_16x16x32_bf16 v[100:103], v[44:47], a[88:91], v[100:103]
    buffer_load_dwordx4 a[232:235], v253, s[8:11], s32 offen offset:2048 sc1
    v_mfma_f32_16x16x32_bf16 v[104:107], v[48:51], a[88:91], v[104:107]
    v_mfma_f32_16x16x32_bf16 v[108:111], v[52:55], a[88:91], v[108:111]
    v_mfma_f32_16x16x32_bf16 v[112:115], a[92:95], v[36:39], v[112:115]
    v_mfma_f32_16x16x32_bf16 v[116:119], a[92:95], v[40:43], v[116:119]
    v_mfma_f32_16x16x32_bf16 v[120:123], a[92:95], v[44:47], v[120:123]
    v_mfma_f32_16x16x32_bf16 v[124:127], a[92:95], v[48:51], v[124:127]
    v_mfma_f32_16x16x32_bf16 v[128:131], a[92:95], v[52:55], v[128:131]
    s_waitcnt vmcnt(22) lgkmcnt(0)
    v_mfma_f32_16x16x32_bf16 v[56:59], a[96:99], v[20:23], v[56:59]
    ds_read_b128 v[36:39], v6 offset:40960
    v_mfma_f32_16x16x32_bf16 v[60:63], a[96:99], v[24:27], v[60:63]
    ds_read_b128 v[40:43], v6 offset:41984
    v_mfma_f32_16x16x32_bf16 v[64:67], a[96:99], v[28:31], v[64:67]
    ds_read_b128 v[44:47], v6 offset:43008
    v_mfma_f32_16x16x32_bf16 v[68:71], a[96:99], v[32:35], v[68:71]
    ds_read_b128 v[48:51], v6 offset:44032
    v_mfma_f32_16x16x32_bf16 v[72:75], a[100:103], v[16:19], v[72:75]
    ds_read_b128 v[52:55], v6 offset:45056
    v_mfma_f32_16x16x32_bf16 v[76:79], a[100:103], v[20:23], v[76:79]
    buffer_load_dwordx4 a[236:239], v253, s[8:11], s33 offen offset:2048 sc1
    v_mfma_f32_16x16x32_bf16 v[80:83], a[100:103], v[24:27], v[80:83]
    v_mfma_f32_16x16x32_bf16 v[84:87], a[100:103], v[28:31], v[84:87]
    buffer_load_dwordx4 a[240:243], v5, s[8:11], s34 offen offset:2048 sc1
    v_mfma_f32_16x16x32_bf16 v[88:91], a[100:103], v[32:35], v[88:91]
    v_mfma_f32_16x16x32_bf16 v[92:95], v[16:19], a[104:107], v[92:95]
    buffer_load_dwordx4 a[244:247], v253, s[8:11], s32 offen offset:3072 sc1
    s_add_u32 s32, s32, 4096
    v_mfma_f32_16x16x32_bf16 v[96:99], v[20:23], a[104:107], v[96:99]
    v_mfma_f32_16x16x32_bf16 v[100:103], v[24:27], a[104:107], v[100:103]
    buffer_load_dwordx4 a[248:251], v253, s[8:11], s33 offen offset:3072 sc1
    s_add_u32 s33, s33, 4096
    v_mfma_f32_16x16x32_bf16 v[104:107], v[28:31], a[104:107], v[104:107]
    v_mfma_f32_16x16x32_bf16 v[108:111], v[32:35], a[104:107], v[108:111]
    v_mfma_f32_16x16x32_bf16 v[112:115], a[108:111], v[16:19], v[112:115]
    v_mfma_f32_16x16x32_bf16 v[116:119], a[108:111], v[20:23], v[116:119]
    v_mfma_f32_16x16x32_bf16 v[120:123], a[108:111], v[24:27], v[120:123]
    v_mfma_f32_16x16x32_bf16 v[124:127], a[108:111], v[28:31], v[124:127]
    v_mfma_f32_16x16x32_bf16 v[128:131], a[108:111], v[32:35], v[128:131]
    s_waitcnt vmcnt(21) lgkmcnt(0)
    v_mfma_f32_16x16x32_bf16 v[56:59], a[112:115], v[40:43], v[56:59]
    v_mfma_f32_16x16x32_bf16 v[60:63], a[112:115], v[44:47], v[60:63]
    v_mfma_f32_16x16x32_bf16 v[64:67], a[112:115], v[48:51], v[64:67]
    v_mfma_f32_16x16x32_bf16 v[68:71], a[112:115], v[52:55], v[68:71]
    v_mfma_f32_16x16x32_bf16 v[72:75], a[116:119], v[36:39], v[72:75]
    v_mfma_f32_16x16x32_bf16 v[76:79], a[116:119], v[40:43], v[76:79]
    buffer_load_dwordx4 a[252:255], v5, s[8:11], s34 offen offset:3072 sc1
    s_add_u32 s34, s34, 4096
    v_mfma_f32_16x16x32_bf16 v[80:83], a[116:119], v[44:47], v[80:83]
    v_mfma_f32_16x16x32_bf16 v[84:87], a[116:119], v[48:51], v[84:87]
    buffer_load_dwordx4 a[128:131], v253, s[8:11], s32 offen offset:0 sc1
    v_mfma_f32_16x16x32_bf16 v[88:91], a[116:119], v[52:55], v[88:91]
    v_mfma_f32_16x16x32_bf16 v[92:95], v[36:39], a[120:123], v[92:95]
    buffer_load_dwordx4 a[132:135], v253, s[8:11], s33 offen offset:0 sc1
    v_mfma_f32_16x16x32_bf16 v[96:99], v[40:43], a[120:123], v[96:99]
    v_mfma_f32_16x16x32_bf16 v[100:103], v[44:47], a[120:123], v[100:103]
    buffer_load_dwordx4 a[136:139], v5, s[8:11], s34 offen offset:0 sc1
    v_mfma_f32_16x16x32_bf16 v[104:107], v[48:51], a[120:123], v[104:107]
    v_mfma_f32_16x16x32_bf16 v[108:111], v[52:55], a[120:123], v[108:111]
    v_mfma_f32_16x16x32_bf16 v[112:115], a[124:127], v[36:39], v[112:115]
    v_mfma_f32_16x16x32_bf16 v[116:119], a[124:127], v[40:43], v[116:119]
    v_mfma_f32_16x16x32_bf16 v[120:123], a[124:127], v[44:47], v[120:123]
    v_mfma_f32_16x16x32_bf16 v[124:127], a[124:127], v[48:51], v[124:127]
    v_mfma_f32_16x16x32_bf16 v[128:131], a[124:127], v[52:55], v[128:131]
    v_cvt_pk_bf16_f32 v136, v56, v57
    v_cvt_pk_bf16_f32 v137, v58, v59
    v_cvt_pk_bf16_f32 v140, v60, v61
    v_cvt_pk_bf16_f32 v141, v62, v63
    v_cvt_pk_bf16_f32 v144, v64, v65
    v_cvt_pk_bf16_f32 v145, v66, v67
    v_cvt_pk_bf16_f32 v148, v68, v69
    v_cvt_pk_bf16_f32 v149, v70, v71
    v_cvt_pk_bf16_f32 v152, v72, v73
    buffer_load_dwordx4 a[140:143], v253, s[8:11], s32 offen offset:1024 sc1
    v_cvt_pk_bf16_f32 v153, v74, v75
    v_cvt_pk_bf16_f32 v156, v76, v77
    v_cvt_pk_bf16_f32 v157, v78, v79
    v_cvt_pk_bf16_f32 v160, v80, v81
    v_cvt_pk_bf16_f32 v161, v82, v83
    v_cvt_pk_bf16_f32 v164, v84, v85
    v_cvt_pk_bf16_f32 v165, v86, v87
    v_cvt_pk_bf16_f32 v168, v88, v89
    v_cvt_pk_bf16_f32 v169, v90, v91
    buffer_load_dwordx4 a[144:147], v253, s[8:11], s33 offen offset:1024 sc1
    v_cvt_pk_bf16_f32 v134, v112, v113
    v_cvt_pk_bf16_f32 v154, v114, v115
    v_cvt_pk_bf16_f32 v138, v116, v117
    v_cvt_pk_bf16_f32 v158, v118, v119
    v_cvt_pk_bf16_f32 v142, v120, v121
    v_cvt_pk_bf16_f32 v162, v122, v123
    v_cvt_pk_bf16_f32 v146, v124, v125
    v_cvt_pk_bf16_f32 v166, v126, v127
    v_cvt_pk_bf16_f32 v150, v128, v129
    buffer_load_dwordx4 a[148:151], v5, s[8:11], s34 offen offset:1024 sc1
    v_cvt_pk_bf16_f32 v170, v130, v131
    v_cvt_pk_bf16_f32 v172, v92, v93
    v_cvt_pk_bf16_f32 v173, v94, v95
    v_cvt_pk_bf16_f32 v174, v96, v97
    v_cvt_pk_bf16_f32 v175, v98, v99
    v_cvt_pk_bf16_f32 v176, v100, v101
    v_cvt_pk_bf16_f32 v177, v102, v103
    v_cvt_pk_bf16_f32 v178, v104, v105
    v_cvt_pk_bf16_f32 v179, v106, v107
    buffer_load_dwordx4 a[152:155], v253, s[8:11], s32 offen offset:2048 sc1
    v_cvt_pk_bf16_f32 v180, v108, v109
    v_cvt_pk_bf16_f32 v181, v110, v111
    v_mfma_f32_16x16x32_bf16 v[16:19], v[152:155], v[136:139], v[208:211]
    v_mfma_f32_16x16x32_bf16 v[20:23], v[156:159], v[136:139], v[204:207]
    v_mfma_f32_16x16x32_bf16 v[24:27], v[156:159], v[140:143], v[200:203]
    v_mfma_f32_16x16x32_bf16 v[28:31], v[160:163], v[140:143], v[204:207]
    v_mfma_f32_16x16x32_bf16 v[32:35], v[160:163], v[144:147], v[200:203]
    v_mfma_f32_16x16x32_bf16 v[36:39], v[164:167], v[144:147], v[204:207]
    v_mfma_f32_16x16x32_bf16 v[40:43], v[164:167], v[148:151], v[200:203]
    buffer_load_dwordx4 a[156:159], v253, s[8:11], s33 offen offset:2048 sc1
    v_mfma_f32_16x16x32_bf16 v[44:47], v[168:171], v[148:151], v[204:207]
    v_mfma_f32_16x16x32_bf16 v[56:59], v[132:135], v[192:195], v[196:199]
    v_mfma_f32_16x16x32_bf16 v[60:63], v[136:139], v[192:195], v[196:199]
    v_mfma_f32_16x16x32_bf16 v[64:67], v[140:143], v[192:195], v[196:199]
    v_mfma_f32_16x16x32_bf16 v[68:71], v[144:147], v[192:195], v[196:199]
    v_mfma_f32_16x16x32_bf16 v[72:75], v[148:151], v[192:195], v[196:199]
    v_max3_f32 v92, v16, v17, v18
    v_max3_f32 v96, v19, v20, v21
    v_max3_f32 v93, v24, v25, v26
    buffer_load_dwordx4 a[0:3], v5, s[8:11], s34 offen offset:2048 sc1
    v_max3_f32 v97, v27, v28, v29
    v_max3_f32 v94, v32, v33, v34
    v_max3_f32 v98, v35, v36, v37
    v_max3_f32 v95, v40, v41, v42
    v_max3_f32 v99, v43, v44, v45
    v_max3_f32 v92, v92, v22, v23
    v_max3_f32 v93, v93, v30, v31
    v_max3_f32 v94, v94, v38, v39
    v_max3_f32 v95, v95, v46, v47
    buffer_load_dwordx4 a[4:7], v253, s[8:11], s32 offen offset:3072 sc1
    s_add_u32 s32, s32, 4096
    v_max_f32 v92, v92, v96
    v_max_f32 v93, v93, v97
    v_max_f32 v94, v94, v98
    v_max_f32 v95, v95, v99
    s_mov_b32 s18, 0x3eae1a93
    v_cvt_pk_bf16_f32 v182, v56, v57
    v_permlane32_swap_b32 v92, v93
    v_permlane32_swap_b32 v94, v95
    v_max_f32 v92, v92, v93
    buffer_load_dwordx4 a[8:11], v253, s[8:11], s33 offen offset:3072 sc1
    s_add_u32 s33, s33, 4096
    v_max_f32 v94, v94, v95
    v_cvt_pk_bf16_f32 v183, v58, v59
    v_cvt_pk_bf16_f32 v184, v60, v61
    v_permlane16_swap_b32 v92, v94
    v_max_f32 v92, v92, v94
    v_mul_f32 v92, 0xbeae1a93, v92
    v_mov_b32 v94, v92
    v_cvt_pk_bf16_f32 v185, v62, v63
    v_cvt_pk_bf16_f32 v186, v64, v65
    buffer_load_dwordx4 a[12:15], v5, s[8:11], s34 offen offset:3072 sc1
    s_add_u32 s34, s34, 4096
    v_permlane16_swap_b32 v92, v94
    v_mov_b32 v93, v92
    v_mov_b32 v95, v94
    v_cvt_pk_bf16_f32 v187, v66, v67
    v_cvt_pk_bf16_f32 v188, v68, v69
    v_permlane32_swap_b32 v92, v93
    v_permlane32_swap_b32 v94, v95
    v_cvt_pk_bf16_f32 v189, v70, v71
    v_cvt_pk_bf16_f32 v190, v72, v73
    buffer_load_dwordx4 a[16:19], v253, s[8:11], s32 offen offset:0 sc1
    v_cvt_pk_bf16_f32 v191, v74, v75
    v_fma_f32 v16, v16, s18, v92
    v_fma_f32 v17, v17, s18, v92
    v_fma_f32 v18, v18, s18, v92
    v_fma_f32 v19, v19, s18, v92
    v_fma_f32 v20, v20, s18, v92
    v_fma_f32 v21, v21, s18, v92
    v_fma_f32 v22, v22, s18, v92
    v_fma_f32 v23, v23, s18, v92
    buffer_load_dwordx4 a[20:23], v253, s[8:11], s33 offen offset:0 sc1
    v_exp_f32 v16, v16
    v_exp_f32 v17, v17
    v_exp_f32 v18, v18
    v_exp_f32 v19, v19
    v_exp_f32 v20, v20
    v_exp_f32 v21, v21
    v_exp_f32 v22, v22
    v_exp_f32 v23, v23
    s_nop 0
    buffer_load_dwordx4 a[24:27], v5, s[8:11], s34 offen offset:0 sc1
    v_cvt_pk_bf16_f32 v76, v16, v17
    v_cvt_pk_bf16_f32 v77, v18, v19
    v_cvt_pk_bf16_f32 v78, v20, v21
    v_cvt_pk_bf16_f32 v79, v22, v23
    v_fma_f32 v24, v24, s18, v93
    v_fma_f32 v25, v25, s18, v93
    v_fma_f32 v26, v26, s18, v93
    v_fma_f32 v27, v27, s18, v93
    v_fma_f32 v28, v28, s18, v93
    buffer_load_dwordx4 a[28:31], v253, s[8:11], s32 offen offset:1024 sc1
    v_fma_f32 v29, v29, s18, v93
    v_fma_f32 v30, v30, s18, v93
    v_fma_f32 v31, v31, s18, v93
    v_exp_f32 v24, v24
    v_exp_f32 v25, v25
    v_exp_f32 v26, v26
    v_exp_f32 v27, v27
    v_exp_f32 v28, v28
    v_exp_f32 v29, v29
    buffer_load_dwordx4 a[32:35], v253, s[8:11], s33 offen offset:1024 sc1
    v_exp_f32 v30, v30
    v_exp_f32 v31, v31
    v_mfma_f32_16x16x32_bf16 v[100:103], v[172:175], v[76:79], 0
    v_mfma_f32_16x16x32_bf16 v[116:119], v[182:185], v[76:79], 0
    v_cvt_pk_bf16_f32 v80, v24, v25
    v_cvt_pk_bf16_f32 v81, v26, v27
    v_cvt_pk_bf16_f32 v82, v28, v29
    v_cvt_pk_bf16_f32 v83, v30, v31
    v_fma_f32 v32, v32, s18, v94
    buffer_load_dwordx4 a[36:39], v5, s[8:11], s34 offen offset:1024 sc1
    v_fma_f32 v33, v33, s18, v94
    v_fma_f32 v34, v34, s18, v94
    v_fma_f32 v35, v35, s18, v94
    v_fma_f32 v36, v36, s18, v94
    v_fma_f32 v37, v37, s18, v94
    v_fma_f32 v38, v38, s18, v94
    v_fma_f32 v39, v39, s18, v94
    v_exp_f32 v32, v32
    v_exp_f32 v33, v33
    buffer_load_dwordx4 a[40:43], v253, s[8:11], s32 offen offset:2048 sc1
    v_exp_f32 v34, v34
    v_exp_f32 v35, v35
    v_exp_f32 v36, v36
    v_exp_f32 v37, v37
    v_exp_f32 v38, v38
    v_exp_f32 v39, v39
    v_mfma_f32_16x16x32_bf16 v[104:107], v[174:177], v[80:83], 0
    v_mfma_f32_16x16x32_bf16 v[120:123], v[184:187], v[80:83], 0
    v_cvt_pk_bf16_f32 v84, v32, v33
    buffer_load_dwordx4 a[44:47], v253, s[8:11], s33 offen offset:2048 sc1
    v_cvt_pk_bf16_f32 v85, v34, v35
    v_cvt_pk_bf16_f32 v86, v36, v37
    v_cvt_pk_bf16_f32 v87, v38, v39
    v_fma_f32 v40, v40, s18, v95
    v_fma_f32 v41, v41, s18, v95
    v_fma_f32 v42, v42, s18, v95
    v_fma_f32 v43, v43, s18, v95
    v_fma_f32 v44, v44, s18, v95
    v_fma_f32 v45, v45, s18, v95
    buffer_load_dwordx4 a[48:51], v5, s[8:11], s34 offen offset:2048 sc1
    v_fma_f32 v46, v46, s18, v95
    v_fma_f32 v47, v47, s18, v95
    v_exp_f32 v40, v40
    v_exp_f32 v41, v41
    v_exp_f32 v42, v42
    v_exp_f32 v43, v43
    v_exp_f32 v44, v44
    v_exp_f32 v45, v45
    v_exp_f32 v46, v46
    buffer_load_dwordx4 a[52:55], v253, s[8:11], s32 offen offset:3072 sc1
    s_add_u32 s32, s32, 4096
    v_exp_f32 v47, v47
    v_mfma_f32_16x16x32_bf16 v[108:111], v[176:179], v[84:87], 0
    v_mfma_f32_16x16x32_bf16 v[124:127], v[186:189], v[84:87], 0
    v_cvt_pk_bf16_f32 v88, v40, v41
    v_cvt_pk_bf16_f32 v89, v42, v43
    v_cvt_pk_bf16_f32 v90, v44, v45
    v_cvt_pk_bf16_f32 v91, v46, v47
    v_rcp_f32 v96, v118
    v_rcp_f32 v97, v122
    buffer_load_dwordx4 v[240:243], v9, s[8:11], s37 offen offset:0 sc1
    v_mfma_f32_16x16x32_bf16 v[112:115], v[178:181], v[88:91], 0
    v_mfma_f32_16x16x32_bf16 v[128:131], v[188:191], v[88:91], 0
    v_pk_mul_f32 v[100:101], v[96:97], v[100:101] op_sel:[0,0] op_sel_hi:[0,1]
    v_pk_mul_f32 v[102:103], v[96:97], v[102:103] op_sel:[0,0] op_sel_hi:[0,1]
    v_pk_mul_f32 v[116:117], v[96:97], v[116:117] op_sel:[0,0] op_sel_hi:[0,1]
    v_cvt_pk_bf16_f32 v212, v100, v101
    v_cvt_pk_bf16_f32 v213, v102, v103
    v_cvt_pk_bf16_f32 v220, v116, v117
    v_rcp_f32 v98, v126
    buffer_load_dwordx4 v[244:247], v9, s[8:11], s37 offen offset:1024 sc1
    v_pk_mul_f32 v[104:105], v[96:97], v[104:105] op_sel:[1,0] op_sel_hi:[1,1]
    v_pk_mul_f32 v[106:107], v[96:97], v[106:107] op_sel:[1,0] op_sel_hi:[1,1]
    v_pk_mul_f32 v[120:121], v[96:97], v[120:121] op_sel:[1,0] op_sel_hi:[1,1]
    v_cvt_pk_bf16_f32 v214, v104, v105
    v_cvt_pk_bf16_f32 v215, v106, v107
    v_cvt_pk_bf16_f32 v221, v120, v121
    v_rcp_f32 v99, v130
    v_permlane16_swap_b32 v212, v214
    v_permlane16_swap_b32 v213, v215
    buffer_load_dwordx4 v[248:251], v7, s[8:11], s37 offen offset:2048 sc1
    v_pk_mul_f32 v[108:109], v[98:99], v[108:109] op_sel:[0,0] op_sel_hi:[0,1]
    v_pk_mul_f32 v[110:111], v[98:99], v[110:111] op_sel:[0,0] op_sel_hi:[0,1]
    v_pk_mul_f32 v[124:125], v[98:99], v[124:125] op_sel:[0,0] op_sel_hi:[0,1]
    v_cvt_pk_bf16_f32 v216, v108, v109
    v_cvt_pk_bf16_f32 v217, v110, v111
    v_cvt_pk_bf16_f32 v222, v124, v125
    v_pk_mul_f32 v[112:113], v[98:99], v[112:113] op_sel:[1,0] op_sel_hi:[1,1]
    v_pk_mul_f32 v[114:115], v[98:99], v[114:115] op_sel:[1,0] op_sel_hi:[1,1]
    v_pk_mul_f32 v[128:129], v[98:99], v[128:129] op_sel:[1,0] op_sel_hi:[1,1]
    buffer_load_dword v252, v8, s[8:11], s47 offen sc1
    v_cvt_pk_bf16_f32 v218, v112, v113
    v_cvt_pk_bf16_f32 v219, v114, v115
    v_cvt_pk_bf16_f32 v223, v128, v129
    s_lshl_b32 s7, s3, 2
    s_add_u32 s7, s7, 94208
    v_permlane16_swap_b32 v220, v221
    v_permlane16_swap_b32 v222, v223
    v_add_u32 v11, s7, v253
    v_lshrrev_b32 v10, 3, v0
    v_permlane32_swap_b32 v220, v222
    v_mul_u32_u24 v10, 9216, v10
    ds_write_b32 v11, v220
    v_permlane16_swap_b32 v216, v218
    v_permlane16_swap_b32 v217, v219
    s_mul_i32 s7, s40, 1152
    s_add_u32 s22, s22, s7
    s_add_u32 s22, s22, 41156608
    s_lshl_b32 s7, s3, 8
    s_add_u32 s23, s22, s7
    s_add_u32 s24, s23, 36864
    buffer_store_dwordx4 v[212:215], v9, s[8:11], s23 offen sc1
    buffer_store_dwordx4 v[216:219], v9, s[8:11], s24 offen sc1
    v_and_b32 v11, 7, v0
    v_lshl_add_u32 v10, v11, 4, v10
    s_cmp_eq_u32 s3, 3
    s_cselect_b32 s7, 0, 1073741824
    v_add_u32 v10, s7, v10
    v_add_u32 v11, 94208, v253
    s_waitcnt lgkmcnt(0)
    s_barrier
    ds_read_b128 v[220:223], v11
    s_waitcnt lgkmcnt(0)
    buffer_store_dwordx4 v[220:223], v10, s[8:11], s22 offen offset:1024 sc1
    v_lshlrev_b32 v15, 7, v0
    s_lshl_b32 s6, s40, 2
    s_add_u32 s6, s6, s44
    v_mov_b32 v1, s76
    s_mov_b64 vcc, 0xff
    s_waitcnt vmcnt(0)
    s_barrier
    s_cmp_lg_u32 s3, 0
    s_cbranch_scc1 L_pub_18
    s_mov_b64 exec, vcc
    buffer_store_dword v1, v15, s[8:11], s6 offen sc1
L_pub_18:
    s_mov_b64 exec, -1
    buffer_load_dwordx4 a[56:59], v253, s[8:11], s33 offen offset:3072 sc1
    s_add_u32 s33, s33, 4096
    buffer_load_dwordx4 a[60:63], v5, s[8:11], s34 offen offset:3072 sc1
    s_add_u32 s34, s34, 4096
    buffer_load_dwordx4 a[64:67], v253, s[8:11], s32 offen offset:0 sc1
    buffer_load_dwordx4 a[68:71], v253, s[8:11], s33 offen offset:0 sc1
    buffer_load_dwordx4 a[72:75], v5, s[8:11], s34 offen offset:0 sc1
    buffer_load_dwordx4 a[76:79], v253, s[8:11], s32 offen offset:1024 sc1
    buffer_load_dwordx4 a[80:83], v253, s[8:11], s33 offen offset:1024 sc1
    buffer_load_dwordx4 a[84:87], v5, s[8:11], s34 offen offset:1024 sc1
    s_cmp_lg_u32 s42, 0
    s_cbranch_scc1 L_swz_19
    s_cmp_eq_u32 s93, 2
    s_cselect_b32 s6, 2, 3
    s_mov_b32 s7, 512
    s_cmov_b32 s7, 2048
    v_lshrrev_b32 v14, 4, v0
    v_lshlrev_b32 v14, s6, v14
    v_bfe_u32 v15, v0, 2, 2
    v_add_u32 v14, v14, v15
    v_mul_u32_u24 v14, 128, v14
    v_and_b32 v15, 3, v0
    v_lshl_add_u32 v14, v15, 3, v14
    v_add_u32 v14, s79, v14
    v_add_u32 v15, s7, v14
    ds_read_b64_tr_b16 v[76:77], v14 offset:0
    ds_read_b64_tr_b16 v[78:79], v15 offset:0
    ds_read_b64_tr_b16 v[80:81], v14 offset:32
    ds_read_b64_tr_b16 v[82:83], v15 offset:32
    ds_read_b64_tr_b16 v[84:85], v14 offset:64
    ds_read_b64_tr_b16 v[86:87], v15 offset:64
    ds_read_b64_tr_b16 v[88:89], v14 offset:96
    ds_read_b64_tr_b16 v[90:91], v15 offset:96
    ds_read_b64_tr_b16 v[92:93], v14 offset:4096
    ds_read_b64_tr_b16 v[94:95], v15 offset:4096
    ds_read_b64_tr_b16 v[96:97], v14 offset:4128
    ds_read_b64_tr_b16 v[98:99], v15 offset:4128
    ds_read_b64_tr_b16 v[176:177], v14 offset:4160
    ds_read_b64_tr_b16 v[178:179], v15 offset:4160
    ds_read_b64_tr_b16 v[180:181], v14 offset:4192
    ds_read_b64_tr_b16 v[182:183], v15 offset:4192
    ds_read_b64_tr_b16 v[196:197], v14 offset:8192
    ds_read_b64_tr_b16 v[198:199], v15 offset:8192
    ds_read_b64_tr_b16 v[200:201], v14 offset:8224
    ds_read_b64_tr_b16 v[202:203], v15 offset:8224
    ds_read_b64_tr_b16 v[204:205], v14 offset:8256
    ds_read_b64_tr_b16 v[206:207], v15 offset:8256
    ds_read_b64_tr_b16 v[208:209], v14 offset:8288
    ds_read_b64_tr_b16 v[210:211], v15 offset:8288
    ds_read_b64_tr_b16 v[212:213], v14 offset:12288
    ds_read_b64_tr_b16 v[214:215], v15 offset:12288
    ds_read_b64_tr_b16 v[216:217], v14 offset:12320
    ds_read_b64_tr_b16 v[218:219], v15 offset:12320
    ds_read_b64_tr_b16 v[220:221], v14 offset:12352
    ds_read_b64_tr_b16 v[222:223], v15 offset:12352
    ds_read_b64_tr_b16 v[228:229], v14 offset:12384
    ds_read_b64_tr_b16 v[230:231], v15 offset:12384
    s_mul_i32 s68, s40, 1990656
    s_add_u32 s68, s68, 3145728
    s_cmp_eq_u32 s93, 2
    s_cbranch_scc1 L_swz_down_20
    s_mul_i32 s6, s84, 349526
    s_lshr_b32 s6, s6, 20
    s_mul_i32 s7, s6, 3
    s_sub_u32 s7, s84, s7
    s_mul_i32 s6, s6, 6
    s_add_u32 s7, s7, s6
    s_mul_i32 s6, s88, 36
    s_add_u32 s7, s7, s6
    s_mul_i32 s6, s93, 3
    s_add_u32 s7, s7, s6
    s_lshl_b32 s7, s7, 10
    s_add_u32 s7, s7, s68
    s_add_u32 s80, s7, 0
    s_add_u32 s81, s7, 497664
    s_add_u32 s82, s7, 995328
    s_add_u32 s83, s7, 1492992
    s_mul_i32 s6, s85, 349526
    s_lshr_b32 s6, s6, 20
    s_mul_i32 s7, s6, 3
    s_sub_u32 s7, s85, s7
    s_mul_i32 s6, s6, 6
    s_add_u32 s7, s7, s6
    s_mul_i32 s6, s89, 36
    s_add_u32 s7, s7, s6
    s_mul_i32 s6, s93, 3
    s_add_u32 s7, s7, s6
    s_lshl_b32 s7, s7, 10
    s_add_u32 s7, s7, s68
    s_add_u32 s64, s7, 0
    s_add_u32 s65, s7, 497664
    s_add_u32 s18, s7, 995328
    s_add_u32 s19, s7, 1492992
    s_mul_i32 s6, s86, 349526
    s_lshr_b32 s6, s6, 20
    s_mul_i32 s7, s6, 3
    s_sub_u32 s7, s86, s7
    s_mul_i32 s6, s6, 6
    s_add_u32 s7, s7, s6
    s_mul_i32 s6, s90, 36
    s_add_u32 s7, s7, s6
    s_mul_i32 s6, s93, 3
    s_add_u32 s7, s7, s6
    s_lshl_b32 s7, s7, 10
    s_add_u32 s7, s7, s68
    s_add_u32 s20, s7, 0
    s_add_u32 s21, s7, 497664
    s_add_u32 s22, s7, 995328
    s_add_u32 s25, s7, 1492992
    s_mul_i32 s6, s87, 349526
    s_lshr_b32 s6, s6, 20
    s_mul_i32 s7, s6, 3
    s_sub_u32 s7, s87, s7
    s_mul_i32 s6, s6, 6
    s_add_u32 s7, s7, s6
    s_mul_i32 s6, s91, 36
    s_add_u32 s7, s7, s6
    s_mul_i32 s6, s93, 3
    s_add_u32 s7, s7, s6
    s_lshl_b32 s7, s7, 10
    s_add_u32 s7, s7, s68
    s_add_u32 s26, s7, 0
    s_add_u32 s27, s7, 497664
    s_add_u32 s28, s7, 995328
    s_add_u32 s29, s7, 1492992
    s_branch L_swz_dest_21
L_swz_down_20:
    s_mul_i32 s7, s88, 18
    s_add_u32 s7, s7, s84
    s_add_u32 s7, s7, 324
    s_lshl_b32 s7, s7, 10
    s_add_u32 s7, s7, s68
    s_add_u32 s80, s7, 0
    s_add_u32 s81, s7, 497664
    s_add_u32 s82, s7, 995328
    s_add_u32 s83, s7, 1492992
    s_mul_i32 s7, s89, 18
    s_add_u32 s7, s7, s85
    s_add_u32 s7, s7, 324
    s_lshl_b32 s7, s7, 10
    s_add_u32 s7, s7, s68
    s_add_u32 s64, s7, 0
    s_add_u32 s65, s7, 497664
    s_add_u32 s18, s7, 995328
    s_add_u32 s19, s7, 1492992
    s_mul_i32 s7, s90, 18
    s_add_u32 s7, s7, s86
    s_add_u32 s7, s7, 324
    s_lshl_b32 s7, s7, 10
    s_add_u32 s7, s7, s68
    s_add_u32 s20, s7, 0
    s_add_u32 s21, s7, 497664
    s_add_u32 s22, s7, 995328
    s_add_u32 s25, s7, 1492992
    s_mul_i32 s7, s91, 18
    s_add_u32 s7, s7, s87
    s_add_u32 s7, s7, 324
    s_lshl_b32 s7, s7, 10
    s_add_u32 s7, s7, s68
    s_add_u32 s26, s7, 0
    s_add_u32 s27, s7, 497664
    s_add_u32 s28, s7, 995328
    s_add_u32 s29, s7, 1492992
L_swz_dest_21:
    s_mov_b32 s72, s8
    s_mov_b32 s73, s9
    s_mov_b32 s74, 268435456
    s_waitcnt lgkmcnt(0)
    buffer_store_dwordx4 v[76:79], v253, s[72:75], s80 offen sc1
    buffer_store_dwordx4 v[80:83], v253, s[72:75], s81 offen sc1
    buffer_store_dwordx4 v[84:87], v253, s[72:75], s82 offen sc1
    buffer_store_dwordx4 v[88:91], v253, s[72:75], s83 offen sc1
    buffer_store_dwordx4 v[92:95], v253, s[72:75], s64 offen sc1
    buffer_store_dwordx4 v[96:99], v253, s[72:75], s65 offen sc1
L_swz_19:
    s_and_b32 s7, s3, 1
    s_mul_i32 s7, s7, 18432
    s_add_u32 s24, s30, s7
    s_lshr_b32 s7, s3, 1
    s_lshl_b32 s7, s7, 9
    s_add_u32 s24, s24, s7
    s_add_u32 s24, s24, 41156608
    s_mov_b32 s16, 0xffff0000
    v_lshlrev_b32 v124, 16, v240
    v_and_b32 v125, s16, v240
    v_lshlrev_b32 v126, 16, v241
    v_and_b32 v127, s16, v241
    v_lshlrev_b32 v128, 16, v242
    v_and_b32 v129, s16, v242
    v_lshlrev_b32 v130, 16, v243
    v_and_b32 v131, s16, v243
    v_lshlrev_b32 v132, 16, v244
    v_and_b32 v133, s16, v244
    v_lshlrev_b32 v134, 16, v245
    v_and_b32 v135, s16, v245
    v_lshlrev_b32 v136, 16, v246
    v_and_b32 v137, s16, v246
    v_lshlrev_b32 v138, 16, v247
    v_and_b32 v139, s16, v247
    v_lshlrev_b32 v140, 16, v248
    v_and_b32 v141, s16, v248
    v_lshlrev_b32 v142, 16, v249
    v_and_b32 v143, s16, v249
    v_lshlrev_b32 v144, 16, v250
    v_and_b32 v145, s16, v250
    v_lshlrev_b32 v146, 16, v251
    v_and_b32 v147, s16, v251
    s_cmp_eq_u32 s3, 1
    s_cselect_b32 s7, 16, 0
    v_lshlrev_b32 v12, 2, v0
    v_cmp_gt_u32 vcc, s7, v0
    v_add_u32 v10, 40960, v12
    v_add_u32 v11, 41472, v12
    v_cndmask_b32 v10, v11, v10, vcc
    v_and_b32 v11, 0x7c, v12
    v_cmp_gt_u32 vcc, 32, v0
    v_mov_b32 v13, 1073741824
    s_and_b32 s7, s40, 3
    s_lshl_b32 s45, s45, 2
    v_cndmask_b32 v8, v13, v12, vcc
    s_add_u32 s6, s7, s3
    s_cmp_eq_u32 s6, 0
    s_cselect_b32 s6, 0, 1073741824
    v_add_u32 v6, s6, v8
    s_add_u32 s45, s45, s7
    s_lshl_b32 s45, s45, 2
    s_add_u32 s45, s45, s3
    s_lshl_b32 s45, s45, 7
    s_add_u32 s45, s45, s43
    s_add_u32 s45, s45, 48300032
    s_cmp_eq_u32 s3, 0
    s_cselect_b32 s35, 1.0, 0
    s_lshl_b32 s7, s40, 2
    s_add_u32 s7, s7, s3
    s_mul_i32 s23, s7, 497664
    s_add_u32 s23, s23, 3145728
    s_add_u32 s50, s23, 497664
    s_mul_i32 s50, s50, s42
    v_mov_b32 v184, v253
    v_add_u32 v185, 4096, v253
    v_add_u32 v186, 8192, v253
    v_add_u32 v187, 12288, v253
    v_add_u32 v188, 16384, v253
    v_add_u32 v189, 20480, v253
    v_add_u32 v190, 24576, v253
    v_add_u32 v191, 28672, v253
    v_add_u32 v192, 32768, v253
    s_cmp_lg_u32 s3, 0
    s_cbranch_scc1 L_pollout_24
    s_lshl_b32 s7, s40, 7
    s_add_u32 s7, s7, s44
    s_add_u32 s52, s4, s7
    s_addc_u32 s53, s5, 0
    s_mov_b32 s6, 0
L_poll_22:
    s_load_dwordx8 s[56:63], s[52:53], 0 glc
    s_add_u32 s6, s6, 1
    s_waitcnt lgkmcnt(0)
    s_xor_b64 s[56:57], s[56:57], s[76:77]
    s_xor_b64 s[58:59], s[58:59], s[76:77]
    s_xor_b64 s[60:61], s[60:61], s[76:77]
    s_xor_b64 s[62:63], s[62:63], s[76:77]
    s_or_b64 s[56:57], s[56:57], s[58:59]
    s_or_b64 s[60:61], s[60:61], s[62:63]
    s_or_b64 s[56:57], s[56:57], s[60:61]
    s_cbranch_scc0 L_polled_23
    s_cmp_lt_u32 s6, 1048576
    s_cbranch_scc1 L_poll_22
    s_branch L_main_end
L_polled_23:
L_pollout_24:
    s_barrier
    s_lshl_b32 m0, s3, 10
    s_nop 0
    buffer_load_dwordx4 v2, s[8:11], s24 offen sc1 lds
    s_add_u32 m0, m0, 4096
    s_add_u32 s24, s24, 1024
    buffer_load_dwordx4 v2, s[8:11], s24 offen sc1 lds
    s_add_u32 m0, m0, 4096
    s_add_u32 s24, s24, 1024
    buffer_load_dwordx4 v2, s[8:11], s24 offen sc1 lds
    s_add_u32 m0, m0, 4096
    s_add_u32 s24, s24, 1024
    buffer_load_dwordx4 v2, s[8:11], s24 offen sc1 lds
    s_add_u32 m0, m0, 4096
    s_add_u32 s24, s24, 1024
    buffer_load_dwordx4 v2, s[8:11], s24 offen sc1 lds
    s_add_u32 m0, m0, 4096
    s_add_u32 s24, s24, 1024
    buffer_load_dwordx4 v2, s[8:11], s24 offen sc1 lds
    s_add_u32 m0, m0, 4096
    s_add_u32 s24, s24, 1024
    buffer_load_dwordx4 v2, s[8:11], s24 offen sc1 lds
    s_add_u32 m0, m0, 4096
    s_add_u32 s24, s24, 1024
    buffer_load_dwordx4 v2, s[8:11], s24 offen sc1 lds
    s_add_u32 m0, m0, 4096
    s_add_u32 s24, s24, 1024
    buffer_load_dwordx4 v2, s[8:11], s24 offen sc1 lds
    s_cmp_lg_u32 s42, 0
    s_cbranch_scc1 L_swz_25
    buffer_store_dwordx4 v[176:179], v253, s[72:75], s18 offen sc1
    buffer_store_dwordx4 v[180:183], v253, s[72:75], s19 offen sc1
    buffer_store_dwordx4 v[196:199], v253, s[72:75], s20 offen sc1
    buffer_store_dwordx4 v[200:203], v253, s[72:75], s21 offen sc1
    buffer_store_dwordx4 v[204:207], v253, s[72:75], s22 offen sc1
    buffer_store_dwordx4 v[208:211], v253, s[72:75], s25 offen sc1
    buffer_store_dwordx4 v[212:215], v253, s[72:75], s26 offen sc1
    buffer_store_dwordx4 v[216:219], v253, s[72:75], s27 offen sc1
    buffer_store_dwordx4 v[220:223], v253, s[72:75], s28 offen sc1
    buffer_store_dwordx4 v[228:231], v253, s[72:75], s29 offen sc1
    s_waitcnt vmcnt(10)
    s_branch L_swz_26
L_swz_25:
    s_waitcnt vmcnt(0)
L_swz_26:
    s_barrier
    ds_read_b128 v[160:163], v253 offset:0
    ds_read_b128 v[164:167], v253 offset:1024
    s_waitcnt lgkmcnt(0)
    v_mfma_f32_16x16x32_bf16 v[100:103], a[160:163], v[160:163], 0
    ds_read_b128 v[168:171], v253 offset:2048
    v_mfma_f32_16x16x32_bf16 v[104:107], a[160:163], v[164:167], 0
    ds_read_b128 v[172:175], v253 offset:3072
    v_mfma_f32_16x16x32_bf16 v[108:111], a[164:167], v[160:163], 0
    v_mfma_f32_16x16x32_bf16 v[112:115], a[164:167], v[164:167], 0
    buffer_load_dwordx4 v[16:19], v184, s[48:51], s23 offen offset:0 sc1
    v_mfma_f32_16x16x32_bf16 v[116:119], a[168:171], v[160:163], 0
    v_mfma_f32_16x16x32_bf16 v[120:123], a[168:171], v[164:167], 0
    s_waitcnt lgkmcnt(0)
    v_mfma_f32_16x16x32_bf16 v[100:103], a[172:175], v[168:171], v[100:103]
    ds_read_b128 v[160:163], v253 offset:4096
    v_mfma_f32_16x16x32_bf16 v[104:107], a[172:175], v[172:175], v[104:107]
    ds_read_b128 v[164:167], v253 offset:5120
    v_mfma_f32_16x16x32_bf16 v[108:111], a[176:179], v[168:171], v[108:111]
    v_mfma_f32_16x16x32_bf16 v[112:115], a[176:179], v[172:175], v[112:115]
    buffer_load_dwordx4 v[20:23], v184, s[48:51], s23 offen offset:1024 sc1
    v_mfma_f32_16x16x32_bf16 v[116:119], a[180:183], v[168:171], v[116:119]
    v_mfma_f32_16x16x32_bf16 v[120:123], a[180:183], v[172:175], v[120:123]
    s_waitcnt lgkmcnt(0)
    v_mfma_f32_16x16x32_bf16 v[100:103], a[184:187], v[160:163], v[100:103]
    ds_read_b128 v[168:171], v253 offset:6144
    v_mfma_f32_16x16x32_bf16 v[104:107], a[184:187], v[164:167], v[104:107]
    ds_read_b128 v[172:175], v253 offset:7168
    v_mfma_f32_16x16x32_bf16 v[108:111], a[188:191], v[160:163], v[108:111]
    v_mfma_f32_16x16x32_bf16 v[112:115], a[188:191], v[164:167], v[112:115]
    buffer_load_dwordx4 v[24:27], v184, s[48:51], s23 offen offset:2048 sc1
    v_mfma_f32_16x16x32_bf16 v[116:119], a[192:195], v[160:163], v[116:119]
    v_mfma_f32_16x16x32_bf16 v[120:123], a[192:195], v[164:167], v[120:123]
    s_waitcnt lgkmcnt(0)
    v_mfma_f32_16x16x32_bf16 v[100:103], a[196:199], v[168:171], v[100:103]
    ds_read_b128 v[160:163], v253 offset:8192
    v_mfma_f32_16x16x32_bf16 v[104:107], a[196:199], v[172:175], v[104:107]
    ds_read_b128 v[164:167], v253 offset:9216
    v_mfma_f32_16x16x32_bf16 v[108:111], a[200:203], v[168:171], v[108:111]
    v_mfma_f32_16x16x32_bf16 v[112:115], a[200:203], v[172:175], v[112:115]
    buffer_load_dwordx4 v[28:31], v184, s[48:51], s23 offen offset:3072 sc1
    v_mfma_f32_16x16x32_bf16 v[116:119], a[204:207], v[168:171], v[116:119]
    v_mfma_f32_16x16x32_bf16 v[120:123], a[204:207], v[172:175], v[120:123]
    s_waitcnt lgkmcnt(0)
    v_mfma_f32_16x16x32_bf16 v[100:103], a[208:211], v[160:163], v[100:103]
    ds_read_b128 v[168:171], v253 offset:10240
    v_mfma_f32_16x16x32_bf16 v[104:107], a[208:211], v[164:167], v[104:107]
    ds_read_b128 v[172:175], v253 offset:11264
    v_mfma_f32_16x16x32_bf16 v[108:111], a[212:215], v[160:163], v[108:111]
    v_mfma_f32_16x16x32_bf16 v[112:115], a[212:215], v[164:167], v[112:115]
    buffer_load_dwordx4 v[32:35], v185, s[48:51], s23 offen offset:0 sc1
    v_mfma_f32_16x16x32_bf16 v[116:119], a[216:219], v[160:163], v[116:119]
    v_mfma_f32_16x16x32_bf16 v[120:123], a[216:219], v[164:167], v[120:123]
    s_waitcnt lgkmcnt(0)
    v_mfma_f32_16x16x32_bf16 v[100:103], a[220:223], v[168:171], v[100:103]
    ds_read_b128 v[160:163], v253 offset:12288
    v_mfma_f32_16x16x32_bf16 v[104:107], a[220:223], v[172:175], v[104:107]
    ds_read_b128 v[164:167], v253 offset:13312
    v_mfma_f32_16x16x32_bf16 v[108:111], a[224:227], v[168:171], v[108:111]
    v_mfma_f32_16x16x32_bf16 v[112:115], a[224:227], v[172:175], v[112:115]
    buffer_load_dwordx4 v[36:39], v185, s[48:51], s23 offen offset:1024 sc1
    v_mfma_f32_16x16x32_bf16 v[116:119], a[228:231], v[168:171], v[116:119]
    v_mfma_f32_16x16x32_bf16 v[120:123], a[228:231], v[172:175], v[120:123]
    s_waitcnt lgkmcnt(0)
    v_mfma_f32_16x16x32_bf16 v[100:103], a[232:235], v[160:163], v[100:103]
    ds_read_b128 v[168:171], v253 offset:14336
    v_mfma_f32_16x16x32_bf16 v[104:107], a[232:235], v[164:167], v[104:107]
    ds_read_b128 v[172:175], v253 offset:15360
    v_mfma_f32_16x16x32_bf16 v[108:111], a[236:239], v[160:163], v[108:111]
    v_mfma_f32_16x16x32_bf16 v[112:115], a[236:239], v[164:167], v[112:115]
    buffer_load_dwordx4 v[40:43], v185, s[48:51], s23 offen offset:2048 sc1
    v_mfma_f32_16x16x32_bf16 v[116:119], a[240:243], v[160:163], v[116:119]
    v_mfma_f32_16x16x32_bf16 v[120:123], a[240:243], v[164:167], v[120:123]
    s_waitcnt lgkmcnt(0)
    v_mfma_f32_16x16x32_bf16 v[100:103], a[244:247], v[168:171], v[100:103]
    ds_read_b128 v[160:163], v253 offset:16384
    v_mfma_f32_16x16x32_bf16 v[104:107], a[244:247], v[172:175], v[104:107]
    ds_read_b128 v[164:167], v253 offset:17408
    v_mfma_f32_16x16x32_bf16 v[108:111], a[248:251], v[168:171], v[108:111]
    v_mfma_f32_16x16x32_bf16 v[112:115], a[248:251], v[172:175], v[112:115]
    buffer_load_dwordx4 v[44:47], v185, s[48:51], s23 offen offset:3072 sc1
    v_mfma_f32_16x16x32_bf16 v[116:119], a[252:255], v[168:171], v[116:119]
    v_mfma_f32_16x16x32_bf16 v[120:123], a[252:255], v[172:175], v[120:123]
    s_waitcnt lgkmcnt(0)
    v_mfma_f32_16x16x32_bf16 v[100:103], a[128:131], v[160:163], v[100:103]
    ds_read_b128 v[168:171], v253 offset:18432
    v_mfma_f32_16x16x32_bf16 v[104:107], a[128:131], v[164:167], v[104:107]
    ds_read_b128 v[172:175], v253 offset:19456
    v_mfma_f32_16x16x32_bf16 v[108:111], a[132:135], v[160:163], v[108:111]
    v_mfma_f32_16x16x32_bf16 v[112:115], a[132:135], v[164:167], v[112:115]
    buffer_load_dwordx4 v[48:51], v186, s[48:51], s23 offen offset:0 sc1
    v_mfma_f32_16x16x32_bf16 v[116:119], a[136:139], v[160:163], v[116:119]
    v_mfma_f32_16x16x32_bf16 v[120:123], a[136:139], v[164:167], v[120:123]
    s_waitcnt lgkmcnt(0)
    v_mfma_f32_16x16x32_bf16 v[100:103], a[140:143], v[168:171], v[100:103]
    ds_read_b128 v[160:163], v253 offset:20480
    v_mfma_f32_16x16x32_bf16 v[104:107], a[140:143], v[172:175], v[104:107]
    ds_read_b128 v[164:167], v253 offset:21504
    v_mfma_f32_16x16x32_bf16 v[108:111], a[144:147], v[168:171], v[108:111]
    v_mfma_f32_16x16x32_bf16 v[112:115], a[144:147], v[172:175], v[112:115]
    buffer_load_dwordx4 v[52:55], v186, s[48:51], s23 offen offset:1024 sc1
    v_mfma_f32_16x16x32_bf16 v[116:119], a[148:151], v[168:171], v[116:119]
    v_mfma_f32_16x16x32_bf16 v[120:123], a[148:151], v[172:175], v[120:123]
    s_waitcnt lgkmcnt(0)
    v_mfma_f32_16x16x32_bf16 v[100:103], a[152:155], v[160:163], v[100:103]
    ds_read_b128 v[168:171], v253 offset:22528
    v_mfma_f32_16x16x32_bf16 v[104:107], a[152:155], v[164:167], v[104:107]
    ds_read_b128 v[172:175], v253 offset:23552
    v_mfma_f32_16x16x32_bf16 v[108:111], a[156:159], v[160:163], v[108:111]
    v_mfma_f32_16x16x32_bf16 v[112:115], a[156:159], v[164:167], v[112:115]
    buffer_load_dwordx4 v[56:59], v186, s[48:51], s23 offen offset:2048 sc1
    v_mfma_f32_16x16x32_bf16 v[116:119], a[0:3], v[160:163], v[116:119]
    v_mfma_f32_16x16x32_bf16 v[120:123], a[0:3], v[164:167], v[120:123]
    s_waitcnt lgkmcnt(0)
    v_mfma_f32_16x16x32_bf16 v[100:103], a[4:7], v[168:171], v[100:103]
    ds_read_b128 v[160:163], v253 offset:24576
    v_mfma_f32_16x16x32_bf16 v[104:107], a[4:7], v[172:175], v[104:107]
    ds_read_b128 v[164:167], v253 offset:25600
    v_mfma_f32_16x16x32_bf16 v[108:111], a[8:11], v[168:171], v[108:111]
    v_mfma_f32_16x16x32_bf16 v[112:115], a[8:11], v[172:175], v[112:115]
    buffer_load_dwordx4 v[60:63], v186, s[48:51], s23 offen offset:3072 sc1
    v_mfma_f32_16x16x32_bf16 v[116:119], a[12:15], v[168:171], v[116:119]
    v_mfma_f32_16x16x32_bf16 v[120:123], a[12:15], v[172:175], v[120:123]
    s_waitcnt lgkmcnt(0)
    v_mfma_f32_16x16x32_bf16 v[100:103], a[16:19], v[160:163], v[100:103]
    ds_read_b128 v[168:171], v253 offset:26624
    v_mfma_f32_16x16x32_bf16 v[104:107], a[16:19], v[164:167], v[104:107]
    ds_read_b128 v[172:175], v253 offset:27648
    v_mfma_f32_16x16x32_bf16 v[108:111], a[20:23], v[160:163], v[108:111]
    v_mfma_f32_16x16x32_bf16 v[112:115], a[20:23], v[164:167], v[112:115]
    buffer_load_dwordx4 v[64:67], v187, s[48:51], s23 offen offset:0 sc1
    v_mfma_f32_16x16x32_bf16 v[116:119], a[24:27], v[160:163], v[116:119]
    v_mfma_f32_16x16x32_bf16 v[120:123], a[24:27], v[164:167], v[120:123]
    s_waitcnt lgkmcnt(0)
    v_mfma_f32_16x16x32_bf16 v[100:103], a[28:31], v[168:171], v[100:103]
    ds_read_b128 v[160:163], v253 offset:28672
    v_mfma_f32_16x16x32_bf16 v[104:107], a[28:31], v[172:175], v[104:107]
    ds_read_b128 v[164:167], v253 offset:29696
    v_mfma_f32_16x16x32_bf16 v[108:111], a[32:35], v[168:171], v[108:111]
    v_mfma_f32_16x16x32_bf16 v[112:115], a[32:35], v[172:175], v[112:115]
    buffer_load_dwordx4 v[68:71], v187, s[48:51], s23 offen offset:1024 sc1
    v_mfma_f32_16x16x32_bf16 v[116:119], a[36:39], v[168:171], v[116:119]
    v_mfma_f32_16x16x32_bf16 v[120:123], a[36:39], v[172:175], v[120:123]
    s_waitcnt lgkmcnt(0)
    v_mfma_f32_16x16x32_bf16 v[100:103], a[40:43], v[160:163], v[100:103]
    ds_read_b128 v[168:171], v253 offset:30720
    v_mfma_f32_16x16x32_bf16 v[104:107], a[40:43], v[164:167], v[104:107]
    ds_read_b128 v[172:175], v253 offset:31744
    v_mfma_f32_16x16x32_bf16 v[108:111], a[44:47], v[160:163], v[108:111]
    v_mfma_f32_16x16x32_bf16 v[112:115], a[44:47], v[164:167], v[112:115]
    buffer_load_dwordx4 v[72:75], v187, s[48:51], s23 offen offset:2048 sc1
    v_mfma_f32_16x16x32_bf16 v[116:119], a[48:51], v[160:163], v[116:119]
    v_mfma_f32_16x16x32_bf16 v[120:123], a[48:51], v[164:167], v[120:123]
    s_waitcnt lgkmcnt(0)
    v_mfma_f32_16x16x32_bf16 v[100:103], a[52:55], v[168:171], v[100:103]
    ds_read_b128 v[160:163], v253 offset:32768
    v_mfma_f32_16x16x32_bf16 v[104:107], a[52:55], v[172:175], v[104:107]
    ds_read_b128 v[164:167], v253 offset:33792
    v_mfma_f32_16x16x32_bf16 v[108:111], a[56:59], v[168:171], v[108:111]
    v_mfma_f32_16x16x32_bf16 v[112:115], a[56:59], v[172:175], v[112:115]
    v_mfma_f32_16x16x32_bf16 v[116:119], a[60:63], v[168:171], v[116:119]
    v_mfma_f32_16x16x32_bf16 v[120:123], a[60:63], v[172:175], v[120:123]
    s_waitcnt lgkmcnt(0)
    v_mfma_f32_16x16x32_bf16 v[100:103], a[64:67], v[160:163], v[100:103]
    ds_read_b128 v[168:171], v253 offset:34816
    v_mfma_f32_16x16x32_bf16 v[104:107], a[64:67], v[164:167], v[104:107]
    ds_read_b128 v[172:175], v253 offset:35840
    v_mfma_f32_16x16x32_bf16 v[108:111], a[68:71], v[160:163], v[108:111]
    v_mfma_f32_16x16x32_bf16 v[112:115], a[68:71], v[164:167], v[112:115]
    v_mfma_f32_16x16x32_bf16 v[116:119], a[72:75], v[160:163], v[116:119]
    v_mfma_f32_16x16x32_bf16 v[120:123], a[72:75], v[164:167], v[120:123]
    s_waitcnt lgkmcnt(0)
    v_mfma_f32_16x16x32_bf16 v[100:103], a[76:79], v[168:171], v[100:103]
    v_mfma_f32_16x16x32_bf16 v[104:107], a[76:79], v[172:175], v[104:107]
    v_mfma_f32_16x16x32_bf16 v[108:111], a[80:83], v[168:171], v[108:111]
    v_mfma_f32_16x16x32_bf16 v[112:115], a[80:83], v[172:175], v[112:115]
    v_mfma_f32_16x16x32_bf16 v[116:119], a[84:87], v[168:171], v[116:119]
    v_mfma_f32_16x16x32_bf16 v[120:123], a[84:87], v[172:175], v[120:123]
    s_nop 3
    v_permlane16_swap_b32 v100, v104
    v_permlane16_swap_b32 v101, v105
    v_permlane16_swap_b32 v102, v106
    v_permlane16_swap_b32 v103, v107
    v_add_f32 v12, v116, v117
    v_add_f32 v13, v120, v121
    ds_write_b32 v10, v12
    ds_write_b32 v10, v13 offset:64
    v_permlane16_swap_b32 v108, v112
    v_permlane16_swap_b32 v109, v113
    v_permlane16_swap_b32 v110, v114
    v_permlane16_swap_b32 v111, v115
    v_permlane16_swap_b32 v116, v120
    v_permlane16_swap_b32 v117, v121
    v_permlane16_swap_b32 v118, v122
    v_permlane16_swap_b32 v119, v123
    s_waitcnt lgkmcnt(0)
    s_barrier
    ds_read_b32 v12, v11 offset:40960
    v_pk_add_f32 v[124:125], v[124:125], v[100:101]
    v_pk_add_f32 v[126:127], v[126:127], v[102:103]
    v_pk_add_f32 v[128:129], v[128:129], v[104:105]
    v_pk_add_f32 v[130:131], v[130:131], v[106:107]
    v_pk_add_f32 v[132:133], v[132:133], v[108:109]
    v_pk_add_f32 v[134:135], v[134:135], v[110:111]
    v_pk_add_f32 v[136:137], v[136:137], v[112:113]
    v_pk_add_f32 v[138:139], v[138:139], v[114:115]
    v_pk_add_f32 v[140:141], v[140:141], v[116:117]
    v_pk_add_f32 v[142:143], v[142:143], v[118:119]
    v_pk_add_f32 v[144:145], v[144:145], v[120:121]
    v_pk_add_f32 v[146:147], v[146:147], v[122:123]
    v_mov_b32 v14, 0
    v_mov_b32 v15, 0
    s_waitcnt lgkmcnt(0)
    v_add_f32 v12, v12, v252
    v_pk_add_f32 v[100:101], v[124:125], v[12:13] op_sel_hi:[1,0] neg_lo:[0,1] neg_hi:[0,1]
    v_pk_add_f32 v[102:103], v[126:127], v[12:13] op_sel_hi:[1,0] neg_lo:[0,1] neg_hi:[0,1]
    v_pk_add_f32 v[104:105], v[128:129], v[12:13] op_sel_hi:[1,0] neg_lo:[0,1] neg_hi:[0,1]
    v_pk_add_f32 v[106:107], v[130:131], v[12:13] op_sel_hi:[1,0] neg_lo:[0,1] neg_hi:[0,1]
    v_cvt_pk_bf16_f32 v148, v100, v101
    v_cvt_pk_bf16_f32 v149, v102, v103
    v_cvt_pk_bf16_f32 v150, v104, v105
    v_cvt_pk_bf16_f32 v151, v106, v107
    buffer_store_dwordx4 v[148:151], v9, s[8:11], s46 offen offset:0 sc1
    v_pk_add_f32 v[108:109], v[132:133], v[12:13] op_sel_hi:[1,0] neg_lo:[0,1] neg_hi:[0,1]
    v_pk_add_f32 v[110:111], v[134:135], v[12:13] op_sel_hi:[1,0] neg_lo:[0,1] neg_hi:[0,1]
    v_pk_add_f32 v[112:113], v[136:137], v[12:13] op_sel_hi:[1,0] neg_lo:[0,1] neg_hi:[0,1]
    v_pk_add_f32 v[114:115], v[138:139], v[12:13] op_sel_hi:[1,0] neg_lo:[0,1] neg_hi:[0,1]
    v_cvt_pk_bf16_f32 v152, v108, v109
    v_cvt_pk_bf16_f32 v153, v110, v111
    v_cvt_pk_bf16_f32 v154, v112, v113
    v_cvt_pk_bf16_f32 v155, v114, v115
    buffer_store_dwordx4 v[152:155], v9, s[8:11], s46 offen offset:1024 sc1
    v_pk_add_f32 v[116:117], v[140:141], v[12:13] op_sel_hi:[1,0] neg_lo:[0,1] neg_hi:[0,1]
    v_pk_add_f32 v[118:119], v[142:143], v[12:13] op_sel_hi:[1,0] neg_lo:[0,1] neg_hi:[0,1]
    v_pk_add_f32 v[120:121], v[144:145], v[12:13] op_sel_hi:[1,0] neg_lo:[0,1] neg_hi:[0,1]
    v_pk_add_f32 v[122:123], v[146:147], v[12:13] op_sel_hi:[1,0] neg_lo:[0,1] neg_hi:[0,1]
    v_cvt_pk_bf16_f32 v156, v116, v117
    v_cvt_pk_bf16_f32 v157, v118, v119
    v_cvt_pk_bf16_f32 v158, v120, v121
    v_cvt_pk_bf16_f32 v159, v122, v123
    buffer_store_dwordx4 v[156:159], v7, s[8:11], s46 offen offset:2048 sc1
    v_dot2c_f32_bf16 v14, v148, v148
    v_dot2c_f32_bf16 v14, v149, v149
    v_dot2c_f32_bf16 v14, v150, v150
    v_dot2c_f32_bf16 v14, v151, v151
    v_dot2c_f32_bf16 v14, v152, v152
    v_dot2c_f32_bf16 v14, v153, v153
    v_dot2c_f32_bf16 v14, v154, v154
    v_dot2c_f32_bf16 v14, v155, v155
    v_dot2c_f32_bf16 v15, v156, v156
    v_dot2c_f32_bf16 v15, v157, v157
    v_dot2c_f32_bf16 v15, v158, v158
    v_dot2c_f32_bf16 v15, v159, v159
    buffer_store_dword v12, v6, s[8:11], s36 offen sc1
    s_nop 1
    v_fma_f32 v14, v15, s35, v14
    v_mov_b32 v15, v14
    s_nop 1
    v_permlane32_swap_b32 v14, v15
    v_add_f32 v14, v14, v15
    buffer_store_dword v14, v8, s[8:11], s45 offen sc1
    v_lshlrev_b32 v15, 7, v0
    s_lshl_b32 s6, s40, 2
    s_add_u32 s6, s6, s44
    s_add_u32 s6, s6, 32768
    v_mov_b32 v1, s76
    s_mov_b64 vcc, 0xff
    s_waitcnt vmcnt(0)
    s_barrier
    s_cmp_lg_u32 s3, 0
    s_cbranch_scc1 L_pub_27
    s_mov_b64 exec, vcc
    buffer_store_dword v1, v15, s[8:11], s6 offen sc1
    s_cmp_lg_u32 s42, 0
    s_cbranch_scc1 L_pub_27
    v_lshlrev_b32 v15, 10, v0
    s_lshl_b32 s6, s40, 7
    s_lshl_b32 s7, s41, 2
    s_add_u32 s6, s6, s7
    s_add_u32 s6, s6, 19464192
    s_mov_b64 exec, 0xffffffff
    v_lshlrev_b32 v15, 10, v0
    v_mov_b32 v1, s76
    buffer_store_dword v1, v15, s[8:11], s6 offen sc1
L_pub_27:
    s_mov_b64 exec, -1
    s_lshl_b32 s7, s41, 2
    s_add_u32 s7, s7, s3
    s_mul_i32 s22, s7, 18432
    s_add_u32 s22, s22, s43
    s_add_u32 s22, s22, 45875200
    s_mul_i32 s24, s3, 18432
    s_lshl_b32 s25, s41, 12
    s_add_u32 s25, s25, s43
    s_add_u32 s25, s25, 48300032
    v_lshrrev_b32 v3, 5, v0
    v_and_b32 v10, 31, v0
    v_lshlrev_b32 v10, 2, v10
    v_lshl_add_u32 v3, v3, 11, v10
    v_add_u32 v11, 36864, v184
    s_mov_b32 s16, 0xffff0000
    s_lshl_b32 s7, s3, 10
    v_add_u32 v172, s7, v253
    v_add_u32 v174, 5120, v172
    v_and_b32 v178, 7, v0
    v_mul_u32_u24 v178, 1152, v178
    v_lshrrev_b32 v179, 3, v0
    v_lshl_add_u32 v178, v179, 4, v178
    s_lshl_b32 s7, s3, 7
    v_add_u32 v175, s7, v178
    v_add_u32 v177, 640, v175
    s_cmp_eq_u32 s3, 0
    s_mov_b32 s17, 1073741824
    s_cmov_b32 s17, 4096
    v_add_u32 v173, s17, v172
    s_mov_b32 s17, 1073741824
    s_cmov_b32 s17, 512
    v_add_u32 v176, s17, v175
    s_lshl_b32 s21, s41, 3
    s_add_u32 s21, s21, s40
    s_mul_i32 s18, s21, 9216
    s_mul_i32 s20, s21, 73728
    s_add_u32 s20, s20, 19922944
    s_mov_b32 s19, s20
    v_bfe_u32 v1, v0, 3, 2
    s_mov_b32 s7, 73728
    v_mul_lo_u32 v178, v1, s7
    v_lshrrev_b32 v1, 5, v0
    v_lshl_add_u32 v178, v1, 7, v178
    v_and_b32 v1, 7, v0
    v_lshl_add_u32 v178, v1, 4, v178
    v_add_u32 v179, 294912, v178
    s_mul_i32 s26, s41, 589824
    s_mul_i32 s7, s40, 9216
    s_add_u32 s26, s26, s7
    s_lshl_b32 s7, s3, 8
    s_add_u32 s27, s26, s7
    s_add_u32 s27, s27, 19921920
    s_mov_b32 s74, 0
    s_mul_i32 s7, s42, 98304
    s_sub_u32 s29, s44, s7
    s_add_u32 s29, s29, 360448
    s_lshl_b32 s7, s40, 7
    s_add_u32 s7, s7, s29
    s_add_u32 s38, s4, s7
    s_addc_u32 s39, s5, 0
    s_lshl_b32 s7, s40, 2
    s_add_u32 s29, s29, s7
    s_cmp_lg_u32 s3, 0
    s_cbranch_scc1 L_pollout_30
    s_lshl_b32 s7, s40, 7
    s_add_u32 s7, s7, s44
    s_add_u32 s7, s7, 32768
    s_add_u32 s52, s4, s7
    s_addc_u32 s53, s5, 0
    s_mov_b32 s6, 0
L_poll_28:
    s_load_dwordx8 s[56:63], s[52:53], 0 glc
    s_add_u32 s6, s6, 1
    s_waitcnt lgkmcnt(0)
    s_xor_b64 s[56:57], s[56:57], s[76:77]
    s_xor_b64 s[58:59], s[58:59], s[76:77]
    s_xor_b64 s[60:61], s[60:61], s[76:77]
    s_xor_b64 s[62:63], s[62:63], s[76:77]
    s_or_b64 s[56:57], s[56:57], s[58:59]
    s_or_b64 s[60:61], s[60:61], s[62:63]
    s_or_b64 s[56:57], s[56:57], s[60:61]
    s_cbranch_scc0 L_polled_29
    s_cmp_lt_u32 s6, 1048576
    s_cbranch_scc1 L_poll_28
    s_branch L_main_end
L_polled_29:
    s_cmp_lg_u32 s42, 0
    s_cbranch_scc1 L_pollout_30
    s_lshl_b32 s7, s41, 3
    s_add_u32 s7, s7, s40
    s_lshl_b32 s7, s7, 7
    s_add_u32 s7, s7, 19464192
    s_add_u32 s68, s4, s7
    s_addc_u32 s69, s5, 0
    s_mov_b32 s6, 0
    s_mov_b32 s7, 0
L_cpoll_31:
    s_load_dwordx16 s[52:67], s[68:69], s7 glc
    s_add_u32 s6, s6, 1
    s_waitcnt lgkmcnt(0)
    s_xor_b64 s[52:53], s[52:53], s[76:77]
    s_xor_b64 s[54:55], s[54:55], s[76:77]
    s_xor_b64 s[56:57], s[56:57], s[76:77]
    s_xor_b64 s[58:59], s[58:59], s[76:77]
    s_xor_b64 s[60:61], s[60:61], s[76:77]
    s_xor_b64 s[62:63], s[62:63], s[76:77]
    s_xor_b64 s[64:65], s[64:65], s[76:77]
    s_xor_b64 s[66:67], s[66:67], s[76:77]
    s_or_b64 s[52:53], s[52:53], s[60:61]
    s_or_b64 s[54:55], s[54:55], s[62:63]
    s_or_b64 s[56:57], s[56:57], s[64:65]
    s_or_b64 s[58:59], s[58:59], s[66:67]
    s_or_b64 s[52:53], s[52:53], s[56:57]
    s_or_b64 s[54:55], s[54:55], s[58:59]
    s_or_b64 s[52:53], s[52:53], s[54:55]
    s_cbranch_scc1 L_cpoll_32
    s_add_u32 s7, s7, 64
    s_cmp_eq_u32 s7, 128
    s_cbranch_scc1 L_cpolled_33
L_cpoll_32:
    s_cmp_lt_u32 s6, 1048576
    s_cbranch_scc1 L_cpoll_31
    s_branch L_main_end
L_cpolled_33:
L_pollout_30:
    s_barrier
    s_add_u32 s50, s23, 497664
    s_cmp_lg_u32 s42, 0
    s_cbranch_scc1 L_ring_34
    buffer_load_dwordx4 v[16:19], v184, s[48:51], s23 offen offset:0 sc1
    buffer_load_dwordx4 v[20:23], v184, s[48:51], s23 offen offset:1024 sc1
    buffer_load_dwordx4 v[24:27], v184, s[48:51], s23 offen offset:2048 sc1
    buffer_load_dwordx4 v[28:31], v184, s[48:51], s23 offen offset:3072 sc1
    buffer_load_dwordx4 v[32:35], v185, s[48:51], s23 offen offset:0 sc1
    buffer_load_dwordx4 v[36:39], v185, s[48:51], s23 offen offset:1024 sc1
    buffer_load_dwordx4 v[40:43], v185, s[48:51], s23 offen offset:2048 sc1
    buffer_load_dwordx4 v[44:47], v185, s[48:51], s23 offen offset:3072 sc1
    buffer_load_dwordx4 v[48:51], v186, s[48:51], s23 offen offset:0 sc1
    buffer_load_dwordx4 v[52:55], v186, s[48:51], s23 offen offset:1024 sc1
    buffer_load_dwordx4 v[56:59], v186, s[48:51], s23 offen offset:2048 sc1
    buffer_load_dwordx4 v[60:63], v186, s[48:51], s23 offen offset:3072 sc1
    buffer_load_dwordx4 v[64:67], v187, s[48:51], s23 offen offset:0 sc1
    buffer_load_dwordx4 v[68:71], v187, s[48:51], s23 offen offset:1024 sc1
    buffer_load_dwordx4 v[72:75], v187, s[48:51], s23 offen offset:2048 sc1
L_ring_34:
    s_add_u32 m0, s24, 0
    s_nop 0
    buffer_load_dwordx4 v2, s[8:11], s22 offen offset:0 sc1 lds
    s_add_u32 m0, s24, 512
    s_nop 0
    buffer_load_dwordx4 v2, s[8:11], s22 offen offset:512 sc1 lds
    s_add_u32 m0, s24, 1024
    s_nop 0
    buffer_load_dwordx4 v2, s[8:11], s22 offen offset:1024 sc1 lds
    s_add_u32 m0, s24, 1536
    s_nop 0
    buffer_load_dwordx4 v2, s[8:11], s22 offen offset:1536 sc1 lds
    s_add_u32 m0, s24, 2048
    s_nop 0
    buffer_load_dwordx4 v2, s[8:11], s22 offen offset:2048 sc1 lds
    s_add_u32 m0, s24, 2560
    s_nop 0
    buffer_load_dwordx4 v2, s[8:11], s22 offen offset:2560 sc1 lds
    s_add_u32 m0, s24, 3072
    s_nop 0
    buffer_load_dwordx4 v2, s[8:11], s22 offen offset:3072 sc1 lds
    s_add_u32 m0, s24, 3584
    s_nop 0
    buffer_load_dwordx4 v2, s[8:11], s22 offen offset:3584 sc1 lds
    s_add_u32 m0, s24, 8192
    s_add_u32 s22, s22, 4096
    buffer_load_dwordx4 v2, s[8:11], s22 offen offset:0 sc1 lds
    s_add_u32 m0, s24, 8704
    s_nop 0
    buffer_load_dwordx4 v2, s[8:11], s22 offen offset:512 sc1 lds
    s_add_u32 m0, s24, 9216
    s_nop 0
    buffer_load_dwordx4 v2, s[8:11], s22 offen offset:1024 sc1 lds
    s_add_u32 m0, s24, 9728
    s_nop 0
    buffer_load_dwordx4 v2, s[8:11], s22 offen offset:1536 sc1 lds
    s_add_u32 s23, s23, 15360
    s_lshr_b32 s7, s3, 1
    s_lshl_b32 s7, s7, 10
    s_and_b32 s6, s3, 1
    s_lshl_b32 s6, s6, 3
    s_add_u32 s28, s7, s6
    s_add_u32 s28, s28, 73728
    s_waitcnt vmcnt(6)
    s_barrier
    ds_read_b128 a[0:3], v184 offset:0
    ds_read_b128 a[72:75], v184 offset:18432
    ds_read_b128 a[144:147], v11 offset:0
    ds_read_b128 a[216:219], v11 offset:18432
    ds_read_b128 a[4:7], v184 offset:1024
    ds_read_b128 a[76:79], v184 offset:19456
    ds_read_b128 a[148:151], v11 offset:1024
    ds_read_b128 a[220:223], v11 offset:19456
    ds_read_b128 a[8:11], v184 offset:2048
    ds_read_b128 a[80:83], v184 offset:20480
    ds_read_b128 a[152:155], v11 offset:2048
    ds_read_b128 a[224:227], v11 offset:20480
    s_waitcnt vmcnt(24) lgkmcnt(0)
    v_mfma_f32_16x16x32_bf16 v[88:91], v[16:19], a[0:3], 0
    ds_read_b128 a[12:15], v184 offset:3072
    v_mfma_f32_16x16x32_bf16 v[88:91], v[20:23], a[4:7], v[88:91]
    buffer_load_dwordx4 v[76:79], v184, s[48:51], s23 offen offset:0 sc1
    v_mfma_f32_16x16x32_bf16 v[88:91], v[24:27], a[8:11], v[88:91]
    ds_read_b128 a[84:87], v184 offset:21504
    v_mfma_f32_16x16x32_bf16 v[92:95], v[16:19], a[72:75], 0
    s_add_u32 m0, s24, 10240
    s_nop 0
    buffer_load_dwordx4 v2, s[8:11], s22 offen offset:2048 sc1 lds
    v_mfma_f32_16x16x32_bf16 v[92:95], v[20:23], a[76:79], v[92:95]
    ds_read_b128 a[156:159], v11 offset:3072
    ds_read_b128 a[228:231], v11 offset:21504
    v_mfma_f32_16x16x32_bf16 v[92:95], v[24:27], a[80:83], v[92:95]
    buffer_load_dwordx4 v[80:83], v184, s[48:51], s23 offen offset:1024 sc1
    v_mfma_f32_16x16x32_bf16 v[96:99], v[16:19], a[144:147], 0
    ds_read_b128 a[16:19], v184 offset:4096
    v_mfma_f32_16x16x32_bf16 v[96:99], v[20:23], a[148:151], v[96:99]
    s_add_u32 m0, s24, 10752
    s_nop 0
    buffer_load_dwordx4 v2, s[8:11], s22 offen offset:2560 sc1 lds
    v_mfma_f32_16x16x32_bf16 v[96:99], v[24:27], a[152:155], v[96:99]
    ds_read_b128 a[88:91], v184 offset:22528
    v_mfma_f32_16x16x32_bf16 v[100:103], v[16:19], a[216:219], 0
    buffer_load_dwordx4 v[84:87], v184, s[48:51], s23 offen offset:2048 sc1
    v_mfma_f32_16x16x32_bf16 v[100:103], v[20:23], a[220:223], v[100:103]
    ds_read_b128 a[160:163], v11 offset:4096
    ds_read_b128 a[232:235], v11 offset:22528
    v_mfma_f32_16x16x32_bf16 v[100:103], v[24:27], a[224:227], v[100:103]
    s_add_u32 m0, s24, 11264
    s_nop 0
    buffer_load_dwordx4 v2, s[8:11], s22 offen offset:3072 sc1 lds
    s_waitcnt vmcnt(27) lgkmcnt(8)
    v_mfma_f32_16x16x32_bf16 v[104:107], v[28:31], a[0:3], 0
    ds_read_b128 a[20:23], v184 offset:5120
    v_mfma_f32_16x16x32_bf16 v[104:107], v[32:35], a[4:7], v[104:107]
    buffer_load_dwordx4 v[16:19], v184, s[48:51], s23 offen offset:3072 sc1
    v_mfma_f32_16x16x32_bf16 v[104:107], v[36:39], a[8:11], v[104:107]
    ds_read_b128 a[92:95], v184 offset:23552
    v_mfma_f32_16x16x32_bf16 v[108:111], v[28:31], a[72:75], 0
    s_add_u32 m0, s24, 11776
    s_nop 0
    buffer_load_dwordx4 v2, s[8:11], s22 offen offset:3584 sc1 lds
    v_mfma_f32_16x16x32_bf16 v[108:111], v[32:35], a[76:79], v[108:111]
    ds_read_b128 a[164:167], v11 offset:5120
    ds_read_b128 a[236:239], v11 offset:23552
    v_mfma_f32_16x16x32_bf16 v[108:111], v[36:39], a[80:83], v[108:111]
    buffer_load_dwordx4 v[20:23], v185, s[48:51], s23 offen offset:0 sc1
    v_mfma_f32_16x16x32_bf16 v[112:115], v[28:31], a[144:147], 0
    v_mfma_f32_16x16x32_bf16 v[112:115], v[32:35], a[148:151], v[112:115]
    s_add_u32 m0, s24, 16384
    s_add_u32 s22, s22, 4096
    buffer_load_dwordx4 v2, s[8:11], s22 offen offset:0 sc1 lds
    v_mfma_f32_16x16x32_bf16 v[112:115], v[36:39], a[152:155], v[112:115]
    v_mfma_f32_16x16x32_bf16 v[116:119], v[28:31], a[216:219], 0
    buffer_load_dwordx4 v[24:27], v185, s[48:51], s23 offen offset:1024 sc1
    v_mfma_f32_16x16x32_bf16 v[116:119], v[32:35], a[220:223], v[116:119]
    v_mfma_f32_16x16x32_bf16 v[116:119], v[36:39], a[224:227], v[116:119]
    s_add_u32 m0, s24, 16896
    s_nop 0
    buffer_load_dwordx4 v2, s[8:11], s22 offen offset:512 sc1 lds
    s_waitcnt vmcnt(12) lgkmcnt(0)
    s_barrier
    v_mfma_f32_16x16x32_bf16 v[88:91], v[40:43], a[12:15], v[88:91]
    ds_read_b128 a[24:27], v184 offset:6144
    v_mfma_f32_16x16x32_bf16 v[88:91], v[44:47], a[16:19], v[88:91]
    buffer_load_dwordx4 v[28:31], v185, s[48:51], s23 offen offset:2048 sc1
    v_mfma_f32_16x16x32_bf16 v[88:91], v[48:51], a[20:23], v[88:91]
    ds_read_b128 a[96:99], v184 offset:24576
    v_mfma_f32_16x16x32_bf16 v[92:95], v[40:43], a[84:87], v[92:95]
    buffer_load_dword v136, v3, s[8:11], s25 offen offset:0 sc1
    v_mfma_f32_16x16x32_bf16 v[92:95], v[44:47], a[88:91], v[92:95]
    ds_read_b128 a[168:171], v11 offset:6144
    ds_read_b128 a[240:243], v11 offset:24576
    v_mfma_f32_16x16x32_bf16 v[92:95], v[48:51], a[92:95], v[92:95]
    buffer_load_dwordx4 v[32:35], v185, s[48:51], s23 offen offset:3072 sc1
    v_mfma_f32_16x16x32_bf16 v[96:99], v[40:43], a[156:159], v[96:99]
    buffer_load_dword v137, v3, s[8:11], s25 offen offset:128 sc1
    v_mfma_f32_16x16x32_bf16 v[96:99], v[44:47], a[160:163], v[96:99]
    buffer_load_dword v138, v3, s[8:11], s25 offen offset:256 sc1
    v_mfma_f32_16x16x32_bf16 v[96:99], v[48:51], a[164:167], v[96:99]
    ds_read_b128 a[28:31], v184 offset:7168
    ds_read_b128 a[100:103], v184 offset:25600
    v_mfma_f32_16x16x32_bf16 v[100:103], v[40:43], a[228:231], v[100:103]
    buffer_load_dwordx4 v[36:39], v186, s[48:51], s23 offen offset:0 sc1
    v_mfma_f32_16x16x32_bf16 v[100:103], v[44:47], a[232:235], v[100:103]
    buffer_load_dword v139, v3, s[8:11], s25 offen offset:384 sc1
    v_mfma_f32_16x16x32_bf16 v[100:103], v[48:51], a[236:239], v[100:103]
    buffer_load_dword v140, v3, s[8:11], s25 offen offset:512 sc1
    s_waitcnt vmcnt(35) lgkmcnt(6)
    v_mfma_f32_16x16x32_bf16 v[104:107], v[52:55], a[12:15], v[104:107]
    ds_read_b128 a[172:175], v11 offset:7168
    ds_read_b128 a[244:247], v11 offset:25600
    v_mfma_f32_16x16x32_bf16 v[104:107], v[56:59], a[16:19], v[104:107]
    buffer_load_dwordx4 v[40:43], v186, s[48:51], s23 offen offset:1024 sc1
    v_mfma_f32_16x16x32_bf16 v[104:107], v[60:63], a[20:23], v[104:107]
    ds_read_b128 a[32:35], v184 offset:8192
    ds_read_b128 a[104:107], v184 offset:26624
    v_mfma_f32_16x16x32_bf16 v[108:111], v[52:55], a[84:87], v[108:111]
    buffer_load_dword v141, v3, s[8:11], s25 offen offset:640 sc1
    v_mfma_f32_16x16x32_bf16 v[108:111], v[56:59], a[88:91], v[108:111]
    ds_read_b128 a[176:179], v11 offset:8192
    ds_read_b128 a[248:251], v11 offset:26624
    v_mfma_f32_16x16x32_bf16 v[108:111], v[60:63], a[92:95], v[108:111]
    buffer_load_dwordx4 v[44:47], v186, s[48:51], s23 offen offset:2048 sc1
    v_mfma_f32_16x16x32_bf16 v[112:115], v[52:55], a[156:159], v[112:115]
    buffer_load_dword v142, v3, s[8:11], s25 offen offset:768 sc1
    v_mfma_f32_16x16x32_bf16 v[112:115], v[56:59], a[160:163], v[112:115]
    buffer_load_dword v143, v3, s[8:11], s25 offen offset:896 sc1
    v_mfma_f32_16x16x32_bf16 v[112:115], v[60:63], a[164:167], v[112:115]
    v_mfma_f32_16x16x32_bf16 v[116:119], v[52:55], a[228:231], v[116:119]
    buffer_load_dwordx4 v[48:51], v186, s[48:51], s23 offen offset:3072 sc1
    v_mfma_f32_16x16x32_bf16 v[116:119], v[56:59], a[232:235], v[116:119]
    buffer_load_dword v144, v3, s[8:11], s25 offen offset:1024 sc1
    v_mfma_f32_16x16x32_bf16 v[116:119], v[60:63], a[236:239], v[116:119]
    buffer_load_dword v145, v3, s[8:11], s25 offen offset:1152 sc1
    s_waitcnt vmcnt(40) lgkmcnt(0)
    v_mfma_f32_16x16x32_bf16 v[88:91], v[64:67], a[24:27], v[88:91]
    ds_read_b128 a[36:39], v184 offset:9216
    v_mfma_f32_16x16x32_bf16 v[88:91], v[68:71], a[28:31], v[88:91]
    buffer_load_dwordx4 v[52:55], v187, s[48:51], s23 offen offset:0 sc1
    v_mfma_f32_16x16x32_bf16 v[88:91], v[72:75], a[32:35], v[88:91]
    ds_read_b128 a[108:111], v184 offset:27648
    v_mfma_f32_16x16x32_bf16 v[92:95], v[64:67], a[96:99], v[92:95]
    buffer_load_dword v146, v3, s[8:11], s25 offen offset:1280 sc1
    v_mfma_f32_16x16x32_bf16 v[92:95], v[68:71], a[100:103], v[92:95]
    ds_read_b128 a[180:183], v11 offset:9216
    ds_read_b128 a[252:255], v11 offset:27648
    v_mfma_f32_16x16x32_bf16 v[92:95], v[72:75], a[104:107], v[92:95]
    buffer_load_dwordx4 v[56:59], v187, s[48:51], s23 offen offset:1024 sc1
    v_mfma_f32_16x16x32_bf16 v[96:99], v[64:67], a[168:171], v[96:99]
    buffer_load_dword v147, v3, s[8:11], s25 offen offset:1408 sc1
    v_mfma_f32_16x16x32_bf16 v[96:99], v[68:71], a[172:175], v[96:99]
    buffer_load_dword v148, v3, s[8:11], s25 offen offset:1536 sc1
    v_mfma_f32_16x16x32_bf16 v[96:99], v[72:75], a[176:179], v[96:99]
    ds_read_b128 a[40:43], v184 offset:10240
    ds_read_b128 a[112:115], v184 offset:28672
    v_mfma_f32_16x16x32_bf16 v[100:103], v[64:67], a[240:243], v[100:103]
    buffer_load_dwordx4 v[60:63], v187, s[48:51], s23 offen offset:2048 sc1
    v_mfma_f32_16x16x32_bf16 v[100:103], v[68:71], a[244:247], v[100:103]
    buffer_load_dword v149, v3, s[8:11], s25 offen offset:1664 sc1
    v_mfma_f32_16x16x32_bf16 v[100:103], v[72:75], a[248:251], v[100:103]
    buffer_load_dword v150, v3, s[8:11], s25 offen offset:1792 sc1
    s_waitcnt vmcnt(31) lgkmcnt(6)
    v_mfma_f32_16x16x32_bf16 v[104:107], v[76:79], a[24:27], v[104:107]
    ds_read_b128 a[184:187], v11 offset:10240
    ds_read_b128 v[220:223], v11 offset:28672
    v_mfma_f32_16x16x32_bf16 v[104:107], v[80:83], a[28:31], v[104:107]
    buffer_load_dwordx4 v[64:67], v187, s[48:51], s23 offen offset:3072 sc1
    v_mfma_f32_16x16x32_bf16 v[104:107], v[84:87], a[32:35], v[104:107]
    ds_read_b128 a[44:47], v184 offset:11264
    ds_read_b128 a[116:119], v184 offset:29696
    v_mfma_f32_16x16x32_bf16 v[108:111], v[76:79], a[96:99], v[108:111]
    buffer_load_dword v151, v3, s[8:11], s25 offen offset:1920 sc1
    v_mfma_f32_16x16x32_bf16 v[108:111], v[80:83], a[100:103], v[108:111]
    ds_read_b128 a[188:191], v11 offset:11264
    ds_read_b128 v[224:227], v11 offset:29696
    v_mfma_f32_16x16x32_bf16 v[108:111], v[84:87], a[104:107], v[108:111]
    buffer_load_dwordx4 v[68:71], v188, s[48:51], s23 offen offset:0 sc1
    v_mfma_f32_16x16x32_bf16 v[112:115], v[76:79], a[168:171], v[112:115]
    v_mfma_f32_16x16x32_bf16 v[112:115], v[80:83], a[172:175], v[112:115]
    v_mfma_f32_16x16x32_bf16 v[112:115], v[84:87], a[176:179], v[112:115]
    v_mfma_f32_16x16x32_bf16 v[116:119], v[76:79], a[240:243], v[116:119]
    buffer_load_dwordx4 v[72:75], v188, s[48:51], s23 offen offset:1024 sc1
    v_mfma_f32_16x16x32_bf16 v[116:119], v[80:83], a[244:247], v[116:119]
    v_mfma_f32_16x16x32_bf16 v[116:119], v[84:87], a[248:251], v[116:119]
    s_waitcnt vmcnt(28) lgkmcnt(0)
    s_barrier
    v_mfma_f32_16x16x32_bf16 v[88:91], v[16:19], a[36:39], v[88:91]
    ds_read_b128 a[48:51], v184 offset:12288
    v_mfma_f32_16x16x32_bf16 v[88:91], v[20:23], a[40:43], v[88:91]
    buffer_load_dwordx4 v[76:79], v188, s[48:51], s23 offen offset:2048 sc1
    v_mfma_f32_16x16x32_bf16 v[88:91], v[24:27], a[44:47], v[88:91]
    ds_read_b128 a[120:123], v184 offset:30720
    v_mfma_f32_16x16x32_bf16 v[92:95], v[16:19], a[108:111], v[92:95]
    ds_read_b128 a[192:195], v11 offset:12288
    v_mfma_f32_16x16x32_bf16 v[92:95], v[20:23], a[112:115], v[92:95]
    ds_read_b128 v[228:231], v11 offset:30720
    v_mfma_f32_16x16x32_bf16 v[92:95], v[24:27], a[116:119], v[92:95]
    buffer_load_dwordx4 v[80:83], v188, s[48:51], s23 offen offset:3072 sc1
    v_mfma_f32_16x16x32_bf16 v[96:99], v[16:19], a[180:183], v[96:99]
    ds_read_b128 a[52:55], v184 offset:13312
    v_mfma_f32_16x16x32_bf16 v[96:99], v[20:23], a[184:187], v[96:99]
    ds_read_b128 a[124:127], v184 offset:31744
    v_mfma_f32_16x16x32_bf16 v[96:99], v[24:27], a[188:191], v[96:99]
    v_mfma_f32_16x16x32_bf16 v[100:103], v[16:19], a[252:255], v[100:103]
    buffer_load_dwordx4 v[84:87], v189, s[48:51], s23 offen offset:0 sc1
    v_mfma_f32_16x16x32_bf16 v[100:103], v[20:23], v[220:223], v[100:103]
    ds_read_b128 a[196:199], v11 offset:13312
    ds_read_b128 v[232:235], v11 offset:31744
    v_mfma_f32_16x16x32_bf16 v[100:103], v[24:27], v[224:227], v[100:103]
    s_waitcnt vmcnt(25) lgkmcnt(8)
    v_mfma_f32_16x16x32_bf16 v[104:107], v[28:31], a[36:39], v[104:107]
    ds_read_b128 a[56:59], v184 offset:14336
    v_mfma_f32_16x16x32_bf16 v[104:107], v[32:35], a[40:43], v[104:107]
    buffer_load_dwordx4 v[16:19], v189, s[48:51], s23 offen offset:1024 sc1
    v_mfma_f32_16x16x32_bf16 v[104:107], v[36:39], a[44:47], v[104:107]
    ds_read_b128 a[128:131], v184 offset:32768
    v_mfma_f32_16x16x32_bf16 v[108:111], v[28:31], a[108:111], v[108:111]
    ds_read_b128 a[200:203], v11 offset:14336
    v_mfma_f32_16x16x32_bf16 v[108:111], v[32:35], a[112:115], v[108:111]
    ds_read_b128 v[236:239], v11 offset:32768
    v_mfma_f32_16x16x32_bf16 v[108:111], v[36:39], a[116:119], v[108:111]
    buffer_load_dwordx4 v[20:23], v189, s[48:51], s23 offen offset:2048 sc1
    v_mfma_f32_16x16x32_bf16 v[112:115], v[28:31], a[180:183], v[112:115]
    v_mfma_f32_16x16x32_bf16 v[112:115], v[32:35], a[184:187], v[112:115]
    v_mfma_f32_16x16x32_bf16 v[112:115], v[36:39], a[188:191], v[112:115]
    v_mfma_f32_16x16x32_bf16 v[116:119], v[28:31], a[252:255], v[116:119]
    buffer_load_dwordx4 v[24:27], v189, s[48:51], s23 offen offset:3072 sc1
    v_mfma_f32_16x16x32_bf16 v[116:119], v[32:35], v[220:223], v[116:119]
    v_mfma_f32_16x16x32_bf16 v[116:119], v[36:39], v[224:227], v[116:119]
    s_waitcnt vmcnt(8) lgkmcnt(0)
    v_mfma_f32_16x16x32_bf16 v[88:91], v[40:43], a[48:51], v[88:91]
    ds_read_b128 a[60:63], v184 offset:15360
    v_add_f32 v136, v136, v144
    v_mfma_f32_16x16x32_bf16 v[88:91], v[44:47], a[52:55], v[88:91]
    buffer_load_dwordx4 v[28:31], v190, s[48:51], s23 offen offset:0 sc1
    v_mfma_f32_16x16x32_bf16 v[88:91], v[48:51], a[56:59], v[88:91]
    ds_read_b128 a[132:135], v184 offset:33792
    v_add_f32 v137, v137, v145
    v_mfma_f32_16x16x32_bf16 v[92:95], v[40:43], a[120:123], v[92:95]
    ds_read_b128 a[204:207], v11 offset:15360
    v_add_f32 v138, v138, v146
    v_mfma_f32_16x16x32_bf16 v[92:95], v[44:47], a[124:127], v[92:95]
    ds_read_b128 v[240:243], v11 offset:33792
    v_add_f32 v139, v139, v147
    v_mfma_f32_16x16x32_bf16 v[92:95], v[48:51], a[128:131], v[92:95]
    buffer_load_dwordx4 v[32:35], v190, s[48:51], s23 offen offset:1024 sc1
    v_mfma_f32_16x16x32_bf16 v[96:99], v[40:43], a[192:195], v[96:99]
    ds_read_b128 a[64:67], v184 offset:16384
    v_add_f32 v140, v140, v148
    v_mfma_f32_16x16x32_bf16 v[96:99], v[44:47], a[196:199], v[96:99]
    ds_read_b128 a[136:139], v184 offset:34816
    v_add_f32 v141, v141, v149
    v_mfma_f32_16x16x32_bf16 v[96:99], v[48:51], a[200:203], v[96:99]
    v_add_f32 v142, v142, v150
    v_add_f32 v143, v143, v151
    v_mfma_f32_16x16x32_bf16 v[100:103], v[40:43], v[228:231], v[100:103]
    buffer_load_dwordx4 v[36:39], v190, s[48:51], s23 offen offset:2048 sc1
    v_mfma_f32_16x16x32_bf16 v[100:103], v[44:47], v[232:235], v[100:103]
    ds_read_b128 a[208:211], v11 offset:16384
    ds_read_b128 v[244:247], v11 offset:34816
    v_mfma_f32_16x16x32_bf16 v[100:103], v[48:51], v[236:239], v[100:103]
    v_add_f32 v136, v136, v140
    v_add_f32 v137, v137, v141
    s_waitcnt vmcnt(15) lgkmcnt(8)
    v_mfma_f32_16x16x32_bf16 v[104:107], v[52:55], a[48:51], v[104:107]
    ds_read_b128 a[68:71], v184 offset:17408
    v_add_f32 v138, v138, v142
    v_mfma_f32_16x16x32_bf16 v[104:107], v[56:59], a[52:55], v[104:107]
    buffer_load_dwordx4 v[40:43], v190, s[48:51], s23 offen offset:3072 sc1
    v_mfma_f32_16x16x32_bf16 v[104:107], v[60:63], a[56:59], v[104:107]
    ds_read_b128 a[140:143], v184 offset:35840
    v_add_f32 v139, v139, v143
    v_mfma_f32_16x16x32_bf16 v[108:111], v[52:55], a[120:123], v[108:111]
    ds_read_b128 a[212:215], v11 offset:17408
    v_add_f32 v136, v136, v138
    v_mfma_f32_16x16x32_bf16 v[108:111], v[56:59], a[124:127], v[108:111]
    ds_read_b128 v[248:251], v11 offset:35840
    v_add_f32 v137, v137, v139
    v_mfma_f32_16x16x32_bf16 v[108:111], v[60:63], a[128:131], v[108:111]
    buffer_load_dwordx4 v[44:47], v191, s[48:51], s23 offen offset:0 sc1
    v_mfma_f32_16x16x32_bf16 v[112:115], v[52:55], a[192:195], v[112:115]
    v_add_f32 v136, v136, v137
    v_mov_b32 v137, 0x3727c5ac
    v_mfma_f32_16x16x32_bf16 v[112:115], v[56:59], a[196:199], v[112:115]
    v_fmac_f32 v137, 0x3ae38e39, v136
    v_mov_b32 v193, v137
    v_mfma_f32_16x16x32_bf16 v[112:115], v[60:63], a[200:203], v[112:115]
    s_nop 0
    v_permlane16_swap_b32 v193, v137
    v_mfma_f32_16x16x32_bf16 v[116:119], v[52:55], v[228:231], v[116:119]
    buffer_load_dwordx4 v[48:51], v191, s[48:51], s23 offen offset:1024 sc1
    v_mfma_f32_16x16x32_bf16 v[116:119], v[56:59], v[232:235], v[116:119]
    v_mov_b32 v195, v193
    v_mov_b32 v194, v137
    v_mfma_f32_16x16x32_bf16 v[116:119], v[60:63], v[236:239], v[116:119]
    v_mov_b32 v252, v137
    s_waitcnt vmcnt(12) lgkmcnt(0)
    v_mfma_f32_16x16x32_bf16 v[88:91], v[64:67], a[60:63], v[88:91]
    s_nop 0
    v_permlane32_swap_b32 v193, v195
    v_mfma_f32_16x16x32_bf16 v[88:91], v[68:71], a[64:67], v[88:91]
    buffer_load_dwordx4 v[52:55], v191, s[48:51], s23 offen offset:2048 sc1
    v_mfma_f32_16x16x32_bf16 v[120:123], v[72:75], a[68:71], v[88:91]
    v_permlane32_swap_b32 v194, v252
    v_mfma_f32_16x16x32_bf16 v[92:95], v[64:67], a[132:135], v[92:95]
    v_rsq_f32 v4, v193
    v_mfma_f32_16x16x32_bf16 v[92:95], v[68:71], a[136:139], v[92:95]
    v_rsq_f32 v5, v194
    v_mfma_f32_16x16x32_bf16 v[124:127], v[72:75], a[140:143], v[92:95]
    buffer_load_dwordx4 v[56:59], v191, s[48:51], s23 offen offset:3072 sc1
    v_mfma_f32_16x16x32_bf16 v[96:99], v[64:67], a[204:207], v[96:99]
    v_rsq_f32 v6, v195
    v_mfma_f32_16x16x32_bf16 v[96:99], v[68:71], a[208:211], v[96:99]
    v_rsq_f32 v7, v252
    v_mfma_f32_16x16x32_bf16 v[128:131], v[72:75], a[212:215], v[96:99]
    v_mul_f32 v8, v4, v4
    v_mul_f32 v9, v5, v5
    v_mfma_f32_16x16x32_bf16 v[100:103], v[64:67], v[240:243], v[100:103]
    buffer_load_dwordx4 v[60:63], v192, s[48:51], s23 offen offset:0 sc1
    v_mfma_f32_16x16x32_bf16 v[100:103], v[68:71], v[244:247], v[100:103]
    v_mul_f32 v13, v6, v6
    v_mul_f32 v14, v7, v7
    v_mfma_f32_16x16x32_bf16 v[132:135], v[72:75], v[248:251], v[100:103]
    v_mul_f32 v4, 0xc0135761, v4
    v_mul_f32 v5, 0xc0135761, v5
    s_waitcnt vmcnt(12) lgkmcnt(0)
    v_mfma_f32_16x16x32_bf16 v[104:107], v[76:79], a[60:63], v[104:107]
    v_mul_f32 v6, 0xc0135761, v6
    v_mul_f32 v7, 0xc0135761, v7
    v_mfma_f32_16x16x32_bf16 v[104:107], v[80:83], a[64:67], v[104:107]
    buffer_load_dwordx4 v[64:67], v192, s[48:51], s23 offen offset:1024 sc1
    v_mfma_f32_16x16x32_bf16 v[136:139], v[84:87], a[68:71], v[104:107]
    v_mul_f32 v8, 0x3d372713, v8
    v_mul_f32 v9, 0x3d372713, v9
    v_mfma_f32_16x16x32_bf16 v[108:111], v[76:79], a[132:135], v[108:111]
    v_mul_f32 v13, 0x3d372713, v13
    v_mul_f32 v14, 0x3d372713, v14
    v_mfma_f32_16x16x32_bf16 v[108:111], v[80:83], a[136:139], v[108:111]
    v_mul_f32 v8, v8, v4
    v_mul_f32 v9, v9, v5
    v_mfma_f32_16x16x32_bf16 v[140:143], v[84:87], a[140:143], v[108:111]
    buffer_load_dwordx4 v[68:71], v192, s[48:51], s23 offen offset:2048 sc1
    v_mfma_f32_16x16x32_bf16 v[112:115], v[76:79], a[204:207], v[112:115]
    v_mul_f32 v13, v13, v6
    v_mul_f32 v14, v14, v7
    v_mfma_f32_16x16x32_bf16 v[112:115], v[80:83], a[208:211], v[112:115]
    s_mov_b32 s25, 0
    v_mfma_f32_16x16x32_bf16 v[144:147], v[84:87], a[212:215], v[112:115]
    s_mov_b32 s7, s28
    v_mfma_f32_16x16x32_bf16 v[116:119], v[76:79], v[240:243], v[116:119]
    buffer_load_dwordx4 v[72:75], v192, s[48:51], s23 offen offset:3072 sc1
    v_mfma_f32_16x16x32_bf16 v[116:119], v[80:83], v[244:247], v[116:119]
    s_add_u32 s23, s23, 36864
    v_mfma_f32_16x16x32_bf16 v[148:151], v[84:87], v[248:251], v[116:119]
    v_add_u32 v12, s7, v184
    s_add_u32 s25, s25, 1
L_ffn_gu_35:
    s_waitcnt vmcnt(12)
    v_mfma_f32_16x16x32_bf16 v[88:91], v[16:19], a[0:3], 0
    v_mfma_f32_16x16x32_bf16 v[88:91], v[20:23], a[4:7], v[88:91]
    buffer_load_dwordx4 v[76:79], v184, s[48:51], s23 offen offset:0 sc1
    v_mfma_f32_16x16x32_bf16 v[88:91], v[24:27], a[8:11], v[88:91]
    v_mul_f32 v152, v120, v120
    v_mul_f32 v153, v121, v121
    v_mfma_f32_16x16x32_bf16 v[92:95], v[16:19], a[72:75], 0
    v_mul_f32 v154, v122, v122
    v_mul_f32 v155, v123, v123
    v_mfma_f32_16x16x32_bf16 v[92:95], v[20:23], a[76:79], v[92:95]
    v_fma_f32 v152, v152, v8, v4
    v_fma_f32 v153, v153, v8, v4
    v_mfma_f32_16x16x32_bf16 v[92:95], v[24:27], a[80:83], v[92:95]
    buffer_load_dwordx4 v[80:83], v184, s[48:51], s23 offen offset:1024 sc1
    v_mfma_f32_16x16x32_bf16 v[96:99], v[16:19], a[144:147], 0
    v_fma_f32 v154, v154, v8, v4
    v_fma_f32 v155, v155, v8, v4
    v_mfma_f32_16x16x32_bf16 v[96:99], v[20:23], a[148:151], v[96:99]
    v_mul_f32 v152, v120, v152
    v_mul_f32 v153, v121, v153
    v_mfma_f32_16x16x32_bf16 v[96:99], v[24:27], a[152:155], v[96:99]
    v_mul_f32 v154, v122, v154
    v_mul_f32 v155, v123, v155
    v_mfma_f32_16x16x32_bf16 v[100:103], v[16:19], a[216:219], 0
    buffer_load_dwordx4 v[84:87], v184, s[48:51], s23 offen offset:2048 sc1
    v_mfma_f32_16x16x32_bf16 v[100:103], v[20:23], a[220:223], v[100:103]
    v_exp_f32 v152, v152
    v_mfma_f32_16x16x32_bf16 v[100:103], v[24:27], a[224:227], v[100:103]
    v_exp_f32 v153, v153
    s_waitcnt vmcnt(12)
    v_mfma_f32_16x16x32_bf16 v[104:107], v[28:31], a[0:3], 0
    v_exp_f32 v154, v154
    v_mfma_f32_16x16x32_bf16 v[104:107], v[32:35], a[4:7], v[104:107]
    buffer_load_dwordx4 v[16:19], v184, s[48:51], s23 offen offset:3072 sc1
    v_mfma_f32_16x16x32_bf16 v[104:107], v[36:39], a[8:11], v[104:107]
    v_exp_f32 v155, v155
    v_mfma_f32_16x16x32_bf16 v[108:111], v[28:31], a[72:75], 0
    v_mul_f32 v156, v120, v136
    v_mul_f32 v157, v121, v137
    v_mfma_f32_16x16x32_bf16 v[108:111], v[32:35], a[76:79], v[108:111]
    v_mul_f32 v158, v122, v138
    v_mul_f32 v159, v123, v139
    v_mfma_f32_16x16x32_bf16 v[108:111], v[36:39], a[80:83], v[108:111]
    buffer_load_dwordx4 v[20:23], v185, s[48:51], s23 offen offset:0 sc1
    v_mfma_f32_16x16x32_bf16 v[112:115], v[28:31], a[144:147], 0
    v_fma_f32 v152, v152, v193, v193
    v_fma_f32 v153, v153, v193, v193
    v_mfma_f32_16x16x32_bf16 v[112:115], v[32:35], a[148:151], v[112:115]
    v_fma_f32 v154, v154, v193, v193
    v_fma_f32 v155, v155, v193, v193
    v_mfma_f32_16x16x32_bf16 v[112:115], v[36:39], a[152:155], v[112:115]
    v_rcp_f32 v152, v152
    v_mfma_f32_16x16x32_bf16 v[116:119], v[28:31], a[216:219], 0
    buffer_load_dwordx4 v[24:27], v185, s[48:51], s23 offen offset:1024 sc1
    v_mfma_f32_16x16x32_bf16 v[116:119], v[32:35], a[220:223], v[116:119]
    v_rcp_f32 v153, v153
    v_mfma_f32_16x16x32_bf16 v[116:119], v[36:39], a[224:227], v[116:119]
    v_rcp_f32 v154, v154
    s_waitcnt vmcnt(12)
    v_mfma_f32_16x16x32_bf16 v[88:91], v[40:43], a[12:15], v[88:91]
    v_rcp_f32 v155, v155
    v_mfma_f32_16x16x32_bf16 v[88:91], v[44:47], a[16:19], v[88:91]
    buffer_load_dwordx4 v[28:31], v185, s[48:51], s23 offen offset:2048 sc1
    v_mfma_f32_16x16x32_bf16 v[88:91], v[48:51], a[20:23], v[88:91]
    v_mul_f32 v156, v156, v152
    v_mul_f32 v157, v157, v153
    v_mfma_f32_16x16x32_bf16 v[92:95], v[40:43], a[84:87], v[92:95]
    v_mul_f32 v158, v158, v154
    v_mul_f32 v159, v159, v155
    v_mfma_f32_16x16x32_bf16 v[92:95], v[44:47], a[88:91], v[92:95]
    v_cvt_pk_bf16_f32 v160, v156, v157
    v_cvt_pk_bf16_f32 v161, v158, v159
    v_mfma_f32_16x16x32_bf16 v[92:95], v[48:51], a[92:95], v[92:95]
    buffer_load_dwordx4 v[32:35], v185, s[48:51], s23 offen offset:3072 sc1
    v_mfma_f32_16x16x32_bf16 v[96:99], v[40:43], a[156:159], v[96:99]
    ds_write_b64 v12, v[160:161] offset:0
    v_mfma_f32_16x16x32_bf16 v[96:99], v[44:47], a[160:163], v[96:99]
    v_mul_f32 v162, v124, v124
    v_mul_f32 v163, v125, v125
    v_mfma_f32_16x16x32_bf16 v[96:99], v[48:51], a[164:167], v[96:99]
    v_mul_f32 v164, v126, v126
    v_mul_f32 v165, v127, v127
    v_mfma_f32_16x16x32_bf16 v[100:103], v[40:43], a[228:231], v[100:103]
    buffer_load_dwordx4 v[36:39], v186, s[48:51], s23 offen offset:0 sc1
    v_mfma_f32_16x16x32_bf16 v[100:103], v[44:47], a[232:235], v[100:103]
    v_fma_f32 v162, v162, v9, v5
    v_fma_f32 v163, v163, v9, v5
    v_mfma_f32_16x16x32_bf16 v[100:103], v[48:51], a[236:239], v[100:103]
    v_fma_f32 v164, v164, v9, v5
    v_fma_f32 v165, v165, v9, v5
    s_waitcnt vmcnt(12)
    v_mfma_f32_16x16x32_bf16 v[104:107], v[52:55], a[12:15], v[104:107]
    v_mul_f32 v162, v124, v162
    v_mul_f32 v163, v125, v163
    v_mfma_f32_16x16x32_bf16 v[104:107], v[56:59], a[16:19], v[104:107]
    buffer_load_dwordx4 v[40:43], v186, s[48:51], s23 offen offset:1024 sc1
    v_mfma_f32_16x16x32_bf16 v[104:107], v[60:63], a[20:23], v[104:107]
    v_mul_f32 v164, v126, v164
    v_mul_f32 v165, v127, v165
    v_mfma_f32_16x16x32_bf16 v[108:111], v[52:55], a[84:87], v[108:111]
    v_exp_f32 v162, v162
    v_mfma_f32_16x16x32_bf16 v[108:111], v[56:59], a[88:91], v[108:111]
    v_exp_f32 v163, v163
    v_mfma_f32_16x16x32_bf16 v[108:111], v[60:63], a[92:95], v[108:111]
    buffer_load_dwordx4 v[44:47], v186, s[48:51], s23 offen offset:2048 sc1
    v_mfma_f32_16x16x32_bf16 v[112:115], v[52:55], a[156:159], v[112:115]
    v_exp_f32 v164, v164
    v_mfma_f32_16x16x32_bf16 v[112:115], v[56:59], a[160:163], v[112:115]
    v_exp_f32 v165, v165
    v_mfma_f32_16x16x32_bf16 v[112:115], v[60:63], a[164:167], v[112:115]
    v_mul_f32 v166, v124, v140
    v_mul_f32 v167, v125, v141
    v_mfma_f32_16x16x32_bf16 v[116:119], v[52:55], a[228:231], v[116:119]
    buffer_load_dwordx4 v[48:51], v186, s[48:51], s23 offen offset:3072 sc1
    v_mfma_f32_16x16x32_bf16 v[116:119], v[56:59], a[232:235], v[116:119]
    v_mul_f32 v168, v126, v142
    v_mul_f32 v169, v127, v143
    v_mfma_f32_16x16x32_bf16 v[116:119], v[60:63], a[236:239], v[116:119]
    v_fma_f32 v162, v162, v194, v194
    v_fma_f32 v163, v163, v194, v194
    s_waitcnt vmcnt(12)
    v_mfma_f32_16x16x32_bf16 v[88:91], v[64:67], a[24:27], v[88:91]
    v_fma_f32 v164, v164, v194, v194
    v_fma_f32 v165, v165, v194, v194
    v_mfma_f32_16x16x32_bf16 v[88:91], v[68:71], a[28:31], v[88:91]
    buffer_load_dwordx4 v[52:55], v187, s[48:51], s23 offen offset:0 sc1
    v_mfma_f32_16x16x32_bf16 v[88:91], v[72:75], a[32:35], v[88:91]
    v_rcp_f32 v162, v162
    v_mfma_f32_16x16x32_bf16 v[92:95], v[64:67], a[96:99], v[92:95]
    v_rcp_f32 v163, v163
    v_mfma_f32_16x16x32_bf16 v[92:95], v[68:71], a[100:103], v[92:95]
    v_rcp_f32 v164, v164
    v_mfma_f32_16x16x32_bf16 v[92:95], v[72:75], a[104:107], v[92:95]
    buffer_load_dwordx4 v[56:59], v187, s[48:51], s23 offen offset:1024 sc1
    v_mfma_f32_16x16x32_bf16 v[96:99], v[64:67], a[168:171], v[96:99]
    v_rcp_f32 v165, v165
    v_mfma_f32_16x16x32_bf16 v[96:99], v[68:71], a[172:175], v[96:99]
    v_mul_f32 v166, v166, v162
    v_mul_f32 v167, v167, v163
    v_mfma_f32_16x16x32_bf16 v[96:99], v[72:75], a[176:179], v[96:99]
    v_mul_f32 v168, v168, v164
    v_mul_f32 v169, v169, v165
    v_mfma_f32_16x16x32_bf16 v[100:103], v[64:67], a[240:243], v[100:103]
    buffer_load_dwordx4 v[60:63], v187, s[48:51], s23 offen offset:2048 sc1
    v_mfma_f32_16x16x32_bf16 v[100:103], v[68:71], a[244:247], v[100:103]
    v_cvt_pk_bf16_f32 v170, v166, v167
    v_cvt_pk_bf16_f32 v171, v168, v169
    v_mfma_f32_16x16x32_bf16 v[100:103], v[72:75], a[248:251], v[100:103]
    ds_write_b64 v12, v[170:171] offset:18432
    s_waitcnt vmcnt(12)
    v_mfma_f32_16x16x32_bf16 v[104:107], v[76:79], a[24:27], v[104:107]
    v_mul_f32 v152, v128, v128
    v_mul_f32 v153, v129, v129
    v_mfma_f32_16x16x32_bf16 v[104:107], v[80:83], a[28:31], v[104:107]
    buffer_load_dwordx4 v[64:67], v187, s[48:51], s23 offen offset:3072 sc1
    v_mfma_f32_16x16x32_bf16 v[104:107], v[84:87], a[32:35], v[104:107]
    v_mul_f32 v154, v130, v130
    v_mul_f32 v155, v131, v131
    v_mfma_f32_16x16x32_bf16 v[108:111], v[76:79], a[96:99], v[108:111]
    v_fma_f32 v152, v152, v13, v6
    v_fma_f32 v153, v153, v13, v6
    v_mfma_f32_16x16x32_bf16 v[108:111], v[80:83], a[100:103], v[108:111]
    v_fma_f32 v154, v154, v13, v6
    v_fma_f32 v155, v155, v13, v6
    v_mfma_f32_16x16x32_bf16 v[108:111], v[84:87], a[104:107], v[108:111]
    buffer_load_dwordx4 v[68:71], v188, s[48:51], s23 offen offset:0 sc1
    v_mfma_f32_16x16x32_bf16 v[112:115], v[76:79], a[168:171], v[112:115]
    v_mul_f32 v152, v128, v152
    v_mul_f32 v153, v129, v153
    v_mfma_f32_16x16x32_bf16 v[112:115], v[80:83], a[172:175], v[112:115]
    v_mul_f32 v154, v130, v154
    v_mul_f32 v155, v131, v155
    v_mfma_f32_16x16x32_bf16 v[112:115], v[84:87], a[176:179], v[112:115]
    v_exp_f32 v152, v152
    v_mfma_f32_16x16x32_bf16 v[116:119], v[76:79], a[240:243], v[116:119]
    buffer_load_dwordx4 v[72:75], v188, s[48:51], s23 offen offset:1024 sc1
    v_mfma_f32_16x16x32_bf16 v[116:119], v[80:83], a[244:247], v[116:119]
    v_exp_f32 v153, v153
    v_mfma_f32_16x16x32_bf16 v[116:119], v[84:87], a[248:251], v[116:119]
    v_exp_f32 v154, v154
    s_waitcnt vmcnt(12)
    v_mfma_f32_16x16x32_bf16 v[88:91], v[16:19], a[36:39], v[88:91]
    v_exp_f32 v155, v155
    v_mfma_f32_16x16x32_bf16 v[88:91], v[20:23], a[40:43], v[88:91]
    buffer_load_dwordx4 v[76:79], v188, s[48:51], s23 offen offset:2048 sc1
    v_mfma_f32_16x16x32_bf16 v[88:91], v[24:27], a[44:47], v[88:91]
    v_mul_f32 v156, v128, v144
    v_mul_f32 v157, v129, v145
    v_mfma_f32_16x16x32_bf16 v[92:95], v[16:19], a[108:111], v[92:95]
    v_mul_f32 v158, v130, v146
    v_mul_f32 v159, v131, v147
    v_mfma_f32_16x16x32_bf16 v[92:95], v[20:23], a[112:115], v[92:95]
    v_fma_f32 v152, v152, v195, v195
    v_fma_f32 v153, v153, v195, v195
    v_mfma_f32_16x16x32_bf16 v[92:95], v[24:27], a[116:119], v[92:95]
    buffer_load_dwordx4 v[80:83], v188, s[48:51], s23 offen offset:3072 sc1
    v_mfma_f32_16x16x32_bf16 v[96:99], v[16:19], a[180:183], v[96:99]
    v_fma_f32 v154, v154, v195, v195
    v_fma_f32 v155, v155, v195, v195
    v_mfma_f32_16x16x32_bf16 v[96:99], v[20:23], a[184:187], v[96:99]
    v_rcp_f32 v152, v152
    v_mfma_f32_16x16x32_bf16 v[96:99], v[24:27], a[188:191], v[96:99]
    v_rcp_f32 v153, v153
    v_mfma_f32_16x16x32_bf16 v[100:103], v[16:19], a[252:255], v[100:103]
    buffer_load_dwordx4 v[84:87], v189, s[48:51], s23 offen offset:0 sc1
    v_mfma_f32_16x16x32_bf16 v[100:103], v[20:23], v[220:223], v[100:103]
    v_rcp_f32 v154, v154
    v_mfma_f32_16x16x32_bf16 v[100:103], v[24:27], v[224:227], v[100:103]
    v_rcp_f32 v155, v155
    s_waitcnt vmcnt(12)
    v_mfma_f32_16x16x32_bf16 v[104:107], v[28:31], a[36:39], v[104:107]
    v_mul_f32 v156, v156, v152
    v_mul_f32 v157, v157, v153
    v_mfma_f32_16x16x32_bf16 v[104:107], v[32:35], a[40:43], v[104:107]
    buffer_load_dwordx4 v[16:19], v189, s[48:51], s23 offen offset:1024 sc1
    v_mfma_f32_16x16x32_bf16 v[104:107], v[36:39], a[44:47], v[104:107]
    v_mul_f32 v158, v158, v154
    v_mul_f32 v159, v159, v155
    v_mfma_f32_16x16x32_bf16 v[108:111], v[28:31], a[108:111], v[108:111]
    v_cvt_pk_bf16_f32 v160, v156, v157
    v_cvt_pk_bf16_f32 v161, v158, v159
    v_mfma_f32_16x16x32_bf16 v[108:111], v[32:35], a[112:115], v[108:111]
    ds_write_b64 v12, v[160:161] offset:36864
    v_mfma_f32_16x16x32_bf16 v[108:111], v[36:39], a[116:119], v[108:111]
    buffer_load_dwordx4 v[20:23], v189, s[48:51], s23 offen offset:2048 sc1
    v_mfma_f32_16x16x32_bf16 v[112:115], v[28:31], a[180:183], v[112:115]
    v_mul_f32 v162, v132, v132
    v_mul_f32 v163, v133, v133
    v_mfma_f32_16x16x32_bf16 v[112:115], v[32:35], a[184:187], v[112:115]
    v_mul_f32 v164, v134, v134
    v_mul_f32 v165, v135, v135
    v_mfma_f32_16x16x32_bf16 v[112:115], v[36:39], a[188:191], v[112:115]
    v_fma_f32 v162, v162, v14, v7
    v_fma_f32 v163, v163, v14, v7
    v_mfma_f32_16x16x32_bf16 v[116:119], v[28:31], a[252:255], v[116:119]
    buffer_load_dwordx4 v[24:27], v189, s[48:51], s23 offen offset:3072 sc1
    v_mfma_f32_16x16x32_bf16 v[116:119], v[32:35], v[220:223], v[116:119]
    v_fma_f32 v164, v164, v14, v7
    v_fma_f32 v165, v165, v14, v7
    v_mfma_f32_16x16x32_bf16 v[116:119], v[36:39], v[224:227], v[116:119]
    v_mul_f32 v162, v132, v162
    v_mul_f32 v163, v133, v163
    s_waitcnt vmcnt(12)
    v_mfma_f32_16x16x32_bf16 v[88:91], v[40:43], a[48:51], v[88:91]
    v_mul_f32 v164, v134, v164
    v_mul_f32 v165, v135, v165
    v_mfma_f32_16x16x32_bf16 v[88:91], v[44:47], a[52:55], v[88:91]
    buffer_load_dwordx4 v[28:31], v190, s[48:51], s23 offen offset:0 sc1
    v_mfma_f32_16x16x32_bf16 v[88:91], v[48:51], a[56:59], v[88:91]
    v_exp_f32 v162, v162
    v_mfma_f32_16x16x32_bf16 v[92:95], v[40:43], a[120:123], v[92:95]
    v_exp_f32 v163, v163
    v_mfma_f32_16x16x32_bf16 v[92:95], v[44:47], a[124:127], v[92:95]
    v_exp_f32 v164, v164
    v_mfma_f32_16x16x32_bf16 v[92:95], v[48:51], a[128:131], v[92:95]
    buffer_load_dwordx4 v[32:35], v190, s[48:51], s23 offen offset:1024 sc1
    v_mfma_f32_16x16x32_bf16 v[96:99], v[40:43], a[192:195], v[96:99]
    v_exp_f32 v165, v165
    v_mfma_f32_16x16x32_bf16 v[96:99], v[44:47], a[196:199], v[96:99]
    v_mul_f32 v166, v132, v148
    v_mul_f32 v167, v133, v149
    v_mfma_f32_16x16x32_bf16 v[96:99], v[48:51], a[200:203], v[96:99]
    v_mul_f32 v168, v134, v150
    v_mul_f32 v169, v135, v151
    v_mfma_f32_16x16x32_bf16 v[100:103], v[40:43], v[228:231], v[100:103]
    buffer_load_dwordx4 v[36:39], v190, s[48:51], s23 offen offset:2048 sc1
    v_mfma_f32_16x16x32_bf16 v[100:103], v[44:47], v[232:235], v[100:103]
    v_fma_f32 v162, v162, v252, v252
    v_fma_f32 v163, v163, v252, v252
    v_mfma_f32_16x16x32_bf16 v[100:103], v[48:51], v[236:239], v[100:103]
    v_fma_f32 v164, v164, v252, v252
    v_fma_f32 v165, v165, v252, v252
    s_waitcnt vmcnt(12)
    v_mfma_f32_16x16x32_bf16 v[104:107], v[52:55], a[48:51], v[104:107]
    v_rcp_f32 v162, v162
    v_mfma_f32_16x16x32_bf16 v[104:107], v[56:59], a[52:55], v[104:107]
    buffer_load_dwordx4 v[40:43], v190, s[48:51], s23 offen offset:3072 sc1
    v_mfma_f32_16x16x32_bf16 v[104:107], v[60:63], a[56:59], v[104:107]
    v_rcp_f32 v163, v163
    v_mfma_f32_16x16x32_bf16 v[108:111], v[52:55], a[120:123], v[108:111]
    v_rcp_f32 v164, v164
    v_mfma_f32_16x16x32_bf16 v[108:111], v[56:59], a[124:127], v[108:111]
    v_rcp_f32 v165, v165
    v_mfma_f32_16x16x32_bf16 v[108:111], v[60:63], a[128:131], v[108:111]
    buffer_load_dwordx4 v[44:47], v191, s[48:51], s23 offen offset:0 sc1
    v_mfma_f32_16x16x32_bf16 v[112:115], v[52:55], a[192:195], v[112:115]
    v_mul_f32 v166, v166, v162
    v_mul_f32 v167, v167, v163
    v_mfma_f32_16x16x32_bf16 v[112:115], v[56:59], a[196:199], v[112:115]
    v_mul_f32 v168, v168, v164
    v_mul_f32 v169, v169, v165
    v_mfma_f32_16x16x32_bf16 v[112:115], v[60:63], a[200:203], v[112:115]
    v_cvt_pk_bf16_f32 v170, v166, v167
    v_cvt_pk_bf16_f32 v171, v168, v169
    v_mfma_f32_16x16x32_bf16 v[116:119], v[52:55], v[228:231], v[116:119]
    buffer_load_dwordx4 v[48:51], v191, s[48:51], s23 offen offset:1024 sc1
    v_mfma_f32_16x16x32_bf16 v[116:119], v[56:59], v[232:235], v[116:119]
    ds_write_b64 v12, v[170:171] offset:55296
    v_mfma_f32_16x16x32_bf16 v[116:119], v[60:63], v[236:239], v[116:119]
    s_waitcnt vmcnt(12)
    v_mfma_f32_16x16x32_bf16 v[88:91], v[64:67], a[60:63], v[88:91]
    v_mfma_f32_16x16x32_bf16 v[88:91], v[68:71], a[64:67], v[88:91]
    buffer_load_dwordx4 v[52:55], v191, s[48:51], s23 offen offset:2048 sc1
    v_mfma_f32_16x16x32_bf16 v[120:123], v[72:75], a[68:71], v[88:91]
    v_mfma_f32_16x16x32_bf16 v[92:95], v[64:67], a[132:135], v[92:95]
    v_mfma_f32_16x16x32_bf16 v[92:95], v[68:71], a[136:139], v[92:95]
    v_mfma_f32_16x16x32_bf16 v[124:127], v[72:75], a[140:143], v[92:95]
    buffer_load_dwordx4 v[56:59], v191, s[48:51], s23 offen offset:3072 sc1
    v_mfma_f32_16x16x32_bf16 v[96:99], v[64:67], a[204:207], v[96:99]
    v_mfma_f32_16x16x32_bf16 v[96:99], v[68:71], a[208:211], v[96:99]
    v_mfma_f32_16x16x32_bf16 v[128:131], v[72:75], a[212:215], v[96:99]
    v_mfma_f32_16x16x32_bf16 v[100:103], v[64:67], v[240:243], v[100:103]
    buffer_load_dwordx4 v[60:63], v192, s[48:51], s23 offen offset:0 sc1
    v_mfma_f32_16x16x32_bf16 v[100:103], v[68:71], v[244:247], v[100:103]
    v_mfma_f32_16x16x32_bf16 v[132:135], v[72:75], v[248:251], v[100:103]
    s_waitcnt vmcnt(12)
    v_mfma_f32_16x16x32_bf16 v[104:107], v[76:79], a[60:63], v[104:107]
    v_mfma_f32_16x16x32_bf16 v[104:107], v[80:83], a[64:67], v[104:107]
    buffer_load_dwordx4 v[64:67], v192, s[48:51], s23 offen offset:1024 sc1
    v_mfma_f32_16x16x32_bf16 v[136:139], v[84:87], a[68:71], v[104:107]
    v_mfma_f32_16x16x32_bf16 v[108:111], v[76:79], a[132:135], v[108:111]
    v_mfma_f32_16x16x32_bf16 v[108:111], v[80:83], a[136:139], v[108:111]
    v_mfma_f32_16x16x32_bf16 v[140:143], v[84:87], a[140:143], v[108:111]
    buffer_load_dwordx4 v[68:71], v192, s[48:51], s23 offen offset:2048 sc1
    v_mfma_f32_16x16x32_bf16 v[112:115], v[76:79], a[204:207], v[112:115]
    v_mfma_f32_16x16x32_bf16 v[112:115], v[80:83], a[208:211], v[112:115]
    s_lshl_b32 s7, s25, 11
    v_mfma_f32_16x16x32_bf16 v[144:147], v[84:87], a[212:215], v[112:115]
    s_add_u32 s7, s7, s28
    v_mfma_f32_16x16x32_bf16 v[116:119], v[76:79], v[240:243], v[116:119]
    buffer_load_dwordx4 v[72:75], v192, s[48:51], s23 offen offset:3072 sc1
    v_mfma_f32_16x16x32_bf16 v[116:119], v[80:83], v[244:247], v[116:119]
    s_add_u32 s23, s23, 36864
    v_mfma_f32_16x16x32_bf16 v[148:151], v[84:87], v[248:251], v[116:119]
    v_add_u32 v12, s7, v184
    s_add_u32 s25, s25, 1
    s_cmp_lt_u32 s25, 8
    s_cbranch_scc1 L_ffn_gu_35
    v_add_u32 v10, 73728, v184
    v_add_u32 v11, 110592, v184
    s_waitcnt lgkmcnt(0)
    s_barrier
    s_waitcnt vmcnt(12)
    v_mfma_f32_16x16x32_bf16 v[88:91], v[16:19], a[0:3], 0
    v_mfma_f32_16x16x32_bf16 v[88:91], v[20:23], a[4:7], v[88:91]
    buffer_load_dwordx4 v[76:79], v184, s[48:51], s23 offen offset:0 sc1
    v_mfma_f32_16x16x32_bf16 v[88:91], v[24:27], a[8:11], v[88:91]
    v_mul_f32 v152, v120, v120
    v_mul_f32 v153, v121, v121
    v_mfma_f32_16x16x32_bf16 v[92:95], v[16:19], a[72:75], 0
    v_mul_f32 v154, v122, v122
    v_mul_f32 v155, v123, v123
    v_mfma_f32_16x16x32_bf16 v[92:95], v[20:23], a[76:79], v[92:95]
    v_fma_f32 v152, v152, v8, v4
    v_fma_f32 v153, v153, v8, v4
    v_mfma_f32_16x16x32_bf16 v[92:95], v[24:27], a[80:83], v[92:95]
    buffer_load_dwordx4 v[80:83], v184, s[48:51], s23 offen offset:1024 sc1
    v_mfma_f32_16x16x32_bf16 v[96:99], v[16:19], a[144:147], 0
    v_fma_f32 v154, v154, v8, v4
    v_fma_f32 v155, v155, v8, v4
    v_mfma_f32_16x16x32_bf16 v[96:99], v[20:23], a[148:151], v[96:99]
    v_mul_f32 v152, v120, v152
    v_mul_f32 v153, v121, v153
    v_mfma_f32_16x16x32_bf16 v[96:99], v[24:27], a[152:155], v[96:99]
    v_mul_f32 v154, v122, v154
    v_mul_f32 v155, v123, v155
    v_mfma_f32_16x16x32_bf16 v[100:103], v[16:19], a[216:219], 0
    buffer_load_dwordx4 v[84:87], v184, s[48:51], s23 offen offset:2048 sc1
    v_mfma_f32_16x16x32_bf16 v[100:103], v[20:23], a[220:223], v[100:103]
    v_exp_f32 v152, v152
    v_mfma_f32_16x16x32_bf16 v[100:103], v[24:27], a[224:227], v[100:103]
    v_exp_f32 v153, v153
    s_waitcnt vmcnt(12)
    v_mfma_f32_16x16x32_bf16 v[104:107], v[28:31], a[0:3], 0
    v_exp_f32 v154, v154
    ds_read_b128 a[0:3], v10 offset:0
    v_mfma_f32_16x16x32_bf16 v[104:107], v[32:35], a[4:7], v[104:107]
    buffer_load_dwordx4 v[16:19], v184, s[48:51], s23 offen offset:3072 sc1
    v_mfma_f32_16x16x32_bf16 v[104:107], v[36:39], a[8:11], v[104:107]
    v_exp_f32 v155, v155
    v_mfma_f32_16x16x32_bf16 v[108:111], v[28:31], a[72:75], 0
    v_mul_f32 v156, v120, v136
    v_mul_f32 v157, v121, v137
    ds_read_b128 a[72:75], v10 offset:18432
    v_mfma_f32_16x16x32_bf16 v[108:111], v[32:35], a[76:79], v[108:111]
    v_mul_f32 v158, v122, v138
    v_mul_f32 v159, v123, v139
    v_mfma_f32_16x16x32_bf16 v[108:111], v[36:39], a[80:83], v[108:111]
    buffer_load_dwordx4 v[20:23], v185, s[48:51], s23 offen offset:0 sc1
    v_mfma_f32_16x16x32_bf16 v[112:115], v[28:31], a[144:147], 0
    v_fma_f32 v152, v152, v193, v193
    v_fma_f32 v153, v153, v193, v193
    ds_read_b128 a[144:147], v11 offset:0
    v_mfma_f32_16x16x32_bf16 v[112:115], v[32:35], a[148:151], v[112:115]
    v_fma_f32 v154, v154, v193, v193
    v_fma_f32 v155, v155, v193, v193
    v_mfma_f32_16x16x32_bf16 v[112:115], v[36:39], a[152:155], v[112:115]
    v_rcp_f32 v152, v152
    v_mfma_f32_16x16x32_bf16 v[116:119], v[28:31], a[216:219], 0
    buffer_load_dwordx4 v[24:27], v185, s[48:51], s23 offen offset:1024 sc1
    v_mfma_f32_16x16x32_bf16 v[116:119], v[32:35], a[220:223], v[116:119]
    v_rcp_f32 v153, v153
    ds_read_b128 a[216:219], v11 offset:18432
    v_mfma_f32_16x16x32_bf16 v[116:119], v[36:39], a[224:227], v[116:119]
    v_rcp_f32 v154, v154
    ds_read_b128 a[4:7], v10 offset:1024
    s_waitcnt vmcnt(12)
    v_mfma_f32_16x16x32_bf16 v[88:91], v[40:43], a[12:15], v[88:91]
    v_rcp_f32 v155, v155
    ds_read_b128 a[76:79], v10 offset:19456
    v_mfma_f32_16x16x32_bf16 v[88:91], v[44:47], a[16:19], v[88:91]
    buffer_load_dwordx4 v[28:31], v185, s[48:51], s23 offen offset:2048 sc1
    v_mfma_f32_16x16x32_bf16 v[88:91], v[48:51], a[20:23], v[88:91]
    v_mul_f32 v156, v156, v152
    v_mul_f32 v157, v157, v153
    ds_read_b128 a[148:151], v11 offset:1024
    v_mfma_f32_16x16x32_bf16 v[92:95], v[40:43], a[84:87], v[92:95]
    v_mul_f32 v158, v158, v154
    v_mul_f32 v159, v159, v155
    ds_read_b128 a[220:223], v11 offset:19456
    v_mfma_f32_16x16x32_bf16 v[92:95], v[44:47], a[88:91], v[92:95]
    v_cvt_pk_bf16_f32 v160, v156, v157
    v_cvt_pk_bf16_f32 v161, v158, v159
    ds_read_b128 a[8:11], v10 offset:2048
    v_mfma_f32_16x16x32_bf16 v[92:95], v[48:51], a[92:95], v[92:95]
    buffer_load_dwordx4 v[32:35], v185, s[48:51], s23 offen offset:3072 sc1
    v_mfma_f32_16x16x32_bf16 v[96:99], v[40:43], a[156:159], v[96:99]
    ds_write_b64 v12, v[160:161] offset:0
    v_mfma_f32_16x16x32_bf16 v[96:99], v[44:47], a[160:163], v[96:99]
    v_mul_f32 v162, v124, v124
    v_mul_f32 v163, v125, v125
    ds_read_b128 a[80:83], v10 offset:20480
    v_mfma_f32_16x16x32_bf16 v[96:99], v[48:51], a[164:167], v[96:99]
    v_mul_f32 v164, v126, v126
    v_mul_f32 v165, v127, v127
    ds_read_b128 a[152:155], v11 offset:2048
    v_mfma_f32_16x16x32_bf16 v[100:103], v[40:43], a[228:231], v[100:103]
    buffer_load_dwordx4 v[36:39], v186, s[48:51], s23 offen offset:0 sc1
    v_mfma_f32_16x16x32_bf16 v[100:103], v[44:47], a[232:235], v[100:103]
    v_fma_f32 v162, v162, v9, v5
    v_fma_f32 v163, v163, v9, v5
    ds_read_b128 a[224:227], v11 offset:20480
    v_mfma_f32_16x16x32_bf16 v[100:103], v[48:51], a[236:239], v[100:103]
    v_fma_f32 v164, v164, v9, v5
    v_fma_f32 v165, v165, v9, v5
    s_waitcnt vmcnt(12)
    v_mfma_f32_16x16x32_bf16 v[104:107], v[52:55], a[12:15], v[104:107]
    v_mul_f32 v162, v124, v162
    v_mul_f32 v163, v125, v163
    ds_read_b128 a[12:15], v10 offset:3072
    v_mfma_f32_16x16x32_bf16 v[104:107], v[56:59], a[16:19], v[104:107]
    buffer_load_dwordx4 v[40:43], v186, s[48:51], s23 offen offset:1024 sc1
    v_mfma_f32_16x16x32_bf16 v[104:107], v[60:63], a[20:23], v[104:107]
    v_mul_f32 v164, v126, v164
    v_mul_f32 v165, v127, v165
    v_mfma_f32_16x16x32_bf16 v[108:111], v[52:55], a[84:87], v[108:111]
    v_exp_f32 v162, v162
    ds_read_b128 a[84:87], v10 offset:21504
    v_mfma_f32_16x16x32_bf16 v[108:111], v[56:59], a[88:91], v[108:111]
    v_exp_f32 v163, v163
    v_mfma_f32_16x16x32_bf16 v[108:111], v[60:63], a[92:95], v[108:111]
    buffer_load_dwordx4 v[44:47], v186, s[48:51], s23 offen offset:2048 sc1
    v_mfma_f32_16x16x32_bf16 v[112:115], v[52:55], a[156:159], v[112:115]
    v_exp_f32 v164, v164
    ds_read_b128 a[156:159], v11 offset:3072
    v_mfma_f32_16x16x32_bf16 v[112:115], v[56:59], a[160:163], v[112:115]
    v_exp_f32 v165, v165
    v_mfma_f32_16x16x32_bf16 v[112:115], v[60:63], a[164:167], v[112:115]
    v_mul_f32 v166, v124, v140
    v_mul_f32 v167, v125, v141
    v_mfma_f32_16x16x32_bf16 v[116:119], v[52:55], a[228:231], v[116:119]
    buffer_load_dwordx4 v[48:51], v186, s[48:51], s23 offen offset:3072 sc1
    v_mfma_f32_16x16x32_bf16 v[116:119], v[56:59], a[232:235], v[116:119]
    v_mul_f32 v168, v126, v142
    v_mul_f32 v169, v127, v143
    ds_read_b128 a[228:231], v11 offset:21504
    v_mfma_f32_16x16x32_bf16 v[116:119], v[60:63], a[236:239], v[116:119]
    v_fma_f32 v162, v162, v194, v194
    v_fma_f32 v163, v163, v194, v194
    ds_read_b128 a[16:19], v10 offset:4096
    s_waitcnt vmcnt(12)
    v_mfma_f32_16x16x32_bf16 v[88:91], v[64:67], a[24:27], v[88:91]
    v_fma_f32 v164, v164, v194, v194
    v_fma_f32 v165, v165, v194, v194
    ds_read_b128 a[88:91], v10 offset:22528
    v_mfma_f32_16x16x32_bf16 v[88:91], v[68:71], a[28:31], v[88:91]
    buffer_load_dwordx4 v[52:55], v187, s[48:51], s23 offen offset:0 sc1
    v_mfma_f32_16x16x32_bf16 v[88:91], v[72:75], a[32:35], v[88:91]
    v_rcp_f32 v162, v162
    ds_read_b128 a[160:163], v11 offset:4096
    v_mfma_f32_16x16x32_bf16 v[92:95], v[64:67], a[96:99], v[92:95]
    v_rcp_f32 v163, v163
    ds_read_b128 a[232:235], v11 offset:22528
    v_mfma_f32_16x16x32_bf16 v[92:95], v[68:71], a[100:103], v[92:95]
    v_rcp_f32 v164, v164
    ds_read_b128 a[20:23], v10 offset:5120
    v_mfma_f32_16x16x32_bf16 v[92:95], v[72:75], a[104:107], v[92:95]
    buffer_load_dwordx4 v[56:59], v187, s[48:51], s23 offen offset:1024 sc1
    v_mfma_f32_16x16x32_bf16 v[96:99], v[64:67], a[168:171], v[96:99]
    v_rcp_f32 v165, v165
    ds_read_b128 a[92:95], v10 offset:23552
    v_mfma_f32_16x16x32_bf16 v[96:99], v[68:71], a[172:175], v[96:99]
    v_mul_f32 v166, v166, v162
    v_mul_f32 v167, v167, v163
    ds_read_b128 a[164:167], v11 offset:5120
    v_mfma_f32_16x16x32_bf16 v[96:99], v[72:75], a[176:179], v[96:99]
    v_mul_f32 v168, v168, v164
    v_mul_f32 v169, v169, v165
    ds_read_b128 a[236:239], v11 offset:23552
    v_mfma_f32_16x16x32_bf16 v[100:103], v[64:67], a[240:243], v[100:103]
    buffer_load_dwordx4 v[60:63], v187, s[48:51], s23 offen offset:2048 sc1
    v_mfma_f32_16x16x32_bf16 v[100:103], v[68:71], a[244:247], v[100:103]
    v_cvt_pk_bf16_f32 v170, v166, v167
    v_cvt_pk_bf16_f32 v171, v168, v169
    v_mfma_f32_16x16x32_bf16 v[100:103], v[72:75], a[248:251], v[100:103]
    ds_write_b64 v12, v[170:171] offset:18432
    s_waitcnt vmcnt(12)
    v_mfma_f32_16x16x32_bf16 v[104:107], v[76:79], a[24:27], v[104:107]
    v_mul_f32 v152, v128, v128
    v_mul_f32 v153, v129, v129
    ds_read_b128 a[24:27], v10 offset:6144
    v_mfma_f32_16x16x32_bf16 v[104:107], v[80:83], a[28:31], v[104:107]
    buffer_load_dwordx4 v[64:67], v187, s[48:51], s23 offen offset:3072 sc1
    v_mfma_f32_16x16x32_bf16 v[104:107], v[84:87], a[32:35], v[104:107]
    v_mul_f32 v154, v130, v130
    v_mul_f32 v155, v131, v131
    v_mfma_f32_16x16x32_bf16 v[108:111], v[76:79], a[96:99], v[108:111]
    v_fma_f32 v152, v152, v13, v6
    v_fma_f32 v153, v153, v13, v6
    ds_read_b128 a[96:99], v10 offset:24576
    v_mfma_f32_16x16x32_bf16 v[108:111], v[80:83], a[100:103], v[108:111]
    v_fma_f32 v154, v154, v13, v6
    v_fma_f32 v155, v155, v13, v6
    v_mfma_f32_16x16x32_bf16 v[108:111], v[84:87], a[104:107], v[108:111]
    buffer_load_dwordx4 v[68:71], v188, s[48:51], s23 offen offset:0 sc1
    v_mfma_f32_16x16x32_bf16 v[112:115], v[76:79], a[168:171], v[112:115]
    v_mul_f32 v152, v128, v152
    v_mul_f32 v153, v129, v153
    ds_read_b128 a[168:171], v11 offset:6144
    v_mfma_f32_16x16x32_bf16 v[112:115], v[80:83], a[172:175], v[112:115]
    v_mul_f32 v154, v130, v154
    v_mul_f32 v155, v131, v155
    v_mfma_f32_16x16x32_bf16 v[112:115], v[84:87], a[176:179], v[112:115]
    v_exp_f32 v152, v152
    v_mfma_f32_16x16x32_bf16 v[116:119], v[76:79], a[240:243], v[116:119]
    buffer_load_dwordx4 v[72:75], v188, s[48:51], s23 offen offset:1024 sc1
    v_mfma_f32_16x16x32_bf16 v[116:119], v[80:83], a[244:247], v[116:119]
    v_exp_f32 v153, v153
    ds_read_b128 a[240:243], v11 offset:24576
    v_mfma_f32_16x16x32_bf16 v[116:119], v[84:87], a[248:251], v[116:119]
    v_exp_f32 v154, v154
    ds_read_b128 a[28:31], v10 offset:7168
    s_waitcnt vmcnt(12)
    v_mfma_f32_16x16x32_bf16 v[88:91], v[16:19], a[36:39], v[88:91]
    v_exp_f32 v155, v155
    ds_read_b128 a[100:103], v10 offset:25600
    v_mfma_f32_16x16x32_bf16 v[88:91], v[20:23], a[40:43], v[88:91]
    buffer_load_dwordx4 v[76:79], v188, s[48:51], s23 offen offset:2048 sc1
    v_mfma_f32_16x16x32_bf16 v[88:91], v[24:27], a[44:47], v[88:91]
    v_mul_f32 v156, v128, v144
    v_mul_f32 v157, v129, v145
    ds_read_b128 a[172:175], v11 offset:7168
    v_mfma_f32_16x16x32_bf16 v[92:95], v[16:19], a[108:111], v[92:95]
    v_mul_f32 v158, v130, v146
    v_mul_f32 v159, v131, v147
    ds_read_b128 a[244:247], v11 offset:25600
    v_mfma_f32_16x16x32_bf16 v[92:95], v[20:23], a[112:115], v[92:95]
    v_fma_f32 v152, v152, v195, v195
    v_fma_f32 v153, v153, v195, v195
    ds_read_b128 a[32:35], v10 offset:8192
    v_mfma_f32_16x16x32_bf16 v[92:95], v[24:27], a[116:119], v[92:95]
    buffer_load_dwordx4 v[80:83], v188, s[48:51], s23 offen offset:3072 sc1
    v_mfma_f32_16x16x32_bf16 v[96:99], v[16:19], a[180:183], v[96:99]
    v_fma_f32 v154, v154, v195, v195
    v_fma_f32 v155, v155, v195, v195
    ds_read_b128 a[104:107], v10 offset:26624
    v_mfma_f32_16x16x32_bf16 v[96:99], v[20:23], a[184:187], v[96:99]
    v_rcp_f32 v152, v152
    ds_read_b128 a[176:179], v11 offset:8192
    v_mfma_f32_16x16x32_bf16 v[96:99], v[24:27], a[188:191], v[96:99]
    v_rcp_f32 v153, v153
    ds_read_b128 a[248:251], v11 offset:26624
    v_mfma_f32_16x16x32_bf16 v[100:103], v[16:19], a[252:255], v[100:103]
    buffer_load_dwordx4 v[84:87], v189, s[48:51], s23 offen offset:0 sc1
    v_mfma_f32_16x16x32_bf16 v[100:103], v[20:23], v[220:223], v[100:103]
    v_rcp_f32 v154, v154
    v_mfma_f32_16x16x32_bf16 v[100:103], v[24:27], v[224:227], v[100:103]
    v_rcp_f32 v155, v155
    s_waitcnt vmcnt(12)
    v_mfma_f32_16x16x32_bf16 v[104:107], v[28:31], a[36:39], v[104:107]
    v_mul_f32 v156, v156, v152
    v_mul_f32 v157, v157, v153
    ds_read_b128 a[36:39], v10 offset:9216
    v_mfma_f32_16x16x32_bf16 v[104:107], v[32:35], a[40:43], v[104:107]
    buffer_load_dwordx4 v[16:19], v189, s[48:51], s23 offen offset:1024 sc1
    v_mfma_f32_16x16x32_bf16 v[104:107], v[36:39], a[44:47], v[104:107]
    v_mul_f32 v158, v158, v154
    v_mul_f32 v159, v159, v155
    v_mfma_f32_16x16x32_bf16 v[108:111], v[28:31], a[108:111], v[108:111]
    v_cvt_pk_bf16_f32 v160, v156, v157
    v_cvt_pk_bf16_f32 v161, v158, v159
    ds_read_b128 a[108:111], v10 offset:27648
    v_mfma_f32_16x16x32_bf16 v[108:111], v[32:35], a[112:115], v[108:111]
    ds_write_b64 v12, v[160:161] offset:36864
    v_mfma_f32_16x16x32_bf16 v[108:111], v[36:39], a[116:119], v[108:111]
    buffer_load_dwordx4 v[20:23], v189, s[48:51], s23 offen offset:2048 sc1
    v_mfma_f32_16x16x32_bf16 v[112:115], v[28:31], a[180:183], v[112:115]
    v_mul_f32 v162, v132, v132
    v_mul_f32 v163, v133, v133
    ds_read_b128 a[180:183], v11 offset:9216
    v_mfma_f32_16x16x32_bf16 v[112:115], v[32:35], a[184:187], v[112:115]
    v_mul_f32 v164, v134, v134
    v_mul_f32 v165, v135, v135
    v_mfma_f32_16x16x32_bf16 v[112:115], v[36:39], a[188:191], v[112:115]
    v_fma_f32 v162, v162, v14, v7
    v_fma_f32 v163, v163, v14, v7
    v_mfma_f32_16x16x32_bf16 v[116:119], v[28:31], a[252:255], v[116:119]
    buffer_load_dwordx4 v[24:27], v189, s[48:51], s23 offen offset:3072 sc1
    v_mfma_f32_16x16x32_bf16 v[116:119], v[32:35], v[220:223], v[116:119]
    v_fma_f32 v164, v164, v14, v7
    v_fma_f32 v165, v165, v14, v7
    ds_read_b128 a[252:255], v11 offset:27648
    v_mfma_f32_16x16x32_bf16 v[116:119], v[36:39], v[224:227], v[116:119]
    v_mul_f32 v162, v132, v162
    v_mul_f32 v163, v133, v163
    ds_read_b128 a[40:43], v10 offset:10240
    s_waitcnt vmcnt(12)
    v_mfma_f32_16x16x32_bf16 v[88:91], v[40:43], a[48:51], v[88:91]
    v_mul_f32 v164, v134, v164
    v_mul_f32 v165, v135, v165
    ds_read_b128 a[112:115], v10 offset:28672
    v_mfma_f32_16x16x32_bf16 v[88:91], v[44:47], a[52:55], v[88:91]
    buffer_load_dwordx4 v[28:31], v190, s[48:51], s23 offen offset:0 sc1
    v_mfma_f32_16x16x32_bf16 v[88:91], v[48:51], a[56:59], v[88:91]
    v_exp_f32 v162, v162
    ds_read_b128 a[184:187], v11 offset:10240
    v_mfma_f32_16x16x32_bf16 v[92:95], v[40:43], a[120:123], v[92:95]
    v_exp_f32 v163, v163
    ds_read_b128 v[220:223], v11 offset:28672
    v_mfma_f32_16x16x32_bf16 v[92:95], v[44:47], a[124:127], v[92:95]
    v_exp_f32 v164, v164
    ds_read_b128 a[44:47], v10 offset:11264
    v_mfma_f32_16x16x32_bf16 v[92:95], v[48:51], a[128:131], v[92:95]
    buffer_load_dwordx4 v[32:35], v190, s[48:51], s23 offen offset:1024 sc1
    v_mfma_f32_16x16x32_bf16 v[96:99], v[40:43], a[192:195], v[96:99]
    v_exp_f32 v165, v165
    ds_read_b128 a[116:119], v10 offset:29696
    v_mfma_f32_16x16x32_bf16 v[96:99], v[44:47], a[196:199], v[96:99]
    v_mul_f32 v166, v132, v148
    v_mul_f32 v167, v133, v149
    ds_read_b128 a[188:191], v11 offset:11264
    v_mfma_f32_16x16x32_bf16 v[96:99], v[48:51], a[200:203], v[96:99]
    v_mul_f32 v168, v134, v150
    v_mul_f32 v169, v135, v151
    ds_read_b128 v[224:227], v11 offset:29696
    v_mfma_f32_16x16x32_bf16 v[100:103], v[40:43], v[228:231], v[100:103]
    buffer_load_dwordx4 v[36:39], v190, s[48:51], s23 offen offset:2048 sc1
    v_mfma_f32_16x16x32_bf16 v[100:103], v[44:47], v[232:235], v[100:103]
    v_fma_f32 v162, v162, v252, v252
    v_fma_f32 v163, v163, v252, v252
    v_mfma_f32_16x16x32_bf16 v[100:103], v[48:51], v[236:239], v[100:103]
    v_fma_f32 v164, v164, v252, v252
    v_fma_f32 v165, v165, v252, v252
    s_waitcnt vmcnt(12)
    v_mfma_f32_16x16x32_bf16 v[104:107], v[52:55], a[48:51], v[104:107]
    v_rcp_f32 v162, v162
    ds_read_b128 a[48:51], v10 offset:12288
    v_mfma_f32_16x16x32_bf16 v[104:107], v[56:59], a[52:55], v[104:107]
    buffer_load_dwordx4 v[40:43], v190, s[48:51], s23 offen offset:3072 sc1
    v_mfma_f32_16x16x32_bf16 v[104:107], v[60:63], a[56:59], v[104:107]
    v_rcp_f32 v163, v163
    v_mfma_f32_16x16x32_bf16 v[108:111], v[52:55], a[120:123], v[108:111]
    v_rcp_f32 v164, v164
    ds_read_b128 a[120:123], v10 offset:30720
    v_mfma_f32_16x16x32_bf16 v[108:111], v[56:59], a[124:127], v[108:111]
    v_rcp_f32 v165, v165
    v_mfma_f32_16x16x32_bf16 v[108:111], v[60:63], a[128:131], v[108:111]
    buffer_load_dwordx4 v[44:47], v191, s[48:51], s23 offen offset:0 sc1
    v_mfma_f32_16x16x32_bf16 v[112:115], v[52:55], a[192:195], v[112:115]
    v_mul_f32 v166, v166, v162
    v_mul_f32 v167, v167, v163
    ds_read_b128 a[192:195], v11 offset:12288
    v_mfma_f32_16x16x32_bf16 v[112:115], v[56:59], a[196:199], v[112:115]
    v_mul_f32 v168, v168, v164
    v_mul_f32 v169, v169, v165
    v_mfma_f32_16x16x32_bf16 v[112:115], v[60:63], a[200:203], v[112:115]
    v_cvt_pk_bf16_f32 v170, v166, v167
    v_cvt_pk_bf16_f32 v171, v168, v169
    v_mfma_f32_16x16x32_bf16 v[116:119], v[52:55], v[228:231], v[116:119]
    buffer_load_dwordx4 v[48:51], v191, s[48:51], s23 offen offset:1024 sc1
    v_mfma_f32_16x16x32_bf16 v[116:119], v[56:59], v[232:235], v[116:119]
    ds_write_b64 v12, v[170:171] offset:55296
    v_mfma_f32_16x16x32_bf16 v[116:119], v[60:63], v[236:239], v[116:119]
    ds_read_b128 v[228:231], v11 offset:30720
    s_waitcnt vmcnt(12)
    v_mfma_f32_16x16x32_bf16 v[88:91], v[64:67], a[60:63], v[88:91]
    ds_read_b128 a[52:55], v10 offset:13312
    v_mfma_f32_16x16x32_bf16 v[88:91], v[68:71], a[64:67], v[88:91]
    buffer_load_dwordx4 v[52:55], v191, s[48:51], s23 offen offset:2048 sc1
    v_mfma_f32_16x16x32_bf16 v[120:123], v[72:75], a[68:71], v[88:91]
    ds_read_b128 a[124:127], v10 offset:31744
    v_mfma_f32_16x16x32_bf16 v[92:95], v[64:67], a[132:135], v[92:95]
    ds_read_b128 a[196:199], v11 offset:13312
    v_mfma_f32_16x16x32_bf16 v[92:95], v[68:71], a[136:139], v[92:95]
    ds_read_b128 v[232:235], v11 offset:31744
    v_mfma_f32_16x16x32_bf16 v[124:127], v[72:75], a[140:143], v[92:95]
    buffer_load_dwordx4 v[56:59], v191, s[48:51], s23 offen offset:3072 sc1
    v_mfma_f32_16x16x32_bf16 v[96:99], v[64:67], a[204:207], v[96:99]
    v_mfma_f32_16x16x32_bf16 v[96:99], v[68:71], a[208:211], v[96:99]
    v_mfma_f32_16x16x32_bf16 v[128:131], v[72:75], a[212:215], v[96:99]
    v_mfma_f32_16x16x32_bf16 v[100:103], v[64:67], v[240:243], v[100:103]
    buffer_load_dwordx4 v[60:63], v192, s[48:51], s23 offen offset:0 sc1
    v_mfma_f32_16x16x32_bf16 v[100:103], v[68:71], v[244:247], v[100:103]
    v_mfma_f32_16x16x32_bf16 v[132:135], v[72:75], v[248:251], v[100:103]
    s_waitcnt vmcnt(12)
    v_mfma_f32_16x16x32_bf16 v[104:107], v[76:79], a[60:63], v[104:107]
    v_mfma_f32_16x16x32_bf16 v[104:107], v[80:83], a[64:67], v[104:107]
    buffer_load_dwordx4 v[64:67], v192, s[48:51], s23 offen offset:1024 sc1
    v_mfma_f32_16x16x32_bf16 v[136:139], v[84:87], a[68:71], v[104:107]
    v_mfma_f32_16x16x32_bf16 v[108:111], v[76:79], a[132:135], v[108:111]
    v_mfma_f32_16x16x32_bf16 v[108:111], v[80:83], a[136:139], v[108:111]
    v_mfma_f32_16x16x32_bf16 v[140:143], v[84:87], a[140:143], v[108:111]
    buffer_load_dwordx4 v[68:71], v192, s[48:51], s23 offen offset:2048 sc1
    v_mfma_f32_16x16x32_bf16 v[112:115], v[76:79], a[204:207], v[112:115]
    v_mfma_f32_16x16x32_bf16 v[112:115], v[80:83], a[208:211], v[112:115]
    s_lshl_b32 s7, s25, 11
    v_mfma_f32_16x16x32_bf16 v[144:147], v[84:87], a[212:215], v[112:115]
    s_add_u32 s7, s7, s28
    v_mfma_f32_16x16x32_bf16 v[116:119], v[76:79], v[240:243], v[116:119]
    buffer_load_dwordx4 v[72:75], v192, s[48:51], s23 offen offset:3072 sc1
    v_mfma_f32_16x16x32_bf16 v[116:119], v[80:83], v[244:247], v[116:119]
    s_add_u32 s23, s23, 36864
    v_mfma_f32_16x16x32_bf16 v[148:151], v[84:87], v[248:251], v[116:119]
    v_add_u32 v12, s7, v184
    s_add_u32 s25, s25, 1
    s_waitcnt lgkmcnt(0)
    s_barrier
    v_pk_mul_f32 v[152:153], v[120:121], v[120:121]
    ds_read_b128 a[56:59], v10 offset:14336
    v_pk_mul_f32 v[154:155], v[122:123], v[122:123]
    ds_read_b128 a[128:131], v10 offset:32768
    v_pk_fma_f32 v[152:153], v[152:153], v[8:9], v[4:5] op_sel:[0,0,0] op_sel_hi:[1,0,0]
    ds_read_b128 a[200:203], v11 offset:14336
    v_pk_fma_f32 v[154:155], v[154:155], v[8:9], v[4:5] op_sel:[0,0,0] op_sel_hi:[1,0,0]
    v_pk_mul_f32 v[152:153], v[120:121], v[152:153]
    ds_read_b128 v[236:239], v11 offset:32768
    v_pk_mul_f32 v[154:155], v[122:123], v[154:155]
    ds_read_b128 a[60:63], v10 offset:15360
    buffer_load_dwordx4 v[76:79], v184, s[48:51], s23 offen offset:0 sc1
    v_exp_f32 v152, v152
    ds_read_b128 a[132:135], v10 offset:33792
    v_exp_f32 v153, v153
    v_exp_f32 v154, v154
    ds_read_b128 a[204:207], v11 offset:15360
    v_exp_f32 v155, v155
    ds_read_b128 v[240:243], v11 offset:33792
    v_pk_mul_f32 v[156:157], v[120:121], v[136:137]
    v_pk_mul_f32 v[158:159], v[122:123], v[138:139]
    buffer_load_dwordx4 v[80:83], v184, s[48:51], s23 offen offset:1024 sc1
    v_pk_fma_f32 v[152:153], v[152:153], v[192:193], v[192:193] op_sel:[0,1,1] op_sel_hi:[1,1,1]
    v_pk_fma_f32 v[154:155], v[154:155], v[192:193], v[192:193] op_sel:[0,1,1] op_sel_hi:[1,1,1]
    v_rcp_f32 v152, v152
    v_rcp_f32 v153, v153
    v_rcp_f32 v154, v154
    v_rcp_f32 v155, v155
    buffer_load_dwordx4 v[84:87], v184, s[48:51], s23 offen offset:2048 sc1
    s_nop 0
    v_pk_mul_f32 v[156:157], v[156:157], v[152:153]
    v_pk_mul_f32 v[158:159], v[158:159], v[154:155]
    v_cvt_pk_bf16_f32 v160, v156, v157
    v_cvt_pk_bf16_f32 v161, v158, v159
    ds_write_b64 v12, v[160:161] offset:0
    buffer_load_dwordx4 v[104:107], v184, s[48:51], s23 offen offset:3072 sc1
    v_pk_mul_f32 v[162:163], v[124:125], v[124:125]
    v_pk_mul_f32 v[164:165], v[126:127], v[126:127]
    v_pk_fma_f32 v[162:163], v[162:163], v[8:9], v[4:5] op_sel:[0,1,1] op_sel_hi:[1,1,1]
    v_pk_fma_f32 v[164:165], v[164:165], v[8:9], v[4:5] op_sel:[0,1,1] op_sel_hi:[1,1,1]
    v_pk_mul_f32 v[162:163], v[124:125], v[162:163]
    v_pk_mul_f32 v[164:165], v[126:127], v[164:165]
    buffer_load_dwordx4 v[108:111], v185, s[48:51], s23 offen offset:0 sc1
    v_exp_f32 v162, v162
    v_exp_f32 v163, v163
    v_exp_f32 v164, v164
    v_exp_f32 v165, v165
    v_pk_mul_f32 v[166:167], v[124:125], v[140:141]
    v_pk_mul_f32 v[168:169], v[126:127], v[142:143]
    buffer_load_dwordx4 v[112:115], v185, s[48:51], s23 offen offset:1024 sc1
    v_pk_fma_f32 v[162:163], v[162:163], v[194:195], v[194:195] op_sel:[0,0,0] op_sel_hi:[1,0,0]
    v_pk_fma_f32 v[164:165], v[164:165], v[194:195], v[194:195] op_sel:[0,0,0] op_sel_hi:[1,0,0]
    v_rcp_f32 v162, v162
    v_rcp_f32 v163, v163
    v_rcp_f32 v164, v164
    v_rcp_f32 v165, v165
    buffer_load_dwordx4 v[116:119], v185, s[48:51], s23 offen offset:2048 sc1
    s_nop 0
    v_pk_mul_f32 v[166:167], v[166:167], v[162:163]
    v_pk_mul_f32 v[168:169], v[168:169], v[164:165]
    v_cvt_pk_bf16_f32 v170, v166, v167
    v_cvt_pk_bf16_f32 v171, v168, v169
    ds_write_b64 v12, v[170:171] offset:18432
    buffer_load_dwordx4 v[180:183], v185, s[48:51], s23 offen offset:3072 sc1
    v_pk_mul_f32 v[152:153], v[128:129], v[128:129]
    v_pk_mul_f32 v[154:155], v[130:131], v[130:131]
    v_pk_fma_f32 v[152:153], v[152:153], v[12:13], v[6:7] op_sel:[0,1,0] op_sel_hi:[1,1,0]
    v_pk_fma_f32 v[154:155], v[154:155], v[12:13], v[6:7] op_sel:[0,1,0] op_sel_hi:[1,1,0]
    v_pk_mul_f32 v[152:153], v[128:129], v[152:153]
    v_pk_mul_f32 v[154:155], v[130:131], v[154:155]
    buffer_load_dwordx4 v[196:199], v186, s[48:51], s23 offen offset:0 sc1
    v_exp_f32 v152, v152
    v_exp_f32 v153, v153
    v_exp_f32 v154, v154
    v_exp_f32 v155, v155
    v_pk_mul_f32 v[156:157], v[128:129], v[144:145]
    v_pk_mul_f32 v[158:159], v[130:131], v[146:147]
    buffer_load_dwordx4 v[200:203], v186, s[48:51], s23 offen offset:1024 sc1
    v_pk_fma_f32 v[152:153], v[152:153], v[194:195], v[194:195] op_sel:[0,1,1] op_sel_hi:[1,1,1]
    v_pk_fma_f32 v[154:155], v[154:155], v[194:195], v[194:195] op_sel:[0,1,1] op_sel_hi:[1,1,1]
    v_rcp_f32 v152, v152
    v_rcp_f32 v153, v153
    v_rcp_f32 v154, v154
    v_rcp_f32 v155, v155
    buffer_load_dwordx4 v[204:207], v186, s[48:51], s23 offen offset:2048 sc1
    s_nop 0
    v_pk_mul_f32 v[156:157], v[156:157], v[152:153]
    v_pk_mul_f32 v[158:159], v[158:159], v[154:155]
    v_cvt_pk_bf16_f32 v160, v156, v157
    v_cvt_pk_bf16_f32 v161, v158, v159
    ds_write_b64 v12, v[160:161] offset:36864
    buffer_load_dwordx4 v[208:211], v186, s[48:51], s23 offen offset:3072 sc1
    v_pk_mul_f32 v[162:163], v[132:133], v[132:133]
    v_pk_mul_f32 v[164:165], v[134:135], v[134:135]
    v_pk_fma_f32 v[162:163], v[162:163], v[14:15], v[6:7] op_sel:[0,0,1] op_sel_hi:[1,0,1]
    v_pk_fma_f32 v[164:165], v[164:165], v[14:15], v[6:7] op_sel:[0,0,1] op_sel_hi:[1,0,1]
    v_pk_mul_f32 v[162:163], v[132:133], v[162:163]
    v_pk_mul_f32 v[164:165], v[134:135], v[164:165]
    buffer_load_dwordx4 v[212:215], v187, s[48:51], s23 offen offset:0 sc1
    v_exp_f32 v162, v162
    v_exp_f32 v163, v163
    v_exp_f32 v164, v164
    v_exp_f32 v165, v165
    v_pk_mul_f32 v[166:167], v[132:133], v[148:149]
    v_pk_mul_f32 v[168:169], v[134:135], v[150:151]
    buffer_load_dwordx4 v[216:219], v187, s[48:51], s23 offen offset:1024 sc1
    v_pk_fma_f32 v[162:163], v[162:163], v[252:253], v[252:253] op_sel:[0,0,0] op_sel_hi:[1,0,0]
    v_pk_fma_f32 v[164:165], v[164:165], v[252:253], v[252:253] op_sel:[0,0,0] op_sel_hi:[1,0,0]
    v_rcp_f32 v162, v162
    v_rcp_f32 v163, v163
    v_rcp_f32 v164, v164
    v_rcp_f32 v165, v165
    s_nop 0
    v_pk_mul_f32 v[166:167], v[166:167], v[162:163]
    v_pk_mul_f32 v[168:169], v[168:169], v[164:165]
    v_cvt_pk_bf16_f32 v170, v166, v167
    v_cvt_pk_bf16_f32 v171, v168, v169
    ds_write_b64 v12, v[170:171] offset:55296
    buffer_load_dwordx4 v[136:139], v187, s[48:51], s23 offen offset:2048 sc1
    buffer_load_dwordx4 v[140:143], v187, s[48:51], s23 offen offset:3072 sc1
    buffer_load_dwordx4 v[144:147], v188, s[48:51], s23 offen offset:0 sc1
    buffer_load_dwordx4 v[148:151], v188, s[48:51], s23 offen offset:1024 sc1
    s_add_u32 s23, s23, 18432
    s_waitcnt lgkmcnt(0)
    s_barrier
    ds_read_b128 a[64:67], v10 offset:16384
    ds_read_b128 a[136:139], v10 offset:34816
    ds_read_b128 a[208:211], v11 offset:16384
    ds_read_b128 v[244:247], v11 offset:34816
    ds_read_b128 a[68:71], v10 offset:17408
    ds_read_b128 a[140:143], v10 offset:35840
    ds_read_b128 a[212:215], v11 offset:17408
    ds_read_b128 v[248:251], v11 offset:35840
    s_mov_b32 s25, 0
    s_waitcnt lgkmcnt(0)
    s_branch L_ffn_dn_mid_37
L_ffn_dn_36:
    s_waitcnt vmcnt(32)
    v_mfma_f32_16x16x32_bf16 v[88:91], v[104:107], a[0:3], 0
    v_mfma_f32_16x16x32_bf16 v[88:91], v[108:111], a[4:7], v[88:91]
    buffer_load_dwordx4 v[76:79], v184, s[48:51], s23 offen offset:0 sc1
    v_mfma_f32_16x16x32_bf16 v[88:91], v[112:115], a[8:11], v[88:91]
    v_mfma_f32_16x16x32_bf16 v[92:95], v[104:107], a[72:75], 0
    v_mfma_f32_16x16x32_bf16 v[92:95], v[108:111], a[76:79], v[92:95]
    v_mfma_f32_16x16x32_bf16 v[92:95], v[112:115], a[80:83], v[92:95]
    buffer_load_dwordx4 v[80:83], v184, s[48:51], s23 offen offset:1024 sc1
    v_mfma_f32_16x16x32_bf16 v[96:99], v[104:107], a[144:147], 0
    v_cvt_pk_bf16_f32 v152, v120, v121
    v_cvt_pk_bf16_f32 v153, v122, v123
    v_mfma_f32_16x16x32_bf16 v[96:99], v[108:111], a[148:151], v[96:99]
    v_cvt_pk_bf16_f32 v154, v124, v125
    v_cvt_pk_bf16_f32 v155, v126, v127
    v_mfma_f32_16x16x32_bf16 v[96:99], v[112:115], a[152:155], v[96:99]
    v_cvt_pk_bf16_f32 v156, v128, v129
    v_cvt_pk_bf16_f32 v157, v130, v131
    v_mfma_f32_16x16x32_bf16 v[100:103], v[104:107], a[216:219], 0
    buffer_load_dwordx4 v[84:87], v184, s[48:51], s23 offen offset:2048 sc1
    v_mfma_f32_16x16x32_bf16 v[100:103], v[108:111], a[220:223], v[100:103]
    v_cvt_pk_bf16_f32 v158, v132, v133
    v_cvt_pk_bf16_f32 v159, v134, v135
    v_mfma_f32_16x16x32_bf16 v[100:103], v[112:115], a[224:227], v[100:103]
    v_permlane16_swap_b32 v152, v154
    s_waitcnt vmcnt(32)
    v_mfma_f32_16x16x32_bf16 v[88:91], v[116:119], a[12:15], v[88:91]
    v_permlane16_swap_b32 v153, v155
    v_mfma_f32_16x16x32_bf16 v[88:91], v[180:183], a[16:19], v[88:91]
    buffer_load_dwordx4 v[104:107], v184, s[48:51], s23 offen offset:3072 sc1
    v_mfma_f32_16x16x32_bf16 v[88:91], v[196:199], a[20:23], v[88:91]
    v_permlane16_swap_b32 v156, v158
    v_mfma_f32_16x16x32_bf16 v[92:95], v[116:119], a[84:87], v[92:95]
    v_permlane16_swap_b32 v157, v159
    v_mfma_f32_16x16x32_bf16 v[92:95], v[180:183], a[88:91], v[92:95]
    buffer_store_dwordx4 v[152:155], v178, s[72:75], s27 offen sc1
    v_mfma_f32_16x16x32_bf16 v[92:95], v[196:199], a[92:95], v[92:95]
    buffer_load_dwordx4 v[108:111], v185, s[48:51], s23 offen offset:0 sc1
    v_mfma_f32_16x16x32_bf16 v[96:99], v[116:119], a[156:159], v[96:99]
    buffer_store_dwordx4 v[156:159], v179, s[72:75], s27 offen sc1
    v_mfma_f32_16x16x32_bf16 v[96:99], v[180:183], a[160:163], v[96:99]
    v_mfma_f32_16x16x32_bf16 v[96:99], v[196:199], a[164:167], v[96:99]
    v_mfma_f32_16x16x32_bf16 v[100:103], v[116:119], a[228:231], v[100:103]
    buffer_load_dwordx4 v[112:115], v185, s[48:51], s23 offen offset:1024 sc1
    v_mfma_f32_16x16x32_bf16 v[100:103], v[180:183], a[232:235], v[100:103]
    v_mfma_f32_16x16x32_bf16 v[100:103], v[196:199], a[236:239], v[100:103]
    s_waitcnt vmcnt(34)
    v_mfma_f32_16x16x32_bf16 v[88:91], v[200:203], a[24:27], v[88:91]
    v_mfma_f32_16x16x32_bf16 v[88:91], v[204:207], a[28:31], v[88:91]
    buffer_load_dwordx4 v[116:119], v185, s[48:51], s23 offen offset:2048 sc1
    v_mfma_f32_16x16x32_bf16 v[88:91], v[208:211], a[32:35], v[88:91]
    v_mfma_f32_16x16x32_bf16 v[92:95], v[200:203], a[96:99], v[92:95]
    v_mfma_f32_16x16x32_bf16 v[92:95], v[204:207], a[100:103], v[92:95]
    v_mfma_f32_16x16x32_bf16 v[92:95], v[208:211], a[104:107], v[92:95]
    buffer_load_dwordx4 v[180:183], v185, s[48:51], s23 offen offset:3072 sc1
    v_mfma_f32_16x16x32_bf16 v[96:99], v[200:203], a[168:171], v[96:99]
    v_mfma_f32_16x16x32_bf16 v[96:99], v[204:207], a[172:175], v[96:99]
    v_mfma_f32_16x16x32_bf16 v[96:99], v[208:211], a[176:179], v[96:99]
    v_mfma_f32_16x16x32_bf16 v[100:103], v[200:203], a[240:243], v[100:103]
    buffer_load_dwordx4 v[196:199], v186, s[48:51], s23 offen offset:0 sc1
    v_mfma_f32_16x16x32_bf16 v[100:103], v[204:207], a[244:247], v[100:103]
    v_mfma_f32_16x16x32_bf16 v[100:103], v[208:211], a[248:251], v[100:103]
    s_waitcnt vmcnt(34)
    v_mfma_f32_16x16x32_bf16 v[88:91], v[212:215], a[36:39], v[88:91]
    v_mfma_f32_16x16x32_bf16 v[88:91], v[216:219], a[40:43], v[88:91]
    buffer_load_dwordx4 v[200:203], v186, s[48:51], s23 offen offset:1024 sc1
    v_mfma_f32_16x16x32_bf16 v[88:91], v[136:139], a[44:47], v[88:91]
    v_mfma_f32_16x16x32_bf16 v[92:95], v[212:215], a[108:111], v[92:95]
    v_mfma_f32_16x16x32_bf16 v[92:95], v[216:219], a[112:115], v[92:95]
    v_mfma_f32_16x16x32_bf16 v[92:95], v[136:139], a[116:119], v[92:95]
    buffer_load_dwordx4 v[204:207], v186, s[48:51], s23 offen offset:2048 sc1
    v_mfma_f32_16x16x32_bf16 v[96:99], v[212:215], a[180:183], v[96:99]
    v_mfma_f32_16x16x32_bf16 v[96:99], v[216:219], a[184:187], v[96:99]
    v_mfma_f32_16x16x32_bf16 v[96:99], v[136:139], a[188:191], v[96:99]
    v_mfma_f32_16x16x32_bf16 v[100:103], v[212:215], a[252:255], v[100:103]
    buffer_load_dwordx4 v[208:211], v186, s[48:51], s23 offen offset:3072 sc1
    v_mfma_f32_16x16x32_bf16 v[100:103], v[216:219], v[220:223], v[100:103]
    v_mfma_f32_16x16x32_bf16 v[100:103], v[136:139], v[224:227], v[100:103]
    s_waitcnt vmcnt(34)
    v_mfma_f32_16x16x32_bf16 v[88:91], v[140:143], a[48:51], v[88:91]
    v_mfma_f32_16x16x32_bf16 v[88:91], v[144:147], a[52:55], v[88:91]
    buffer_load_dwordx4 v[212:215], v187, s[48:51], s23 offen offset:0 sc1
    v_mfma_f32_16x16x32_bf16 v[88:91], v[148:151], a[56:59], v[88:91]
    v_mfma_f32_16x16x32_bf16 v[92:95], v[140:143], a[120:123], v[92:95]
    v_mfma_f32_16x16x32_bf16 v[92:95], v[144:147], a[124:127], v[92:95]
    v_mfma_f32_16x16x32_bf16 v[92:95], v[148:151], a[128:131], v[92:95]
    buffer_load_dwordx4 v[216:219], v187, s[48:51], s23 offen offset:1024 sc1
    v_mfma_f32_16x16x32_bf16 v[96:99], v[140:143], a[192:195], v[96:99]
    v_mfma_f32_16x16x32_bf16 v[96:99], v[144:147], a[196:199], v[96:99]
    v_mfma_f32_16x16x32_bf16 v[96:99], v[148:151], a[200:203], v[96:99]
    v_mfma_f32_16x16x32_bf16 v[100:103], v[140:143], v[228:231], v[100:103]
    buffer_load_dwordx4 v[136:139], v187, s[48:51], s23 offen offset:2048 sc1
    v_mfma_f32_16x16x32_bf16 v[100:103], v[144:147], v[232:235], v[100:103]
    v_mfma_f32_16x16x32_bf16 v[100:103], v[148:151], v[236:239], v[100:103]
    s_waitcnt vmcnt(34)
    v_mfma_f32_16x16x32_bf16 v[88:91], v[160:163], a[60:63], v[88:91]
    v_mfma_f32_16x16x32_bf16 v[88:91], v[164:167], a[64:67], v[88:91]
    buffer_load_dwordx4 v[140:143], v187, s[48:51], s23 offen offset:3072 sc1
    v_mfma_f32_16x16x32_bf16 v[120:123], v[168:171], a[68:71], v[88:91]
    v_mfma_f32_16x16x32_bf16 v[92:95], v[160:163], a[132:135], v[92:95]
    v_mfma_f32_16x16x32_bf16 v[92:95], v[164:167], a[136:139], v[92:95]
    v_mfma_f32_16x16x32_bf16 v[124:127], v[168:171], a[140:143], v[92:95]
    buffer_load_dwordx4 v[144:147], v188, s[48:51], s23 offen offset:0 sc1
    v_mfma_f32_16x16x32_bf16 v[96:99], v[160:163], a[204:207], v[96:99]
    s_mov_b32 s74, 268435456
    v_mfma_f32_16x16x32_bf16 v[96:99], v[164:167], a[208:211], v[96:99]
    s_add_u32 s27, s27, 1024
    v_mfma_f32_16x16x32_bf16 v[128:131], v[168:171], a[212:215], v[96:99]
    s_add_u32 s25, s25, 1
    v_mfma_f32_16x16x32_bf16 v[100:103], v[160:163], v[240:243], v[100:103]
    buffer_load_dwordx4 v[148:151], v188, s[48:51], s23 offen offset:1024 sc1
    v_mfma_f32_16x16x32_bf16 v[100:103], v[164:167], v[244:247], v[100:103]
    s_add_u32 s23, s23, 18432
    v_mfma_f32_16x16x32_bf16 v[132:135], v[168:171], v[248:251], v[100:103]
L_ffn_dn_mid_37:
    s_waitcnt vmcnt(30)
    v_mfma_f32_16x16x32_bf16 v[88:91], v[16:19], a[0:3], 0
    v_mfma_f32_16x16x32_bf16 v[88:91], v[20:23], a[4:7], v[88:91]
    buffer_load_dwordx4 v[160:163], v184, s[48:51], s23 offen offset:0 sc1
    v_mfma_f32_16x16x32_bf16 v[88:91], v[24:27], a[8:11], v[88:91]
    v_mfma_f32_16x16x32_bf16 v[92:95], v[16:19], a[72:75], 0
    v_mfma_f32_16x16x32_bf16 v[92:95], v[20:23], a[76:79], v[92:95]
    v_mfma_f32_16x16x32_bf16 v[92:95], v[24:27], a[80:83], v[92:95]
    buffer_load_dwordx4 v[164:167], v184, s[48:51], s23 offen offset:1024 sc1
    v_mfma_f32_16x16x32_bf16 v[96:99], v[16:19], a[144:147], 0
    v_cvt_pk_bf16_f32 v152, v120, v121
    v_cvt_pk_bf16_f32 v153, v122, v123
    v_mfma_f32_16x16x32_bf16 v[96:99], v[20:23], a[148:151], v[96:99]
    v_cvt_pk_bf16_f32 v154, v124, v125
    v_cvt_pk_bf16_f32 v155, v126, v127
    v_mfma_f32_16x16x32_bf16 v[96:99], v[24:27], a[152:155], v[96:99]
    v_cvt_pk_bf16_f32 v156, v128, v129
    v_cvt_pk_bf16_f32 v157, v130, v131
    v_mfma_f32_16x16x32_bf16 v[100:103], v[16:19], a[216:219], 0
    buffer_load_dwordx4 v[168:171], v184, s[48:51], s23 offen offset:2048 sc1
    v_mfma_f32_16x16x32_bf16 v[100:103], v[20:23], a[220:223], v[100:103]
    v_cvt_pk_bf16_f32 v158, v132, v133
    v_cvt_pk_bf16_f32 v159, v134, v135
    v_mfma_f32_16x16x32_bf16 v[100:103], v[24:27], a[224:227], v[100:103]
    v_permlane16_swap_b32 v152, v154
    s_waitcnt vmcnt(30)
    v_mfma_f32_16x16x32_bf16 v[88:91], v[28:31], a[12:15], v[88:91]
    v_permlane16_swap_b32 v153, v155
    v_mfma_f32_16x16x32_bf16 v[88:91], v[32:35], a[16:19], v[88:91]
    buffer_load_dwordx4 v[16:19], v184, s[48:51], s23 offen offset:3072 sc1
    v_mfma_f32_16x16x32_bf16 v[88:91], v[36:39], a[20:23], v[88:91]
    v_permlane16_swap_b32 v156, v158
    v_mfma_f32_16x16x32_bf16 v[92:95], v[28:31], a[84:87], v[92:95]
    v_permlane16_swap_b32 v157, v159
    v_mfma_f32_16x16x32_bf16 v[92:95], v[32:35], a[88:91], v[92:95]
    buffer_store_dwordx4 v[152:155], v178, s[72:75], s27 offen sc1
    v_mfma_f32_16x16x32_bf16 v[92:95], v[36:39], a[92:95], v[92:95]
    buffer_load_dwordx4 v[20:23], v185, s[48:51], s23 offen offset:0 sc1
    v_mfma_f32_16x16x32_bf16 v[96:99], v[28:31], a[156:159], v[96:99]
    buffer_store_dwordx4 v[156:159], v179, s[72:75], s27 offen sc1
    v_mfma_f32_16x16x32_bf16 v[96:99], v[32:35], a[160:163], v[96:99]
    v_mfma_f32_16x16x32_bf16 v[96:99], v[36:39], a[164:167], v[96:99]
    v_mfma_f32_16x16x32_bf16 v[100:103], v[28:31], a[228:231], v[100:103]
    buffer_load_dwordx4 v[24:27], v185, s[48:51], s23 offen offset:1024 sc1
    v_mfma_f32_16x16x32_bf16 v[100:103], v[32:35], a[232:235], v[100:103]
    v_mfma_f32_16x16x32_bf16 v[100:103], v[36:39], a[236:239], v[100:103]
    s_waitcnt vmcnt(32)
    v_mfma_f32_16x16x32_bf16 v[88:91], v[40:43], a[24:27], v[88:91]
    v_mfma_f32_16x16x32_bf16 v[88:91], v[44:47], a[28:31], v[88:91]
    buffer_load_dwordx4 v[28:31], v185, s[48:51], s23 offen offset:2048 sc1
    v_mfma_f32_16x16x32_bf16 v[88:91], v[48:51], a[32:35], v[88:91]
    v_mfma_f32_16x16x32_bf16 v[92:95], v[40:43], a[96:99], v[92:95]
    v_mfma_f32_16x16x32_bf16 v[92:95], v[44:47], a[100:103], v[92:95]
    v_mfma_f32_16x16x32_bf16 v[92:95], v[48:51], a[104:107], v[92:95]
    buffer_load_dwordx4 v[32:35], v185, s[48:51], s23 offen offset:3072 sc1
    v_mfma_f32_16x16x32_bf16 v[96:99], v[40:43], a[168:171], v[96:99]
    v_mfma_f32_16x16x32_bf16 v[96:99], v[44:47], a[172:175], v[96:99]
    v_mfma_f32_16x16x32_bf16 v[96:99], v[48:51], a[176:179], v[96:99]
    v_mfma_f32_16x16x32_bf16 v[100:103], v[40:43], a[240:243], v[100:103]
    buffer_load_dwordx4 v[36:39], v186, s[48:51], s23 offen offset:0 sc1
    v_mfma_f32_16x16x32_bf16 v[100:103], v[44:47], a[244:247], v[100:103]
    v_mfma_f32_16x16x32_bf16 v[100:103], v[48:51], a[248:251], v[100:103]
    s_waitcnt vmcnt(32)
    s_cmp_lg_u32 s25, 6
    s_cbranch_scc1 L_early_38
    s_waitcnt vmcnt(24)
    s_barrier
    s_cmp_lg_u32 s3, 0
    s_cbranch_scc1 L_early_38
    v_lshlrev_b32 v15, 7, v0
    v_mov_b32 v1, s76
    s_mov_b64 exec, 0xff
    buffer_store_dword v1, v15, s[8:11], s29 offen sc1
    s_mov_b64 exec, -1
L_early_38:
    v_mfma_f32_16x16x32_bf16 v[88:91], v[52:55], a[36:39], v[88:91]
    v_mfma_f32_16x16x32_bf16 v[88:91], v[56:59], a[40:43], v[88:91]
    buffer_load_dwordx4 v[40:43], v186, s[48:51], s23 offen offset:1024 sc1
    v_mfma_f32_16x16x32_bf16 v[88:91], v[60:63], a[44:47], v[88:91]
    v_mfma_f32_16x16x32_bf16 v[92:95], v[52:55], a[108:111], v[92:95]
    v_mfma_f32_16x16x32_bf16 v[92:95], v[56:59], a[112:115], v[92:95]
    v_mfma_f32_16x16x32_bf16 v[92:95], v[60:63], a[116:119], v[92:95]
    buffer_load_dwordx4 v[44:47], v186, s[48:51], s23 offen offset:2048 sc1
    v_mfma_f32_16x16x32_bf16 v[96:99], v[52:55], a[180:183], v[96:99]
    v_mfma_f32_16x16x32_bf16 v[96:99], v[56:59], a[184:187], v[96:99]
    v_mfma_f32_16x16x32_bf16 v[96:99], v[60:63], a[188:191], v[96:99]
    v_mfma_f32_16x16x32_bf16 v[100:103], v[52:55], a[252:255], v[100:103]
    buffer_load_dwordx4 v[48:51], v186, s[48:51], s23 offen offset:3072 sc1
    v_mfma_f32_16x16x32_bf16 v[100:103], v[56:59], v[220:223], v[100:103]
    v_mfma_f32_16x16x32_bf16 v[100:103], v[60:63], v[224:227], v[100:103]
    s_waitcnt vmcnt(32)
    v_mfma_f32_16x16x32_bf16 v[88:91], v[64:67], a[48:51], v[88:91]
    v_mfma_f32_16x16x32_bf16 v[88:91], v[68:71], a[52:55], v[88:91]
    buffer_load_dwordx4 v[52:55], v187, s[48:51], s23 offen offset:0 sc1
    v_mfma_f32_16x16x32_bf16 v[88:91], v[72:75], a[56:59], v[88:91]
    v_mfma_f32_16x16x32_bf16 v[92:95], v[64:67], a[120:123], v[92:95]
    v_mfma_f32_16x16x32_bf16 v[92:95], v[68:71], a[124:127], v[92:95]
    v_mfma_f32_16x16x32_bf16 v[92:95], v[72:75], a[128:131], v[92:95]
    buffer_load_dwordx4 v[56:59], v187, s[48:51], s23 offen offset:1024 sc1
    v_mfma_f32_16x16x32_bf16 v[96:99], v[64:67], a[192:195], v[96:99]
    v_mfma_f32_16x16x32_bf16 v[96:99], v[68:71], a[196:199], v[96:99]
    v_mfma_f32_16x16x32_bf16 v[96:99], v[72:75], a[200:203], v[96:99]
    v_mfma_f32_16x16x32_bf16 v[100:103], v[64:67], v[228:231], v[100:103]
    buffer_load_dwordx4 v[60:63], v187, s[48:51], s23 offen offset:2048 sc1
    v_mfma_f32_16x16x32_bf16 v[100:103], v[68:71], v[232:235], v[100:103]
    v_mfma_f32_16x16x32_bf16 v[100:103], v[72:75], v[236:239], v[100:103]
    s_waitcnt vmcnt(32)
    v_mfma_f32_16x16x32_bf16 v[88:91], v[76:79], a[60:63], v[88:91]
    v_mfma_f32_16x16x32_bf16 v[88:91], v[80:83], a[64:67], v[88:91]
    buffer_load_dwordx4 v[64:67], v187, s[48:51], s23 offen offset:3072 sc1
    v_mfma_f32_16x16x32_bf16 v[120:123], v[84:87], a[68:71], v[88:91]
    v_mfma_f32_16x16x32_bf16 v[92:95], v[76:79], a[132:135], v[92:95]
    v_mfma_f32_16x16x32_bf16 v[92:95], v[80:83], a[136:139], v[92:95]
    v_mfma_f32_16x16x32_bf16 v[124:127], v[84:87], a[140:143], v[92:95]
    buffer_load_dwordx4 v[68:71], v188, s[48:51], s23 offen offset:0 sc1
    v_mfma_f32_16x16x32_bf16 v[96:99], v[76:79], a[204:207], v[96:99]
    s_mov_b32 s74, 268435456
    v_mfma_f32_16x16x32_bf16 v[96:99], v[80:83], a[208:211], v[96:99]
    s_add_u32 s27, s27, 1024
    v_mfma_f32_16x16x32_bf16 v[128:131], v[84:87], a[212:215], v[96:99]
    s_add_u32 s25, s25, 1
    v_mfma_f32_16x16x32_bf16 v[100:103], v[76:79], v[240:243], v[100:103]
    buffer_load_dwordx4 v[72:75], v188, s[48:51], s23 offen offset:1024 sc1
    v_mfma_f32_16x16x32_bf16 v[100:103], v[80:83], v[244:247], v[100:103]
    s_add_u32 s23, s23, 18432
    v_mfma_f32_16x16x32_bf16 v[132:135], v[84:87], v[248:251], v[100:103]
    s_cmp_lt_u32 s25, 7
    s_cbranch_scc1 L_ffn_dn_36
    s_waitcnt vmcnt(32)
    v_mfma_f32_16x16x32_bf16 v[88:91], v[104:107], a[0:3], 0
    v_mfma_f32_16x16x32_bf16 v[88:91], v[108:111], a[4:7], v[88:91]
    buffer_load_dwordx4 v[76:79], v184, s[48:51], s23 offen offset:0 sc1
    v_mfma_f32_16x16x32_bf16 v[88:91], v[112:115], a[8:11], v[88:91]
    v_mfma_f32_16x16x32_bf16 v[92:95], v[104:107], a[72:75], 0
    v_mfma_f32_16x16x32_bf16 v[92:95], v[108:111], a[76:79], v[92:95]
    v_mfma_f32_16x16x32_bf16 v[92:95], v[112:115], a[80:83], v[92:95]
    buffer_load_dwordx4 v[80:83], v184, s[48:51], s23 offen offset:1024 sc1
    v_mfma_f32_16x16x32_bf16 v[96:99], v[104:107], a[144:147], 0
    v_cvt_pk_bf16_f32 v152, v120, v121
    v_cvt_pk_bf16_f32 v153, v122, v123
    v_mfma_f32_16x16x32_bf16 v[96:99], v[108:111], a[148:151], v[96:99]
    v_cvt_pk_bf16_f32 v154, v124, v125
    v_cvt_pk_bf16_f32 v155, v126, v127
    v_mfma_f32_16x16x32_bf16 v[96:99], v[112:115], a[152:155], v[96:99]
    v_cvt_pk_bf16_f32 v156, v128, v129
    v_cvt_pk_bf16_f32 v157, v130, v131
    v_mfma_f32_16x16x32_bf16 v[100:103], v[104:107], a[216:219], 0
    buffer_load_dwordx4 v[84:87], v184, s[48:51], s23 offen offset:2048 sc1
    v_mfma_f32_16x16x32_bf16 v[100:103], v[108:111], a[220:223], v[100:103]
    v_cvt_pk_bf16_f32 v158, v132, v133
    v_cvt_pk_bf16_f32 v159, v134, v135
    v_mfma_f32_16x16x32_bf16 v[100:103], v[112:115], a[224:227], v[100:103]
    v_permlane16_swap_b32 v152, v154
    s_waitcnt vmcnt(32)
    v_mfma_f32_16x16x32_bf16 v[88:91], v[116:119], a[12:15], v[88:91]
    v_permlane16_swap_b32 v153, v155
    v_mfma_f32_16x16x32_bf16 v[88:91], v[180:183], a[16:19], v[88:91]
    v_permlane16_swap_b32 v156, v158
    v_mfma_f32_16x16x32_bf16 v[88:91], v[196:199], a[20:23], v[88:91]
    v_permlane16_swap_b32 v157, v159
    s_load_dwordx8 s[56:63], s[38:39], 0 glc
    v_mfma_f32_16x16x32_bf16 v[92:95], v[116:119], a[84:87], v[92:95]
    buffer_store_dwordx4 v[152:155], v178, s[72:75], s27 offen sc1
    s_mov_b32 s6, 0
    v_mfma_f32_16x16x32_bf16 v[92:95], v[180:183], a[88:91], v[92:95]
    buffer_store_dwordx4 v[156:159], v179, s[72:75], s27 offen sc1
    v_mfma_f32_16x16x32_bf16 v[92:95], v[196:199], a[92:95], v[92:95]
    v_mfma_f32_16x16x32_bf16 v[96:99], v[116:119], a[156:159], v[96:99]
    v_mfma_f32_16x16x32_bf16 v[96:99], v[180:183], a[160:163], v[96:99]
    v_mfma_f32_16x16x32_bf16 v[96:99], v[196:199], a[164:167], v[96:99]
    v_mfma_f32_16x16x32_bf16 v[100:103], v[116:119], a[228:231], v[100:103]
    v_mfma_f32_16x16x32_bf16 v[100:103], v[180:183], a[232:235], v[100:103]
    v_mfma_f32_16x16x32_bf16 v[100:103], v[196:199], a[236:239], v[100:103]
    s_waitcnt vmcnt(31)
L_epoll_39:
    s_waitcnt lgkmcnt(0)
    s_xor_b64 s[56:57], s[56:57], s[76:77]
    s_xor_b64 s[58:59], s[58:59], s[76:77]
    s_xor_b64 s[60:61], s[60:61], s[76:77]
    s_xor_b64 s[62:63], s[62:63], s[76:77]
    s_or_b64 s[56:57], s[56:57], s[58:59]
    s_or_b64 s[60:61], s[60:61], s[62:63]
    s_or_b64 s[56:57], s[56:57], s[60:61]
    s_cbranch_scc0 L_epolled_40
    s_load_dwordx8 s[56:63], s[38:39], 0 glc
    s_add_u32 s6, s6, 1
    s_cmp_lt_u32 s6, 1048576
    s_cbranch_scc1 L_epoll_39
    s_branch L_main_end
L_epolled_40:
    v_mfma_f32_16x16x32_bf16 v[88:91], v[200:203], a[24:27], v[88:91]
    v_mfma_f32_16x16x32_bf16 v[88:91], v[204:207], a[28:31], v[88:91]
    buffer_load_dwordx4 v[104:107], v172, s[8:11], s19 offen sc1
    v_mfma_f32_16x16x32_bf16 v[88:91], v[208:211], a[32:35], v[88:91]
    v_mfma_f32_16x16x32_bf16 v[92:95], v[200:203], a[96:99], v[92:95]
    v_mfma_f32_16x16x32_bf16 v[92:95], v[204:207], a[100:103], v[92:95]
    v_mfma_f32_16x16x32_bf16 v[92:95], v[208:211], a[104:107], v[92:95]
    buffer_load_dwordx4 v[108:111], v173, s[8:11], s19 offen sc1
    s_add_u32 s19, s19, 9216
    v_mfma_f32_16x16x32_bf16 v[96:99], v[200:203], a[168:171], v[96:99]
    v_mfma_f32_16x16x32_bf16 v[96:99], v[204:207], a[172:175], v[96:99]
    v_mfma_f32_16x16x32_bf16 v[96:99], v[208:211], a[176:179], v[96:99]
    v_mfma_f32_16x16x32_bf16 v[100:103], v[200:203], a[240:243], v[100:103]
    buffer_load_dwordx4 v[112:115], v172, s[8:11], s19 offen sc1
    v_mfma_f32_16x16x32_bf16 v[100:103], v[204:207], a[244:247], v[100:103]
    v_mfma_f32_16x16x32_bf16 v[100:103], v[208:211], a[248:251], v[100:103]
    s_waitcnt vmcnt(31)
    v_mfma_f32_16x16x32_bf16 v[88:91], v[212:215], a[36:39], v[88:91]
    v_mfma_f32_16x16x32_bf16 v[88:91], v[216:219], a[40:43], v[88:91]
    buffer_load_dwordx4 v[116:119], v173, s[8:11], s19 offen sc1
    s_add_u32 s19, s19, 9216
    v_mfma_f32_16x16x32_bf16 v[88:91], v[136:139], a[44:47], v[88:91]
    v_mfma_f32_16x16x32_bf16 v[92:95], v[212:215], a[108:111], v[92:95]
    v_mfma_f32_16x16x32_bf16 v[92:95], v[216:219], a[112:115], v[92:95]
    v_mfma_f32_16x16x32_bf16 v[92:95], v[136:139], a[116:119], v[92:95]
    buffer_load_dwordx4 v[180:183], v172, s[8:11], s19 offen sc1
    v_mfma_f32_16x16x32_bf16 v[96:99], v[212:215], a[180:183], v[96:99]
    v_mfma_f32_16x16x32_bf16 v[96:99], v[216:219], a[184:187], v[96:99]
    v_mfma_f32_16x16x32_bf16 v[96:99], v[136:139], a[188:191], v[96:99]
    v_mfma_f32_16x16x32_bf16 v[100:103], v[212:215], a[252:255], v[100:103]
    buffer_load_dwordx4 v[196:199], v173, s[8:11], s19 offen sc1
    s_add_u32 s19, s19, 9216
    v_mfma_f32_16x16x32_bf16 v[100:103], v[216:219], v[220:223], v[100:103]
    v_mfma_f32_16x16x32_bf16 v[100:103], v[136:139], v[224:227], v[100:103]
    s_waitcnt vmcnt(31)
    v_mfma_f32_16x16x32_bf16 v[88:91], v[140:143], a[48:51], v[88:91]
    v_mfma_f32_16x16x32_bf16 v[88:91], v[144:147], a[52:55], v[88:91]
    buffer_load_dwordx4 v[200:203], v172, s[8:11], s19 offen sc1
    v_mfma_f32_16x16x32_bf16 v[88:91], v[148:151], a[56:59], v[88:91]
    v_mfma_f32_16x16x32_bf16 v[92:95], v[140:143], a[120:123], v[92:95]
    v_mfma_f32_16x16x32_bf16 v[92:95], v[144:147], a[124:127], v[92:95]
    v_mfma_f32_16x16x32_bf16 v[92:95], v[148:151], a[128:131], v[92:95]
    buffer_load_dwordx4 v[204:207], v173, s[8:11], s19 offen sc1
    s_add_u32 s19, s19, 9216
    v_mfma_f32_16x16x32_bf16 v[96:99], v[140:143], a[192:195], v[96:99]
    v_mfma_f32_16x16x32_bf16 v[96:99], v[144:147], a[196:199], v[96:99]
    v_mfma_f32_16x16x32_bf16 v[96:99], v[148:151], a[200:203], v[96:99]
    v_mfma_f32_16x16x32_bf16 v[100:103], v[140:143], v[228:231], v[100:103]
    buffer_load_dwordx4 v[208:211], v172, s[8:11], s19 offen sc1
    v_mfma_f32_16x16x32_bf16 v[100:103], v[144:147], v[232:235], v[100:103]
    v_mfma_f32_16x16x32_bf16 v[100:103], v[148:151], v[236:239], v[100:103]
    s_waitcnt vmcnt(31)
    v_mfma_f32_16x16x32_bf16 v[88:91], v[160:163], a[60:63], v[88:91]
    v_mfma_f32_16x16x32_bf16 v[88:91], v[164:167], a[64:67], v[88:91]
    buffer_load_dwordx4 v[212:215], v173, s[8:11], s19 offen sc1
    s_add_u32 s19, s19, 9216
    v_mfma_f32_16x16x32_bf16 v[120:123], v[168:171], a[68:71], v[88:91]
    v_mfma_f32_16x16x32_bf16 v[92:95], v[160:163], a[132:135], v[92:95]
    v_mfma_f32_16x16x32_bf16 v[92:95], v[164:167], a[136:139], v[92:95]
    v_mfma_f32_16x16x32_bf16 v[124:127], v[168:171], a[140:143], v[92:95]
    buffer_load_dwordx4 v[216:219], v172, s[8:11], s19 offen sc1
    v_mfma_f32_16x16x32_bf16 v[96:99], v[160:163], a[204:207], v[96:99]
    s_mov_b32 s74, 268435456
    v_mfma_f32_16x16x32_bf16 v[96:99], v[164:167], a[208:211], v[96:99]
    s_add_u32 s27, s27, 1024
    v_mfma_f32_16x16x32_bf16 v[128:131], v[168:171], a[212:215], v[96:99]
    s_add_u32 s25, s25, 1
    v_mfma_f32_16x16x32_bf16 v[100:103], v[160:163], v[240:243], v[100:103]
    buffer_load_dwordx4 v[136:139], v173, s[8:11], s19 offen sc1
    s_add_u32 s19, s19, 9216
    v_mfma_f32_16x16x32_bf16 v[100:103], v[164:167], v[244:247], v[100:103]
    s_add_u32 s23, s23, 18432
    v_mfma_f32_16x16x32_bf16 v[132:135], v[168:171], v[248:251], v[100:103]
    s_waitcnt vmcnt(29)
    v_mfma_f32_16x16x32_bf16 v[88:91], v[16:19], a[0:3], 0
    v_mfma_f32_16x16x32_bf16 v[88:91], v[20:23], a[4:7], v[88:91]
    buffer_load_dwordx4 v[140:143], v172, s[8:11], s19 offen sc1
    v_mfma_f32_16x16x32_bf16 v[88:91], v[24:27], a[8:11], v[88:91]
    v_mfma_f32_16x16x32_bf16 v[92:95], v[16:19], a[72:75], 0
    v_mfma_f32_16x16x32_bf16 v[92:95], v[20:23], a[76:79], v[92:95]
    v_mfma_f32_16x16x32_bf16 v[92:95], v[24:27], a[80:83], v[92:95]
    buffer_load_dwordx4 v[144:147], v173, s[8:11], s19 offen sc1
    s_add_u32 s19, s19, 9216
    v_mfma_f32_16x16x32_bf16 v[96:99], v[16:19], a[144:147], 0
    v_cvt_pk_bf16_f32 v152, v120, v121
    v_cvt_pk_bf16_f32 v153, v122, v123
    v_mfma_f32_16x16x32_bf16 v[96:99], v[20:23], a[148:151], v[96:99]
    v_cvt_pk_bf16_f32 v154, v124, v125
    v_cvt_pk_bf16_f32 v155, v126, v127
    v_mfma_f32_16x16x32_bf16 v[96:99], v[24:27], a[152:155], v[96:99]
    v_cvt_pk_bf16_f32 v156, v128, v129
    v_cvt_pk_bf16_f32 v157, v130, v131
    v_mfma_f32_16x16x32_bf16 v[100:103], v[16:19], a[216:219], 0
    buffer_load_dwordx4 v[148:151], v172, s[8:11], s19 offen sc1
    v_mfma_f32_16x16x32_bf16 v[100:103], v[20:23], a[220:223], v[100:103]
    v_cvt_pk_bf16_f32 v158, v132, v133
    v_cvt_pk_bf16_f32 v159, v134, v135
    v_mfma_f32_16x16x32_bf16 v[100:103], v[24:27], a[224:227], v[100:103]
    v_permlane16_swap_b32 v152, v154
    s_waitcnt vmcnt(29)
    v_mfma_f32_16x16x32_bf16 v[88:91], v[28:31], a[12:15], v[88:91]
    v_permlane16_swap_b32 v153, v155
    v_mfma_f32_16x16x32_bf16 v[88:91], v[32:35], a[16:19], v[88:91]
    buffer_load_dwordx4 v[160:163], v173, s[8:11], s19 offen sc1
    v_mfma_f32_16x16x32_bf16 v[88:91], v[36:39], a[20:23], v[88:91]
    v_permlane16_swap_b32 v156, v158
    v_mfma_f32_16x16x32_bf16 v[92:95], v[28:31], a[84:87], v[92:95]
    v_permlane16_swap_b32 v157, v159
    v_mfma_f32_16x16x32_bf16 v[92:95], v[32:35], a[88:91], v[92:95]
    buffer_store_dwordx4 v[152:155], v178, s[72:75], s27 offen sc1
    v_mfma_f32_16x16x32_bf16 v[92:95], v[36:39], a[92:95], v[92:95]
    buffer_store_dwordx4 v[156:159], v179, s[72:75], s27 offen sc1
    v_mfma_f32_16x16x32_bf16 v[96:99], v[28:31], a[156:159], v[96:99]
    v_mfma_f32_16x16x32_bf16 v[96:99], v[32:35], a[160:163], v[96:99]
    v_mfma_f32_16x16x32_bf16 v[96:99], v[36:39], a[164:167], v[96:99]
    v_mfma_f32_16x16x32_bf16 v[100:103], v[28:31], a[228:231], v[100:103]
    v_mfma_f32_16x16x32_bf16 v[100:103], v[32:35], a[232:235], v[100:103]
    v_mfma_f32_16x16x32_bf16 v[100:103], v[36:39], a[236:239], v[100:103]
    s_waitcnt vmcnt(29)
    v_mfma_f32_16x16x32_bf16 v[88:91], v[40:43], a[24:27], v[88:91]
    v_mfma_f32_16x16x32_bf16 v[88:91], v[44:47], a[28:31], v[88:91]
    v_mfma_f32_16x16x32_bf16 v[88:91], v[48:51], a[32:35], v[88:91]
    v_mfma_f32_16x16x32_bf16 v[92:95], v[40:43], a[96:99], v[92:95]
    v_mfma_f32_16x16x32_bf16 v[92:95], v[44:47], a[100:103], v[92:95]
    v_mfma_f32_16x16x32_bf16 v[92:95], v[48:51], a[104:107], v[92:95]
    v_mfma_f32_16x16x32_bf16 v[96:99], v[40:43], a[168:171], v[96:99]
    v_mfma_f32_16x16x32_bf16 v[96:99], v[44:47], a[172:175], v[96:99]
    v_mfma_f32_16x16x32_bf16 v[96:99], v[48:51], a[176:179], v[96:99]
    v_mfma_f32_16x16x32_bf16 v[100:103], v[40:43], a[240:243], v[100:103]
    v_mfma_f32_16x16x32_bf16 v[100:103], v[44:47], a[244:247], v[100:103]
    v_mfma_f32_16x16x32_bf16 v[100:103], v[48:51], a[248:251], v[100:103]
    s_waitcnt vmcnt(26)
    v_mfma_f32_16x16x32_bf16 v[88:91], v[52:55], a[36:39], v[88:91]
    v_mfma_f32_16x16x32_bf16 v[88:91], v[56:59], a[40:43], v[88:91]
    v_mfma_f32_16x16x32_bf16 v[88:91], v[60:63], a[44:47], v[88:91]
    v_mfma_f32_16x16x32_bf16 v[92:95], v[52:55], a[108:111], v[92:95]
    v_mfma_f32_16x16x32_bf16 v[92:95], v[56:59], a[112:115], v[92:95]
    v_mfma_f32_16x16x32_bf16 v[92:95], v[60:63], a[116:119], v[92:95]
    v_mfma_f32_16x16x32_bf16 v[96:99], v[52:55], a[180:183], v[96:99]
    v_mfma_f32_16x16x32_bf16 v[96:99], v[56:59], a[184:187], v[96:99]
    v_mfma_f32_16x16x32_bf16 v[96:99], v[60:63], a[188:191], v[96:99]
    v_mfma_f32_16x16x32_bf16 v[100:103], v[52:55], a[252:255], v[100:103]
    v_mfma_f32_16x16x32_bf16 v[100:103], v[56:59], v[220:223], v[100:103]
    v_mfma_f32_16x16x32_bf16 v[100:103], v[60:63], v[224:227], v[100:103]
    s_waitcnt vmcnt(23)
    v_mfma_f32_16x16x32_bf16 v[88:91], v[64:67], a[48:51], v[88:91]
    v_mfma_f32_16x16x32_bf16 v[88:91], v[68:71], a[52:55], v[88:91]
    v_mfma_f32_16x16x32_bf16 v[88:91], v[72:75], a[56:59], v[88:91]
    v_mfma_f32_16x16x32_bf16 v[92:95], v[64:67], a[120:123], v[92:95]
    v_mfma_f32_16x16x32_bf16 v[92:95], v[68:71], a[124:127], v[92:95]
    v_mfma_f32_16x16x32_bf16 v[92:95], v[72:75], a[128:131], v[92:95]
    v_mfma_f32_16x16x32_bf16 v[96:99], v[64:67], a[192:195], v[96:99]
    v_mfma_f32_16x16x32_bf16 v[96:99], v[68:71], a[196:199], v[96:99]
    v_mfma_f32_16x16x32_bf16 v[96:99], v[72:75], a[200:203], v[96:99]
    v_mfma_f32_16x16x32_bf16 v[100:103], v[64:67], v[228:231], v[100:103]
    v_mfma_f32_16x16x32_bf16 v[100:103], v[68:71], v[232:235], v[100:103]
    v_mfma_f32_16x16x32_bf16 v[100:103], v[72:75], v[236:239], v[100:103]
    s_waitcnt vmcnt(20)
    v_mfma_f32_16x16x32_bf16 v[88:91], v[76:79], a[60:63], v[88:91]
    v_mfma_f32_16x16x32_bf16 v[88:91], v[80:83], a[64:67], v[88:91]
    v_mfma_f32_16x16x32_bf16 v[120:123], v[84:87], a[68:71], v[88:91]
    v_mfma_f32_16x16x32_bf16 v[92:95], v[76:79], a[132:135], v[92:95]
    v_mfma_f32_16x16x32_bf16 v[92:95], v[80:83], a[136:139], v[92:95]
    v_mfma_f32_16x16x32_bf16 v[124:127], v[84:87], a[140:143], v[92:95]
    v_mfma_f32_16x16x32_bf16 v[96:99], v[76:79], a[204:207], v[96:99]
    s_mov_b32 s74, 268435456
    v_mfma_f32_16x16x32_bf16 v[96:99], v[80:83], a[208:211], v[96:99]
    s_add_u32 s27, s27, 1024
    v_mfma_f32_16x16x32_bf16 v[128:131], v[84:87], a[212:215], v[96:99]
    s_add_u32 s25, s25, 1
    v_mfma_f32_16x16x32_bf16 v[100:103], v[76:79], v[240:243], v[100:103]
    v_mfma_f32_16x16x32_bf16 v[100:103], v[80:83], v[244:247], v[100:103]
    s_add_u32 s23, s23, 18432
    v_mfma_f32_16x16x32_bf16 v[132:135], v[84:87], v[248:251], v[100:103]
    s_nop 7
    v_cvt_pk_bf16_f32 v152, v120, v121
    v_cvt_pk_bf16_f32 v153, v122, v123
    v_cvt_pk_bf16_f32 v154, v124, v125
    v_cvt_pk_bf16_f32 v155, v126, v127
    v_cvt_pk_bf16_f32 v156, v128, v129
    v_cvt_pk_bf16_f32 v157, v130, v131
    v_cvt_pk_bf16_f32 v158, v132, v133
    v_cvt_pk_bf16_f32 v159, v134, v135
    s_nop 1
    v_permlane16_swap_b32 v152, v154
    v_permlane16_swap_b32 v153, v155
    v_permlane16_swap_b32 v156, v158
    v_permlane16_swap_b32 v157, v159
    buffer_store_dwordx4 v[152:155], v178, s[72:75], s27 offen sc1
    buffer_store_dwordx4 v[156:159], v179, s[72:75], s27 offen sc1
    v_lshlrev_b32 v15, 7, v0
    s_lshl_b32 s6, s40, 2
    s_add_u32 s6, s6, s44
    s_add_u32 s6, s6, 65536
    v_mov_b32 v1, s76
    s_mov_b64 vcc, 0xff
    s_waitcnt vmcnt(0)
    s_barrier
    s_cmp_lg_u32 s3, 0
    s_cbranch_scc1 L_pub_41
    s_mov_b64 exec, vcc
    buffer_store_dword v1, v15, s[8:11], s6 offen sc1
L_pub_41:
    s_mov_b64 exec, -1
    s_add_u32 s19, s18, s43
    s_add_u32 s22, s19, 45875200
    s_lshl_b32 s23, s21, 5
    s_add_u32 s23, s23, s43
    s_add_u32 s23, s23, 48431104
    v_and_b32 v12, 7, v0
    v_lshlrev_b32 v12, 2, v12
    buffer_load_dword v10, v12, s[8:11], s23 offen sc1
    buffer_load_dwordx4 v[92:95], v172, s[8:11], s22 offen sc1
    buffer_load_dwordx4 v[96:99], v173, s[8:11], s22 offen sc1
    buffer_load_dwordx4 v[100:103], v174, s[8:11], s22 offen sc1
    v_lshlrev_b32 v16, 16, v104
    v_and_b32 v17, s16, v104
    v_lshlrev_b32 v18, 16, v105
    v_and_b32 v19, s16, v105
    v_lshlrev_b32 v20, 16, v106
    v_and_b32 v21, s16, v106
    v_lshlrev_b32 v22, 16, v107
    v_and_b32 v23, s16, v107
    v_lshlrev_b32 v24, 16, v108
    v_and_b32 v25, s16, v108
    v_lshlrev_b32 v26, 16, v109
    v_and_b32 v27, s16, v109
    v_lshlrev_b32 v28, 16, v110
    v_and_b32 v29, s16, v110
    v_lshlrev_b32 v30, 16, v111
    v_and_b32 v31, s16, v111
    v_lshlrev_b32 v40, 16, v112
    v_and_b32 v41, s16, v112
    v_lshlrev_b32 v42, 16, v113
    v_and_b32 v43, s16, v113
    v_lshlrev_b32 v44, 16, v114
    v_and_b32 v45, s16, v114
    v_lshlrev_b32 v46, 16, v115
    v_and_b32 v47, s16, v115
    v_pk_add_f32 v[16:17], v[16:17], v[40:41]
    v_pk_add_f32 v[18:19], v[18:19], v[42:43]
    v_pk_add_f32 v[20:21], v[20:21], v[44:45]
    v_pk_add_f32 v[22:23], v[22:23], v[46:47]
    v_lshlrev_b32 v40, 16, v116
    v_and_b32 v41, s16, v116
    v_lshlrev_b32 v42, 16, v117
    v_and_b32 v43, s16, v117
    v_lshlrev_b32 v44, 16, v118
    v_and_b32 v45, s16, v118
    v_lshlrev_b32 v46, 16, v119
    v_and_b32 v47, s16, v119
    v_pk_add_f32 v[24:25], v[24:25], v[40:41]
    v_pk_add_f32 v[26:27], v[26:27], v[42:43]
    v_pk_add_f32 v[28:29], v[28:29], v[44:45]
    v_pk_add_f32 v[30:31], v[30:31], v[46:47]
    v_lshlrev_b32 v40, 16, v180
    v_and_b32 v41, s16, v180
    v_lshlrev_b32 v42, 16, v181
    v_and_b32 v43, s16, v181
    v_lshlrev_b32 v44, 16, v182
    v_and_b32 v45, s16, v182
    v_lshlrev_b32 v46, 16, v183
    v_and_b32 v47, s16, v183
    v_pk_add_f32 v[16:17], v[16:17], v[40:41]
    v_pk_add_f32 v[18:19], v[18:19], v[42:43]
    v_pk_add_f32 v[20:21], v[20:21], v[44:45]
    v_pk_add_f32 v[22:23], v[22:23], v[46:47]
    v_lshlrev_b32 v40, 16, v196
    v_and_b32 v41, s16, v196
    v_lshlrev_b32 v42, 16, v197
    v_and_b32 v43, s16, v197
    v_lshlrev_b32 v44, 16, v198
    v_and_b32 v45, s16, v198
    v_lshlrev_b32 v46, 16, v199
    v_and_b32 v47, s16, v199
    v_pk_add_f32 v[24:25], v[24:25], v[40:41]
    v_pk_add_f32 v[26:27], v[26:27], v[42:43]
    v_pk_add_f32 v[28:29], v[28:29], v[44:45]
    v_pk_add_f32 v[30:31], v[30:31], v[46:47]
    v_lshlrev_b32 v40, 16, v200
    v_and_b32 v41, s16, v200
    v_lshlrev_b32 v42, 16, v201
    v_and_b32 v43, s16, v201
    v_lshlrev_b32 v44, 16, v202
    v_and_b32 v45, s16, v202
    v_lshlrev_b32 v46, 16, v203
    v_and_b32 v47, s16, v203
    v_pk_add_f32 v[16:17], v[16:17], v[40:41]
    v_pk_add_f32 v[18:19], v[18:19], v[42:43]
    v_pk_add_f32 v[20:21], v[20:21], v[44:45]
    v_pk_add_f32 v[22:23], v[22:23], v[46:47]
    v_lshlrev_b32 v40, 16, v204
    v_and_b32 v41, s16, v204
    v_lshlrev_b32 v42, 16, v205
    v_and_b32 v43, s16, v205
    v_lshlrev_b32 v44, 16, v206
    v_and_b32 v45, s16, v206
    v_lshlrev_b32 v46, 16, v207
    v_and_b32 v47, s16, v207
    v_pk_add_f32 v[24:25], v[24:25], v[40:41]
    v_pk_add_f32 v[26:27], v[26:27], v[42:43]
    v_pk_add_f32 v[28:29], v[28:29], v[44:45]
    v_pk_add_f32 v[30:31], v[30:31], v[46:47]
    s_cmp_lg_u32 s3, 0
    s_cbranch_scc1 L_pollout_44
    s_lshl_b32 s7, s40, 7
    s_add_u32 s7, s7, s44
    s_add_u32 s7, s7, 65536
    s_add_u32 s52, s4, s7
    s_addc_u32 s53, s5, 0
    s_mov_b32 s6, 0
L_poll_42:
    s_load_dwordx8 s[56:63], s[52:53], 0 glc
    s_add_u32 s6, s6, 1
    s_waitcnt lgkmcnt(0)
    s_xor_b64 s[56:57], s[56:57], s[76:77]
    s_xor_b64 s[58:59], s[58:59], s[76:77]
    s_xor_b64 s[60:61], s[60:61], s[76:77]
    s_xor_b64 s[62:63], s[62:63], s[76:77]
    s_or_b64 s[56:57], s[56:57], s[58:59]
    s_or_b64 s[60:61], s[60:61], s[62:63]
    s_or_b64 s[56:57], s[56:57], s[60:61]
    s_cbranch_scc0 L_polled_43
    s_cmp_lt_u32 s6, 1048576
    s_cbranch_scc1 L_poll_42
    s_branch L_main_end
L_polled_43:
L_pollout_44:
    s_barrier
    buffer_load_dwordx4 v[60:63], v174, s[8:11], s20 offen sc1
    s_add_u32 s20, s20, 9216
    buffer_load_dwordx4 v[64:67], v174, s[8:11], s20 offen sc1
    s_add_u32 s20, s20, 9216
    buffer_load_dwordx4 v[68:71], v174, s[8:11], s20 offen sc1
    s_add_u32 s20, s20, 9216
    buffer_load_dwordx4 v[72:75], v174, s[8:11], s20 offen sc1
    s_add_u32 s20, s20, 9216
    buffer_load_dwordx4 v[76:79], v174, s[8:11], s20 offen sc1
    s_add_u32 s20, s20, 9216
    buffer_load_dwordx4 v[80:83], v174, s[8:11], s20 offen sc1
    s_add_u32 s20, s20, 9216
    buffer_load_dwordx4 v[84:87], v174, s[8:11], s20 offen sc1
    s_add_u32 s20, s20, 9216
    buffer_load_dwordx4 v[88:91], v174, s[8:11], s20 offen sc1
    v_lshlrev_b32 v40, 16, v208
    v_and_b32 v41, s16, v208
    v_lshlrev_b32 v42, 16, v209
    v_and_b32 v43, s16, v209
    v_lshlrev_b32 v44, 16, v210
    v_and_b32 v45, s16, v210
    v_lshlrev_b32 v46, 16, v211
    v_and_b32 v47, s16, v211
    v_pk_add_f32 v[16:17], v[16:17], v[40:41]
    v_pk_add_f32 v[18:19], v[18:19], v[42:43]
    v_pk_add_f32 v[20:21], v[20:21], v[44:45]
    v_pk_add_f32 v[22:23], v[22:23], v[46:47]
    v_lshlrev_b32 v40, 16, v212
    v_and_b32 v41, s16, v212
    v_lshlrev_b32 v42, 16, v213
    v_and_b32 v43, s16, v213
    v_lshlrev_b32 v44, 16, v214
    v_and_b32 v45, s16, v214
    v_lshlrev_b32 v46, 16, v215
    v_and_b32 v47, s16, v215
    v_pk_add_f32 v[24:25], v[24:25], v[40:41]
    v_pk_add_f32 v[26:27], v[26:27], v[42:43]
    v_pk_add_f32 v[28:29], v[28:29], v[44:45]
    v_pk_add_f32 v[30:31], v[30:31], v[46:47]
    v_lshlrev_b32 v40, 16, v216
    v_and_b32 v41, s16, v216
    v_lshlrev_b32 v42, 16, v217
    v_and_b32 v43, s16, v217
    v_lshlrev_b32 v44, 16, v218
    v_and_b32 v45, s16, v218
    v_lshlrev_b32 v46, 16, v219
    v_and_b32 v47, s16, v219
    v_pk_add_f32 v[16:17], v[16:17], v[40:41]
    v_pk_add_f32 v[18:19], v[18:19], v[42:43]
    v_pk_add_f32 v[20:21], v[20:21], v[44:45]
    v_pk_add_f32 v[22:23], v[22:23], v[46:47]
    v_lshlrev_b32 v40, 16, v136
    v_and_b32 v41, s16, v136
    v_lshlrev_b32 v42, 16, v137
    v_and_b32 v43, s16, v137
    v_lshlrev_b32 v44, 16, v138
    v_and_b32 v45, s16, v138
    v_lshlrev_b32 v46, 16, v139
    v_and_b32 v47, s16, v139
    v_pk_add_f32 v[24:25], v[24:25], v[40:41]
    v_pk_add_f32 v[26:27], v[26:27], v[42:43]
    v_pk_add_f32 v[28:29], v[28:29], v[44:45]
    v_pk_add_f32 v[30:31], v[30:31], v[46:47]
    v_lshlrev_b32 v40, 16, v140
    v_and_b32 v41, s16, v140
    v_lshlrev_b32 v42, 16, v141
    v_and_b32 v43, s16, v141
    v_lshlrev_b32 v44, 16, v142
    v_and_b32 v45, s16, v142
    v_lshlrev_b32 v46, 16, v143
    v_and_b32 v47, s16, v143
    v_pk_add_f32 v[16:17], v[16:17], v[40:41]
    v_pk_add_f32 v[18:19], v[18:19], v[42:43]
    v_pk_add_f32 v[20:21], v[20:21], v[44:45]
    v_pk_add_f32 v[22:23], v[22:23], v[46:47]
    v_lshlrev_b32 v40, 16, v144
    v_and_b32 v41, s16, v144
    v_lshlrev_b32 v42, 16, v145
    v_and_b32 v43, s16, v145
    v_lshlrev_b32 v44, 16, v146
    v_and_b32 v45, s16, v146
    v_lshlrev_b32 v46, 16, v147
    v_and_b32 v47, s16, v147
    v_pk_add_f32 v[24:25], v[24:25], v[40:41]
    v_pk_add_f32 v[26:27], v[26:27], v[42:43]
    v_pk_add_f32 v[28:29], v[28:29], v[44:45]
    v_pk_add_f32 v[30:31], v[30:31], v[46:47]
    v_lshlrev_b32 v40, 16, v148
    v_and_b32 v41, s16, v148
    v_lshlrev_b32 v42, 16, v149
    v_and_b32 v43, s16, v149
    v_lshlrev_b32 v44, 16, v150
    v_and_b32 v45, s16, v150
    v_lshlrev_b32 v46, 16, v151
    v_and_b32 v47, s16, v151
    v_pk_add_f32 v[16:17], v[16:17], v[40:41]
    v_pk_add_f32 v[18:19], v[18:19], v[42:43]
    v_pk_add_f32 v[20:21], v[20:21], v[44:45]
    v_pk_add_f32 v[22:23], v[22:23], v[46:47]
    v_lshlrev_b32 v40, 16, v160
    v_and_b32 v41, s16, v160
    v_lshlrev_b32 v42, 16, v161
    v_and_b32 v43, s16, v161
    v_lshlrev_b32 v44, 16, v162
    v_and_b32 v45, s16, v162
    v_lshlrev_b32 v46, 16, v163
    v_and_b32 v47, s16, v163
    v_pk_add_f32 v[24:25], v[24:25], v[40:41]
    v_pk_add_f32 v[26:27], v[26:27], v[42:43]
    v_pk_add_f32 v[28:29], v[28:29], v[44:45]
    v_pk_add_f32 v[30:31], v[30:31], v[46:47]
    s_cmp_eq_u32 s3, 0
    s_cselect_b32 s7, 1.0, 0
    s_waitcnt vmcnt(8)
    v_mul_f32 v11, s7, v10
    v_lshlrev_b32 v40, 16, v92
    v_and_b32 v41, s16, v92
    v_lshlrev_b32 v42, 16, v93
    v_and_b32 v43, s16, v93
    v_lshlrev_b32 v44, 16, v94
    v_and_b32 v45, s16, v94
    v_lshlrev_b32 v46, 16, v95
    v_and_b32 v47, s16, v95
    v_pk_add_f32 v[16:17], v[16:17], v[40:41]
    v_pk_add_f32 v[18:19], v[18:19], v[42:43]
    v_pk_add_f32 v[20:21], v[20:21], v[44:45]
    v_pk_add_f32 v[22:23], v[22:23], v[46:47]
    v_lshlrev_b32 v40, 16, v96
    v_and_b32 v41, s16, v96
    v_lshlrev_b32 v42, 16, v97
    v_and_b32 v43, s16, v97
    v_lshlrev_b32 v44, 16, v98
    v_and_b32 v45, s16, v98
    v_lshlrev_b32 v46, 16, v99
    v_and_b32 v47, s16, v99
    v_pk_add_f32 v[24:25], v[24:25], v[40:41]
    v_pk_add_f32 v[26:27], v[26:27], v[42:43]
    v_pk_add_f32 v[28:29], v[28:29], v[44:45]
    v_pk_add_f32 v[30:31], v[30:31], v[46:47]
    v_lshlrev_b32 v32, 16, v100
    v_and_b32 v33, s16, v100
    v_lshlrev_b32 v34, 16, v101
    v_and_b32 v35, s16, v101
    v_lshlrev_b32 v36, 16, v102
    v_and_b32 v37, s16, v102
    v_lshlrev_b32 v38, 16, v103
    v_and_b32 v39, s16, v103
    v_pk_add_f32 v[16:17], v[16:17], v[10:11] op_sel_hi:[1,0]
    v_pk_add_f32 v[18:19], v[18:19], v[10:11] op_sel_hi:[1,0]
    v_pk_add_f32 v[20:21], v[20:21], v[10:11] op_sel_hi:[1,0]
    v_pk_add_f32 v[22:23], v[22:23], v[10:11] op_sel_hi:[1,0]
    v_pk_add_f32 v[24:25], v[24:25], v[10:11] op_sel:[0,1] op_sel_hi:[1,1]
    v_pk_add_f32 v[26:27], v[26:27], v[10:11] op_sel:[0,1] op_sel_hi:[1,1]
    v_pk_add_f32 v[28:29], v[28:29], v[10:11] op_sel:[0,1] op_sel_hi:[1,1]
    v_pk_add_f32 v[30:31], v[30:31], v[10:11] op_sel:[0,1] op_sel_hi:[1,1]
    v_pk_add_f32 v[32:33], v[32:33], v[10:11] op_sel_hi:[1,0]
    v_pk_add_f32 v[34:35], v[34:35], v[10:11] op_sel_hi:[1,0]
    v_pk_add_f32 v[36:37], v[36:37], v[10:11] op_sel_hi:[1,0]
    v_pk_add_f32 v[38:39], v[38:39], v[10:11] op_sel_hi:[1,0]
    s_waitcnt vmcnt(7)
    s_lshl_b32 s28, s40, 2
    s_add_u32 s28, s28, s3
    s_mul_i32 s28, s28, 73728
    s_mul_i32 s7, s42, 1073741824
    v_add_u32 v1, s7, v253
    buffer_load_dwordx4 a[0:3], v1, s[8:11], s28 offen offset:0 sc1
    buffer_load_dwordx4 a[4:7], v1, s[8:11], s28 offen offset:1024 sc1
    v_lshlrev_b32 v40, 16, v60
    v_and_b32 v41, s16, v60
    v_lshlrev_b32 v42, 16, v61
    v_and_b32 v43, s16, v61
    v_lshlrev_b32 v44, 16, v62
    v_and_b32 v45, s16, v62
    v_lshlrev_b32 v46, 16, v63
    v_and_b32 v47, s16, v63
    v_pk_add_f32 v[32:33], v[32:33], v[40:41]
    v_pk_add_f32 v[34:35], v[34:35], v[42:43]
    v_pk_add_f32 v[36:37], v[36:37], v[44:45]
    v_pk_add_f32 v[38:39], v[38:39], v[46:47]
    s_waitcnt vmcnt(8)
    buffer_load_dwordx4 a[8:11], v1, s[8:11], s28 offen offset:2048 sc1
    buffer_load_dwordx4 a[12:15], v1, s[8:11], s28 offen offset:3072 sc1
    v_lshlrev_b32 v40, 16, v64
    v_and_b32 v41, s16, v64
    v_lshlrev_b32 v42, 16, v65
    v_and_b32 v43, s16, v65
    v_lshlrev_b32 v44, 16, v66
    v_and_b32 v45, s16, v66
    v_lshlrev_b32 v46, 16, v67
    v_and_b32 v47, s16, v67
    v_pk_add_f32 v[32:33], v[32:33], v[40:41]
    v_pk_add_f32 v[34:35], v[34:35], v[42:43]
    v_pk_add_f32 v[36:37], v[36:37], v[44:45]
    v_pk_add_f32 v[38:39], v[38:39], v[46:47]
    s_waitcnt vmcnt(9)
    s_add_u32 s28, s28, 4096
    buffer_load_dwordx4 a[16:19], v1, s[8:11], s28 offen offset:0 sc1
    buffer_load_dwordx4 a[20:23], v1, s[8:11], s28 offen offset:1024 sc1
    v_lshlrev_b32 v40, 16, v68
    v_and_b32 v41, s16, v68
    v_lshlrev_b32 v42, 16, v69
    v_and_b32 v43, s16, v69
    v_lshlrev_b32 v44, 16, v70
    v_and_b32 v45, s16, v70
    v_lshlrev_b32 v46, 16, v71
    v_and_b32 v47, s16, v71
    v_pk_add_f32 v[32:33], v[32:33], v[40:41]
    v_pk_add_f32 v[34:35], v[34:35], v[42:43]
    v_pk_add_f32 v[36:37], v[36:37], v[44:45]
    v_pk_add_f32 v[38:39], v[38:39], v[46:47]
    s_waitcnt vmcnt(10)
    buffer_load_dwordx4 a[24:27], v1, s[8:11], s28 offen offset:2048 sc1
    buffer_load_dwordx4 a[28:31], v1, s[8:11], s28 offen offset:3072 sc1
    v_lshlrev_b32 v40, 16, v72
    v_and_b32 v41, s16, v72
    v_lshlrev_b32 v42, 16, v73
    v_and_b32 v43, s16, v73
    v_lshlrev_b32 v44, 16, v74
    v_and_b32 v45, s16, v74
    v_lshlrev_b32 v46, 16, v75
    v_and_b32 v47, s16, v75
    v_pk_add_f32 v[32:33], v[32:33], v[40:41]
    v_pk_add_f32 v[34:35], v[34:35], v[42:43]
    v_pk_add_f32 v[36:37], v[36:37], v[44:45]
    v_pk_add_f32 v[38:39], v[38:39], v[46:47]
    s_waitcnt vmcnt(11)
    s_add_u32 s28, s28, 4096
    buffer_load_dwordx4 a[32:35], v1, s[8:11], s28 offen offset:0 sc1
    buffer_load_dwordx4 a[36:39], v1, s[8:11], s28 offen offset:1024 sc1
    v_lshlrev_b32 v40, 16, v76
    v_and_b32 v41, s16, v76
    v_lshlrev_b32 v42, 16, v77
    v_and_b32 v43, s16, v77
    v_lshlrev_b32 v44, 16, v78
    v_and_b32 v45, s16, v78
    v_lshlrev_b32 v46, 16, v79
    v_and_b32 v47, s16, v79
    v_pk_add_f32 v[32:33], v[32:33], v[40:41]
    v_pk_add_f32 v[34:35], v[34:35], v[42:43]
    v_pk_add_f32 v[36:37], v[36:37], v[44:45]
    v_pk_add_f32 v[38:39], v[38:39], v[46:47]
    s_waitcnt vmcnt(12)
    buffer_load_dwordx4 a[40:43], v1, s[8:11], s28 offen offset:2048 sc1
    buffer_load_dwordx4 a[44:47], v1, s[8:11], s28 offen offset:3072 sc1
    v_lshlrev_b32 v40, 16, v80
    v_and_b32 v41, s16, v80
    v_lshlrev_b32 v42, 16, v81
    v_and_b32 v43, s16, v81
    v_lshlrev_b32 v44, 16, v82
    v_and_b32 v45, s16, v82
    v_lshlrev_b32 v46, 16, v83
    v_and_b32 v47, s16, v83
    v_pk_add_f32 v[32:33], v[32:33], v[40:41]
    v_pk_add_f32 v[34:35], v[34:35], v[42:43]
    v_pk_add_f32 v[36:37], v[36:37], v[44:45]
    v_pk_add_f32 v[38:39], v[38:39], v[46:47]
    s_waitcnt vmcnt(13)
    s_add_u32 s28, s28, 4096
    buffer_load_dwordx4 a[48:51], v1, s[8:11], s28 offen offset:0 sc1
    buffer_load_dwordx4 a[52:55], v1, s[8:11], s28 offen offset:1024 sc1
    v_lshlrev_b32 v40, 16, v84
    v_and_b32 v41, s16, v84
    v_lshlrev_b32 v42, 16, v85
    v_and_b32 v43, s16, v85
    v_lshlrev_b32 v44, 16, v86
    v_and_b32 v45, s16, v86
    v_lshlrev_b32 v46, 16, v87
    v_and_b32 v47, s16, v87
    v_pk_add_f32 v[32:33], v[32:33], v[40:41]
    v_pk_add_f32 v[34:35], v[34:35], v[42:43]
    v_pk_add_f32 v[36:37], v[36:37], v[44:45]
    v_pk_add_f32 v[38:39], v[38:39], v[46:47]
    s_waitcnt vmcnt(14)
    buffer_load_dwordx4 a[56:59], v1, s[8:11], s28 offen offset:2048 sc1
    buffer_load_dwordx4 a[60:63], v1, s[8:11], s28 offen offset:3072 sc1
    v_lshlrev_b32 v40, 16, v88
    v_and_b32 v41, s16, v88
    v_lshlrev_b32 v42, 16, v89
    v_and_b32 v43, s16, v89
    v_lshlrev_b32 v44, 16, v90
    v_and_b32 v45, s16, v90
    v_lshlrev_b32 v46, 16, v91
    v_and_b32 v47, s16, v91
    v_pk_add_f32 v[32:33], v[32:33], v[40:41]
    v_pk_add_f32 v[34:35], v[34:35], v[42:43]
    v_pk_add_f32 v[36:37], v[36:37], v[44:45]
    v_pk_add_f32 v[38:39], v[38:39], v[46:47]
    s_add_u32 s28, s28, 4096
    buffer_load_dwordx4 a[64:67], v1, s[8:11], s28 offen offset:0 sc1
    buffer_load_dwordx4 a[68:71], v1, s[8:11], s28 offen offset:1024 sc1
    buffer_load_dwordx4 a[72:75], v1, s[8:11], s28 offen offset:2048 sc1
    buffer_load_dwordx4 a[76:79], v1, s[8:11], s28 offen offset:3072 sc1
    s_add_u32 s28, s28, 4096
    buffer_load_dwordx4 a[80:83], v1, s[8:11], s28 offen offset:0 sc1
    buffer_load_dwordx4 a[84:87], v1, s[8:11], s28 offen offset:1024 sc1
    buffer_load_dwordx4 a[88:91], v1, s[8:11], s28 offen offset:2048 sc1
    buffer_load_dwordx4 a[92:95], v1, s[8:11], s28 offen offset:3072 sc1
    s_add_u32 s28, s28, 4096
    v_cvt_pk_bf16_f32 v120, v16, v17
    v_cvt_pk_bf16_f32 v121, v18, v19
    v_cvt_pk_bf16_f32 v122, v20, v21
    v_cvt_pk_bf16_f32 v123, v22, v23
    v_cvt_pk_bf16_f32 v124, v24, v25
    v_cvt_pk_bf16_f32 v125, v26, v27
    v_cvt_pk_bf16_f32 v126, v28, v29
    v_cvt_pk_bf16_f32 v127, v30, v31
    v_cvt_pk_bf16_f32 v128, v32, v33
    v_cvt_pk_bf16_f32 v129, v34, v35
    v_cvt_pk_bf16_f32 v130, v36, v37
    v_cvt_pk_bf16_f32 v131, v38, v39
    s_cmp_lg_u32 s42, 0
    s_cbranch_scc1 L_main_last
    s_add_u32 s19, s18, 53215232
    s_add_u32 s20, s18, 48496640
    s_lshl_b32 s22, s21, 7
    s_add_u32 s22, s22, 57933824
    buffer_store_dwordx4 v[120:123], v172, s[8:11], s19 offen sc1
    buffer_store_dwordx4 v[124:127], v173, s[8:11], s19 offen sc1
    buffer_store_dwordx4 v[128:131], v174, s[8:11], s19 offen sc1
    s_mov_b32 s17, 0x3f803f80
    v_mov_b32 v8, 0
    v_mov_b32 v9, 0
    v_mov_b32 v10, 0
    v_mov_b32 v11, 0
    v_dot2c_f32_bf16 v8, s17, v120
    v_dot2c_f32_bf16 v9, v120, v120
    v_dot2c_f32_bf16 v10, s17, v121
    v_dot2c_f32_bf16 v11, v121, v121
    v_dot2c_f32_bf16 v8, s17, v122
    v_dot2c_f32_bf16 v9, v122, v122
    v_dot2c_f32_bf16 v10, s17, v123
    v_dot2c_f32_bf16 v11, v123, v123
    v_dot2c_f32_bf16 v8, s17, v124
    v_dot2c_f32_bf16 v9, v124, v124
    v_dot2c_f32_bf16 v10, s17, v125
    v_dot2c_f32_bf16 v11, v125, v125
    v_dot2c_f32_bf16 v8, s17, v126
    v_dot2c_f32_bf16 v9, v126, v126
    v_dot2c_f32_bf16 v10, s17, v127
    v_dot2c_f32_bf16 v11, v127, v127
    v_dot2c_f32_bf16 v8, s17, v128
    v_dot2c_f32_bf16 v9, v128, v128
    v_dot2c_f32_bf16 v10, s17, v129
    v_dot2c_f32_bf16 v11, v129, v129
    v_dot2c_f32_bf16 v8, s17, v130
    v_dot2c_f32_bf16 v9, v130, v130
    v_dot2c_f32_bf16 v10, s17, v131
    v_dot2c_f32_bf16 v11, v131, v131
    v_and_b32 v12, 7, v0
    v_lshlrev_b32 v12, 3, v12
    s_lshl_b32 s7, s3, 6
    v_add_u32 v13, s7, v12
    v_pk_add_f32 v[8:9], v[8:9], v[10:11]
    s_nop 1
    v_add_f32_dpp v8, v8, v8 row_ror:8 row_mask:0xf bank_mask:0xf
    v_add_f32_dpp v9, v9, v9 row_ror:8 row_mask:0xf bank_mask:0xf
    v_mov_b32 v10, v8
    v_mov_b32 v11, v9
    s_nop 1
    v_permlane32_swap_b32 v10, v8
    v_permlane32_swap_b32 v11, v9
    v_add_f32 v8, v8, v10
    v_add_f32 v9, v9, v11
    v_mov_b32 v10, v8
    v_mov_b32 v11, v9
    s_nop 1
    v_permlane16_swap_b32 v10, v8
    v_permlane16_swap_b32 v11, v9
    v_add_f32 v8, v8, v10
    v_add_f32 v9, v9, v11
    ds_write_b64 v13, v[8:9]
    s_waitcnt lgkmcnt(0)
    s_barrier
    ds_read_b64 v[40:41], v12 offset:0
    ds_read_b64 v[42:43], v12 offset:64
    ds_read_b64 v[44:45], v12 offset:128
    ds_read_b64 v[46:47], v12 offset:192
    s_waitcnt lgkmcnt(0)
    v_pk_add_f32 v[40:41], v[40:41], v[42:43]
    v_pk_add_f32 v[44:45], v[44:45], v[46:47]
    v_pk_add_f32 v[8:9], v[40:41], v[44:45]
    v_mul_f32 v8, 0x3ae38e39, v8
    v_mul_f32 v9, 0x3ae38e39, v9
    v_fma_f32 v9, -v8, v8, v9
    v_max_f32 v9, 0, v9
    v_add_f32 v9, 0x3727c5ac, v9
    v_rsq_f32 v10, v9
    s_nop 0
    v_mul_f32 v12, v8, v10
    v_mov_b32 v11, v10
    v_sub_f32 v12, 0, v12
    v_mov_b32 v13, v12
    s_cmp_eq_u32 s3, 0
    s_cselect_b32 s7, 32, 0
    v_lshlrev_b32 v14, 2, v0
    v_cmp_gt_u32 vcc, s7, v0
    v_mov_b32 v9, 1073741824
    s_nop 0
    v_cndmask_b32 v14, v9, v14, vcc
    buffer_store_dword v8, v14, s[8:11], s22 offen sc1
    v_lshlrev_b32 v40, 16, v120
    v_and_b32 v41, s16, v120
    v_lshlrev_b32 v42, 16, v121
    v_and_b32 v43, s16, v121
    v_lshlrev_b32 v44, 16, v122
    v_and_b32 v45, s16, v122
    v_lshlrev_b32 v46, 16, v123
    v_and_b32 v47, s16, v123
    v_pk_fma_f32 v[40:41], v[40:41], v[10:11], v[12:13]
    v_pk_fma_f32 v[42:43], v[42:43], v[10:11], v[12:13]
    v_pk_fma_f32 v[44:45], v[44:45], v[10:11], v[12:13]
    v_pk_fma_f32 v[46:47], v[46:47], v[10:11], v[12:13]
    v_cvt_pk_bf16_f32 v48, v40, v41
    v_cvt_pk_bf16_f32 v49, v42, v43
    v_cvt_pk_bf16_f32 v50, v44, v45
    v_cvt_pk_bf16_f32 v51, v46, v47
    v_lshlrev_b32 v40, 16, v124
    v_and_b32 v41, s16, v124
    v_lshlrev_b32 v42, 16, v125
    v_and_b32 v43, s16, v125
    v_lshlrev_b32 v44, 16, v126
    v_and_b32 v45, s16, v126
    v_lshlrev_b32 v46, 16, v127
    v_and_b32 v47, s16, v127
    v_pk_fma_f32 v[40:41], v[40:41], v[10:11], v[12:13]
    v_pk_fma_f32 v[42:43], v[42:43], v[10:11], v[12:13]
    v_pk_fma_f32 v[44:45], v[44:45], v[10:11], v[12:13]
    v_pk_fma_f32 v[46:47], v[46:47], v[10:11], v[12:13]
    v_cvt_pk_bf16_f32 v52, v40, v41
    v_cvt_pk_bf16_f32 v53, v42, v43
    v_cvt_pk_bf16_f32 v54, v44, v45
    v_cvt_pk_bf16_f32 v55, v46, v47
    v_lshlrev_b32 v40, 16, v128
    v_and_b32 v41, s16, v128
    v_lshlrev_b32 v42, 16, v129
    v_and_b32 v43, s16, v129
    v_lshlrev_b32 v44, 16, v130
    v_and_b32 v45, s16, v130
    v_lshlrev_b32 v46, 16, v131
    v_and_b32 v47, s16, v131
    v_pk_fma_f32 v[40:41], v[40:41], v[10:11], v[12:13]
    v_pk_fma_f32 v[42:43], v[42:43], v[10:11], v[12:13]
    v_pk_fma_f32 v[44:45], v[44:45], v[10:11], v[12:13]
    v_pk_fma_f32 v[46:47], v[46:47], v[10:11], v[12:13]
    v_cvt_pk_bf16_f32 v56, v40, v41
    v_cvt_pk_bf16_f32 v57, v42, v43
    v_cvt_pk_bf16_f32 v58, v44, v45
    v_cvt_pk_bf16_f32 v59, v46, v47
    buffer_store_dwordx4 v[48:51], v172, s[8:11], s20 offen sc1
    buffer_store_dwordx4 v[52:55], v173, s[8:11], s20 offen sc1
    buffer_store_dwordx4 v[56:59], v174, s[8:11], s20 offen sc1
    v_lshlrev_b32 v15, 7, v0
    s_lshl_b32 s6, s40, 2
    s_add_u32 s6, s6, s44
    s_add_u32 s6, s6, 98304
    v_mov_b32 v1, s76
    s_mov_b64 vcc, 0xff
    v_lshrrev_b32 v14, 3, v0
    v_lshl_add_u32 v15, v14, 3, v15
    s_cmp_ge_u32 s40, 6
    s_cselect_b32 s7, s41, 31
    s_cmp_lt_u32 s7, 31
    s_cmov_b64 vcc, 0xffff
    s_waitcnt vmcnt(0)
    s_barrier
    s_cmp_lg_u32 s3, 0
    s_cbranch_scc1 L_pub_45
    s_mov_b64 exec, vcc
    buffer_store_dword v1, v15, s[8:11], s6 offen sc1
L_pub_45:
    s_mov_b64 exec, -1
    s_mov_b32 s42, 1
    s_mov_b32 s43, 9699328
    s_add_u32 s44, s44, 131072
    s_branch L_main_layer
L_main_last:
    buffer_store_dwordx4 v[120:123], v175, s[12:15], s18 offen
    buffer_store_dwordx4 v[124:127], v176, s[12:15], s18 offen
    buffer_store_dwordx4 v[128:131], v177, s[12:15], s18 offen
    s_or_b32 s7, s40, s41
    s_or_b32 s7, s7, s3
    s_cbranch_scc1 L_done_46
    v_mov_b32 v1, s76
    s_mov_b32 s7, 19660800
    s_mov_b64 exec, 1
    buffer_store_dword v1, off, s[8:11], s7 sc1
    s_mov_b64 exec, -1
L_done_46:
L_main_end:
    s_endpgm
L_main_code_end:
.section .rodata,"a"
.p2align 6
.amdhsa_kernel interleave_layers__sliding_local_dilated__glu_gated_geglu__prompt_kernel
.amdhsa_next_free_vgpr 512
.amdhsa_next_free_sgpr 102
.amdhsa_accum_offset 256
.amdhsa_group_segment_fixed_size 0
.amdhsa_kernarg_size 80
.amdhsa_user_sgpr_count 2
.amdhsa_user_sgpr_kernarg_segment_ptr 1
.amdhsa_system_sgpr_workgroup_id_x 1
.amdhsa_float_denorm_mode_32 3
.amdhsa_float_denorm_mode_16_64 3
.end_amdhsa_kernel
```

```asm
; @launch grid=(256,1,1) block=(256,1,1) lds=163840
.amdgcn_target "amdgcn-amd-amdhsa--gfx950"
.text
.globl interleave_layers__sliding_local_dilated__glu_gated_geglu__prompt_kernel
.p2align 8
.type interleave_layers__sliding_local_dilated__glu_gated_geglu__prompt_kernel,@function
interleave_layers__sliding_local_dilated__glu_gated_geglu__prompt_kernel:
    s_cmp_ge_u32 s2, 256
    s_cbranch_scc1 L_main_end
    s_load_dwordx2 s[4:5], s[0:1], 72
    s_load_dwordx4 s[16:19], s[0:1], 0
    s_load_dwordx2 s[22:23], s[0:1], 16
    s_load_dwordx8 s[24:31], s[0:1], 32
    v_lshrrev_b32 v1, 6, v0
    v_and_b32 v0, 63, v0
    v_readfirstlane_b32 s3, v1
    s_waitcnt lgkmcnt(0)
    s_mov_b32 s8, s4
    s_and_b32 s9, s5, 0xffff
    s_mov_b32 s10, 268435456
    s_mov_b32 s11, 0x20000
    s_mov_b32 s7, 19660800
    s_load_dword s76, s[4:5], s7
    s_mov_b64 s[20:21], s[18:19]
    s_mov_b64 s[18:19], s[16:17]
    s_mov_b32 s48, s4
    s_and_b32 s49, s5, 0xffff
    s_mov_b32 s50, 268435456
    s_mov_b32 s51, 0x20000
    s_and_b32 s40, s2, 1
    s_lshl_b32 s40, s40, 2
    s_bfe_u32 s7, s2, 131075
    s_add_u32 s40, s40, s7
    s_bfe_u32 s41, s2, 131073
    s_lshl_b32 s41, s41, 3
    s_lshr_b32 s7, s2, 5
    s_add_u32 s41, s41, s7
    s_mov_b32 s42, 0
    s_mov_b32 s43, 0
    s_lshl_b32 s44, s41, 10
    s_add_u32 s44, s44, 19169280
    v_lshlrev_b32 v253, 4, v0
    s_getpc_b64 s[96:97]
L_main_pc:
    s_sub_u32 s96, s96, L_main_pc-interleave_layers__sliding_local_dilated__glu_gated_geglu__prompt_kernel
    s_subb_u32 s97, s97, 0
    s_and_b32 s97, s97, 0xffff
    s_mov_b32 s98, L_main_code_end-interleave_layers__sliding_local_dilated__glu_gated_geglu__prompt_kernel
    s_mov_b32 s99, 0x20000
    s_lshr_b32 s7, s2, 3
    s_lshl_b32 s7, s7, 2
    s_add_u32 s7, s7, s3
    s_lshl_b32 s7, s7, 9
    v_lshrrev_b32 v1, 1, v253
    v_add_u32 v1, s7, v1
    buffer_load_dwordx2 v[2:3], v1, s[96:99], 0 offen
    s_mov_b32 s12, s18
    s_and_b32 s13, s19, 0xffff
    s_mov_b32 s14, 2359296
    s_mov_b32 s15, 0x20000
    s_mov_b32 s64, s20
    s_and_b32 s65, s21, 0xffff
    s_mov_b32 s66, 1990656
    s_mov_b32 s67, 0x20000
    s_mov_b32 s68, s22
    s_and_b32 s69, s23, 0xffff
    s_mov_b32 s70, 663552
    s_mov_b32 s71, 0x20000
    s_mov_b32 s16, 0xffff0000
    s_lshl_b32 s7, s3, 10
    v_add_u32 v172, s7, v253
    v_add_u32 v174, 5120, v172
    v_and_b32 v178, 7, v0
    v_mul_u32_u24 v178, 1152, v178
    v_lshrrev_b32 v179, 3, v0
    v_lshl_add_u32 v178, v179, 4, v178
    s_lshl_b32 s7, s3, 7
    v_add_u32 v175, s7, v178
    v_add_u32 v177, 640, v175
    s_cmp_eq_u32 s3, 0
    s_mov_b32 s17, 1073741824
    s_cmov_b32 s17, 4096
    v_add_u32 v173, s17, v172
    s_mov_b32 s17, 1073741824
    s_cmov_b32 s17, 512
    v_add_u32 v176, s17, v175
    s_lshl_b32 s21, s41, 3
    s_add_u32 s21, s21, s40
    s_mul_i32 s18, s21, 9216
    buffer_load_dwordx4 v[16:19], v175, s[12:15], s18 offen
    buffer_load_dwordx4 v[20:23], v176, s[12:15], s18 offen
    buffer_load_dwordx4 v[24:27], v177, s[12:15], s18 offen
    s_mov_b32 s12, s30
    s_and_b32 s13, s31, 0xffff
    s_mov_b32 s14, 2359296
    s_mov_b32 s15, 0x20000
    s_lshl_b32 s79, s3, 14
    s_add_u32 s79, s79, 98304
    s_sub_u32 s36, s21, 144
    s_cmp_ge_u32 s41, 18
    s_cbranch_scc1 L_prep_o_1
    s_mul_i32 s35, s41, 110592
    s_mul_i32 s7, s40, 144
    s_and_b32 s46, s7, 127
    s_sub_u32 s7, s7, s46
    s_add_u32 s35, s35, s7
    s_mul_i32 s7, s3, 13824
    s_add_u32 s35, s35, s7
    v_lshrrev_b32 v8, 4, v0
    v_mul_u32_u24 v8, 3456, v8
    v_and_b32 v9, 15, v0
    v_lshl_add_u32 v8, v9, 4, v8
    s_lshl_b32 s34, s3, 10
    s_add_u32 m0, s34, 8192
    s_add_u32 s7, s35, 0
    buffer_load_dwordx4 v8, s[64:67], s7 offen lds
    s_add_u32 m0, s34, 12288
    s_add_u32 s7, s35, 55296
    buffer_load_dwordx4 v8, s[64:67], s7 offen lds
    s_add_u32 m0, s34, 16384
    s_add_u32 s7, s35, 1152
    buffer_load_dwordx4 v8, s[64:67], s7 offen lds
    s_add_u32 m0, s34, 20480
    s_add_u32 s7, s35, 56448
    buffer_load_dwordx4 v8, s[64:67], s7 offen lds
    s_add_u32 m0, s34, 24576
    s_add_u32 s7, s35, 2304
    buffer_load_dwordx4 v8, s[64:67], s7 offen lds
    s_add_u32 m0, s34, 28672
    s_add_u32 s7, s35, 57600
    buffer_load_dwordx4 v8, s[64:67], s7 offen lds
    s_branch L_prep_go_3
L_prep_o_1:
    s_cmp_ge_u32 s36, 54
    s_cbranch_scc1 L_prep_m_2
    s_mul_i32 s33, s36, 349526
    s_lshr_b32 s33, s33, 20
    s_mul_i32 s34, s33, 3
    s_sub_u32 s34, s36, s34
    s_lshl_b32 s7, s33, 2
    s_add_u32 s7, s7, s3
    v_mov_b32 v8, s7
    v_lshrrev_b32 v9, 3, v0
    v_mul_u32_u24 v11, 7282, v8
    v_lshrrev_b32 v11, 16, v11
    v_mul_u32_u24 v12, 9, v11
    v_sub_u32 v12, v8, v12
    v_mul_u32_u24 v11, 72, v11
    v_cmp_eq_u32 vcc, 8, v12
    v_lshrrev_b32 v10, 1, v12
    v_mad_u32_u24 v10, v10, 18, v11
    v_and_b32 v12, 1, v12
    v_lshl_add_u32 v10, v12, 3, v10
    v_add_u32 v10, v10, v9
    v_lshrrev_b32 v12, 1, v9
    v_mad_u32_u24 v11, v12, 18, v11
    v_and_b32 v12, 1, v9
    v_add3_u32 v11, v11, v12, 16
    v_cndmask_b32 v10, v10, v11, vcc
    v_mul_u32_u24 v10, 1152, v10
    v_and_b32 v9, 7, v0
    v_lshl_add_u32 v10, v9, 4, v10
    s_mul_i32 s35, s34, 384
    s_lshl_b32 s6, s3, 10
    s_add_u32 m0, s6, 8192
    s_add_u32 s7, s35, 0
    buffer_load_dwordx4 v10, s[68:71], s7 offen lds
    s_add_u32 m0, s6, 12288
    s_add_u32 s7, s35, 128
    buffer_load_dwordx4 v10, s[68:71], s7 offen lds
    s_add_u32 m0, s6, 16384
    s_add_u32 s7, s35, 256
    buffer_load_dwordx4 v10, s[68:71], s7 offen lds
    s_branch L_prep_go_3
L_prep_m_2:
    s_sub_u32 s37, s36, 54
    s_lshl_b32 s7, s3, 6
    s_add_u32 s37, s37, s7
    s_cmp_ge_u32 s37, 36
    s_cbranch_scc1 L_prep_go_3
    s_lshl_b32 s7, s37, 1
    v_bfe_u32 v8, v0, 3, 1
    v_add_u32 v8, s7, v8
    v_and_b32 v9, 7, v0
    v_mul_u32_u24 v11, 7282, v8
    v_lshrrev_b32 v11, 16, v11
    v_mul_u32_u24 v12, 9, v11
    v_sub_u32 v12, v8, v12
    v_mul_u32_u24 v11, 72, v11
    v_cmp_eq_u32 vcc, 8, v12
    v_lshrrev_b32 v10, 1, v12
    v_mad_u32_u24 v10, v10, 18, v11
    v_and_b32 v12, 1, v12
    v_lshl_add_u32 v10, v12, 3, v10
    v_add_u32 v10, v10, v9
    v_lshrrev_b32 v12, 1, v9
    v_mad_u32_u24 v11, v12, 18, v11
    v_and_b32 v12, 1, v9
    v_add3_u32 v11, v11, v12, 16
    v_cndmask_b32 v10, v10, v11, vcc
    v_mul_u32_u24 v10, 1152, v10
    v_lshrrev_b32 v9, 4, v0
    v_lshl_add_u32 v10, v9, 4, v10
    buffer_load_dwordx4 v[64:67], v10, s[68:71], 0 offen offset:0
    buffer_load_dwordx4 v[68:71], v10, s[68:71], 0 offen offset:64
    buffer_load_dwordx4 v[72:75], v10, s[68:71], 0 offen offset:128
    buffer_load_dwordx4 v[76:79], v10, s[68:71], 0 offen offset:192
    buffer_load_dwordx4 v[80:83], v10, s[68:71], 0 offen offset:256
    buffer_load_dwordx4 v[84:87], v10, s[68:71], 0 offen offset:320
    buffer_load_dwordx4 v[88:91], v10, s[68:71], 0 offen offset:384
    buffer_load_dwordx4 v[92:95], v10, s[68:71], 0 offen offset:448
    buffer_load_dwordx4 v[96:99], v10, s[68:71], 0 offen offset:512
    buffer_load_dwordx4 v[100:103], v10, s[68:71], 0 offen offset:576
    buffer_load_dwordx4 v[104:107], v10, s[68:71], 0 offen offset:640
    buffer_load_dwordx4 v[108:111], v10, s[68:71], 0 offen offset:704
    buffer_load_dwordx4 v[112:115], v10, s[68:71], 0 offen offset:768
    buffer_load_dwordx4 v[116:119], v10, s[68:71], 0 offen offset:832
    buffer_load_dwordx4 v[120:123], v10, s[68:71], 0 offen offset:896
    buffer_load_dwordx4 v[124:127], v10, s[68:71], 0 offen offset:960
    buffer_load_dwordx4 v[128:131], v10, s[68:71], 0 offen offset:1024
    buffer_load_dwordx4 v[132:135], v10, s[68:71], 0 offen offset:1088
L_prep_go_3:
    s_lshl_b32 s7, s41, 2
    s_add_u32 s7, s7, s3
    s_mul_i32 s93, s7, 25576
    s_lshr_b32 s93, s93, 20
    s_min_u32 s93, s93, 2
    s_mul_i32 s6, s93, 41
    s_sub_u32 s7, s7, s6
    s_lshl_b32 s17, s7, 2
    s_cmp_eq_u32 s93, 1
    s_cselect_b32 s72, s26, s24
    s_cselect_b32 s73, s27, s25
    s_cmp_eq_u32 s93, 2
    s_cselect_b32 s72, s28, s72
    s_cselect_b32 s73, s29, s73
    s_mov_b32 s92, 73728
    s_cmov_b32 s92, 9216
    s_mov_b32 s47, 1152
    s_cmov_b32 s47, 663552
    s_and_b32 s73, s73, 0xffff
    s_mov_b32 s74, 5308416
    s_mov_b32 s75, 0x20000
    s_mul_i32 s47, s47, s40
    s_add_u32 s7, s17, 0
    s_min_u32 s7, s7, 161
    s_mul_i32 s84, s7, 116509
    s_lshr_b32 s84, s84, 20
    s_mul_i32 s88, s84, 9
    s_sub_u32 s88, s7, s88
    s_mul_i32 s7, s84, s92
    s_lshl_b32 s7, s7, 2
    s_add_u32 s7, s7, s47
    s_lshl_b32 s6, s88, 7
    s_add_u32 s80, s7, s6
    s_add_u32 s7, s17, 1
    s_min_u32 s7, s7, 161
    s_mul_i32 s85, s7, 116509
    s_lshr_b32 s85, s85, 20
    s_mul_i32 s89, s85, 9
    s_sub_u32 s89, s7, s89
    s_mul_i32 s7, s85, s92
    s_lshl_b32 s7, s7, 2
    s_add_u32 s7, s7, s47
    s_lshl_b32 s6, s89, 7
    s_add_u32 s81, s7, s6
    s_add_u32 s7, s17, 2
    s_min_u32 s7, s7, 161
    s_mul_i32 s86, s7, 116509
    s_lshr_b32 s86, s86, 20
    s_mul_i32 s90, s86, 9
    s_sub_u32 s90, s7, s90
    s_mul_i32 s7, s86, s92
    s_lshl_b32 s7, s7, 2
    s_add_u32 s7, s7, s47
    s_lshl_b32 s6, s90, 7
    s_add_u32 s82, s7, s6
    s_add_u32 s7, s17, 3
    s_min_u32 s7, s7, 161
    s_mul_i32 s87, s7, 116509
    s_lshr_b32 s87, s87, 20
    s_mul_i32 s91, s87, 9
    s_sub_u32 s91, s7, s91
    s_mul_i32 s7, s87, s92
    s_lshl_b32 s7, s7, 2
    s_add_u32 s7, s7, s47
    s_lshl_b32 s6, s91, 7
    s_add_u32 s83, s7, s6
    s_lshr_b32 s7, s92, 3
    v_lshrrev_b32 v224, 3, v0
    v_mul_lo_u32 v224, v224, s7
    v_and_b32 v8, 7, v0
    v_lshl_add_u32 v224, v8, 4, v224
    s_waitcnt lgkmcnt(0)
    s_mul_i32 s76, s76, 0x9e3779b1
    s_add_u32 s76, s76, 0x7f4a7c15
    s_mov_b32 s77, s76
    s_add_u32 m0, s79, 0
    s_mov_b32 s71, s80
    buffer_load_dwordx4 v224, s[72:75], s71 offen nt lds
    s_add_u32 m0, s79, 1024
    s_add_u32 s71, s71, s92
    buffer_load_dwordx4 v224, s[72:75], s71 offen nt lds
    s_add_u32 m0, s79, 2048
    s_add_u32 s71, s71, s92
    buffer_load_dwordx4 v224, s[72:75], s71 offen nt lds
    s_waitcnt vmcnt(3)
    s_barrier
    s_cmp_ge_u32 s41, 18
    s_cbranch_scc1 L_prep_o_4
    s_mul_i32 s7, s3, 36
    s_add_u32 s7, s7, s46
    v_lshrrev_b32 v8, 4, v0
    v_lshlrev_b32 v8, 11, v8
    v_add_u32 v8, s7, v8
    v_and_b32 v9, 15, v0
    v_cmp_gt_u32 s[22:23], 6, v9
    v_lshrrev_b32 v10, 1, v9
    v_min_u32 v10, 2, v10
    v_lshl_add_u32 v10, v10, 13, v8
    v_and_b32 v11, 1, v0
    v_lshl_add_u32 v10, v11, 1, v10
    v_lshl_add_u32 v8, v9, 1, v8
    ds_read_u16 v136, v8 offset:8192
    ds_read_u16 v137, v8 offset:8448
    ds_read_u16 v138, v8 offset:8704
    ds_read_u16 v139, v8 offset:8960
    ds_read_u16 v140, v8 offset:9216
    ds_read_u16 v141, v8 offset:9472
    ds_read_u16 v142, v8 offset:9728
    ds_read_u16 v143, v8 offset:9984
    s_lshl_b32 s33, s40, 2
    s_add_u32 s33, s33, s3
    s_mul_i32 s33, s33, 18
    s_add_u32 s33, s33, s41
    s_lshl_b32 s33, s33, 12
    ds_read_u16 v144, v8 offset:16384
    ds_read_u16 v145, v8 offset:16640
    ds_read_u16 v146, v8 offset:16896
    ds_read_u16 v147, v8 offset:17152
    ds_read_u16 v148, v8 offset:17408
    ds_read_u16 v149, v8 offset:17664
    ds_read_u16 v150, v8 offset:17920
    ds_read_u16 v151, v8 offset:18176
    s_waitcnt lgkmcnt(8)
    v_lshl_or_b32 v32, v137, 16, v136
    v_lshl_or_b32 v33, v139, 16, v138
    v_lshl_or_b32 v34, v141, 16, v140
    v_lshl_or_b32 v35, v143, 16, v142
    buffer_store_dwordx4 v[32:35], v253, s[8:11], s33 offen offset:0 sc1
    ds_read_u16 v152, v8 offset:24576
    ds_read_u16 v153, v8 offset:24832
    ds_read_u16 v154, v8 offset:25088
    ds_read_u16 v155, v8 offset:25344
    ds_read_u16 v156, v8 offset:25600
    ds_read_u16 v157, v8 offset:25856
    ds_read_u16 v158, v8 offset:26112
    ds_read_u16 v159, v8 offset:26368
    s_waitcnt lgkmcnt(8)
    v_lshl_or_b32 v36, v145, 16, v144
    v_lshl_or_b32 v37, v147, 16, v146
    v_lshl_or_b32 v38, v149, 16, v148
    v_lshl_or_b32 v39, v151, 16, v150
    buffer_store_dwordx4 v[36:39], v253, s[8:11], s33 offen offset:1024 sc1
    ds_read_u16 v160, v10 offset:8224
    ds_read_u16 v161, v10 offset:8480
    ds_read_u16 v162, v10 offset:8736
    ds_read_u16 v163, v10 offset:8992
    ds_read_u16 v164, v10 offset:9248
    ds_read_u16 v165, v10 offset:9504
    ds_read_u16 v166, v10 offset:9760
    ds_read_u16 v167, v10 offset:10016
    s_waitcnt lgkmcnt(8)
    v_lshl_or_b32 v40, v153, 16, v152
    v_lshl_or_b32 v41, v155, 16, v154
    v_lshl_or_b32 v42, v157, 16, v156
    v_lshl_or_b32 v43, v159, 16, v158
    buffer_store_dwordx4 v[40:43], v253, s[8:11], s33 offen offset:2048 sc1
    s_waitcnt lgkmcnt(0)
    v_lshl_or_b32 v44, v161, 16, v160
    v_cndmask_b32 v44, 0, v44, s[22:23]
    v_lshl_or_b32 v45, v163, 16, v162
    v_cndmask_b32 v45, 0, v45, s[22:23]
    v_lshl_or_b32 v46, v165, 16, v164
    v_cndmask_b32 v46, 0, v46, s[22:23]
    v_lshl_or_b32 v47, v167, 16, v166
    v_cndmask_b32 v47, 0, v47, s[22:23]
    buffer_store_dwordx4 v[44:47], v253, s[8:11], s33 offen offset:3072 sc1
    s_branch L_prep_done_6
L_prep_o_4:
    s_cmp_ge_u32 s36, 54
    s_cbranch_scc1 L_prep_m_5
    v_lshrrev_b32 v8, 4, v0
    v_lshlrev_b32 v8, 3, v8
    v_bfe_u32 v9, v0, 2, 2
    v_add_u32 v8, v8, v9
    v_mul_u32_u24 v8, 128, v8
    v_and_b32 v9, 3, v0
    v_lshl_add_u32 v8, v9, 3, v8
    s_lshl_b32 s7, s3, 5
    v_add_u32 v8, s7, v8
    ds_read_b64_tr_b16 v[32:33], v8 offset:8192
    ds_read_b64_tr_b16 v[34:35], v8 offset:8704
    ds_read_b64_tr_b16 v[36:37], v8 offset:12288
    ds_read_b64_tr_b16 v[38:39], v8 offset:12800
    ds_read_b64_tr_b16 v[40:41], v8 offset:16384
    ds_read_b64_tr_b16 v[42:43], v8 offset:16896
    s_mul_i32 s34, s34, 12
    s_add_u32 s34, s34, s3
    s_mul_i32 s34, s34, 18
    s_add_u32 s34, s34, s33
    s_lshl_b32 s34, s34, 10
    s_add_u32 s7, s34, 2359296
    s_waitcnt lgkmcnt(4)
    buffer_store_dwordx4 v[32:35], v253, s[8:11], s7 offen sc1
    s_add_u32 s7, s34, 2433024
    s_waitcnt lgkmcnt(2)
    buffer_store_dwordx4 v[36:39], v253, s[8:11], s7 offen sc1
    s_add_u32 s7, s34, 2506752
    s_waitcnt lgkmcnt(0)
    buffer_store_dwordx4 v[40:43], v253, s[8:11], s7 offen sc1
    s_branch L_prep_done_6
L_prep_m_5:
    s_cmp_ge_u32 s37, 36
    s_cbranch_scc1 L_prep_done_6
    v_mov_b32 v28, 0x3f803f80
    v_mov_b32 v29, 0x3f803f80
    v_mov_b32 v30, 0x3f803f80
    v_mov_b32 v31, 0x3f803f80
    v_and_b32 v9, 15, v0
    v_cmp_eq_u32 vcc, 0, v9
    v_cmp_eq_u32 s[22:23], 1, v9
    v_mfma_f32_16x16x32_bf16 v[32:35], v[64:67], v[28:31], 0
    v_mfma_f32_16x16x32_bf16 v[32:35], v[68:71], v[28:31], v[32:35]
    v_mfma_f32_16x16x32_bf16 v[32:35], v[72:75], v[28:31], v[32:35]
    v_mfma_f32_16x16x32_bf16 v[32:35], v[76:79], v[28:31], v[32:35]
    v_mfma_f32_16x16x32_bf16 v[32:35], v[80:83], v[28:31], v[32:35]
    v_mfma_f32_16x16x32_bf16 v[32:35], v[84:87], v[28:31], v[32:35]
    v_mfma_f32_16x16x32_bf16 v[32:35], v[88:91], v[28:31], v[32:35]
    v_mfma_f32_16x16x32_bf16 v[32:35], v[92:95], v[28:31], v[32:35]
    v_mfma_f32_16x16x32_bf16 v[32:35], v[96:99], v[28:31], v[32:35]
    v_mfma_f32_16x16x32_bf16 v[32:35], v[100:103], v[28:31], v[32:35]
    v_mfma_f32_16x16x32_bf16 v[32:35], v[104:107], v[28:31], v[32:35]
    v_mfma_f32_16x16x32_bf16 v[32:35], v[108:111], v[28:31], v[32:35]
    v_mfma_f32_16x16x32_bf16 v[32:35], v[112:115], v[28:31], v[32:35]
    v_mfma_f32_16x16x32_bf16 v[32:35], v[116:119], v[28:31], v[32:35]
    v_mfma_f32_16x16x32_bf16 v[32:35], v[120:123], v[28:31], v[32:35]
    v_mfma_f32_16x16x32_bf16 v[32:35], v[124:127], v[28:31], v[32:35]
    v_mfma_f32_16x16x32_bf16 v[32:35], v[128:131], v[28:31], v[32:35]
    v_mfma_f32_16x16x32_bf16 v[32:35], v[132:135], v[28:31], v[32:35]
    v_lshrrev_b32 v10, 5, v0
    v_lshlrev_b32 v10, 8, v10
    v_lshl_add_u32 v10, v9, 4, v10
    v_bfe_u32 v9, v0, 4, 1
    v_lshl_add_u32 v10, v9, 3, v10
    s_lshl_b32 s7, s37, 9
    s_add_u32 s7, s7, 3022848
    s_nop 0
    v_mul_f32 v32, 0x3ae38e39, v32
    v_mul_f32 v33, 0x3ae38e39, v33
    v_mul_f32 v34, 0x3ae38e39, v34
    v_mul_f32 v35, 0x3ae38e39, v35
    v_cvt_pk_bf16_f32 v36, v32, v33
    v_cvt_pk_bf16_f32 v37, v34, v35
    v_lshlrev_b32 v38, 16, v36
    v_and_b32 v39, s16, v36
    v_sub_f32 v38, v32, v38
    v_sub_f32 v39, v33, v39
    v_cvt_pk_bf16_f32 v28, v38, v39
    v_cndmask_b32 v28, 0, v28, s[22:23]
    v_cndmask_b32 v28, v28, v36, vcc
    v_lshlrev_b32 v38, 16, v37
    v_and_b32 v39, s16, v37
    v_sub_f32 v38, v34, v38
    v_sub_f32 v39, v35, v39
    v_cvt_pk_bf16_f32 v29, v38, v39
    v_cndmask_b32 v29, 0, v29, s[22:23]
    v_cndmask_b32 v29, v29, v37, vcc
    buffer_store_dwordx2 v[28:29], v10, s[8:11], s7 offen sc1
L_prep_done_6:
    s_add_u32 s19, s18, 43515904
    s_add_u32 s20, s18, 38797312
    s_lshl_b32 s22, s21, 7
    s_add_u32 s22, s22, 48234496
    buffer_store_dwordx4 v[16:19], v172, s[8:11], s19 offen sc1
    buffer_store_dwordx4 v[20:23], v173, s[8:11], s19 offen sc1
    buffer_store_dwordx4 v[24:27], v174, s[8:11], s19 offen sc1
    s_mov_b32 s17, 0x3f803f80
    v_mov_b32 v8, 0
    v_mov_b32 v9, 0
    v_mov_b32 v10, 0
    v_mov_b32 v11, 0
    v_dot2c_f32_bf16 v8, s17, v16
    v_dot2c_f32_bf16 v9, v16, v16
    v_dot2c_f32_bf16 v10, s17, v17
    v_dot2c_f32_bf16 v11, v17, v17
    v_dot2c_f32_bf16 v8, s17, v18
    v_dot2c_f32_bf16 v9, v18, v18
    v_dot2c_f32_bf16 v10, s17, v19
    v_dot2c_f32_bf16 v11, v19, v19
    v_dot2c_f32_bf16 v8, s17, v20
    v_dot2c_f32_bf16 v9, v20, v20
    v_dot2c_f32_bf16 v10, s17, v21
    v_dot2c_f32_bf16 v11, v21, v21
    v_dot2c_f32_bf16 v8, s17, v22
    v_dot2c_f32_bf16 v9, v22, v22
    v_dot2c_f32_bf16 v10, s17, v23
    v_dot2c_f32_bf16 v11, v23, v23
    v_dot2c_f32_bf16 v8, s17, v24
    v_dot2c_f32_bf16 v9, v24, v24
    v_dot2c_f32_bf16 v10, s17, v25
    v_dot2c_f32_bf16 v11, v25, v25
    v_dot2c_f32_bf16 v8, s17, v26
    v_dot2c_f32_bf16 v9, v26, v26
    v_dot2c_f32_bf16 v10, s17, v27
    v_dot2c_f32_bf16 v11, v27, v27
    v_and_b32 v12, 7, v0
    v_lshlrev_b32 v12, 3, v12
    s_lshl_b32 s7, s3, 6
    v_add_u32 v13, s7, v12
    v_pk_add_f32 v[8:9], v[8:9], v[10:11]
    s_nop 1
    v_add_f32_dpp v8, v8, v8 row_ror:8 row_mask:0xf bank_mask:0xf
    v_add_f32_dpp v9, v9, v9 row_ror:8 row_mask:0xf bank_mask:0xf
    v_mov_b32 v10, v8
    v_mov_b32 v11, v9
    s_nop 1
    v_permlane32_swap_b32 v10, v8
    v_permlane32_swap_b32 v11, v9
    v_add_f32 v8, v8, v10
    v_add_f32 v9, v9, v11
    v_mov_b32 v10, v8
    v_mov_b32 v11, v9
    s_nop 1
    v_permlane16_swap_b32 v10, v8
    v_permlane16_swap_b32 v11, v9
    v_add_f32 v8, v8, v10
    v_add_f32 v9, v9, v11
    ds_write_b64 v13, v[8:9]
    s_waitcnt lgkmcnt(0)
    s_barrier
    ds_read_b64 v[40:41], v12 offset:0
    ds_read_b64 v[42:43], v12 offset:64
    ds_read_b64 v[44:45], v12 offset:128
    ds_read_b64 v[46:47], v12 offset:192
    s_waitcnt lgkmcnt(0)
    v_pk_add_f32 v[40:41], v[40:41], v[42:43]
    v_pk_add_f32 v[44:45], v[44:45], v[46:47]
    v_pk_add_f32 v[8:9], v[40:41], v[44:45]
    v_mul_f32 v8, 0x3ae38e39, v8
    v_mul_f32 v9, 0x3ae38e39, v9
    v_fma_f32 v9, -v8, v8, v9
    v_max_f32 v9, 0, v9
    v_add_f32 v9, 0x3727c5ac, v9
    v_rsq_f32 v10, v9
    s_nop 0
    v_mul_f32 v12, v8, v10
    v_mov_b32 v11, v10
    v_sub_f32 v12, 0, v12
    v_mov_b32 v13, v12
    s_cmp_eq_u32 s3, 0
    s_cselect_b32 s7, 32, 0
    v_lshlrev_b32 v14, 2, v0
    v_cmp_gt_u32 vcc, s7, v0
    v_mov_b32 v9, 1073741824
    s_nop 0
    v_cndmask_b32 v14, v9, v14, vcc
    buffer_store_dword v8, v14, s[8:11], s22 offen sc1
    v_lshlrev_b32 v40, 16, v16
    v_and_b32 v41, s16, v16
    v_lshlrev_b32 v42, 16, v17
    v_and_b32 v43, s16, v17
    v_lshlrev_b32 v44, 16, v18
    v_and_b32 v45, s16, v18
    v_lshlrev_b32 v46, 16, v19
    v_and_b32 v47, s16, v19
    v_pk_fma_f32 v[40:41], v[40:41], v[10:11], v[12:13]
    v_pk_fma_f32 v[42:43], v[42:43], v[10:11], v[12:13]
    v_pk_fma_f32 v[44:45], v[44:45], v[10:11], v[12:13]
    v_pk_fma_f32 v[46:47], v[46:47], v[10:11], v[12:13]
    v_cvt_pk_bf16_f32 v48, v40, v41
    v_cvt_pk_bf16_f32 v49, v42, v43
    v_cvt_pk_bf16_f32 v50, v44, v45
    v_cvt_pk_bf16_f32 v51, v46, v47
    v_lshlrev_b32 v40, 16, v20
    v_and_b32 v41, s16, v20
    v_lshlrev_b32 v42, 16, v21
    v_and_b32 v43, s16, v21
    v_lshlrev_b32 v44, 16, v22
    v_and_b32 v45, s16, v22
    v_lshlrev_b32 v46, 16, v23
    v_and_b32 v47, s16, v23
    v_pk_fma_f32 v[40:41], v[40:41], v[10:11], v[12:13]
    v_pk_fma_f32 v[42:43], v[42:43], v[10:11], v[12:13]
    v_pk_fma_f32 v[44:45], v[44:45], v[10:11], v[12:13]
    v_pk_fma_f32 v[46:47], v[46:47], v[10:11], v[12:13]
    v_cvt_pk_bf16_f32 v52, v40, v41
    v_cvt_pk_bf16_f32 v53, v42, v43
    v_cvt_pk_bf16_f32 v54, v44, v45
    v_cvt_pk_bf16_f32 v55, v46, v47
    v_lshlrev_b32 v40, 16, v24
    v_and_b32 v41, s16, v24
    v_lshlrev_b32 v42, 16, v25
    v_and_b32 v43, s16, v25
    v_lshlrev_b32 v44, 16, v26
    v_and_b32 v45, s16, v26
    v_lshlrev_b32 v46, 16, v27
    v_and_b32 v47, s16, v27
    v_pk_fma_f32 v[40:41], v[40:41], v[10:11], v[12:13]
    v_pk_fma_f32 v[42:43], v[42:43], v[10:11], v[12:13]
    v_pk_fma_f32 v[44:45], v[44:45], v[10:11], v[12:13]
    v_pk_fma_f32 v[46:47], v[46:47], v[10:11], v[12:13]
    v_cvt_pk_bf16_f32 v56, v40, v41
    v_cvt_pk_bf16_f32 v57, v42, v43
    v_cvt_pk_bf16_f32 v58, v44, v45
    v_cvt_pk_bf16_f32 v59, v46, v47
    buffer_store_dwordx4 v[48:51], v172, s[8:11], s20 offen sc1
    buffer_store_dwordx4 v[52:55], v173, s[8:11], s20 offen sc1
    buffer_store_dwordx4 v[56:59], v174, s[8:11], s20 offen sc1
    v_lshlrev_b32 v15, 7, v0
    s_lshl_b32 s6, s40, 2
    s_add_u32 s6, s6, s44
    s_sub_u32 s6, s6, 32768
    v_mov_b32 v1, s76
    s_mov_b64 vcc, 0xff
    v_lshrrev_b32 v14, 3, v0
    v_lshl_add_u32 v15, v14, 3, v15
    s_cmp_ge_u32 s40, 6
    s_cselect_b32 s7, s41, 31
    s_cmp_lt_u32 s7, 31
    s_cmov_b64 vcc, 0xffff
    s_waitcnt vmcnt(0)
    s_barrier
    s_cmp_lg_u32 s3, 0
    s_cbranch_scc1 L_pub_7
    s_mov_b64 exec, vcc
    buffer_store_dword v1, v15, s[8:11], s6 offen sc1
    v_lshlrev_b32 v15, 10, v0
    s_lshl_b32 s6, s40, 7
    s_lshl_b32 s7, s41, 2
    s_add_u32 s6, s6, s7
    s_add_u32 s6, s6, 19431424
    s_mov_b64 exec, 0xffffffff
    v_lshlrev_b32 v15, 10, v0
    v_mov_b32 v1, s76
    buffer_store_dword v1, v15, s[8:11], s6 offen sc1
    s_cmp_lt_u32 s41, 18
    s_cbranch_scc1 L_pub_7
    s_lshl_b32 s6, s36, 2
    s_add_u32 s6, s6, 19496960
    s_mov_b64 exec, 1
    buffer_store_dword v1, off, s[8:11], s6 sc1
L_pub_7:
    s_mov_b64 exec, -1
    s_add_u32 m0, s79, 3072
    s_add_u32 s71, s71, s92
    buffer_load_dwordx4 v224, s[72:75], s71 offen nt lds
    s_add_u32 m0, s79, 4096
    s_mov_b32 s71, s81
    buffer_load_dwordx4 v224, s[72:75], s71 offen nt lds
    s_add_u32 m0, s79, 5120
    s_add_u32 s71, s71, s92
    buffer_load_dwordx4 v224, s[72:75], s71 offen nt lds
    s_add_u32 m0, s79, 6144
    s_add_u32 s71, s71, s92
    buffer_load_dwordx4 v224, s[72:75], s71 offen nt lds
    s_add_u32 m0, s79, 7168
    s_add_u32 s71, s71, s92
    buffer_load_dwordx4 v224, s[72:75], s71 offen nt lds
    s_add_u32 m0, s79, 8192
    s_mov_b32 s71, s82
    buffer_load_dwordx4 v224, s[72:75], s71 offen nt lds
    s_add_u32 m0, s79, 9216
    s_add_u32 s71, s71, s92
    buffer_load_dwordx4 v224, s[72:75], s71 offen nt lds
    s_add_u32 m0, s79, 10240
    s_add_u32 s71, s71, s92
    buffer_load_dwordx4 v224, s[72:75], s71 offen nt lds
    s_add_u32 m0, s79, 11264
    s_add_u32 s71, s71, s92
    buffer_load_dwordx4 v224, s[72:75], s71 offen nt lds
    s_add_u32 m0, s79, 12288
    s_mov_b32 s71, s83
    buffer_load_dwordx4 v224, s[72:75], s71 offen nt lds
    s_add_u32 m0, s79, 13312
    s_add_u32 s71, s71, s92
    buffer_load_dwordx4 v224, s[72:75], s71 offen nt lds
    s_add_u32 m0, s79, 14336
    s_add_u32 s71, s71, s92
    buffer_load_dwordx4 v224, s[72:75], s71 offen nt lds
    s_add_u32 m0, s79, 15360
    s_add_u32 s71, s71, s92
    buffer_load_dwordx4 v224, s[72:75], s71 offen nt lds
    s_cmp_lg_u32 s3, 0
    s_cbranch_scc1 L_wq_ready_8
    s_lshl_b32 s7, s41, 3
    s_add_u32 s7, s7, s40
    s_lshl_b32 s7, s7, 7
    s_add_u32 s7, s7, 19431424
    s_add_u32 s68, s4, s7
    s_addc_u32 s69, s5, 0
    s_mov_b32 s6, 0
    s_mov_b32 s7, 0
L_cpoll_9:
    s_load_dwordx16 s[52:67], s[68:69], s7 glc
    s_add_u32 s6, s6, 1
    s_waitcnt lgkmcnt(0)
    s_xor_b64 s[52:53], s[52:53], s[76:77]
    s_xor_b64 s[54:55], s[54:55], s[76:77]
    s_xor_b64 s[56:57], s[56:57], s[76:77]
    s_xor_b64 s[58:59], s[58:59], s[76:77]
    s_xor_b64 s[60:61], s[60:61], s[76:77]
    s_xor_b64 s[62:63], s[62:63], s[76:77]
    s_xor_b64 s[64:65], s[64:65], s[76:77]
    s_xor_b64 s[66:67], s[66:67], s[76:77]
    s_or_b64 s[52:53], s[52:53], s[60:61]
    s_or_b64 s[54:55], s[54:55], s[62:63]
    s_or_b64 s[56:57], s[56:57], s[64:65]
    s_or_b64 s[58:59], s[58:59], s[66:67]
    s_or_b64 s[52:53], s[52:53], s[56:57]
    s_or_b64 s[54:55], s[54:55], s[58:59]
    s_or_b64 s[52:53], s[52:53], s[54:55]
    s_cbranch_scc1 L_cpoll_10
    s_add_u32 s7, s7, 64
    s_cmp_eq_u32 s7, 128
    s_cbranch_scc1 L_cpolled_11
L_cpoll_10:
    s_cmp_lt_u32 s6, 1048576
    s_cbranch_scc1 L_cpoll_9
    s_branch L_main_end
L_cpolled_11:
L_wq_ready_8:
    s_barrier
    s_lshl_b32 s28, s40, 2
    s_add_u32 s28, s28, s3
    s_mul_i32 s28, s28, 73728
    buffer_load_dwordx4 a[0:3], v253, s[8:11], s28 offen offset:0 sc1
    buffer_load_dwordx4 a[4:7], v253, s[8:11], s28 offen offset:1024 sc1
    buffer_load_dwordx4 a[8:11], v253, s[8:11], s28 offen offset:2048 sc1
    buffer_load_dwordx4 a[12:15], v253, s[8:11], s28 offen offset:3072 sc1
    s_add_u32 s28, s28, 4096
    buffer_load_dwordx4 a[16:19], v253, s[8:11], s28 offen offset:0 sc1
    buffer_load_dwordx4 a[20:23], v253, s[8:11], s28 offen offset:1024 sc1
    buffer_load_dwordx4 a[24:27], v253, s[8:11], s28 offen offset:2048 sc1
    buffer_load_dwordx4 a[28:31], v253, s[8:11], s28 offen offset:3072 sc1
    s_add_u32 s28, s28, 4096
    buffer_load_dwordx4 a[32:35], v253, s[8:11], s28 offen offset:0 sc1
    buffer_load_dwordx4 a[36:39], v253, s[8:11], s28 offen offset:1024 sc1
    buffer_load_dwordx4 a[40:43], v253, s[8:11], s28 offen offset:2048 sc1
    buffer_load_dwordx4 a[44:47], v253, s[8:11], s28 offen offset:3072 sc1
    s_add_u32 s28, s28, 4096
    buffer_load_dwordx4 a[48:51], v253, s[8:11], s28 offen offset:0 sc1
    buffer_load_dwordx4 a[52:55], v253, s[8:11], s28 offen offset:1024 sc1
    buffer_load_dwordx4 a[56:59], v253, s[8:11], s28 offen offset:2048 sc1
    buffer_load_dwordx4 a[60:63], v253, s[8:11], s28 offen offset:3072 sc1
    s_add_u32 s28, s28, 4096
    buffer_load_dwordx4 a[64:67], v253, s[8:11], s28 offen offset:0 sc1
    buffer_load_dwordx4 a[68:71], v253, s[8:11], s28 offen offset:1024 sc1
    buffer_load_dwordx4 a[72:75], v253, s[8:11], s28 offen offset:2048 sc1
    buffer_load_dwordx4 a[76:79], v253, s[8:11], s28 offen offset:3072 sc1
    s_add_u32 s28, s28, 4096
    buffer_load_dwordx4 a[80:83], v253, s[8:11], s28 offen offset:0 sc1
    buffer_load_dwordx4 a[84:87], v253, s[8:11], s28 offen offset:1024 sc1
    buffer_load_dwordx4 a[88:91], v253, s[8:11], s28 offen offset:2048 sc1
    buffer_load_dwordx4 a[92:95], v253, s[8:11], s28 offen offset:3072 sc1
    s_add_u32 s28, s28, 4096
L_main_layer:
    buffer_load_dwordx4 a[96:99], v253, s[8:11], s28 offen offset:0 sc1
    buffer_load_dwordx4 a[100:103], v253, s[8:11], s28 offen offset:1024 sc1
    buffer_load_dwordx4 a[104:107], v253, s[8:11], s28 offen offset:2048 sc1
    buffer_load_dwordx4 a[108:111], v253, s[8:11], s28 offen offset:3072 sc1
    s_add_u32 s28, s28, 4096
    buffer_load_dwordx4 a[112:115], v253, s[8:11], s28 offen offset:0 sc1
    buffer_load_dwordx4 a[116:119], v253, s[8:11], s28 offen offset:1024 sc1
    buffer_load_dwordx4 a[120:123], v253, s[8:11], s28 offen offset:2048 sc1
    buffer_load_dwordx4 a[124:127], v253, s[8:11], s28 offen offset:3072 sc1
    s_add_u32 s28, s28, 4096
    buffer_load_dwordx4 a[128:131], v253, s[8:11], s28 offen offset:0 sc1
    buffer_load_dwordx4 a[132:135], v253, s[8:11], s28 offen offset:1024 sc1
    buffer_load_dwordx4 a[136:139], v253, s[8:11], s28 offen offset:2048 sc1
    buffer_load_dwordx4 a[140:143], v253, s[8:11], s28 offen offset:3072 sc1
    s_add_u32 s28, s28, 4096
    v_bfe_u32 v3, v0, 3, 1
    v_mul_u32_u24 v2, 9216, v3
    v_lshrrev_b32 v3, 4, v0
    v_lshl_add_u32 v2, v3, 7, v2
    v_and_b32 v3, 7, v0
    v_lshl_add_u32 v2, v3, 4, v2
    v_bfe_u32 v3, v0, 3, 2
    s_mov_b32 s7, 9216
    v_mul_lo_u32 v9, v3, s7
    v_lshrrev_b32 v3, 5, v0
    v_lshl_add_u32 v9, v3, 7, v9
    v_and_b32 v3, 7, v0
    v_lshl_add_u32 v9, v3, 4, v9
    s_mul_i32 s22, s41, 73728
    s_add_u32 s22, s22, s43
    s_add_u32 s23, s22, 38797312
    s_mul_i32 s7, s3, 18432
    s_add_u32 s24, s23, s7
    s_cmp_eq_u32 s41, 0
    s_cselect_b32 s7, 0, 18432
    s_sub_u32 s23, s23, s7
    s_lshl_b32 s25, s3, 10
    s_add_u32 s25, s25, 1024
    s_mul_i32 s26, s3, 5120
    s_lshl_b32 s7, s3, 9
    s_add_u32 s27, s23, s7
    s_and_b32 s7, s3, 1
    s_add_u32 s7, s7, 4
    s_mul_i32 s29, s7, 5120
    s_lshl_b32 s7, s7, 9
    s_add_u32 s23, s23, s7
    s_cmp_lg_u32 s3, 0
    s_cbranch_scc1 L_pollout_14
    s_lshl_b32 s7, s40, 7
    s_add_u32 s7, s7, s44
    s_sub_u32 s7, s7, 32768
    s_add_u32 s52, s4, s7
    s_addc_u32 s53, s5, 0
    s_cmp_eq_u32 s41, 0
    s_cselect_b32 s7, 0, 32
    s_mov_b32 s6, 0
L_poll_12:
    s_load_dwordx8 s[56:63], s[52:53], 0 glc
    s_load_dwordx2 s[54:55], s[52:53], s7 glc
    s_add_u32 s6, s6, 1
    s_waitcnt lgkmcnt(0)
    s_xor_b64 s[54:55], s[54:55], s[76:77]
    s_xor_b64 s[56:57], s[56:57], s[76:77]
    s_xor_b64 s[58:59], s[58:59], s[76:77]
    s_xor_b64 s[60:61], s[60:61], s[76:77]
    s_xor_b64 s[62:63], s[62:63], s[76:77]
    s_or_b64 s[56:57], s[56:57], s[58:59]
    s_or_b64 s[60:61], s[60:61], s[62:63]
    s_or_b64 s[56:57], s[56:57], s[54:55]
    s_or_b64 s[56:57], s[56:57], s[60:61]
    s_cbranch_scc0 L_polled_13
    s_cmp_lt_u32 s6, 1048576
    s_cbranch_scc1 L_poll_12
    s_branch L_main_end
L_polled_13:
L_pollout_14:
    s_barrier
    s_add_u32 m0, s25, 0
    s_nop 0
    buffer_load_dwordx4 v2, s[8:11], s24 offen offset:0 sc1 lds
    s_add_u32 m0, s25, 4608
    s_nop 0
    buffer_load_dwordx4 v2, s[8:11], s24 offen offset:512 sc1 lds
    s_add_u32 m0, s25, 9216
    s_nop 0
    buffer_load_dwordx4 v2, s[8:11], s24 offen offset:1024 sc1 lds
    s_add_u32 m0, s25, 13824
    s_nop 0
    buffer_load_dwordx4 v2, s[8:11], s24 offen offset:1536 sc1 lds
    s_add_u32 m0, s25, 18432
    s_nop 0
    buffer_load_dwordx4 v2, s[8:11], s24 offen offset:2048 sc1 lds
    s_add_u32 m0, s25, 23040
    s_nop 0
    buffer_load_dwordx4 v2, s[8:11], s24 offen offset:2560 sc1 lds
    s_add_u32 m0, s26, 0
    s_add_u32 s7, s27, 0
    buffer_load_dwordx4 v2, s[8:11], s7 offen sc1 lds
    s_add_u32 m0, s29, 0
    s_add_u32 s7, s23, 0
    buffer_load_dwordx4 v2, s[8:11], s7 offen sc1 lds
    v_mov_b32 v132, 0
    v_mov_b32 v133, 0
    v_mov_b32 v192, 0
    v_mov_b32 v193, 0
    v_mov_b32 v195, 0
    v_mov_b32 v135, 0
    v_mov_b32 v139, 0
    v_mov_b32 v143, 0
    v_mov_b32 v147, 0
    v_mov_b32 v151, 0
    v_mov_b32 v155, 0
    v_mov_b32 v159, 0
    v_mov_b32 v163, 0
    v_mov_b32 v167, 0
    v_mov_b32 v171, 0
    v_cmp_eq_u32 vcc, 16, v0
    v_mov_b32 v10, 0x3f80
    v_cmp_eq_u32 s[20:21], 17, v0
    v_cndmask_b32 v194, 0, v10, vcc
    v_and_b32 v11, 3, v0
    v_cndmask_b32 v194, v194, 1.0, s[20:21]
    v_cmp_eq_u32 vcc, 2, v11
    v_and_b32 v10, 15, v0
    v_lshrrev_b32 v11, 4, v0
    v_cndmask_b32 v196, 0, 1.0, vcc
    v_cndmask_b32 v197, 0, 1.0, vcc
    v_cndmask_b32 v198, 0, 1.0, vcc
    v_cndmask_b32 v199, 0, 1.0, vcc
    v_lshlrev_b32 v11, 2, v11
    v_sub_u32 v10, v11, v10
    v_mov_b32 v12, 0xf149f2ca
    s_cmp_eq_u32 s41, 0
    s_cselect_b64 s[38:39], 0, -1
    v_add_u32 v11, 0, v10
    v_and_b32 v13, 1, v11
    v_cmp_eq_u32 s[20:21], 0, v13
    v_cmp_lt_i32 vcc, 1, v11
    v_cmp_gt_i32 s[18:19], 1, v11
    s_and_b64 vcc, vcc, s[20:21]
    s_and_b64 s[18:19], s[18:19], s[20:21]
    s_and_b64 s[20:21], vcc, s[38:39]
    v_cndmask_b32 v200, v12, 0, vcc
    v_cndmask_b32 v204, v12, 0, s[18:19]
    v_cndmask_b32 v208, v12, 0, s[20:21]
    v_add_u32 v11, 1, v10
    v_and_b32 v13, 1, v11
    v_cmp_eq_u32 s[20:21], 0, v13
    v_cmp_lt_i32 vcc, 1, v11
    v_cmp_gt_i32 s[18:19], 1, v11
    s_and_b64 vcc, vcc, s[20:21]
    s_and_b64 s[18:19], s[18:19], s[20:21]
    s_and_b64 s[20:21], vcc, s[38:39]
    v_cndmask_b32 v201, v12, 0, vcc
    v_cndmask_b32 v205, v12, 0, s[18:19]
    v_cndmask_b32 v209, v12, 0, s[20:21]
    v_add_u32 v11, 2, v10
    v_and_b32 v13, 1, v11
    v_cmp_eq_u32 s[20:21], 0, v13
    v_cmp_lt_i32 vcc, 1, v11
    v_cmp_gt_i32 s[18:19], 1, v11
    s_and_b64 vcc, vcc, s[20:21]
    s_and_b64 s[18:19], s[18:19], s[20:21]
    s_and_b64 s[20:21], vcc, s[38:39]
    v_cndmask_b32 v202, v12, 0, vcc
    v_cndmask_b32 v206, v12, 0, s[18:19]
    v_cndmask_b32 v210, v12, 0, s[20:21]
    v_add_u32 v11, 3, v10
    v_and_b32 v13, 1, v11
    v_cmp_eq_u32 s[20:21], 0, v13
    v_cmp_lt_i32 vcc, 1, v11
    v_cmp_gt_i32 s[18:19], 1, v11
    s_and_b64 vcc, vcc, s[20:21]
    s_and_b64 s[18:19], s[18:19], s[20:21]
    s_and_b64 s[20:21], vcc, s[38:39]
    v_cndmask_b32 v203, v12, 0, vcc
    v_cndmask_b32 v207, v12, 0, s[18:19]
    v_cndmask_b32 v211, v12, 0, s[20:21]
    s_lshl_b32 s45, s41, 1
    s_lshr_b32 s7, s40, 2
    s_add_u32 s45, s45, s7
    s_mul_i32 s30, s45, 36864
    s_add_u32 s30, s30, s43
    s_and_b32 s31, s40, 3
    s_mul_i32 s31, s31, 9
    s_add_u32 s31, s31, s3
    s_mul_i32 s32, s31, 18432
    s_add_u32 s32, s32, 2359296
    s_add_u32 s33, s32, 73728
    s_add_u32 s34, s32, 147456
    s_mov_b32 s39, 19496960
    v_min_u32 v228, 44, v0
    v_lshlrev_b32 v228, 3, v228
    s_cmp_eq_u32 s3, 1
    s_cmov_b32 s34, 3022848
    s_cmp_lt_u32 s3, 2
    s_cselect_b32 s35, 0, 1073741824
    v_add_u32 v5, s35, v253
    s_cmp_eq_u32 s3, 0
    s_cselect_b32 s35, 0, 1073741824
    v_add_u32 v7, s35, v9
    s_lshl_b32 s7, s31, 8
    s_add_u32 s36, s30, s7
    s_add_u32 s37, s36, 43515904
    s_add_u32 s46, s36, 45875200
    s_lshl_b32 s36, s45, 7
    s_add_u32 s36, s36, s43
    s_add_u32 s36, s36, 48431104
    s_lshl_b32 s47, s45, 9
    s_add_u32 s47, s47, s43
    s_add_u32 s47, s47, 48234496
    v_bfe_u32 v10, v0, 3, 2
    v_and_b32 v8, 7, v0
    v_lshlrev_b32 v8, 2, v8
    v_lshl_add_u32 v8, v10, 7, v8
    v_add_u32 v6, 46080, v253
    s_waitcnt vmcnt(0)
    s_barrier
    ds_read_b128 v[16:19], v253 offset:0
    ds_read_b128 v[20:23], v253 offset:1024
    ds_read_b128 v[24:27], v253 offset:2048
    ds_read_b128 v[28:31], v253 offset:3072
    ds_read_b128 v[32:35], v253 offset:4096
    s_waitcnt lgkmcnt(0)
    v_mfma_f32_16x16x32_bf16 v[56:59], a[0:3], v[20:23], 0
    ds_read_b128 v[36:39], v253 offset:5120
    v_mfma_f32_16x16x32_bf16 v[60:63], a[0:3], v[24:27], 0
    ds_read_b128 v[40:43], v253 offset:6144
    v_mfma_f32_16x16x32_bf16 v[64:67], a[0:3], v[28:31], 0
    ds_read_b128 v[44:47], v253 offset:7168
    v_mfma_f32_16x16x32_bf16 v[68:71], a[0:3], v[32:35], 0
    ds_read_b128 v[48:51], v253 offset:8192
    v_mfma_f32_16x16x32_bf16 v[72:75], a[4:7], v[16:19], 0
    ds_read_b128 v[52:55], v253 offset:9216
    v_mfma_f32_16x16x32_bf16 v[76:79], a[4:7], v[20:23], 0
    s_add_u32 m0, s25, 27648
    s_nop 0
    buffer_load_dwordx4 v2, s[8:11], s24 offen offset:3072 sc1 lds
    v_mfma_f32_16x16x32_bf16 v[80:83], a[4:7], v[24:27], 0
    v_mfma_f32_16x16x32_bf16 v[84:87], a[4:7], v[28:31], 0
    s_add_u32 m0, s25, 32256
    s_nop 0
    buffer_load_dwordx4 v2, s[8:11], s24 offen offset:3584 sc1 lds
    v_mfma_f32_16x16x32_bf16 v[88:91], a[4:7], v[32:35], 0
    v_mfma_f32_16x16x32_bf16 v[92:95], v[16:19], a[8:11], 0
    buffer_load_dwordx4 a[144:147], v253, s[8:11], s28 offen offset:0 sc1
    v_mfma_f32_16x16x32_bf16 v[96:99], v[20:23], a[8:11], 0
    v_mfma_f32_16x16x32_bf16 v[100:103], v[24:27], a[8:11], 0
    buffer_load_dwordx4 a[148:151], v253, s[8:11], s28 offen offset:1024 sc1
    v_mfma_f32_16x16x32_bf16 v[104:107], v[28:31], a[8:11], 0
    v_mfma_f32_16x16x32_bf16 v[108:111], v[32:35], a[8:11], 0
    buffer_load_dwordx4 a[152:155], v253, s[8:11], s28 offen offset:2048 sc1
    v_mfma_f32_16x16x32_bf16 v[112:115], a[12:15], v[16:19], 0
    v_mfma_f32_16x16x32_bf16 v[116:119], a[12:15], v[20:23], 0
    v_mfma_f32_16x16x32_bf16 v[120:123], a[12:15], v[24:27], 0
    v_mfma_f32_16x16x32_bf16 v[124:127], a[12:15], v[28:31], 0
    v_mfma_f32_16x16x32_bf16 v[128:131], a[12:15], v[32:35], 0
    s_waitcnt lgkmcnt(0)
    v_mfma_f32_16x16x32_bf16 v[56:59], a[16:19], v[40:43], v[56:59]
    ds_read_b128 v[16:19], v253 offset:10240
    v_mfma_f32_16x16x32_bf16 v[60:63], a[16:19], v[44:47], v[60:63]
    ds_read_b128 v[20:23], v253 offset:11264
    v_mfma_f32_16x16x32_bf16 v[64:67], a[16:19], v[48:51], v[64:67]
    ds_read_b128 v[24:27], v253 offset:12288
    v_mfma_f32_16x16x32_bf16 v[68:71], a[16:19], v[52:55], v[68:71]
    ds_read_b128 v[28:31], v253 offset:13312
    v_mfma_f32_16x16x32_bf16 v[72:75], a[20:23], v[36:39], v[72:75]
    ds_read_b128 v[32:35], v253 offset:14336
    v_mfma_f32_16x16x32_bf16 v[76:79], a[20:23], v[40:43], v[76:79]
    s_add_u32 m0, s25, 40960
    s_add_u32 s24, s24, 4096
    buffer_load_dwordx4 v2, s[8:11], s24 offen offset:0 sc1 lds
    v_mfma_f32_16x16x32_bf16 v[80:83], a[20:23], v[44:47], v[80:83]
    v_mfma_f32_16x16x32_bf16 v[84:87], a[20:23], v[48:51], v[84:87]
    s_add_u32 m0, s25, 45568
    s_nop 0
    buffer_load_dwordx4 v2, s[8:11], s24 offen offset:512 sc1 lds
    v_mfma_f32_16x16x32_bf16 v[88:91], a[20:23], v[52:55], v[88:91]
    v_mfma_f32_16x16x32_bf16 v[92:95], v[36:39], a[24:27], v[92:95]
    buffer_load_dwordx4 a[156:159], v253, s[8:11], s28 offen offset:3072 sc1
    s_add_u32 s28, s28, 4096
    v_mfma_f32_16x16x32_bf16 v[96:99], v[40:43], a[24:27], v[96:99]
    v_mfma_f32_16x16x32_bf16 v[100:103], v[44:47], a[24:27], v[100:103]
    buffer_load_dwordx4 a[0:3], v253, s[8:11], s28 offen offset:0 sc1
    v_mfma_f32_16x16x32_bf16 v[104:107], v[48:51], a[24:27], v[104:107]
    v_mfma_f32_16x16x32_bf16 v[108:111], v[52:55], a[24:27], v[108:111]
    buffer_load_dwordx4 a[4:7], v253, s[8:11], s28 offen offset:1024 sc1
    v_mfma_f32_16x16x32_bf16 v[112:115], a[28:31], v[36:39], v[112:115]
    v_mfma_f32_16x16x32_bf16 v[116:119], a[28:31], v[40:43], v[116:119]
    v_mfma_f32_16x16x32_bf16 v[120:123], a[28:31], v[44:47], v[120:123]
    v_mfma_f32_16x16x32_bf16 v[124:127], a[28:31], v[48:51], v[124:127]
    v_mfma_f32_16x16x32_bf16 v[128:131], a[28:31], v[52:55], v[128:131]
    s_waitcnt lgkmcnt(0)
    v_mfma_f32_16x16x32_bf16 v[56:59], a[32:35], v[20:23], v[56:59]
    ds_read_b128 v[36:39], v253 offset:15360
    v_mfma_f32_16x16x32_bf16 v[60:63], a[32:35], v[24:27], v[60:63]
    ds_read_b128 v[40:43], v253 offset:16384
    v_mfma_f32_16x16x32_bf16 v[64:67], a[32:35], v[28:31], v[64:67]
    ds_read_b128 v[44:47], v253 offset:17408
    v_mfma_f32_16x16x32_bf16 v[68:71], a[32:35], v[32:35], v[68:71]
    ds_read_b128 v[48:51], v253 offset:18432
    v_mfma_f32_16x16x32_bf16 v[72:75], a[36:39], v[16:19], v[72:75]
    ds_read_b128 v[52:55], v253 offset:19456
    v_mfma_f32_16x16x32_bf16 v[76:79], a[36:39], v[20:23], v[76:79]
    s_add_u32 m0, s25, 50176
    s_nop 0
    buffer_load_dwordx4 v2, s[8:11], s24 offen offset:1024 sc1 lds
    v_mfma_f32_16x16x32_bf16 v[80:83], a[36:39], v[24:27], v[80:83]
    v_mfma_f32_16x16x32_bf16 v[84:87], a[36:39], v[28:31], v[84:87]
    s_add_u32 m0, s25, 54784
    s_nop 0
    buffer_load_dwordx4 v2, s[8:11], s24 offen offset:1536 sc1 lds
    v_mfma_f32_16x16x32_bf16 v[88:91], a[36:39], v[32:35], v[88:91]
    v_mfma_f32_16x16x32_bf16 v[92:95], v[16:19], a[40:43], v[92:95]
    buffer_load_dwordx4 a[8:11], v253, s[8:11], s28 offen offset:2048 sc1
    v_mfma_f32_16x16x32_bf16 v[96:99], v[20:23], a[40:43], v[96:99]
    v_mfma_f32_16x16x32_bf16 v[100:103], v[24:27], a[40:43], v[100:103]
    buffer_load_dwordx4 a[12:15], v253, s[8:11], s28 offen offset:3072 sc1
    s_add_u32 s28, s28, 4096
    v_mfma_f32_16x16x32_bf16 v[104:107], v[28:31], a[40:43], v[104:107]
    v_mfma_f32_16x16x32_bf16 v[108:111], v[32:35], a[40:43], v[108:111]
    buffer_load_dwordx4 a[16:19], v253, s[8:11], s28 offen offset:0 sc1
    v_mfma_f32_16x16x32_bf16 v[112:115], a[44:47], v[16:19], v[112:115]
    v_mfma_f32_16x16x32_bf16 v[116:119], a[44:47], v[20:23], v[116:119]
    v_mfma_f32_16x16x32_bf16 v[120:123], a[44:47], v[24:27], v[120:123]
    v_mfma_f32_16x16x32_bf16 v[124:127], a[44:47], v[28:31], v[124:127]
    v_mfma_f32_16x16x32_bf16 v[128:131], a[44:47], v[32:35], v[128:131]
    s_waitcnt lgkmcnt(0)
    v_mfma_f32_16x16x32_bf16 v[56:59], a[48:51], v[40:43], v[56:59]
    ds_read_b128 v[16:19], v253 offset:20480
    v_mfma_f32_16x16x32_bf16 v[60:63], a[48:51], v[44:47], v[60:63]
    ds_read_b128 v[20:23], v253 offset:21504
    v_mfma_f32_16x16x32_bf16 v[64:67], a[48:51], v[48:51], v[64:67]
    ds_read_b128 v[24:27], v253 offset:22528
    v_mfma_f32_16x16x32_bf16 v[68:71], a[48:51], v[52:55], v[68:71]
    ds_read_b128 v[28:31], v253 offset:23552
    v_mfma_f32_16x16x32_bf16 v[72:75], a[52:55], v[36:39], v[72:75]
    ds_read_b128 v[32:35], v253 offset:24576
    v_mfma_f32_16x16x32_bf16 v[76:79], a[52:55], v[40:43], v[76:79]
    s_add_u32 m0, s26, 30720
    s_add_u32 s7, s27, 3072
    buffer_load_dwordx4 v2, s[8:11], s7 offen sc1 lds
    v_mfma_f32_16x16x32_bf16 v[80:83], a[52:55], v[44:47], v[80:83]
    v_mfma_f32_16x16x32_bf16 v[84:87], a[52:55], v[48:51], v[84:87]
    s_add_u32 m0, s29, 30720
    s_add_u32 s7, s23, 3072
    buffer_load_dwordx4 v2, s[8:11], s7 offen sc1 lds
    v_mfma_f32_16x16x32_bf16 v[88:91], a[52:55], v[52:55], v[88:91]
    v_mfma_f32_16x16x32_bf16 v[92:95], v[36:39], a[56:59], v[92:95]
    buffer_load_dwordx4 a[20:23], v253, s[8:11], s28 offen offset:1024 sc1
    v_mfma_f32_16x16x32_bf16 v[96:99], v[40:43], a[56:59], v[96:99]
    v_mfma_f32_16x16x32_bf16 v[100:103], v[44:47], a[56:59], v[100:103]
    buffer_load_dwordx4 a[24:27], v253, s[8:11], s28 offen offset:2048 sc1
    v_mfma_f32_16x16x32_bf16 v[104:107], v[48:51], a[56:59], v[104:107]
    v_mfma_f32_16x16x32_bf16 v[108:111], v[52:55], a[56:59], v[108:111]
    buffer_load_dwordx4 a[28:31], v253, s[8:11], s28 offen offset:3072 sc1
    s_add_u32 s28, s28, 4096
    v_mfma_f32_16x16x32_bf16 v[112:115], a[60:63], v[36:39], v[112:115]
    v_mfma_f32_16x16x32_bf16 v[116:119], a[60:63], v[40:43], v[116:119]
    v_mfma_f32_16x16x32_bf16 v[120:123], a[60:63], v[44:47], v[120:123]
    v_mfma_f32_16x16x32_bf16 v[124:127], a[60:63], v[48:51], v[124:127]
    v_mfma_f32_16x16x32_bf16 v[128:131], a[60:63], v[52:55], v[128:131]
    s_waitcnt lgkmcnt(0)
    v_mfma_f32_16x16x32_bf16 v[56:59], a[64:67], v[20:23], v[56:59]
    ds_read_b128 v[36:39], v253 offset:25600
    v_mfma_f32_16x16x32_bf16 v[60:63], a[64:67], v[24:27], v[60:63]
    ds_read_b128 v[40:43], v253 offset:26624
    v_mfma_f32_16x16x32_bf16 v[64:67], a[64:67], v[28:31], v[64:67]
    ds_read_b128 v[44:47], v253 offset:27648
    v_mfma_f32_16x16x32_bf16 v[68:71], a[64:67], v[32:35], v[68:71]
    ds_read_b128 v[48:51], v253 offset:28672
    v_mfma_f32_16x16x32_bf16 v[72:75], a[68:71], v[16:19], v[72:75]
    ds_read_b128 v[52:55], v253 offset:29696
    v_mfma_f32_16x16x32_bf16 v[76:79], a[68:71], v[20:23], v[76:79]
    buffer_load_dwordx4 a[32:35], v253, s[8:11], s28 offen offset:0 sc1
    v_mfma_f32_16x16x32_bf16 v[80:83], a[68:71], v[24:27], v[80:83]
    v_mfma_f32_16x16x32_bf16 v[84:87], a[68:71], v[28:31], v[84:87]
    buffer_load_dwordx4 a[36:39], v253, s[8:11], s28 offen offset:1024 sc1
    v_mfma_f32_16x16x32_bf16 v[88:91], a[68:71], v[32:35], v[88:91]
    v_mfma_f32_16x16x32_bf16 v[92:95], v[16:19], a[72:75], v[92:95]
    buffer_load_dwordx4 a[40:43], v253, s[8:11], s28 offen offset:2048 sc1
    v_mfma_f32_16x16x32_bf16 v[96:99], v[20:23], a[72:75], v[96:99]
    v_mfma_f32_16x16x32_bf16 v[100:103], v[24:27], a[72:75], v[100:103]
    buffer_load_dwordx2 v[226:227], v228, s[8:11], s39 offen sc1
    v_mfma_f32_16x16x32_bf16 v[104:107], v[28:31], a[72:75], v[104:107]
    v_mfma_f32_16x16x32_bf16 v[108:111], v[32:35], a[72:75], v[108:111]
    v_mfma_f32_16x16x32_bf16 v[112:115], a[76:79], v[16:19], v[112:115]
    v_mfma_f32_16x16x32_bf16 v[116:119], a[76:79], v[20:23], v[116:119]
    v_mfma_f32_16x16x32_bf16 v[120:123], a[76:79], v[24:27], v[120:123]
    v_mfma_f32_16x16x32_bf16 v[124:127], a[76:79], v[28:31], v[124:127]
    v_mfma_f32_16x16x32_bf16 v[128:131], a[76:79], v[32:35], v[128:131]
    s_waitcnt vmcnt(7) lgkmcnt(0)
    s_barrier
    v_mfma_f32_16x16x32_bf16 v[56:59], a[80:83], v[40:43], v[56:59]
    ds_read_b128 v[16:19], v253 offset:30720
    v_mfma_f32_16x16x32_bf16 v[60:63], a[80:83], v[44:47], v[60:63]
    ds_read_b128 v[20:23], v253 offset:31744
    v_mfma_f32_16x16x32_bf16 v[64:67], a[80:83], v[48:51], v[64:67]
    ds_read_b128 v[24:27], v253 offset:32768
    v_mfma_f32_16x16x32_bf16 v[68:71], a[80:83], v[52:55], v[68:71]
    ds_read_b128 v[28:31], v253 offset:33792
    v_mfma_f32_16x16x32_bf16 v[72:75], a[84:87], v[36:39], v[72:75]
    ds_read_b128 v[32:35], v253 offset:34816
    v_mfma_f32_16x16x32_bf16 v[76:79], a[84:87], v[40:43], v[76:79]
    s_add_u32 m0, s25, 59392
    s_nop 0
    buffer_load_dwordx4 v2, s[8:11], s24 offen offset:2048 sc1 lds
    v_mfma_f32_16x16x32_bf16 v[80:83], a[84:87], v[44:47], v[80:83]
    v_mfma_f32_16x16x32_bf16 v[84:87], a[84:87], v[48:51], v[84:87]
    s_add_u32 m0, s25, 64000
    s_nop 0
    buffer_load_dwordx4 v2, s[8:11], s24 offen offset:2560 sc1 lds
    v_mfma_f32_16x16x32_bf16 v[88:91], a[84:87], v[52:55], v[88:91]
    v_mfma_f32_16x16x32_bf16 v[92:95], v[36:39], a[88:91], v[92:95]
    buffer_load_dwordx4 a[44:47], v253, s[8:11], s28 offen offset:3072 sc1
    s_add_u32 s28, s28, 4096
    v_mfma_f32_16x16x32_bf16 v[96:99], v[40:43], a[88:91], v[96:99]
    v_mfma_f32_16x16x32_bf16 v[100:103], v[44:47], a[88:91], v[100:103]
    buffer_load_dwordx4 a[48:51], v253, s[8:11], s28 offen offset:0 sc1
    v_mfma_f32_16x16x32_bf16 v[104:107], v[48:51], a[88:91], v[104:107]
    v_mfma_f32_16x16x32_bf16 v[108:111], v[52:55], a[88:91], v[108:111]
    buffer_load_dwordx4 a[52:55], v253, s[8:11], s28 offen offset:1024 sc1
    v_mfma_f32_16x16x32_bf16 v[112:115], a[92:95], v[36:39], v[112:115]
    v_mfma_f32_16x16x32_bf16 v[116:119], a[92:95], v[40:43], v[116:119]
    v_mfma_f32_16x16x32_bf16 v[120:123], a[92:95], v[44:47], v[120:123]
    v_mfma_f32_16x16x32_bf16 v[124:127], a[92:95], v[48:51], v[124:127]
    v_mfma_f32_16x16x32_bf16 v[128:131], a[92:95], v[52:55], v[128:131]
    s_waitcnt lgkmcnt(0)
    v_mfma_f32_16x16x32_bf16 v[56:59], a[96:99], v[20:23], v[56:59]
    ds_read_b128 v[36:39], v253 offset:35840
    v_mfma_f32_16x16x32_bf16 v[60:63], a[96:99], v[24:27], v[60:63]
    ds_read_b128 v[40:43], v253 offset:36864
    v_mfma_f32_16x16x32_bf16 v[64:67], a[96:99], v[28:31], v[64:67]
    ds_read_b128 v[44:47], v253 offset:37888
    v_mfma_f32_16x16x32_bf16 v[68:71], a[96:99], v[32:35], v[68:71]
    ds_read_b128 v[48:51], v253 offset:38912
    v_mfma_f32_16x16x32_bf16 v[72:75], a[100:103], v[16:19], v[72:75]
    ds_read_b128 v[52:55], v253 offset:39936
    v_mfma_f32_16x16x32_bf16 v[76:79], a[100:103], v[20:23], v[76:79]
    s_add_u32 m0, s25, 68608
    s_nop 0
    buffer_load_dwordx4 v2, s[8:11], s24 offen offset:3072 sc1 lds
    v_mfma_f32_16x16x32_bf16 v[80:83], a[100:103], v[24:27], v[80:83]
    v_mfma_f32_16x16x32_bf16 v[84:87], a[100:103], v[28:31], v[84:87]
    s_add_u32 m0, s25, 73216
    s_nop 0
    buffer_load_dwordx4 v2, s[8:11], s24 offen offset:3584 sc1 lds
    v_mfma_f32_16x16x32_bf16 v[88:91], a[100:103], v[32:35], v[88:91]
    v_mfma_f32_16x16x32_bf16 v[92:95], v[16:19], a[104:107], v[92:95]
    buffer_load_dwordx4 a[56:59], v253, s[8:11], s28 offen offset:2048 sc1
    v_mfma_f32_16x16x32_bf16 v[96:99], v[20:23], a[104:107], v[96:99]
    v_mfma_f32_16x16x32_bf16 v[100:103], v[24:27], a[104:107], v[100:103]
    buffer_load_dwordx4 a[60:63], v253, s[8:11], s28 offen offset:3072 sc1
    s_add_u32 s28, s28, 4096
    v_mfma_f32_16x16x32_bf16 v[104:107], v[28:31], a[104:107], v[104:107]
    v_mfma_f32_16x16x32_bf16 v[108:111], v[32:35], a[104:107], v[108:111]
    buffer_load_dwordx4 a[64:67], v253, s[8:11], s28 offen offset:0 sc1
    v_mfma_f32_16x16x32_bf16 v[112:115], a[108:111], v[16:19], v[112:115]
    v_mfma_f32_16x16x32_bf16 v[116:119], a[108:111], v[20:23], v[116:119]
    v_mfma_f32_16x16x32_bf16 v[120:123], a[108:111], v[24:27], v[120:123]
    v_mfma_f32_16x16x32_bf16 v[124:127], a[108:111], v[28:31], v[124:127]
    v_mfma_f32_16x16x32_bf16 v[128:131], a[108:111], v[32:35], v[128:131]
    s_waitcnt lgkmcnt(0)
    v_mfma_f32_16x16x32_bf16 v[56:59], a[112:115], v[40:43], v[56:59]
    ds_read_b128 v[16:19], v253 offset:40960
    v_mfma_f32_16x16x32_bf16 v[60:63], a[112:115], v[44:47], v[60:63]
    ds_read_b128 v[20:23], v253 offset:41984
    v_mfma_f32_16x16x32_bf16 v[64:67], a[112:115], v[48:51], v[64:67]
    ds_read_b128 v[24:27], v253 offset:43008
    v_mfma_f32_16x16x32_bf16 v[68:71], a[112:115], v[52:55], v[68:71]
    ds_read_b128 v[28:31], v253 offset:44032
    v_mfma_f32_16x16x32_bf16 v[72:75], a[116:119], v[36:39], v[72:75]
    ds_read_b128 v[32:35], v253 offset:45056
    v_mfma_f32_16x16x32_bf16 v[76:79], a[116:119], v[40:43], v[76:79]
    s_add_u32 m0, s25, 81920
    s_add_u32 s24, s24, 4096
    buffer_load_dwordx4 v2, s[8:11], s24 offen offset:0 sc1 lds
    v_mfma_f32_16x16x32_bf16 v[80:83], a[116:119], v[44:47], v[80:83]
    v_mfma_f32_16x16x32_bf16 v[84:87], a[116:119], v[48:51], v[84:87]
    s_add_u32 m0, s25, 86528
    s_nop 0
    buffer_load_dwordx4 v2, s[8:11], s24 offen offset:512 sc1 lds
    v_mfma_f32_16x16x32_bf16 v[88:91], a[116:119], v[52:55], v[88:91]
    v_mfma_f32_16x16x32_bf16 v[92:95], v[36:39], a[120:123], v[92:95]
    buffer_load_dwordx4 a[68:71], v253, s[8:11], s28 offen offset:1024 sc1
    v_mfma_f32_16x16x32_bf16 v[96:99], v[40:43], a[120:123], v[96:99]
    v_mfma_f32_16x16x32_bf16 v[100:103], v[44:47], a[120:123], v[100:103]
    buffer_load_dwordx4 a[72:75], v253, s[8:11], s28 offen offset:2048 sc1
    v_mfma_f32_16x16x32_bf16 v[104:107], v[48:51], a[120:123], v[104:107]
    v_mfma_f32_16x16x32_bf16 v[108:111], v[52:55], a[120:123], v[108:111]
    buffer_load_dwordx4 a[76:79], v253, s[8:11], s28 offen offset:3072 sc1
    s_add_u32 s28, s28, 4096
    v_mfma_f32_16x16x32_bf16 v[112:115], a[124:127], v[36:39], v[112:115]
    v_mfma_f32_16x16x32_bf16 v[116:119], a[124:127], v[40:43], v[116:119]
    v_mfma_f32_16x16x32_bf16 v[120:123], a[124:127], v[44:47], v[120:123]
    v_mfma_f32_16x16x32_bf16 v[124:127], a[124:127], v[48:51], v[124:127]
    v_mfma_f32_16x16x32_bf16 v[128:131], a[124:127], v[52:55], v[128:131]
    s_waitcnt lgkmcnt(0)
    v_mfma_f32_16x16x32_bf16 v[56:59], a[128:131], v[20:23], v[56:59]
    ds_read_b128 v[36:39], v6 offset:0
    v_mfma_f32_16x16x32_bf16 v[60:63], a[128:131], v[24:27], v[60:63]
    ds_read_b128 v[40:43], v6 offset:1024
    v_mfma_f32_16x16x32_bf16 v[64:67], a[128:131], v[28:31], v[64:67]
    ds_read_b128 v[44:47], v6 offset:2048
    v_mfma_f32_16x16x32_bf16 v[68:71], a[128:131], v[32:35], v[68:71]
    ds_read_b128 v[48:51], v6 offset:3072
    v_mfma_f32_16x16x32_bf16 v[72:75], a[132:135], v[16:19], v[72:75]
    ds_read_b128 v[52:55], v6 offset:4096
    v_mfma_f32_16x16x32_bf16 v[76:79], a[132:135], v[20:23], v[76:79]
    s_add_u32 m0, s26, 61440
    s_add_u32 s7, s27, 6144
    buffer_load_dwordx4 v2, s[8:11], s7 offen sc1 lds
    v_mfma_f32_16x16x32_bf16 v[80:83], a[132:135], v[24:27], v[80:83]
    v_mfma_f32_16x16x32_bf16 v[84:87], a[132:135], v[28:31], v[84:87]
    s_add_u32 m0, s29, 61440
    s_add_u32 s7, s23, 6144
    buffer_load_dwordx4 v2, s[8:11], s7 offen sc1 lds
    v_mfma_f32_16x16x32_bf16 v[88:91], a[132:135], v[32:35], v[88:91]
    v_mfma_f32_16x16x32_bf16 v[92:95], v[16:19], a[136:139], v[92:95]
    buffer_load_dwordx4 a[80:83], v253, s[8:11], s28 offen offset:0 sc1
    v_mfma_f32_16x16x32_bf16 v[96:99], v[20:23], a[136:139], v[96:99]
    v_mfma_f32_16x16x32_bf16 v[100:103], v[24:27], a[136:139], v[100:103]
    buffer_load_dwordx4 a[84:87], v253, s[8:11], s28 offen offset:1024 sc1
    v_mfma_f32_16x16x32_bf16 v[104:107], v[28:31], a[136:139], v[104:107]
    v_mfma_f32_16x16x32_bf16 v[108:111], v[32:35], a[136:139], v[108:111]
    buffer_load_dwordx4 a[88:91], v253, s[8:11], s28 offen offset:2048 sc1
    v_mfma_f32_16x16x32_bf16 v[112:115], a[140:143], v[16:19], v[112:115]
    v_mfma_f32_16x16x32_bf16 v[116:119], a[140:143], v[20:23], v[116:119]
    v_mfma_f32_16x16x32_bf16 v[120:123], a[140:143], v[24:27], v[120:123]
    v_mfma_f32_16x16x32_bf16 v[124:127], a[140:143], v[28:31], v[124:127]
    v_mfma_f32_16x16x32_bf16 v[128:131], a[140:143], v[32:35], v[128:131]
    s_waitcnt vmcnt(20) lgkmcnt(0)
    s_mov_b32 s6, 0
L_wo_poll_15:
    v_cmp_eq_u32 vcc, s76, v226
    v_cmp_eq_u32 s[20:21], s76, v227
    s_and_b64 vcc, vcc, s[20:21]
    s_cmp_eq_u64 vcc, exec
    s_cbranch_scc1 L_wo_ready_16
    buffer_load_dwordx2 v[226:227], v228, s[8:11], s39 offen sc1
    s_add_u32 s6, s6, 1
    s_cmp_lt_u32 s6, 1048576
    s_waitcnt vmcnt(0)
    s_cbranch_scc1 L_wo_poll_15
    s_branch L_main_end
L_wo_ready_16:
    v_mfma_f32_16x16x32_bf16 v[56:59], a[144:147], v[40:43], v[56:59]
    ds_read_b128 v[16:19], v6 offset:5120
    v_mfma_f32_16x16x32_bf16 v[60:63], a[144:147], v[44:47], v[60:63]
    ds_read_b128 v[20:23], v6 offset:6144
    v_mfma_f32_16x16x32_bf16 v[64:67], a[144:147], v[48:51], v[64:67]
    ds_read_b128 v[24:27], v6 offset:7168
    v_mfma_f32_16x16x32_bf16 v[68:71], a[144:147], v[52:55], v[68:71]
    ds_read_b128 v[28:31], v6 offset:8192
    v_mfma_f32_16x16x32_bf16 v[72:75], a[148:151], v[36:39], v[72:75]
    ds_read_b128 v[32:35], v6 offset:9216
    v_mfma_f32_16x16x32_bf16 v[76:79], a[148:151], v[40:43], v[76:79]
    buffer_load_dwordx4 a[92:95], v253, s[8:11], s28 offen offset:3072 sc1
    s_add_u32 s28, s28, 4096
    v_mfma_f32_16x16x32_bf16 v[80:83], a[148:151], v[44:47], v[80:83]
    v_mfma_f32_16x16x32_bf16 v[84:87], a[148:151], v[48:51], v[84:87]
    buffer_load_dwordx4 a[96:99], v253, s[8:11], s28 offen offset:0 sc1
    v_mfma_f32_16x16x32_bf16 v[88:91], a[148:151], v[52:55], v[88:91]
    v_mfma_f32_16x16x32_bf16 v[92:95], v[36:39], a[152:155], v[92:95]
    buffer_load_dwordx4 a[100:103], v253, s[8:11], s28 offen offset:1024 sc1
    v_mfma_f32_16x16x32_bf16 v[96:99], v[40:43], a[152:155], v[96:99]
    v_mfma_f32_16x16x32_bf16 v[100:103], v[44:47], a[152:155], v[100:103]
    buffer_load_dwordx4 a[160:163], v253, s[8:11], s32 offen offset:0 sc1
    v_mfma_f32_16x16x32_bf16 v[104:107], v[48:51], a[152:155], v[104:107]
    v_mfma_f32_16x16x32_bf16 v[108:111], v[52:55], a[152:155], v[108:111]
    v_mfma_f32_16x16x32_bf16 v[112:115], a[156:159], v[36:39], v[112:115]
    v_mfma_f32_16x16x32_bf16 v[116:119], a[156:159], v[40:43], v[116:119]
    v_mfma_f32_16x16x32_bf16 v[120:123], a[156:159], v[44:47], v[120:123]
    v_mfma_f32_16x16x32_bf16 v[124:127], a[156:159], v[48:51], v[124:127]
    v_mfma_f32_16x16x32_bf16 v[128:131], a[156:159], v[52:55], v[128:131]
    s_waitcnt vmcnt(34) lgkmcnt(0)
    v_mfma_f32_16x16x32_bf16 v[56:59], a[0:3], v[20:23], v[56:59]
    ds_read_b128 v[36:39], v6 offset:10240
    v_mfma_f32_16x16x32_bf16 v[60:63], a[0:3], v[24:27], v[60:63]
    ds_read_b128 v[40:43], v6 offset:11264
    v_mfma_f32_16x16x32_bf16 v[64:67], a[0:3], v[28:31], v[64:67]
    ds_read_b128 v[44:47], v6 offset:12288
    v_mfma_f32_16x16x32_bf16 v[68:71], a[0:3], v[32:35], v[68:71]
    ds_read_b128 v[48:51], v6 offset:13312
    v_mfma_f32_16x16x32_bf16 v[72:75], a[4:7], v[16:19], v[72:75]
    ds_read_b128 v[52:55], v6 offset:14336
    v_mfma_f32_16x16x32_bf16 v[76:79], a[4:7], v[20:23], v[76:79]
    buffer_load_dwordx4 a[104:107], v253, s[8:11], s28 offen offset:2048 sc1
    v_mfma_f32_16x16x32_bf16 v[80:83], a[4:7], v[24:27], v[80:83]
    v_mfma_f32_16x16x32_bf16 v[84:87], a[4:7], v[28:31], v[84:87]
    buffer_load_dwordx4 a[108:111], v253, s[8:11], s28 offen offset:3072 sc1
    s_add_u32 s28, s28, 4096
    v_mfma_f32_16x16x32_bf16 v[88:91], a[4:7], v[32:35], v[88:91]
    v_mfma_f32_16x16x32_bf16 v[92:95], v[16:19], a[8:11], v[92:95]
    buffer_load_dwordx4 a[112:115], v253, s[8:11], s28 offen offset:0 sc1
    v_mfma_f32_16x16x32_bf16 v[96:99], v[20:23], a[8:11], v[96:99]
    v_mfma_f32_16x16x32_bf16 v[100:103], v[24:27], a[8:11], v[100:103]
    buffer_load_dwordx4 a[164:167], v253, s[8:11], s33 offen offset:0 sc1
    v_mfma_f32_16x16x32_bf16 v[104:107], v[28:31], a[8:11], v[104:107]
    v_mfma_f32_16x16x32_bf16 v[108:111], v[32:35], a[8:11], v[108:111]
    v_mfma_f32_16x16x32_bf16 v[112:115], a[12:15], v[16:19], v[112:115]
    v_mfma_f32_16x16x32_bf16 v[116:119], a[12:15], v[20:23], v[116:119]
    v_mfma_f32_16x16x32_bf16 v[120:123], a[12:15], v[24:27], v[120:123]
    v_mfma_f32_16x16x32_bf16 v[124:127], a[12:15], v[28:31], v[124:127]
    v_mfma_f32_16x16x32_bf16 v[128:131], a[12:15], v[32:35], v[128:131]
    s_waitcnt vmcnt(11) lgkmcnt(0)
    s_barrier
    v_mfma_f32_16x16x32_bf16 v[56:59], a[16:19], v[40:43], v[56:59]
    ds_read_b128 v[16:19], v6 offset:15360
    v_mfma_f32_16x16x32_bf16 v[60:63], a[16:19], v[44:47], v[60:63]
    ds_read_b128 v[20:23], v6 offset:16384
    v_mfma_f32_16x16x32_bf16 v[64:67], a[16:19], v[48:51], v[64:67]
    ds_read_b128 v[24:27], v6 offset:17408
    v_mfma_f32_16x16x32_bf16 v[68:71], a[16:19], v[52:55], v[68:71]
    ds_read_b128 v[28:31], v6 offset:18432
    v_mfma_f32_16x16x32_bf16 v[72:75], a[20:23], v[36:39], v[72:75]
    ds_read_b128 v[32:35], v6 offset:19456
    v_mfma_f32_16x16x32_bf16 v[76:79], a[20:23], v[40:43], v[76:79]
    buffer_load_dwordx4 a[116:119], v253, s[8:11], s28 offen offset:1024 sc1
    v_mfma_f32_16x16x32_bf16 v[80:83], a[20:23], v[44:47], v[80:83]
    v_mfma_f32_16x16x32_bf16 v[84:87], a[20:23], v[48:51], v[84:87]
    buffer_load_dwordx4 a[120:123], v253, s[8:11], s28 offen offset:2048 sc1
    v_mfma_f32_16x16x32_bf16 v[88:91], a[20:23], v[52:55], v[88:91]
    v_mfma_f32_16x16x32_bf16 v[92:95], v[36:39], a[24:27], v[92:95]
    buffer_load_dwordx4 a[124:127], v253, s[8:11], s28 offen offset:3072 sc1
    s_add_u32 s28, s28, 4096
    v_mfma_f32_16x16x32_bf16 v[96:99], v[40:43], a[24:27], v[96:99]
    v_mfma_f32_16x16x32_bf16 v[100:103], v[44:47], a[24:27], v[100:103]
    buffer_load_dwordx4 a[168:171], v5, s[8:11], s34 offen offset:0 sc1
    v_mfma_f32_16x16x32_bf16 v[104:107], v[48:51], a[24:27], v[104:107]
    v_mfma_f32_16x16x32_bf16 v[108:111], v[52:55], a[24:27], v[108:111]
    v_mfma_f32_16x16x32_bf16 v[112:115], a[28:31], v[36:39], v[112:115]
    v_mfma_f32_16x16x32_bf16 v[116:119], a[28:31], v[40:43], v[116:119]
    v_mfma_f32_16x16x32_bf16 v[120:123], a[28:31], v[44:47], v[120:123]
    v_mfma_f32_16x16x32_bf16 v[124:127], a[28:31], v[48:51], v[124:127]
    v_mfma_f32_16x16x32_bf16 v[128:131], a[28:31], v[52:55], v[128:131]
    s_waitcnt vmcnt(29) lgkmcnt(0)
    v_mfma_f32_16x16x32_bf16 v[56:59], a[32:35], v[20:23], v[56:59]
    ds_read_b128 v[36:39], v6 offset:20480
    v_mfma_f32_16x16x32_bf16 v[60:63], a[32:35], v[24:27], v[60:63]
    ds_read_b128 v[40:43], v6 offset:21504
    v_mfma_f32_16x16x32_bf16 v[64:67], a[32:35], v[28:31], v[64:67]
    ds_read_b128 v[44:47], v6 offset:22528
    v_mfma_f32_16x16x32_bf16 v[68:71], a[32:35], v[32:35], v[68:71]
    ds_read_b128 v[48:51], v6 offset:23552
    v_mfma_f32_16x16x32_bf16 v[72:75], a[36:39], v[16:19], v[72:75]
    ds_read_b128 v[52:55], v6 offset:24576
    v_mfma_f32_16x16x32_bf16 v[76:79], a[36:39], v[20:23], v[76:79]
    buffer_load_dwordx4 a[172:175], v253, s[8:11], s32 offen offset:1024 sc1
    v_mfma_f32_16x16x32_bf16 v[80:83], a[36:39], v[24:27], v[80:83]
    v_mfma_f32_16x16x32_bf16 v[84:87], a[36:39], v[28:31], v[84:87]
    buffer_load_dwordx4 a[176:179], v253, s[8:11], s33 offen offset:1024 sc1
    v_mfma_f32_16x16x32_bf16 v[88:91], a[36:39], v[32:35], v[88:91]
    v_mfma_f32_16x16x32_bf16 v[92:95], v[16:19], a[40:43], v[92:95]
    buffer_load_dwordx4 a[180:183], v5, s[8:11], s34 offen offset:1024 sc1
    v_mfma_f32_16x16x32_bf16 v[96:99], v[20:23], a[40:43], v[96:99]
    v_mfma_f32_16x16x32_bf16 v[100:103], v[24:27], a[40:43], v[100:103]
    buffer_load_dwordx4 a[184:187], v253, s[8:11], s32 offen offset:2048 sc1
    v_mfma_f32_16x16x32_bf16 v[104:107], v[28:31], a[40:43], v[104:107]
    v_mfma_f32_16x16x32_bf16 v[108:111], v[32:35], a[40:43], v[108:111]
    v_mfma_f32_16x16x32_bf16 v[112:115], a[44:47], v[16:19], v[112:115]
    v_mfma_f32_16x16x32_bf16 v[116:119], a[44:47], v[20:23], v[116:119]
    v_mfma_f32_16x16x32_bf16 v[120:123], a[44:47], v[24:27], v[120:123]
    v_mfma_f32_16x16x32_bf16 v[124:127], a[44:47], v[28:31], v[124:127]
    v_mfma_f32_16x16x32_bf16 v[128:131], a[44:47], v[32:35], v[128:131]
    s_waitcnt vmcnt(27) lgkmcnt(0)
    v_mfma_f32_16x16x32_bf16 v[56:59], a[48:51], v[40:43], v[56:59]
    ds_read_b128 v[16:19], v6 offset:25600
    v_mfma_f32_16x16x32_bf16 v[60:63], a[48:51], v[44:47], v[60:63]
    ds_read_b128 v[20:23], v6 offset:26624
    v_mfma_f32_16x16x32_bf16 v[64:67], a[48:51], v[48:51], v[64:67]
    ds_read_b128 v[24:27], v6 offset:27648
    v_mfma_f32_16x16x32_bf16 v[68:71], a[48:51], v[52:55], v[68:71]
    ds_read_b128 v[28:31], v6 offset:28672
    v_mfma_f32_16x16x32_bf16 v[72:75], a[52:55], v[36:39], v[72:75]
    ds_read_b128 v[32:35], v6 offset:29696
    v_mfma_f32_16x16x32_bf16 v[76:79], a[52:55], v[40:43], v[76:79]
    buffer_load_dwordx4 a[188:191], v253, s[8:11], s33 offen offset:2048 sc1
    v_mfma_f32_16x16x32_bf16 v[80:83], a[52:55], v[44:47], v[80:83]
    v_mfma_f32_16x16x32_bf16 v[84:87], a[52:55], v[48:51], v[84:87]
    buffer_load_dwordx4 a[192:195], v5, s[8:11], s34 offen offset:2048 sc1
    v_mfma_f32_16x16x32_bf16 v[88:91], a[52:55], v[52:55], v[88:91]
    v_mfma_f32_16x16x32_bf16 v[92:95], v[36:39], a[56:59], v[92:95]
    buffer_load_dwordx4 a[196:199], v253, s[8:11], s32 offen offset:3072 sc1
    s_add_u32 s32, s32, 4096
    v_mfma_f32_16x16x32_bf16 v[96:99], v[40:43], a[56:59], v[96:99]
    v_mfma_f32_16x16x32_bf16 v[100:103], v[44:47], a[56:59], v[100:103]
    buffer_load_dwordx4 a[200:203], v253, s[8:11], s33 offen offset:3072 sc1
    s_add_u32 s33, s33, 4096
    v_mfma_f32_16x16x32_bf16 v[104:107], v[48:51], a[56:59], v[104:107]
    v_mfma_f32_16x16x32_bf16 v[108:111], v[52:55], a[56:59], v[108:111]
    v_mfma_f32_16x16x32_bf16 v[112:115], a[60:63], v[36:39], v[112:115]
    v_mfma_f32_16x16x32_bf16 v[116:119], a[60:63], v[40:43], v[116:119]
    v_mfma_f32_16x16x32_bf16 v[120:123], a[60:63], v[44:47], v[120:123]
    v_mfma_f32_16x16x32_bf16 v[124:127], a[60:63], v[48:51], v[124:127]
    v_mfma_f32_16x16x32_bf16 v[128:131], a[60:63], v[52:55], v[128:131]
    s_waitcnt vmcnt(25) lgkmcnt(0)
    v_mfma_f32_16x16x32_bf16 v[56:59], a[64:67], v[20:23], v[56:59]
    ds_read_b128 v[36:39], v6 offset:30720
    v_mfma_f32_16x16x32_bf16 v[60:63], a[64:67], v[24:27], v[60:63]
    ds_read_b128 v[40:43], v6 offset:31744
    v_mfma_f32_16x16x32_bf16 v[64:67], a[64:67], v[28:31], v[64:67]
    ds_read_b128 v[44:47], v6 offset:32768
    v_mfma_f32_16x16x32_bf16 v[68:71], a[64:67], v[32:35], v[68:71]
    ds_read_b128 v[48:51], v6 offset:33792
    v_mfma_f32_16x16x32_bf16 v[72:75], a[68:71], v[16:19], v[72:75]
    ds_read_b128 v[52:55], v6 offset:34816
    v_mfma_f32_16x16x32_bf16 v[76:79], a[68:71], v[20:23], v[76:79]
    buffer_load_dwordx4 a[204:207], v5, s[8:11], s34 offen offset:3072 sc1
    s_add_u32 s34, s34, 4096
    v_mfma_f32_16x16x32_bf16 v[80:83], a[68:71], v[24:27], v[80:83]
    v_mfma_f32_16x16x32_bf16 v[84:87], a[68:71], v[28:31], v[84:87]
    buffer_load_dwordx4 a[208:211], v253, s[8:11], s32 offen offset:0 sc1
    v_mfma_f32_16x16x32_bf16 v[88:91], a[68:71], v[32:35], v[88:91]
    v_mfma_f32_16x16x32_bf16 v[92:95], v[16:19], a[72:75], v[92:95]
    buffer_load_dwordx4 a[212:215], v253, s[8:11], s33 offen offset:0 sc1
    v_mfma_f32_16x16x32_bf16 v[96:99], v[20:23], a[72:75], v[96:99]
    v_mfma_f32_16x16x32_bf16 v[100:103], v[24:27], a[72:75], v[100:103]
    buffer_load_dwordx4 a[216:219], v5, s[8:11], s34 offen offset:0 sc1
    v_mfma_f32_16x16x32_bf16 v[104:107], v[28:31], a[72:75], v[104:107]
    v_mfma_f32_16x16x32_bf16 v[108:111], v[32:35], a[72:75], v[108:111]
    v_mfma_f32_16x16x32_bf16 v[112:115], a[76:79], v[16:19], v[112:115]
    v_mfma_f32_16x16x32_bf16 v[116:119], a[76:79], v[20:23], v[116:119]
    v_mfma_f32_16x16x32_bf16 v[120:123], a[76:79], v[24:27], v[120:123]
    v_mfma_f32_16x16x32_bf16 v[124:127], a[76:79], v[28:31], v[124:127]
    v_mfma_f32_16x16x32_bf16 v[128:131], a[76:79], v[32:35], v[128:131]
    s_waitcnt vmcnt(23) lgkmcnt(0)
    v_mfma_f32_16x16x32_bf16 v[56:59], a[80:83], v[40:43], v[56:59]
    ds_read_b128 v[16:19], v6 offset:35840
    v_mfma_f32_16x16x32_bf16 v[60:63], a[80:83], v[44:47], v[60:63]
    ds_read_b128 v[20:23], v6 offset:36864
    v_mfma_f32_16x16x32_bf16 v[64:67], a[80:83], v[48:51], v[64:67]
    ds_read_b128 v[24:27], v6 offset:37888
    v_mfma_f32_16x16x32_bf16 v[68:71], a[80:83], v[52:55], v[68:71]
    ds_read_b128 v[28:31], v6 offset:38912
    v_mfma_f32_16x16x32_bf16 v[72:75], a[84:87], v[36:39], v[72:75]
    ds_read_b128 v[32:35], v6 offset:39936
    v_mfma_f32_16x16x32_bf16 v[76:79], a[84:87], v[40:43], v[76:79]
    buffer_load_dwordx4 a[220:223], v253, s[8:11], s32 offen offset:1024 sc1
    v_mfma_f32_16x16x32_bf16 v[80:83], a[84:87], v[44:47], v[80:83]
    v_mfma_f32_16x16x32_bf16 v[84:87], a[84:87], v[48:51], v[84:87]
    buffer_load_dwordx4 a[224:227], v253, s[8:11], s33 offen offset:1024 sc1
    v_mfma_f32_16x16x32_bf16 v[88:91], a[84:87], v[52:55], v[88:91]
    v_mfma_f32_16x16x32_bf16 v[92:95], v[36:39], a[88:91], v[92:95]
    buffer_load_dwordx4 a[228:231], v5, s[8:11], s34 offen offset:1024 sc1
    v_mfma_f32_16x16x32_bf16 v[96:99], v[40:43], a[88:91], v[96:99]
    v_mfma_f32_16x16x32_bf16 v[100:103], v[44:47], a[88:91], v[100:103]
    buffer_load_dwordx4 a[232:235], v253, s[8:11], s32 offen offset:2048 sc1
    v_mfma_f32_16x16x32_bf16 v[104:107], v[48:51], a[88:91], v[104:107]
    v_mfma_f32_16x16x32_bf16 v[108:111], v[52:55], a[88:91], v[108:111]
    v_mfma_f32_16x16x32_bf16 v[112:115], a[92:95], v[36:39], v[112:115]
    v_mfma_f32_16x16x32_bf16 v[116:119], a[92:95], v[40:43], v[116:119]
    v_mfma_f32_16x16x32_bf16 v[120:123], a[92:95], v[44:47], v[120:123]
    v_mfma_f32_16x16x32_bf16 v[124:127], a[92:95], v[48:51], v[124:127]
    v_mfma_f32_16x16x32_bf16 v[128:131], a[92:95], v[52:55], v[128:131]
    s_waitcnt vmcnt(22) lgkmcnt(0)
    v_mfma_f32_16x16x32_bf16 v[56:59], a[96:99], v[20:23], v[56:59]
    ds_read_b128 v[36:39], v6 offset:40960
    v_mfma_f32_16x16x32_bf16 v[60:63], a[96:99], v[24:27], v[60:63]
    ds_read_b128 v[40:43], v6 offset:41984
    v_mfma_f32_16x16x32_bf16 v[64:67], a[96:99], v[28:31], v[64:67]
    ds_read_b128 v[44:47], v6 offset:43008
    v_mfma_f32_16x16x32_bf16 v[68:71], a[96:99], v[32:35], v[68:71]
    ds_read_b128 v[48:51], v6 offset:44032
    v_mfma_f32_16x16x32_bf16 v[72:75], a[100:103], v[16:19], v[72:75]
    ds_read_b128 v[52:55], v6 offset:45056
    v_mfma_f32_16x16x32_bf16 v[76:79], a[100:103], v[20:23], v[76:79]
    buffer_load_dwordx4 a[236:239], v253, s[8:11], s33 offen offset:2048 sc1
    v_mfma_f32_16x16x32_bf16 v[80:83], a[100:103], v[24:27], v[80:83]
    v_mfma_f32_16x16x32_bf16 v[84:87], a[100:103], v[28:31], v[84:87]
    buffer_load_dwordx4 a[240:243], v5, s[8:11], s34 offen offset:2048 sc1
    v_mfma_f32_16x16x32_bf16 v[88:91], a[100:103], v[32:35], v[88:91]
    v_mfma_f32_16x16x32_bf16 v[92:95], v[16:19], a[104:107], v[92:95]
    buffer_load_dwordx4 a[244:247], v253, s[8:11], s32 offen offset:3072 sc1
    s_add_u32 s32, s32, 4096
    v_mfma_f32_16x16x32_bf16 v[96:99], v[20:23], a[104:107], v[96:99]
    v_mfma_f32_16x16x32_bf16 v[100:103], v[24:27], a[104:107], v[100:103]
    buffer_load_dwordx4 a[248:251], v253, s[8:11], s33 offen offset:3072 sc1
    s_add_u32 s33, s33, 4096
    v_mfma_f32_16x16x32_bf16 v[104:107], v[28:31], a[104:107], v[104:107]
    v_mfma_f32_16x16x32_bf16 v[108:111], v[32:35], a[104:107], v[108:111]
    v_mfma_f32_16x16x32_bf16 v[112:115], a[108:111], v[16:19], v[112:115]
    v_mfma_f32_16x16x32_bf16 v[116:119], a[108:111], v[20:23], v[116:119]
    v_mfma_f32_16x16x32_bf16 v[120:123], a[108:111], v[24:27], v[120:123]
    v_mfma_f32_16x16x32_bf16 v[124:127], a[108:111], v[28:31], v[124:127]
    v_mfma_f32_16x16x32_bf16 v[128:131], a[108:111], v[32:35], v[128:131]
    s_waitcnt vmcnt(21) lgkmcnt(0)
    v_mfma_f32_16x16x32_bf16 v[56:59], a[112:115], v[40:43], v[56:59]
    v_mfma_f32_16x16x32_bf16 v[60:63], a[112:115], v[44:47], v[60:63]
    v_mfma_f32_16x16x32_bf16 v[64:67], a[112:115], v[48:51], v[64:67]
    v_mfma_f32_16x16x32_bf16 v[68:71], a[112:115], v[52:55], v[68:71]
    v_mfma_f32_16x16x32_bf16 v[72:75], a[116:119], v[36:39], v[72:75]
    v_mfma_f32_16x16x32_bf16 v[76:79], a[116:119], v[40:43], v[76:79]
    buffer_load_dwordx4 a[252:255], v5, s[8:11], s34 offen offset:3072 sc1
    s_add_u32 s34, s34, 4096
    v_mfma_f32_16x16x32_bf16 v[80:83], a[116:119], v[44:47], v[80:83]
    v_mfma_f32_16x16x32_bf16 v[84:87], a[116:119], v[48:51], v[84:87]
    buffer_load_dwordx4 a[128:131], v253, s[8:11], s32 offen offset:0 sc1
    v_mfma_f32_16x16x32_bf16 v[88:91], a[116:119], v[52:55], v[88:91]
    v_mfma_f32_16x16x32_bf16 v[92:95], v[36:39], a[120:123], v[92:95]
    buffer_load_dwordx4 a[132:135], v253, s[8:11], s33 offen offset:0 sc1
    v_mfma_f32_16x16x32_bf16 v[96:99], v[40:43], a[120:123], v[96:99]
    v_mfma_f32_16x16x32_bf16 v[100:103], v[44:47], a[120:123], v[100:103]
    buffer_load_dwordx4 a[136:139], v5, s[8:11], s34 offen offset:0 sc1
    v_mfma_f32_16x16x32_bf16 v[104:107], v[48:51], a[120:123], v[104:107]
    v_mfma_f32_16x16x32_bf16 v[108:111], v[52:55], a[120:123], v[108:111]
    v_mfma_f32_16x16x32_bf16 v[112:115], a[124:127], v[36:39], v[112:115]
    v_mfma_f32_16x16x32_bf16 v[116:119], a[124:127], v[40:43], v[116:119]
    v_mfma_f32_16x16x32_bf16 v[120:123], a[124:127], v[44:47], v[120:123]
    v_mfma_f32_16x16x32_bf16 v[124:127], a[124:127], v[48:51], v[124:127]
    v_mfma_f32_16x16x32_bf16 v[128:131], a[124:127], v[52:55], v[128:131]
    v_cvt_pk_bf16_f32 v136, v56, v57
    v_cvt_pk_bf16_f32 v137, v58, v59
    v_cvt_pk_bf16_f32 v140, v60, v61
    v_cvt_pk_bf16_f32 v141, v62, v63
    v_cvt_pk_bf16_f32 v144, v64, v65
    v_cvt_pk_bf16_f32 v145, v66, v67
    v_cvt_pk_bf16_f32 v148, v68, v69
    v_cvt_pk_bf16_f32 v149, v70, v71
    v_cvt_pk_bf16_f32 v152, v72, v73
    buffer_load_dwordx4 a[140:143], v253, s[8:11], s32 offen offset:1024 sc1
    v_cvt_pk_bf16_f32 v153, v74, v75
    v_cvt_pk_bf16_f32 v156, v76, v77
    v_cvt_pk_bf16_f32 v157, v78, v79
    v_cvt_pk_bf16_f32 v160, v80, v81
    v_cvt_pk_bf16_f32 v161, v82, v83
    v_cvt_pk_bf16_f32 v164, v84, v85
    v_cvt_pk_bf16_f32 v165, v86, v87
    v_cvt_pk_bf16_f32 v168, v88, v89
    v_cvt_pk_bf16_f32 v169, v90, v91
    buffer_load_dwordx4 a[144:147], v253, s[8:11], s33 offen offset:1024 sc1
    v_cvt_pk_bf16_f32 v134, v112, v113
    v_cvt_pk_bf16_f32 v154, v114, v115
    v_cvt_pk_bf16_f32 v138, v116, v117
    v_cvt_pk_bf16_f32 v158, v118, v119
    v_cvt_pk_bf16_f32 v142, v120, v121
    v_cvt_pk_bf16_f32 v162, v122, v123
    v_cvt_pk_bf16_f32 v146, v124, v125
    v_cvt_pk_bf16_f32 v166, v126, v127
    v_cvt_pk_bf16_f32 v150, v128, v129
    buffer_load_dwordx4 a[148:151], v5, s[8:11], s34 offen offset:1024 sc1
    v_cvt_pk_bf16_f32 v170, v130, v131
    v_cvt_pk_bf16_f32 v172, v92, v93
    v_cvt_pk_bf16_f32 v173, v94, v95
    v_cvt_pk_bf16_f32 v174, v96, v97
    v_cvt_pk_bf16_f32 v175, v98, v99
    v_cvt_pk_bf16_f32 v176, v100, v101
    v_cvt_pk_bf16_f32 v177, v102, v103
    v_cvt_pk_bf16_f32 v178, v104, v105
    v_cvt_pk_bf16_f32 v179, v106, v107
    buffer_load_dwordx4 a[152:155], v253, s[8:11], s32 offen offset:2048 sc1
    v_cvt_pk_bf16_f32 v180, v108, v109
    v_cvt_pk_bf16_f32 v181, v110, v111
    v_mfma_f32_16x16x32_bf16 v[16:19], v[152:155], v[136:139], v[208:211]
    v_mfma_f32_16x16x32_bf16 v[20:23], v[156:159], v[136:139], v[204:207]
    v_mfma_f32_16x16x32_bf16 v[24:27], v[156:159], v[140:143], v[200:203]
    v_mfma_f32_16x16x32_bf16 v[28:31], v[160:163], v[140:143], v[204:207]
    v_mfma_f32_16x16x32_bf16 v[32:35], v[160:163], v[144:147], v[200:203]
    v_mfma_f32_16x16x32_bf16 v[36:39], v[164:167], v[144:147], v[204:207]
    v_mfma_f32_16x16x32_bf16 v[40:43], v[164:167], v[148:151], v[200:203]
    buffer_load_dwordx4 a[156:159], v253, s[8:11], s33 offen offset:2048 sc1
    v_mfma_f32_16x16x32_bf16 v[44:47], v[168:171], v[148:151], v[204:207]
    v_mfma_f32_16x16x32_bf16 v[56:59], v[132:135], v[192:195], v[196:199]
    v_mfma_f32_16x16x32_bf16 v[60:63], v[136:139], v[192:195], v[196:199]
    v_mfma_f32_16x16x32_bf16 v[64:67], v[140:143], v[192:195], v[196:199]
    v_mfma_f32_16x16x32_bf16 v[68:71], v[144:147], v[192:195], v[196:199]
    v_mfma_f32_16x16x32_bf16 v[72:75], v[148:151], v[192:195], v[196:199]
    v_max3_f32 v92, v16, v17, v18
    v_max3_f32 v96, v19, v20, v21
    v_max3_f32 v93, v24, v25, v26
    buffer_load_dwordx4 a[0:3], v5, s[8:11], s34 offen offset:2048 sc1
    v_max3_f32 v97, v27, v28, v29
    v_max3_f32 v94, v32, v33, v34
    v_max3_f32 v98, v35, v36, v37
    v_max3_f32 v95, v40, v41, v42
    v_max3_f32 v99, v43, v44, v45
    v_max3_f32 v92, v92, v22, v23
    v_max3_f32 v93, v93, v30, v31
    v_max3_f32 v94, v94, v38, v39
    v_max3_f32 v95, v95, v46, v47
    buffer_load_dwordx4 a[4:7], v253, s[8:11], s32 offen offset:3072 sc1
    s_add_u32 s32, s32, 4096
    v_max_f32 v92, v92, v96
    v_max_f32 v93, v93, v97
    v_max_f32 v94, v94, v98
    v_max_f32 v95, v95, v99
    s_mov_b32 s18, 0x3eae1a93
    v_cvt_pk_bf16_f32 v182, v56, v57
    v_permlane32_swap_b32 v92, v93
    v_permlane32_swap_b32 v94, v95
    v_max_f32 v92, v92, v93
    buffer_load_dwordx4 a[8:11], v253, s[8:11], s33 offen offset:3072 sc1
    s_add_u32 s33, s33, 4096
    v_max_f32 v94, v94, v95
    v_cvt_pk_bf16_f32 v183, v58, v59
    v_cvt_pk_bf16_f32 v184, v60, v61
    v_permlane16_swap_b32 v92, v94
    v_max_f32 v92, v92, v94
    v_mul_f32 v92, 0xbeae1a93, v92
    v_mov_b32 v94, v92
    v_cvt_pk_bf16_f32 v185, v62, v63
    v_cvt_pk_bf16_f32 v186, v64, v65
    buffer_load_dwordx4 a[12:15], v5, s[8:11], s34 offen offset:3072 sc1
    s_add_u32 s34, s34, 4096
    v_permlane16_swap_b32 v92, v94
    v_mov_b32 v93, v92
    v_mov_b32 v95, v94
    v_cvt_pk_bf16_f32 v187, v66, v67
    v_cvt_pk_bf16_f32 v188, v68, v69
    v_permlane32_swap_b32 v92, v93
    v_permlane32_swap_b32 v94, v95
    v_cvt_pk_bf16_f32 v189, v70, v71
    v_cvt_pk_bf16_f32 v190, v72, v73
    buffer_load_dwordx4 a[16:19], v253, s[8:11], s32 offen offset:0 sc1
    v_cvt_pk_bf16_f32 v191, v74, v75
    v_fma_f32 v16, v16, s18, v92
    v_fma_f32 v17, v17, s18, v92
    v_fma_f32 v18, v18, s18, v92
    v_fma_f32 v19, v19, s18, v92
    v_fma_f32 v20, v20, s18, v92
    v_fma_f32 v21, v21, s18, v92
    v_fma_f32 v22, v22, s18, v92
    v_fma_f32 v23, v23, s18, v92
    buffer_load_dwordx4 a[20:23], v253, s[8:11], s33 offen offset:0 sc1
    v_exp_f32 v16, v16
    v_exp_f32 v17, v17
    v_exp_f32 v18, v18
    v_exp_f32 v19, v19
    v_exp_f32 v20, v20
    v_exp_f32 v21, v21
    v_exp_f32 v22, v22
    v_exp_f32 v23, v23
    s_nop 0
    buffer_load_dwordx4 a[24:27], v5, s[8:11], s34 offen offset:0 sc1
    v_cvt_pk_bf16_f32 v76, v16, v17
    v_cvt_pk_bf16_f32 v77, v18, v19
    v_cvt_pk_bf16_f32 v78, v20, v21
    v_cvt_pk_bf16_f32 v79, v22, v23
    v_fma_f32 v24, v24, s18, v93
    v_fma_f32 v25, v25, s18, v93
    v_fma_f32 v26, v26, s18, v93
    v_fma_f32 v27, v27, s18, v93
    v_fma_f32 v28, v28, s18, v93
    buffer_load_dwordx4 a[28:31], v253, s[8:11], s32 offen offset:1024 sc1
    v_fma_f32 v29, v29, s18, v93
    v_fma_f32 v30, v30, s18, v93
    v_fma_f32 v31, v31, s18, v93
    v_exp_f32 v24, v24
    v_exp_f32 v25, v25
    v_exp_f32 v26, v26
    v_exp_f32 v27, v27
    v_exp_f32 v28, v28
    v_exp_f32 v29, v29
    buffer_load_dwordx4 a[32:35], v253, s[8:11], s33 offen offset:1024 sc1
    v_exp_f32 v30, v30
    v_exp_f32 v31, v31
    v_mfma_f32_16x16x32_bf16 v[100:103], v[172:175], v[76:79], 0
    v_mfma_f32_16x16x32_bf16 v[116:119], v[182:185], v[76:79], 0
    v_cvt_pk_bf16_f32 v80, v24, v25
    v_cvt_pk_bf16_f32 v81, v26, v27
    v_cvt_pk_bf16_f32 v82, v28, v29
    v_cvt_pk_bf16_f32 v83, v30, v31
    v_fma_f32 v32, v32, s18, v94
    buffer_load_dwordx4 a[36:39], v5, s[8:11], s34 offen offset:1024 sc1
    v_fma_f32 v33, v33, s18, v94
    v_fma_f32 v34, v34, s18, v94
    v_fma_f32 v35, v35, s18, v94
    v_fma_f32 v36, v36, s18, v94
    v_fma_f32 v37, v37, s18, v94
    v_fma_f32 v38, v38, s18, v94
    v_fma_f32 v39, v39, s18, v94
    v_exp_f32 v32, v32
    v_exp_f32 v33, v33
    buffer_load_dwordx4 a[40:43], v253, s[8:11], s32 offen offset:2048 sc1
    v_exp_f32 v34, v34
    v_exp_f32 v35, v35
    v_exp_f32 v36, v36
    v_exp_f32 v37, v37
    v_exp_f32 v38, v38
    v_exp_f32 v39, v39
    v_mfma_f32_16x16x32_bf16 v[104:107], v[174:177], v[80:83], 0
    v_mfma_f32_16x16x32_bf16 v[120:123], v[184:187], v[80:83], 0
    v_cvt_pk_bf16_f32 v84, v32, v33
    buffer_load_dwordx4 a[44:47], v253, s[8:11], s33 offen offset:2048 sc1
    v_cvt_pk_bf16_f32 v85, v34, v35
    v_cvt_pk_bf16_f32 v86, v36, v37
    v_cvt_pk_bf16_f32 v87, v38, v39
    v_fma_f32 v40, v40, s18, v95
    v_fma_f32 v41, v41, s18, v95
    v_fma_f32 v42, v42, s18, v95
    v_fma_f32 v43, v43, s18, v95
    v_fma_f32 v44, v44, s18, v95
    v_fma_f32 v45, v45, s18, v95
    buffer_load_dwordx4 a[48:51], v5, s[8:11], s34 offen offset:2048 sc1
    v_fma_f32 v46, v46, s18, v95
    v_fma_f32 v47, v47, s18, v95
    v_exp_f32 v40, v40
    v_exp_f32 v41, v41
    v_exp_f32 v42, v42
    v_exp_f32 v43, v43
    v_exp_f32 v44, v44
    v_exp_f32 v45, v45
    v_exp_f32 v46, v46
    buffer_load_dwordx4 a[52:55], v253, s[8:11], s32 offen offset:3072 sc1
    s_add_u32 s32, s32, 4096
    v_exp_f32 v47, v47
    v_mfma_f32_16x16x32_bf16 v[108:111], v[176:179], v[84:87], 0
    v_mfma_f32_16x16x32_bf16 v[124:127], v[186:189], v[84:87], 0
    v_cvt_pk_bf16_f32 v88, v40, v41
    v_cvt_pk_bf16_f32 v89, v42, v43
    v_cvt_pk_bf16_f32 v90, v44, v45
    v_cvt_pk_bf16_f32 v91, v46, v47
    v_rcp_f32 v96, v118
    v_rcp_f32 v97, v122
    buffer_load_dwordx4 v[240:243], v9, s[8:11], s37 offen offset:0 sc1
    v_mfma_f32_16x16x32_bf16 v[112:115], v[178:181], v[88:91], 0
    v_mfma_f32_16x16x32_bf16 v[128:131], v[188:191], v[88:91], 0
    v_pk_mul_f32 v[100:101], v[96:97], v[100:101] op_sel:[0,0] op_sel_hi:[0,1]
    v_pk_mul_f32 v[102:103], v[96:97], v[102:103] op_sel:[0,0] op_sel_hi:[0,1]
    v_pk_mul_f32 v[116:117], v[96:97], v[116:117] op_sel:[0,0] op_sel_hi:[0,1]
    v_cvt_pk_bf16_f32 v212, v100, v101
    v_cvt_pk_bf16_f32 v213, v102, v103
    v_cvt_pk_bf16_f32 v220, v116, v117
    v_rcp_f32 v98, v126
    buffer_load_dwordx4 v[244:247], v9, s[8:11], s37 offen offset:1024 sc1
    v_pk_mul_f32 v[104:105], v[96:97], v[104:105] op_sel:[1,0] op_sel_hi:[1,1]
    v_pk_mul_f32 v[106:107], v[96:97], v[106:107] op_sel:[1,0] op_sel_hi:[1,1]
    v_pk_mul_f32 v[120:121], v[96:97], v[120:121] op_sel:[1,0] op_sel_hi:[1,1]
    v_cvt_pk_bf16_f32 v214, v104, v105
    v_cvt_pk_bf16_f32 v215, v106, v107
    v_cvt_pk_bf16_f32 v221, v120, v121
    v_rcp_f32 v99, v130
    v_permlane16_swap_b32 v212, v214
    v_permlane16_swap_b32 v213, v215
    buffer_load_dwordx4 v[248:251], v7, s[8:11], s37 offen offset:2048 sc1
    v_pk_mul_f32 v[108:109], v[98:99], v[108:109] op_sel:[0,0] op_sel_hi:[0,1]
    v_pk_mul_f32 v[110:111], v[98:99], v[110:111] op_sel:[0,0] op_sel_hi:[0,1]
    v_pk_mul_f32 v[124:125], v[98:99], v[124:125] op_sel:[0,0] op_sel_hi:[0,1]
    v_cvt_pk_bf16_f32 v216, v108, v109
    v_cvt_pk_bf16_f32 v217, v110, v111
    v_cvt_pk_bf16_f32 v222, v124, v125
    v_pk_mul_f32 v[112:113], v[98:99], v[112:113] op_sel:[1,0] op_sel_hi:[1,1]
    v_pk_mul_f32 v[114:115], v[98:99], v[114:115] op_sel:[1,0] op_sel_hi:[1,1]
    v_pk_mul_f32 v[128:129], v[98:99], v[128:129] op_sel:[1,0] op_sel_hi:[1,1]
    buffer_load_dword v252, v8, s[8:11], s47 offen sc1
    v_cvt_pk_bf16_f32 v218, v112, v113
    v_cvt_pk_bf16_f32 v219, v114, v115
    v_cvt_pk_bf16_f32 v223, v128, v129
    s_lshl_b32 s7, s3, 2
    s_add_u32 s7, s7, 94208
    v_permlane16_swap_b32 v220, v221
    v_permlane16_swap_b32 v222, v223
    v_add_u32 v11, s7, v253
    v_lshrrev_b32 v10, 3, v0
    v_permlane32_swap_b32 v220, v222
    v_mul_u32_u24 v10, 9216, v10
    ds_write_b32 v11, v220
    v_permlane16_swap_b32 v216, v218
    v_permlane16_swap_b32 v217, v219
    s_mul_i32 s7, s40, 1152
    s_add_u32 s22, s22, s7
    s_add_u32 s22, s22, 41156608
    s_lshl_b32 s7, s3, 8
    s_add_u32 s23, s22, s7
    s_add_u32 s24, s23, 36864
    buffer_store_dwordx4 v[212:215], v9, s[8:11], s23 offen sc1
    buffer_store_dwordx4 v[216:219], v9, s[8:11], s24 offen sc1
    v_and_b32 v11, 7, v0
    v_lshl_add_u32 v10, v11, 4, v10
    s_cmp_eq_u32 s3, 3
    s_cselect_b32 s7, 0, 1073741824
    v_add_u32 v10, s7, v10
    v_add_u32 v11, 94208, v253
    s_waitcnt lgkmcnt(0)
    s_barrier
    ds_read_b128 v[220:223], v11
    s_waitcnt lgkmcnt(0)
    buffer_store_dwordx4 v[220:223], v10, s[8:11], s22 offen offset:1024 sc1
    v_lshlrev_b32 v15, 7, v0
    s_lshl_b32 s6, s40, 2
    s_add_u32 s6, s6, s44
    v_mov_b32 v1, s76
    s_mov_b64 vcc, 0xff
    s_waitcnt vmcnt(0)
    s_barrier
    s_cmp_lg_u32 s3, 0
    s_cbranch_scc1 L_pub_17
    s_mov_b64 exec, vcc
    buffer_store_dword v1, v15, s[8:11], s6 offen sc1
L_pub_17:
    s_mov_b64 exec, -1
    buffer_load_dwordx4 a[56:59], v253, s[8:11], s33 offen offset:3072 sc1
    s_add_u32 s33, s33, 4096
    buffer_load_dwordx4 a[60:63], v5, s[8:11], s34 offen offset:3072 sc1
    s_add_u32 s34, s34, 4096
    buffer_load_dwordx4 a[64:67], v253, s[8:11], s32 offen offset:0 sc1
    buffer_load_dwordx4 a[68:71], v253, s[8:11], s33 offen offset:0 sc1
    buffer_load_dwordx4 a[72:75], v5, s[8:11], s34 offen offset:0 sc1
    buffer_load_dwordx4 a[76:79], v253, s[8:11], s32 offen offset:1024 sc1
    buffer_load_dwordx4 a[80:83], v253, s[8:11], s33 offen offset:1024 sc1
    buffer_load_dwordx4 a[84:87], v5, s[8:11], s34 offen offset:1024 sc1
    s_cmp_lg_u32 s42, 0
    s_cbranch_scc1 L_swz_18
    s_cmp_eq_u32 s93, 2
    s_cselect_b32 s6, 2, 3
    s_mov_b32 s7, 512
    s_cmov_b32 s7, 2048
    v_lshrrev_b32 v14, 4, v0
    v_lshlrev_b32 v14, s6, v14
    v_bfe_u32 v15, v0, 2, 2
    v_add_u32 v14, v14, v15
    v_mul_u32_u24 v14, 128, v14
    v_and_b32 v15, 3, v0
    v_lshl_add_u32 v14, v15, 3, v14
    v_add_u32 v14, s79, v14
    v_add_u32 v15, s7, v14
    ds_read_b64_tr_b16 v[76:77], v14 offset:0
    ds_read_b64_tr_b16 v[78:79], v15 offset:0
    ds_read_b64_tr_b16 v[80:81], v14 offset:32
    ds_read_b64_tr_b16 v[82:83], v15 offset:32
    ds_read_b64_tr_b16 v[84:85], v14 offset:64
    ds_read_b64_tr_b16 v[86:87], v15 offset:64
    ds_read_b64_tr_b16 v[88:89], v14 offset:96
    ds_read_b64_tr_b16 v[90:91], v15 offset:96
    ds_read_b64_tr_b16 v[92:93], v14 offset:4096
    ds_read_b64_tr_b16 v[94:95], v15 offset:4096
    ds_read_b64_tr_b16 v[96:97], v14 offset:4128
    ds_read_b64_tr_b16 v[98:99], v15 offset:4128
    ds_read_b64_tr_b16 v[176:177], v14 offset:4160
    ds_read_b64_tr_b16 v[178:179], v15 offset:4160
    ds_read_b64_tr_b16 v[180:181], v14 offset:4192
    ds_read_b64_tr_b16 v[182:183], v15 offset:4192
    ds_read_b64_tr_b16 v[196:197], v14 offset:8192
    ds_read_b64_tr_b16 v[198:199], v15 offset:8192
    ds_read_b64_tr_b16 v[200:201], v14 offset:8224
    ds_read_b64_tr_b16 v[202:203], v15 offset:8224
    ds_read_b64_tr_b16 v[204:205], v14 offset:8256
    ds_read_b64_tr_b16 v[206:207], v15 offset:8256
    ds_read_b64_tr_b16 v[208:209], v14 offset:8288
    ds_read_b64_tr_b16 v[210:211], v15 offset:8288
    ds_read_b64_tr_b16 v[212:213], v14 offset:12288
    ds_read_b64_tr_b16 v[214:215], v15 offset:12288
    ds_read_b64_tr_b16 v[216:217], v14 offset:12320
    ds_read_b64_tr_b16 v[218:219], v15 offset:12320
    ds_read_b64_tr_b16 v[220:221], v14 offset:12352
    ds_read_b64_tr_b16 v[222:223], v15 offset:12352
    ds_read_b64_tr_b16 v[228:229], v14 offset:12384
    ds_read_b64_tr_b16 v[230:231], v15 offset:12384
    s_mul_i32 s68, s40, 1990656
    s_add_u32 s68, s68, 3145728
    s_cmp_eq_u32 s93, 2
    s_cbranch_scc1 L_swz_down_19
    s_mul_i32 s6, s84, 349526
    s_lshr_b32 s6, s6, 20
    s_mul_i32 s7, s6, 3
    s_sub_u32 s7, s84, s7
    s_mul_i32 s6, s6, 6
    s_add_u32 s7, s7, s6
    s_mul_i32 s6, s88, 36
    s_add_u32 s7, s7, s6
    s_mul_i32 s6, s93, 3
    s_add_u32 s7, s7, s6
    s_lshl_b32 s7, s7, 10
    s_add_u32 s7, s7, s68
    s_add_u32 s80, s7, 0
    s_add_u32 s81, s7, 497664
    s_add_u32 s82, s7, 995328
    s_add_u32 s83, s7, 1492992
    s_mul_i32 s6, s85, 349526
    s_lshr_b32 s6, s6, 20
    s_mul_i32 s7, s6, 3
    s_sub_u32 s7, s85, s7
    s_mul_i32 s6, s6, 6
    s_add_u32 s7, s7, s6
    s_mul_i32 s6, s89, 36
    s_add_u32 s7, s7, s6
    s_mul_i32 s6, s93, 3
    s_add_u32 s7, s7, s6
    s_lshl_b32 s7, s7, 10
    s_add_u32 s7, s7, s68
    s_add_u32 s64, s7, 0
    s_add_u32 s65, s7, 497664
    s_add_u32 s18, s7, 995328
    s_add_u32 s19, s7, 1492992
    s_mul_i32 s6, s86, 349526
    s_lshr_b32 s6, s6, 20
    s_mul_i32 s7, s6, 3
    s_sub_u32 s7, s86, s7
    s_mul_i32 s6, s6, 6
    s_add_u32 s7, s7, s6
    s_mul_i32 s6, s90, 36
    s_add_u32 s7, s7, s6
    s_mul_i32 s6, s93, 3
    s_add_u32 s7, s7, s6
    s_lshl_b32 s7, s7, 10
    s_add_u32 s7, s7, s68
    s_add_u32 s20, s7, 0
    s_add_u32 s21, s7, 497664
    s_add_u32 s22, s7, 995328
    s_add_u32 s25, s7, 1492992
    s_mul_i32 s6, s87, 349526
    s_lshr_b32 s6, s6, 20
    s_mul_i32 s7, s6, 3
    s_sub_u32 s7, s87, s7
    s_mul_i32 s6, s6, 6
    s_add_u32 s7, s7, s6
    s_mul_i32 s6, s91, 36
    s_add_u32 s7, s7, s6
    s_mul_i32 s6, s93, 3
    s_add_u32 s7, s7, s6
    s_lshl_b32 s7, s7, 10
    s_add_u32 s7, s7, s68
    s_add_u32 s26, s7, 0
    s_add_u32 s27, s7, 497664
    s_add_u32 s28, s7, 995328
    s_add_u32 s29, s7, 1492992
    s_branch L_swz_dest_20
L_swz_down_19:
    s_mul_i32 s7, s88, 18
    s_add_u32 s7, s7, s84
    s_add_u32 s7, s7, 324
    s_lshl_b32 s7, s7, 10
    s_add_u32 s7, s7, s68
    s_add_u32 s80, s7, 0
    s_add_u32 s81, s7, 497664
    s_add_u32 s82, s7, 995328
    s_add_u32 s83, s7, 1492992
    s_mul_i32 s7, s89, 18
    s_add_u32 s7, s7, s85
    s_add_u32 s7, s7, 324
    s_lshl_b32 s7, s7, 10
    s_add_u32 s7, s7, s68
    s_add_u32 s64, s7, 0
    s_add_u32 s65, s7, 497664
    s_add_u32 s18, s7, 995328
    s_add_u32 s19, s7, 1492992
    s_mul_i32 s7, s90, 18
    s_add_u32 s7, s7, s86
    s_add_u32 s7, s7, 324
    s_lshl_b32 s7, s7, 10
    s_add_u32 s7, s7, s68
    s_add_u32 s20, s7, 0
    s_add_u32 s21, s7, 497664
    s_add_u32 s22, s7, 995328
    s_add_u32 s25, s7, 1492992
    s_mul_i32 s7, s91, 18
    s_add_u32 s7, s7, s87
    s_add_u32 s7, s7, 324
    s_lshl_b32 s7, s7, 10
    s_add_u32 s7, s7, s68
    s_add_u32 s26, s7, 0
    s_add_u32 s27, s7, 497664
    s_add_u32 s28, s7, 995328
    s_add_u32 s29, s7, 1492992
L_swz_dest_20:
    s_mov_b32 s72, s8
    s_mov_b32 s73, s9
    s_mov_b32 s74, 268435456
    s_waitcnt lgkmcnt(0)
    buffer_store_dwordx4 v[76:79], v253, s[72:75], s80 offen sc1
    buffer_store_dwordx4 v[80:83], v253, s[72:75], s81 offen sc1
    buffer_store_dwordx4 v[84:87], v253, s[72:75], s82 offen sc1
    buffer_store_dwordx4 v[88:91], v253, s[72:75], s83 offen sc1
    buffer_store_dwordx4 v[92:95], v253, s[72:75], s64 offen sc1
    buffer_store_dwordx4 v[96:99], v253, s[72:75], s65 offen sc1
    buffer_store_dwordx4 v[176:179], v253, s[72:75], s18 offen sc1
    buffer_store_dwordx4 v[180:183], v253, s[72:75], s19 offen sc1
    buffer_store_dwordx4 v[196:199], v253, s[72:75], s20 offen sc1
    buffer_store_dwordx4 v[200:203], v253, s[72:75], s21 offen sc1
    buffer_store_dwordx4 v[204:207], v253, s[72:75], s22 offen sc1
    buffer_store_dwordx4 v[208:211], v253, s[72:75], s25 offen sc1
    buffer_store_dwordx4 v[212:215], v253, s[72:75], s26 offen sc1
    buffer_store_dwordx4 v[216:219], v253, s[72:75], s27 offen sc1
    buffer_store_dwordx4 v[220:223], v253, s[72:75], s28 offen sc1
    buffer_store_dwordx4 v[228:231], v253, s[72:75], s29 offen sc1
    s_lshr_b32 s7, s2, 3
    s_lshl_b32 s7, s7, 2
    s_add_u32 s7, s7, s3
    s_lshl_b32 s7, s7, 9
    v_lshrrev_b32 v1, 1, v253
    v_add_u32 v1, s7, v1
    buffer_load_dwordx2 v[14:15], v1, s[96:99], 0 offen
L_swz_18:
    s_and_b32 s7, s3, 1
    s_mul_i32 s7, s7, 18432
    s_add_u32 s24, s30, s7
    s_lshr_b32 s7, s3, 1
    s_lshl_b32 s7, s7, 9
    s_add_u32 s24, s24, s7
    s_add_u32 s24, s24, 41156608
    s_mov_b32 s16, 0xffff0000
    v_lshlrev_b32 v124, 16, v240
    v_and_b32 v125, s16, v240
    v_lshlrev_b32 v126, 16, v241
    v_and_b32 v127, s16, v241
    v_lshlrev_b32 v128, 16, v242
    v_and_b32 v129, s16, v242
    v_lshlrev_b32 v130, 16, v243
    v_and_b32 v131, s16, v243
    v_lshlrev_b32 v132, 16, v244
    v_and_b32 v133, s16, v244
    v_lshlrev_b32 v134, 16, v245
    v_and_b32 v135, s16, v245
    v_lshlrev_b32 v136, 16, v246
    v_and_b32 v137, s16, v246
    v_lshlrev_b32 v138, 16, v247
    v_and_b32 v139, s16, v247
    v_lshlrev_b32 v140, 16, v248
    v_and_b32 v141, s16, v248
    v_lshlrev_b32 v142, 16, v249
    v_and_b32 v143, s16, v249
    v_lshlrev_b32 v144, 16, v250
    v_and_b32 v145, s16, v250
    v_lshlrev_b32 v146, 16, v251
    v_and_b32 v147, s16, v251
    s_cmp_eq_u32 s3, 1
    s_cselect_b32 s7, 16, 0
    v_lshlrev_b32 v12, 2, v0
    v_cmp_gt_u32 vcc, s7, v0
    v_add_u32 v10, 40960, v12
    v_add_u32 v11, 41472, v12
    v_cndmask_b32 v10, v11, v10, vcc
    v_and_b32 v11, 0x7c, v12
    v_cmp_gt_u32 vcc, 32, v0
    v_mov_b32 v13, 1073741824
    s_and_b32 s7, s40, 3
    s_lshl_b32 s45, s45, 2
    v_cndmask_b32 v8, v13, v12, vcc
    s_add_u32 s6, s7, s3
    s_cmp_eq_u32 s6, 0
    s_cselect_b32 s6, 0, 1073741824
    v_add_u32 v6, s6, v8
    s_add_u32 s45, s45, s7
    s_lshl_b32 s45, s45, 2
    s_add_u32 s45, s45, s3
    s_lshl_b32 s45, s45, 7
    s_add_u32 s45, s45, s43
    s_add_u32 s45, s45, 48300032
    s_cmp_eq_u32 s3, 0
    s_cselect_b32 s35, 1.0, 0
    s_lshl_b32 s7, s40, 2
    s_add_u32 s7, s7, s3
    s_mul_i32 s23, s7, 497664
    s_add_u32 s23, s23, 3145728
    s_add_u32 s50, s23, 497664
    s_mul_i32 s50, s50, s42
    v_mov_b32 v184, v253
    v_add_u32 v185, 4096, v253
    v_add_u32 v186, 8192, v253
    v_add_u32 v187, 12288, v253
    v_add_u32 v188, 16384, v253
    v_add_u32 v189, 20480, v253
    v_add_u32 v190, 24576, v253
    v_add_u32 v191, 28672, v253
    v_add_u32 v192, 32768, v253
    s_cmp_lg_u32 s3, 0
    s_cbranch_scc1 L_pollout_23
    s_lshl_b32 s7, s40, 7
    s_add_u32 s7, s7, s44
    s_add_u32 s52, s4, s7
    s_addc_u32 s53, s5, 0
    s_mov_b32 s6, 0
L_poll_21:
    s_load_dwordx8 s[56:63], s[52:53], 0 glc
    s_add_u32 s6, s6, 1
    s_waitcnt lgkmcnt(0)
    s_xor_b64 s[56:57], s[56:57], s[76:77]
    s_xor_b64 s[58:59], s[58:59], s[76:77]
    s_xor_b64 s[60:61], s[60:61], s[76:77]
    s_xor_b64 s[62:63], s[62:63], s[76:77]
    s_or_b64 s[56:57], s[56:57], s[58:59]
    s_or_b64 s[60:61], s[60:61], s[62:63]
    s_or_b64 s[56:57], s[56:57], s[60:61]
    s_cbranch_scc0 L_polled_22
    s_cmp_lt_u32 s6, 1048576
    s_cbranch_scc1 L_poll_21
    s_branch L_main_end
L_polled_22:
L_pollout_23:
    s_barrier
    s_lshl_b32 m0, s3, 10
    s_nop 0
    buffer_load_dwordx4 v2, s[8:11], s24 offen sc1 lds
    s_add_u32 m0, m0, 4096
    s_add_u32 s24, s24, 1024
    buffer_load_dwordx4 v2, s[8:11], s24 offen sc1 lds
    s_add_u32 m0, m0, 4096
    s_add_u32 s24, s24, 1024
    buffer_load_dwordx4 v2, s[8:11], s24 offen sc1 lds
    s_add_u32 m0, m0, 4096
    s_add_u32 s24, s24, 1024
    buffer_load_dwordx4 v2, s[8:11], s24 offen sc1 lds
    s_add_u32 m0, m0, 4096
    s_add_u32 s24, s24, 1024
    buffer_load_dwordx4 v2, s[8:11], s24 offen sc1 lds
    s_add_u32 m0, m0, 4096
    s_add_u32 s24, s24, 1024
    buffer_load_dwordx4 v2, s[8:11], s24 offen sc1 lds
    s_add_u32 m0, m0, 4096
    s_add_u32 s24, s24, 1024
    buffer_load_dwordx4 v2, s[8:11], s24 offen sc1 lds
    s_add_u32 m0, m0, 4096
    s_add_u32 s24, s24, 1024
    buffer_load_dwordx4 v2, s[8:11], s24 offen sc1 lds
    s_add_u32 m0, m0, 4096
    s_add_u32 s24, s24, 1024
    buffer_load_dwordx4 v2, s[8:11], s24 offen sc1 lds
    s_waitcnt vmcnt(0)
    s_barrier
    s_add_u32 s7, s42, s3
    s_cmp_lg_u32 s7, 0
    s_cbranch_scc1 L_swz_24
    v_lshlrev_b32 v15, 10, v0
    s_lshl_b32 s6, s40, 7
    s_lshl_b32 s7, s41, 2
    s_add_u32 s6, s6, s7
    s_add_u32 s6, s6, 19464192
    s_mov_b64 exec, 0xffffffff
    v_lshlrev_b32 v15, 10, v0
    v_mov_b32 v1, s76
    buffer_store_dword v1, v15, s[8:11], s6 offen sc1
    s_mov_b64 exec, -1
L_swz_24:
    ds_read_b128 v[160:163], v253 offset:0
    ds_read_b128 v[164:167], v253 offset:1024
    s_waitcnt lgkmcnt(0)
    v_mfma_f32_16x16x32_bf16 v[100:103], a[160:163], v[160:163], 0
    ds_read_b128 v[168:171], v253 offset:2048
    v_mfma_f32_16x16x32_bf16 v[104:107], a[160:163], v[164:167], 0
    ds_read_b128 v[172:175], v253 offset:3072
    v_mfma_f32_16x16x32_bf16 v[108:111], a[164:167], v[160:163], 0
    v_mfma_f32_16x16x32_bf16 v[112:115], a[164:167], v[164:167], 0
    buffer_load_dwordx4 v[16:19], v184, s[48:51], s23 offen offset:0 sc1
    v_mfma_f32_16x16x32_bf16 v[116:119], a[168:171], v[160:163], 0
    v_mfma_f32_16x16x32_bf16 v[120:123], a[168:171], v[164:167], 0
    s_waitcnt lgkmcnt(0)
    v_mfma_f32_16x16x32_bf16 v[100:103], a[172:175], v[168:171], v[100:103]
    ds_read_b128 v[160:163], v253 offset:4096
    v_mfma_f32_16x16x32_bf16 v[104:107], a[172:175], v[172:175], v[104:107]
    ds_read_b128 v[164:167], v253 offset:5120
    v_mfma_f32_16x16x32_bf16 v[108:111], a[176:179], v[168:171], v[108:111]
    v_mfma_f32_16x16x32_bf16 v[112:115], a[176:179], v[172:175], v[112:115]
    buffer_load_dwordx4 v[20:23], v184, s[48:51], s23 offen offset:1024 sc1
    v_mfma_f32_16x16x32_bf16 v[116:119], a[180:183], v[168:171], v[116:119]
    v_mfma_f32_16x16x32_bf16 v[120:123], a[180:183], v[172:175], v[120:123]
    s_waitcnt lgkmcnt(0)
    v_mfma_f32_16x16x32_bf16 v[100:103], a[184:187], v[160:163], v[100:103]
    ds_read_b128 v[168:171], v253 offset:6144
    v_mfma_f32_16x16x32_bf16 v[104:107], a[184:187], v[164:167], v[104:107]
    ds_read_b128 v[172:175], v253 offset:7168
    v_mfma_f32_16x16x32_bf16 v[108:111], a[188:191], v[160:163], v[108:111]
    v_mfma_f32_16x16x32_bf16 v[112:115], a[188:191], v[164:167], v[112:115]
    buffer_load_dwordx4 v[24:27], v184, s[48:51], s23 offen offset:2048 sc1
    v_mfma_f32_16x16x32_bf16 v[116:119], a[192:195], v[160:163], v[116:119]
    v_mfma_f32_16x16x32_bf16 v[120:123], a[192:195], v[164:167], v[120:123]
    s_waitcnt lgkmcnt(0)
    v_mfma_f32_16x16x32_bf16 v[100:103], a[196:199], v[168:171], v[100:103]
    ds_read_b128 v[160:163], v253 offset:8192
    v_mfma_f32_16x16x32_bf16 v[104:107], a[196:199], v[172:175], v[104:107]
    ds_read_b128 v[164:167], v253 offset:9216
    v_mfma_f32_16x16x32_bf16 v[108:111], a[200:203], v[168:171], v[108:111]
    v_mfma_f32_16x16x32_bf16 v[112:115], a[200:203], v[172:175], v[112:115]
    buffer_load_dwordx4 v[28:31], v184, s[48:51], s23 offen offset:3072 sc1
    v_mfma_f32_16x16x32_bf16 v[116:119], a[204:207], v[168:171], v[116:119]
    v_mfma_f32_16x16x32_bf16 v[120:123], a[204:207], v[172:175], v[120:123]
    s_waitcnt lgkmcnt(0)
    v_mfma_f32_16x16x32_bf16 v[100:103], a[208:211], v[160:163], v[100:103]
    ds_read_b128 v[168:171], v253 offset:10240
    v_mfma_f32_16x16x32_bf16 v[104:107], a[208:211], v[164:167], v[104:107]
    ds_read_b128 v[172:175], v253 offset:11264
    v_mfma_f32_16x16x32_bf16 v[108:111], a[212:215], v[160:163], v[108:111]
    v_mfma_f32_16x16x32_bf16 v[112:115], a[212:215], v[164:167], v[112:115]
    buffer_load_dwordx4 v[32:35], v185, s[48:51], s23 offen offset:0 sc1
    v_mfma_f32_16x16x32_bf16 v[116:119], a[216:219], v[160:163], v[116:119]
    v_mfma_f32_16x16x32_bf16 v[120:123], a[216:219], v[164:167], v[120:123]
    s_waitcnt lgkmcnt(0)
    v_mfma_f32_16x16x32_bf16 v[100:103], a[220:223], v[168:171], v[100:103]
    ds_read_b128 v[160:163], v253 offset:12288
    v_mfma_f32_16x16x32_bf16 v[104:107], a[220:223], v[172:175], v[104:107]
    ds_read_b128 v[164:167], v253 offset:13312
    v_mfma_f32_16x16x32_bf16 v[108:111], a[224:227], v[168:171], v[108:111]
    v_mfma_f32_16x16x32_bf16 v[112:115], a[224:227], v[172:175], v[112:115]
    buffer_load_dwordx4 v[36:39], v185, s[48:51], s23 offen offset:1024 sc1
    v_mfma_f32_16x16x32_bf16 v[116:119], a[228:231], v[168:171], v[116:119]
    v_mfma_f32_16x16x32_bf16 v[120:123], a[228:231], v[172:175], v[120:123]
    s_waitcnt lgkmcnt(0)
    v_mfma_f32_16x16x32_bf16 v[100:103], a[232:235], v[160:163], v[100:103]
    ds_read_b128 v[168:171], v253 offset:14336
    v_mfma_f32_16x16x32_bf16 v[104:107], a[232:235], v[164:167], v[104:107]
    ds_read_b128 v[172:175], v253 offset:15360
    v_mfma_f32_16x16x32_bf16 v[108:111], a[236:239], v[160:163], v[108:111]
    v_mfma_f32_16x16x32_bf16 v[112:115], a[236:239], v[164:167], v[112:115]
    buffer_load_dwordx4 v[40:43], v185, s[48:51], s23 offen offset:2048 sc1
    v_mfma_f32_16x16x32_bf16 v[116:119], a[240:243], v[160:163], v[116:119]
    v_mfma_f32_16x16x32_bf16 v[120:123], a[240:243], v[164:167], v[120:123]
    s_waitcnt lgkmcnt(0)
    v_mfma_f32_16x16x32_bf16 v[100:103], a[244:247], v[168:171], v[100:103]
    ds_read_b128 v[160:163], v253 offset:16384
    v_mfma_f32_16x16x32_bf16 v[104:107], a[244:247], v[172:175], v[104:107]
    ds_read_b128 v[164:167], v253 offset:17408
    v_mfma_f32_16x16x32_bf16 v[108:111], a[248:251], v[168:171], v[108:111]
    v_mfma_f32_16x16x32_bf16 v[112:115], a[248:251], v[172:175], v[112:115]
    buffer_load_dwordx4 v[44:47], v185, s[48:51], s23 offen offset:3072 sc1
    v_mfma_f32_16x16x32_bf16 v[116:119], a[252:255], v[168:171], v[116:119]
    v_mfma_f32_16x16x32_bf16 v[120:123], a[252:255], v[172:175], v[120:123]
    s_waitcnt lgkmcnt(0)
    v_mfma_f32_16x16x32_bf16 v[100:103], a[128:131], v[160:163], v[100:103]
    ds_read_b128 v[168:171], v253 offset:18432
    v_mfma_f32_16x16x32_bf16 v[104:107], a[128:131], v[164:167], v[104:107]
    ds_read_b128 v[172:175], v253 offset:19456
    v_mfma_f32_16x16x32_bf16 v[108:111], a[132:135], v[160:163], v[108:111]
    v_mfma_f32_16x16x32_bf16 v[112:115], a[132:135], v[164:167], v[112:115]
    buffer_load_dwordx4 v[48:51], v186, s[48:51], s23 offen offset:0 sc1
    v_mfma_f32_16x16x32_bf16 v[116:119], a[136:139], v[160:163], v[116:119]
    v_mfma_f32_16x16x32_bf16 v[120:123], a[136:139], v[164:167], v[120:123]
    s_waitcnt lgkmcnt(0)
    v_mfma_f32_16x16x32_bf16 v[100:103], a[140:143], v[168:171], v[100:103]
    ds_read_b128 v[160:163], v253 offset:20480
    v_mfma_f32_16x16x32_bf16 v[104:107], a[140:143], v[172:175], v[104:107]
    ds_read_b128 v[164:167], v253 offset:21504
    v_mfma_f32_16x16x32_bf16 v[108:111], a[144:147], v[168:171], v[108:111]
    v_mfma_f32_16x16x32_bf16 v[112:115], a[144:147], v[172:175], v[112:115]
    buffer_load_dwordx4 v[52:55], v186, s[48:51], s23 offen offset:1024 sc1
    v_mfma_f32_16x16x32_bf16 v[116:119], a[148:151], v[168:171], v[116:119]
    v_mfma_f32_16x16x32_bf16 v[120:123], a[148:151], v[172:175], v[120:123]
    s_waitcnt lgkmcnt(0)
    v_mfma_f32_16x16x32_bf16 v[100:103], a[152:155], v[160:163], v[100:103]
    ds_read_b128 v[168:171], v253 offset:22528
    v_mfma_f32_16x16x32_bf16 v[104:107], a[152:155], v[164:167], v[104:107]
    ds_read_b128 v[172:175], v253 offset:23552
    v_mfma_f32_16x16x32_bf16 v[108:111], a[156:159], v[160:163], v[108:111]
    v_mfma_f32_16x16x32_bf16 v[112:115], a[156:159], v[164:167], v[112:115]
    buffer_load_dwordx4 v[56:59], v186, s[48:51], s23 offen offset:2048 sc1
    v_mfma_f32_16x16x32_bf16 v[116:119], a[0:3], v[160:163], v[116:119]
    v_mfma_f32_16x16x32_bf16 v[120:123], a[0:3], v[164:167], v[120:123]
    s_waitcnt lgkmcnt(0)
    v_mfma_f32_16x16x32_bf16 v[100:103], a[4:7], v[168:171], v[100:103]
    ds_read_b128 v[160:163], v253 offset:24576
    v_mfma_f32_16x16x32_bf16 v[104:107], a[4:7], v[172:175], v[104:107]
    ds_read_b128 v[164:167], v253 offset:25600
    v_mfma_f32_16x16x32_bf16 v[108:111], a[8:11], v[168:171], v[108:111]
    v_mfma_f32_16x16x32_bf16 v[112:115], a[8:11], v[172:175], v[112:115]
    buffer_load_dwordx4 v[60:63], v186, s[48:51], s23 offen offset:3072 sc1
    v_mfma_f32_16x16x32_bf16 v[116:119], a[12:15], v[168:171], v[116:119]
    v_mfma_f32_16x16x32_bf16 v[120:123], a[12:15], v[172:175], v[120:123]
    s_waitcnt lgkmcnt(0)
    v_mfma_f32_16x16x32_bf16 v[100:103], a[16:19], v[160:163], v[100:103]
    ds_read_b128 v[168:171], v253 offset:26624
    v_mfma_f32_16x16x32_bf16 v[104:107], a[16:19], v[164:167], v[104:107]
    ds_read_b128 v[172:175], v253 offset:27648
    v_mfma_f32_16x16x32_bf16 v[108:111], a[20:23], v[160:163], v[108:111]
    v_mfma_f32_16x16x32_bf16 v[112:115], a[20:23], v[164:167], v[112:115]
    buffer_load_dwordx4 v[64:67], v187, s[48:51], s23 offen offset:0 sc1
    v_mfma_f32_16x16x32_bf16 v[116:119], a[24:27], v[160:163], v[116:119]
    v_mfma_f32_16x16x32_bf16 v[120:123], a[24:27], v[164:167], v[120:123]
    s_waitcnt lgkmcnt(0)
    v_mfma_f32_16x16x32_bf16 v[100:103], a[28:31], v[168:171], v[100:103]
    ds_read_b128 v[160:163], v253 offset:28672
    v_mfma_f32_16x16x32_bf16 v[104:107], a[28:31], v[172:175], v[104:107]
    ds_read_b128 v[164:167], v253 offset:29696
    v_mfma_f32_16x16x32_bf16 v[108:111], a[32:35], v[168:171], v[108:111]
    v_mfma_f32_16x16x32_bf16 v[112:115], a[32:35], v[172:175], v[112:115]
    buffer_load_dwordx4 v[68:71], v187, s[48:51], s23 offen offset:1024 sc1
    v_mfma_f32_16x16x32_bf16 v[116:119], a[36:39], v[168:171], v[116:119]
    v_mfma_f32_16x16x32_bf16 v[120:123], a[36:39], v[172:175], v[120:123]
    s_waitcnt lgkmcnt(0)
    v_mfma_f32_16x16x32_bf16 v[100:103], a[40:43], v[160:163], v[100:103]
    ds_read_b128 v[168:171], v253 offset:30720
    v_mfma_f32_16x16x32_bf16 v[104:107], a[40:43], v[164:167], v[104:107]
    ds_read_b128 v[172:175], v253 offset:31744
    v_mfma_f32_16x16x32_bf16 v[108:111], a[44:47], v[160:163], v[108:111]
    v_mfma_f32_16x16x32_bf16 v[112:115], a[44:47], v[164:167], v[112:115]
    buffer_load_dwordx4 v[72:75], v187, s[48:51], s23 offen offset:2048 sc1
    v_mfma_f32_16x16x32_bf16 v[116:119], a[48:51], v[160:163], v[116:119]
    v_mfma_f32_16x16x32_bf16 v[120:123], a[48:51], v[164:167], v[120:123]
    s_waitcnt lgkmcnt(0)
    v_mfma_f32_16x16x32_bf16 v[100:103], a[52:55], v[168:171], v[100:103]
    ds_read_b128 v[160:163], v253 offset:32768
    v_mfma_f32_16x16x32_bf16 v[104:107], a[52:55], v[172:175], v[104:107]
    ds_read_b128 v[164:167], v253 offset:33792
    v_mfma_f32_16x16x32_bf16 v[108:111], a[56:59], v[168:171], v[108:111]
    v_mfma_f32_16x16x32_bf16 v[112:115], a[56:59], v[172:175], v[112:115]
    v_mfma_f32_16x16x32_bf16 v[116:119], a[60:63], v[168:171], v[116:119]
    v_mfma_f32_16x16x32_bf16 v[120:123], a[60:63], v[172:175], v[120:123]
    s_waitcnt lgkmcnt(0)
    v_mfma_f32_16x16x32_bf16 v[100:103], a[64:67], v[160:163], v[100:103]
    ds_read_b128 v[168:171], v253 offset:34816
    v_mfma_f32_16x16x32_bf16 v[104:107], a[64:67], v[164:167], v[104:107]
    ds_read_b128 v[172:175], v253 offset:35840
    v_mfma_f32_16x16x32_bf16 v[108:111], a[68:71], v[160:163], v[108:111]
    v_mfma_f32_16x16x32_bf16 v[112:115], a[68:71], v[164:167], v[112:115]
    v_mfma_f32_16x16x32_bf16 v[116:119], a[72:75], v[160:163], v[116:119]
    v_mfma_f32_16x16x32_bf16 v[120:123], a[72:75], v[164:167], v[120:123]
    s_waitcnt lgkmcnt(0)
    v_mfma_f32_16x16x32_bf16 v[100:103], a[76:79], v[168:171], v[100:103]
    v_mfma_f32_16x16x32_bf16 v[104:107], a[76:79], v[172:175], v[104:107]
    v_mfma_f32_16x16x32_bf16 v[108:111], a[80:83], v[168:171], v[108:111]
    v_mfma_f32_16x16x32_bf16 v[112:115], a[80:83], v[172:175], v[112:115]
    v_mfma_f32_16x16x32_bf16 v[116:119], a[84:87], v[168:171], v[116:119]
    v_mfma_f32_16x16x32_bf16 v[120:123], a[84:87], v[172:175], v[120:123]
    s_nop 3
    v_permlane16_swap_b32 v100, v104
    v_permlane16_swap_b32 v101, v105
    v_permlane16_swap_b32 v102, v106
    v_permlane16_swap_b32 v103, v107
    v_add_f32 v12, v116, v117
    v_add_f32 v13, v120, v121
    ds_write_b32 v10, v12
    ds_write_b32 v10, v13 offset:64
    v_permlane16_swap_b32 v108, v112
    v_permlane16_swap_b32 v109, v113
    v_permlane16_swap_b32 v110, v114
    v_permlane16_swap_b32 v111, v115
    v_permlane16_swap_b32 v116, v120
    v_permlane16_swap_b32 v117, v121
    v_permlane16_swap_b32 v118, v122
    v_permlane16_swap_b32 v119, v123
    s_waitcnt lgkmcnt(0)
    s_barrier
    ds_read_b32 v12, v11 offset:40960
    v_pk_add_f32 v[124:125], v[124:125], v[100:101]
    v_pk_add_f32 v[126:127], v[126:127], v[102:103]
    v_pk_add_f32 v[128:129], v[128:129], v[104:105]
    v_pk_add_f32 v[130:131], v[130:131], v[106:107]
    v_pk_add_f32 v[132:133], v[132:133], v[108:109]
    v_pk_add_f32 v[134:135], v[134:135], v[110:111]
    v_pk_add_f32 v[136:137], v[136:137], v[112:113]
    v_pk_add_f32 v[138:139], v[138:139], v[114:115]
    v_pk_add_f32 v[140:141], v[140:141], v[116:117]
    v_pk_add_f32 v[142:143], v[142:143], v[118:119]
    v_pk_add_f32 v[144:145], v[144:145], v[120:121]
    v_pk_add_f32 v[146:147], v[146:147], v[122:123]
    v_mov_b32 v14, 0
    v_mov_b32 v15, 0
    s_waitcnt lgkmcnt(0)
    v_add_f32 v12, v12, v252
    v_pk_add_f32 v[100:101], v[124:125], v[12:13] op_sel_hi:[1,0] neg_lo:[0,1] neg_hi:[0,1]
    v_pk_add_f32 v[102:103], v[126:127], v[12:13] op_sel_hi:[1,0] neg_lo:[0,1] neg_hi:[0,1]
    v_pk_add_f32 v[104:105], v[128:129], v[12:13] op_sel_hi:[1,0] neg_lo:[0,1] neg_hi:[0,1]
    v_pk_add_f32 v[106:107], v[130:131], v[12:13] op_sel_hi:[1,0] neg_lo:[0,1] neg_hi:[0,1]
    v_cvt_pk_bf16_f32 v148, v100, v101
    v_cvt_pk_bf16_f32 v149, v102, v103
    v_cvt_pk_bf16_f32 v150, v104, v105
    v_cvt_pk_bf16_f32 v151, v106, v107
    buffer_store_dwordx4 v[148:151], v9, s[8:11], s46 offen offset:0 sc1
    v_pk_add_f32 v[108:109], v[132:133], v[12:13] op_sel_hi:[1,0] neg_lo:[0,1] neg_hi:[0,1]
    v_pk_add_f32 v[110:111], v[134:135], v[12:13] op_sel_hi:[1,0] neg_lo:[0,1] neg_hi:[0,1]
    v_pk_add_f32 v[112:113], v[136:137], v[12:13] op_sel_hi:[1,0] neg_lo:[0,1] neg_hi:[0,1]
    v_pk_add_f32 v[114:115], v[138:139], v[12:13] op_sel_hi:[1,0] neg_lo:[0,1] neg_hi:[0,1]
    v_cvt_pk_bf16_f32 v152, v108, v109
    v_cvt_pk_bf16_f32 v153, v110, v111
    v_cvt_pk_bf16_f32 v154, v112, v113
    v_cvt_pk_bf16_f32 v155, v114, v115
    buffer_store_dwordx4 v[152:155], v9, s[8:11], s46 offen offset:1024 sc1
    v_pk_add_f32 v[116:117], v[140:141], v[12:13] op_sel_hi:[1,0] neg_lo:[0,1] neg_hi:[0,1]
    v_pk_add_f32 v[118:119], v[142:143], v[12:13] op_sel_hi:[1,0] neg_lo:[0,1] neg_hi:[0,1]
    v_pk_add_f32 v[120:121], v[144:145], v[12:13] op_sel_hi:[1,0] neg_lo:[0,1] neg_hi:[0,1]
    v_pk_add_f32 v[122:123], v[146:147], v[12:13] op_sel_hi:[1,0] neg_lo:[0,1] neg_hi:[0,1]
    v_cvt_pk_bf16_f32 v156, v116, v117
    v_cvt_pk_bf16_f32 v157, v118, v119
    v_cvt_pk_bf16_f32 v158, v120, v121
    v_cvt_pk_bf16_f32 v159, v122, v123
    buffer_store_dwordx4 v[156:159], v7, s[8:11], s46 offen offset:2048 sc1
    v_dot2c_f32_bf16 v14, v148, v148
    v_dot2c_f32_bf16 v14, v149, v149
    v_dot2c_f32_bf16 v14, v150, v150
    v_dot2c_f32_bf16 v14, v151, v151
    v_dot2c_f32_bf16 v14, v152, v152
    v_dot2c_f32_bf16 v14, v153, v153
    v_dot2c_f32_bf16 v14, v154, v154
    v_dot2c_f32_bf16 v14, v155, v155
    v_dot2c_f32_bf16 v15, v156, v156
    v_dot2c_f32_bf16 v15, v157, v157
    v_dot2c_f32_bf16 v15, v158, v158
    v_dot2c_f32_bf16 v15, v159, v159
    buffer_store_dword v12, v6, s[8:11], s36 offen sc1
    s_nop 1
    v_fma_f32 v14, v15, s35, v14
    v_mov_b32 v15, v14
    s_nop 1
    v_permlane32_swap_b32 v14, v15
    v_add_f32 v14, v14, v15
    buffer_store_dword v14, v8, s[8:11], s45 offen sc1
    v_lshlrev_b32 v15, 7, v0
    s_lshl_b32 s6, s40, 2
    s_add_u32 s6, s6, s44
    s_add_u32 s6, s6, 32768
    v_mov_b32 v1, s76
    s_mov_b64 vcc, 0xff
    s_waitcnt vmcnt(0)
    s_barrier
    s_cmp_lg_u32 s3, 0
    s_cbranch_scc1 L_pub_25
    s_mov_b64 exec, vcc
    buffer_store_dword v1, v15, s[8:11], s6 offen sc1
L_pub_25:
    s_mov_b64 exec, -1
    s_lshl_b32 s7, s41, 2
    s_add_u32 s7, s7, s3
    s_mul_i32 s22, s7, 18432
    s_add_u32 s22, s22, s43
    s_add_u32 s22, s22, 45875200
    s_mul_i32 s24, s3, 18432
    s_lshl_b32 s25, s41, 12
    s_add_u32 s25, s25, s43
    s_add_u32 s25, s25, 48300032
    v_lshrrev_b32 v3, 5, v0
    v_and_b32 v10, 31, v0
    v_lshlrev_b32 v10, 2, v10
    v_lshl_add_u32 v3, v3, 11, v10
    v_add_u32 v11, 36864, v184
    s_mov_b32 s16, 0xffff0000
    s_lshl_b32 s7, s3, 10
    v_add_u32 v172, s7, v253
    v_add_u32 v174, 5120, v172
    v_and_b32 v178, 7, v0
    v_mul_u32_u24 v178, 1152, v178
    v_lshrrev_b32 v179, 3, v0
    v_lshl_add_u32 v178, v179, 4, v178
    s_lshl_b32 s7, s3, 7
    v_add_u32 v175, s7, v178
    v_add_u32 v177, 640, v175
    s_cmp_eq_u32 s3, 0
    s_mov_b32 s17, 1073741824
    s_cmov_b32 s17, 4096
    v_add_u32 v173, s17, v172
    s_mov_b32 s17, 1073741824
    s_cmov_b32 s17, 512
    v_add_u32 v176, s17, v175
    s_lshl_b32 s21, s41, 3
    s_add_u32 s21, s21, s40
    s_mul_i32 s18, s21, 9216
    s_mul_i32 s20, s21, 73728
    s_add_u32 s20, s20, 19922944
    s_mov_b32 s19, s20
    v_bfe_u32 v1, v0, 3, 2
    s_mov_b32 s7, 73728
    v_mul_lo_u32 v178, v1, s7
    v_lshrrev_b32 v1, 5, v0
    v_lshl_add_u32 v178, v1, 7, v178
    v_and_b32 v1, 7, v0
    v_lshl_add_u32 v178, v1, 4, v178
    v_add_u32 v179, 294912, v178
    s_mul_i32 s26, s41, 589824
    s_mul_i32 s7, s40, 9216
    s_add_u32 s26, s26, s7
    s_lshl_b32 s7, s3, 8
    s_add_u32 s27, s26, s7
    s_add_u32 s27, s27, 19921920
    s_mov_b32 s74, 0
    s_mul_i32 s7, s42, 98304
    s_sub_u32 s29, s44, s7
    s_add_u32 s29, s29, 360448
    s_lshl_b32 s7, s40, 7
    s_add_u32 s7, s7, s29
    s_add_u32 s38, s4, s7
    s_addc_u32 s39, s5, 0
    s_lshl_b32 s7, s40, 2
    s_add_u32 s29, s29, s7
    s_add_u32 s50, s23, 497664
    s_cmp_lg_u32 s42, 0
    s_cbranch_scc1 L_ring_26
    s_cmp_lg_u32 s3, 0
    s_cbranch_scc1 L_ring_27
    s_lshl_b32 s7, s41, 3
    s_add_u32 s7, s7, s40
    s_lshl_b32 s7, s7, 7
    s_add_u32 s7, s7, 19464192
    s_add_u32 s68, s4, s7
    s_addc_u32 s69, s5, 0
    s_mov_b32 s6, 0
    s_mov_b32 s7, 0
L_cpoll_28:
    s_load_dwordx16 s[52:67], s[68:69], s7 glc
    s_add_u32 s6, s6, 1
    s_waitcnt lgkmcnt(0)
    s_xor_b64 s[52:53], s[52:53], s[76:77]
    s_xor_b64 s[54:55], s[54:55], s[76:77]
    s_xor_b64 s[56:57], s[56:57], s[76:77]
    s_xor_b64 s[58:59], s[58:59], s[76:77]
    s_xor_b64 s[60:61], s[60:61], s[76:77]
    s_xor_b64 s[62:63], s[62:63], s[76:77]
    s_xor_b64 s[64:65], s[64:65], s[76:77]
    s_xor_b64 s[66:67], s[66:67], s[76:77]
    s_or_b64 s[52:53], s[52:53], s[60:61]
    s_or_b64 s[54:55], s[54:55], s[62:63]
    s_or_b64 s[56:57], s[56:57], s[64:65]
    s_or_b64 s[58:59], s[58:59], s[66:67]
    s_or_b64 s[52:53], s[52:53], s[56:57]
    s_or_b64 s[54:55], s[54:55], s[58:59]
    s_or_b64 s[52:53], s[52:53], s[54:55]
    s_cbranch_scc1 L_cpoll_29
    s_add_u32 s7, s7, 64
    s_cmp_eq_u32 s7, 128
    s_cbranch_scc1 L_cpolled_30
L_cpoll_29:
    s_cmp_lt_u32 s6, 1048576
    s_cbranch_scc1 L_cpoll_28
    s_branch L_main_end
L_cpolled_30:
L_ring_27:
    s_barrier
    buffer_load_dwordx4 v[16:19], v184, s[48:51], s23 offen offset:0 sc1
    buffer_load_dwordx4 v[20:23], v184, s[48:51], s23 offen offset:1024 sc1
    buffer_load_dwordx4 v[24:27], v184, s[48:51], s23 offen offset:2048 sc1
    buffer_load_dwordx4 v[28:31], v184, s[48:51], s23 offen offset:3072 sc1
    buffer_load_dwordx4 v[32:35], v185, s[48:51], s23 offen offset:0 sc1
    buffer_load_dwordx4 v[36:39], v185, s[48:51], s23 offen offset:1024 sc1
    buffer_load_dwordx4 v[40:43], v185, s[48:51], s23 offen offset:2048 sc1
    buffer_load_dwordx4 v[44:47], v185, s[48:51], s23 offen offset:3072 sc1
    buffer_load_dwordx4 v[48:51], v186, s[48:51], s23 offen offset:0 sc1
    buffer_load_dwordx4 v[52:55], v186, s[48:51], s23 offen offset:1024 sc1
    buffer_load_dwordx4 v[56:59], v186, s[48:51], s23 offen offset:2048 sc1
    buffer_load_dwordx4 v[60:63], v186, s[48:51], s23 offen offset:3072 sc1
    buffer_load_dwordx4 v[64:67], v187, s[48:51], s23 offen offset:0 sc1
    buffer_load_dwordx4 v[68:71], v187, s[48:51], s23 offen offset:1024 sc1
    buffer_load_dwordx4 v[72:75], v187, s[48:51], s23 offen offset:2048 sc1
L_ring_26:
    s_cmp_lg_u32 s3, 0
    s_cbranch_scc1 L_pollout_33
    s_lshl_b32 s7, s40, 7
    s_add_u32 s7, s7, s44
    s_add_u32 s7, s7, 32768
    s_add_u32 s52, s4, s7
    s_addc_u32 s53, s5, 0
    s_mov_b32 s6, 0
L_poll_31:
    s_load_dwordx8 s[56:63], s[52:53], 0 glc
    s_add_u32 s6, s6, 1
    s_waitcnt lgkmcnt(0)
    s_xor_b64 s[56:57], s[56:57], s[76:77]
    s_xor_b64 s[58:59], s[58:59], s[76:77]
    s_xor_b64 s[60:61], s[60:61], s[76:77]
    s_xor_b64 s[62:63], s[62:63], s[76:77]
    s_or_b64 s[56:57], s[56:57], s[58:59]
    s_or_b64 s[60:61], s[60:61], s[62:63]
    s_or_b64 s[56:57], s[56:57], s[60:61]
    s_cbranch_scc0 L_polled_32
    s_cmp_lt_u32 s6, 1048576
    s_cbranch_scc1 L_poll_31
    s_branch L_main_end
L_polled_32:
L_pollout_33:
    s_barrier
    s_add_u32 m0, s24, 0
    s_nop 0
    buffer_load_dwordx4 v2, s[8:11], s22 offen offset:0 sc1 lds
    s_add_u32 m0, s24, 512
    s_nop 0
    buffer_load_dwordx4 v2, s[8:11], s22 offen offset:512 sc1 lds
    s_add_u32 m0, s24, 1024
    s_nop 0
    buffer_load_dwordx4 v2, s[8:11], s22 offen offset:1024 sc1 lds
    s_add_u32 m0, s24, 1536
    s_nop 0
    buffer_load_dwordx4 v2, s[8:11], s22 offen offset:1536 sc1 lds
    s_add_u32 m0, s24, 2048
    s_nop 0
    buffer_load_dwordx4 v2, s[8:11], s22 offen offset:2048 sc1 lds
    s_add_u32 m0, s24, 2560
    s_nop 0
    buffer_load_dwordx4 v2, s[8:11], s22 offen offset:2560 sc1 lds
    s_add_u32 m0, s24, 3072
    s_nop 0
    buffer_load_dwordx4 v2, s[8:11], s22 offen offset:3072 sc1 lds
    s_add_u32 m0, s24, 3584
    s_nop 0
    buffer_load_dwordx4 v2, s[8:11], s22 offen offset:3584 sc1 lds
    s_add_u32 m0, s24, 8192
    s_add_u32 s22, s22, 4096
    buffer_load_dwordx4 v2, s[8:11], s22 offen offset:0 sc1 lds
    s_add_u32 m0, s24, 8704
    s_nop 0
    buffer_load_dwordx4 v2, s[8:11], s22 offen offset:512 sc1 lds
    s_add_u32 m0, s24, 9216
    s_nop 0
    buffer_load_dwordx4 v2, s[8:11], s22 offen offset:1024 sc1 lds
    s_add_u32 m0, s24, 9728
    s_nop 0
    buffer_load_dwordx4 v2, s[8:11], s22 offen offset:1536 sc1 lds
    s_add_u32 s23, s23, 15360
    s_lshr_b32 s7, s3, 1
    s_lshl_b32 s7, s7, 10
    s_and_b32 s6, s3, 1
    s_lshl_b32 s6, s6, 3
    s_add_u32 s28, s7, s6
    s_add_u32 s28, s28, 73728
    s_waitcnt vmcnt(6)
    s_barrier
    ds_read_b128 a[0:3], v184 offset:0
    ds_read_b128 a[72:75], v184 offset:18432
    ds_read_b128 a[144:147], v11 offset:0
    ds_read_b128 a[216:219], v11 offset:18432
    ds_read_b128 a[4:7], v184 offset:1024
    ds_read_b128 a[76:79], v184 offset:19456
    ds_read_b128 a[148:151], v11 offset:1024
    ds_read_b128 a[220:223], v11 offset:19456
    ds_read_b128 a[8:11], v184 offset:2048
    ds_read_b128 a[80:83], v184 offset:20480
    ds_read_b128 a[152:155], v11 offset:2048
    ds_read_b128 a[224:227], v11 offset:20480
    s_waitcnt vmcnt(24) lgkmcnt(0)
    v_mfma_f32_16x16x32_bf16 v[88:91], v[16:19], a[0:3], 0
    ds_read_b128 a[12:15], v184 offset:3072
    v_mfma_f32_16x16x32_bf16 v[88:91], v[20:23], a[4:7], v[88:91]
    buffer_load_dwordx4 v[76:79], v184, s[48:51], s23 offen offset:0 sc1
    v_mfma_f32_16x16x32_bf16 v[88:91], v[24:27], a[8:11], v[88:91]
    ds_read_b128 a[84:87], v184 offset:21504
    v_mfma_f32_16x16x32_bf16 v[92:95], v[16:19], a[72:75], 0
    s_add_u32 m0, s24, 10240
    s_nop 0
    buffer_load_dwordx4 v2, s[8:11], s22 offen offset:2048 sc1 lds
    v_mfma_f32_16x16x32_bf16 v[92:95], v[20:23], a[76:79], v[92:95]
    ds_read_b128 a[156:159], v11 offset:3072
    ds_read_b128 a[228:231], v11 offset:21504
    v_mfma_f32_16x16x32_bf16 v[92:95], v[24:27], a[80:83], v[92:95]
    buffer_load_dwordx4 v[80:83], v184, s[48:51], s23 offen offset:1024 sc1
    v_mfma_f32_16x16x32_bf16 v[96:99], v[16:19], a[144:147], 0
    ds_read_b128 a[16:19], v184 offset:4096
    v_mfma_f32_16x16x32_bf16 v[96:99], v[20:23], a[148:151], v[96:99]
    s_add_u32 m0, s24, 10752
    s_nop 0
    buffer_load_dwordx4 v2, s[8:11], s22 offen offset:2560 sc1 lds
    v_mfma_f32_16x16x32_bf16 v[96:99], v[24:27], a[152:155], v[96:99]
    ds_read_b128 a[88:91], v184 offset:22528
    v_mfma_f32_16x16x32_bf16 v[100:103], v[16:19], a[216:219], 0
    buffer_load_dwordx4 v[84:87], v184, s[48:51], s23 offen offset:2048 sc1
    v_mfma_f32_16x16x32_bf16 v[100:103], v[20:23], a[220:223], v[100:103]
    ds_read_b128 a[160:163], v11 offset:4096
    ds_read_b128 a[232:235], v11 offset:22528
    v_mfma_f32_16x16x32_bf16 v[100:103], v[24:27], a[224:227], v[100:103]
    s_add_u32 m0, s24, 11264
    s_nop 0
    buffer_load_dwordx4 v2, s[8:11], s22 offen offset:3072 sc1 lds
    s_waitcnt vmcnt(27) lgkmcnt(8)
    v_mfma_f32_16x16x32_bf16 v[104:107], v[28:31], a[0:3], 0
    ds_read_b128 a[20:23], v184 offset:5120
    v_mfma_f32_16x16x32_bf16 v[104:107], v[32:35], a[4:7], v[104:107]
    buffer_load_dwordx4 v[16:19], v184, s[48:51], s23 offen offset:3072 sc1
    v_mfma_f32_16x16x32_bf16 v[104:107], v[36:39], a[8:11], v[104:107]
    ds_read_b128 a[92:95], v184 offset:23552
    v_mfma_f32_16x16x32_bf16 v[108:111], v[28:31], a[72:75], 0
    s_add_u32 m0, s24, 11776
    s_nop 0
    buffer_load_dwordx4 v2, s[8:11], s22 offen offset:3584 sc1 lds
    v_mfma_f32_16x16x32_bf16 v[108:111], v[32:35], a[76:79], v[108:111]
    ds_read_b128 a[164:167], v11 offset:5120
    ds_read_b128 a[236:239], v11 offset:23552
    v_mfma_f32_16x16x32_bf16 v[108:111], v[36:39], a[80:83], v[108:111]
    buffer_load_dwordx4 v[20:23], v185, s[48:51], s23 offen offset:0 sc1
    v_mfma_f32_16x16x32_bf16 v[112:115], v[28:31], a[144:147], 0
    v_mfma_f32_16x16x32_bf16 v[112:115], v[32:35], a[148:151], v[112:115]
    s_add_u32 m0, s24, 16384
    s_add_u32 s22, s22, 4096
    buffer_load_dwordx4 v2, s[8:11], s22 offen offset:0 sc1 lds
    v_mfma_f32_16x16x32_bf16 v[112:115], v[36:39], a[152:155], v[112:115]
    v_mfma_f32_16x16x32_bf16 v[116:119], v[28:31], a[216:219], 0
    buffer_load_dwordx4 v[24:27], v185, s[48:51], s23 offen offset:1024 sc1
    v_mfma_f32_16x16x32_bf16 v[116:119], v[32:35], a[220:223], v[116:119]
    v_mfma_f32_16x16x32_bf16 v[116:119], v[36:39], a[224:227], v[116:119]
    s_add_u32 m0, s24, 16896
    s_nop 0
    buffer_load_dwordx4 v2, s[8:11], s22 offen offset:512 sc1 lds
    s_waitcnt vmcnt(12) lgkmcnt(0)
    s_barrier
    v_mfma_f32_16x16x32_bf16 v[88:91], v[40:43], a[12:15], v[88:91]
    ds_read_b128 a[24:27], v184 offset:6144
    v_mfma_f32_16x16x32_bf16 v[88:91], v[44:47], a[16:19], v[88:91]
    buffer_load_dwordx4 v[28:31], v185, s[48:51], s23 offen offset:2048 sc1
    v_mfma_f32_16x16x32_bf16 v[88:91], v[48:51], a[20:23], v[88:91]
    ds_read_b128 a[96:99], v184 offset:24576
    v_mfma_f32_16x16x32_bf16 v[92:95], v[40:43], a[84:87], v[92:95]
    buffer_load_dword v136, v3, s[8:11], s25 offen offset:0 sc1
    v_mfma_f32_16x16x32_bf16 v[92:95], v[44:47], a[88:91], v[92:95]
    ds_read_b128 a[168:171], v11 offset:6144
    ds_read_b128 a[240:243], v11 offset:24576
    v_mfma_f32_16x16x32_bf16 v[92:95], v[48:51], a[92:95], v[92:95]
    buffer_load_dwordx4 v[32:35], v185, s[48:51], s23 offen offset:3072 sc1
    v_mfma_f32_16x16x32_bf16 v[96:99], v[40:43], a[156:159], v[96:99]
    buffer_load_dword v137, v3, s[8:11], s25 offen offset:128 sc1
    v_mfma_f32_16x16x32_bf16 v[96:99], v[44:47], a[160:163], v[96:99]
    buffer_load_dword v138, v3, s[8:11], s25 offen offset:256 sc1
    v_mfma_f32_16x16x32_bf16 v[96:99], v[48:51], a[164:167], v[96:99]
    ds_read_b128 a[28:31], v184 offset:7168
    ds_read_b128 a[100:103], v184 offset:25600
    v_mfma_f32_16x16x32_bf16 v[100:103], v[40:43], a[228:231], v[100:103]
    buffer_load_dwordx4 v[36:39], v186, s[48:51], s23 offen offset:0 sc1
    v_mfma_f32_16x16x32_bf16 v[100:103], v[44:47], a[232:235], v[100:103]
    buffer_load_dword v139, v3, s[8:11], s25 offen offset:384 sc1
    v_mfma_f32_16x16x32_bf16 v[100:103], v[48:51], a[236:239], v[100:103]
    buffer_load_dword v140, v3, s[8:11], s25 offen offset:512 sc1
    s_waitcnt vmcnt(35) lgkmcnt(6)
    v_mfma_f32_16x16x32_bf16 v[104:107], v[52:55], a[12:15], v[104:107]
    ds_read_b128 a[172:175], v11 offset:7168
    ds_read_b128 a[244:247], v11 offset:25600
    v_mfma_f32_16x16x32_bf16 v[104:107], v[56:59], a[16:19], v[104:107]
    buffer_load_dwordx4 v[40:43], v186, s[48:51], s23 offen offset:1024 sc1
    v_mfma_f32_16x16x32_bf16 v[104:107], v[60:63], a[20:23], v[104:107]
    ds_read_b128 a[32:35], v184 offset:8192
    ds_read_b128 a[104:107], v184 offset:26624
    v_mfma_f32_16x16x32_bf16 v[108:111], v[52:55], a[84:87], v[108:111]
    buffer_load_dword v141, v3, s[8:11], s25 offen offset:640 sc1
    v_mfma_f32_16x16x32_bf16 v[108:111], v[56:59], a[88:91], v[108:111]
    ds_read_b128 a[176:179], v11 offset:8192
    ds_read_b128 a[248:251], v11 offset:26624
    v_mfma_f32_16x16x32_bf16 v[108:111], v[60:63], a[92:95], v[108:111]
    buffer_load_dwordx4 v[44:47], v186, s[48:51], s23 offen offset:2048 sc1
    v_mfma_f32_16x16x32_bf16 v[112:115], v[52:55], a[156:159], v[112:115]
    buffer_load_dword v142, v3, s[8:11], s25 offen offset:768 sc1
    v_mfma_f32_16x16x32_bf16 v[112:115], v[56:59], a[160:163], v[112:115]
    buffer_load_dword v143, v3, s[8:11], s25 offen offset:896 sc1
    v_mfma_f32_16x16x32_bf16 v[112:115], v[60:63], a[164:167], v[112:115]
    v_mfma_f32_16x16x32_bf16 v[116:119], v[52:55], a[228:231], v[116:119]
    buffer_load_dwordx4 v[48:51], v186, s[48:51], s23 offen offset:3072 sc1
    v_mfma_f32_16x16x32_bf16 v[116:119], v[56:59], a[232:235], v[116:119]
    buffer_load_dword v144, v3, s[8:11], s25 offen offset:1024 sc1
    v_mfma_f32_16x16x32_bf16 v[116:119], v[60:63], a[236:239], v[116:119]
    buffer_load_dword v145, v3, s[8:11], s25 offen offset:1152 sc1
    s_waitcnt vmcnt(40) lgkmcnt(0)
    v_mfma_f32_16x16x32_bf16 v[88:91], v[64:67], a[24:27], v[88:91]
    ds_read_b128 a[36:39], v184 offset:9216
    v_mfma_f32_16x16x32_bf16 v[88:91], v[68:71], a[28:31], v[88:91]
    buffer_load_dwordx4 v[52:55], v187, s[48:51], s23 offen offset:0 sc1
    v_mfma_f32_16x16x32_bf16 v[88:91], v[72:75], a[32:35], v[88:91]
    ds_read_b128 a[108:111], v184 offset:27648
    v_mfma_f32_16x16x32_bf16 v[92:95], v[64:67], a[96:99], v[92:95]
    buffer_load_dword v146, v3, s[8:11], s25 offen offset:1280 sc1
    v_mfma_f32_16x16x32_bf16 v[92:95], v[68:71], a[100:103], v[92:95]
    ds_read_b128 a[180:183], v11 offset:9216
    ds_read_b128 a[252:255], v11 offset:27648
    v_mfma_f32_16x16x32_bf16 v[92:95], v[72:75], a[104:107], v[92:95]
    buffer_load_dwordx4 v[56:59], v187, s[48:51], s23 offen offset:1024 sc1
    v_mfma_f32_16x16x32_bf16 v[96:99], v[64:67], a[168:171], v[96:99]
    buffer_load_dword v147, v3, s[8:11], s25 offen offset:1408 sc1
    v_mfma_f32_16x16x32_bf16 v[96:99], v[68:71], a[172:175], v[96:99]
    buffer_load_dword v148, v3, s[8:11], s25 offen offset:1536 sc1
    v_mfma_f32_16x16x32_bf16 v[96:99], v[72:75], a[176:179], v[96:99]
    ds_read_b128 a[40:43], v184 offset:10240
    ds_read_b128 a[112:115], v184 offset:28672
    v_mfma_f32_16x16x32_bf16 v[100:103], v[64:67], a[240:243], v[100:103]
    buffer_load_dwordx4 v[60:63], v187, s[48:51], s23 offen offset:2048 sc1
    v_mfma_f32_16x16x32_bf16 v[100:103], v[68:71], a[244:247], v[100:103]
    buffer_load_dword v149, v3, s[8:11], s25 offen offset:1664 sc1
    v_mfma_f32_16x16x32_bf16 v[100:103], v[72:75], a[248:251], v[100:103]
    buffer_load_dword v150, v3, s[8:11], s25 offen offset:1792 sc1
    s_waitcnt vmcnt(31) lgkmcnt(6)
    v_mfma_f32_16x16x32_bf16 v[104:107], v[76:79], a[24:27], v[104:107]
    ds_read_b128 a[184:187], v11 offset:10240
    ds_read_b128 v[220:223], v11 offset:28672
    v_mfma_f32_16x16x32_bf16 v[104:107], v[80:83], a[28:31], v[104:107]
    buffer_load_dwordx4 v[64:67], v187, s[48:51], s23 offen offset:3072 sc1
    v_mfma_f32_16x16x32_bf16 v[104:107], v[84:87], a[32:35], v[104:107]
    ds_read_b128 a[44:47], v184 offset:11264
    ds_read_b128 a[116:119], v184 offset:29696
    v_mfma_f32_16x16x32_bf16 v[108:111], v[76:79], a[96:99], v[108:111]
    buffer_load_dword v151, v3, s[8:11], s25 offen offset:1920 sc1
    v_mfma_f32_16x16x32_bf16 v[108:111], v[80:83], a[100:103], v[108:111]
    ds_read_b128 a[188:191], v11 offset:11264
    ds_read_b128 v[224:227], v11 offset:29696
    v_mfma_f32_16x16x32_bf16 v[108:111], v[84:87], a[104:107], v[108:111]
    buffer_load_dwordx4 v[68:71], v188, s[48:51], s23 offen offset:0 sc1
    v_mfma_f32_16x16x32_bf16 v[112:115], v[76:79], a[168:171], v[112:115]
    v_mfma_f32_16x16x32_bf16 v[112:115], v[80:83], a[172:175], v[112:115]
    v_mfma_f32_16x16x32_bf16 v[112:115], v[84:87], a[176:179], v[112:115]
    v_mfma_f32_16x16x32_bf16 v[116:119], v[76:79], a[240:243], v[116:119]
    buffer_load_dwordx4 v[72:75], v188, s[48:51], s23 offen offset:1024 sc1
    v_mfma_f32_16x16x32_bf16 v[116:119], v[80:83], a[244:247], v[116:119]
    v_mfma_f32_16x16x32_bf16 v[116:119], v[84:87], a[248:251], v[116:119]
    s_waitcnt vmcnt(28) lgkmcnt(0)
    s_barrier
    v_mfma_f32_16x16x32_bf16 v[88:91], v[16:19], a[36:39], v[88:91]
    ds_read_b128 a[48:51], v184 offset:12288
    v_mfma_f32_16x16x32_bf16 v[88:91], v[20:23], a[40:43], v[88:91]
    buffer_load_dwordx4 v[76:79], v188, s[48:51], s23 offen offset:2048 sc1
    v_mfma_f32_16x16x32_bf16 v[88:91], v[24:27], a[44:47], v[88:91]
    ds_read_b128 a[120:123], v184 offset:30720
    v_mfma_f32_16x16x32_bf16 v[92:95], v[16:19], a[108:111], v[92:95]
    ds_read_b128 a[192:195], v11 offset:12288
    v_mfma_f32_16x16x32_bf16 v[92:95], v[20:23], a[112:115], v[92:95]
    ds_read_b128 v[228:231], v11 offset:30720
    v_mfma_f32_16x16x32_bf16 v[92:95], v[24:27], a[116:119], v[92:95]
    buffer_load_dwordx4 v[80:83], v188, s[48:51], s23 offen offset:3072 sc1
    v_mfma_f32_16x16x32_bf16 v[96:99], v[16:19], a[180:183], v[96:99]
    ds_read_b128 a[52:55], v184 offset:13312
    v_mfma_f32_16x16x32_bf16 v[96:99], v[20:23], a[184:187], v[96:99]
    ds_read_b128 a[124:127], v184 offset:31744
    v_mfma_f32_16x16x32_bf16 v[96:99], v[24:27], a[188:191], v[96:99]
    v_mfma_f32_16x16x32_bf16 v[100:103], v[16:19], a[252:255], v[100:103]
    buffer_load_dwordx4 v[84:87], v189, s[48:51], s23 offen offset:0 sc1
    v_mfma_f32_16x16x32_bf16 v[100:103], v[20:23], v[220:223], v[100:103]
    ds_read_b128 a[196:199], v11 offset:13312
    ds_read_b128 v[232:235], v11 offset:31744
    v_mfma_f32_16x16x32_bf16 v[100:103], v[24:27], v[224:227], v[100:103]
    s_waitcnt vmcnt(25) lgkmcnt(8)
    v_mfma_f32_16x16x32_bf16 v[104:107], v[28:31], a[36:39], v[104:107]
    ds_read_b128 a[56:59], v184 offset:14336
    v_mfma_f32_16x16x32_bf16 v[104:107], v[32:35], a[40:43], v[104:107]
    buffer_load_dwordx4 v[16:19], v189, s[48:51], s23 offen offset:1024 sc1
    v_mfma_f32_16x16x32_bf16 v[104:107], v[36:39], a[44:47], v[104:107]
    ds_read_b128 a[128:131], v184 offset:32768
    v_mfma_f32_16x16x32_bf16 v[108:111], v[28:31], a[108:111], v[108:111]
    ds_read_b128 a[200:203], v11 offset:14336
    v_mfma_f32_16x16x32_bf16 v[108:111], v[32:35], a[112:115], v[108:111]
    ds_read_b128 v[236:239], v11 offset:32768
    v_mfma_f32_16x16x32_bf16 v[108:111], v[36:39], a[116:119], v[108:111]
    buffer_load_dwordx4 v[20:23], v189, s[48:51], s23 offen offset:2048 sc1
    v_mfma_f32_16x16x32_bf16 v[112:115], v[28:31], a[180:183], v[112:115]
    v_mfma_f32_16x16x32_bf16 v[112:115], v[32:35], a[184:187], v[112:115]
    v_mfma_f32_16x16x32_bf16 v[112:115], v[36:39], a[188:191], v[112:115]
    v_mfma_f32_16x16x32_bf16 v[116:119], v[28:31], a[252:255], v[116:119]
    buffer_load_dwordx4 v[24:27], v189, s[48:51], s23 offen offset:3072 sc1
    v_mfma_f32_16x16x32_bf16 v[116:119], v[32:35], v[220:223], v[116:119]
    v_mfma_f32_16x16x32_bf16 v[116:119], v[36:39], v[224:227], v[116:119]
    s_waitcnt vmcnt(8) lgkmcnt(0)
    v_mfma_f32_16x16x32_bf16 v[88:91], v[40:43], a[48:51], v[88:91]
    ds_read_b128 a[60:63], v184 offset:15360
    v_add_f32 v136, v136, v144
    v_mfma_f32_16x16x32_bf16 v[88:91], v[44:47], a[52:55], v[88:91]
    buffer_load_dwordx4 v[28:31], v190, s[48:51], s23 offen offset:0 sc1
    v_mfma_f32_16x16x32_bf16 v[88:91], v[48:51], a[56:59], v[88:91]
    ds_read_b128 a[132:135], v184 offset:33792
    v_add_f32 v137, v137, v145
    v_mfma_f32_16x16x32_bf16 v[92:95], v[40:43], a[120:123], v[92:95]
    ds_read_b128 a[204:207], v11 offset:15360
    v_add_f32 v138, v138, v146
    v_mfma_f32_16x16x32_bf16 v[92:95], v[44:47], a[124:127], v[92:95]
    ds_read_b128 v[240:243], v11 offset:33792
    v_add_f32 v139, v139, v147
    v_mfma_f32_16x16x32_bf16 v[92:95], v[48:51], a[128:131], v[92:95]
    buffer_load_dwordx4 v[32:35], v190, s[48:51], s23 offen offset:1024 sc1
    v_mfma_f32_16x16x32_bf16 v[96:99], v[40:43], a[192:195], v[96:99]
    ds_read_b128 a[64:67], v184 offset:16384
    v_add_f32 v140, v140, v148
    v_mfma_f32_16x16x32_bf16 v[96:99], v[44:47], a[196:199], v[96:99]
    ds_read_b128 a[136:139], v184 offset:34816
    v_add_f32 v141, v141, v149
    v_mfma_f32_16x16x32_bf16 v[96:99], v[48:51], a[200:203], v[96:99]
    v_add_f32 v142, v142, v150
    v_add_f32 v143, v143, v151
    v_mfma_f32_16x16x32_bf16 v[100:103], v[40:43], v[228:231], v[100:103]
    buffer_load_dwordx4 v[36:39], v190, s[48:51], s23 offen offset:2048 sc1
    v_mfma_f32_16x16x32_bf16 v[100:103], v[44:47], v[232:235], v[100:103]
    ds_read_b128 a[208:211], v11 offset:16384
    ds_read_b128 v[244:247], v11 offset:34816
    v_mfma_f32_16x16x32_bf16 v[100:103], v[48:51], v[236:239], v[100:103]
    v_add_f32 v136, v136, v140
    v_add_f32 v137, v137, v141
    s_waitcnt vmcnt(15) lgkmcnt(8)
    v_mfma_f32_16x16x32_bf16 v[104:107], v[52:55], a[48:51], v[104:107]
    ds_read_b128 a[68:71], v184 offset:17408
    v_add_f32 v138, v138, v142
    v_mfma_f32_16x16x32_bf16 v[104:107], v[56:59], a[52:55], v[104:107]
    buffer_load_dwordx4 v[40:43], v190, s[48:51], s23 offen offset:3072 sc1
    v_mfma_f32_16x16x32_bf16 v[104:107], v[60:63], a[56:59], v[104:107]
    ds_read_b128 a[140:143], v184 offset:35840
    v_add_f32 v139, v139, v143
    v_mfma_f32_16x16x32_bf16 v[108:111], v[52:55], a[120:123], v[108:111]
    ds_read_b128 a[212:215], v11 offset:17408
    v_add_f32 v136, v136, v138
    v_mfma_f32_16x16x32_bf16 v[108:111], v[56:59], a[124:127], v[108:111]
    ds_read_b128 v[248:251], v11 offset:35840
    v_add_f32 v137, v137, v139
    v_mfma_f32_16x16x32_bf16 v[108:111], v[60:63], a[128:131], v[108:111]
    buffer_load_dwordx4 v[44:47], v191, s[48:51], s23 offen offset:0 sc1
    v_mfma_f32_16x16x32_bf16 v[112:115], v[52:55], a[192:195], v[112:115]
    v_add_f32 v136, v136, v137
    v_mov_b32 v137, 0x3727c5ac
    v_mfma_f32_16x16x32_bf16 v[112:115], v[56:59], a[196:199], v[112:115]
    v_fmac_f32 v137, 0x3ae38e39, v136
    v_mov_b32 v193, v137
    v_mfma_f32_16x16x32_bf16 v[112:115], v[60:63], a[200:203], v[112:115]
    s_nop 0
    v_permlane16_swap_b32 v193, v137
    v_mfma_f32_16x16x32_bf16 v[116:119], v[52:55], v[228:231], v[116:119]
    buffer_load_dwordx4 v[48:51], v191, s[48:51], s23 offen offset:1024 sc1
    v_mfma_f32_16x16x32_bf16 v[116:119], v[56:59], v[232:235], v[116:119]
    v_mov_b32 v195, v193
    v_mov_b32 v194, v137
    v_mfma_f32_16x16x32_bf16 v[116:119], v[60:63], v[236:239], v[116:119]
    v_mov_b32 v252, v137
    s_waitcnt vmcnt(12) lgkmcnt(0)
    v_mfma_f32_16x16x32_bf16 v[88:91], v[64:67], a[60:63], v[88:91]
    s_nop 0
    v_permlane32_swap_b32 v193, v195
    v_mfma_f32_16x16x32_bf16 v[88:91], v[68:71], a[64:67], v[88:91]
    buffer_load_dwordx4 v[52:55], v191, s[48:51], s23 offen offset:2048 sc1
    v_mfma_f32_16x16x32_bf16 v[120:123], v[72:75], a[68:71], v[88:91]
    v_permlane32_swap_b32 v194, v252
    v_mfma_f32_16x16x32_bf16 v[92:95], v[64:67], a[132:135], v[92:95]
    v_rsq_f32 v4, v193
    v_mfma_f32_16x16x32_bf16 v[92:95], v[68:71], a[136:139], v[92:95]
    v_rsq_f32 v5, v194
    v_mfma_f32_16x16x32_bf16 v[124:127], v[72:75], a[140:143], v[92:95]
    buffer_load_dwordx4 v[56:59], v191, s[48:51], s23 offen offset:3072 sc1
    v_mfma_f32_16x16x32_bf16 v[96:99], v[64:67], a[204:207], v[96:99]
    v_rsq_f32 v6, v195
    v_mfma_f32_16x16x32_bf16 v[96:99], v[68:71], a[208:211], v[96:99]
    v_rsq_f32 v7, v252
    v_mfma_f32_16x16x32_bf16 v[128:131], v[72:75], a[212:215], v[96:99]
    v_mul_f32 v8, v4, v4
    v_mul_f32 v9, v5, v5
    v_mfma_f32_16x16x32_bf16 v[100:103], v[64:67], v[240:243], v[100:103]
    buffer_load_dwordx4 v[60:63], v192, s[48:51], s23 offen offset:0 sc1
    v_mfma_f32_16x16x32_bf16 v[100:103], v[68:71], v[244:247], v[100:103]
    v_mul_f32 v13, v6, v6
    v_mul_f32 v14, v7, v7
    v_mfma_f32_16x16x32_bf16 v[132:135], v[72:75], v[248:251], v[100:103]
    v_mul_f32 v4, 0xc0135761, v4
    v_mul_f32 v5, 0xc0135761, v5
    s_waitcnt vmcnt(12) lgkmcnt(0)
    v_mfma_f32_16x16x32_bf16 v[104:107], v[76:79], a[60:63], v[104:107]
    v_mul_f32 v6, 0xc0135761, v6
    v_mul_f32 v7, 0xc0135761, v7
    v_mfma_f32_16x16x32_bf16 v[104:107], v[80:83], a[64:67], v[104:107]
    buffer_load_dwordx4 v[64:67], v192, s[48:51], s23 offen offset:1024 sc1
    v_mfma_f32_16x16x32_bf16 v[136:139], v[84:87], a[68:71], v[104:107]
    v_mul_f32 v8, 0x3d372713, v8
    v_mul_f32 v9, 0x3d372713, v9
    v_mfma_f32_16x16x32_bf16 v[108:111], v[76:79], a[132:135], v[108:111]
    v_mul_f32 v13, 0x3d372713, v13
    v_mul_f32 v14, 0x3d372713, v14
    v_mfma_f32_16x16x32_bf16 v[108:111], v[80:83], a[136:139], v[108:111]
    v_mul_f32 v8, v8, v4
    v_mul_f32 v9, v9, v5
    v_mfma_f32_16x16x32_bf16 v[140:143], v[84:87], a[140:143], v[108:111]
    buffer_load_dwordx4 v[68:71], v192, s[48:51], s23 offen offset:2048 sc1
    v_mfma_f32_16x16x32_bf16 v[112:115], v[76:79], a[204:207], v[112:115]
    v_mul_f32 v13, v13, v6
    v_mul_f32 v14, v14, v7
    v_mfma_f32_16x16x32_bf16 v[112:115], v[80:83], a[208:211], v[112:115]
    s_mov_b32 s25, 0
    v_mfma_f32_16x16x32_bf16 v[144:147], v[84:87], a[212:215], v[112:115]
    s_mov_b32 s7, s28
    v_mfma_f32_16x16x32_bf16 v[116:119], v[76:79], v[240:243], v[116:119]
    buffer_load_dwordx4 v[72:75], v192, s[48:51], s23 offen offset:3072 sc1
    v_mfma_f32_16x16x32_bf16 v[116:119], v[80:83], v[244:247], v[116:119]
    s_add_u32 s23, s23, 36864
    v_mfma_f32_16x16x32_bf16 v[148:151], v[84:87], v[248:251], v[116:119]
    v_add_u32 v12, s7, v184
    s_add_u32 s25, s25, 1
L_ffn_gu_34:
    s_waitcnt vmcnt(12)
    v_mfma_f32_16x16x32_bf16 v[88:91], v[16:19], a[0:3], 0
    v_mfma_f32_16x16x32_bf16 v[88:91], v[20:23], a[4:7], v[88:91]
    buffer_load_dwordx4 v[76:79], v184, s[48:51], s23 offen offset:0 sc1
    v_mfma_f32_16x16x32_bf16 v[88:91], v[24:27], a[8:11], v[88:91]
    v_mul_f32 v152, v120, v120
    v_mul_f32 v153, v121, v121
    v_mfma_f32_16x16x32_bf16 v[92:95], v[16:19], a[72:75], 0
    v_mul_f32 v154, v122, v122
    v_mul_f32 v155, v123, v123
    v_mfma_f32_16x16x32_bf16 v[92:95], v[20:23], a[76:79], v[92:95]
    v_fma_f32 v152, v152, v8, v4
    v_fma_f32 v153, v153, v8, v4
    v_mfma_f32_16x16x32_bf16 v[92:95], v[24:27], a[80:83], v[92:95]
    buffer_load_dwordx4 v[80:83], v184, s[48:51], s23 offen offset:1024 sc1
    v_mfma_f32_16x16x32_bf16 v[96:99], v[16:19], a[144:147], 0
    v_fma_f32 v154, v154, v8, v4
    v_fma_f32 v155, v155, v8, v4
    v_mfma_f32_16x16x32_bf16 v[96:99], v[20:23], a[148:151], v[96:99]
    v_mul_f32 v152, v120, v152
    v_mul_f32 v153, v121, v153
    v_mfma_f32_16x16x32_bf16 v[96:99], v[24:27], a[152:155], v[96:99]
    v_mul_f32 v154, v122, v154
    v_mul_f32 v155, v123, v155
    v_mfma_f32_16x16x32_bf16 v[100:103], v[16:19], a[216:219], 0
    buffer_load_dwordx4 v[84:87], v184, s[48:51], s23 offen offset:2048 sc1
    v_mfma_f32_16x16x32_bf16 v[100:103], v[20:23], a[220:223], v[100:103]
    v_exp_f32 v152, v152
    v_mfma_f32_16x16x32_bf16 v[100:103], v[24:27], a[224:227], v[100:103]
    v_exp_f32 v153, v153
    s_waitcnt vmcnt(12)
    v_mfma_f32_16x16x32_bf16 v[104:107], v[28:31], a[0:3], 0
    v_exp_f32 v154, v154
    v_mfma_f32_16x16x32_bf16 v[104:107], v[32:35], a[4:7], v[104:107]
    buffer_load_dwordx4 v[16:19], v184, s[48:51], s23 offen offset:3072 sc1
    v_mfma_f32_16x16x32_bf16 v[104:107], v[36:39], a[8:11], v[104:107]
    v_exp_f32 v155, v155
    v_mfma_f32_16x16x32_bf16 v[108:111], v[28:31], a[72:75], 0
    v_mul_f32 v156, v120, v136
    v_mul_f32 v157, v121, v137
    v_mfma_f32_16x16x32_bf16 v[108:111], v[32:35], a[76:79], v[108:111]
    v_mul_f32 v158, v122, v138
    v_mul_f32 v159, v123, v139
    v_mfma_f32_16x16x32_bf16 v[108:111], v[36:39], a[80:83], v[108:111]
    buffer_load_dwordx4 v[20:23], v185, s[48:51], s23 offen offset:0 sc1
    v_mfma_f32_16x16x32_bf16 v[112:115], v[28:31], a[144:147], 0
    v_fma_f32 v152, v152, v193, v193
    v_fma_f32 v153, v153, v193, v193
    v_mfma_f32_16x16x32_bf16 v[112:115], v[32:35], a[148:151], v[112:115]
    v_fma_f32 v154, v154, v193, v193
    v_fma_f32 v155, v155, v193, v193
    v_mfma_f32_16x16x32_bf16 v[112:115], v[36:39], a[152:155], v[112:115]
    v_rcp_f32 v152, v152
    v_mfma_f32_16x16x32_bf16 v[116:119], v[28:31], a[216:219], 0
    buffer_load_dwordx4 v[24:27], v185, s[48:51], s23 offen offset:1024 sc1
    v_mfma_f32_16x16x32_bf16 v[116:119], v[32:35], a[220:223], v[116:119]
    v_rcp_f32 v153, v153
    v_mfma_f32_16x16x32_bf16 v[116:119], v[36:39], a[224:227], v[116:119]
    v_rcp_f32 v154, v154
    s_waitcnt vmcnt(12)
    v_mfma_f32_16x16x32_bf16 v[88:91], v[40:43], a[12:15], v[88:91]
    v_rcp_f32 v155, v155
    v_mfma_f32_16x16x32_bf16 v[88:91], v[44:47], a[16:19], v[88:91]
    buffer_load_dwordx4 v[28:31], v185, s[48:51], s23 offen offset:2048 sc1
    v_mfma_f32_16x16x32_bf16 v[88:91], v[48:51], a[20:23], v[88:91]
    v_mul_f32 v156, v156, v152
    v_mul_f32 v157, v157, v153
    v_mfma_f32_16x16x32_bf16 v[92:95], v[40:43], a[84:87], v[92:95]
    v_mul_f32 v158, v158, v154
    v_mul_f32 v159, v159, v155
    v_mfma_f32_16x16x32_bf16 v[92:95], v[44:47], a[88:91], v[92:95]
    v_cvt_pk_bf16_f32 v160, v156, v157
    v_cvt_pk_bf16_f32 v161, v158, v159
    v_mfma_f32_16x16x32_bf16 v[92:95], v[48:51], a[92:95], v[92:95]
    buffer_load_dwordx4 v[32:35], v185, s[48:51], s23 offen offset:3072 sc1
    v_mfma_f32_16x16x32_bf16 v[96:99], v[40:43], a[156:159], v[96:99]
    ds_write_b64 v12, v[160:161] offset:0
    v_mfma_f32_16x16x32_bf16 v[96:99], v[44:47], a[160:163], v[96:99]
    v_mul_f32 v162, v124, v124
    v_mul_f32 v163, v125, v125
    v_mfma_f32_16x16x32_bf16 v[96:99], v[48:51], a[164:167], v[96:99]
    v_mul_f32 v164, v126, v126
    v_mul_f32 v165, v127, v127
    v_mfma_f32_16x16x32_bf16 v[100:103], v[40:43], a[228:231], v[100:103]
    buffer_load_dwordx4 v[36:39], v186, s[48:51], s23 offen offset:0 sc1
    v_mfma_f32_16x16x32_bf16 v[100:103], v[44:47], a[232:235], v[100:103]
    v_fma_f32 v162, v162, v9, v5
    v_fma_f32 v163, v163, v9, v5
    v_mfma_f32_16x16x32_bf16 v[100:103], v[48:51], a[236:239], v[100:103]
    v_fma_f32 v164, v164, v9, v5
    v_fma_f32 v165, v165, v9, v5
    s_waitcnt vmcnt(12)
    v_mfma_f32_16x16x32_bf16 v[104:107], v[52:55], a[12:15], v[104:107]
    v_mul_f32 v162, v124, v162
    v_mul_f32 v163, v125, v163
    v_mfma_f32_16x16x32_bf16 v[104:107], v[56:59], a[16:19], v[104:107]
    buffer_load_dwordx4 v[40:43], v186, s[48:51], s23 offen offset:1024 sc1
    v_mfma_f32_16x16x32_bf16 v[104:107], v[60:63], a[20:23], v[104:107]
    v_mul_f32 v164, v126, v164
    v_mul_f32 v165, v127, v165
    v_mfma_f32_16x16x32_bf16 v[108:111], v[52:55], a[84:87], v[108:111]
    v_exp_f32 v162, v162
    v_mfma_f32_16x16x32_bf16 v[108:111], v[56:59], a[88:91], v[108:111]
    v_exp_f32 v163, v163
    v_mfma_f32_16x16x32_bf16 v[108:111], v[60:63], a[92:95], v[108:111]
    buffer_load_dwordx4 v[44:47], v186, s[48:51], s23 offen offset:2048 sc1
    v_mfma_f32_16x16x32_bf16 v[112:115], v[52:55], a[156:159], v[112:115]
    v_exp_f32 v164, v164
    v_mfma_f32_16x16x32_bf16 v[112:115], v[56:59], a[160:163], v[112:115]
    v_exp_f32 v165, v165
    v_mfma_f32_16x16x32_bf16 v[112:115], v[60:63], a[164:167], v[112:115]
    v_mul_f32 v166, v124, v140
    v_mul_f32 v167, v125, v141
    v_mfma_f32_16x16x32_bf16 v[116:119], v[52:55], a[228:231], v[116:119]
    buffer_load_dwordx4 v[48:51], v186, s[48:51], s23 offen offset:3072 sc1
    v_mfma_f32_16x16x32_bf16 v[116:119], v[56:59], a[232:235], v[116:119]
    v_mul_f32 v168, v126, v142
    v_mul_f32 v169, v127, v143
    v_mfma_f32_16x16x32_bf16 v[116:119], v[60:63], a[236:239], v[116:119]
    v_fma_f32 v162, v162, v194, v194
    v_fma_f32 v163, v163, v194, v194
    s_waitcnt vmcnt(12)
    v_mfma_f32_16x16x32_bf16 v[88:91], v[64:67], a[24:27], v[88:91]
    v_fma_f32 v164, v164, v194, v194
    v_fma_f32 v165, v165, v194, v194
    v_mfma_f32_16x16x32_bf16 v[88:91], v[68:71], a[28:31], v[88:91]
    buffer_load_dwordx4 v[52:55], v187, s[48:51], s23 offen offset:0 sc1
    v_mfma_f32_16x16x32_bf16 v[88:91], v[72:75], a[32:35], v[88:91]
    v_rcp_f32 v162, v162
    v_mfma_f32_16x16x32_bf16 v[92:95], v[64:67], a[96:99], v[92:95]
    v_rcp_f32 v163, v163
    v_mfma_f32_16x16x32_bf16 v[92:95], v[68:71], a[100:103], v[92:95]
    v_rcp_f32 v164, v164
    v_mfma_f32_16x16x32_bf16 v[92:95], v[72:75], a[104:107], v[92:95]
    buffer_load_dwordx4 v[56:59], v187, s[48:51], s23 offen offset:1024 sc1
    v_mfma_f32_16x16x32_bf16 v[96:99], v[64:67], a[168:171], v[96:99]
    v_rcp_f32 v165, v165
    v_mfma_f32_16x16x32_bf16 v[96:99], v[68:71], a[172:175], v[96:99]
    v_mul_f32 v166, v166, v162
    v_mul_f32 v167, v167, v163
    v_mfma_f32_16x16x32_bf16 v[96:99], v[72:75], a[176:179], v[96:99]
    v_mul_f32 v168, v168, v164
    v_mul_f32 v169, v169, v165
    v_mfma_f32_16x16x32_bf16 v[100:103], v[64:67], a[240:243], v[100:103]
    buffer_load_dwordx4 v[60:63], v187, s[48:51], s23 offen offset:2048 sc1
    v_mfma_f32_16x16x32_bf16 v[100:103], v[68:71], a[244:247], v[100:103]
    v_cvt_pk_bf16_f32 v170, v166, v167
    v_cvt_pk_bf16_f32 v171, v168, v169
    v_mfma_f32_16x16x32_bf16 v[100:103], v[72:75], a[248:251], v[100:103]
    ds_write_b64 v12, v[170:171] offset:18432
    s_waitcnt vmcnt(12)
    v_mfma_f32_16x16x32_bf16 v[104:107], v[76:79], a[24:27], v[104:107]
    v_mul_f32 v152, v128, v128
    v_mul_f32 v153, v129, v129
    v_mfma_f32_16x16x32_bf16 v[104:107], v[80:83], a[28:31], v[104:107]
    buffer_load_dwordx4 v[64:67], v187, s[48:51], s23 offen offset:3072 sc1
    v_mfma_f32_16x16x32_bf16 v[104:107], v[84:87], a[32:35], v[104:107]
    v_mul_f32 v154, v130, v130
    v_mul_f32 v155, v131, v131
    v_mfma_f32_16x16x32_bf16 v[108:111], v[76:79], a[96:99], v[108:111]
    v_fma_f32 v152, v152, v13, v6
    v_fma_f32 v153, v153, v13, v6
    v_mfma_f32_16x16x32_bf16 v[108:111], v[80:83], a[100:103], v[108:111]
    v_fma_f32 v154, v154, v13, v6
    v_fma_f32 v155, v155, v13, v6
    v_mfma_f32_16x16x32_bf16 v[108:111], v[84:87], a[104:107], v[108:111]
    buffer_load_dwordx4 v[68:71], v188, s[48:51], s23 offen offset:0 sc1
    v_mfma_f32_16x16x32_bf16 v[112:115], v[76:79], a[168:171], v[112:115]
    v_mul_f32 v152, v128, v152
    v_mul_f32 v153, v129, v153
    v_mfma_f32_16x16x32_bf16 v[112:115], v[80:83], a[172:175], v[112:115]
    v_mul_f32 v154, v130, v154
    v_mul_f32 v155, v131, v155
    v_mfma_f32_16x16x32_bf16 v[112:115], v[84:87], a[176:179], v[112:115]
    v_exp_f32 v152, v152
    v_mfma_f32_16x16x32_bf16 v[116:119], v[76:79], a[240:243], v[116:119]
    buffer_load_dwordx4 v[72:75], v188, s[48:51], s23 offen offset:1024 sc1
    v_mfma_f32_16x16x32_bf16 v[116:119], v[80:83], a[244:247], v[116:119]
    v_exp_f32 v153, v153
    v_mfma_f32_16x16x32_bf16 v[116:119], v[84:87], a[248:251], v[116:119]
    v_exp_f32 v154, v154
    s_waitcnt vmcnt(12)
    v_mfma_f32_16x16x32_bf16 v[88:91], v[16:19], a[36:39], v[88:91]
    v_exp_f32 v155, v155
    v_mfma_f32_16x16x32_bf16 v[88:91], v[20:23], a[40:43], v[88:91]
    buffer_load_dwordx4 v[76:79], v188, s[48:51], s23 offen offset:2048 sc1
    v_mfma_f32_16x16x32_bf16 v[88:91], v[24:27], a[44:47], v[88:91]
    v_mul_f32 v156, v128, v144
    v_mul_f32 v157, v129, v145
    v_mfma_f32_16x16x32_bf16 v[92:95], v[16:19], a[108:111], v[92:95]
    v_mul_f32 v158, v130, v146
    v_mul_f32 v159, v131, v147
    v_mfma_f32_16x16x32_bf16 v[92:95], v[20:23], a[112:115], v[92:95]
    v_fma_f32 v152, v152, v195, v195
    v_fma_f32 v153, v153, v195, v195
    v_mfma_f32_16x16x32_bf16 v[92:95], v[24:27], a[116:119], v[92:95]
    buffer_load_dwordx4 v[80:83], v188, s[48:51], s23 offen offset:3072 sc1
    v_mfma_f32_16x16x32_bf16 v[96:99], v[16:19], a[180:183], v[96:99]
    v_fma_f32 v154, v154, v195, v195
    v_fma_f32 v155, v155, v195, v195
    v_mfma_f32_16x16x32_bf16 v[96:99], v[20:23], a[184:187], v[96:99]
    v_rcp_f32 v152, v152
    v_mfma_f32_16x16x32_bf16 v[96:99], v[24:27], a[188:191], v[96:99]
    v_rcp_f32 v153, v153
    v_mfma_f32_16x16x32_bf16 v[100:103], v[16:19], a[252:255], v[100:103]
    buffer_load_dwordx4 v[84:87], v189, s[48:51], s23 offen offset:0 sc1
    v_mfma_f32_16x16x32_bf16 v[100:103], v[20:23], v[220:223], v[100:103]
    v_rcp_f32 v154, v154
    v_mfma_f32_16x16x32_bf16 v[100:103], v[24:27], v[224:227], v[100:103]
    v_rcp_f32 v155, v155
    s_waitcnt vmcnt(12)
    v_mfma_f32_16x16x32_bf16 v[104:107], v[28:31], a[36:39], v[104:107]
    v_mul_f32 v156, v156, v152
    v_mul_f32 v157, v157, v153
    v_mfma_f32_16x16x32_bf16 v[104:107], v[32:35], a[40:43], v[104:107]
    buffer_load_dwordx4 v[16:19], v189, s[48:51], s23 offen offset:1024 sc1
    v_mfma_f32_16x16x32_bf16 v[104:107], v[36:39], a[44:47], v[104:107]
    v_mul_f32 v158, v158, v154
    v_mul_f32 v159, v159, v155
    v_mfma_f32_16x16x32_bf16 v[108:111], v[28:31], a[108:111], v[108:111]
    v_cvt_pk_bf16_f32 v160, v156, v157
    v_cvt_pk_bf16_f32 v161, v158, v159
    v_mfma_f32_16x16x32_bf16 v[108:111], v[32:35], a[112:115], v[108:111]
    ds_write_b64 v12, v[160:161] offset:36864
    v_mfma_f32_16x16x32_bf16 v[108:111], v[36:39], a[116:119], v[108:111]
    buffer_load_dwordx4 v[20:23], v189, s[48:51], s23 offen offset:2048 sc1
    v_mfma_f32_16x16x32_bf16 v[112:115], v[28:31], a[180:183], v[112:115]
    v_mul_f32 v162, v132, v132
    v_mul_f32 v163, v133, v133
    v_mfma_f32_16x16x32_bf16 v[112:115], v[32:35], a[184:187], v[112:115]
    v_mul_f32 v164, v134, v134
    v_mul_f32 v165, v135, v135
    v_mfma_f32_16x16x32_bf16 v[112:115], v[36:39], a[188:191], v[112:115]
    v_fma_f32 v162, v162, v14, v7
    v_fma_f32 v163, v163, v14, v7
    v_mfma_f32_16x16x32_bf16 v[116:119], v[28:31], a[252:255], v[116:119]
    buffer_load_dwordx4 v[24:27], v189, s[48:51], s23 offen offset:3072 sc1
    v_mfma_f32_16x16x32_bf16 v[116:119], v[32:35], v[220:223], v[116:119]
    v_fma_f32 v164, v164, v14, v7
    v_fma_f32 v165, v165, v14, v7
    v_mfma_f32_16x16x32_bf16 v[116:119], v[36:39], v[224:227], v[116:119]
    v_mul_f32 v162, v132, v162
    v_mul_f32 v163, v133, v163
    s_waitcnt vmcnt(12)
    v_mfma_f32_16x16x32_bf16 v[88:91], v[40:43], a[48:51], v[88:91]
    v_mul_f32 v164, v134, v164
    v_mul_f32 v165, v135, v165
    v_mfma_f32_16x16x32_bf16 v[88:91], v[44:47], a[52:55], v[88:91]
    buffer_load_dwordx4 v[28:31], v190, s[48:51], s23 offen offset:0 sc1
    v_mfma_f32_16x16x32_bf16 v[88:91], v[48:51], a[56:59], v[88:91]
    v_exp_f32 v162, v162
    v_mfma_f32_16x16x32_bf16 v[92:95], v[40:43], a[120:123], v[92:95]
    v_exp_f32 v163, v163
    v_mfma_f32_16x16x32_bf16 v[92:95], v[44:47], a[124:127], v[92:95]
    v_exp_f32 v164, v164
    v_mfma_f32_16x16x32_bf16 v[92:95], v[48:51], a[128:131], v[92:95]
    buffer_load_dwordx4 v[32:35], v190, s[48:51], s23 offen offset:1024 sc1
    v_mfma_f32_16x16x32_bf16 v[96:99], v[40:43], a[192:195], v[96:99]
    v_exp_f32 v165, v165
    v_mfma_f32_16x16x32_bf16 v[96:99], v[44:47], a[196:199], v[96:99]
    v_mul_f32 v166, v132, v148
    v_mul_f32 v167, v133, v149
    v_mfma_f32_16x16x32_bf16 v[96:99], v[48:51], a[200:203], v[96:99]
    v_mul_f32 v168, v134, v150
    v_mul_f32 v169, v135, v151
    v_mfma_f32_16x16x32_bf16 v[100:103], v[40:43], v[228:231], v[100:103]
    buffer_load_dwordx4 v[36:39], v190, s[48:51], s23 offen offset:2048 sc1
    v_mfma_f32_16x16x32_bf16 v[100:103], v[44:47], v[232:235], v[100:103]
    v_fma_f32 v162, v162, v252, v252
    v_fma_f32 v163, v163, v252, v252
    v_mfma_f32_16x16x32_bf16 v[100:103], v[48:51], v[236:239], v[100:103]
    v_fma_f32 v164, v164, v252, v252
    v_fma_f32 v165, v165, v252, v252
    s_waitcnt vmcnt(12)
    v_mfma_f32_16x16x32_bf16 v[104:107], v[52:55], a[48:51], v[104:107]
    v_rcp_f32 v162, v162
    v_mfma_f32_16x16x32_bf16 v[104:107], v[56:59], a[52:55], v[104:107]
    buffer_load_dwordx4 v[40:43], v190, s[48:51], s23 offen offset:3072 sc1
    v_mfma_f32_16x16x32_bf16 v[104:107], v[60:63], a[56:59], v[104:107]
    v_rcp_f32 v163, v163
    v_mfma_f32_16x16x32_bf16 v[108:111], v[52:55], a[120:123], v[108:111]
    v_rcp_f32 v164, v164
    v_mfma_f32_16x16x32_bf16 v[108:111], v[56:59], a[124:127], v[108:111]
    v_rcp_f32 v165, v165
    v_mfma_f32_16x16x32_bf16 v[108:111], v[60:63], a[128:131], v[108:111]
    buffer_load_dwordx4 v[44:47], v191, s[48:51], s23 offen offset:0 sc1
    v_mfma_f32_16x16x32_bf16 v[112:115], v[52:55], a[192:195], v[112:115]
    v_mul_f32 v166, v166, v162
    v_mul_f32 v167, v167, v163
    v_mfma_f32_16x16x32_bf16 v[112:115], v[56:59], a[196:199], v[112:115]
    v_mul_f32 v168, v168, v164
    v_mul_f32 v169, v169, v165
    v_mfma_f32_16x16x32_bf16 v[112:115], v[60:63], a[200:203], v[112:115]
    v_cvt_pk_bf16_f32 v170, v166, v167
    v_cvt_pk_bf16_f32 v171, v168, v169
    v_mfma_f32_16x16x32_bf16 v[116:119], v[52:55], v[228:231], v[116:119]
    buffer_load_dwordx4 v[48:51], v191, s[48:51], s23 offen offset:1024 sc1
    v_mfma_f32_16x16x32_bf16 v[116:119], v[56:59], v[232:235], v[116:119]
    ds_write_b64 v12, v[170:171] offset:55296
    v_mfma_f32_16x16x32_bf16 v[116:119], v[60:63], v[236:239], v[116:119]
    s_waitcnt vmcnt(12)
    v_mfma_f32_16x16x32_bf16 v[88:91], v[64:67], a[60:63], v[88:91]
    v_mfma_f32_16x16x32_bf16 v[88:91], v[68:71], a[64:67], v[88:91]
    buffer_load_dwordx4 v[52:55], v191, s[48:51], s23 offen offset:2048 sc1
    v_mfma_f32_16x16x32_bf16 v[120:123], v[72:75], a[68:71], v[88:91]
    v_mfma_f32_16x16x32_bf16 v[92:95], v[64:67], a[132:135], v[92:95]
    v_mfma_f32_16x16x32_bf16 v[92:95], v[68:71], a[136:139], v[92:95]
    v_mfma_f32_16x16x32_bf16 v[124:127], v[72:75], a[140:143], v[92:95]
    buffer_load_dwordx4 v[56:59], v191, s[48:51], s23 offen offset:3072 sc1
    v_mfma_f32_16x16x32_bf16 v[96:99], v[64:67], a[204:207], v[96:99]
    v_mfma_f32_16x16x32_bf16 v[96:99], v[68:71], a[208:211], v[96:99]
    v_mfma_f32_16x16x32_bf16 v[128:131], v[72:75], a[212:215], v[96:99]
    v_mfma_f32_16x16x32_bf16 v[100:103], v[64:67], v[240:243], v[100:103]
    buffer_load_dwordx4 v[60:63], v192, s[48:51], s23 offen offset:0 sc1
    v_mfma_f32_16x16x32_bf16 v[100:103], v[68:71], v[244:247], v[100:103]
    v_mfma_f32_16x16x32_bf16 v[132:135], v[72:75], v[248:251], v[100:103]
    s_waitcnt vmcnt(12)
    v_mfma_f32_16x16x32_bf16 v[104:107], v[76:79], a[60:63], v[104:107]
    v_mfma_f32_16x16x32_bf16 v[104:107], v[80:83], a[64:67], v[104:107]
    buffer_load_dwordx4 v[64:67], v192, s[48:51], s23 offen offset:1024 sc1
    v_mfma_f32_16x16x32_bf16 v[136:139], v[84:87], a[68:71], v[104:107]
    v_mfma_f32_16x16x32_bf16 v[108:111], v[76:79], a[132:135], v[108:111]
    v_mfma_f32_16x16x32_bf16 v[108:111], v[80:83], a[136:139], v[108:111]
    v_mfma_f32_16x16x32_bf16 v[140:143], v[84:87], a[140:143], v[108:111]
    buffer_load_dwordx4 v[68:71], v192, s[48:51], s23 offen offset:2048 sc1
    v_mfma_f32_16x16x32_bf16 v[112:115], v[76:79], a[204:207], v[112:115]
    v_mfma_f32_16x16x32_bf16 v[112:115], v[80:83], a[208:211], v[112:115]
    s_lshl_b32 s7, s25, 11
    v_mfma_f32_16x16x32_bf16 v[144:147], v[84:87], a[212:215], v[112:115]
    s_add_u32 s7, s7, s28
    v_mfma_f32_16x16x32_bf16 v[116:119], v[76:79], v[240:243], v[116:119]
    buffer_load_dwordx4 v[72:75], v192, s[48:51], s23 offen offset:3072 sc1
    v_mfma_f32_16x16x32_bf16 v[116:119], v[80:83], v[244:247], v[116:119]
    s_add_u32 s23, s23, 36864
    v_mfma_f32_16x16x32_bf16 v[148:151], v[84:87], v[248:251], v[116:119]
    v_add_u32 v12, s7, v184
    s_add_u32 s25, s25, 1
    s_cmp_lt_u32 s25, 8
    s_cbranch_scc1 L_ffn_gu_34
    v_add_u32 v10, 73728, v184
    v_add_u32 v11, 110592, v184
    s_lshr_b32 s7, s2, 3
    s_lshl_b32 s7, s7, 2
    s_add_u32 s7, s7, s3
    s_lshl_b32 s7, s7, 9
    v_lshrrev_b32 v1, 1, v253
    v_add_u32 v1, s7, v1
    buffer_load_dwordx2 v[2:3], v1, s[96:99], 0 offen
    s_waitcnt lgkmcnt(0)
    s_barrier
    s_waitcnt vmcnt(12)
    v_mfma_f32_16x16x32_bf16 v[88:91], v[16:19], a[0:3], 0
    v_mfma_f32_16x16x32_bf16 v[88:91], v[20:23], a[4:7], v[88:91]
    buffer_load_dwordx4 v[76:79], v184, s[48:51], s23 offen offset:0 sc1
    v_mfma_f32_16x16x32_bf16 v[88:91], v[24:27], a[8:11], v[88:91]
    v_mul_f32 v152, v120, v120
    v_mul_f32 v153, v121, v121
    v_mfma_f32_16x16x32_bf16 v[92:95], v[16:19], a[72:75], 0
    v_mul_f32 v154, v122, v122
    v_mul_f32 v155, v123, v123
    v_mfma_f32_16x16x32_bf16 v[92:95], v[20:23], a[76:79], v[92:95]
    v_fma_f32 v152, v152, v8, v4
    v_fma_f32 v153, v153, v8, v4
    v_mfma_f32_16x16x32_bf16 v[92:95], v[24:27], a[80:83], v[92:95]
    buffer_load_dwordx4 v[80:83], v184, s[48:51], s23 offen offset:1024 sc1
    v_mfma_f32_16x16x32_bf16 v[96:99], v[16:19], a[144:147], 0
    v_fma_f32 v154, v154, v8, v4
    v_fma_f32 v155, v155, v8, v4
    v_mfma_f32_16x16x32_bf16 v[96:99], v[20:23], a[148:151], v[96:99]
    v_mul_f32 v152, v120, v152
    v_mul_f32 v153, v121, v153
    v_mfma_f32_16x16x32_bf16 v[96:99], v[24:27], a[152:155], v[96:99]
    v_mul_f32 v154, v122, v154
    v_mul_f32 v155, v123, v155
    v_mfma_f32_16x16x32_bf16 v[100:103], v[16:19], a[216:219], 0
    buffer_load_dwordx4 v[84:87], v184, s[48:51], s23 offen offset:2048 sc1
    v_mfma_f32_16x16x32_bf16 v[100:103], v[20:23], a[220:223], v[100:103]
    v_exp_f32 v152, v152
    v_mfma_f32_16x16x32_bf16 v[100:103], v[24:27], a[224:227], v[100:103]
    v_exp_f32 v153, v153
    s_waitcnt vmcnt(12)
    v_mfma_f32_16x16x32_bf16 v[104:107], v[28:31], a[0:3], 0
    v_exp_f32 v154, v154
    ds_read_b128 a[0:3], v10 offset:0
    v_mfma_f32_16x16x32_bf16 v[104:107], v[32:35], a[4:7], v[104:107]
    buffer_load_dwordx4 v[16:19], v184, s[48:51], s23 offen offset:3072 sc1
    v_mfma_f32_16x16x32_bf16 v[104:107], v[36:39], a[8:11], v[104:107]
    v_exp_f32 v155, v155
    v_mfma_f32_16x16x32_bf16 v[108:111], v[28:31], a[72:75], 0
    v_mul_f32 v156, v120, v136
    v_mul_f32 v157, v121, v137
    ds_read_b128 a[72:75], v10 offset:18432
    v_mfma_f32_16x16x32_bf16 v[108:111], v[32:35], a[76:79], v[108:111]
    v_mul_f32 v158, v122, v138
    v_mul_f32 v159, v123, v139
    v_mfma_f32_16x16x32_bf16 v[108:111], v[36:39], a[80:83], v[108:111]
    buffer_load_dwordx4 v[20:23], v185, s[48:51], s23 offen offset:0 sc1
    v_mfma_f32_16x16x32_bf16 v[112:115], v[28:31], a[144:147], 0
    v_fma_f32 v152, v152, v193, v193
    v_fma_f32 v153, v153, v193, v193
    ds_read_b128 a[144:147], v11 offset:0
    v_mfma_f32_16x16x32_bf16 v[112:115], v[32:35], a[148:151], v[112:115]
    v_fma_f32 v154, v154, v193, v193
    v_fma_f32 v155, v155, v193, v193
    v_mfma_f32_16x16x32_bf16 v[112:115], v[36:39], a[152:155], v[112:115]
    v_rcp_f32 v152, v152
    v_mfma_f32_16x16x32_bf16 v[116:119], v[28:31], a[216:219], 0
    buffer_load_dwordx4 v[24:27], v185, s[48:51], s23 offen offset:1024 sc1
    v_mfma_f32_16x16x32_bf16 v[116:119], v[32:35], a[220:223], v[116:119]
    v_rcp_f32 v153, v153
    ds_read_b128 a[216:219], v11 offset:18432
    v_mfma_f32_16x16x32_bf16 v[116:119], v[36:39], a[224:227], v[116:119]
    v_rcp_f32 v154, v154
    ds_read_b128 a[4:7], v10 offset:1024
    s_waitcnt vmcnt(12)
    v_mfma_f32_16x16x32_bf16 v[88:91], v[40:43], a[12:15], v[88:91]
    v_rcp_f32 v155, v155
    ds_read_b128 a[76:79], v10 offset:19456
    v_mfma_f32_16x16x32_bf16 v[88:91], v[44:47], a[16:19], v[88:91]
    buffer_load_dwordx4 v[28:31], v185, s[48:51], s23 offen offset:2048 sc1
    v_mfma_f32_16x16x32_bf16 v[88:91], v[48:51], a[20:23], v[88:91]
    v_mul_f32 v156, v156, v152
    v_mul_f32 v157, v157, v153
    ds_read_b128 a[148:151], v11 offset:1024
    v_mfma_f32_16x16x32_bf16 v[92:95], v[40:43], a[84:87], v[92:95]
    v_mul_f32 v158, v158, v154
    v_mul_f32 v159, v159, v155
    ds_read_b128 a[220:223], v11 offset:19456
    v_mfma_f32_16x16x32_bf16 v[92:95], v[44:47], a[88:91], v[92:95]
    v_cvt_pk_bf16_f32 v160, v156, v157
    v_cvt_pk_bf16_f32 v161, v158, v159
    ds_read_b128 a[8:11], v10 offset:2048
    v_mfma_f32_16x16x32_bf16 v[92:95], v[48:51], a[92:95], v[92:95]
    buffer_load_dwordx4 v[32:35], v185, s[48:51], s23 offen offset:3072 sc1
    v_mfma_f32_16x16x32_bf16 v[96:99], v[40:43], a[156:159], v[96:99]
    ds_write_b64 v12, v[160:161] offset:0
    v_mfma_f32_16x16x32_bf16 v[96:99], v[44:47], a[160:163], v[96:99]
    v_mul_f32 v162, v124, v124
    v_mul_f32 v163, v125, v125
    ds_read_b128 a[80:83], v10 offset:20480
    v_mfma_f32_16x16x32_bf16 v[96:99], v[48:51], a[164:167], v[96:99]
    v_mul_f32 v164, v126, v126
    v_mul_f32 v165, v127, v127
    ds_read_b128 a[152:155], v11 offset:2048
    v_mfma_f32_16x16x32_bf16 v[100:103], v[40:43], a[228:231], v[100:103]
    buffer_load_dwordx4 v[36:39], v186, s[48:51], s23 offen offset:0 sc1
    v_mfma_f32_16x16x32_bf16 v[100:103], v[44:47], a[232:235], v[100:103]
    v_fma_f32 v162, v162, v9, v5
    v_fma_f32 v163, v163, v9, v5
    ds_read_b128 a[224:227], v11 offset:20480
    v_mfma_f32_16x16x32_bf16 v[100:103], v[48:51], a[236:239], v[100:103]
    v_fma_f32 v164, v164, v9, v5
    v_fma_f32 v165, v165, v9, v5
    s_waitcnt vmcnt(12)
    v_mfma_f32_16x16x32_bf16 v[104:107], v[52:55], a[12:15], v[104:107]
    v_mul_f32 v162, v124, v162
    v_mul_f32 v163, v125, v163
    ds_read_b128 a[12:15], v10 offset:3072
    v_mfma_f32_16x16x32_bf16 v[104:107], v[56:59], a[16:19], v[104:107]
    buffer_load_dwordx4 v[40:43], v186, s[48:51], s23 offen offset:1024 sc1
    v_mfma_f32_16x16x32_bf16 v[104:107], v[60:63], a[20:23], v[104:107]
    v_mul_f32 v164, v126, v164
    v_mul_f32 v165, v127, v165
    v_mfma_f32_16x16x32_bf16 v[108:111], v[52:55], a[84:87], v[108:111]
    v_exp_f32 v162, v162
    ds_read_b128 a[84:87], v10 offset:21504
    v_mfma_f32_16x16x32_bf16 v[108:111], v[56:59], a[88:91], v[108:111]
    v_exp_f32 v163, v163
    v_mfma_f32_16x16x32_bf16 v[108:111], v[60:63], a[92:95], v[108:111]
    buffer_load_dwordx4 v[44:47], v186, s[48:51], s23 offen offset:2048 sc1
    v_mfma_f32_16x16x32_bf16 v[112:115], v[52:55], a[156:159], v[112:115]
    v_exp_f32 v164, v164
    ds_read_b128 a[156:159], v11 offset:3072
    v_mfma_f32_16x16x32_bf16 v[112:115], v[56:59], a[160:163], v[112:115]
    v_exp_f32 v165, v165
    v_mfma_f32_16x16x32_bf16 v[112:115], v[60:63], a[164:167], v[112:115]
    v_mul_f32 v166, v124, v140
    v_mul_f32 v167, v125, v141
    v_mfma_f32_16x16x32_bf16 v[116:119], v[52:55], a[228:231], v[116:119]
    buffer_load_dwordx4 v[48:51], v186, s[48:51], s23 offen offset:3072 sc1
    v_mfma_f32_16x16x32_bf16 v[116:119], v[56:59], a[232:235], v[116:119]
    v_mul_f32 v168, v126, v142
    v_mul_f32 v169, v127, v143
    ds_read_b128 a[228:231], v11 offset:21504
    v_mfma_f32_16x16x32_bf16 v[116:119], v[60:63], a[236:239], v[116:119]
    v_fma_f32 v162, v162, v194, v194
    v_fma_f32 v163, v163, v194, v194
    ds_read_b128 a[16:19], v10 offset:4096
    s_waitcnt vmcnt(12)
    v_mfma_f32_16x16x32_bf16 v[88:91], v[64:67], a[24:27], v[88:91]
    v_fma_f32 v164, v164, v194, v194
    v_fma_f32 v165, v165, v194, v194
    ds_read_b128 a[88:91], v10 offset:22528
    v_mfma_f32_16x16x32_bf16 v[88:91], v[68:71], a[28:31], v[88:91]
    buffer_load_dwordx4 v[52:55], v187, s[48:51], s23 offen offset:0 sc1
    v_mfma_f32_16x16x32_bf16 v[88:91], v[72:75], a[32:35], v[88:91]
    v_rcp_f32 v162, v162
    ds_read_b128 a[160:163], v11 offset:4096
    v_mfma_f32_16x16x32_bf16 v[92:95], v[64:67], a[96:99], v[92:95]
    v_rcp_f32 v163, v163
    ds_read_b128 a[232:235], v11 offset:22528
    v_mfma_f32_16x16x32_bf16 v[92:95], v[68:71], a[100:103], v[92:95]
    v_rcp_f32 v164, v164
    ds_read_b128 a[20:23], v10 offset:5120
    v_mfma_f32_16x16x32_bf16 v[92:95], v[72:75], a[104:107], v[92:95]
    buffer_load_dwordx4 v[56:59], v187, s[48:51], s23 offen offset:1024 sc1
    v_mfma_f32_16x16x32_bf16 v[96:99], v[64:67], a[168:171], v[96:99]
    v_rcp_f32 v165, v165
    ds_read_b128 a[92:95], v10 offset:23552
    v_mfma_f32_16x16x32_bf16 v[96:99], v[68:71], a[172:175], v[96:99]
    v_mul_f32 v166, v166, v162
    v_mul_f32 v167, v167, v163
    ds_read_b128 a[164:167], v11 offset:5120
    v_mfma_f32_16x16x32_bf16 v[96:99], v[72:75], a[176:179], v[96:99]
    v_mul_f32 v168, v168, v164
    v_mul_f32 v169, v169, v165
    ds_read_b128 a[236:239], v11 offset:23552
    v_mfma_f32_16x16x32_bf16 v[100:103], v[64:67], a[240:243], v[100:103]
    buffer_load_dwordx4 v[60:63], v187, s[48:51], s23 offen offset:2048 sc1
    v_mfma_f32_16x16x32_bf16 v[100:103], v[68:71], a[244:247], v[100:103]
    v_cvt_pk_bf16_f32 v170, v166, v167
    v_cvt_pk_bf16_f32 v171, v168, v169
    v_mfma_f32_16x16x32_bf16 v[100:103], v[72:75], a[248:251], v[100:103]
    ds_write_b64 v12, v[170:171] offset:18432
    s_waitcnt vmcnt(12)
    v_mfma_f32_16x16x32_bf16 v[104:107], v[76:79], a[24:27], v[104:107]
    v_mul_f32 v152, v128, v128
    v_mul_f32 v153, v129, v129
    ds_read_b128 a[24:27], v10 offset:6144
    v_mfma_f32_16x16x32_bf16 v[104:107], v[80:83], a[28:31], v[104:107]
    buffer_load_dwordx4 v[64:67], v187, s[48:51], s23 offen offset:3072 sc1
    v_mfma_f32_16x16x32_bf16 v[104:107], v[84:87], a[32:35], v[104:107]
    v_mul_f32 v154, v130, v130
    v_mul_f32 v155, v131, v131
    v_mfma_f32_16x16x32_bf16 v[108:111], v[76:79], a[96:99], v[108:111]
    v_fma_f32 v152, v152, v13, v6
    v_fma_f32 v153, v153, v13, v6
    ds_read_b128 a[96:99], v10 offset:24576
    v_mfma_f32_16x16x32_bf16 v[108:111], v[80:83], a[100:103], v[108:111]
    v_fma_f32 v154, v154, v13, v6
    v_fma_f32 v155, v155, v13, v6
    v_mfma_f32_16x16x32_bf16 v[108:111], v[84:87], a[104:107], v[108:111]
    buffer_load_dwordx4 v[68:71], v188, s[48:51], s23 offen offset:0 sc1
    v_mfma_f32_16x16x32_bf16 v[112:115], v[76:79], a[168:171], v[112:115]
    v_mul_f32 v152, v128, v152
    v_mul_f32 v153, v129, v153
    ds_read_b128 a[168:171], v11 offset:6144
    v_mfma_f32_16x16x32_bf16 v[112:115], v[80:83], a[172:175], v[112:115]
    v_mul_f32 v154, v130, v154
    v_mul_f32 v155, v131, v155
    v_mfma_f32_16x16x32_bf16 v[112:115], v[84:87], a[176:179], v[112:115]
    v_exp_f32 v152, v152
    v_mfma_f32_16x16x32_bf16 v[116:119], v[76:79], a[240:243], v[116:119]
    buffer_load_dwordx4 v[72:75], v188, s[48:51], s23 offen offset:1024 sc1
    v_mfma_f32_16x16x32_bf16 v[116:119], v[80:83], a[244:247], v[116:119]
    v_exp_f32 v153, v153
    ds_read_b128 a[240:243], v11 offset:24576
    v_mfma_f32_16x16x32_bf16 v[116:119], v[84:87], a[248:251], v[116:119]
    v_exp_f32 v154, v154
    ds_read_b128 a[28:31], v10 offset:7168
    s_waitcnt vmcnt(12)
    v_mfma_f32_16x16x32_bf16 v[88:91], v[16:19], a[36:39], v[88:91]
    v_exp_f32 v155, v155
    ds_read_b128 a[100:103], v10 offset:25600
    v_mfma_f32_16x16x32_bf16 v[88:91], v[20:23], a[40:43], v[88:91]
    buffer_load_dwordx4 v[76:79], v188, s[48:51], s23 offen offset:2048 sc1
    v_mfma_f32_16x16x32_bf16 v[88:91], v[24:27], a[44:47], v[88:91]
    v_mul_f32 v156, v128, v144
    v_mul_f32 v157, v129, v145
    ds_read_b128 a[172:175], v11 offset:7168
    v_mfma_f32_16x16x32_bf16 v[92:95], v[16:19], a[108:111], v[92:95]
    v_mul_f32 v158, v130, v146
    v_mul_f32 v159, v131, v147
    ds_read_b128 a[244:247], v11 offset:25600
    v_mfma_f32_16x16x32_bf16 v[92:95], v[20:23], a[112:115], v[92:95]
    v_fma_f32 v152, v152, v195, v195
    v_fma_f32 v153, v153, v195, v195
    ds_read_b128 a[32:35], v10 offset:8192
    v_mfma_f32_16x16x32_bf16 v[92:95], v[24:27], a[116:119], v[92:95]
    buffer_load_dwordx4 v[80:83], v188, s[48:51], s23 offen offset:3072 sc1
    v_mfma_f32_16x16x32_bf16 v[96:99], v[16:19], a[180:183], v[96:99]
    v_fma_f32 v154, v154, v195, v195
    v_fma_f32 v155, v155, v195, v195
    ds_read_b128 a[104:107], v10 offset:26624
    v_mfma_f32_16x16x32_bf16 v[96:99], v[20:23], a[184:187], v[96:99]
    v_rcp_f32 v152, v152
    ds_read_b128 a[176:179], v11 offset:8192
    v_mfma_f32_16x16x32_bf16 v[96:99], v[24:27], a[188:191], v[96:99]
    v_rcp_f32 v153, v153
    ds_read_b128 a[248:251], v11 offset:26624
    v_mfma_f32_16x16x32_bf16 v[100:103], v[16:19], a[252:255], v[100:103]
    buffer_load_dwordx4 v[84:87], v189, s[48:51], s23 offen offset:0 sc1
    v_mfma_f32_16x16x32_bf16 v[100:103], v[20:23], v[220:223], v[100:103]
    v_rcp_f32 v154, v154
    v_mfma_f32_16x16x32_bf16 v[100:103], v[24:27], v[224:227], v[100:103]
    v_rcp_f32 v155, v155
    s_waitcnt vmcnt(12)
    v_mfma_f32_16x16x32_bf16 v[104:107], v[28:31], a[36:39], v[104:107]
    v_mul_f32 v156, v156, v152
    v_mul_f32 v157, v157, v153
    ds_read_b128 a[36:39], v10 offset:9216
    v_mfma_f32_16x16x32_bf16 v[104:107], v[32:35], a[40:43], v[104:107]
    buffer_load_dwordx4 v[16:19], v189, s[48:51], s23 offen offset:1024 sc1
    v_mfma_f32_16x16x32_bf16 v[104:107], v[36:39], a[44:47], v[104:107]
    v_mul_f32 v158, v158, v154
    v_mul_f32 v159, v159, v155
    v_mfma_f32_16x16x32_bf16 v[108:111], v[28:31], a[108:111], v[108:111]
    v_cvt_pk_bf16_f32 v160, v156, v157
    v_cvt_pk_bf16_f32 v161, v158, v159
    ds_read_b128 a[108:111], v10 offset:27648
    v_mfma_f32_16x16x32_bf16 v[108:111], v[32:35], a[112:115], v[108:111]
    ds_write_b64 v12, v[160:161] offset:36864
    v_mfma_f32_16x16x32_bf16 v[108:111], v[36:39], a[116:119], v[108:111]
    buffer_load_dwordx4 v[20:23], v189, s[48:51], s23 offen offset:2048 sc1
    v_mfma_f32_16x16x32_bf16 v[112:115], v[28:31], a[180:183], v[112:115]
    v_mul_f32 v162, v132, v132
    v_mul_f32 v163, v133, v133
    ds_read_b128 a[180:183], v11 offset:9216
    v_mfma_f32_16x16x32_bf16 v[112:115], v[32:35], a[184:187], v[112:115]
    v_mul_f32 v164, v134, v134
    v_mul_f32 v165, v135, v135
    v_mfma_f32_16x16x32_bf16 v[112:115], v[36:39], a[188:191], v[112:115]
    v_fma_f32 v162, v162, v14, v7
    v_fma_f32 v163, v163, v14, v7
    v_mfma_f32_16x16x32_bf16 v[116:119], v[28:31], a[252:255], v[116:119]
    buffer_load_dwordx4 v[24:27], v189, s[48:51], s23 offen offset:3072 sc1
    v_mfma_f32_16x16x32_bf16 v[116:119], v[32:35], v[220:223], v[116:119]
    v_fma_f32 v164, v164, v14, v7
    v_fma_f32 v165, v165, v14, v7
    ds_read_b128 a[252:255], v11 offset:27648
    v_mfma_f32_16x16x32_bf16 v[116:119], v[36:39], v[224:227], v[116:119]
    v_mul_f32 v162, v132, v162
    v_mul_f32 v163, v133, v163
    ds_read_b128 a[40:43], v10 offset:10240
    s_waitcnt vmcnt(12)
    v_mfma_f32_16x16x32_bf16 v[88:91], v[40:43], a[48:51], v[88:91]
    v_mul_f32 v164, v134, v164
    v_mul_f32 v165, v135, v165
    ds_read_b128 a[112:115], v10 offset:28672
    v_mfma_f32_16x16x32_bf16 v[88:91], v[44:47], a[52:55], v[88:91]
    buffer_load_dwordx4 v[28:31], v190, s[48:51], s23 offen offset:0 sc1
    v_mfma_f32_16x16x32_bf16 v[88:91], v[48:51], a[56:59], v[88:91]
    v_exp_f32 v162, v162
    ds_read_b128 a[184:187], v11 offset:10240
    v_mfma_f32_16x16x32_bf16 v[92:95], v[40:43], a[120:123], v[92:95]
    v_exp_f32 v163, v163
    ds_read_b128 v[220:223], v11 offset:28672
    v_mfma_f32_16x16x32_bf16 v[92:95], v[44:47], a[124:127], v[92:95]
    v_exp_f32 v164, v164
    ds_read_b128 a[44:47], v10 offset:11264
    v_mfma_f32_16x16x32_bf16 v[92:95], v[48:51], a[128:131], v[92:95]
    buffer_load_dwordx4 v[32:35], v190, s[48:51], s23 offen offset:1024 sc1
    v_mfma_f32_16x16x32_bf16 v[96:99], v[40:43], a[192:195], v[96:99]
    v_exp_f32 v165, v165
    ds_read_b128 a[116:119], v10 offset:29696
    v_mfma_f32_16x16x32_bf16 v[96:99], v[44:47], a[196:199], v[96:99]
    v_mul_f32 v166, v132, v148
    v_mul_f32 v167, v133, v149
    ds_read_b128 a[188:191], v11 offset:11264
    v_mfma_f32_16x16x32_bf16 v[96:99], v[48:51], a[200:203], v[96:99]
    v_mul_f32 v168, v134, v150
    v_mul_f32 v169, v135, v151
    ds_read_b128 v[224:227], v11 offset:29696
    v_mfma_f32_16x16x32_bf16 v[100:103], v[40:43], v[228:231], v[100:103]
    buffer_load_dwordx4 v[36:39], v190, s[48:51], s23 offen offset:2048 sc1
    v_mfma_f32_16x16x32_bf16 v[100:103], v[44:47], v[232:235], v[100:103]
    v_fma_f32 v162, v162, v252, v252
    v_fma_f32 v163, v163, v252, v252
    v_mfma_f32_16x16x32_bf16 v[100:103], v[48:51], v[236:239], v[100:103]
    v_fma_f32 v164, v164, v252, v252
    v_fma_f32 v165, v165, v252, v252
    s_waitcnt vmcnt(12)
    v_mfma_f32_16x16x32_bf16 v[104:107], v[52:55], a[48:51], v[104:107]
    v_rcp_f32 v162, v162
    ds_read_b128 a[48:51], v10 offset:12288
    v_mfma_f32_16x16x32_bf16 v[104:107], v[56:59], a[52:55], v[104:107]
    buffer_load_dwordx4 v[40:43], v190, s[48:51], s23 offen offset:3072 sc1
    v_mfma_f32_16x16x32_bf16 v[104:107], v[60:63], a[56:59], v[104:107]
    v_rcp_f32 v163, v163
    v_mfma_f32_16x16x32_bf16 v[108:111], v[52:55], a[120:123], v[108:111]
    v_rcp_f32 v164, v164
    ds_read_b128 a[120:123], v10 offset:30720
    v_mfma_f32_16x16x32_bf16 v[108:111], v[56:59], a[124:127], v[108:111]
    v_rcp_f32 v165, v165
    v_mfma_f32_16x16x32_bf16 v[108:111], v[60:63], a[128:131], v[108:111]
    buffer_load_dwordx4 v[44:47], v191, s[48:51], s23 offen offset:0 sc1
    v_mfma_f32_16x16x32_bf16 v[112:115], v[52:55], a[192:195], v[112:115]
    v_mul_f32 v166, v166, v162
    v_mul_f32 v167, v167, v163
    ds_read_b128 a[192:195], v11 offset:12288
    v_mfma_f32_16x16x32_bf16 v[112:115], v[56:59], a[196:199], v[112:115]
    v_mul_f32 v168, v168, v164
    v_mul_f32 v169, v169, v165
    v_mfma_f32_16x16x32_bf16 v[112:115], v[60:63], a[200:203], v[112:115]
    v_cvt_pk_bf16_f32 v170, v166, v167
    v_cvt_pk_bf16_f32 v171, v168, v169
    v_mfma_f32_16x16x32_bf16 v[116:119], v[52:55], v[228:231], v[116:119]
    buffer_load_dwordx4 v[48:51], v191, s[48:51], s23 offen offset:1024 sc1
    v_mfma_f32_16x16x32_bf16 v[116:119], v[56:59], v[232:235], v[116:119]
    ds_write_b64 v12, v[170:171] offset:55296
    v_mfma_f32_16x16x32_bf16 v[116:119], v[60:63], v[236:239], v[116:119]
    ds_read_b128 v[228:231], v11 offset:30720
    s_waitcnt vmcnt(12)
    v_mfma_f32_16x16x32_bf16 v[88:91], v[64:67], a[60:63], v[88:91]
    ds_read_b128 a[52:55], v10 offset:13312
    v_mfma_f32_16x16x32_bf16 v[88:91], v[68:71], a[64:67], v[88:91]
    buffer_load_dwordx4 v[52:55], v191, s[48:51], s23 offen offset:2048 sc1
    v_mfma_f32_16x16x32_bf16 v[120:123], v[72:75], a[68:71], v[88:91]
    ds_read_b128 a[124:127], v10 offset:31744
    v_mfma_f32_16x16x32_bf16 v[92:95], v[64:67], a[132:135], v[92:95]
    ds_read_b128 a[196:199], v11 offset:13312
    v_mfma_f32_16x16x32_bf16 v[92:95], v[68:71], a[136:139], v[92:95]
    ds_read_b128 v[232:235], v11 offset:31744
    v_mfma_f32_16x16x32_bf16 v[124:127], v[72:75], a[140:143], v[92:95]
    buffer_load_dwordx4 v[56:59], v191, s[48:51], s23 offen offset:3072 sc1
    v_mfma_f32_16x16x32_bf16 v[96:99], v[64:67], a[204:207], v[96:99]
    v_mfma_f32_16x16x32_bf16 v[96:99], v[68:71], a[208:211], v[96:99]
    v_mfma_f32_16x16x32_bf16 v[128:131], v[72:75], a[212:215], v[96:99]
    v_mfma_f32_16x16x32_bf16 v[100:103], v[64:67], v[240:243], v[100:103]
    buffer_load_dwordx4 v[60:63], v192, s[48:51], s23 offen offset:0 sc1
    v_mfma_f32_16x16x32_bf16 v[100:103], v[68:71], v[244:247], v[100:103]
    v_mfma_f32_16x16x32_bf16 v[132:135], v[72:75], v[248:251], v[100:103]
    s_waitcnt vmcnt(12)
    v_mfma_f32_16x16x32_bf16 v[104:107], v[76:79], a[60:63], v[104:107]
    v_mfma_f32_16x16x32_bf16 v[104:107], v[80:83], a[64:67], v[104:107]
    buffer_load_dwordx4 v[64:67], v192, s[48:51], s23 offen offset:1024 sc1
    v_mfma_f32_16x16x32_bf16 v[136:139], v[84:87], a[68:71], v[104:107]
    v_mfma_f32_16x16x32_bf16 v[108:111], v[76:79], a[132:135], v[108:111]
    v_mfma_f32_16x16x32_bf16 v[108:111], v[80:83], a[136:139], v[108:111]
    v_mfma_f32_16x16x32_bf16 v[140:143], v[84:87], a[140:143], v[108:111]
    buffer_load_dwordx4 v[68:71], v192, s[48:51], s23 offen offset:2048 sc1
    v_mfma_f32_16x16x32_bf16 v[112:115], v[76:79], a[204:207], v[112:115]
    v_mfma_f32_16x16x32_bf16 v[112:115], v[80:83], a[208:211], v[112:115]
    s_lshl_b32 s7, s25, 11
    v_mfma_f32_16x16x32_bf16 v[144:147], v[84:87], a[212:215], v[112:115]
    s_add_u32 s7, s7, s28
    v_mfma_f32_16x16x32_bf16 v[116:119], v[76:79], v[240:243], v[116:119]
    buffer_load_dwordx4 v[72:75], v192, s[48:51], s23 offen offset:3072 sc1
    v_mfma_f32_16x16x32_bf16 v[116:119], v[80:83], v[244:247], v[116:119]
    s_add_u32 s23, s23, 36864
    v_mfma_f32_16x16x32_bf16 v[148:151], v[84:87], v[248:251], v[116:119]
    v_add_u32 v12, s7, v184
    s_add_u32 s25, s25, 1
    s_waitcnt lgkmcnt(0)
    s_barrier
    v_pk_mul_f32 v[152:153], v[120:121], v[120:121]
    ds_read_b128 a[56:59], v10 offset:14336
    v_pk_mul_f32 v[154:155], v[122:123], v[122:123]
    ds_read_b128 a[128:131], v10 offset:32768
    v_pk_fma_f32 v[152:153], v[152:153], v[8:9], v[4:5] op_sel:[0,0,0] op_sel_hi:[1,0,0]
    ds_read_b128 a[200:203], v11 offset:14336
    v_pk_fma_f32 v[154:155], v[154:155], v[8:9], v[4:5] op_sel:[0,0,0] op_sel_hi:[1,0,0]
    v_pk_mul_f32 v[152:153], v[120:121], v[152:153]
    ds_read_b128 v[236:239], v11 offset:32768
    v_pk_mul_f32 v[154:155], v[122:123], v[154:155]
    ds_read_b128 a[60:63], v10 offset:15360
    buffer_load_dwordx4 v[76:79], v184, s[48:51], s23 offen offset:0 sc1
    v_exp_f32 v152, v152
    ds_read_b128 a[132:135], v10 offset:33792
    v_exp_f32 v153, v153
    v_exp_f32 v154, v154
    ds_read_b128 a[204:207], v11 offset:15360
    v_exp_f32 v155, v155
    ds_read_b128 v[240:243], v11 offset:33792
    v_pk_mul_f32 v[156:157], v[120:121], v[136:137]
    v_pk_mul_f32 v[158:159], v[122:123], v[138:139]
    buffer_load_dwordx4 v[80:83], v184, s[48:51], s23 offen offset:1024 sc1
    v_pk_fma_f32 v[152:153], v[152:153], v[192:193], v[192:193] op_sel:[0,1,1] op_sel_hi:[1,1,1]
    v_pk_fma_f32 v[154:155], v[154:155], v[192:193], v[192:193] op_sel:[0,1,1] op_sel_hi:[1,1,1]
    v_rcp_f32 v152, v152
    v_rcp_f32 v153, v153
    v_rcp_f32 v154, v154
    v_rcp_f32 v155, v155
    buffer_load_dwordx4 v[84:87], v184, s[48:51], s23 offen offset:2048 sc1
    s_nop 0
    v_pk_mul_f32 v[156:157], v[156:157], v[152:153]
    v_pk_mul_f32 v[158:159], v[158:159], v[154:155]
    v_cvt_pk_bf16_f32 v160, v156, v157
    v_cvt_pk_bf16_f32 v161, v158, v159
    ds_write_b64 v12, v[160:161] offset:0
    buffer_load_dwordx4 v[104:107], v184, s[48:51], s23 offen offset:3072 sc1
    v_pk_mul_f32 v[162:163], v[124:125], v[124:125]
    v_pk_mul_f32 v[164:165], v[126:127], v[126:127]
    v_pk_fma_f32 v[162:163], v[162:163], v[8:9], v[4:5] op_sel:[0,1,1] op_sel_hi:[1,1,1]
    v_pk_fma_f32 v[164:165], v[164:165], v[8:9], v[4:5] op_sel:[0,1,1] op_sel_hi:[1,1,1]
    v_pk_mul_f32 v[162:163], v[124:125], v[162:163]
    v_pk_mul_f32 v[164:165], v[126:127], v[164:165]
    buffer_load_dwordx4 v[108:111], v185, s[48:51], s23 offen offset:0 sc1
    v_exp_f32 v162, v162
    v_exp_f32 v163, v163
    v_exp_f32 v164, v164
    v_exp_f32 v165, v165
    v_pk_mul_f32 v[166:167], v[124:125], v[140:141]
    v_pk_mul_f32 v[168:169], v[126:127], v[142:143]
    buffer_load_dwordx4 v[112:115], v185, s[48:51], s23 offen offset:1024 sc1
    v_pk_fma_f32 v[162:163], v[162:163], v[194:195], v[194:195] op_sel:[0,0,0] op_sel_hi:[1,0,0]
    v_pk_fma_f32 v[164:165], v[164:165], v[194:195], v[194:195] op_sel:[0,0,0] op_sel_hi:[1,0,0]
    v_rcp_f32 v162, v162
    v_rcp_f32 v163, v163
    v_rcp_f32 v164, v164
    v_rcp_f32 v165, v165
    buffer_load_dwordx4 v[116:119], v185, s[48:51], s23 offen offset:2048 sc1
    s_nop 0
    v_pk_mul_f32 v[166:167], v[166:167], v[162:163]
    v_pk_mul_f32 v[168:169], v[168:169], v[164:165]
    v_cvt_pk_bf16_f32 v170, v166, v167
    v_cvt_pk_bf16_f32 v171, v168, v169
    ds_write_b64 v12, v[170:171] offset:18432
    buffer_load_dwordx4 v[180:183], v185, s[48:51], s23 offen offset:3072 sc1
    v_pk_mul_f32 v[152:153], v[128:129], v[128:129]
    v_pk_mul_f32 v[154:155], v[130:131], v[130:131]
    v_pk_fma_f32 v[152:153], v[152:153], v[12:13], v[6:7] op_sel:[0,1,0] op_sel_hi:[1,1,0]
    v_pk_fma_f32 v[154:155], v[154:155], v[12:13], v[6:7] op_sel:[0,1,0] op_sel_hi:[1,1,0]
    v_pk_mul_f32 v[152:153], v[128:129], v[152:153]
    v_pk_mul_f32 v[154:155], v[130:131], v[154:155]
    buffer_load_dwordx4 v[196:199], v186, s[48:51], s23 offen offset:0 sc1
    v_exp_f32 v152, v152
    v_exp_f32 v153, v153
    v_exp_f32 v154, v154
    v_exp_f32 v155, v155
    v_pk_mul_f32 v[156:157], v[128:129], v[144:145]
    v_pk_mul_f32 v[158:159], v[130:131], v[146:147]
    buffer_load_dwordx4 v[200:203], v186, s[48:51], s23 offen offset:1024 sc1
    v_pk_fma_f32 v[152:153], v[152:153], v[194:195], v[194:195] op_sel:[0,1,1] op_sel_hi:[1,1,1]
    v_pk_fma_f32 v[154:155], v[154:155], v[194:195], v[194:195] op_sel:[0,1,1] op_sel_hi:[1,1,1]
    v_rcp_f32 v152, v152
    v_rcp_f32 v153, v153
    v_rcp_f32 v154, v154
    v_rcp_f32 v155, v155
    buffer_load_dwordx4 v[204:207], v186, s[48:51], s23 offen offset:2048 sc1
    s_nop 0
    v_pk_mul_f32 v[156:157], v[156:157], v[152:153]
    v_pk_mul_f32 v[158:159], v[158:159], v[154:155]
    v_cvt_pk_bf16_f32 v160, v156, v157
    v_cvt_pk_bf16_f32 v161, v158, v159
    ds_write_b64 v12, v[160:161] offset:36864
    buffer_load_dwordx4 v[208:211], v186, s[48:51], s23 offen offset:3072 sc1
    v_pk_mul_f32 v[162:163], v[132:133], v[132:133]
    v_pk_mul_f32 v[164:165], v[134:135], v[134:135]
    v_pk_fma_f32 v[162:163], v[162:163], v[14:15], v[6:7] op_sel:[0,0,1] op_sel_hi:[1,0,1]
    v_pk_fma_f32 v[164:165], v[164:165], v[14:15], v[6:7] op_sel:[0,0,1] op_sel_hi:[1,0,1]
    v_pk_mul_f32 v[162:163], v[132:133], v[162:163]
    v_pk_mul_f32 v[164:165], v[134:135], v[164:165]
    buffer_load_dwordx4 v[212:215], v187, s[48:51], s23 offen offset:0 sc1
    v_exp_f32 v162, v162
    v_exp_f32 v163, v163
    v_exp_f32 v164, v164
    v_exp_f32 v165, v165
    v_pk_mul_f32 v[166:167], v[132:133], v[148:149]
    v_pk_mul_f32 v[168:169], v[134:135], v[150:151]
    buffer_load_dwordx4 v[216:219], v187, s[48:51], s23 offen offset:1024 sc1
    v_pk_fma_f32 v[162:163], v[162:163], v[252:253], v[252:253] op_sel:[0,0,0] op_sel_hi:[1,0,0]
    v_pk_fma_f32 v[164:165], v[164:165], v[252:253], v[252:253] op_sel:[0,0,0] op_sel_hi:[1,0,0]
    v_rcp_f32 v162, v162
    v_rcp_f32 v163, v163
    v_rcp_f32 v164, v164
    v_rcp_f32 v165, v165
    s_nop 0
    v_pk_mul_f32 v[166:167], v[166:167], v[162:163]
    v_pk_mul_f32 v[168:169], v[168:169], v[164:165]
    v_cvt_pk_bf16_f32 v170, v166, v167
    v_cvt_pk_bf16_f32 v171, v168, v169
    ds_write_b64 v12, v[170:171] offset:55296
    buffer_load_dwordx4 v[136:139], v187, s[48:51], s23 offen offset:2048 sc1
    buffer_load_dwordx4 v[140:143], v187, s[48:51], s23 offen offset:3072 sc1
    buffer_load_dwordx4 v[144:147], v188, s[48:51], s23 offen offset:0 sc1
    buffer_load_dwordx4 v[148:151], v188, s[48:51], s23 offen offset:1024 sc1
    s_add_u32 s23, s23, 18432
    s_waitcnt lgkmcnt(0)
    s_barrier
    ds_read_b128 a[64:67], v10 offset:16384
    ds_read_b128 a[136:139], v10 offset:34816
    ds_read_b128 a[208:211], v11 offset:16384
    ds_read_b128 v[244:247], v11 offset:34816
    ds_read_b128 a[68:71], v10 offset:17408
    ds_read_b128 a[140:143], v10 offset:35840
    ds_read_b128 a[212:215], v11 offset:17408
    ds_read_b128 v[248:251], v11 offset:35840
    s_mov_b32 s25, 0
    s_waitcnt lgkmcnt(0)
    s_branch L_ffn_dn_mid_36
L_ffn_dn_35:
    s_waitcnt vmcnt(32)
    v_mfma_f32_16x16x32_bf16 v[88:91], v[104:107], a[0:3], 0
    v_mfma_f32_16x16x32_bf16 v[88:91], v[108:111], a[4:7], v[88:91]
    buffer_load_dwordx4 v[76:79], v184, s[48:51], s23 offen offset:0 sc1
    v_mfma_f32_16x16x32_bf16 v[88:91], v[112:115], a[8:11], v[88:91]
    v_mfma_f32_16x16x32_bf16 v[92:95], v[104:107], a[72:75], 0
    v_mfma_f32_16x16x32_bf16 v[92:95], v[108:111], a[76:79], v[92:95]
    v_mfma_f32_16x16x32_bf16 v[92:95], v[112:115], a[80:83], v[92:95]
    buffer_load_dwordx4 v[80:83], v184, s[48:51], s23 offen offset:1024 sc1
    v_mfma_f32_16x16x32_bf16 v[96:99], v[104:107], a[144:147], 0
    v_cvt_pk_bf16_f32 v152, v120, v121
    v_cvt_pk_bf16_f32 v153, v122, v123
    v_mfma_f32_16x16x32_bf16 v[96:99], v[108:111], a[148:151], v[96:99]
    v_cvt_pk_bf16_f32 v154, v124, v125
    v_cvt_pk_bf16_f32 v155, v126, v127
    v_mfma_f32_16x16x32_bf16 v[96:99], v[112:115], a[152:155], v[96:99]
    v_cvt_pk_bf16_f32 v156, v128, v129
    v_cvt_pk_bf16_f32 v157, v130, v131
    v_mfma_f32_16x16x32_bf16 v[100:103], v[104:107], a[216:219], 0
    buffer_load_dwordx4 v[84:87], v184, s[48:51], s23 offen offset:2048 sc1
    v_mfma_f32_16x16x32_bf16 v[100:103], v[108:111], a[220:223], v[100:103]
    v_cvt_pk_bf16_f32 v158, v132, v133
    v_cvt_pk_bf16_f32 v159, v134, v135
    v_mfma_f32_16x16x32_bf16 v[100:103], v[112:115], a[224:227], v[100:103]
    v_permlane16_swap_b32 v152, v154
    s_waitcnt vmcnt(32)
    v_mfma_f32_16x16x32_bf16 v[88:91], v[116:119], a[12:15], v[88:91]
    v_permlane16_swap_b32 v153, v155
    v_mfma_f32_16x16x32_bf16 v[88:91], v[180:183], a[16:19], v[88:91]
    buffer_load_dwordx4 v[104:107], v184, s[48:51], s23 offen offset:3072 sc1
    v_mfma_f32_16x16x32_bf16 v[88:91], v[196:199], a[20:23], v[88:91]
    v_permlane16_swap_b32 v156, v158
    v_mfma_f32_16x16x32_bf16 v[92:95], v[116:119], a[84:87], v[92:95]
    v_permlane16_swap_b32 v157, v159
    v_mfma_f32_16x16x32_bf16 v[92:95], v[180:183], a[88:91], v[92:95]
    buffer_store_dwordx4 v[152:155], v178, s[72:75], s27 offen sc1
    v_mfma_f32_16x16x32_bf16 v[92:95], v[196:199], a[92:95], v[92:95]
    buffer_load_dwordx4 v[108:111], v185, s[48:51], s23 offen offset:0 sc1
    v_mfma_f32_16x16x32_bf16 v[96:99], v[116:119], a[156:159], v[96:99]
    buffer_store_dwordx4 v[156:159], v179, s[72:75], s27 offen sc1
    v_mfma_f32_16x16x32_bf16 v[96:99], v[180:183], a[160:163], v[96:99]
    v_mfma_f32_16x16x32_bf16 v[96:99], v[196:199], a[164:167], v[96:99]
    v_mfma_f32_16x16x32_bf16 v[100:103], v[116:119], a[228:231], v[100:103]
    buffer_load_dwordx4 v[112:115], v185, s[48:51], s23 offen offset:1024 sc1
    v_mfma_f32_16x16x32_bf16 v[100:103], v[180:183], a[232:235], v[100:103]
    v_mfma_f32_16x16x32_bf16 v[100:103], v[196:199], a[236:239], v[100:103]
    s_waitcnt vmcnt(34)
    v_mfma_f32_16x16x32_bf16 v[88:91], v[200:203], a[24:27], v[88:91]
    v_mfma_f32_16x16x32_bf16 v[88:91], v[204:207], a[28:31], v[88:91]
    buffer_load_dwordx4 v[116:119], v185, s[48:51], s23 offen offset:2048 sc1
    v_mfma_f32_16x16x32_bf16 v[88:91], v[208:211], a[32:35], v[88:91]
    v_mfma_f32_16x16x32_bf16 v[92:95], v[200:203], a[96:99], v[92:95]
    v_mfma_f32_16x16x32_bf16 v[92:95], v[204:207], a[100:103], v[92:95]
    v_mfma_f32_16x16x32_bf16 v[92:95], v[208:211], a[104:107], v[92:95]
    buffer_load_dwordx4 v[180:183], v185, s[48:51], s23 offen offset:3072 sc1
    v_mfma_f32_16x16x32_bf16 v[96:99], v[200:203], a[168:171], v[96:99]
    v_mfma_f32_16x16x32_bf16 v[96:99], v[204:207], a[172:175], v[96:99]
    v_mfma_f32_16x16x32_bf16 v[96:99], v[208:211], a[176:179], v[96:99]
    v_mfma_f32_16x16x32_bf16 v[100:103], v[200:203], a[240:243], v[100:103]
    buffer_load_dwordx4 v[196:199], v186, s[48:51], s23 offen offset:0 sc1
    v_mfma_f32_16x16x32_bf16 v[100:103], v[204:207], a[244:247], v[100:103]
    v_mfma_f32_16x16x32_bf16 v[100:103], v[208:211], a[248:251], v[100:103]
    s_waitcnt vmcnt(34)
    v_mfma_f32_16x16x32_bf16 v[88:91], v[212:215], a[36:39], v[88:91]
    v_mfma_f32_16x16x32_bf16 v[88:91], v[216:219], a[40:43], v[88:91]
    buffer_load_dwordx4 v[200:203], v186, s[48:51], s23 offen offset:1024 sc1
    v_mfma_f32_16x16x32_bf16 v[88:91], v[136:139], a[44:47], v[88:91]
    v_mfma_f32_16x16x32_bf16 v[92:95], v[212:215], a[108:111], v[92:95]
    v_mfma_f32_16x16x32_bf16 v[92:95], v[216:219], a[112:115], v[92:95]
    v_mfma_f32_16x16x32_bf16 v[92:95], v[136:139], a[116:119], v[92:95]
    buffer_load_dwordx4 v[204:207], v186, s[48:51], s23 offen offset:2048 sc1
    v_mfma_f32_16x16x32_bf16 v[96:99], v[212:215], a[180:183], v[96:99]
    v_mfma_f32_16x16x32_bf16 v[96:99], v[216:219], a[184:187], v[96:99]
    v_mfma_f32_16x16x32_bf16 v[96:99], v[136:139], a[188:191], v[96:99]
    v_mfma_f32_16x16x32_bf16 v[100:103], v[212:215], a[252:255], v[100:103]
    buffer_load_dwordx4 v[208:211], v186, s[48:51], s23 offen offset:3072 sc1
    v_mfma_f32_16x16x32_bf16 v[100:103], v[216:219], v[220:223], v[100:103]
    v_mfma_f32_16x16x32_bf16 v[100:103], v[136:139], v[224:227], v[100:103]
    s_waitcnt vmcnt(34)
    v_mfma_f32_16x16x32_bf16 v[88:91], v[140:143], a[48:51], v[88:91]
    v_mfma_f32_16x16x32_bf16 v[88:91], v[144:147], a[52:55], v[88:91]
    buffer_load_dwordx4 v[212:215], v187, s[48:51], s23 offen offset:0 sc1
    v_mfma_f32_16x16x32_bf16 v[88:91], v[148:151], a[56:59], v[88:91]
    v_mfma_f32_16x16x32_bf16 v[92:95], v[140:143], a[120:123], v[92:95]
    v_mfma_f32_16x16x32_bf16 v[92:95], v[144:147], a[124:127], v[92:95]
    v_mfma_f32_16x16x32_bf16 v[92:95], v[148:151], a[128:131], v[92:95]
    buffer_load_dwordx4 v[216:219], v187, s[48:51], s23 offen offset:1024 sc1
    v_mfma_f32_16x16x32_bf16 v[96:99], v[140:143], a[192:195], v[96:99]
    v_mfma_f32_16x16x32_bf16 v[96:99], v[144:147], a[196:199], v[96:99]
    v_mfma_f32_16x16x32_bf16 v[96:99], v[148:151], a[200:203], v[96:99]
    v_mfma_f32_16x16x32_bf16 v[100:103], v[140:143], v[228:231], v[100:103]
    buffer_load_dwordx4 v[136:139], v187, s[48:51], s23 offen offset:2048 sc1
    v_mfma_f32_16x16x32_bf16 v[100:103], v[144:147], v[232:235], v[100:103]
    v_mfma_f32_16x16x32_bf16 v[100:103], v[148:151], v[236:239], v[100:103]
    s_waitcnt vmcnt(34)
    v_mfma_f32_16x16x32_bf16 v[88:91], v[160:163], a[60:63], v[88:91]
    v_mfma_f32_16x16x32_bf16 v[88:91], v[164:167], a[64:67], v[88:91]
    buffer_load_dwordx4 v[140:143], v187, s[48:51], s23 offen offset:3072 sc1
    v_mfma_f32_16x16x32_bf16 v[120:123], v[168:171], a[68:71], v[88:91]
    v_mfma_f32_16x16x32_bf16 v[92:95], v[160:163], a[132:135], v[92:95]
    v_mfma_f32_16x16x32_bf16 v[92:95], v[164:167], a[136:139], v[92:95]
    v_mfma_f32_16x16x32_bf16 v[124:127], v[168:171], a[140:143], v[92:95]
    buffer_load_dwordx4 v[144:147], v188, s[48:51], s23 offen offset:0 sc1
    v_mfma_f32_16x16x32_bf16 v[96:99], v[160:163], a[204:207], v[96:99]
    s_mov_b32 s74, 268435456
    v_mfma_f32_16x16x32_bf16 v[96:99], v[164:167], a[208:211], v[96:99]
    s_add_u32 s27, s27, 1024
    v_mfma_f32_16x16x32_bf16 v[128:131], v[168:171], a[212:215], v[96:99]
    s_add_u32 s25, s25, 1
    v_mfma_f32_16x16x32_bf16 v[100:103], v[160:163], v[240:243], v[100:103]
    buffer_load_dwordx4 v[148:151], v188, s[48:51], s23 offen offset:1024 sc1
    v_mfma_f32_16x16x32_bf16 v[100:103], v[164:167], v[244:247], v[100:103]
    s_add_u32 s23, s23, 18432
    v_mfma_f32_16x16x32_bf16 v[132:135], v[168:171], v[248:251], v[100:103]
L_ffn_dn_mid_36:
    s_waitcnt vmcnt(30)
    v_mfma_f32_16x16x32_bf16 v[88:91], v[16:19], a[0:3], 0
    v_mfma_f32_16x16x32_bf16 v[88:91], v[20:23], a[4:7], v[88:91]
    buffer_load_dwordx4 v[160:163], v184, s[48:51], s23 offen offset:0 sc1
    v_mfma_f32_16x16x32_bf16 v[88:91], v[24:27], a[8:11], v[88:91]
    v_mfma_f32_16x16x32_bf16 v[92:95], v[16:19], a[72:75], 0
    v_mfma_f32_16x16x32_bf16 v[92:95], v[20:23], a[76:79], v[92:95]
    v_mfma_f32_16x16x32_bf16 v[92:95], v[24:27], a[80:83], v[92:95]
    buffer_load_dwordx4 v[164:167], v184, s[48:51], s23 offen offset:1024 sc1
    v_mfma_f32_16x16x32_bf16 v[96:99], v[16:19], a[144:147], 0
    v_cvt_pk_bf16_f32 v152, v120, v121
    v_cvt_pk_bf16_f32 v153, v122, v123
    v_mfma_f32_16x16x32_bf16 v[96:99], v[20:23], a[148:151], v[96:99]
    v_cvt_pk_bf16_f32 v154, v124, v125
    v_cvt_pk_bf16_f32 v155, v126, v127
    v_mfma_f32_16x16x32_bf16 v[96:99], v[24:27], a[152:155], v[96:99]
    v_cvt_pk_bf16_f32 v156, v128, v129
    v_cvt_pk_bf16_f32 v157, v130, v131
    v_mfma_f32_16x16x32_bf16 v[100:103], v[16:19], a[216:219], 0
    buffer_load_dwordx4 v[168:171], v184, s[48:51], s23 offen offset:2048 sc1
    v_mfma_f32_16x16x32_bf16 v[100:103], v[20:23], a[220:223], v[100:103]
    v_cvt_pk_bf16_f32 v158, v132, v133
    v_cvt_pk_bf16_f32 v159, v134, v135
    v_mfma_f32_16x16x32_bf16 v[100:103], v[24:27], a[224:227], v[100:103]
    v_permlane16_swap_b32 v152, v154
    s_waitcnt vmcnt(30)
    v_mfma_f32_16x16x32_bf16 v[88:91], v[28:31], a[12:15], v[88:91]
    v_permlane16_swap_b32 v153, v155
    v_mfma_f32_16x16x32_bf16 v[88:91], v[32:35], a[16:19], v[88:91]
    buffer_load_dwordx4 v[16:19], v184, s[48:51], s23 offen offset:3072 sc1
    v_mfma_f32_16x16x32_bf16 v[88:91], v[36:39], a[20:23], v[88:91]
    v_permlane16_swap_b32 v156, v158
    v_mfma_f32_16x16x32_bf16 v[92:95], v[28:31], a[84:87], v[92:95]
    v_permlane16_swap_b32 v157, v159
    v_mfma_f32_16x16x32_bf16 v[92:95], v[32:35], a[88:91], v[92:95]
    buffer_store_dwordx4 v[152:155], v178, s[72:75], s27 offen sc1
    v_mfma_f32_16x16x32_bf16 v[92:95], v[36:39], a[92:95], v[92:95]
    buffer_load_dwordx4 v[20:23], v185, s[48:51], s23 offen offset:0 sc1
    v_mfma_f32_16x16x32_bf16 v[96:99], v[28:31], a[156:159], v[96:99]
    buffer_store_dwordx4 v[156:159], v179, s[72:75], s27 offen sc1
    v_mfma_f32_16x16x32_bf16 v[96:99], v[32:35], a[160:163], v[96:99]
    v_mfma_f32_16x16x32_bf16 v[96:99], v[36:39], a[164:167], v[96:99]
    v_mfma_f32_16x16x32_bf16 v[100:103], v[28:31], a[228:231], v[100:103]
    buffer_load_dwordx4 v[24:27], v185, s[48:51], s23 offen offset:1024 sc1
    v_mfma_f32_16x16x32_bf16 v[100:103], v[32:35], a[232:235], v[100:103]
    v_mfma_f32_16x16x32_bf16 v[100:103], v[36:39], a[236:239], v[100:103]
    s_waitcnt vmcnt(32)
    v_mfma_f32_16x16x32_bf16 v[88:91], v[40:43], a[24:27], v[88:91]
    v_mfma_f32_16x16x32_bf16 v[88:91], v[44:47], a[28:31], v[88:91]
    buffer_load_dwordx4 v[28:31], v185, s[48:51], s23 offen offset:2048 sc1
    v_mfma_f32_16x16x32_bf16 v[88:91], v[48:51], a[32:35], v[88:91]
    v_mfma_f32_16x16x32_bf16 v[92:95], v[40:43], a[96:99], v[92:95]
    v_mfma_f32_16x16x32_bf16 v[92:95], v[44:47], a[100:103], v[92:95]
    v_mfma_f32_16x16x32_bf16 v[92:95], v[48:51], a[104:107], v[92:95]
    buffer_load_dwordx4 v[32:35], v185, s[48:51], s23 offen offset:3072 sc1
    v_mfma_f32_16x16x32_bf16 v[96:99], v[40:43], a[168:171], v[96:99]
    v_mfma_f32_16x16x32_bf16 v[96:99], v[44:47], a[172:175], v[96:99]
    v_mfma_f32_16x16x32_bf16 v[96:99], v[48:51], a[176:179], v[96:99]
    v_mfma_f32_16x16x32_bf16 v[100:103], v[40:43], a[240:243], v[100:103]
    buffer_load_dwordx4 v[36:39], v186, s[48:51], s23 offen offset:0 sc1
    v_mfma_f32_16x16x32_bf16 v[100:103], v[44:47], a[244:247], v[100:103]
    v_mfma_f32_16x16x32_bf16 v[100:103], v[48:51], a[248:251], v[100:103]
    s_waitcnt vmcnt(32)
    s_cmp_lg_u32 s25, 6
    s_cbranch_scc1 L_early_37
    s_waitcnt vmcnt(24)
    s_barrier
    s_cmp_lg_u32 s3, 0
    s_cbranch_scc1 L_early_37
    v_lshlrev_b32 v15, 7, v0
    v_mov_b32 v1, s76
    s_mov_b64 exec, 0xff
    buffer_store_dword v1, v15, s[8:11], s29 offen sc1
    s_mov_b64 exec, -1
L_early_37:
    v_mfma_f32_16x16x32_bf16 v[88:91], v[52:55], a[36:39], v[88:91]
    v_mfma_f32_16x16x32_bf16 v[88:91], v[56:59], a[40:43], v[88:91]
    buffer_load_dwordx4 v[40:43], v186, s[48:51], s23 offen offset:1024 sc1
    v_mfma_f32_16x16x32_bf16 v[88:91], v[60:63], a[44:47], v[88:91]
    v_mfma_f32_16x16x32_bf16 v[92:95], v[52:55], a[108:111], v[92:95]
    v_mfma_f32_16x16x32_bf16 v[92:95], v[56:59], a[112:115], v[92:95]
    v_mfma_f32_16x16x32_bf16 v[92:95], v[60:63], a[116:119], v[92:95]
    buffer_load_dwordx4 v[44:47], v186, s[48:51], s23 offen offset:2048 sc1
    v_mfma_f32_16x16x32_bf16 v[96:99], v[52:55], a[180:183], v[96:99]
    v_mfma_f32_16x16x32_bf16 v[96:99], v[56:59], a[184:187], v[96:99]
    v_mfma_f32_16x16x32_bf16 v[96:99], v[60:63], a[188:191], v[96:99]
    v_mfma_f32_16x16x32_bf16 v[100:103], v[52:55], a[252:255], v[100:103]
    buffer_load_dwordx4 v[48:51], v186, s[48:51], s23 offen offset:3072 sc1
    v_mfma_f32_16x16x32_bf16 v[100:103], v[56:59], v[220:223], v[100:103]
    v_mfma_f32_16x16x32_bf16 v[100:103], v[60:63], v[224:227], v[100:103]
    s_waitcnt vmcnt(32)
    v_mfma_f32_16x16x32_bf16 v[88:91], v[64:67], a[48:51], v[88:91]
    v_mfma_f32_16x16x32_bf16 v[88:91], v[68:71], a[52:55], v[88:91]
    buffer_load_dwordx4 v[52:55], v187, s[48:51], s23 offen offset:0 sc1
    v_mfma_f32_16x16x32_bf16 v[88:91], v[72:75], a[56:59], v[88:91]
    v_mfma_f32_16x16x32_bf16 v[92:95], v[64:67], a[120:123], v[92:95]
    v_mfma_f32_16x16x32_bf16 v[92:95], v[68:71], a[124:127], v[92:95]
    v_mfma_f32_16x16x32_bf16 v[92:95], v[72:75], a[128:131], v[92:95]
    buffer_load_dwordx4 v[56:59], v187, s[48:51], s23 offen offset:1024 sc1
    v_mfma_f32_16x16x32_bf16 v[96:99], v[64:67], a[192:195], v[96:99]
    v_mfma_f32_16x16x32_bf16 v[96:99], v[68:71], a[196:199], v[96:99]
    v_mfma_f32_16x16x32_bf16 v[96:99], v[72:75], a[200:203], v[96:99]
    v_mfma_f32_16x16x32_bf16 v[100:103], v[64:67], v[228:231], v[100:103]
    buffer_load_dwordx4 v[60:63], v187, s[48:51], s23 offen offset:2048 sc1
    v_mfma_f32_16x16x32_bf16 v[100:103], v[68:71], v[232:235], v[100:103]
    v_mfma_f32_16x16x32_bf16 v[100:103], v[72:75], v[236:239], v[100:103]
    s_waitcnt vmcnt(32)
    v_mfma_f32_16x16x32_bf16 v[88:91], v[76:79], a[60:63], v[88:91]
    v_mfma_f32_16x16x32_bf16 v[88:91], v[80:83], a[64:67], v[88:91]
    buffer_load_dwordx4 v[64:67], v187, s[48:51], s23 offen offset:3072 sc1
    v_mfma_f32_16x16x32_bf16 v[120:123], v[84:87], a[68:71], v[88:91]
    v_mfma_f32_16x16x32_bf16 v[92:95], v[76:79], a[132:135], v[92:95]
    v_mfma_f32_16x16x32_bf16 v[92:95], v[80:83], a[136:139], v[92:95]
    v_mfma_f32_16x16x32_bf16 v[124:127], v[84:87], a[140:143], v[92:95]
    buffer_load_dwordx4 v[68:71], v188, s[48:51], s23 offen offset:0 sc1
    v_mfma_f32_16x16x32_bf16 v[96:99], v[76:79], a[204:207], v[96:99]
    s_mov_b32 s74, 268435456
    v_mfma_f32_16x16x32_bf16 v[96:99], v[80:83], a[208:211], v[96:99]
    s_add_u32 s27, s27, 1024
    v_mfma_f32_16x16x32_bf16 v[128:131], v[84:87], a[212:215], v[96:99]
    s_add_u32 s25, s25, 1
    v_mfma_f32_16x16x32_bf16 v[100:103], v[76:79], v[240:243], v[100:103]
    buffer_load_dwordx4 v[72:75], v188, s[48:51], s23 offen offset:1024 sc1
    v_mfma_f32_16x16x32_bf16 v[100:103], v[80:83], v[244:247], v[100:103]
    s_add_u32 s23, s23, 18432
    v_mfma_f32_16x16x32_bf16 v[132:135], v[84:87], v[248:251], v[100:103]
    s_cmp_lt_u32 s25, 7
    s_cbranch_scc1 L_ffn_dn_35
    s_waitcnt vmcnt(32)
    v_mfma_f32_16x16x32_bf16 v[88:91], v[104:107], a[0:3], 0
    v_mfma_f32_16x16x32_bf16 v[88:91], v[108:111], a[4:7], v[88:91]
    buffer_load_dwordx4 v[76:79], v184, s[48:51], s23 offen offset:0 sc1
    v_mfma_f32_16x16x32_bf16 v[88:91], v[112:115], a[8:11], v[88:91]
    v_mfma_f32_16x16x32_bf16 v[92:95], v[104:107], a[72:75], 0
    v_mfma_f32_16x16x32_bf16 v[92:95], v[108:111], a[76:79], v[92:95]
    v_mfma_f32_16x16x32_bf16 v[92:95], v[112:115], a[80:83], v[92:95]
    buffer_load_dwordx4 v[80:83], v184, s[48:51], s23 offen offset:1024 sc1
    v_mfma_f32_16x16x32_bf16 v[96:99], v[104:107], a[144:147], 0
    v_cvt_pk_bf16_f32 v152, v120, v121
    v_cvt_pk_bf16_f32 v153, v122, v123
    v_mfma_f32_16x16x32_bf16 v[96:99], v[108:111], a[148:151], v[96:99]
    v_cvt_pk_bf16_f32 v154, v124, v125
    v_cvt_pk_bf16_f32 v155, v126, v127
    v_mfma_f32_16x16x32_bf16 v[96:99], v[112:115], a[152:155], v[96:99]
    v_cvt_pk_bf16_f32 v156, v128, v129
    v_cvt_pk_bf16_f32 v157, v130, v131
    v_mfma_f32_16x16x32_bf16 v[100:103], v[104:107], a[216:219], 0
    buffer_load_dwordx4 v[84:87], v184, s[48:51], s23 offen offset:2048 sc1
    v_mfma_f32_16x16x32_bf16 v[100:103], v[108:111], a[220:223], v[100:103]
    v_cvt_pk_bf16_f32 v158, v132, v133
    v_cvt_pk_bf16_f32 v159, v134, v135
    v_mfma_f32_16x16x32_bf16 v[100:103], v[112:115], a[224:227], v[100:103]
    v_permlane16_swap_b32 v152, v154
    s_waitcnt vmcnt(32)
    v_mfma_f32_16x16x32_bf16 v[88:91], v[116:119], a[12:15], v[88:91]
    v_permlane16_swap_b32 v153, v155
    v_mfma_f32_16x16x32_bf16 v[88:91], v[180:183], a[16:19], v[88:91]
    v_permlane16_swap_b32 v156, v158
    v_mfma_f32_16x16x32_bf16 v[88:91], v[196:199], a[20:23], v[88:91]
    v_permlane16_swap_b32 v157, v159
    s_load_dwordx8 s[56:63], s[38:39], 0 glc
    v_mfma_f32_16x16x32_bf16 v[92:95], v[116:119], a[84:87], v[92:95]
    buffer_store_dwordx4 v[152:155], v178, s[72:75], s27 offen sc1
    s_mov_b32 s6, 0
    v_mfma_f32_16x16x32_bf16 v[92:95], v[180:183], a[88:91], v[92:95]
    buffer_store_dwordx4 v[156:159], v179, s[72:75], s27 offen sc1
    v_mfma_f32_16x16x32_bf16 v[92:95], v[196:199], a[92:95], v[92:95]
    v_mfma_f32_16x16x32_bf16 v[96:99], v[116:119], a[156:159], v[96:99]
    v_mfma_f32_16x16x32_bf16 v[96:99], v[180:183], a[160:163], v[96:99]
    v_mfma_f32_16x16x32_bf16 v[96:99], v[196:199], a[164:167], v[96:99]
    v_mfma_f32_16x16x32_bf16 v[100:103], v[116:119], a[228:231], v[100:103]
    v_mfma_f32_16x16x32_bf16 v[100:103], v[180:183], a[232:235], v[100:103]
    v_mfma_f32_16x16x32_bf16 v[100:103], v[196:199], a[236:239], v[100:103]
    s_waitcnt vmcnt(31)
L_epoll_38:
    s_waitcnt lgkmcnt(0)
    s_xor_b64 s[56:57], s[56:57], s[76:77]
    s_xor_b64 s[58:59], s[58:59], s[76:77]
    s_xor_b64 s[60:61], s[60:61], s[76:77]
    s_xor_b64 s[62:63], s[62:63], s[76:77]
    s_or_b64 s[56:57], s[56:57], s[58:59]
    s_or_b64 s[60:61], s[60:61], s[62:63]
    s_or_b64 s[56:57], s[56:57], s[60:61]
    s_cbranch_scc0 L_epolled_39
    s_load_dwordx8 s[56:63], s[38:39], 0 glc
    s_add_u32 s6, s6, 1
    s_cmp_lt_u32 s6, 1048576
    s_cbranch_scc1 L_epoll_38
    s_branch L_main_end
L_epolled_39:
    v_mfma_f32_16x16x32_bf16 v[88:91], v[200:203], a[24:27], v[88:91]
    v_mfma_f32_16x16x32_bf16 v[88:91], v[204:207], a[28:31], v[88:91]
    buffer_load_dwordx4 v[104:107], v172, s[8:11], s19 offen sc1
    v_mfma_f32_16x16x32_bf16 v[88:91], v[208:211], a[32:35], v[88:91]
    v_mfma_f32_16x16x32_bf16 v[92:95], v[200:203], a[96:99], v[92:95]
    v_mfma_f32_16x16x32_bf16 v[92:95], v[204:207], a[100:103], v[92:95]
    v_mfma_f32_16x16x32_bf16 v[92:95], v[208:211], a[104:107], v[92:95]
    buffer_load_dwordx4 v[108:111], v173, s[8:11], s19 offen sc1
    s_add_u32 s19, s19, 9216
    v_mfma_f32_16x16x32_bf16 v[96:99], v[200:203], a[168:171], v[96:99]
    v_mfma_f32_16x16x32_bf16 v[96:99], v[204:207], a[172:175], v[96:99]
    v_mfma_f32_16x16x32_bf16 v[96:99], v[208:211], a[176:179], v[96:99]
    v_mfma_f32_16x16x32_bf16 v[100:103], v[200:203], a[240:243], v[100:103]
    buffer_load_dwordx4 v[112:115], v172, s[8:11], s19 offen sc1
    v_mfma_f32_16x16x32_bf16 v[100:103], v[204:207], a[244:247], v[100:103]
    v_mfma_f32_16x16x32_bf16 v[100:103], v[208:211], a[248:251], v[100:103]
    s_waitcnt vmcnt(31)
    v_mfma_f32_16x16x32_bf16 v[88:91], v[212:215], a[36:39], v[88:91]
    v_mfma_f32_16x16x32_bf16 v[88:91], v[216:219], a[40:43], v[88:91]
    buffer_load_dwordx4 v[116:119], v173, s[8:11], s19 offen sc1
    s_add_u32 s19, s19, 9216
    v_mfma_f32_16x16x32_bf16 v[88:91], v[136:139], a[44:47], v[88:91]
    v_mfma_f32_16x16x32_bf16 v[92:95], v[212:215], a[108:111], v[92:95]
    v_mfma_f32_16x16x32_bf16 v[92:95], v[216:219], a[112:115], v[92:95]
    v_mfma_f32_16x16x32_bf16 v[92:95], v[136:139], a[116:119], v[92:95]
    buffer_load_dwordx4 v[180:183], v172, s[8:11], s19 offen sc1
    v_mfma_f32_16x16x32_bf16 v[96:99], v[212:215], a[180:183], v[96:99]
    v_mfma_f32_16x16x32_bf16 v[96:99], v[216:219], a[184:187], v[96:99]
    v_mfma_f32_16x16x32_bf16 v[96:99], v[136:139], a[188:191], v[96:99]
    v_mfma_f32_16x16x32_bf16 v[100:103], v[212:215], a[252:255], v[100:103]
    buffer_load_dwordx4 v[196:199], v173, s[8:11], s19 offen sc1
    s_add_u32 s19, s19, 9216
    v_mfma_f32_16x16x32_bf16 v[100:103], v[216:219], v[220:223], v[100:103]
    v_mfma_f32_16x16x32_bf16 v[100:103], v[136:139], v[224:227], v[100:103]
    s_waitcnt vmcnt(31)
    v_mfma_f32_16x16x32_bf16 v[88:91], v[140:143], a[48:51], v[88:91]
    v_mfma_f32_16x16x32_bf16 v[88:91], v[144:147], a[52:55], v[88:91]
    buffer_load_dwordx4 v[200:203], v172, s[8:11], s19 offen sc1
    v_mfma_f32_16x16x32_bf16 v[88:91], v[148:151], a[56:59], v[88:91]
    v_mfma_f32_16x16x32_bf16 v[92:95], v[140:143], a[120:123], v[92:95]
    v_mfma_f32_16x16x32_bf16 v[92:95], v[144:147], a[124:127], v[92:95]
    v_mfma_f32_16x16x32_bf16 v[92:95], v[148:151], a[128:131], v[92:95]
    buffer_load_dwordx4 v[204:207], v173, s[8:11], s19 offen sc1
    s_add_u32 s19, s19, 9216
    v_mfma_f32_16x16x32_bf16 v[96:99], v[140:143], a[192:195], v[96:99]
    v_mfma_f32_16x16x32_bf16 v[96:99], v[144:147], a[196:199], v[96:99]
    v_mfma_f32_16x16x32_bf16 v[96:99], v[148:151], a[200:203], v[96:99]
    v_mfma_f32_16x16x32_bf16 v[100:103], v[140:143], v[228:231], v[100:103]
    buffer_load_dwordx4 v[208:211], v172, s[8:11], s19 offen sc1
    v_mfma_f32_16x16x32_bf16 v[100:103], v[144:147], v[232:235], v[100:103]
    v_mfma_f32_16x16x32_bf16 v[100:103], v[148:151], v[236:239], v[100:103]
    s_waitcnt vmcnt(31)
    v_mfma_f32_16x16x32_bf16 v[88:91], v[160:163], a[60:63], v[88:91]
    v_mfma_f32_16x16x32_bf16 v[88:91], v[164:167], a[64:67], v[88:91]
    buffer_load_dwordx4 v[212:215], v173, s[8:11], s19 offen sc1
    s_add_u32 s19, s19, 9216
    v_mfma_f32_16x16x32_bf16 v[120:123], v[168:171], a[68:71], v[88:91]
    v_mfma_f32_16x16x32_bf16 v[92:95], v[160:163], a[132:135], v[92:95]
    v_mfma_f32_16x16x32_bf16 v[92:95], v[164:167], a[136:139], v[92:95]
    v_mfma_f32_16x16x32_bf16 v[124:127], v[168:171], a[140:143], v[92:95]
    buffer_load_dwordx4 v[216:219], v172, s[8:11], s19 offen sc1
    v_mfma_f32_16x16x32_bf16 v[96:99], v[160:163], a[204:207], v[96:99]
    s_mov_b32 s74, 268435456
    v_mfma_f32_16x16x32_bf16 v[96:99], v[164:167], a[208:211], v[96:99]
    s_add_u32 s27, s27, 1024
    v_mfma_f32_16x16x32_bf16 v[128:131], v[168:171], a[212:215], v[96:99]
    s_add_u32 s25, s25, 1
    v_mfma_f32_16x16x32_bf16 v[100:103], v[160:163], v[240:243], v[100:103]
    buffer_load_dwordx4 v[136:139], v173, s[8:11], s19 offen sc1
    s_add_u32 s19, s19, 9216
    v_mfma_f32_16x16x32_bf16 v[100:103], v[164:167], v[244:247], v[100:103]
    s_add_u32 s23, s23, 18432
    v_mfma_f32_16x16x32_bf16 v[132:135], v[168:171], v[248:251], v[100:103]
    s_waitcnt vmcnt(29)
    v_mfma_f32_16x16x32_bf16 v[88:91], v[16:19], a[0:3], 0
    v_mfma_f32_16x16x32_bf16 v[88:91], v[20:23], a[4:7], v[88:91]
    buffer_load_dwordx4 v[140:143], v172, s[8:11], s19 offen sc1
    v_mfma_f32_16x16x32_bf16 v[88:91], v[24:27], a[8:11], v[88:91]
    v_mfma_f32_16x16x32_bf16 v[92:95], v[16:19], a[72:75], 0
    v_mfma_f32_16x16x32_bf16 v[92:95], v[20:23], a[76:79], v[92:95]
    v_mfma_f32_16x16x32_bf16 v[92:95], v[24:27], a[80:83], v[92:95]
    buffer_load_dwordx4 v[144:147], v173, s[8:11], s19 offen sc1
    s_add_u32 s19, s19, 9216
    v_mfma_f32_16x16x32_bf16 v[96:99], v[16:19], a[144:147], 0
    v_cvt_pk_bf16_f32 v152, v120, v121
    v_cvt_pk_bf16_f32 v153, v122, v123
    v_mfma_f32_16x16x32_bf16 v[96:99], v[20:23], a[148:151], v[96:99]
    v_cvt_pk_bf16_f32 v154, v124, v125
    v_cvt_pk_bf16_f32 v155, v126, v127
    v_mfma_f32_16x16x32_bf16 v[96:99], v[24:27], a[152:155], v[96:99]
    v_cvt_pk_bf16_f32 v156, v128, v129
    v_cvt_pk_bf16_f32 v157, v130, v131
    v_mfma_f32_16x16x32_bf16 v[100:103], v[16:19], a[216:219], 0
    buffer_load_dwordx4 v[148:151], v172, s[8:11], s19 offen sc1
    v_mfma_f32_16x16x32_bf16 v[100:103], v[20:23], a[220:223], v[100:103]
    v_cvt_pk_bf16_f32 v158, v132, v133
    v_cvt_pk_bf16_f32 v159, v134, v135
    v_mfma_f32_16x16x32_bf16 v[100:103], v[24:27], a[224:227], v[100:103]
    v_permlane16_swap_b32 v152, v154
    s_waitcnt vmcnt(29)
    v_mfma_f32_16x16x32_bf16 v[88:91], v[28:31], a[12:15], v[88:91]
    v_permlane16_swap_b32 v153, v155
    v_mfma_f32_16x16x32_bf16 v[88:91], v[32:35], a[16:19], v[88:91]
    buffer_load_dwordx4 v[160:163], v173, s[8:11], s19 offen sc1
    v_mfma_f32_16x16x32_bf16 v[88:91], v[36:39], a[20:23], v[88:91]
    v_permlane16_swap_b32 v156, v158
    v_mfma_f32_16x16x32_bf16 v[92:95], v[28:31], a[84:87], v[92:95]
    v_permlane16_swap_b32 v157, v159
    v_mfma_f32_16x16x32_bf16 v[92:95], v[32:35], a[88:91], v[92:95]
    buffer_store_dwordx4 v[152:155], v178, s[72:75], s27 offen sc1
    v_mfma_f32_16x16x32_bf16 v[92:95], v[36:39], a[92:95], v[92:95]
    buffer_store_dwordx4 v[156:159], v179, s[72:75], s27 offen sc1
    v_mfma_f32_16x16x32_bf16 v[96:99], v[28:31], a[156:159], v[96:99]
    v_mfma_f32_16x16x32_bf16 v[96:99], v[32:35], a[160:163], v[96:99]
    v_mfma_f32_16x16x32_bf16 v[96:99], v[36:39], a[164:167], v[96:99]
    v_mfma_f32_16x16x32_bf16 v[100:103], v[28:31], a[228:231], v[100:103]
    v_mfma_f32_16x16x32_bf16 v[100:103], v[32:35], a[232:235], v[100:103]
    v_mfma_f32_16x16x32_bf16 v[100:103], v[36:39], a[236:239], v[100:103]
    s_waitcnt vmcnt(29)
    v_mfma_f32_16x16x32_bf16 v[88:91], v[40:43], a[24:27], v[88:91]
    v_mfma_f32_16x16x32_bf16 v[88:91], v[44:47], a[28:31], v[88:91]
    v_mfma_f32_16x16x32_bf16 v[88:91], v[48:51], a[32:35], v[88:91]
    v_mfma_f32_16x16x32_bf16 v[92:95], v[40:43], a[96:99], v[92:95]
    v_mfma_f32_16x16x32_bf16 v[92:95], v[44:47], a[100:103], v[92:95]
    v_mfma_f32_16x16x32_bf16 v[92:95], v[48:51], a[104:107], v[92:95]
    v_mfma_f32_16x16x32_bf16 v[96:99], v[40:43], a[168:171], v[96:99]
    v_mfma_f32_16x16x32_bf16 v[96:99], v[44:47], a[172:175], v[96:99]
    v_mfma_f32_16x16x32_bf16 v[96:99], v[48:51], a[176:179], v[96:99]
    v_mfma_f32_16x16x32_bf16 v[100:103], v[40:43], a[240:243], v[100:103]
    v_mfma_f32_16x16x32_bf16 v[100:103], v[44:47], a[244:247], v[100:103]
    v_mfma_f32_16x16x32_bf16 v[100:103], v[48:51], a[248:251], v[100:103]
    s_waitcnt vmcnt(26)
    v_mfma_f32_16x16x32_bf16 v[88:91], v[52:55], a[36:39], v[88:91]
    v_mfma_f32_16x16x32_bf16 v[88:91], v[56:59], a[40:43], v[88:91]
    v_mfma_f32_16x16x32_bf16 v[88:91], v[60:63], a[44:47], v[88:91]
    v_mfma_f32_16x16x32_bf16 v[92:95], v[52:55], a[108:111], v[92:95]
    v_mfma_f32_16x16x32_bf16 v[92:95], v[56:59], a[112:115], v[92:95]
    v_mfma_f32_16x16x32_bf16 v[92:95], v[60:63], a[116:119], v[92:95]
    v_mfma_f32_16x16x32_bf16 v[96:99], v[52:55], a[180:183], v[96:99]
    v_mfma_f32_16x16x32_bf16 v[96:99], v[56:59], a[184:187], v[96:99]
    v_mfma_f32_16x16x32_bf16 v[96:99], v[60:63], a[188:191], v[96:99]
    v_mfma_f32_16x16x32_bf16 v[100:103], v[52:55], a[252:255], v[100:103]
    v_mfma_f32_16x16x32_bf16 v[100:103], v[56:59], v[220:223], v[100:103]
    v_mfma_f32_16x16x32_bf16 v[100:103], v[60:63], v[224:227], v[100:103]
    s_waitcnt vmcnt(23)
    v_mfma_f32_16x16x32_bf16 v[88:91], v[64:67], a[48:51], v[88:91]
    v_mfma_f32_16x16x32_bf16 v[88:91], v[68:71], a[52:55], v[88:91]
    v_mfma_f32_16x16x32_bf16 v[88:91], v[72:75], a[56:59], v[88:91]
    v_mfma_f32_16x16x32_bf16 v[92:95], v[64:67], a[120:123], v[92:95]
    v_mfma_f32_16x16x32_bf16 v[92:95], v[68:71], a[124:127], v[92:95]
    v_mfma_f32_16x16x32_bf16 v[92:95], v[72:75], a[128:131], v[92:95]
    v_mfma_f32_16x16x32_bf16 v[96:99], v[64:67], a[192:195], v[96:99]
    v_mfma_f32_16x16x32_bf16 v[96:99], v[68:71], a[196:199], v[96:99]
    v_mfma_f32_16x16x32_bf16 v[96:99], v[72:75], a[200:203], v[96:99]
    v_mfma_f32_16x16x32_bf16 v[100:103], v[64:67], v[228:231], v[100:103]
    v_mfma_f32_16x16x32_bf16 v[100:103], v[68:71], v[232:235], v[100:103]
    v_mfma_f32_16x16x32_bf16 v[100:103], v[72:75], v[236:239], v[100:103]
    s_waitcnt vmcnt(20)
    v_mfma_f32_16x16x32_bf16 v[88:91], v[76:79], a[60:63], v[88:91]
    v_mfma_f32_16x16x32_bf16 v[88:91], v[80:83], a[64:67], v[88:91]
    v_mfma_f32_16x16x32_bf16 v[120:123], v[84:87], a[68:71], v[88:91]
    v_mfma_f32_16x16x32_bf16 v[92:95], v[76:79], a[132:135], v[92:95]
    v_mfma_f32_16x16x32_bf16 v[92:95], v[80:83], a[136:139], v[92:95]
    v_mfma_f32_16x16x32_bf16 v[124:127], v[84:87], a[140:143], v[92:95]
    v_mfma_f32_16x16x32_bf16 v[96:99], v[76:79], a[204:207], v[96:99]
    s_mov_b32 s74, 268435456
    v_mfma_f32_16x16x32_bf16 v[96:99], v[80:83], a[208:211], v[96:99]
    s_add_u32 s27, s27, 1024
    v_mfma_f32_16x16x32_bf16 v[128:131], v[84:87], a[212:215], v[96:99]
    s_add_u32 s25, s25, 1
    v_mfma_f32_16x16x32_bf16 v[100:103], v[76:79], v[240:243], v[100:103]
    v_mfma_f32_16x16x32_bf16 v[100:103], v[80:83], v[244:247], v[100:103]
    s_add_u32 s23, s23, 18432
    v_mfma_f32_16x16x32_bf16 v[132:135], v[84:87], v[248:251], v[100:103]
    s_nop 7
    v_cvt_pk_bf16_f32 v152, v120, v121
    v_cvt_pk_bf16_f32 v153, v122, v123
    v_cvt_pk_bf16_f32 v154, v124, v125
    v_cvt_pk_bf16_f32 v155, v126, v127
    v_cvt_pk_bf16_f32 v156, v128, v129
    v_cvt_pk_bf16_f32 v157, v130, v131
    v_cvt_pk_bf16_f32 v158, v132, v133
    v_cvt_pk_bf16_f32 v159, v134, v135
    s_nop 1
    v_permlane16_swap_b32 v152, v154
    v_permlane16_swap_b32 v153, v155
    v_permlane16_swap_b32 v156, v158
    v_permlane16_swap_b32 v157, v159
    buffer_store_dwordx4 v[152:155], v178, s[72:75], s27 offen sc1
    buffer_store_dwordx4 v[156:159], v179, s[72:75], s27 offen sc1
    v_lshlrev_b32 v15, 7, v0
    s_lshl_b32 s6, s40, 2
    s_add_u32 s6, s6, s44
    s_add_u32 s6, s6, 65536
    v_mov_b32 v1, s76
    s_mov_b64 vcc, 0xff
    s_waitcnt vmcnt(0)
    s_barrier
    s_cmp_lg_u32 s3, 0
    s_cbranch_scc1 L_pub_40
    s_mov_b64 exec, vcc
    buffer_store_dword v1, v15, s[8:11], s6 offen sc1
L_pub_40:
    s_mov_b64 exec, -1
    s_add_u32 s19, s18, s43
    s_add_u32 s22, s19, 45875200
    s_lshl_b32 s23, s21, 5
    s_add_u32 s23, s23, s43
    s_add_u32 s23, s23, 48431104
    v_and_b32 v12, 7, v0
    v_lshlrev_b32 v12, 2, v12
    buffer_load_dword v10, v12, s[8:11], s23 offen sc1
    buffer_load_dwordx4 v[92:95], v172, s[8:11], s22 offen sc1
    buffer_load_dwordx4 v[96:99], v173, s[8:11], s22 offen sc1
    buffer_load_dwordx4 v[100:103], v174, s[8:11], s22 offen sc1
    v_lshlrev_b32 v16, 16, v104
    v_and_b32 v17, s16, v104
    v_lshlrev_b32 v18, 16, v105
    v_and_b32 v19, s16, v105
    v_lshlrev_b32 v20, 16, v106
    v_and_b32 v21, s16, v106
    v_lshlrev_b32 v22, 16, v107
    v_and_b32 v23, s16, v107
    v_lshlrev_b32 v24, 16, v108
    v_and_b32 v25, s16, v108
    v_lshlrev_b32 v26, 16, v109
    v_and_b32 v27, s16, v109
    v_lshlrev_b32 v28, 16, v110
    v_and_b32 v29, s16, v110
    v_lshlrev_b32 v30, 16, v111
    v_and_b32 v31, s16, v111
    v_lshlrev_b32 v40, 16, v112
    v_and_b32 v41, s16, v112
    v_lshlrev_b32 v42, 16, v113
    v_and_b32 v43, s16, v113
    v_lshlrev_b32 v44, 16, v114
    v_and_b32 v45, s16, v114
    v_lshlrev_b32 v46, 16, v115
    v_and_b32 v47, s16, v115
    v_pk_add_f32 v[16:17], v[16:17], v[40:41]
    v_pk_add_f32 v[18:19], v[18:19], v[42:43]
    v_pk_add_f32 v[20:21], v[20:21], v[44:45]
    v_pk_add_f32 v[22:23], v[22:23], v[46:47]
    v_lshlrev_b32 v40, 16, v116
    v_and_b32 v41, s16, v116
    v_lshlrev_b32 v42, 16, v117
    v_and_b32 v43, s16, v117
    v_lshlrev_b32 v44, 16, v118
    v_and_b32 v45, s16, v118
    v_lshlrev_b32 v46, 16, v119
    v_and_b32 v47, s16, v119
    v_pk_add_f32 v[24:25], v[24:25], v[40:41]
    v_pk_add_f32 v[26:27], v[26:27], v[42:43]
    v_pk_add_f32 v[28:29], v[28:29], v[44:45]
    v_pk_add_f32 v[30:31], v[30:31], v[46:47]
    v_lshlrev_b32 v40, 16, v180
    v_and_b32 v41, s16, v180
    v_lshlrev_b32 v42, 16, v181
    v_and_b32 v43, s16, v181
    v_lshlrev_b32 v44, 16, v182
    v_and_b32 v45, s16, v182
    v_lshlrev_b32 v46, 16, v183
    v_and_b32 v47, s16, v183
    v_pk_add_f32 v[16:17], v[16:17], v[40:41]
    v_pk_add_f32 v[18:19], v[18:19], v[42:43]
    v_pk_add_f32 v[20:21], v[20:21], v[44:45]
    v_pk_add_f32 v[22:23], v[22:23], v[46:47]
    v_lshlrev_b32 v40, 16, v196
    v_and_b32 v41, s16, v196
    v_lshlrev_b32 v42, 16, v197
    v_and_b32 v43, s16, v197
    v_lshlrev_b32 v44, 16, v198
    v_and_b32 v45, s16, v198
    v_lshlrev_b32 v46, 16, v199
    v_and_b32 v47, s16, v199
    v_pk_add_f32 v[24:25], v[24:25], v[40:41]
    v_pk_add_f32 v[26:27], v[26:27], v[42:43]
    v_pk_add_f32 v[28:29], v[28:29], v[44:45]
    v_pk_add_f32 v[30:31], v[30:31], v[46:47]
    v_lshlrev_b32 v40, 16, v200
    v_and_b32 v41, s16, v200
    v_lshlrev_b32 v42, 16, v201
    v_and_b32 v43, s16, v201
    v_lshlrev_b32 v44, 16, v202
    v_and_b32 v45, s16, v202
    v_lshlrev_b32 v46, 16, v203
    v_and_b32 v47, s16, v203
    v_pk_add_f32 v[16:17], v[16:17], v[40:41]
    v_pk_add_f32 v[18:19], v[18:19], v[42:43]
    v_pk_add_f32 v[20:21], v[20:21], v[44:45]
    v_pk_add_f32 v[22:23], v[22:23], v[46:47]
    v_lshlrev_b32 v40, 16, v204
    v_and_b32 v41, s16, v204
    v_lshlrev_b32 v42, 16, v205
    v_and_b32 v43, s16, v205
    v_lshlrev_b32 v44, 16, v206
    v_and_b32 v45, s16, v206
    v_lshlrev_b32 v46, 16, v207
    v_and_b32 v47, s16, v207
    v_pk_add_f32 v[24:25], v[24:25], v[40:41]
    v_pk_add_f32 v[26:27], v[26:27], v[42:43]
    v_pk_add_f32 v[28:29], v[28:29], v[44:45]
    v_pk_add_f32 v[30:31], v[30:31], v[46:47]
    s_cmp_lg_u32 s3, 0
    s_cbranch_scc1 L_pollout_43
    s_lshl_b32 s7, s40, 7
    s_add_u32 s7, s7, s44
    s_add_u32 s7, s7, 65536
    s_add_u32 s52, s4, s7
    s_addc_u32 s53, s5, 0
    s_mov_b32 s6, 0
L_poll_41:
    s_load_dwordx8 s[56:63], s[52:53], 0 glc
    s_add_u32 s6, s6, 1
    s_waitcnt lgkmcnt(0)
    s_xor_b64 s[56:57], s[56:57], s[76:77]
    s_xor_b64 s[58:59], s[58:59], s[76:77]
    s_xor_b64 s[60:61], s[60:61], s[76:77]
    s_xor_b64 s[62:63], s[62:63], s[76:77]
    s_or_b64 s[56:57], s[56:57], s[58:59]
    s_or_b64 s[60:61], s[60:61], s[62:63]
    s_or_b64 s[56:57], s[56:57], s[60:61]
    s_cbranch_scc0 L_polled_42
    s_cmp_lt_u32 s6, 1048576
    s_cbranch_scc1 L_poll_41
    s_branch L_main_end
L_polled_42:
L_pollout_43:
    s_barrier
    buffer_load_dwordx4 v[60:63], v174, s[8:11], s20 offen sc1
    s_add_u32 s20, s20, 9216
    buffer_load_dwordx4 v[64:67], v174, s[8:11], s20 offen sc1
    s_add_u32 s20, s20, 9216
    buffer_load_dwordx4 v[68:71], v174, s[8:11], s20 offen sc1
    s_add_u32 s20, s20, 9216
    buffer_load_dwordx4 v[72:75], v174, s[8:11], s20 offen sc1
    s_add_u32 s20, s20, 9216
    buffer_load_dwordx4 v[76:79], v174, s[8:11], s20 offen sc1
    s_add_u32 s20, s20, 9216
    buffer_load_dwordx4 v[80:83], v174, s[8:11], s20 offen sc1
    s_add_u32 s20, s20, 9216
    buffer_load_dwordx4 v[84:87], v174, s[8:11], s20 offen sc1
    s_add_u32 s20, s20, 9216
    buffer_load_dwordx4 v[88:91], v174, s[8:11], s20 offen sc1
    v_lshlrev_b32 v40, 16, v208
    v_and_b32 v41, s16, v208
    v_lshlrev_b32 v42, 16, v209
    v_and_b32 v43, s16, v209
    v_lshlrev_b32 v44, 16, v210
    v_and_b32 v45, s16, v210
    v_lshlrev_b32 v46, 16, v211
    v_and_b32 v47, s16, v211
    v_pk_add_f32 v[16:17], v[16:17], v[40:41]
    v_pk_add_f32 v[18:19], v[18:19], v[42:43]
    v_pk_add_f32 v[20:21], v[20:21], v[44:45]
    v_pk_add_f32 v[22:23], v[22:23], v[46:47]
    v_lshlrev_b32 v40, 16, v212
    v_and_b32 v41, s16, v212
    v_lshlrev_b32 v42, 16, v213
    v_and_b32 v43, s16, v213
    v_lshlrev_b32 v44, 16, v214
    v_and_b32 v45, s16, v214
    v_lshlrev_b32 v46, 16, v215
    v_and_b32 v47, s16, v215
    v_pk_add_f32 v[24:25], v[24:25], v[40:41]
    v_pk_add_f32 v[26:27], v[26:27], v[42:43]
    v_pk_add_f32 v[28:29], v[28:29], v[44:45]
    v_pk_add_f32 v[30:31], v[30:31], v[46:47]
    v_lshlrev_b32 v40, 16, v216
    v_and_b32 v41, s16, v216
    v_lshlrev_b32 v42, 16, v217
    v_and_b32 v43, s16, v217
    v_lshlrev_b32 v44, 16, v218
    v_and_b32 v45, s16, v218
    v_lshlrev_b32 v46, 16, v219
    v_and_b32 v47, s16, v219
    v_pk_add_f32 v[16:17], v[16:17], v[40:41]
    v_pk_add_f32 v[18:19], v[18:19], v[42:43]
    v_pk_add_f32 v[20:21], v[20:21], v[44:45]
    v_pk_add_f32 v[22:23], v[22:23], v[46:47]
    v_lshlrev_b32 v40, 16, v136
    v_and_b32 v41, s16, v136
    v_lshlrev_b32 v42, 16, v137
    v_and_b32 v43, s16, v137
    v_lshlrev_b32 v44, 16, v138
    v_and_b32 v45, s16, v138
    v_lshlrev_b32 v46, 16, v139
    v_and_b32 v47, s16, v139
    v_pk_add_f32 v[24:25], v[24:25], v[40:41]
    v_pk_add_f32 v[26:27], v[26:27], v[42:43]
    v_pk_add_f32 v[28:29], v[28:29], v[44:45]
    v_pk_add_f32 v[30:31], v[30:31], v[46:47]
    v_lshlrev_b32 v40, 16, v140
    v_and_b32 v41, s16, v140
    v_lshlrev_b32 v42, 16, v141
    v_and_b32 v43, s16, v141
    v_lshlrev_b32 v44, 16, v142
    v_and_b32 v45, s16, v142
    v_lshlrev_b32 v46, 16, v143
    v_and_b32 v47, s16, v143
    v_pk_add_f32 v[16:17], v[16:17], v[40:41]
    v_pk_add_f32 v[18:19], v[18:19], v[42:43]
    v_pk_add_f32 v[20:21], v[20:21], v[44:45]
    v_pk_add_f32 v[22:23], v[22:23], v[46:47]
    v_lshlrev_b32 v40, 16, v144
    v_and_b32 v41, s16, v144
    v_lshlrev_b32 v42, 16, v145
    v_and_b32 v43, s16, v145
    v_lshlrev_b32 v44, 16, v146
    v_and_b32 v45, s16, v146
    v_lshlrev_b32 v46, 16, v147
    v_and_b32 v47, s16, v147
    v_pk_add_f32 v[24:25], v[24:25], v[40:41]
    v_pk_add_f32 v[26:27], v[26:27], v[42:43]
    v_pk_add_f32 v[28:29], v[28:29], v[44:45]
    v_pk_add_f32 v[30:31], v[30:31], v[46:47]
    v_lshlrev_b32 v40, 16, v148
    v_and_b32 v41, s16, v148
    v_lshlrev_b32 v42, 16, v149
    v_and_b32 v43, s16, v149
    v_lshlrev_b32 v44, 16, v150
    v_and_b32 v45, s16, v150
    v_lshlrev_b32 v46, 16, v151
    v_and_b32 v47, s16, v151
    v_pk_add_f32 v[16:17], v[16:17], v[40:41]
    v_pk_add_f32 v[18:19], v[18:19], v[42:43]
    v_pk_add_f32 v[20:21], v[20:21], v[44:45]
    v_pk_add_f32 v[22:23], v[22:23], v[46:47]
    v_lshlrev_b32 v40, 16, v160
    v_and_b32 v41, s16, v160
    v_lshlrev_b32 v42, 16, v161
    v_and_b32 v43, s16, v161
    v_lshlrev_b32 v44, 16, v162
    v_and_b32 v45, s16, v162
    v_lshlrev_b32 v46, 16, v163
    v_and_b32 v47, s16, v163
    v_pk_add_f32 v[24:25], v[24:25], v[40:41]
    v_pk_add_f32 v[26:27], v[26:27], v[42:43]
    v_pk_add_f32 v[28:29], v[28:29], v[44:45]
    v_pk_add_f32 v[30:31], v[30:31], v[46:47]
    s_cmp_eq_u32 s3, 0
    s_cselect_b32 s7, 1.0, 0
    s_waitcnt vmcnt(8)
    v_mul_f32 v11, s7, v10
    v_lshlrev_b32 v40, 16, v92
    v_and_b32 v41, s16, v92
    v_lshlrev_b32 v42, 16, v93
    v_and_b32 v43, s16, v93
    v_lshlrev_b32 v44, 16, v94
    v_and_b32 v45, s16, v94
    v_lshlrev_b32 v46, 16, v95
    v_and_b32 v47, s16, v95
    v_pk_add_f32 v[16:17], v[16:17], v[40:41]
    v_pk_add_f32 v[18:19], v[18:19], v[42:43]
    v_pk_add_f32 v[20:21], v[20:21], v[44:45]
    v_pk_add_f32 v[22:23], v[22:23], v[46:47]
    v_lshlrev_b32 v40, 16, v96
    v_and_b32 v41, s16, v96
    v_lshlrev_b32 v42, 16, v97
    v_and_b32 v43, s16, v97
    v_lshlrev_b32 v44, 16, v98
    v_and_b32 v45, s16, v98
    v_lshlrev_b32 v46, 16, v99
    v_and_b32 v47, s16, v99
    v_pk_add_f32 v[24:25], v[24:25], v[40:41]
    v_pk_add_f32 v[26:27], v[26:27], v[42:43]
    v_pk_add_f32 v[28:29], v[28:29], v[44:45]
    v_pk_add_f32 v[30:31], v[30:31], v[46:47]
    v_lshlrev_b32 v32, 16, v100
    v_and_b32 v33, s16, v100
    v_lshlrev_b32 v34, 16, v101
    v_and_b32 v35, s16, v101
    v_lshlrev_b32 v36, 16, v102
    v_and_b32 v37, s16, v102
    v_lshlrev_b32 v38, 16, v103
    v_and_b32 v39, s16, v103
    v_pk_add_f32 v[16:17], v[16:17], v[10:11] op_sel_hi:[1,0]
    v_pk_add_f32 v[18:19], v[18:19], v[10:11] op_sel_hi:[1,0]
    v_pk_add_f32 v[20:21], v[20:21], v[10:11] op_sel_hi:[1,0]
    v_pk_add_f32 v[22:23], v[22:23], v[10:11] op_sel_hi:[1,0]
    v_pk_add_f32 v[24:25], v[24:25], v[10:11] op_sel:[0,1] op_sel_hi:[1,1]
    v_pk_add_f32 v[26:27], v[26:27], v[10:11] op_sel:[0,1] op_sel_hi:[1,1]
    v_pk_add_f32 v[28:29], v[28:29], v[10:11] op_sel:[0,1] op_sel_hi:[1,1]
    v_pk_add_f32 v[30:31], v[30:31], v[10:11] op_sel:[0,1] op_sel_hi:[1,1]
    v_pk_add_f32 v[32:33], v[32:33], v[10:11] op_sel_hi:[1,0]
    v_pk_add_f32 v[34:35], v[34:35], v[10:11] op_sel_hi:[1,0]
    v_pk_add_f32 v[36:37], v[36:37], v[10:11] op_sel_hi:[1,0]
    v_pk_add_f32 v[38:39], v[38:39], v[10:11] op_sel_hi:[1,0]
    s_waitcnt vmcnt(7)
    s_lshl_b32 s28, s40, 2
    s_add_u32 s28, s28, s3
    s_mul_i32 s28, s28, 73728
    s_mul_i32 s7, s42, 1073741824
    v_add_u32 v1, s7, v253
    buffer_load_dwordx4 a[0:3], v1, s[8:11], s28 offen offset:0 sc1
    buffer_load_dwordx4 a[4:7], v1, s[8:11], s28 offen offset:1024 sc1
    v_lshlrev_b32 v40, 16, v60
    v_and_b32 v41, s16, v60
    v_lshlrev_b32 v42, 16, v61
    v_and_b32 v43, s16, v61
    v_lshlrev_b32 v44, 16, v62
    v_and_b32 v45, s16, v62
    v_lshlrev_b32 v46, 16, v63
    v_and_b32 v47, s16, v63
    v_pk_add_f32 v[32:33], v[32:33], v[40:41]
    v_pk_add_f32 v[34:35], v[34:35], v[42:43]
    v_pk_add_f32 v[36:37], v[36:37], v[44:45]
    v_pk_add_f32 v[38:39], v[38:39], v[46:47]
    s_waitcnt vmcnt(8)
    buffer_load_dwordx4 a[8:11], v1, s[8:11], s28 offen offset:2048 sc1
    buffer_load_dwordx4 a[12:15], v1, s[8:11], s28 offen offset:3072 sc1
    v_lshlrev_b32 v40, 16, v64
    v_and_b32 v41, s16, v64
    v_lshlrev_b32 v42, 16, v65
    v_and_b32 v43, s16, v65
    v_lshlrev_b32 v44, 16, v66
    v_and_b32 v45, s16, v66
    v_lshlrev_b32 v46, 16, v67
    v_and_b32 v47, s16, v67
    v_pk_add_f32 v[32:33], v[32:33], v[40:41]
    v_pk_add_f32 v[34:35], v[34:35], v[42:43]
    v_pk_add_f32 v[36:37], v[36:37], v[44:45]
    v_pk_add_f32 v[38:39], v[38:39], v[46:47]
    s_waitcnt vmcnt(9)
    s_add_u32 s28, s28, 4096
    buffer_load_dwordx4 a[16:19], v1, s[8:11], s28 offen offset:0 sc1
    buffer_load_dwordx4 a[20:23], v1, s[8:11], s28 offen offset:1024 sc1
    v_lshlrev_b32 v40, 16, v68
    v_and_b32 v41, s16, v68
    v_lshlrev_b32 v42, 16, v69
    v_and_b32 v43, s16, v69
    v_lshlrev_b32 v44, 16, v70
    v_and_b32 v45, s16, v70
    v_lshlrev_b32 v46, 16, v71
    v_and_b32 v47, s16, v71
    v_pk_add_f32 v[32:33], v[32:33], v[40:41]
    v_pk_add_f32 v[34:35], v[34:35], v[42:43]
    v_pk_add_f32 v[36:37], v[36:37], v[44:45]
    v_pk_add_f32 v[38:39], v[38:39], v[46:47]
    s_waitcnt vmcnt(10)
    buffer_load_dwordx4 a[24:27], v1, s[8:11], s28 offen offset:2048 sc1
    buffer_load_dwordx4 a[28:31], v1, s[8:11], s28 offen offset:3072 sc1
    v_lshlrev_b32 v40, 16, v72
    v_and_b32 v41, s16, v72
    v_lshlrev_b32 v42, 16, v73
    v_and_b32 v43, s16, v73
    v_lshlrev_b32 v44, 16, v74
    v_and_b32 v45, s16, v74
    v_lshlrev_b32 v46, 16, v75
    v_and_b32 v47, s16, v75
    v_pk_add_f32 v[32:33], v[32:33], v[40:41]
    v_pk_add_f32 v[34:35], v[34:35], v[42:43]
    v_pk_add_f32 v[36:37], v[36:37], v[44:45]
    v_pk_add_f32 v[38:39], v[38:39], v[46:47]
    s_waitcnt vmcnt(11)
    s_add_u32 s28, s28, 4096
    buffer_load_dwordx4 a[32:35], v1, s[8:11], s28 offen offset:0 sc1
    buffer_load_dwordx4 a[36:39], v1, s[8:11], s28 offen offset:1024 sc1
    v_lshlrev_b32 v40, 16, v76
    v_and_b32 v41, s16, v76
    v_lshlrev_b32 v42, 16, v77
    v_and_b32 v43, s16, v77
    v_lshlrev_b32 v44, 16, v78
    v_and_b32 v45, s16, v78
    v_lshlrev_b32 v46, 16, v79
    v_and_b32 v47, s16, v79
    v_pk_add_f32 v[32:33], v[32:33], v[40:41]
    v_pk_add_f32 v[34:35], v[34:35], v[42:43]
    v_pk_add_f32 v[36:37], v[36:37], v[44:45]
    v_pk_add_f32 v[38:39], v[38:39], v[46:47]
    s_waitcnt vmcnt(12)
    buffer_load_dwordx4 a[40:43], v1, s[8:11], s28 offen offset:2048 sc1
    buffer_load_dwordx4 a[44:47], v1, s[8:11], s28 offen offset:3072 sc1
    v_lshlrev_b32 v40, 16, v80
    v_and_b32 v41, s16, v80
    v_lshlrev_b32 v42, 16, v81
    v_and_b32 v43, s16, v81
    v_lshlrev_b32 v44, 16, v82
    v_and_b32 v45, s16, v82
    v_lshlrev_b32 v46, 16, v83
    v_and_b32 v47, s16, v83
    v_pk_add_f32 v[32:33], v[32:33], v[40:41]
    v_pk_add_f32 v[34:35], v[34:35], v[42:43]
    v_pk_add_f32 v[36:37], v[36:37], v[44:45]
    v_pk_add_f32 v[38:39], v[38:39], v[46:47]
    s_waitcnt vmcnt(13)
    s_add_u32 s28, s28, 4096
    buffer_load_dwordx4 a[48:51], v1, s[8:11], s28 offen offset:0 sc1
    buffer_load_dwordx4 a[52:55], v1, s[8:11], s28 offen offset:1024 sc1
    v_lshlrev_b32 v40, 16, v84
    v_and_b32 v41, s16, v84
    v_lshlrev_b32 v42, 16, v85
    v_and_b32 v43, s16, v85
    v_lshlrev_b32 v44, 16, v86
    v_and_b32 v45, s16, v86
    v_lshlrev_b32 v46, 16, v87
    v_and_b32 v47, s16, v87
    v_pk_add_f32 v[32:33], v[32:33], v[40:41]
    v_pk_add_f32 v[34:35], v[34:35], v[42:43]
    v_pk_add_f32 v[36:37], v[36:37], v[44:45]
    v_pk_add_f32 v[38:39], v[38:39], v[46:47]
    s_waitcnt vmcnt(14)
    buffer_load_dwordx4 a[56:59], v1, s[8:11], s28 offen offset:2048 sc1
    buffer_load_dwordx4 a[60:63], v1, s[8:11], s28 offen offset:3072 sc1
    v_lshlrev_b32 v40, 16, v88
    v_and_b32 v41, s16, v88
    v_lshlrev_b32 v42, 16, v89
    v_and_b32 v43, s16, v89
    v_lshlrev_b32 v44, 16, v90
    v_and_b32 v45, s16, v90
    v_lshlrev_b32 v46, 16, v91
    v_and_b32 v47, s16, v91
    v_pk_add_f32 v[32:33], v[32:33], v[40:41]
    v_pk_add_f32 v[34:35], v[34:35], v[42:43]
    v_pk_add_f32 v[36:37], v[36:37], v[44:45]
    v_pk_add_f32 v[38:39], v[38:39], v[46:47]
    s_add_u32 s28, s28, 4096
    buffer_load_dwordx4 a[64:67], v1, s[8:11], s28 offen offset:0 sc1
    buffer_load_dwordx4 a[68:71], v1, s[8:11], s28 offen offset:1024 sc1
    buffer_load_dwordx4 a[72:75], v1, s[8:11], s28 offen offset:2048 sc1
    buffer_load_dwordx4 a[76:79], v1, s[8:11], s28 offen offset:3072 sc1
    s_add_u32 s28, s28, 4096
    buffer_load_dwordx4 a[80:83], v1, s[8:11], s28 offen offset:0 sc1
    buffer_load_dwordx4 a[84:87], v1, s[8:11], s28 offen offset:1024 sc1
    buffer_load_dwordx4 a[88:91], v1, s[8:11], s28 offen offset:2048 sc1
    buffer_load_dwordx4 a[92:95], v1, s[8:11], s28 offen offset:3072 sc1
    s_add_u32 s28, s28, 4096
    v_cvt_pk_bf16_f32 v120, v16, v17
    v_cvt_pk_bf16_f32 v121, v18, v19
    v_cvt_pk_bf16_f32 v122, v20, v21
    v_cvt_pk_bf16_f32 v123, v22, v23
    v_cvt_pk_bf16_f32 v124, v24, v25
    v_cvt_pk_bf16_f32 v125, v26, v27
    v_cvt_pk_bf16_f32 v126, v28, v29
    v_cvt_pk_bf16_f32 v127, v30, v31
    v_cvt_pk_bf16_f32 v128, v32, v33
    v_cvt_pk_bf16_f32 v129, v34, v35
    v_cvt_pk_bf16_f32 v130, v36, v37
    v_cvt_pk_bf16_f32 v131, v38, v39
    s_cmp_lg_u32 s42, 0
    s_cbranch_scc1 L_main_last
    s_add_u32 s19, s18, 53215232
    s_add_u32 s20, s18, 48496640
    s_lshl_b32 s22, s21, 7
    s_add_u32 s22, s22, 57933824
    buffer_store_dwordx4 v[120:123], v172, s[8:11], s19 offen sc1
    buffer_store_dwordx4 v[124:127], v173, s[8:11], s19 offen sc1
    buffer_store_dwordx4 v[128:131], v174, s[8:11], s19 offen sc1
    s_mov_b32 s17, 0x3f803f80
    v_mov_b32 v8, 0
    v_mov_b32 v9, 0
    v_mov_b32 v10, 0
    v_mov_b32 v11, 0
    v_dot2c_f32_bf16 v8, s17, v120
    v_dot2c_f32_bf16 v9, v120, v120
    v_dot2c_f32_bf16 v10, s17, v121
    v_dot2c_f32_bf16 v11, v121, v121
    v_dot2c_f32_bf16 v8, s17, v122
    v_dot2c_f32_bf16 v9, v122, v122
    v_dot2c_f32_bf16 v10, s17, v123
    v_dot2c_f32_bf16 v11, v123, v123
    v_dot2c_f32_bf16 v8, s17, v124
    v_dot2c_f32_bf16 v9, v124, v124
    v_dot2c_f32_bf16 v10, s17, v125
    v_dot2c_f32_bf16 v11, v125, v125
    v_dot2c_f32_bf16 v8, s17, v126
    v_dot2c_f32_bf16 v9, v126, v126
    v_dot2c_f32_bf16 v10, s17, v127
    v_dot2c_f32_bf16 v11, v127, v127
    v_dot2c_f32_bf16 v8, s17, v128
    v_dot2c_f32_bf16 v9, v128, v128
    v_dot2c_f32_bf16 v10, s17, v129
    v_dot2c_f32_bf16 v11, v129, v129
    v_dot2c_f32_bf16 v8, s17, v130
    v_dot2c_f32_bf16 v9, v130, v130
    v_dot2c_f32_bf16 v10, s17, v131
    v_dot2c_f32_bf16 v11, v131, v131
    v_and_b32 v12, 7, v0
    v_lshlrev_b32 v12, 3, v12
    s_lshl_b32 s7, s3, 6
    v_add_u32 v13, s7, v12
    v_pk_add_f32 v[8:9], v[8:9], v[10:11]
    s_nop 1
    v_add_f32_dpp v8, v8, v8 row_ror:8 row_mask:0xf bank_mask:0xf
    v_add_f32_dpp v9, v9, v9 row_ror:8 row_mask:0xf bank_mask:0xf
    v_mov_b32 v10, v8
    v_mov_b32 v11, v9
    s_nop 1
    v_permlane32_swap_b32 v10, v8
    v_permlane32_swap_b32 v11, v9
    v_add_f32 v8, v8, v10
    v_add_f32 v9, v9, v11
    v_mov_b32 v10, v8
    v_mov_b32 v11, v9
    s_nop 1
    v_permlane16_swap_b32 v10, v8
    v_permlane16_swap_b32 v11, v9
    v_add_f32 v8, v8, v10
    v_add_f32 v9, v9, v11
    ds_write_b64 v13, v[8:9]
    s_waitcnt lgkmcnt(0)
    s_barrier
    ds_read_b64 v[40:41], v12 offset:0
    ds_read_b64 v[42:43], v12 offset:64
    ds_read_b64 v[44:45], v12 offset:128
    ds_read_b64 v[46:47], v12 offset:192
    s_waitcnt lgkmcnt(0)
    v_pk_add_f32 v[40:41], v[40:41], v[42:43]
    v_pk_add_f32 v[44:45], v[44:45], v[46:47]
    v_pk_add_f32 v[8:9], v[40:41], v[44:45]
    v_mul_f32 v8, 0x3ae38e39, v8
    v_mul_f32 v9, 0x3ae38e39, v9
    v_fma_f32 v9, -v8, v8, v9
    v_max_f32 v9, 0, v9
    v_add_f32 v9, 0x3727c5ac, v9
    v_rsq_f32 v10, v9
    s_nop 0
    v_mul_f32 v12, v8, v10
    v_mov_b32 v11, v10
    v_sub_f32 v12, 0, v12
    v_mov_b32 v13, v12
    s_cmp_eq_u32 s3, 0
    s_cselect_b32 s7, 32, 0
    v_lshlrev_b32 v14, 2, v0
    v_cmp_gt_u32 vcc, s7, v0
    v_mov_b32 v9, 1073741824
    s_nop 0
    v_cndmask_b32 v14, v9, v14, vcc
    buffer_store_dword v8, v14, s[8:11], s22 offen sc1
    v_lshlrev_b32 v40, 16, v120
    v_and_b32 v41, s16, v120
    v_lshlrev_b32 v42, 16, v121
    v_and_b32 v43, s16, v121
    v_lshlrev_b32 v44, 16, v122
    v_and_b32 v45, s16, v122
    v_lshlrev_b32 v46, 16, v123
    v_and_b32 v47, s16, v123
    v_pk_fma_f32 v[40:41], v[40:41], v[10:11], v[12:13]
    v_pk_fma_f32 v[42:43], v[42:43], v[10:11], v[12:13]
    v_pk_fma_f32 v[44:45], v[44:45], v[10:11], v[12:13]
    v_pk_fma_f32 v[46:47], v[46:47], v[10:11], v[12:13]
    v_cvt_pk_bf16_f32 v48, v40, v41
    v_cvt_pk_bf16_f32 v49, v42, v43
    v_cvt_pk_bf16_f32 v50, v44, v45
    v_cvt_pk_bf16_f32 v51, v46, v47
    v_lshlrev_b32 v40, 16, v124
    v_and_b32 v41, s16, v124
    v_lshlrev_b32 v42, 16, v125
    v_and_b32 v43, s16, v125
    v_lshlrev_b32 v44, 16, v126
    v_and_b32 v45, s16, v126
    v_lshlrev_b32 v46, 16, v127
    v_and_b32 v47, s16, v127
    v_pk_fma_f32 v[40:41], v[40:41], v[10:11], v[12:13]
    v_pk_fma_f32 v[42:43], v[42:43], v[10:11], v[12:13]
    v_pk_fma_f32 v[44:45], v[44:45], v[10:11], v[12:13]
    v_pk_fma_f32 v[46:47], v[46:47], v[10:11], v[12:13]
    v_cvt_pk_bf16_f32 v52, v40, v41
    v_cvt_pk_bf16_f32 v53, v42, v43
    v_cvt_pk_bf16_f32 v54, v44, v45
    v_cvt_pk_bf16_f32 v55, v46, v47
    v_lshlrev_b32 v40, 16, v128
    v_and_b32 v41, s16, v128
    v_lshlrev_b32 v42, 16, v129
    v_and_b32 v43, s16, v129
    v_lshlrev_b32 v44, 16, v130
    v_and_b32 v45, s16, v130
    v_lshlrev_b32 v46, 16, v131
    v_and_b32 v47, s16, v131
    v_pk_fma_f32 v[40:41], v[40:41], v[10:11], v[12:13]
    v_pk_fma_f32 v[42:43], v[42:43], v[10:11], v[12:13]
    v_pk_fma_f32 v[44:45], v[44:45], v[10:11], v[12:13]
    v_pk_fma_f32 v[46:47], v[46:47], v[10:11], v[12:13]
    v_cvt_pk_bf16_f32 v56, v40, v41
    v_cvt_pk_bf16_f32 v57, v42, v43
    v_cvt_pk_bf16_f32 v58, v44, v45
    v_cvt_pk_bf16_f32 v59, v46, v47
    buffer_store_dwordx4 v[48:51], v172, s[8:11], s20 offen sc1
    buffer_store_dwordx4 v[52:55], v173, s[8:11], s20 offen sc1
    buffer_store_dwordx4 v[56:59], v174, s[8:11], s20 offen sc1
    v_lshlrev_b32 v15, 7, v0
    s_lshl_b32 s6, s40, 2
    s_add_u32 s6, s6, s44
    s_add_u32 s6, s6, 98304
    v_mov_b32 v1, s76
    s_mov_b64 vcc, 0xff
    v_lshrrev_b32 v14, 3, v0
    v_lshl_add_u32 v15, v14, 3, v15
    s_cmp_ge_u32 s40, 6
    s_cselect_b32 s7, s41, 31
    s_cmp_lt_u32 s7, 31
    s_cmov_b64 vcc, 0xffff
    s_waitcnt vmcnt(0)
    s_barrier
    s_cmp_lg_u32 s3, 0
    s_cbranch_scc1 L_pub_44
    s_mov_b64 exec, vcc
    buffer_store_dword v1, v15, s[8:11], s6 offen sc1
L_pub_44:
    s_mov_b64 exec, -1
    s_mov_b32 s42, 1
    s_mov_b32 s43, 9699328
    s_add_u32 s44, s44, 131072
    s_mov_b32 s74, 0
    s_branch L_main_layer
L_main_last:
    buffer_store_dwordx4 v[120:123], v175, s[12:15], s18 offen
    buffer_store_dwordx4 v[124:127], v176, s[12:15], s18 offen
    buffer_store_dwordx4 v[128:131], v177, s[12:15], s18 offen
    s_or_b32 s7, s40, s41
    s_or_b32 s7, s7, s3
    s_cbranch_scc1 L_done_45
    v_mov_b32 v1, s76
    s_mov_b32 s7, 19660800
    s_mov_b64 exec, 1
    buffer_store_dword v1, off, s[8:11], s7 sc1
    s_mov_b64 exec, -1
L_done_45:
L_main_end:
    s_endpgm
L_main_code_end:
.section .rodata,"a"
.p2align 6
.amdhsa_kernel interleave_layers__sliding_local_dilated__glu_gated_geglu__prompt_kernel
.amdhsa_next_free_vgpr 512
.amdhsa_next_free_sgpr 102
.amdhsa_accum_offset 256
.amdhsa_group_segment_fixed_size 0
.amdhsa_kernarg_size 80
.amdhsa_user_sgpr_count 2
.amdhsa_user_sgpr_kernarg_segment_ptr 1
.amdhsa_system_sgpr_workgroup_id_x 1
.amdhsa_float_denorm_mode_32 3
.amdhsa_float_denorm_mode_16_64 3
.end_amdhsa_kernel
```

```asm
; @launch grid=(256,1,1) block=(256,1,1) lds=163840
.amdgcn_target "amdgcn-amd-amdhsa--gfx950"
.text
.globl interleave_layers__sliding_local_dilated__glu_gated_geglu__prompt_kernel
.p2align 8
.type interleave_layers__sliding_local_dilated__glu_gated_geglu__prompt_kernel,@function
interleave_layers__sliding_local_dilated__glu_gated_geglu__prompt_kernel:
    s_cmp_ge_u32 s2, 256
    s_cbranch_scc1 L_main_end
    s_load_dwordx2 s[4:5], s[0:1], 72
    s_load_dwordx4 s[16:19], s[0:1], 0
    s_load_dwordx2 s[22:23], s[0:1], 16
    s_load_dwordx8 s[24:31], s[0:1], 32
    v_lshrrev_b32 v1, 6, v0
    v_and_b32 v0, 63, v0
    v_readfirstlane_b32 s3, v1
    s_waitcnt lgkmcnt(0)
    s_mov_b32 s8, s4
    s_and_b32 s9, s5, 0xffff
    s_mov_b32 s10, 268435456
    s_mov_b32 s11, 0x20000
    s_mov_b32 s7, 19660800
    s_load_dword s76, s[4:5], s7
    s_mov_b64 s[20:21], s[18:19]
    s_mov_b64 s[18:19], s[16:17]
    s_mov_b32 s48, s4
    s_and_b32 s49, s5, 0xffff
    s_mov_b32 s50, 268435456
    s_mov_b32 s51, 0x20000
    s_and_b32 s40, s2, 1
    s_lshl_b32 s40, s40, 2
    s_bfe_u32 s7, s2, 131075
    s_add_u32 s40, s40, s7
    s_bfe_u32 s41, s2, 131073
    s_lshl_b32 s41, s41, 3
    s_lshr_b32 s7, s2, 5
    s_add_u32 s41, s41, s7
    s_mov_b32 s42, 0
    s_mov_b32 s43, 0
    s_lshl_b32 s44, s41, 10
    s_add_u32 s44, s44, 19169280
    v_lshlrev_b32 v253, 4, v0
    s_getpc_b64 s[96:97]
L_main_pc:
    s_sub_u32 s96, s96, L_main_pc-interleave_layers__sliding_local_dilated__glu_gated_geglu__prompt_kernel
    s_subb_u32 s97, s97, 0
    s_and_b32 s97, s97, 0xffff
    s_mov_b32 s98, L_main_code_end-interleave_layers__sliding_local_dilated__glu_gated_geglu__prompt_kernel
    s_mov_b32 s99, 0x20000
    s_lshr_b32 s7, s2, 3
    s_lshl_b32 s7, s7, 2
    s_add_u32 s7, s7, s3
    s_lshl_b32 s7, s7, 9
    v_lshrrev_b32 v1, 1, v253
    v_add_u32 v1, s7, v1
    buffer_load_dwordx2 v[2:3], v1, s[96:99], 0 offen
    s_mov_b32 s12, s18
    s_and_b32 s13, s19, 0xffff
    s_mov_b32 s14, 2359296
    s_mov_b32 s15, 0x20000
    s_mov_b32 s64, s20
    s_and_b32 s65, s21, 0xffff
    s_mov_b32 s66, 1990656
    s_mov_b32 s67, 0x20000
    s_mov_b32 s68, s22
    s_and_b32 s69, s23, 0xffff
    s_mov_b32 s70, 663552
    s_mov_b32 s71, 0x20000
    s_mov_b32 s16, 0xffff0000
    s_lshl_b32 s7, s3, 10
    v_add_u32 v172, s7, v253
    v_add_u32 v174, 5120, v172
    v_and_b32 v178, 7, v0
    v_mul_u32_u24 v178, 1152, v178
    v_lshrrev_b32 v179, 3, v0
    v_lshl_add_u32 v178, v179, 4, v178
    s_lshl_b32 s7, s3, 7
    v_add_u32 v175, s7, v178
    v_add_u32 v177, 640, v175
    s_cmp_eq_u32 s3, 0
    s_mov_b32 s17, 1073741824
    s_cmov_b32 s17, 4096
    v_add_u32 v173, s17, v172
    s_mov_b32 s17, 1073741824
    s_cmov_b32 s17, 512
    v_add_u32 v176, s17, v175
    s_lshl_b32 s21, s41, 3
    s_add_u32 s21, s21, s40
    s_mul_i32 s18, s21, 9216
    buffer_load_dwordx4 v[16:19], v175, s[12:15], s18 offen
    buffer_load_dwordx4 v[20:23], v176, s[12:15], s18 offen
    buffer_load_dwordx4 v[24:27], v177, s[12:15], s18 offen
    s_mov_b32 s12, s30
    s_and_b32 s13, s31, 0xffff
    s_mov_b32 s14, 2359296
    s_mov_b32 s15, 0x20000
    s_lshl_b32 s79, s3, 14
    s_add_u32 s79, s79, 98304
    s_sub_u32 s36, s21, 144
    s_cmp_ge_u32 s41, 18
    s_cbranch_scc1 L_prep_o_1
    s_mul_i32 s35, s41, 110592
    s_mul_i32 s7, s40, 144
    s_and_b32 s46, s7, 127
    s_sub_u32 s7, s7, s46
    s_add_u32 s35, s35, s7
    s_mul_i32 s7, s3, 13824
    s_add_u32 s35, s35, s7
    v_lshrrev_b32 v8, 4, v0
    v_mul_u32_u24 v8, 3456, v8
    v_and_b32 v9, 15, v0
    v_lshl_add_u32 v8, v9, 4, v8
    s_lshl_b32 s34, s3, 10
    s_add_u32 m0, s34, 8192
    s_add_u32 s7, s35, 0
    buffer_load_dwordx4 v8, s[64:67], s7 offen lds
    s_add_u32 m0, s34, 12288
    s_add_u32 s7, s35, 55296
    buffer_load_dwordx4 v8, s[64:67], s7 offen lds
    s_add_u32 m0, s34, 16384
    s_add_u32 s7, s35, 1152
    buffer_load_dwordx4 v8, s[64:67], s7 offen lds
    s_add_u32 m0, s34, 20480
    s_add_u32 s7, s35, 56448
    buffer_load_dwordx4 v8, s[64:67], s7 offen lds
    s_add_u32 m0, s34, 24576
    s_add_u32 s7, s35, 2304
    buffer_load_dwordx4 v8, s[64:67], s7 offen lds
    s_add_u32 m0, s34, 28672
    s_add_u32 s7, s35, 57600
    buffer_load_dwordx4 v8, s[64:67], s7 offen lds
    s_branch L_prep_go_3
L_prep_o_1:
    s_cmp_ge_u32 s36, 54
    s_cbranch_scc1 L_prep_m_2
    s_mul_i32 s33, s36, 349526
    s_lshr_b32 s33, s33, 20
    s_mul_i32 s34, s33, 3
    s_sub_u32 s34, s36, s34
    s_lshl_b32 s7, s33, 2
    s_add_u32 s7, s7, s3
    v_mov_b32 v8, s7
    v_lshrrev_b32 v9, 3, v0
    v_mul_u32_u24 v11, 7282, v8
    v_lshrrev_b32 v11, 16, v11
    v_mul_u32_u24 v12, 9, v11
    v_sub_u32 v12, v8, v12
    v_mul_u32_u24 v11, 72, v11
    v_cmp_eq_u32 vcc, 8, v12
    v_lshrrev_b32 v10, 1, v12
    v_mad_u32_u24 v10, v10, 18, v11
    v_and_b32 v12, 1, v12
    v_lshl_add_u32 v10, v12, 3, v10
    v_add_u32 v10, v10, v9
    v_lshrrev_b32 v12, 1, v9
    v_mad_u32_u24 v11, v12, 18, v11
    v_and_b32 v12, 1, v9
    v_add3_u32 v11, v11, v12, 16
    v_cndmask_b32 v10, v10, v11, vcc
    v_mul_u32_u24 v10, 1152, v10
    v_and_b32 v9, 7, v0
    v_lshl_add_u32 v10, v9, 4, v10
    s_mul_i32 s35, s34, 384
    s_lshl_b32 s6, s3, 10
    s_add_u32 m0, s6, 8192
    s_add_u32 s7, s35, 0
    buffer_load_dwordx4 v10, s[68:71], s7 offen lds
    s_add_u32 m0, s6, 12288
    s_add_u32 s7, s35, 128
    buffer_load_dwordx4 v10, s[68:71], s7 offen lds
    s_add_u32 m0, s6, 16384
    s_add_u32 s7, s35, 256
    buffer_load_dwordx4 v10, s[68:71], s7 offen lds
    s_branch L_prep_go_3
L_prep_m_2:
    s_sub_u32 s37, s36, 54
    s_lshl_b32 s7, s3, 6
    s_add_u32 s37, s37, s7
    s_cmp_ge_u32 s37, 36
    s_cbranch_scc1 L_prep_go_3
    s_lshl_b32 s7, s37, 1
    v_bfe_u32 v8, v0, 3, 1
    v_add_u32 v8, s7, v8
    v_and_b32 v9, 7, v0
    v_mul_u32_u24 v11, 7282, v8
    v_lshrrev_b32 v11, 16, v11
    v_mul_u32_u24 v12, 9, v11
    v_sub_u32 v12, v8, v12
    v_mul_u32_u24 v11, 72, v11
    v_cmp_eq_u32 vcc, 8, v12
    v_lshrrev_b32 v10, 1, v12
    v_mad_u32_u24 v10, v10, 18, v11
    v_and_b32 v12, 1, v12
    v_lshl_add_u32 v10, v12, 3, v10
    v_add_u32 v10, v10, v9
    v_lshrrev_b32 v12, 1, v9
    v_mad_u32_u24 v11, v12, 18, v11
    v_and_b32 v12, 1, v9
    v_add3_u32 v11, v11, v12, 16
    v_cndmask_b32 v10, v10, v11, vcc
    v_mul_u32_u24 v10, 1152, v10
    v_lshrrev_b32 v9, 4, v0
    v_lshl_add_u32 v10, v9, 4, v10
    buffer_load_dwordx4 v[64:67], v10, s[68:71], 0 offen offset:0
    buffer_load_dwordx4 v[68:71], v10, s[68:71], 0 offen offset:64
    buffer_load_dwordx4 v[72:75], v10, s[68:71], 0 offen offset:128
    buffer_load_dwordx4 v[76:79], v10, s[68:71], 0 offen offset:192
    buffer_load_dwordx4 v[80:83], v10, s[68:71], 0 offen offset:256
    buffer_load_dwordx4 v[84:87], v10, s[68:71], 0 offen offset:320
    buffer_load_dwordx4 v[88:91], v10, s[68:71], 0 offen offset:384
    buffer_load_dwordx4 v[92:95], v10, s[68:71], 0 offen offset:448
    buffer_load_dwordx4 v[96:99], v10, s[68:71], 0 offen offset:512
    buffer_load_dwordx4 v[100:103], v10, s[68:71], 0 offen offset:576
    buffer_load_dwordx4 v[104:107], v10, s[68:71], 0 offen offset:640
    buffer_load_dwordx4 v[108:111], v10, s[68:71], 0 offen offset:704
    buffer_load_dwordx4 v[112:115], v10, s[68:71], 0 offen offset:768
    buffer_load_dwordx4 v[116:119], v10, s[68:71], 0 offen offset:832
    buffer_load_dwordx4 v[120:123], v10, s[68:71], 0 offen offset:896
    buffer_load_dwordx4 v[124:127], v10, s[68:71], 0 offen offset:960
    buffer_load_dwordx4 v[128:131], v10, s[68:71], 0 offen offset:1024
    buffer_load_dwordx4 v[132:135], v10, s[68:71], 0 offen offset:1088
L_prep_go_3:
    s_lshl_b32 s7, s41, 2
    s_add_u32 s7, s7, s3
    s_mul_i32 s93, s7, 25576
    s_lshr_b32 s93, s93, 20
    s_min_u32 s93, s93, 2
    s_mul_i32 s6, s93, 41
    s_sub_u32 s7, s7, s6
    s_lshl_b32 s17, s7, 2
    s_cmp_eq_u32 s93, 1
    s_cselect_b32 s72, s26, s24
    s_cselect_b32 s73, s27, s25
    s_cmp_eq_u32 s93, 2
    s_cselect_b32 s72, s28, s72
    s_cselect_b32 s73, s29, s73
    s_mov_b32 s92, 73728
    s_cmov_b32 s92, 9216
    s_mov_b32 s47, 1152
    s_cmov_b32 s47, 663552
    s_and_b32 s73, s73, 0xffff
    s_mov_b32 s74, 5308416
    s_mov_b32 s75, 0x20000
    s_mul_i32 s47, s47, s40
    s_add_u32 s7, s17, 0
    s_min_u32 s7, s7, 161
    s_mul_i32 s84, s7, 116509
    s_lshr_b32 s84, s84, 20
    s_mul_i32 s88, s84, 9
    s_sub_u32 s88, s7, s88
    s_mul_i32 s7, s84, s92
    s_lshl_b32 s7, s7, 2
    s_add_u32 s7, s7, s47
    s_lshl_b32 s6, s88, 7
    s_add_u32 s80, s7, s6
    s_add_u32 s7, s17, 1
    s_min_u32 s7, s7, 161
    s_mul_i32 s85, s7, 116509
    s_lshr_b32 s85, s85, 20
    s_mul_i32 s89, s85, 9
    s_sub_u32 s89, s7, s89
    s_mul_i32 s7, s85, s92
    s_lshl_b32 s7, s7, 2
    s_add_u32 s7, s7, s47
    s_lshl_b32 s6, s89, 7
    s_add_u32 s81, s7, s6
    s_add_u32 s7, s17, 2
    s_min_u32 s7, s7, 161
    s_mul_i32 s86, s7, 116509
    s_lshr_b32 s86, s86, 20
    s_mul_i32 s90, s86, 9
    s_sub_u32 s90, s7, s90
    s_mul_i32 s7, s86, s92
    s_lshl_b32 s7, s7, 2
    s_add_u32 s7, s7, s47
    s_lshl_b32 s6, s90, 7
    s_add_u32 s82, s7, s6
    s_add_u32 s7, s17, 3
    s_min_u32 s7, s7, 161
    s_mul_i32 s87, s7, 116509
    s_lshr_b32 s87, s87, 20
    s_mul_i32 s91, s87, 9
    s_sub_u32 s91, s7, s91
    s_mul_i32 s7, s87, s92
    s_lshl_b32 s7, s7, 2
    s_add_u32 s7, s7, s47
    s_lshl_b32 s6, s91, 7
    s_add_u32 s83, s7, s6
    s_lshr_b32 s7, s92, 3
    v_lshrrev_b32 v224, 3, v0
    v_mul_lo_u32 v224, v224, s7
    v_and_b32 v8, 7, v0
    v_lshl_add_u32 v224, v8, 4, v224
    s_waitcnt lgkmcnt(0)
    s_mul_i32 s76, s76, 0x9e3779b1
    s_add_u32 s76, s76, 0x7f4a7c15
    s_mov_b32 s77, s76
    s_add_u32 m0, s79, 0
    s_mov_b32 s71, s80
    buffer_load_dwordx4 v224, s[72:75], s71 offen nt lds
    s_add_u32 m0, s79, 1024
    s_add_u32 s71, s71, s92
    buffer_load_dwordx4 v224, s[72:75], s71 offen nt lds
    s_add_u32 m0, s79, 2048
    s_add_u32 s71, s71, s92
    buffer_load_dwordx4 v224, s[72:75], s71 offen nt lds
    s_waitcnt vmcnt(3)
    s_barrier
    s_cmp_ge_u32 s41, 18
    s_cbranch_scc1 L_prep_o_4
    s_mul_i32 s7, s3, 36
    s_add_u32 s7, s7, s46
    v_lshrrev_b32 v8, 4, v0
    v_lshlrev_b32 v8, 11, v8
    v_add_u32 v8, s7, v8
    v_and_b32 v9, 15, v0
    v_cmp_gt_u32 s[22:23], 6, v9
    v_lshrrev_b32 v10, 1, v9
    v_min_u32 v10, 2, v10
    v_lshl_add_u32 v10, v10, 13, v8
    v_and_b32 v11, 1, v0
    v_lshl_add_u32 v10, v11, 1, v10
    v_lshl_add_u32 v8, v9, 1, v8
    ds_read_u16 v136, v8 offset:8192
    ds_read_u16 v137, v8 offset:8448
    ds_read_u16 v138, v8 offset:8704
    ds_read_u16 v139, v8 offset:8960
    ds_read_u16 v140, v8 offset:9216
    ds_read_u16 v141, v8 offset:9472
    ds_read_u16 v142, v8 offset:9728
    ds_read_u16 v143, v8 offset:9984
    s_lshl_b32 s33, s40, 2
    s_add_u32 s33, s33, s3
    s_mul_i32 s33, s33, 18
    s_add_u32 s33, s33, s41
    s_lshl_b32 s33, s33, 12
    ds_read_u16 v144, v8 offset:16384
    ds_read_u16 v145, v8 offset:16640
    ds_read_u16 v146, v8 offset:16896
    ds_read_u16 v147, v8 offset:17152
    ds_read_u16 v148, v8 offset:17408
    ds_read_u16 v149, v8 offset:17664
    ds_read_u16 v150, v8 offset:17920
    ds_read_u16 v151, v8 offset:18176
    s_waitcnt lgkmcnt(8)
    v_lshl_or_b32 v32, v137, 16, v136
    v_lshl_or_b32 v33, v139, 16, v138
    v_lshl_or_b32 v34, v141, 16, v140
    v_lshl_or_b32 v35, v143, 16, v142
    buffer_store_dwordx4 v[32:35], v253, s[8:11], s33 offen offset:0 sc1
    ds_read_u16 v152, v8 offset:24576
    ds_read_u16 v153, v8 offset:24832
    ds_read_u16 v154, v8 offset:25088
    ds_read_u16 v155, v8 offset:25344
    ds_read_u16 v156, v8 offset:25600
    ds_read_u16 v157, v8 offset:25856
    ds_read_u16 v158, v8 offset:26112
    ds_read_u16 v159, v8 offset:26368
    s_waitcnt lgkmcnt(8)
    v_lshl_or_b32 v36, v145, 16, v144
    v_lshl_or_b32 v37, v147, 16, v146
    v_lshl_or_b32 v38, v149, 16, v148
    v_lshl_or_b32 v39, v151, 16, v150
    buffer_store_dwordx4 v[36:39], v253, s[8:11], s33 offen offset:1024 sc1
    ds_read_u16 v160, v10 offset:8224
    ds_read_u16 v161, v10 offset:8480
    ds_read_u16 v162, v10 offset:8736
    ds_read_u16 v163, v10 offset:8992
    ds_read_u16 v164, v10 offset:9248
    ds_read_u16 v165, v10 offset:9504
    ds_read_u16 v166, v10 offset:9760
    ds_read_u16 v167, v10 offset:10016
    s_waitcnt lgkmcnt(8)
    v_lshl_or_b32 v40, v153, 16, v152
    v_lshl_or_b32 v41, v155, 16, v154
    v_lshl_or_b32 v42, v157, 16, v156
    v_lshl_or_b32 v43, v159, 16, v158
    buffer_store_dwordx4 v[40:43], v253, s[8:11], s33 offen offset:2048 sc1
    s_waitcnt lgkmcnt(0)
    v_lshl_or_b32 v44, v161, 16, v160
    v_cndmask_b32 v44, 0, v44, s[22:23]
    v_lshl_or_b32 v45, v163, 16, v162
    v_cndmask_b32 v45, 0, v45, s[22:23]
    v_lshl_or_b32 v46, v165, 16, v164
    v_cndmask_b32 v46, 0, v46, s[22:23]
    v_lshl_or_b32 v47, v167, 16, v166
    v_cndmask_b32 v47, 0, v47, s[22:23]
    buffer_store_dwordx4 v[44:47], v253, s[8:11], s33 offen offset:3072 sc1
    s_branch L_prep_done_6
L_prep_o_4:
    s_cmp_ge_u32 s36, 54
    s_cbranch_scc1 L_prep_m_5
    v_lshrrev_b32 v8, 4, v0
    v_lshlrev_b32 v8, 3, v8
    v_bfe_u32 v9, v0, 2, 2
    v_add_u32 v8, v8, v9
    v_mul_u32_u24 v8, 128, v8
    v_and_b32 v9, 3, v0
    v_lshl_add_u32 v8, v9, 3, v8
    s_lshl_b32 s7, s3, 5
    v_add_u32 v8, s7, v8
    ds_read_b64_tr_b16 v[32:33], v8 offset:8192
    ds_read_b64_tr_b16 v[34:35], v8 offset:8704
    ds_read_b64_tr_b16 v[36:37], v8 offset:12288
    ds_read_b64_tr_b16 v[38:39], v8 offset:12800
    ds_read_b64_tr_b16 v[40:41], v8 offset:16384
    ds_read_b64_tr_b16 v[42:43], v8 offset:16896
    s_mul_i32 s34, s34, 12
    s_add_u32 s34, s34, s3
    s_mul_i32 s34, s34, 18
    s_add_u32 s34, s34, s33
    s_lshl_b32 s34, s34, 10
    s_add_u32 s7, s34, 2359296
    s_waitcnt lgkmcnt(4)
    buffer_store_dwordx4 v[32:35], v253, s[8:11], s7 offen sc1
    s_add_u32 s7, s34, 2433024
    s_waitcnt lgkmcnt(2)
    buffer_store_dwordx4 v[36:39], v253, s[8:11], s7 offen sc1
    s_add_u32 s7, s34, 2506752
    s_waitcnt lgkmcnt(0)
    buffer_store_dwordx4 v[40:43], v253, s[8:11], s7 offen sc1
    s_branch L_prep_done_6
L_prep_m_5:
    s_cmp_ge_u32 s37, 36
    s_cbranch_scc1 L_prep_done_6
    v_mov_b32 v28, 0x3f803f80
    v_mov_b32 v29, 0x3f803f80
    v_mov_b32 v30, 0x3f803f80
    v_mov_b32 v31, 0x3f803f80
    v_and_b32 v9, 15, v0
    v_cmp_eq_u32 vcc, 0, v9
    v_cmp_eq_u32 s[22:23], 1, v9
    v_mfma_f32_16x16x32_bf16 v[32:35], v[64:67], v[28:31], 0
    v_mfma_f32_16x16x32_bf16 v[32:35], v[68:71], v[28:31], v[32:35]
    v_mfma_f32_16x16x32_bf16 v[32:35], v[72:75], v[28:31], v[32:35]
    v_mfma_f32_16x16x32_bf16 v[32:35], v[76:79], v[28:31], v[32:35]
    v_mfma_f32_16x16x32_bf16 v[32:35], v[80:83], v[28:31], v[32:35]
    v_mfma_f32_16x16x32_bf16 v[32:35], v[84:87], v[28:31], v[32:35]
    v_mfma_f32_16x16x32_bf16 v[32:35], v[88:91], v[28:31], v[32:35]
    v_mfma_f32_16x16x32_bf16 v[32:35], v[92:95], v[28:31], v[32:35]
    v_mfma_f32_16x16x32_bf16 v[32:35], v[96:99], v[28:31], v[32:35]
    v_mfma_f32_16x16x32_bf16 v[32:35], v[100:103], v[28:31], v[32:35]
    v_mfma_f32_16x16x32_bf16 v[32:35], v[104:107], v[28:31], v[32:35]
    v_mfma_f32_16x16x32_bf16 v[32:35], v[108:111], v[28:31], v[32:35]
    v_mfma_f32_16x16x32_bf16 v[32:35], v[112:115], v[28:31], v[32:35]
    v_mfma_f32_16x16x32_bf16 v[32:35], v[116:119], v[28:31], v[32:35]
    v_mfma_f32_16x16x32_bf16 v[32:35], v[120:123], v[28:31], v[32:35]
    v_mfma_f32_16x16x32_bf16 v[32:35], v[124:127], v[28:31], v[32:35]
    v_mfma_f32_16x16x32_bf16 v[32:35], v[128:131], v[28:31], v[32:35]
    v_mfma_f32_16x16x32_bf16 v[32:35], v[132:135], v[28:31], v[32:35]
    v_lshrrev_b32 v10, 5, v0
    v_lshlrev_b32 v10, 8, v10
    v_lshl_add_u32 v10, v9, 4, v10
    v_bfe_u32 v9, v0, 4, 1
    v_lshl_add_u32 v10, v9, 3, v10
    s_lshl_b32 s7, s37, 9
    s_add_u32 s7, s7, 3022848
    s_nop 0
    v_mul_f32 v32, 0x3ae38e39, v32
    v_mul_f32 v33, 0x3ae38e39, v33
    v_mul_f32 v34, 0x3ae38e39, v34
    v_mul_f32 v35, 0x3ae38e39, v35
    v_cvt_pk_bf16_f32 v36, v32, v33
    v_cvt_pk_bf16_f32 v37, v34, v35
    v_lshlrev_b32 v38, 16, v36
    v_and_b32 v39, s16, v36
    v_sub_f32 v38, v32, v38
    v_sub_f32 v39, v33, v39
    v_cvt_pk_bf16_f32 v28, v38, v39
    v_cndmask_b32 v28, 0, v28, s[22:23]
    v_cndmask_b32 v28, v28, v36, vcc
    v_lshlrev_b32 v38, 16, v37
    v_and_b32 v39, s16, v37
    v_sub_f32 v38, v34, v38
    v_sub_f32 v39, v35, v39
    v_cvt_pk_bf16_f32 v29, v38, v39
    v_cndmask_b32 v29, 0, v29, s[22:23]
    v_cndmask_b32 v29, v29, v37, vcc
    buffer_store_dwordx2 v[28:29], v10, s[8:11], s7 offen sc1
L_prep_done_6:
    s_add_u32 s19, s18, 43515904
    s_add_u32 s20, s18, 38797312
    s_lshl_b32 s22, s21, 7
    s_add_u32 s22, s22, 48234496
    buffer_store_dwordx4 v[16:19], v172, s[8:11], s19 offen sc1
    buffer_store_dwordx4 v[20:23], v173, s[8:11], s19 offen sc1
    buffer_store_dwordx4 v[24:27], v174, s[8:11], s19 offen sc1
    s_mov_b32 s17, 0x3f803f80
    v_mov_b32 v8, 0
    v_mov_b32 v9, 0
    v_mov_b32 v10, 0
    v_mov_b32 v11, 0
    v_dot2c_f32_bf16 v8, s17, v16
    v_dot2c_f32_bf16 v9, v16, v16
    v_dot2c_f32_bf16 v10, s17, v17
    v_dot2c_f32_bf16 v11, v17, v17
    v_dot2c_f32_bf16 v8, s17, v18
    v_dot2c_f32_bf16 v9, v18, v18
    v_dot2c_f32_bf16 v10, s17, v19
    v_dot2c_f32_bf16 v11, v19, v19
    v_dot2c_f32_bf16 v8, s17, v20
    v_dot2c_f32_bf16 v9, v20, v20
    v_dot2c_f32_bf16 v10, s17, v21
    v_dot2c_f32_bf16 v11, v21, v21
    v_dot2c_f32_bf16 v8, s17, v22
    v_dot2c_f32_bf16 v9, v22, v22
    v_dot2c_f32_bf16 v10, s17, v23
    v_dot2c_f32_bf16 v11, v23, v23
    v_dot2c_f32_bf16 v8, s17, v24
    v_dot2c_f32_bf16 v9, v24, v24
    v_dot2c_f32_bf16 v10, s17, v25
    v_dot2c_f32_bf16 v11, v25, v25
    v_dot2c_f32_bf16 v8, s17, v26
    v_dot2c_f32_bf16 v9, v26, v26
    v_dot2c_f32_bf16 v10, s17, v27
    v_dot2c_f32_bf16 v11, v27, v27
    v_and_b32 v12, 7, v0
    v_lshlrev_b32 v12, 3, v12
    s_lshl_b32 s7, s3, 6
    v_add_u32 v13, s7, v12
    v_pk_add_f32 v[8:9], v[8:9], v[10:11]
    s_nop 1
    v_add_f32_dpp v8, v8, v8 row_ror:8 row_mask:0xf bank_mask:0xf
    v_add_f32_dpp v9, v9, v9 row_ror:8 row_mask:0xf bank_mask:0xf
    v_mov_b32 v10, v8
    v_mov_b32 v11, v9
    s_nop 1
    v_permlane32_swap_b32 v10, v8
    v_permlane32_swap_b32 v11, v9
    v_add_f32 v8, v8, v10
    v_add_f32 v9, v9, v11
    v_mov_b32 v10, v8
    v_mov_b32 v11, v9
    s_nop 1
    v_permlane16_swap_b32 v10, v8
    v_permlane16_swap_b32 v11, v9
    v_add_f32 v8, v8, v10
    v_add_f32 v9, v9, v11
    ds_write_b64 v13, v[8:9]
    s_waitcnt lgkmcnt(0)
    s_barrier
    ds_read_b64 v[40:41], v12 offset:0
    ds_read_b64 v[42:43], v12 offset:64
    ds_read_b64 v[44:45], v12 offset:128
    ds_read_b64 v[46:47], v12 offset:192
    s_waitcnt lgkmcnt(0)
    v_pk_add_f32 v[40:41], v[40:41], v[42:43]
    v_pk_add_f32 v[44:45], v[44:45], v[46:47]
    v_pk_add_f32 v[8:9], v[40:41], v[44:45]
    v_mul_f32 v8, 0x3ae38e39, v8
    v_mul_f32 v9, 0x3ae38e39, v9
    v_fma_f32 v9, -v8, v8, v9
    v_max_f32 v9, 0, v9
    v_add_f32 v9, 0x3727c5ac, v9
    v_rsq_f32 v10, v9
    s_nop 0
    v_mul_f32 v12, v8, v10
    v_mov_b32 v11, v10
    v_sub_f32 v12, 0, v12
    v_mov_b32 v13, v12
    s_cmp_eq_u32 s3, 0
    s_cselect_b32 s7, 32, 0
    v_lshlrev_b32 v14, 2, v0
    v_cmp_gt_u32 vcc, s7, v0
    v_mov_b32 v9, 1073741824
    s_nop 0
    v_cndmask_b32 v14, v9, v14, vcc
    buffer_store_dword v8, v14, s[8:11], s22 offen sc1
    v_lshlrev_b32 v40, 16, v16
    v_and_b32 v41, s16, v16
    v_lshlrev_b32 v42, 16, v17
    v_and_b32 v43, s16, v17
    v_lshlrev_b32 v44, 16, v18
    v_and_b32 v45, s16, v18
    v_lshlrev_b32 v46, 16, v19
    v_and_b32 v47, s16, v19
    v_pk_fma_f32 v[40:41], v[40:41], v[10:11], v[12:13]
    v_pk_fma_f32 v[42:43], v[42:43], v[10:11], v[12:13]
    v_pk_fma_f32 v[44:45], v[44:45], v[10:11], v[12:13]
    v_pk_fma_f32 v[46:47], v[46:47], v[10:11], v[12:13]
    v_cvt_pk_bf16_f32 v48, v40, v41
    v_cvt_pk_bf16_f32 v49, v42, v43
    v_cvt_pk_bf16_f32 v50, v44, v45
    v_cvt_pk_bf16_f32 v51, v46, v47
    v_lshlrev_b32 v40, 16, v20
    v_and_b32 v41, s16, v20
    v_lshlrev_b32 v42, 16, v21
    v_and_b32 v43, s16, v21
    v_lshlrev_b32 v44, 16, v22
    v_and_b32 v45, s16, v22
    v_lshlrev_b32 v46, 16, v23
    v_and_b32 v47, s16, v23
    v_pk_fma_f32 v[40:41], v[40:41], v[10:11], v[12:13]
    v_pk_fma_f32 v[42:43], v[42:43], v[10:11], v[12:13]
    v_pk_fma_f32 v[44:45], v[44:45], v[10:11], v[12:13]
    v_pk_fma_f32 v[46:47], v[46:47], v[10:11], v[12:13]
    v_cvt_pk_bf16_f32 v52, v40, v41
    v_cvt_pk_bf16_f32 v53, v42, v43
    v_cvt_pk_bf16_f32 v54, v44, v45
    v_cvt_pk_bf16_f32 v55, v46, v47
    v_lshlrev_b32 v40, 16, v24
    v_and_b32 v41, s16, v24
    v_lshlrev_b32 v42, 16, v25
    v_and_b32 v43, s16, v25
    v_lshlrev_b32 v44, 16, v26
    v_and_b32 v45, s16, v26
    v_lshlrev_b32 v46, 16, v27
    v_and_b32 v47, s16, v27
    v_pk_fma_f32 v[40:41], v[40:41], v[10:11], v[12:13]
    v_pk_fma_f32 v[42:43], v[42:43], v[10:11], v[12:13]
    v_pk_fma_f32 v[44:45], v[44:45], v[10:11], v[12:13]
    v_pk_fma_f32 v[46:47], v[46:47], v[10:11], v[12:13]
    v_cvt_pk_bf16_f32 v56, v40, v41
    v_cvt_pk_bf16_f32 v57, v42, v43
    v_cvt_pk_bf16_f32 v58, v44, v45
    v_cvt_pk_bf16_f32 v59, v46, v47
    buffer_store_dwordx4 v[48:51], v172, s[8:11], s20 offen sc1
    buffer_store_dwordx4 v[52:55], v173, s[8:11], s20 offen sc1
    buffer_store_dwordx4 v[56:59], v174, s[8:11], s20 offen sc1
    v_lshlrev_b32 v15, 7, v0
    s_lshl_b32 s6, s40, 2
    s_add_u32 s6, s6, s44
    s_sub_u32 s6, s6, 32768
    v_mov_b32 v1, s76
    s_mov_b64 vcc, 0xff
    v_lshrrev_b32 v14, 3, v0
    v_lshl_add_u32 v15, v14, 3, v15
    s_cmp_ge_u32 s40, 6
    s_cselect_b32 s7, s41, 31
    s_cmp_lt_u32 s7, 31
    s_cmov_b64 vcc, 0xffff
    s_waitcnt vmcnt(0)
    s_barrier
    s_cmp_lg_u32 s3, 0
    s_cbranch_scc1 L_pub_7
    s_mov_b64 exec, vcc
    buffer_store_dword v1, v15, s[8:11], s6 offen sc1
    v_lshlrev_b32 v15, 10, v0
    s_lshl_b32 s6, s40, 7
    s_lshl_b32 s7, s41, 2
    s_add_u32 s6, s6, s7
    s_add_u32 s6, s6, 19431424
    s_mov_b64 exec, 0xffffffff
    v_lshlrev_b32 v15, 10, v0
    v_mov_b32 v1, s76
    buffer_store_dword v1, v15, s[8:11], s6 offen sc1
    s_cmp_lt_u32 s41, 18
    s_cbranch_scc1 L_pub_7
    s_lshl_b32 s6, s36, 2
    s_add_u32 s6, s6, 19496960
    s_mov_b64 exec, 1
    buffer_store_dword v1, off, s[8:11], s6 sc1
L_pub_7:
    s_mov_b64 exec, -1
    s_add_u32 m0, s79, 3072
    s_add_u32 s71, s71, s92
    buffer_load_dwordx4 v224, s[72:75], s71 offen nt lds
    s_add_u32 m0, s79, 4096
    s_mov_b32 s71, s81
    buffer_load_dwordx4 v224, s[72:75], s71 offen nt lds
    s_add_u32 m0, s79, 5120
    s_add_u32 s71, s71, s92
    buffer_load_dwordx4 v224, s[72:75], s71 offen nt lds
    s_add_u32 m0, s79, 6144
    s_add_u32 s71, s71, s92
    buffer_load_dwordx4 v224, s[72:75], s71 offen nt lds
    s_add_u32 m0, s79, 7168
    s_add_u32 s71, s71, s92
    buffer_load_dwordx4 v224, s[72:75], s71 offen nt lds
    s_add_u32 m0, s79, 8192
    s_mov_b32 s71, s82
    buffer_load_dwordx4 v224, s[72:75], s71 offen nt lds
    s_add_u32 m0, s79, 9216
    s_add_u32 s71, s71, s92
    buffer_load_dwordx4 v224, s[72:75], s71 offen nt lds
    s_add_u32 m0, s79, 10240
    s_add_u32 s71, s71, s92
    buffer_load_dwordx4 v224, s[72:75], s71 offen nt lds
    s_add_u32 m0, s79, 11264
    s_add_u32 s71, s71, s92
    buffer_load_dwordx4 v224, s[72:75], s71 offen nt lds
    s_add_u32 m0, s79, 12288
    s_mov_b32 s71, s83
    buffer_load_dwordx4 v224, s[72:75], s71 offen nt lds
    s_add_u32 m0, s79, 13312
    s_add_u32 s71, s71, s92
    buffer_load_dwordx4 v224, s[72:75], s71 offen nt lds
    s_add_u32 m0, s79, 14336
    s_add_u32 s71, s71, s92
    buffer_load_dwordx4 v224, s[72:75], s71 offen nt lds
    s_add_u32 m0, s79, 15360
    s_add_u32 s71, s71, s92
    buffer_load_dwordx4 v224, s[72:75], s71 offen nt lds
    s_cmp_lg_u32 s3, 0
    s_cbranch_scc1 L_wq_ready_8
    s_lshl_b32 s7, s41, 3
    s_add_u32 s7, s7, s40
    s_lshl_b32 s7, s7, 7
    s_add_u32 s7, s7, 19431424
    s_add_u32 s68, s4, s7
    s_addc_u32 s69, s5, 0
    s_mov_b32 s6, 0
    s_mov_b32 s7, 0
L_cpoll_9:
    s_load_dwordx16 s[52:67], s[68:69], s7 glc
    s_add_u32 s6, s6, 1
    s_waitcnt lgkmcnt(0)
    s_xor_b64 s[52:53], s[52:53], s[76:77]
    s_xor_b64 s[54:55], s[54:55], s[76:77]
    s_xor_b64 s[56:57], s[56:57], s[76:77]
    s_xor_b64 s[58:59], s[58:59], s[76:77]
    s_xor_b64 s[60:61], s[60:61], s[76:77]
    s_xor_b64 s[62:63], s[62:63], s[76:77]
    s_xor_b64 s[64:65], s[64:65], s[76:77]
    s_xor_b64 s[66:67], s[66:67], s[76:77]
    s_or_b64 s[52:53], s[52:53], s[60:61]
    s_or_b64 s[54:55], s[54:55], s[62:63]
    s_or_b64 s[56:57], s[56:57], s[64:65]
    s_or_b64 s[58:59], s[58:59], s[66:67]
    s_or_b64 s[52:53], s[52:53], s[56:57]
    s_or_b64 s[54:55], s[54:55], s[58:59]
    s_or_b64 s[52:53], s[52:53], s[54:55]
    s_cbranch_scc1 L_cpoll_10
    s_add_u32 s7, s7, 64
    s_cmp_eq_u32 s7, 128
    s_cbranch_scc1 L_cpolled_11
L_cpoll_10:
    s_cmp_lt_u32 s6, 1048576
    s_cbranch_scc1 L_cpoll_9
    s_branch L_main_end
L_cpolled_11:
L_wq_ready_8:
    s_barrier
    s_lshl_b32 s28, s40, 2
    s_add_u32 s28, s28, s3
    s_mul_i32 s28, s28, 73728
    buffer_load_dwordx4 a[0:3], v253, s[8:11], s28 offen offset:0 sc1
    buffer_load_dwordx4 a[4:7], v253, s[8:11], s28 offen offset:1024 sc1
    buffer_load_dwordx4 a[8:11], v253, s[8:11], s28 offen offset:2048 sc1
    buffer_load_dwordx4 a[12:15], v253, s[8:11], s28 offen offset:3072 sc1
    s_add_u32 s28, s28, 4096
    buffer_load_dwordx4 a[16:19], v253, s[8:11], s28 offen offset:0 sc1
    buffer_load_dwordx4 a[20:23], v253, s[8:11], s28 offen offset:1024 sc1
    buffer_load_dwordx4 a[24:27], v253, s[8:11], s28 offen offset:2048 sc1
    buffer_load_dwordx4 a[28:31], v253, s[8:11], s28 offen offset:3072 sc1
    s_add_u32 s28, s28, 4096
    buffer_load_dwordx4 a[32:35], v253, s[8:11], s28 offen offset:0 sc1
    buffer_load_dwordx4 a[36:39], v253, s[8:11], s28 offen offset:1024 sc1
    buffer_load_dwordx4 a[40:43], v253, s[8:11], s28 offen offset:2048 sc1
    buffer_load_dwordx4 a[44:47], v253, s[8:11], s28 offen offset:3072 sc1
    s_add_u32 s28, s28, 4096
    buffer_load_dwordx4 a[48:51], v253, s[8:11], s28 offen offset:0 sc1
    buffer_load_dwordx4 a[52:55], v253, s[8:11], s28 offen offset:1024 sc1
    buffer_load_dwordx4 a[56:59], v253, s[8:11], s28 offen offset:2048 sc1
    buffer_load_dwordx4 a[60:63], v253, s[8:11], s28 offen offset:3072 sc1
    s_add_u32 s28, s28, 4096
    buffer_load_dwordx4 a[64:67], v253, s[8:11], s28 offen offset:0 sc1
    buffer_load_dwordx4 a[68:71], v253, s[8:11], s28 offen offset:1024 sc1
    buffer_load_dwordx4 a[72:75], v253, s[8:11], s28 offen offset:2048 sc1
    buffer_load_dwordx4 a[76:79], v253, s[8:11], s28 offen offset:3072 sc1
    s_add_u32 s28, s28, 4096
    buffer_load_dwordx4 a[80:83], v253, s[8:11], s28 offen offset:0 sc1
    buffer_load_dwordx4 a[84:87], v253, s[8:11], s28 offen offset:1024 sc1
    buffer_load_dwordx4 a[88:91], v253, s[8:11], s28 offen offset:2048 sc1
    buffer_load_dwordx4 a[92:95], v253, s[8:11], s28 offen offset:3072 sc1
    s_add_u32 s28, s28, 4096
L_main_layer:
    buffer_load_dwordx4 a[96:99], v253, s[8:11], s28 offen offset:0 sc1
    buffer_load_dwordx4 a[100:103], v253, s[8:11], s28 offen offset:1024 sc1
    buffer_load_dwordx4 a[104:107], v253, s[8:11], s28 offen offset:2048 sc1
    buffer_load_dwordx4 a[108:111], v253, s[8:11], s28 offen offset:3072 sc1
    s_add_u32 s28, s28, 4096
    buffer_load_dwordx4 a[112:115], v253, s[8:11], s28 offen offset:0 sc1
    buffer_load_dwordx4 a[116:119], v253, s[8:11], s28 offen offset:1024 sc1
    buffer_load_dwordx4 a[120:123], v253, s[8:11], s28 offen offset:2048 sc1
    buffer_load_dwordx4 a[124:127], v253, s[8:11], s28 offen offset:3072 sc1
    s_add_u32 s28, s28, 4096
    buffer_load_dwordx4 a[128:131], v253, s[8:11], s28 offen offset:0 sc1
    buffer_load_dwordx4 a[132:135], v253, s[8:11], s28 offen offset:1024 sc1
    buffer_load_dwordx4 a[136:139], v253, s[8:11], s28 offen offset:2048 sc1
    buffer_load_dwordx4 a[140:143], v253, s[8:11], s28 offen offset:3072 sc1
    s_add_u32 s28, s28, 4096
    v_bfe_u32 v3, v0, 3, 1
    v_mul_u32_u24 v2, 9216, v3
    v_lshrrev_b32 v3, 4, v0
    v_lshl_add_u32 v2, v3, 7, v2
    v_and_b32 v3, 7, v0
    v_lshl_add_u32 v2, v3, 4, v2
    v_bfe_u32 v3, v0, 3, 2
    s_mov_b32 s7, 9216
    v_mul_lo_u32 v9, v3, s7
    v_lshrrev_b32 v3, 5, v0
    v_lshl_add_u32 v9, v3, 7, v9
    v_and_b32 v3, 7, v0
    v_lshl_add_u32 v9, v3, 4, v9
    s_mul_i32 s22, s41, 73728
    s_add_u32 s22, s22, s43
    s_add_u32 s23, s22, 38797312
    s_mul_i32 s7, s3, 18432
    s_add_u32 s24, s23, s7
    s_cmp_eq_u32 s41, 0
    s_cselect_b32 s7, 0, 18432
    s_sub_u32 s23, s23, s7
    s_lshl_b32 s25, s3, 10
    s_add_u32 s25, s25, 1024
    s_mul_i32 s26, s3, 5120
    s_lshl_b32 s7, s3, 9
    s_add_u32 s27, s23, s7
    s_and_b32 s7, s3, 1
    s_add_u32 s7, s7, 4
    s_mul_i32 s29, s7, 5120
    s_lshl_b32 s7, s7, 9
    s_add_u32 s23, s23, s7
    s_cmp_lg_u32 s3, 3
    s_cbranch_scc1 L_pollout_14
    s_lshl_b32 s7, s40, 7
    s_add_u32 s7, s7, s44
    s_sub_u32 s7, s7, 32768
    s_add_u32 s52, s4, s7
    s_addc_u32 s53, s5, 0
    s_cmp_eq_u32 s41, 0
    s_cselect_b32 s7, 0, 32
    s_mov_b32 s6, 0
L_poll_12:
    s_load_dwordx8 s[56:63], s[52:53], 0 glc
    s_load_dwordx2 s[54:55], s[52:53], s7 glc
    s_add_u32 s6, s6, 1
    s_waitcnt lgkmcnt(0)
    s_xor_b64 s[54:55], s[54:55], s[76:77]
    s_xor_b64 s[56:57], s[56:57], s[76:77]
    s_xor_b64 s[58:59], s[58:59], s[76:77]
    s_xor_b64 s[60:61], s[60:61], s[76:77]
    s_xor_b64 s[62:63], s[62:63], s[76:77]
    s_or_b64 s[56:57], s[56:57], s[58:59]
    s_or_b64 s[60:61], s[60:61], s[62:63]
    s_or_b64 s[56:57], s[56:57], s[54:55]
    s_or_b64 s[56:57], s[56:57], s[60:61]
    s_cbranch_scc0 L_polled_13
    s_cmp_lt_u32 s6, 1048576
    s_cbranch_scc1 L_poll_12
    s_branch L_main_end
L_polled_13:
L_pollout_14:
    s_barrier
    s_add_u32 m0, s25, 0
    s_nop 0
    buffer_load_dwordx4 v2, s[8:11], s24 offen offset:0 sc1 lds
    s_add_u32 m0, s25, 4608
    s_nop 0
    buffer_load_dwordx4 v2, s[8:11], s24 offen offset:512 sc1 lds
    s_add_u32 m0, s25, 9216
    s_nop 0
    buffer_load_dwordx4 v2, s[8:11], s24 offen offset:1024 sc1 lds
    s_add_u32 m0, s25, 13824
    s_nop 0
    buffer_load_dwordx4 v2, s[8:11], s24 offen offset:1536 sc1 lds
    s_add_u32 m0, s25, 18432
    s_nop 0
    buffer_load_dwordx4 v2, s[8:11], s24 offen offset:2048 sc1 lds
    s_add_u32 m0, s25, 23040
    s_nop 0
    buffer_load_dwordx4 v2, s[8:11], s24 offen offset:2560 sc1 lds
    s_add_u32 m0, s26, 0
    s_add_u32 s7, s27, 0
    buffer_load_dwordx4 v2, s[8:11], s7 offen sc1 lds
    s_add_u32 m0, s29, 0
    s_add_u32 s7, s23, 0
    buffer_load_dwordx4 v2, s[8:11], s7 offen sc1 lds
    v_mov_b32 v132, 0
    v_mov_b32 v133, 0
    v_mov_b32 v192, 0
    v_mov_b32 v193, 0
    v_mov_b32 v195, 0
    v_mov_b32 v135, 0
    v_mov_b32 v139, 0
    v_mov_b32 v143, 0
    v_mov_b32 v147, 0
    v_mov_b32 v151, 0
    v_mov_b32 v155, 0
    v_mov_b32 v159, 0
    v_mov_b32 v163, 0
    v_mov_b32 v167, 0
    v_mov_b32 v171, 0
    v_cmp_eq_u32 vcc, 16, v0
    v_mov_b32 v10, 0x3f80
    v_cmp_eq_u32 s[20:21], 17, v0
    v_cndmask_b32 v194, 0, v10, vcc
    v_and_b32 v11, 3, v0
    v_cndmask_b32 v194, v194, 1.0, s[20:21]
    v_cmp_eq_u32 vcc, 2, v11
    v_and_b32 v10, 15, v0
    v_lshrrev_b32 v11, 4, v0
    v_cndmask_b32 v196, 0, 1.0, vcc
    v_cndmask_b32 v197, 0, 1.0, vcc
    v_cndmask_b32 v198, 0, 1.0, vcc
    v_cndmask_b32 v199, 0, 1.0, vcc
    v_lshlrev_b32 v11, 2, v11
    v_sub_u32 v10, v11, v10
    v_mov_b32 v12, 0xf149f2ca
    s_cmp_eq_u32 s41, 0
    s_cselect_b64 s[38:39], 0, -1
    v_add_u32 v11, 0, v10
    v_and_b32 v13, 1, v11
    v_cmp_eq_u32 s[20:21], 0, v13
    v_cmp_lt_i32 vcc, 1, v11
    v_cmp_gt_i32 s[18:19], 1, v11
    s_and_b64 vcc, vcc, s[20:21]
    s_and_b64 s[18:19], s[18:19], s[20:21]
    s_and_b64 s[20:21], vcc, s[38:39]
    v_cndmask_b32 v200, v12, 0, vcc
    v_cndmask_b32 v204, v12, 0, s[18:19]
    v_cndmask_b32 v208, v12, 0, s[20:21]
    v_add_u32 v11, 1, v10
    v_and_b32 v13, 1, v11
    v_cmp_eq_u32 s[20:21], 0, v13
    v_cmp_lt_i32 vcc, 1, v11
    v_cmp_gt_i32 s[18:19], 1, v11
    s_and_b64 vcc, vcc, s[20:21]
    s_and_b64 s[18:19], s[18:19], s[20:21]
    s_and_b64 s[20:21], vcc, s[38:39]
    v_cndmask_b32 v201, v12, 0, vcc
    v_cndmask_b32 v205, v12, 0, s[18:19]
    v_cndmask_b32 v209, v12, 0, s[20:21]
    v_add_u32 v11, 2, v10
    v_and_b32 v13, 1, v11
    v_cmp_eq_u32 s[20:21], 0, v13
    v_cmp_lt_i32 vcc, 1, v11
    v_cmp_gt_i32 s[18:19], 1, v11
    s_and_b64 vcc, vcc, s[20:21]
    s_and_b64 s[18:19], s[18:19], s[20:21]
    s_and_b64 s[20:21], vcc, s[38:39]
    v_cndmask_b32 v202, v12, 0, vcc
    v_cndmask_b32 v206, v12, 0, s[18:19]
    v_cndmask_b32 v210, v12, 0, s[20:21]
    v_add_u32 v11, 3, v10
    v_and_b32 v13, 1, v11
    v_cmp_eq_u32 s[20:21], 0, v13
    v_cmp_lt_i32 vcc, 1, v11
    v_cmp_gt_i32 s[18:19], 1, v11
    s_and_b64 vcc, vcc, s[20:21]
    s_and_b64 s[18:19], s[18:19], s[20:21]
    s_and_b64 s[20:21], vcc, s[38:39]
    v_cndmask_b32 v203, v12, 0, vcc
    v_cndmask_b32 v207, v12, 0, s[18:19]
    v_cndmask_b32 v211, v12, 0, s[20:21]
    s_lshl_b32 s45, s41, 1
    s_lshr_b32 s7, s40, 2
    s_add_u32 s45, s45, s7
    s_mul_i32 s30, s45, 36864
    s_add_u32 s30, s30, s43
    s_and_b32 s31, s40, 3
    s_mul_i32 s31, s31, 9
    s_add_u32 s31, s31, s3
    s_mul_i32 s32, s31, 18432
    s_add_u32 s32, s32, 2359296
    s_add_u32 s33, s32, 73728
    s_add_u32 s34, s32, 147456
    s_mov_b32 s39, 19496960
    v_min_u32 v228, 44, v0
    v_lshlrev_b32 v228, 3, v228
    s_cmp_eq_u32 s3, 1
    s_cmov_b32 s34, 3022848
    s_cmp_lt_u32 s3, 2
    s_cselect_b32 s35, 0, 1073741824
    v_add_u32 v5, s35, v253
    s_cmp_eq_u32 s3, 0
    s_cselect_b32 s35, 0, 1073741824
    v_add_u32 v7, s35, v9
    s_lshl_b32 s7, s31, 8
    s_add_u32 s36, s30, s7
    s_add_u32 s37, s36, 43515904
    s_add_u32 s46, s36, 45875200
    s_lshl_b32 s36, s45, 7
    s_add_u32 s36, s36, s43
    s_add_u32 s36, s36, 48431104
    s_lshl_b32 s47, s45, 9
    s_add_u32 s47, s47, s43
    s_add_u32 s47, s47, 48234496
    v_bfe_u32 v10, v0, 3, 2
    v_and_b32 v8, 7, v0
    v_lshlrev_b32 v8, 2, v8
    v_lshl_add_u32 v8, v10, 7, v8
    v_add_u32 v6, 46080, v253
    s_waitcnt vmcnt(0)
    s_barrier
    ds_read_b128 v[16:19], v253 offset:0
    ds_read_b128 v[20:23], v253 offset:1024
    ds_read_b128 v[24:27], v253 offset:2048
    ds_read_b128 v[28:31], v253 offset:3072
    ds_read_b128 v[32:35], v253 offset:4096
    s_waitcnt lgkmcnt(0)
    v_mfma_f32_16x16x32_bf16 v[56:59], a[0:3], v[20:23], 0
    ds_read_b128 v[36:39], v253 offset:5120
    v_mfma_f32_16x16x32_bf16 v[60:63], a[0:3], v[24:27], 0
    ds_read_b128 v[40:43], v253 offset:6144
    v_mfma_f32_16x16x32_bf16 v[64:67], a[0:3], v[28:31], 0
    ds_read_b128 v[44:47], v253 offset:7168
    v_mfma_f32_16x16x32_bf16 v[68:71], a[0:3], v[32:35], 0
    ds_read_b128 v[48:51], v253 offset:8192
    v_mfma_f32_16x16x32_bf16 v[72:75], a[4:7], v[16:19], 0
    ds_read_b128 v[52:55], v253 offset:9216
    v_mfma_f32_16x16x32_bf16 v[76:79], a[4:7], v[20:23], 0
    s_add_u32 m0, s25, 27648
    s_nop 0
    buffer_load_dwordx4 v2, s[8:11], s24 offen offset:3072 sc1 lds
    v_mfma_f32_16x16x32_bf16 v[80:83], a[4:7], v[24:27], 0
    v_mfma_f32_16x16x32_bf16 v[84:87], a[4:7], v[28:31], 0
    s_add_u32 m0, s25, 32256
    s_nop 0
    buffer_load_dwordx4 v2, s[8:11], s24 offen offset:3584 sc1 lds
    v_mfma_f32_16x16x32_bf16 v[88:91], a[4:7], v[32:35], 0
    v_mfma_f32_16x16x32_bf16 v[92:95], v[16:19], a[8:11], 0
    buffer_load_dwordx4 a[144:147], v253, s[8:11], s28 offen offset:0 sc1
    v_mfma_f32_16x16x32_bf16 v[96:99], v[20:23], a[8:11], 0
    v_mfma_f32_16x16x32_bf16 v[100:103], v[24:27], a[8:11], 0
    buffer_load_dwordx4 a[148:151], v253, s[8:11], s28 offen offset:1024 sc1
    v_mfma_f32_16x16x32_bf16 v[104:107], v[28:31], a[8:11], 0
    v_mfma_f32_16x16x32_bf16 v[108:111], v[32:35], a[8:11], 0
    buffer_load_dwordx4 a[152:155], v253, s[8:11], s28 offen offset:2048 sc1
    v_mfma_f32_16x16x32_bf16 v[112:115], a[12:15], v[16:19], 0
    v_mfma_f32_16x16x32_bf16 v[116:119], a[12:15], v[20:23], 0
    v_mfma_f32_16x16x32_bf16 v[120:123], a[12:15], v[24:27], 0
    v_mfma_f32_16x16x32_bf16 v[124:127], a[12:15], v[28:31], 0
    v_mfma_f32_16x16x32_bf16 v[128:131], a[12:15], v[32:35], 0
    s_waitcnt lgkmcnt(0)
    v_mfma_f32_16x16x32_bf16 v[56:59], a[16:19], v[40:43], v[56:59]
    ds_read_b128 v[16:19], v253 offset:10240
    v_mfma_f32_16x16x32_bf16 v[60:63], a[16:19], v[44:47], v[60:63]
    ds_read_b128 v[20:23], v253 offset:11264
    v_mfma_f32_16x16x32_bf16 v[64:67], a[16:19], v[48:51], v[64:67]
    ds_read_b128 v[24:27], v253 offset:12288
    v_mfma_f32_16x16x32_bf16 v[68:71], a[16:19], v[52:55], v[68:71]
    ds_read_b128 v[28:31], v253 offset:13312
    v_mfma_f32_16x16x32_bf16 v[72:75], a[20:23], v[36:39], v[72:75]
    ds_read_b128 v[32:35], v253 offset:14336
    v_mfma_f32_16x16x32_bf16 v[76:79], a[20:23], v[40:43], v[76:79]
    s_add_u32 m0, s25, 40960
    s_add_u32 s24, s24, 4096
    buffer_load_dwordx4 v2, s[8:11], s24 offen offset:0 sc1 lds
    v_mfma_f32_16x16x32_bf16 v[80:83], a[20:23], v[44:47], v[80:83]
    v_mfma_f32_16x16x32_bf16 v[84:87], a[20:23], v[48:51], v[84:87]
    s_add_u32 m0, s25, 45568
    s_nop 0
    buffer_load_dwordx4 v2, s[8:11], s24 offen offset:512 sc1 lds
    v_mfma_f32_16x16x32_bf16 v[88:91], a[20:23], v[52:55], v[88:91]
    v_mfma_f32_16x16x32_bf16 v[92:95], v[36:39], a[24:27], v[92:95]
    buffer_load_dwordx4 a[156:159], v253, s[8:11], s28 offen offset:3072 sc1
    s_add_u32 s28, s28, 4096
    v_mfma_f32_16x16x32_bf16 v[96:99], v[40:43], a[24:27], v[96:99]
    v_mfma_f32_16x16x32_bf16 v[100:103], v[44:47], a[24:27], v[100:103]
    buffer_load_dwordx4 a[0:3], v253, s[8:11], s28 offen offset:0 sc1
    v_mfma_f32_16x16x32_bf16 v[104:107], v[48:51], a[24:27], v[104:107]
    v_mfma_f32_16x16x32_bf16 v[108:111], v[52:55], a[24:27], v[108:111]
    buffer_load_dwordx4 a[4:7], v253, s[8:11], s28 offen offset:1024 sc1
    v_mfma_f32_16x16x32_bf16 v[112:115], a[28:31], v[36:39], v[112:115]
    v_mfma_f32_16x16x32_bf16 v[116:119], a[28:31], v[40:43], v[116:119]
    v_mfma_f32_16x16x32_bf16 v[120:123], a[28:31], v[44:47], v[120:123]
    v_mfma_f32_16x16x32_bf16 v[124:127], a[28:31], v[48:51], v[124:127]
    v_mfma_f32_16x16x32_bf16 v[128:131], a[28:31], v[52:55], v[128:131]
    s_waitcnt lgkmcnt(0)
    v_mfma_f32_16x16x32_bf16 v[56:59], a[32:35], v[20:23], v[56:59]
    ds_read_b128 v[36:39], v253 offset:15360
    v_mfma_f32_16x16x32_bf16 v[60:63], a[32:35], v[24:27], v[60:63]
    ds_read_b128 v[40:43], v253 offset:16384
    v_mfma_f32_16x16x32_bf16 v[64:67], a[32:35], v[28:31], v[64:67]
    ds_read_b128 v[44:47], v253 offset:17408
    v_mfma_f32_16x16x32_bf16 v[68:71], a[32:35], v[32:35], v[68:71]
    ds_read_b128 v[48:51], v253 offset:18432
    v_mfma_f32_16x16x32_bf16 v[72:75], a[36:39], v[16:19], v[72:75]
    ds_read_b128 v[52:55], v253 offset:19456
    v_mfma_f32_16x16x32_bf16 v[76:79], a[36:39], v[20:23], v[76:79]
    s_add_u32 m0, s25, 50176
    s_nop 0
    buffer_load_dwordx4 v2, s[8:11], s24 offen offset:1024 sc1 lds
    v_mfma_f32_16x16x32_bf16 v[80:83], a[36:39], v[24:27], v[80:83]
    v_mfma_f32_16x16x32_bf16 v[84:87], a[36:39], v[28:31], v[84:87]
    s_add_u32 m0, s25, 54784
    s_nop 0
    buffer_load_dwordx4 v2, s[8:11], s24 offen offset:1536 sc1 lds
    v_mfma_f32_16x16x32_bf16 v[88:91], a[36:39], v[32:35], v[88:91]
    v_mfma_f32_16x16x32_bf16 v[92:95], v[16:19], a[40:43], v[92:95]
    buffer_load_dwordx4 a[8:11], v253, s[8:11], s28 offen offset:2048 sc1
    v_mfma_f32_16x16x32_bf16 v[96:99], v[20:23], a[40:43], v[96:99]
    v_mfma_f32_16x16x32_bf16 v[100:103], v[24:27], a[40:43], v[100:103]
    buffer_load_dwordx4 a[12:15], v253, s[8:11], s28 offen offset:3072 sc1
    s_add_u32 s28, s28, 4096
    v_mfma_f32_16x16x32_bf16 v[104:107], v[28:31], a[40:43], v[104:107]
    v_mfma_f32_16x16x32_bf16 v[108:111], v[32:35], a[40:43], v[108:111]
    buffer_load_dwordx4 a[16:19], v253, s[8:11], s28 offen offset:0 sc1
    v_mfma_f32_16x16x32_bf16 v[112:115], a[44:47], v[16:19], v[112:115]
    v_mfma_f32_16x16x32_bf16 v[116:119], a[44:47], v[20:23], v[116:119]
    v_mfma_f32_16x16x32_bf16 v[120:123], a[44:47], v[24:27], v[120:123]
    v_mfma_f32_16x16x32_bf16 v[124:127], a[44:47], v[28:31], v[124:127]
    v_mfma_f32_16x16x32_bf16 v[128:131], a[44:47], v[32:35], v[128:131]
    s_waitcnt lgkmcnt(0)
    v_mfma_f32_16x16x32_bf16 v[56:59], a[48:51], v[40:43], v[56:59]
    ds_read_b128 v[16:19], v253 offset:20480
    v_mfma_f32_16x16x32_bf16 v[60:63], a[48:51], v[44:47], v[60:63]
    ds_read_b128 v[20:23], v253 offset:21504
    v_mfma_f32_16x16x32_bf16 v[64:67], a[48:51], v[48:51], v[64:67]
    ds_read_b128 v[24:27], v253 offset:22528
    v_mfma_f32_16x16x32_bf16 v[68:71], a[48:51], v[52:55], v[68:71]
    ds_read_b128 v[28:31], v253 offset:23552
    v_mfma_f32_16x16x32_bf16 v[72:75], a[52:55], v[36:39], v[72:75]
    ds_read_b128 v[32:35], v253 offset:24576
    v_mfma_f32_16x16x32_bf16 v[76:79], a[52:55], v[40:43], v[76:79]
    s_add_u32 m0, s26, 30720
    s_add_u32 s7, s27, 3072
    buffer_load_dwordx4 v2, s[8:11], s7 offen sc1 lds
    v_mfma_f32_16x16x32_bf16 v[80:83], a[52:55], v[44:47], v[80:83]
    v_mfma_f32_16x16x32_bf16 v[84:87], a[52:55], v[48:51], v[84:87]
    s_add_u32 m0, s29, 30720
    s_add_u32 s7, s23, 3072
    buffer_load_dwordx4 v2, s[8:11], s7 offen sc1 lds
    v_mfma_f32_16x16x32_bf16 v[88:91], a[52:55], v[52:55], v[88:91]
    v_mfma_f32_16x16x32_bf16 v[92:95], v[36:39], a[56:59], v[92:95]
    buffer_load_dwordx4 a[20:23], v253, s[8:11], s28 offen offset:1024 sc1
    v_mfma_f32_16x16x32_bf16 v[96:99], v[40:43], a[56:59], v[96:99]
    v_mfma_f32_16x16x32_bf16 v[100:103], v[44:47], a[56:59], v[100:103]
    buffer_load_dwordx4 a[24:27], v253, s[8:11], s28 offen offset:2048 sc1
    v_mfma_f32_16x16x32_bf16 v[104:107], v[48:51], a[56:59], v[104:107]
    v_mfma_f32_16x16x32_bf16 v[108:111], v[52:55], a[56:59], v[108:111]
    buffer_load_dwordx4 a[28:31], v253, s[8:11], s28 offen offset:3072 sc1
    s_add_u32 s28, s28, 4096
    v_mfma_f32_16x16x32_bf16 v[112:115], a[60:63], v[36:39], v[112:115]
    v_mfma_f32_16x16x32_bf16 v[116:119], a[60:63], v[40:43], v[116:119]
    v_mfma_f32_16x16x32_bf16 v[120:123], a[60:63], v[44:47], v[120:123]
    v_mfma_f32_16x16x32_bf16 v[124:127], a[60:63], v[48:51], v[124:127]
    v_mfma_f32_16x16x32_bf16 v[128:131], a[60:63], v[52:55], v[128:131]
    s_waitcnt lgkmcnt(0)
    v_mfma_f32_16x16x32_bf16 v[56:59], a[64:67], v[20:23], v[56:59]
    ds_read_b128 v[36:39], v253 offset:25600
    v_mfma_f32_16x16x32_bf16 v[60:63], a[64:67], v[24:27], v[60:63]
    ds_read_b128 v[40:43], v253 offset:26624
    v_mfma_f32_16x16x32_bf16 v[64:67], a[64:67], v[28:31], v[64:67]
    ds_read_b128 v[44:47], v253 offset:27648
    v_mfma_f32_16x16x32_bf16 v[68:71], a[64:67], v[32:35], v[68:71]
    ds_read_b128 v[48:51], v253 offset:28672
    v_mfma_f32_16x16x32_bf16 v[72:75], a[68:71], v[16:19], v[72:75]
    ds_read_b128 v[52:55], v253 offset:29696
    v_mfma_f32_16x16x32_bf16 v[76:79], a[68:71], v[20:23], v[76:79]
    buffer_load_dwordx4 a[32:35], v253, s[8:11], s28 offen offset:0 sc1
    v_mfma_f32_16x16x32_bf16 v[80:83], a[68:71], v[24:27], v[80:83]
    v_mfma_f32_16x16x32_bf16 v[84:87], a[68:71], v[28:31], v[84:87]
    buffer_load_dwordx4 a[36:39], v253, s[8:11], s28 offen offset:1024 sc1
    v_mfma_f32_16x16x32_bf16 v[88:91], a[68:71], v[32:35], v[88:91]
    v_mfma_f32_16x16x32_bf16 v[92:95], v[16:19], a[72:75], v[92:95]
    buffer_load_dwordx4 a[40:43], v253, s[8:11], s28 offen offset:2048 sc1
    v_mfma_f32_16x16x32_bf16 v[96:99], v[20:23], a[72:75], v[96:99]
    v_mfma_f32_16x16x32_bf16 v[100:103], v[24:27], a[72:75], v[100:103]
    buffer_load_dwordx2 v[226:227], v228, s[8:11], s39 offen sc1
    v_mfma_f32_16x16x32_bf16 v[104:107], v[28:31], a[72:75], v[104:107]
    v_mfma_f32_16x16x32_bf16 v[108:111], v[32:35], a[72:75], v[108:111]
    v_mfma_f32_16x16x32_bf16 v[112:115], a[76:79], v[16:19], v[112:115]
    v_mfma_f32_16x16x32_bf16 v[116:119], a[76:79], v[20:23], v[116:119]
    v_mfma_f32_16x16x32_bf16 v[120:123], a[76:79], v[24:27], v[120:123]
    v_mfma_f32_16x16x32_bf16 v[124:127], a[76:79], v[28:31], v[124:127]
    v_mfma_f32_16x16x32_bf16 v[128:131], a[76:79], v[32:35], v[128:131]
    s_waitcnt vmcnt(7) lgkmcnt(0)
    s_barrier
    v_mfma_f32_16x16x32_bf16 v[56:59], a[80:83], v[40:43], v[56:59]
    ds_read_b128 v[16:19], v253 offset:30720
    v_mfma_f32_16x16x32_bf16 v[60:63], a[80:83], v[44:47], v[60:63]
    ds_read_b128 v[20:23], v253 offset:31744
    v_mfma_f32_16x16x32_bf16 v[64:67], a[80:83], v[48:51], v[64:67]
    ds_read_b128 v[24:27], v253 offset:32768
    v_mfma_f32_16x16x32_bf16 v[68:71], a[80:83], v[52:55], v[68:71]
    ds_read_b128 v[28:31], v253 offset:33792
    v_mfma_f32_16x16x32_bf16 v[72:75], a[84:87], v[36:39], v[72:75]
    ds_read_b128 v[32:35], v253 offset:34816
    v_mfma_f32_16x16x32_bf16 v[76:79], a[84:87], v[40:43], v[76:79]
    s_add_u32 m0, s25, 59392
    s_nop 0
    buffer_load_dwordx4 v2, s[8:11], s24 offen offset:2048 sc1 lds
    v_mfma_f32_16x16x32_bf16 v[80:83], a[84:87], v[44:47], v[80:83]
    v_mfma_f32_16x16x32_bf16 v[84:87], a[84:87], v[48:51], v[84:87]
    s_add_u32 m0, s25, 64000
    s_nop 0
    buffer_load_dwordx4 v2, s[8:11], s24 offen offset:2560 sc1 lds
    v_mfma_f32_16x16x32_bf16 v[88:91], a[84:87], v[52:55], v[88:91]
    v_mfma_f32_16x16x32_bf16 v[92:95], v[36:39], a[88:91], v[92:95]
    buffer_load_dwordx4 a[44:47], v253, s[8:11], s28 offen offset:3072 sc1
    s_add_u32 s28, s28, 4096
    v_mfma_f32_16x16x32_bf16 v[96:99], v[40:43], a[88:91], v[96:99]
    v_mfma_f32_16x16x32_bf16 v[100:103], v[44:47], a[88:91], v[100:103]
    buffer_load_dwordx4 a[48:51], v253, s[8:11], s28 offen offset:0 sc1
    v_mfma_f32_16x16x32_bf16 v[104:107], v[48:51], a[88:91], v[104:107]
    v_mfma_f32_16x16x32_bf16 v[108:111], v[52:55], a[88:91], v[108:111]
    buffer_load_dwordx4 a[52:55], v253, s[8:11], s28 offen offset:1024 sc1
    v_mfma_f32_16x16x32_bf16 v[112:115], a[92:95], v[36:39], v[112:115]
    v_mfma_f32_16x16x32_bf16 v[116:119], a[92:95], v[40:43], v[116:119]
    v_mfma_f32_16x16x32_bf16 v[120:123], a[92:95], v[44:47], v[120:123]
    v_mfma_f32_16x16x32_bf16 v[124:127], a[92:95], v[48:51], v[124:127]
    v_mfma_f32_16x16x32_bf16 v[128:131], a[92:95], v[52:55], v[128:131]
    s_waitcnt lgkmcnt(0)
    v_mfma_f32_16x16x32_bf16 v[56:59], a[96:99], v[20:23], v[56:59]
    ds_read_b128 v[36:39], v253 offset:35840
    v_mfma_f32_16x16x32_bf16 v[60:63], a[96:99], v[24:27], v[60:63]
    ds_read_b128 v[40:43], v253 offset:36864
    v_mfma_f32_16x16x32_bf16 v[64:67], a[96:99], v[28:31], v[64:67]
    ds_read_b128 v[44:47], v253 offset:37888
    v_mfma_f32_16x16x32_bf16 v[68:71], a[96:99], v[32:35], v[68:71]
    ds_read_b128 v[48:51], v253 offset:38912
    v_mfma_f32_16x16x32_bf16 v[72:75], a[100:103], v[16:19], v[72:75]
    ds_read_b128 v[52:55], v253 offset:39936
    v_mfma_f32_16x16x32_bf16 v[76:79], a[100:103], v[20:23], v[76:79]
    s_add_u32 m0, s25, 68608
    s_nop 0
    buffer_load_dwordx4 v2, s[8:11], s24 offen offset:3072 sc1 lds
    v_mfma_f32_16x16x32_bf16 v[80:83], a[100:103], v[24:27], v[80:83]
    v_mfma_f32_16x16x32_bf16 v[84:87], a[100:103], v[28:31], v[84:87]
    s_add_u32 m0, s25, 73216
    s_nop 0
    buffer_load_dwordx4 v2, s[8:11], s24 offen offset:3584 sc1 lds
    v_mfma_f32_16x16x32_bf16 v[88:91], a[100:103], v[32:35], v[88:91]
    v_mfma_f32_16x16x32_bf16 v[92:95], v[16:19], a[104:107], v[92:95]
    buffer_load_dwordx4 a[56:59], v253, s[8:11], s28 offen offset:2048 sc1
    v_mfma_f32_16x16x32_bf16 v[96:99], v[20:23], a[104:107], v[96:99]
    v_mfma_f32_16x16x32_bf16 v[100:103], v[24:27], a[104:107], v[100:103]
    buffer_load_dwordx4 a[60:63], v253, s[8:11], s28 offen offset:3072 sc1
    s_add_u32 s28, s28, 4096
    v_mfma_f32_16x16x32_bf16 v[104:107], v[28:31], a[104:107], v[104:107]
    v_mfma_f32_16x16x32_bf16 v[108:111], v[32:35], a[104:107], v[108:111]
    buffer_load_dwordx4 a[64:67], v253, s[8:11], s28 offen offset:0 sc1
    v_mfma_f32_16x16x32_bf16 v[112:115], a[108:111], v[16:19], v[112:115]
    v_mfma_f32_16x16x32_bf16 v[116:119], a[108:111], v[20:23], v[116:119]
    v_mfma_f32_16x16x32_bf16 v[120:123], a[108:111], v[24:27], v[120:123]
    v_mfma_f32_16x16x32_bf16 v[124:127], a[108:111], v[28:31], v[124:127]
    v_mfma_f32_16x16x32_bf16 v[128:131], a[108:111], v[32:35], v[128:131]
    s_waitcnt lgkmcnt(0)
    v_mfma_f32_16x16x32_bf16 v[56:59], a[112:115], v[40:43], v[56:59]
    ds_read_b128 v[16:19], v253 offset:40960
    v_mfma_f32_16x16x32_bf16 v[60:63], a[112:115], v[44:47], v[60:63]
    ds_read_b128 v[20:23], v253 offset:41984
    v_mfma_f32_16x16x32_bf16 v[64:67], a[112:115], v[48:51], v[64:67]
    ds_read_b128 v[24:27], v253 offset:43008
    v_mfma_f32_16x16x32_bf16 v[68:71], a[112:115], v[52:55], v[68:71]
    ds_read_b128 v[28:31], v253 offset:44032
    v_mfma_f32_16x16x32_bf16 v[72:75], a[116:119], v[36:39], v[72:75]
    ds_read_b128 v[32:35], v253 offset:45056
    v_mfma_f32_16x16x32_bf16 v[76:79], a[116:119], v[40:43], v[76:79]
    s_add_u32 m0, s25, 81920
    s_add_u32 s24, s24, 4096
    buffer_load_dwordx4 v2, s[8:11], s24 offen offset:0 sc1 lds
    v_mfma_f32_16x16x32_bf16 v[80:83], a[116:119], v[44:47], v[80:83]
    v_mfma_f32_16x16x32_bf16 v[84:87], a[116:119], v[48:51], v[84:87]
    s_add_u32 m0, s25, 86528
    s_nop 0
    buffer_load_dwordx4 v2, s[8:11], s24 offen offset:512 sc1 lds
    v_mfma_f32_16x16x32_bf16 v[88:91], a[116:119], v[52:55], v[88:91]
    v_mfma_f32_16x16x32_bf16 v[92:95], v[36:39], a[120:123], v[92:95]
    buffer_load_dwordx4 a[68:71], v253, s[8:11], s28 offen offset:1024 sc1
    v_mfma_f32_16x16x32_bf16 v[96:99], v[40:43], a[120:123], v[96:99]
    v_mfma_f32_16x16x32_bf16 v[100:103], v[44:47], a[120:123], v[100:103]
    buffer_load_dwordx4 a[72:75], v253, s[8:11], s28 offen offset:2048 sc1
    v_mfma_f32_16x16x32_bf16 v[104:107], v[48:51], a[120:123], v[104:107]
    v_mfma_f32_16x16x32_bf16 v[108:111], v[52:55], a[120:123], v[108:111]
    buffer_load_dwordx4 a[76:79], v253, s[8:11], s28 offen offset:3072 sc1
    s_add_u32 s28, s28, 4096
    v_mfma_f32_16x16x32_bf16 v[112:115], a[124:127], v[36:39], v[112:115]
    v_mfma_f32_16x16x32_bf16 v[116:119], a[124:127], v[40:43], v[116:119]
    v_mfma_f32_16x16x32_bf16 v[120:123], a[124:127], v[44:47], v[120:123]
    v_mfma_f32_16x16x32_bf16 v[124:127], a[124:127], v[48:51], v[124:127]
    v_mfma_f32_16x16x32_bf16 v[128:131], a[124:127], v[52:55], v[128:131]
    s_waitcnt lgkmcnt(0)
    v_mfma_f32_16x16x32_bf16 v[56:59], a[128:131], v[20:23], v[56:59]
    ds_read_b128 v[36:39], v6 offset:0
    v_mfma_f32_16x16x32_bf16 v[60:63], a[128:131], v[24:27], v[60:63]
    ds_read_b128 v[40:43], v6 offset:1024
    v_mfma_f32_16x16x32_bf16 v[64:67], a[128:131], v[28:31], v[64:67]
    ds_read_b128 v[44:47], v6 offset:2048
    v_mfma_f32_16x16x32_bf16 v[68:71], a[128:131], v[32:35], v[68:71]
    ds_read_b128 v[48:51], v6 offset:3072
    v_mfma_f32_16x16x32_bf16 v[72:75], a[132:135], v[16:19], v[72:75]
    ds_read_b128 v[52:55], v6 offset:4096
    v_mfma_f32_16x16x32_bf16 v[76:79], a[132:135], v[20:23], v[76:79]
    s_add_u32 m0, s26, 61440
    s_add_u32 s7, s27, 6144
    buffer_load_dwordx4 v2, s[8:11], s7 offen sc1 lds
    v_mfma_f32_16x16x32_bf16 v[80:83], a[132:135], v[24:27], v[80:83]
    v_mfma_f32_16x16x32_bf16 v[84:87], a[132:135], v[28:31], v[84:87]
    s_add_u32 m0, s29, 61440
    s_add_u32 s7, s23, 6144
    buffer_load_dwordx4 v2, s[8:11], s7 offen sc1 lds
    v_mfma_f32_16x16x32_bf16 v[88:91], a[132:135], v[32:35], v[88:91]
    v_mfma_f32_16x16x32_bf16 v[92:95], v[16:19], a[136:139], v[92:95]
    buffer_load_dwordx4 a[80:83], v253, s[8:11], s28 offen offset:0 sc1
    v_mfma_f32_16x16x32_bf16 v[96:99], v[20:23], a[136:139], v[96:99]
    v_mfma_f32_16x16x32_bf16 v[100:103], v[24:27], a[136:139], v[100:103]
    buffer_load_dwordx4 a[84:87], v253, s[8:11], s28 offen offset:1024 sc1
    v_mfma_f32_16x16x32_bf16 v[104:107], v[28:31], a[136:139], v[104:107]
    v_mfma_f32_16x16x32_bf16 v[108:111], v[32:35], a[136:139], v[108:111]
    buffer_load_dwordx4 a[88:91], v253, s[8:11], s28 offen offset:2048 sc1
    v_mfma_f32_16x16x32_bf16 v[112:115], a[140:143], v[16:19], v[112:115]
    v_mfma_f32_16x16x32_bf16 v[116:119], a[140:143], v[20:23], v[116:119]
    v_mfma_f32_16x16x32_bf16 v[120:123], a[140:143], v[24:27], v[120:123]
    v_mfma_f32_16x16x32_bf16 v[124:127], a[140:143], v[28:31], v[124:127]
    v_mfma_f32_16x16x32_bf16 v[128:131], a[140:143], v[32:35], v[128:131]
    s_waitcnt vmcnt(20) lgkmcnt(0)
    s_mov_b32 s6, 0
L_wo_poll_15:
    v_cmp_eq_u32 vcc, s76, v226
    v_cmp_eq_u32 s[20:21], s76, v227
    s_and_b64 vcc, vcc, s[20:21]
    s_cmp_eq_u64 vcc, exec
    s_cbranch_scc1 L_wo_ready_16
    buffer_load_dwordx2 v[226:227], v228, s[8:11], s39 offen sc1
    s_add_u32 s6, s6, 1
    s_cmp_lt_u32 s6, 1048576
    s_waitcnt vmcnt(0)
    s_cbranch_scc1 L_wo_poll_15
    s_branch L_main_end
L_wo_ready_16:
    v_mfma_f32_16x16x32_bf16 v[56:59], a[144:147], v[40:43], v[56:59]
    ds_read_b128 v[16:19], v6 offset:5120
    v_mfma_f32_16x16x32_bf16 v[60:63], a[144:147], v[44:47], v[60:63]
    ds_read_b128 v[20:23], v6 offset:6144
    v_mfma_f32_16x16x32_bf16 v[64:67], a[144:147], v[48:51], v[64:67]
    ds_read_b128 v[24:27], v6 offset:7168
    v_mfma_f32_16x16x32_bf16 v[68:71], a[144:147], v[52:55], v[68:71]
    ds_read_b128 v[28:31], v6 offset:8192
    v_mfma_f32_16x16x32_bf16 v[72:75], a[148:151], v[36:39], v[72:75]
    ds_read_b128 v[32:35], v6 offset:9216
    v_mfma_f32_16x16x32_bf16 v[76:79], a[148:151], v[40:43], v[76:79]
    buffer_load_dwordx4 a[92:95], v253, s[8:11], s28 offen offset:3072 sc1
    s_add_u32 s28, s28, 4096
    v_mfma_f32_16x16x32_bf16 v[80:83], a[148:151], v[44:47], v[80:83]
    v_mfma_f32_16x16x32_bf16 v[84:87], a[148:151], v[48:51], v[84:87]
    buffer_load_dwordx4 a[96:99], v253, s[8:11], s28 offen offset:0 sc1
    v_mfma_f32_16x16x32_bf16 v[88:91], a[148:151], v[52:55], v[88:91]
    v_mfma_f32_16x16x32_bf16 v[92:95], v[36:39], a[152:155], v[92:95]
    buffer_load_dwordx4 a[100:103], v253, s[8:11], s28 offen offset:1024 sc1
    v_mfma_f32_16x16x32_bf16 v[96:99], v[40:43], a[152:155], v[96:99]
    v_mfma_f32_16x16x32_bf16 v[100:103], v[44:47], a[152:155], v[100:103]
    buffer_load_dwordx4 a[160:163], v253, s[8:11], s32 offen offset:0 sc1
    v_mfma_f32_16x16x32_bf16 v[104:107], v[48:51], a[152:155], v[104:107]
    v_mfma_f32_16x16x32_bf16 v[108:111], v[52:55], a[152:155], v[108:111]
    v_mfma_f32_16x16x32_bf16 v[112:115], a[156:159], v[36:39], v[112:115]
    v_mfma_f32_16x16x32_bf16 v[116:119], a[156:159], v[40:43], v[116:119]
    v_mfma_f32_16x16x32_bf16 v[120:123], a[156:159], v[44:47], v[120:123]
    v_mfma_f32_16x16x32_bf16 v[124:127], a[156:159], v[48:51], v[124:127]
    v_mfma_f32_16x16x32_bf16 v[128:131], a[156:159], v[52:55], v[128:131]
    s_waitcnt vmcnt(34) lgkmcnt(0)
    v_mfma_f32_16x16x32_bf16 v[56:59], a[0:3], v[20:23], v[56:59]
    ds_read_b128 v[36:39], v6 offset:10240
    v_mfma_f32_16x16x32_bf16 v[60:63], a[0:3], v[24:27], v[60:63]
    ds_read_b128 v[40:43], v6 offset:11264
    v_mfma_f32_16x16x32_bf16 v[64:67], a[0:3], v[28:31], v[64:67]
    ds_read_b128 v[44:47], v6 offset:12288
    v_mfma_f32_16x16x32_bf16 v[68:71], a[0:3], v[32:35], v[68:71]
    ds_read_b128 v[48:51], v6 offset:13312
    v_mfma_f32_16x16x32_bf16 v[72:75], a[4:7], v[16:19], v[72:75]
    ds_read_b128 v[52:55], v6 offset:14336
    v_mfma_f32_16x16x32_bf16 v[76:79], a[4:7], v[20:23], v[76:79]
    buffer_load_dwordx4 a[104:107], v253, s[8:11], s28 offen offset:2048 sc1
    v_mfma_f32_16x16x32_bf16 v[80:83], a[4:7], v[24:27], v[80:83]
    v_mfma_f32_16x16x32_bf16 v[84:87], a[4:7], v[28:31], v[84:87]
    buffer_load_dwordx4 a[108:111], v253, s[8:11], s28 offen offset:3072 sc1
    s_add_u32 s28, s28, 4096
    v_mfma_f32_16x16x32_bf16 v[88:91], a[4:7], v[32:35], v[88:91]
    v_mfma_f32_16x16x32_bf16 v[92:95], v[16:19], a[8:11], v[92:95]
    buffer_load_dwordx4 a[112:115], v253, s[8:11], s28 offen offset:0 sc1
    v_mfma_f32_16x16x32_bf16 v[96:99], v[20:23], a[8:11], v[96:99]
    v_mfma_f32_16x16x32_bf16 v[100:103], v[24:27], a[8:11], v[100:103]
    buffer_load_dwordx4 a[164:167], v253, s[8:11], s33 offen offset:0 sc1
    v_mfma_f32_16x16x32_bf16 v[104:107], v[28:31], a[8:11], v[104:107]
    v_mfma_f32_16x16x32_bf16 v[108:111], v[32:35], a[8:11], v[108:111]
    v_mfma_f32_16x16x32_bf16 v[112:115], a[12:15], v[16:19], v[112:115]
    v_mfma_f32_16x16x32_bf16 v[116:119], a[12:15], v[20:23], v[116:119]
    v_mfma_f32_16x16x32_bf16 v[120:123], a[12:15], v[24:27], v[120:123]
    v_mfma_f32_16x16x32_bf16 v[124:127], a[12:15], v[28:31], v[124:127]
    v_mfma_f32_16x16x32_bf16 v[128:131], a[12:15], v[32:35], v[128:131]
    s_waitcnt vmcnt(11) lgkmcnt(0)
    s_barrier
    v_mfma_f32_16x16x32_bf16 v[56:59], a[16:19], v[40:43], v[56:59]
    ds_read_b128 v[16:19], v6 offset:15360
    v_mfma_f32_16x16x32_bf16 v[60:63], a[16:19], v[44:47], v[60:63]
    ds_read_b128 v[20:23], v6 offset:16384
    v_mfma_f32_16x16x32_bf16 v[64:67], a[16:19], v[48:51], v[64:67]
    ds_read_b128 v[24:27], v6 offset:17408
    v_mfma_f32_16x16x32_bf16 v[68:71], a[16:19], v[52:55], v[68:71]
    ds_read_b128 v[28:31], v6 offset:18432
    v_mfma_f32_16x16x32_bf16 v[72:75], a[20:23], v[36:39], v[72:75]
    ds_read_b128 v[32:35], v6 offset:19456
    v_mfma_f32_16x16x32_bf16 v[76:79], a[20:23], v[40:43], v[76:79]
    buffer_load_dwordx4 a[116:119], v253, s[8:11], s28 offen offset:1024 sc1
    v_mfma_f32_16x16x32_bf16 v[80:83], a[20:23], v[44:47], v[80:83]
    v_mfma_f32_16x16x32_bf16 v[84:87], a[20:23], v[48:51], v[84:87]
    buffer_load_dwordx4 a[120:123], v253, s[8:11], s28 offen offset:2048 sc1
    v_mfma_f32_16x16x32_bf16 v[88:91], a[20:23], v[52:55], v[88:91]
    v_mfma_f32_16x16x32_bf16 v[92:95], v[36:39], a[24:27], v[92:95]
    buffer_load_dwordx4 a[124:127], v253, s[8:11], s28 offen offset:3072 sc1
    s_add_u32 s28, s28, 4096
    v_mfma_f32_16x16x32_bf16 v[96:99], v[40:43], a[24:27], v[96:99]
    v_mfma_f32_16x16x32_bf16 v[100:103], v[44:47], a[24:27], v[100:103]
    buffer_load_dwordx4 a[168:171], v5, s[8:11], s34 offen offset:0 sc1
    v_mfma_f32_16x16x32_bf16 v[104:107], v[48:51], a[24:27], v[104:107]
    v_mfma_f32_16x16x32_bf16 v[108:111], v[52:55], a[24:27], v[108:111]
    v_mfma_f32_16x16x32_bf16 v[112:115], a[28:31], v[36:39], v[112:115]
    v_mfma_f32_16x16x32_bf16 v[116:119], a[28:31], v[40:43], v[116:119]
    v_mfma_f32_16x16x32_bf16 v[120:123], a[28:31], v[44:47], v[120:123]
    v_mfma_f32_16x16x32_bf16 v[124:127], a[28:31], v[48:51], v[124:127]
    v_mfma_f32_16x16x32_bf16 v[128:131], a[28:31], v[52:55], v[128:131]
    s_waitcnt vmcnt(29) lgkmcnt(0)
    v_mfma_f32_16x16x32_bf16 v[56:59], a[32:35], v[20:23], v[56:59]
    ds_read_b128 v[36:39], v6 offset:20480
    v_mfma_f32_16x16x32_bf16 v[60:63], a[32:35], v[24:27], v[60:63]
    ds_read_b128 v[40:43], v6 offset:21504
    v_mfma_f32_16x16x32_bf16 v[64:67], a[32:35], v[28:31], v[64:67]
    ds_read_b128 v[44:47], v6 offset:22528
    v_mfma_f32_16x16x32_bf16 v[68:71], a[32:35], v[32:35], v[68:71]
    ds_read_b128 v[48:51], v6 offset:23552
    v_mfma_f32_16x16x32_bf16 v[72:75], a[36:39], v[16:19], v[72:75]
    ds_read_b128 v[52:55], v6 offset:24576
    v_mfma_f32_16x16x32_bf16 v[76:79], a[36:39], v[20:23], v[76:79]
    buffer_load_dwordx4 a[172:175], v253, s[8:11], s32 offen offset:1024 sc1
    v_mfma_f32_16x16x32_bf16 v[80:83], a[36:39], v[24:27], v[80:83]
    v_mfma_f32_16x16x32_bf16 v[84:87], a[36:39], v[28:31], v[84:87]
    buffer_load_dwordx4 a[176:179], v253, s[8:11], s33 offen offset:1024 sc1
    v_mfma_f32_16x16x32_bf16 v[88:91], a[36:39], v[32:35], v[88:91]
    v_mfma_f32_16x16x32_bf16 v[92:95], v[16:19], a[40:43], v[92:95]
    buffer_load_dwordx4 a[180:183], v5, s[8:11], s34 offen offset:1024 sc1
    v_mfma_f32_16x16x32_bf16 v[96:99], v[20:23], a[40:43], v[96:99]
    v_mfma_f32_16x16x32_bf16 v[100:103], v[24:27], a[40:43], v[100:103]
    buffer_load_dwordx4 a[184:187], v253, s[8:11], s32 offen offset:2048 sc1
    v_mfma_f32_16x16x32_bf16 v[104:107], v[28:31], a[40:43], v[104:107]
    v_mfma_f32_16x16x32_bf16 v[108:111], v[32:35], a[40:43], v[108:111]
    v_mfma_f32_16x16x32_bf16 v[112:115], a[44:47], v[16:19], v[112:115]
    v_mfma_f32_16x16x32_bf16 v[116:119], a[44:47], v[20:23], v[116:119]
    v_mfma_f32_16x16x32_bf16 v[120:123], a[44:47], v[24:27], v[120:123]
    v_mfma_f32_16x16x32_bf16 v[124:127], a[44:47], v[28:31], v[124:127]
    v_mfma_f32_16x16x32_bf16 v[128:131], a[44:47], v[32:35], v[128:131]
    s_waitcnt vmcnt(27) lgkmcnt(0)
    v_mfma_f32_16x16x32_bf16 v[56:59], a[48:51], v[40:43], v[56:59]
    ds_read_b128 v[16:19], v6 offset:25600
    v_mfma_f32_16x16x32_bf16 v[60:63], a[48:51], v[44:47], v[60:63]
    ds_read_b128 v[20:23], v6 offset:26624
    v_mfma_f32_16x16x32_bf16 v[64:67], a[48:51], v[48:51], v[64:67]
    ds_read_b128 v[24:27], v6 offset:27648
    v_mfma_f32_16x16x32_bf16 v[68:71], a[48:51], v[52:55], v[68:71]
    ds_read_b128 v[28:31], v6 offset:28672
    v_mfma_f32_16x16x32_bf16 v[72:75], a[52:55], v[36:39], v[72:75]
    ds_read_b128 v[32:35], v6 offset:29696
    v_mfma_f32_16x16x32_bf16 v[76:79], a[52:55], v[40:43], v[76:79]
    buffer_load_dwordx4 a[188:191], v253, s[8:11], s33 offen offset:2048 sc1
    v_mfma_f32_16x16x32_bf16 v[80:83], a[52:55], v[44:47], v[80:83]
    v_mfma_f32_16x16x32_bf16 v[84:87], a[52:55], v[48:51], v[84:87]
    buffer_load_dwordx4 a[192:195], v5, s[8:11], s34 offen offset:2048 sc1
    v_mfma_f32_16x16x32_bf16 v[88:91], a[52:55], v[52:55], v[88:91]
    v_mfma_f32_16x16x32_bf16 v[92:95], v[36:39], a[56:59], v[92:95]
    buffer_load_dwordx4 a[196:199], v253, s[8:11], s32 offen offset:3072 sc1
    s_add_u32 s32, s32, 4096
    v_mfma_f32_16x16x32_bf16 v[96:99], v[40:43], a[56:59], v[96:99]
    v_mfma_f32_16x16x32_bf16 v[100:103], v[44:47], a[56:59], v[100:103]
    buffer_load_dwordx4 a[200:203], v253, s[8:11], s33 offen offset:3072 sc1
    s_add_u32 s33, s33, 4096
    v_mfma_f32_16x16x32_bf16 v[104:107], v[48:51], a[56:59], v[104:107]
    v_mfma_f32_16x16x32_bf16 v[108:111], v[52:55], a[56:59], v[108:111]
    v_mfma_f32_16x16x32_bf16 v[112:115], a[60:63], v[36:39], v[112:115]
    v_mfma_f32_16x16x32_bf16 v[116:119], a[60:63], v[40:43], v[116:119]
    v_mfma_f32_16x16x32_bf16 v[120:123], a[60:63], v[44:47], v[120:123]
    v_mfma_f32_16x16x32_bf16 v[124:127], a[60:63], v[48:51], v[124:127]
    v_mfma_f32_16x16x32_bf16 v[128:131], a[60:63], v[52:55], v[128:131]
    s_waitcnt vmcnt(25) lgkmcnt(0)
    v_mfma_f32_16x16x32_bf16 v[56:59], a[64:67], v[20:23], v[56:59]
    ds_read_b128 v[36:39], v6 offset:30720
    v_mfma_f32_16x16x32_bf16 v[60:63], a[64:67], v[24:27], v[60:63]
    ds_read_b128 v[40:43], v6 offset:31744
    v_mfma_f32_16x16x32_bf16 v[64:67], a[64:67], v[28:31], v[64:67]
    ds_read_b128 v[44:47], v6 offset:32768
    v_mfma_f32_16x16x32_bf16 v[68:71], a[64:67], v[32:35], v[68:71]
    ds_read_b128 v[48:51], v6 offset:33792
    v_mfma_f32_16x16x32_bf16 v[72:75], a[68:71], v[16:19], v[72:75]
    ds_read_b128 v[52:55], v6 offset:34816
    v_mfma_f32_16x16x32_bf16 v[76:79], a[68:71], v[20:23], v[76:79]
    buffer_load_dwordx4 a[204:207], v5, s[8:11], s34 offen offset:3072 sc1
    s_add_u32 s34, s34, 4096
    v_mfma_f32_16x16x32_bf16 v[80:83], a[68:71], v[24:27], v[80:83]
    v_mfma_f32_16x16x32_bf16 v[84:87], a[68:71], v[28:31], v[84:87]
    buffer_load_dwordx4 a[208:211], v253, s[8:11], s32 offen offset:0 sc1
    v_mfma_f32_16x16x32_bf16 v[88:91], a[68:71], v[32:35], v[88:91]
    v_mfma_f32_16x16x32_bf16 v[92:95], v[16:19], a[72:75], v[92:95]
    buffer_load_dwordx4 a[212:215], v253, s[8:11], s33 offen offset:0 sc1
    v_mfma_f32_16x16x32_bf16 v[96:99], v[20:23], a[72:75], v[96:99]
    v_mfma_f32_16x16x32_bf16 v[100:103], v[24:27], a[72:75], v[100:103]
    buffer_load_dwordx4 a[216:219], v5, s[8:11], s34 offen offset:0 sc1
    v_mfma_f32_16x16x32_bf16 v[104:107], v[28:31], a[72:75], v[104:107]
    v_mfma_f32_16x16x32_bf16 v[108:111], v[32:35], a[72:75], v[108:111]
    v_mfma_f32_16x16x32_bf16 v[112:115], a[76:79], v[16:19], v[112:115]
    v_mfma_f32_16x16x32_bf16 v[116:119], a[76:79], v[20:23], v[116:119]
    v_mfma_f32_16x16x32_bf16 v[120:123], a[76:79], v[24:27], v[120:123]
    v_mfma_f32_16x16x32_bf16 v[124:127], a[76:79], v[28:31], v[124:127]
    v_mfma_f32_16x16x32_bf16 v[128:131], a[76:79], v[32:35], v[128:131]
    s_waitcnt vmcnt(23) lgkmcnt(0)
    v_mfma_f32_16x16x32_bf16 v[56:59], a[80:83], v[40:43], v[56:59]
    ds_read_b128 v[16:19], v6 offset:35840
    v_mfma_f32_16x16x32_bf16 v[60:63], a[80:83], v[44:47], v[60:63]
    ds_read_b128 v[20:23], v6 offset:36864
    v_mfma_f32_16x16x32_bf16 v[64:67], a[80:83], v[48:51], v[64:67]
    ds_read_b128 v[24:27], v6 offset:37888
    v_mfma_f32_16x16x32_bf16 v[68:71], a[80:83], v[52:55], v[68:71]
    ds_read_b128 v[28:31], v6 offset:38912
    v_mfma_f32_16x16x32_bf16 v[72:75], a[84:87], v[36:39], v[72:75]
    ds_read_b128 v[32:35], v6 offset:39936
    v_mfma_f32_16x16x32_bf16 v[76:79], a[84:87], v[40:43], v[76:79]
    buffer_load_dwordx4 a[220:223], v253, s[8:11], s32 offen offset:1024 sc1
    v_mfma_f32_16x16x32_bf16 v[80:83], a[84:87], v[44:47], v[80:83]
    v_mfma_f32_16x16x32_bf16 v[84:87], a[84:87], v[48:51], v[84:87]
    buffer_load_dwordx4 a[224:227], v253, s[8:11], s33 offen offset:1024 sc1
    v_mfma_f32_16x16x32_bf16 v[88:91], a[84:87], v[52:55], v[88:91]
    v_mfma_f32_16x16x32_bf16 v[92:95], v[36:39], a[88:91], v[92:95]
    buffer_load_dwordx4 a[228:231], v5, s[8:11], s34 offen offset:1024 sc1
    v_mfma_f32_16x16x32_bf16 v[96:99], v[40:43], a[88:91], v[96:99]
    v_mfma_f32_16x16x32_bf16 v[100:103], v[44:47], a[88:91], v[100:103]
    buffer_load_dwordx4 a[232:235], v253, s[8:11], s32 offen offset:2048 sc1
    v_mfma_f32_16x16x32_bf16 v[104:107], v[48:51], a[88:91], v[104:107]
    v_mfma_f32_16x16x32_bf16 v[108:111], v[52:55], a[88:91], v[108:111]
    v_mfma_f32_16x16x32_bf16 v[112:115], a[92:95], v[36:39], v[112:115]
    v_mfma_f32_16x16x32_bf16 v[116:119], a[92:95], v[40:43], v[116:119]
    v_mfma_f32_16x16x32_bf16 v[120:123], a[92:95], v[44:47], v[120:123]
    v_mfma_f32_16x16x32_bf16 v[124:127], a[92:95], v[48:51], v[124:127]
    v_mfma_f32_16x16x32_bf16 v[128:131], a[92:95], v[52:55], v[128:131]
    s_waitcnt vmcnt(22) lgkmcnt(0)
    v_mfma_f32_16x16x32_bf16 v[56:59], a[96:99], v[20:23], v[56:59]
    ds_read_b128 v[36:39], v6 offset:40960
    v_mfma_f32_16x16x32_bf16 v[60:63], a[96:99], v[24:27], v[60:63]
    ds_read_b128 v[40:43], v6 offset:41984
    v_mfma_f32_16x16x32_bf16 v[64:67], a[96:99], v[28:31], v[64:67]
    ds_read_b128 v[44:47], v6 offset:43008
    v_mfma_f32_16x16x32_bf16 v[68:71], a[96:99], v[32:35], v[68:71]
    ds_read_b128 v[48:51], v6 offset:44032
    v_mfma_f32_16x16x32_bf16 v[72:75], a[100:103], v[16:19], v[72:75]
    ds_read_b128 v[52:55], v6 offset:45056
    v_mfma_f32_16x16x32_bf16 v[76:79], a[100:103], v[20:23], v[76:79]
    buffer_load_dwordx4 a[236:239], v253, s[8:11], s33 offen offset:2048 sc1
    v_mfma_f32_16x16x32_bf16 v[80:83], a[100:103], v[24:27], v[80:83]
    v_mfma_f32_16x16x32_bf16 v[84:87], a[100:103], v[28:31], v[84:87]
    buffer_load_dwordx4 a[240:243], v5, s[8:11], s34 offen offset:2048 sc1
    v_mfma_f32_16x16x32_bf16 v[88:91], a[100:103], v[32:35], v[88:91]
    v_mfma_f32_16x16x32_bf16 v[92:95], v[16:19], a[104:107], v[92:95]
    buffer_load_dwordx4 a[244:247], v253, s[8:11], s32 offen offset:3072 sc1
    s_add_u32 s32, s32, 4096
    v_mfma_f32_16x16x32_bf16 v[96:99], v[20:23], a[104:107], v[96:99]
    v_mfma_f32_16x16x32_bf16 v[100:103], v[24:27], a[104:107], v[100:103]
    buffer_load_dwordx4 a[248:251], v253, s[8:11], s33 offen offset:3072 sc1
    s_add_u32 s33, s33, 4096
    v_mfma_f32_16x16x32_bf16 v[104:107], v[28:31], a[104:107], v[104:107]
    v_mfma_f32_16x16x32_bf16 v[108:111], v[32:35], a[104:107], v[108:111]
    v_mfma_f32_16x16x32_bf16 v[112:115], a[108:111], v[16:19], v[112:115]
    v_mfma_f32_16x16x32_bf16 v[116:119], a[108:111], v[20:23], v[116:119]
    v_mfma_f32_16x16x32_bf16 v[120:123], a[108:111], v[24:27], v[120:123]
    v_mfma_f32_16x16x32_bf16 v[124:127], a[108:111], v[28:31], v[124:127]
    v_mfma_f32_16x16x32_bf16 v[128:131], a[108:111], v[32:35], v[128:131]
    s_waitcnt vmcnt(21) lgkmcnt(0)
    v_mfma_f32_16x16x32_bf16 v[56:59], a[112:115], v[40:43], v[56:59]
    v_mfma_f32_16x16x32_bf16 v[60:63], a[112:115], v[44:47], v[60:63]
    v_mfma_f32_16x16x32_bf16 v[64:67], a[112:115], v[48:51], v[64:67]
    v_mfma_f32_16x16x32_bf16 v[68:71], a[112:115], v[52:55], v[68:71]
    v_mfma_f32_16x16x32_bf16 v[72:75], a[116:119], v[36:39], v[72:75]
    v_mfma_f32_16x16x32_bf16 v[76:79], a[116:119], v[40:43], v[76:79]
    buffer_load_dwordx4 a[252:255], v5, s[8:11], s34 offen offset:3072 sc1
    s_add_u32 s34, s34, 4096
    v_mfma_f32_16x16x32_bf16 v[80:83], a[116:119], v[44:47], v[80:83]
    v_mfma_f32_16x16x32_bf16 v[84:87], a[116:119], v[48:51], v[84:87]
    buffer_load_dwordx4 a[128:131], v253, s[8:11], s32 offen offset:0 sc1
    v_mfma_f32_16x16x32_bf16 v[88:91], a[116:119], v[52:55], v[88:91]
    v_mfma_f32_16x16x32_bf16 v[92:95], v[36:39], a[120:123], v[92:95]
    buffer_load_dwordx4 a[132:135], v253, s[8:11], s33 offen offset:0 sc1
    v_mfma_f32_16x16x32_bf16 v[96:99], v[40:43], a[120:123], v[96:99]
    v_mfma_f32_16x16x32_bf16 v[100:103], v[44:47], a[120:123], v[100:103]
    buffer_load_dwordx4 a[136:139], v5, s[8:11], s34 offen offset:0 sc1
    v_mfma_f32_16x16x32_bf16 v[104:107], v[48:51], a[120:123], v[104:107]
    v_mfma_f32_16x16x32_bf16 v[108:111], v[52:55], a[120:123], v[108:111]
    v_mfma_f32_16x16x32_bf16 v[112:115], a[124:127], v[36:39], v[112:115]
    v_mfma_f32_16x16x32_bf16 v[116:119], a[124:127], v[40:43], v[116:119]
    v_mfma_f32_16x16x32_bf16 v[120:123], a[124:127], v[44:47], v[120:123]
    v_mfma_f32_16x16x32_bf16 v[124:127], a[124:127], v[48:51], v[124:127]
    v_mfma_f32_16x16x32_bf16 v[128:131], a[124:127], v[52:55], v[128:131]
    v_cvt_pk_bf16_f32 v136, v56, v57
    v_cvt_pk_bf16_f32 v137, v58, v59
    v_cvt_pk_bf16_f32 v140, v60, v61
    v_cvt_pk_bf16_f32 v141, v62, v63
    v_cvt_pk_bf16_f32 v144, v64, v65
    v_cvt_pk_bf16_f32 v145, v66, v67
    v_cvt_pk_bf16_f32 v148, v68, v69
    v_cvt_pk_bf16_f32 v149, v70, v71
    v_cvt_pk_bf16_f32 v152, v72, v73
    buffer_load_dwordx4 a[140:143], v253, s[8:11], s32 offen offset:1024 sc1
    v_cvt_pk_bf16_f32 v153, v74, v75
    v_cvt_pk_bf16_f32 v156, v76, v77
    v_cvt_pk_bf16_f32 v157, v78, v79
    v_cvt_pk_bf16_f32 v160, v80, v81
    v_cvt_pk_bf16_f32 v161, v82, v83
    v_cvt_pk_bf16_f32 v164, v84, v85
    v_cvt_pk_bf16_f32 v165, v86, v87
    v_cvt_pk_bf16_f32 v168, v88, v89
    v_cvt_pk_bf16_f32 v169, v90, v91
    buffer_load_dwordx4 a[144:147], v253, s[8:11], s33 offen offset:1024 sc1
    v_cvt_pk_bf16_f32 v134, v112, v113
    v_cvt_pk_bf16_f32 v154, v114, v115
    v_cvt_pk_bf16_f32 v138, v116, v117
    v_cvt_pk_bf16_f32 v158, v118, v119
    v_cvt_pk_bf16_f32 v142, v120, v121
    v_cvt_pk_bf16_f32 v162, v122, v123
    v_cvt_pk_bf16_f32 v146, v124, v125
    v_cvt_pk_bf16_f32 v166, v126, v127
    v_cvt_pk_bf16_f32 v150, v128, v129
    buffer_load_dwordx4 a[148:151], v5, s[8:11], s34 offen offset:1024 sc1
    v_cvt_pk_bf16_f32 v170, v130, v131
    v_cvt_pk_bf16_f32 v172, v92, v93
    v_cvt_pk_bf16_f32 v173, v94, v95
    v_cvt_pk_bf16_f32 v174, v96, v97
    v_cvt_pk_bf16_f32 v175, v98, v99
    v_cvt_pk_bf16_f32 v176, v100, v101
    v_cvt_pk_bf16_f32 v177, v102, v103
    v_cvt_pk_bf16_f32 v178, v104, v105
    v_cvt_pk_bf16_f32 v179, v106, v107
    buffer_load_dwordx4 a[152:155], v253, s[8:11], s32 offen offset:2048 sc1
    v_cvt_pk_bf16_f32 v180, v108, v109
    v_cvt_pk_bf16_f32 v181, v110, v111
    v_mfma_f32_16x16x32_bf16 v[16:19], v[152:155], v[136:139], v[208:211]
    v_mfma_f32_16x16x32_bf16 v[20:23], v[156:159], v[136:139], v[204:207]
    v_mfma_f32_16x16x32_bf16 v[24:27], v[156:159], v[140:143], v[200:203]
    v_mfma_f32_16x16x32_bf16 v[28:31], v[160:163], v[140:143], v[204:207]
    v_mfma_f32_16x16x32_bf16 v[32:35], v[160:163], v[144:147], v[200:203]
    v_mfma_f32_16x16x32_bf16 v[36:39], v[164:167], v[144:147], v[204:207]
    v_mfma_f32_16x16x32_bf16 v[40:43], v[164:167], v[148:151], v[200:203]
    buffer_load_dwordx4 a[156:159], v253, s[8:11], s33 offen offset:2048 sc1
    v_mfma_f32_16x16x32_bf16 v[44:47], v[168:171], v[148:151], v[204:207]
    v_mfma_f32_16x16x32_bf16 v[56:59], v[132:135], v[192:195], v[196:199]
    v_mfma_f32_16x16x32_bf16 v[60:63], v[136:139], v[192:195], v[196:199]
    v_mfma_f32_16x16x32_bf16 v[64:67], v[140:143], v[192:195], v[196:199]
    v_mfma_f32_16x16x32_bf16 v[68:71], v[144:147], v[192:195], v[196:199]
    v_mfma_f32_16x16x32_bf16 v[72:75], v[148:151], v[192:195], v[196:199]
    v_max3_f32 v92, v16, v17, v18
    v_max3_f32 v96, v19, v20, v21
    v_max3_f32 v93, v24, v25, v26
    buffer_load_dwordx4 a[0:3], v5, s[8:11], s34 offen offset:2048 sc1
    v_max3_f32 v97, v27, v28, v29
    v_max3_f32 v94, v32, v33, v34
    v_max3_f32 v98, v35, v36, v37
    v_max3_f32 v95, v40, v41, v42
    v_max3_f32 v99, v43, v44, v45
    v_max3_f32 v92, v92, v22, v23
    v_max3_f32 v93, v93, v30, v31
    v_max3_f32 v94, v94, v38, v39
    v_max3_f32 v95, v95, v46, v47
    buffer_load_dwordx4 a[4:7], v253, s[8:11], s32 offen offset:3072 sc1
    s_add_u32 s32, s32, 4096
    v_max_f32 v92, v92, v96
    v_max_f32 v93, v93, v97
    v_max_f32 v94, v94, v98
    v_max_f32 v95, v95, v99
    s_mov_b32 s18, 0x3eae1a93
    v_cvt_pk_bf16_f32 v182, v56, v57
    v_permlane32_swap_b32 v92, v93
    v_permlane32_swap_b32 v94, v95
    v_max_f32 v92, v92, v93
    buffer_load_dwordx4 a[8:11], v253, s[8:11], s33 offen offset:3072 sc1
    s_add_u32 s33, s33, 4096
    v_max_f32 v94, v94, v95
    v_cvt_pk_bf16_f32 v183, v58, v59
    v_cvt_pk_bf16_f32 v184, v60, v61
    v_permlane16_swap_b32 v92, v94
    v_max_f32 v92, v92, v94
    v_mul_f32 v92, 0xbeae1a93, v92
    v_mov_b32 v94, v92
    v_cvt_pk_bf16_f32 v185, v62, v63
    v_cvt_pk_bf16_f32 v186, v64, v65
    buffer_load_dwordx4 a[12:15], v5, s[8:11], s34 offen offset:3072 sc1
    s_add_u32 s34, s34, 4096
    v_permlane16_swap_b32 v92, v94
    v_mov_b32 v93, v92
    v_mov_b32 v95, v94
    v_cvt_pk_bf16_f32 v187, v66, v67
    v_cvt_pk_bf16_f32 v188, v68, v69
    v_permlane32_swap_b32 v92, v93
    v_permlane32_swap_b32 v94, v95
    v_cvt_pk_bf16_f32 v189, v70, v71
    v_cvt_pk_bf16_f32 v190, v72, v73
    buffer_load_dwordx4 a[16:19], v253, s[8:11], s32 offen offset:0 sc1
    v_cvt_pk_bf16_f32 v191, v74, v75
    v_fma_f32 v16, v16, s18, v92
    v_fma_f32 v17, v17, s18, v92
    v_fma_f32 v18, v18, s18, v92
    v_fma_f32 v19, v19, s18, v92
    v_fma_f32 v20, v20, s18, v92
    v_fma_f32 v21, v21, s18, v92
    v_fma_f32 v22, v22, s18, v92
    v_fma_f32 v23, v23, s18, v92
    buffer_load_dwordx4 a[20:23], v253, s[8:11], s33 offen offset:0 sc1
    v_exp_f32 v16, v16
    v_exp_f32 v17, v17
    v_exp_f32 v18, v18
    v_exp_f32 v19, v19
    v_exp_f32 v20, v20
    v_exp_f32 v21, v21
    v_exp_f32 v22, v22
    v_exp_f32 v23, v23
    s_nop 0
    buffer_load_dwordx4 a[24:27], v5, s[8:11], s34 offen offset:0 sc1
    v_cvt_pk_bf16_f32 v76, v16, v17
    v_cvt_pk_bf16_f32 v77, v18, v19
    v_cvt_pk_bf16_f32 v78, v20, v21
    v_cvt_pk_bf16_f32 v79, v22, v23
    v_fma_f32 v24, v24, s18, v93
    v_fma_f32 v25, v25, s18, v93
    v_fma_f32 v26, v26, s18, v93
    v_fma_f32 v27, v27, s18, v93
    v_fma_f32 v28, v28, s18, v93
    buffer_load_dwordx4 a[28:31], v253, s[8:11], s32 offen offset:1024 sc1
    v_fma_f32 v29, v29, s18, v93
    v_fma_f32 v30, v30, s18, v93
    v_fma_f32 v31, v31, s18, v93
    v_exp_f32 v24, v24
    v_exp_f32 v25, v25
    v_exp_f32 v26, v26
    v_exp_f32 v27, v27
    v_exp_f32 v28, v28
    v_exp_f32 v29, v29
    buffer_load_dwordx4 a[32:35], v253, s[8:11], s33 offen offset:1024 sc1
    v_exp_f32 v30, v30
    v_exp_f32 v31, v31
    v_mfma_f32_16x16x32_bf16 v[100:103], v[172:175], v[76:79], 0
    v_mfma_f32_16x16x32_bf16 v[116:119], v[182:185], v[76:79], 0
    v_cvt_pk_bf16_f32 v80, v24, v25
    v_cvt_pk_bf16_f32 v81, v26, v27
    v_cvt_pk_bf16_f32 v82, v28, v29
    v_cvt_pk_bf16_f32 v83, v30, v31
    v_fma_f32 v32, v32, s18, v94
    buffer_load_dwordx4 a[36:39], v5, s[8:11], s34 offen offset:1024 sc1
    v_fma_f32 v33, v33, s18, v94
    v_fma_f32 v34, v34, s18, v94
    v_fma_f32 v35, v35, s18, v94
    v_fma_f32 v36, v36, s18, v94
    v_fma_f32 v37, v37, s18, v94
    v_fma_f32 v38, v38, s18, v94
    v_fma_f32 v39, v39, s18, v94
    v_exp_f32 v32, v32
    v_exp_f32 v33, v33
    buffer_load_dwordx4 a[40:43], v253, s[8:11], s32 offen offset:2048 sc1
    v_exp_f32 v34, v34
    v_exp_f32 v35, v35
    v_exp_f32 v36, v36
    v_exp_f32 v37, v37
    v_exp_f32 v38, v38
    v_exp_f32 v39, v39
    v_mfma_f32_16x16x32_bf16 v[104:107], v[174:177], v[80:83], 0
    v_mfma_f32_16x16x32_bf16 v[120:123], v[184:187], v[80:83], 0
    v_cvt_pk_bf16_f32 v84, v32, v33
    buffer_load_dwordx4 a[44:47], v253, s[8:11], s33 offen offset:2048 sc1
    v_cvt_pk_bf16_f32 v85, v34, v35
    v_cvt_pk_bf16_f32 v86, v36, v37
    v_cvt_pk_bf16_f32 v87, v38, v39
    v_fma_f32 v40, v40, s18, v95
    v_fma_f32 v41, v41, s18, v95
    v_fma_f32 v42, v42, s18, v95
    v_fma_f32 v43, v43, s18, v95
    v_fma_f32 v44, v44, s18, v95
    v_fma_f32 v45, v45, s18, v95
    buffer_load_dwordx4 a[48:51], v5, s[8:11], s34 offen offset:2048 sc1
    v_fma_f32 v46, v46, s18, v95
    v_fma_f32 v47, v47, s18, v95
    v_exp_f32 v40, v40
    v_exp_f32 v41, v41
    v_exp_f32 v42, v42
    v_exp_f32 v43, v43
    v_exp_f32 v44, v44
    v_exp_f32 v45, v45
    v_exp_f32 v46, v46
    buffer_load_dwordx4 a[52:55], v253, s[8:11], s32 offen offset:3072 sc1
    s_add_u32 s32, s32, 4096
    v_exp_f32 v47, v47
    v_mfma_f32_16x16x32_bf16 v[108:111], v[176:179], v[84:87], 0
    v_mfma_f32_16x16x32_bf16 v[124:127], v[186:189], v[84:87], 0
    v_cvt_pk_bf16_f32 v88, v40, v41
    v_cvt_pk_bf16_f32 v89, v42, v43
    v_cvt_pk_bf16_f32 v90, v44, v45
    v_cvt_pk_bf16_f32 v91, v46, v47
    v_rcp_f32 v96, v118
    v_rcp_f32 v97, v122
    buffer_load_dwordx4 v[240:243], v9, s[8:11], s37 offen offset:0 sc1
    v_mfma_f32_16x16x32_bf16 v[112:115], v[178:181], v[88:91], 0
    v_mfma_f32_16x16x32_bf16 v[128:131], v[188:191], v[88:91], 0
    v_pk_mul_f32 v[100:101], v[96:97], v[100:101] op_sel:[0,0] op_sel_hi:[0,1]
    v_pk_mul_f32 v[102:103], v[96:97], v[102:103] op_sel:[0,0] op_sel_hi:[0,1]
    v_pk_mul_f32 v[116:117], v[96:97], v[116:117] op_sel:[0,0] op_sel_hi:[0,1]
    v_cvt_pk_bf16_f32 v212, v100, v101
    v_cvt_pk_bf16_f32 v213, v102, v103
    v_cvt_pk_bf16_f32 v220, v116, v117
    v_rcp_f32 v98, v126
    buffer_load_dwordx4 v[244:247], v9, s[8:11], s37 offen offset:1024 sc1
    v_pk_mul_f32 v[104:105], v[96:97], v[104:105] op_sel:[1,0] op_sel_hi:[1,1]
    v_pk_mul_f32 v[106:107], v[96:97], v[106:107] op_sel:[1,0] op_sel_hi:[1,1]
    v_pk_mul_f32 v[120:121], v[96:97], v[120:121] op_sel:[1,0] op_sel_hi:[1,1]
    v_cvt_pk_bf16_f32 v214, v104, v105
    v_cvt_pk_bf16_f32 v215, v106, v107
    v_cvt_pk_bf16_f32 v221, v120, v121
    v_rcp_f32 v99, v130
    v_permlane16_swap_b32 v212, v214
    v_permlane16_swap_b32 v213, v215
    buffer_load_dwordx4 v[248:251], v7, s[8:11], s37 offen offset:2048 sc1
    v_pk_mul_f32 v[108:109], v[98:99], v[108:109] op_sel:[0,0] op_sel_hi:[0,1]
    v_pk_mul_f32 v[110:111], v[98:99], v[110:111] op_sel:[0,0] op_sel_hi:[0,1]
    v_pk_mul_f32 v[124:125], v[98:99], v[124:125] op_sel:[0,0] op_sel_hi:[0,1]
    v_cvt_pk_bf16_f32 v216, v108, v109
    v_cvt_pk_bf16_f32 v217, v110, v111
    v_cvt_pk_bf16_f32 v222, v124, v125
    v_pk_mul_f32 v[112:113], v[98:99], v[112:113] op_sel:[1,0] op_sel_hi:[1,1]
    v_pk_mul_f32 v[114:115], v[98:99], v[114:115] op_sel:[1,0] op_sel_hi:[1,1]
    v_pk_mul_f32 v[128:129], v[98:99], v[128:129] op_sel:[1,0] op_sel_hi:[1,1]
    buffer_load_dword v252, v8, s[8:11], s47 offen sc1
    v_cvt_pk_bf16_f32 v218, v112, v113
    v_cvt_pk_bf16_f32 v219, v114, v115
    v_cvt_pk_bf16_f32 v223, v128, v129
    s_lshl_b32 s7, s3, 2
    s_add_u32 s7, s7, 94208
    v_permlane16_swap_b32 v220, v221
    v_permlane16_swap_b32 v222, v223
    v_add_u32 v11, s7, v253
    v_lshrrev_b32 v10, 3, v0
    v_permlane32_swap_b32 v220, v222
    v_mul_u32_u24 v10, 9216, v10
    ds_write_b32 v11, v220
    v_permlane16_swap_b32 v216, v218
    v_permlane16_swap_b32 v217, v219
    s_mul_i32 s7, s40, 1152
    s_add_u32 s22, s22, s7
    s_add_u32 s22, s22, 41156608
    s_lshl_b32 s7, s3, 8
    s_add_u32 s23, s22, s7
    s_add_u32 s24, s23, 36864
    buffer_store_dwordx4 v[212:215], v9, s[8:11], s23 offen sc1
    buffer_store_dwordx4 v[216:219], v9, s[8:11], s24 offen sc1
    v_and_b32 v11, 7, v0
    v_lshl_add_u32 v10, v11, 4, v10
    s_cmp_eq_u32 s3, 3
    s_cselect_b32 s7, 0, 1073741824
    v_add_u32 v10, s7, v10
    v_add_u32 v11, 94208, v253
    s_waitcnt lgkmcnt(0)
    s_barrier
    ds_read_b128 v[220:223], v11
    s_waitcnt lgkmcnt(0)
    buffer_store_dwordx4 v[220:223], v10, s[8:11], s22 offen offset:1024 sc1
    v_lshlrev_b32 v15, 7, v0
    s_lshl_b32 s6, s40, 2
    s_add_u32 s6, s6, s44
    v_mov_b32 v1, s76
    s_mov_b64 vcc, 0xff
    s_waitcnt vmcnt(0)
    s_barrier
    s_cmp_lg_u32 s3, 0
    s_cbranch_scc1 L_pub_17
    s_mov_b64 exec, vcc
    buffer_store_dword v1, v15, s[8:11], s6 offen sc1
L_pub_17:
    s_mov_b64 exec, -1
    buffer_load_dwordx4 a[56:59], v253, s[8:11], s33 offen offset:3072 sc1
    s_add_u32 s33, s33, 4096
    buffer_load_dwordx4 a[60:63], v5, s[8:11], s34 offen offset:3072 sc1
    s_add_u32 s34, s34, 4096
    buffer_load_dwordx4 a[64:67], v253, s[8:11], s32 offen offset:0 sc1
    buffer_load_dwordx4 a[68:71], v253, s[8:11], s33 offen offset:0 sc1
    buffer_load_dwordx4 a[72:75], v5, s[8:11], s34 offen offset:0 sc1
    buffer_load_dwordx4 a[76:79], v253, s[8:11], s32 offen offset:1024 sc1
    buffer_load_dwordx4 a[80:83], v253, s[8:11], s33 offen offset:1024 sc1
    buffer_load_dwordx4 a[84:87], v5, s[8:11], s34 offen offset:1024 sc1
    s_cmp_lg_u32 s42, 0
    s_cbranch_scc1 L_swz_18
    s_cmp_eq_u32 s93, 2
    s_cselect_b32 s6, 2, 3
    s_mov_b32 s7, 512
    s_cmov_b32 s7, 2048
    v_lshrrev_b32 v14, 4, v0
    v_lshlrev_b32 v14, s6, v14
    v_bfe_u32 v15, v0, 2, 2
    v_add_u32 v14, v14, v15
    v_mul_u32_u24 v14, 128, v14
    v_and_b32 v15, 3, v0
    v_lshl_add_u32 v14, v15, 3, v14
    v_add_u32 v14, s79, v14
    v_add_u32 v15, s7, v14
    ds_read_b64_tr_b16 v[76:77], v14 offset:0
    ds_read_b64_tr_b16 v[78:79], v15 offset:0
    ds_read_b64_tr_b16 v[80:81], v14 offset:32
    ds_read_b64_tr_b16 v[82:83], v15 offset:32
    ds_read_b64_tr_b16 v[84:85], v14 offset:64
    ds_read_b64_tr_b16 v[86:87], v15 offset:64
    ds_read_b64_tr_b16 v[88:89], v14 offset:96
    ds_read_b64_tr_b16 v[90:91], v15 offset:96
    ds_read_b64_tr_b16 v[92:93], v14 offset:4096
    ds_read_b64_tr_b16 v[94:95], v15 offset:4096
    ds_read_b64_tr_b16 v[96:97], v14 offset:4128
    ds_read_b64_tr_b16 v[98:99], v15 offset:4128
    ds_read_b64_tr_b16 v[176:177], v14 offset:4160
    ds_read_b64_tr_b16 v[178:179], v15 offset:4160
    ds_read_b64_tr_b16 v[180:181], v14 offset:4192
    ds_read_b64_tr_b16 v[182:183], v15 offset:4192
    ds_read_b64_tr_b16 v[196:197], v14 offset:8192
    ds_read_b64_tr_b16 v[198:199], v15 offset:8192
    ds_read_b64_tr_b16 v[200:201], v14 offset:8224
    ds_read_b64_tr_b16 v[202:203], v15 offset:8224
    ds_read_b64_tr_b16 v[204:205], v14 offset:8256
    ds_read_b64_tr_b16 v[206:207], v15 offset:8256
    ds_read_b64_tr_b16 v[208:209], v14 offset:8288
    ds_read_b64_tr_b16 v[210:211], v15 offset:8288
    ds_read_b64_tr_b16 v[212:213], v14 offset:12288
    ds_read_b64_tr_b16 v[214:215], v15 offset:12288
    ds_read_b64_tr_b16 v[216:217], v14 offset:12320
    ds_read_b64_tr_b16 v[218:219], v15 offset:12320
    ds_read_b64_tr_b16 v[220:221], v14 offset:12352
    ds_read_b64_tr_b16 v[222:223], v15 offset:12352
    ds_read_b64_tr_b16 v[228:229], v14 offset:12384
    ds_read_b64_tr_b16 v[230:231], v15 offset:12384
    s_mul_i32 s68, s40, 1990656
    s_add_u32 s68, s68, 3145728
    s_cmp_eq_u32 s93, 2
    s_cbranch_scc1 L_swz_down_19
    s_mul_i32 s6, s84, 349526
    s_lshr_b32 s6, s6, 20
    s_mul_i32 s7, s6, 3
    s_sub_u32 s7, s84, s7
    s_mul_i32 s6, s6, 6
    s_add_u32 s7, s7, s6
    s_mul_i32 s6, s88, 36
    s_add_u32 s7, s7, s6
    s_mul_i32 s6, s93, 3
    s_add_u32 s7, s7, s6
    s_lshl_b32 s7, s7, 10
    s_add_u32 s7, s7, s68
    s_add_u32 s80, s7, 0
    s_add_u32 s81, s7, 497664
    s_add_u32 s82, s7, 995328
    s_add_u32 s83, s7, 1492992
    s_mul_i32 s6, s85, 349526
    s_lshr_b32 s6, s6, 20
    s_mul_i32 s7, s6, 3
    s_sub_u32 s7, s85, s7
    s_mul_i32 s6, s6, 6
    s_add_u32 s7, s7, s6
    s_mul_i32 s6, s89, 36
    s_add_u32 s7, s7, s6
    s_mul_i32 s6, s93, 3
    s_add_u32 s7, s7, s6
    s_lshl_b32 s7, s7, 10
    s_add_u32 s7, s7, s68
    s_add_u32 s64, s7, 0
    s_add_u32 s65, s7, 497664
    s_add_u32 s18, s7, 995328
    s_add_u32 s19, s7, 1492992
    s_mul_i32 s6, s86, 349526
    s_lshr_b32 s6, s6, 20
    s_mul_i32 s7, s6, 3
    s_sub_u32 s7, s86, s7
    s_mul_i32 s6, s6, 6
    s_add_u32 s7, s7, s6
    s_mul_i32 s6, s90, 36
    s_add_u32 s7, s7, s6
    s_mul_i32 s6, s93, 3
    s_add_u32 s7, s7, s6
    s_lshl_b32 s7, s7, 10
    s_add_u32 s7, s7, s68
    s_add_u32 s20, s7, 0
    s_add_u32 s21, s7, 497664
    s_add_u32 s22, s7, 995328
    s_add_u32 s25, s7, 1492992
    s_mul_i32 s6, s87, 349526
    s_lshr_b32 s6, s6, 20
    s_mul_i32 s7, s6, 3
    s_sub_u32 s7, s87, s7
    s_mul_i32 s6, s6, 6
    s_add_u32 s7, s7, s6
    s_mul_i32 s6, s91, 36
    s_add_u32 s7, s7, s6
    s_mul_i32 s6, s93, 3
    s_add_u32 s7, s7, s6
    s_lshl_b32 s7, s7, 10
    s_add_u32 s7, s7, s68
    s_add_u32 s26, s7, 0
    s_add_u32 s27, s7, 497664
    s_add_u32 s28, s7, 995328
    s_add_u32 s29, s7, 1492992
    s_branch L_swz_dest_20
L_swz_down_19:
    s_mul_i32 s7, s88, 18
    s_add_u32 s7, s7, s84
    s_add_u32 s7, s7, 324
    s_lshl_b32 s7, s7, 10
    s_add_u32 s7, s7, s68
    s_add_u32 s80, s7, 0
    s_add_u32 s81, s7, 497664
    s_add_u32 s82, s7, 995328
    s_add_u32 s83, s7, 1492992
    s_mul_i32 s7, s89, 18
    s_add_u32 s7, s7, s85
    s_add_u32 s7, s7, 324
    s_lshl_b32 s7, s7, 10
    s_add_u32 s7, s7, s68
    s_add_u32 s64, s7, 0
    s_add_u32 s65, s7, 497664
    s_add_u32 s18, s7, 995328
    s_add_u32 s19, s7, 1492992
    s_mul_i32 s7, s90, 18
    s_add_u32 s7, s7, s86
    s_add_u32 s7, s7, 324
    s_lshl_b32 s7, s7, 10
    s_add_u32 s7, s7, s68
    s_add_u32 s20, s7, 0
    s_add_u32 s21, s7, 497664
    s_add_u32 s22, s7, 995328
    s_add_u32 s25, s7, 1492992
    s_mul_i32 s7, s91, 18
    s_add_u32 s7, s7, s87
    s_add_u32 s7, s7, 324
    s_lshl_b32 s7, s7, 10
    s_add_u32 s7, s7, s68
    s_add_u32 s26, s7, 0
    s_add_u32 s27, s7, 497664
    s_add_u32 s28, s7, 995328
    s_add_u32 s29, s7, 1492992
L_swz_dest_20:
    s_mov_b32 s72, s8
    s_mov_b32 s73, s9
    s_mov_b32 s74, 268435456
    s_waitcnt lgkmcnt(0)
    buffer_store_dwordx4 v[76:79], v253, s[72:75], s80 offen sc1
    buffer_store_dwordx4 v[80:83], v253, s[72:75], s81 offen sc1
    buffer_store_dwordx4 v[84:87], v253, s[72:75], s82 offen sc1
    buffer_store_dwordx4 v[88:91], v253, s[72:75], s83 offen sc1
    buffer_store_dwordx4 v[92:95], v253, s[72:75], s64 offen sc1
    buffer_store_dwordx4 v[96:99], v253, s[72:75], s65 offen sc1
    buffer_store_dwordx4 v[176:179], v253, s[72:75], s18 offen sc1
    buffer_store_dwordx4 v[180:183], v253, s[72:75], s19 offen sc1
    buffer_store_dwordx4 v[196:199], v253, s[72:75], s20 offen sc1
    buffer_store_dwordx4 v[200:203], v253, s[72:75], s21 offen sc1
    buffer_store_dwordx4 v[204:207], v253, s[72:75], s22 offen sc1
    buffer_store_dwordx4 v[208:211], v253, s[72:75], s25 offen sc1
    buffer_store_dwordx4 v[212:215], v253, s[72:75], s26 offen sc1
    buffer_store_dwordx4 v[216:219], v253, s[72:75], s27 offen sc1
    buffer_store_dwordx4 v[220:223], v253, s[72:75], s28 offen sc1
    buffer_store_dwordx4 v[228:231], v253, s[72:75], s29 offen sc1
    s_lshr_b32 s7, s2, 3
    s_lshl_b32 s7, s7, 2
    s_add_u32 s7, s7, s3
    s_lshl_b32 s7, s7, 9
    v_lshrrev_b32 v1, 1, v253
    v_add_u32 v1, s7, v1
    buffer_load_dwordx2 v[14:15], v1, s[96:99], 0 offen
L_swz_18:
    s_and_b32 s7, s3, 1
    s_mul_i32 s7, s7, 18432
    s_add_u32 s24, s30, s7
    s_lshr_b32 s7, s3, 1
    s_lshl_b32 s7, s7, 9
    s_add_u32 s24, s24, s7
    s_add_u32 s24, s24, 41156608
    s_mov_b32 s16, 0xffff0000
    v_lshlrev_b32 v124, 16, v240
    v_and_b32 v125, s16, v240
    v_lshlrev_b32 v126, 16, v241
    v_and_b32 v127, s16, v241
    v_lshlrev_b32 v128, 16, v242
    v_and_b32 v129, s16, v242
    v_lshlrev_b32 v130, 16, v243
    v_and_b32 v131, s16, v243
    v_lshlrev_b32 v132, 16, v244
    v_and_b32 v133, s16, v244
    v_lshlrev_b32 v134, 16, v245
    v_and_b32 v135, s16, v245
    v_lshlrev_b32 v136, 16, v246
    v_and_b32 v137, s16, v246
    v_lshlrev_b32 v138, 16, v247
    v_and_b32 v139, s16, v247
    v_lshlrev_b32 v140, 16, v248
    v_and_b32 v141, s16, v248
    v_lshlrev_b32 v142, 16, v249
    v_and_b32 v143, s16, v249
    v_lshlrev_b32 v144, 16, v250
    v_and_b32 v145, s16, v250
    v_lshlrev_b32 v146, 16, v251
    v_and_b32 v147, s16, v251
    s_cmp_eq_u32 s3, 1
    s_cselect_b32 s7, 16, 0
    v_lshlrev_b32 v12, 2, v0
    v_cmp_gt_u32 vcc, s7, v0
    v_add_u32 v10, 40960, v12
    v_add_u32 v11, 41472, v12
    v_cndmask_b32 v10, v11, v10, vcc
    v_and_b32 v11, 0x7c, v12
    v_cmp_gt_u32 vcc, 32, v0
    v_mov_b32 v13, 1073741824
    s_and_b32 s7, s40, 3
    s_lshl_b32 s45, s45, 2
    v_cndmask_b32 v8, v13, v12, vcc
    s_add_u32 s6, s7, s3
    s_cmp_eq_u32 s6, 0
    s_cselect_b32 s6, 0, 1073741824
    v_add_u32 v6, s6, v8
    s_add_u32 s45, s45, s7
    s_lshl_b32 s45, s45, 2
    s_add_u32 s45, s45, s3
    s_lshl_b32 s45, s45, 7
    s_add_u32 s45, s45, s43
    s_add_u32 s45, s45, 48300032
    s_cmp_eq_u32 s3, 0
    s_cselect_b32 s35, 1.0, 0
    s_lshl_b32 s7, s40, 2
    s_add_u32 s7, s7, s3
    s_mul_i32 s23, s7, 497664
    s_add_u32 s23, s23, 3145728
    s_add_u32 s50, s23, 497664
    s_mul_i32 s50, s50, s42
    v_mov_b32 v184, v253
    v_add_u32 v185, 4096, v253
    v_add_u32 v186, 8192, v253
    v_add_u32 v187, 12288, v253
    v_add_u32 v188, 16384, v253
    v_add_u32 v189, 20480, v253
    v_add_u32 v190, 24576, v253
    v_add_u32 v191, 28672, v253
    v_add_u32 v192, 32768, v253
    s_cmp_lg_u32 s3, 3
    s_cbranch_scc1 L_pollout_23
    s_lshl_b32 s7, s40, 7
    s_add_u32 s7, s7, s44
    s_add_u32 s52, s4, s7
    s_addc_u32 s53, s5, 0
    s_mov_b32 s6, 0
L_poll_21:
    s_load_dwordx8 s[56:63], s[52:53], 0 glc
    s_add_u32 s6, s6, 1
    s_waitcnt lgkmcnt(0)
    s_xor_b64 s[56:57], s[56:57], s[76:77]
    s_xor_b64 s[58:59], s[58:59], s[76:77]
    s_xor_b64 s[60:61], s[60:61], s[76:77]
    s_xor_b64 s[62:63], s[62:63], s[76:77]
    s_or_b64 s[56:57], s[56:57], s[58:59]
    s_or_b64 s[60:61], s[60:61], s[62:63]
    s_or_b64 s[56:57], s[56:57], s[60:61]
    s_cbranch_scc0 L_polled_22
    s_cmp_lt_u32 s6, 1048576
    s_cbranch_scc1 L_poll_21
    s_branch L_main_end
L_polled_22:
L_pollout_23:
    s_barrier
    s_lshl_b32 m0, s3, 10
    s_nop 0
    buffer_load_dwordx4 v2, s[8:11], s24 offen sc1 lds
    s_add_u32 m0, m0, 4096
    s_add_u32 s24, s24, 1024
    buffer_load_dwordx4 v2, s[8:11], s24 offen sc1 lds
    s_add_u32 m0, m0, 4096
    s_add_u32 s24, s24, 1024
    buffer_load_dwordx4 v2, s[8:11], s24 offen sc1 lds
    s_add_u32 m0, m0, 4096
    s_add_u32 s24, s24, 1024
    buffer_load_dwordx4 v2, s[8:11], s24 offen sc1 lds
    s_add_u32 m0, m0, 4096
    s_add_u32 s24, s24, 1024
    buffer_load_dwordx4 v2, s[8:11], s24 offen sc1 lds
    s_add_u32 m0, m0, 4096
    s_add_u32 s24, s24, 1024
    buffer_load_dwordx4 v2, s[8:11], s24 offen sc1 lds
    s_add_u32 m0, m0, 4096
    s_add_u32 s24, s24, 1024
    buffer_load_dwordx4 v2, s[8:11], s24 offen sc1 lds
    s_add_u32 m0, m0, 4096
    s_add_u32 s24, s24, 1024
    buffer_load_dwordx4 v2, s[8:11], s24 offen sc1 lds
    s_add_u32 m0, m0, 4096
    s_add_u32 s24, s24, 1024
    buffer_load_dwordx4 v2, s[8:11], s24 offen sc1 lds
    s_waitcnt vmcnt(0)
    s_barrier
    s_add_u32 s7, s42, s3
    s_cmp_lg_u32 s7, 0
    s_cbranch_scc1 L_swz_24
    v_lshlrev_b32 v15, 10, v0
    s_lshl_b32 s6, s40, 7
    s_lshl_b32 s7, s41, 2
    s_add_u32 s6, s6, s7
    s_add_u32 s6, s6, 19464192
    s_mov_b64 exec, 0xffffffff
    v_lshlrev_b32 v15, 10, v0
    v_mov_b32 v1, s76
    buffer_store_dword v1, v15, s[8:11], s6 offen sc1
    s_mov_b64 exec, -1
L_swz_24:
    ds_read_b128 v[160:163], v253 offset:0
    ds_read_b128 v[164:167], v253 offset:1024
    s_waitcnt lgkmcnt(0)
    v_mfma_f32_16x16x32_bf16 v[100:103], a[160:163], v[160:163], 0
    ds_read_b128 v[168:171], v253 offset:2048
    v_mfma_f32_16x16x32_bf16 v[104:107], a[160:163], v[164:167], 0
    ds_read_b128 v[172:175], v253 offset:3072
    v_mfma_f32_16x16x32_bf16 v[108:111], a[164:167], v[160:163], 0
    v_mfma_f32_16x16x32_bf16 v[112:115], a[164:167], v[164:167], 0
    buffer_load_dwordx4 v[16:19], v184, s[48:51], s23 offen offset:0 sc1
    v_mfma_f32_16x16x32_bf16 v[116:119], a[168:171], v[160:163], 0
    v_mfma_f32_16x16x32_bf16 v[120:123], a[168:171], v[164:167], 0
    s_waitcnt lgkmcnt(0)
    v_mfma_f32_16x16x32_bf16 v[100:103], a[172:175], v[168:171], v[100:103]
    ds_read_b128 v[160:163], v253 offset:4096
    v_mfma_f32_16x16x32_bf16 v[104:107], a[172:175], v[172:175], v[104:107]
    ds_read_b128 v[164:167], v253 offset:5120
    v_mfma_f32_16x16x32_bf16 v[108:111], a[176:179], v[168:171], v[108:111]
    v_mfma_f32_16x16x32_bf16 v[112:115], a[176:179], v[172:175], v[112:115]
    buffer_load_dwordx4 v[20:23], v184, s[48:51], s23 offen offset:1024 sc1
    v_mfma_f32_16x16x32_bf16 v[116:119], a[180:183], v[168:171], v[116:119]
    v_mfma_f32_16x16x32_bf16 v[120:123], a[180:183], v[172:175], v[120:123]
    s_waitcnt lgkmcnt(0)
    v_mfma_f32_16x16x32_bf16 v[100:103], a[184:187], v[160:163], v[100:103]
    ds_read_b128 v[168:171], v253 offset:6144
    v_mfma_f32_16x16x32_bf16 v[104:107], a[184:187], v[164:167], v[104:107]
    ds_read_b128 v[172:175], v253 offset:7168
    v_mfma_f32_16x16x32_bf16 v[108:111], a[188:191], v[160:163], v[108:111]
    v_mfma_f32_16x16x32_bf16 v[112:115], a[188:191], v[164:167], v[112:115]
    buffer_load_dwordx4 v[24:27], v184, s[48:51], s23 offen offset:2048 sc1
    v_mfma_f32_16x16x32_bf16 v[116:119], a[192:195], v[160:163], v[116:119]
    v_mfma_f32_16x16x32_bf16 v[120:123], a[192:195], v[164:167], v[120:123]
    s_waitcnt lgkmcnt(0)
    v_mfma_f32_16x16x32_bf16 v[100:103], a[196:199], v[168:171], v[100:103]
    ds_read_b128 v[160:163], v253 offset:8192
    v_mfma_f32_16x16x32_bf16 v[104:107], a[196:199], v[172:175], v[104:107]
    ds_read_b128 v[164:167], v253 offset:9216
    v_mfma_f32_16x16x32_bf16 v[108:111], a[200:203], v[168:171], v[108:111]
    v_mfma_f32_16x16x32_bf16 v[112:115], a[200:203], v[172:175], v[112:115]
    buffer_load_dwordx4 v[28:31], v184, s[48:51], s23 offen offset:3072 sc1
    v_mfma_f32_16x16x32_bf16 v[116:119], a[204:207], v[168:171], v[116:119]
    v_mfma_f32_16x16x32_bf16 v[120:123], a[204:207], v[172:175], v[120:123]
    s_waitcnt lgkmcnt(0)
    v_mfma_f32_16x16x32_bf16 v[100:103], a[208:211], v[160:163], v[100:103]
    ds_read_b128 v[168:171], v253 offset:10240
    v_mfma_f32_16x16x32_bf16 v[104:107], a[208:211], v[164:167], v[104:107]
    ds_read_b128 v[172:175], v253 offset:11264
    v_mfma_f32_16x16x32_bf16 v[108:111], a[212:215], v[160:163], v[108:111]
    v_mfma_f32_16x16x32_bf16 v[112:115], a[212:215], v[164:167], v[112:115]
    buffer_load_dwordx4 v[32:35], v185, s[48:51], s23 offen offset:0 sc1
    v_mfma_f32_16x16x32_bf16 v[116:119], a[216:219], v[160:163], v[116:119]
    v_mfma_f32_16x16x32_bf16 v[120:123], a[216:219], v[164:167], v[120:123]
    s_waitcnt lgkmcnt(0)
    v_mfma_f32_16x16x32_bf16 v[100:103], a[220:223], v[168:171], v[100:103]
    ds_read_b128 v[160:163], v253 offset:12288
    v_mfma_f32_16x16x32_bf16 v[104:107], a[220:223], v[172:175], v[104:107]
    ds_read_b128 v[164:167], v253 offset:13312
    v_mfma_f32_16x16x32_bf16 v[108:111], a[224:227], v[168:171], v[108:111]
    v_mfma_f32_16x16x32_bf16 v[112:115], a[224:227], v[172:175], v[112:115]
    buffer_load_dwordx4 v[36:39], v185, s[48:51], s23 offen offset:1024 sc1
    v_mfma_f32_16x16x32_bf16 v[116:119], a[228:231], v[168:171], v[116:119]
    v_mfma_f32_16x16x32_bf16 v[120:123], a[228:231], v[172:175], v[120:123]
    s_waitcnt lgkmcnt(0)
    v_mfma_f32_16x16x32_bf16 v[100:103], a[232:235], v[160:163], v[100:103]
    ds_read_b128 v[168:171], v253 offset:14336
    v_mfma_f32_16x16x32_bf16 v[104:107], a[232:235], v[164:167], v[104:107]
    ds_read_b128 v[172:175], v253 offset:15360
    v_mfma_f32_16x16x32_bf16 v[108:111], a[236:239], v[160:163], v[108:111]
    v_mfma_f32_16x16x32_bf16 v[112:115], a[236:239], v[164:167], v[112:115]
    buffer_load_dwordx4 v[40:43], v185, s[48:51], s23 offen offset:2048 sc1
    v_mfma_f32_16x16x32_bf16 v[116:119], a[240:243], v[160:163], v[116:119]
    v_mfma_f32_16x16x32_bf16 v[120:123], a[240:243], v[164:167], v[120:123]
    s_waitcnt lgkmcnt(0)
    v_mfma_f32_16x16x32_bf16 v[100:103], a[244:247], v[168:171], v[100:103]
    ds_read_b128 v[160:163], v253 offset:16384
    v_mfma_f32_16x16x32_bf16 v[104:107], a[244:247], v[172:175], v[104:107]
    ds_read_b128 v[164:167], v253 offset:17408
    v_mfma_f32_16x16x32_bf16 v[108:111], a[248:251], v[168:171], v[108:111]
    v_mfma_f32_16x16x32_bf16 v[112:115], a[248:251], v[172:175], v[112:115]
    buffer_load_dwordx4 v[44:47], v185, s[48:51], s23 offen offset:3072 sc1
    v_mfma_f32_16x16x32_bf16 v[116:119], a[252:255], v[168:171], v[116:119]
    v_mfma_f32_16x16x32_bf16 v[120:123], a[252:255], v[172:175], v[120:123]
    s_waitcnt lgkmcnt(0)
    v_mfma_f32_16x16x32_bf16 v[100:103], a[128:131], v[160:163], v[100:103]
    ds_read_b128 v[168:171], v253 offset:18432
    v_mfma_f32_16x16x32_bf16 v[104:107], a[128:131], v[164:167], v[104:107]
    ds_read_b128 v[172:175], v253 offset:19456
    v_mfma_f32_16x16x32_bf16 v[108:111], a[132:135], v[160:163], v[108:111]
    v_mfma_f32_16x16x32_bf16 v[112:115], a[132:135], v[164:167], v[112:115]
    buffer_load_dwordx4 v[48:51], v186, s[48:51], s23 offen offset:0 sc1
    v_mfma_f32_16x16x32_bf16 v[116:119], a[136:139], v[160:163], v[116:119]
    v_mfma_f32_16x16x32_bf16 v[120:123], a[136:139], v[164:167], v[120:123]
    s_waitcnt lgkmcnt(0)
    v_mfma_f32_16x16x32_bf16 v[100:103], a[140:143], v[168:171], v[100:103]
    ds_read_b128 v[160:163], v253 offset:20480
    v_mfma_f32_16x16x32_bf16 v[104:107], a[140:143], v[172:175], v[104:107]
    ds_read_b128 v[164:167], v253 offset:21504
    v_mfma_f32_16x16x32_bf16 v[108:111], a[144:147], v[168:171], v[108:111]
    v_mfma_f32_16x16x32_bf16 v[112:115], a[144:147], v[172:175], v[112:115]
    buffer_load_dwordx4 v[52:55], v186, s[48:51], s23 offen offset:1024 sc1
    v_mfma_f32_16x16x32_bf16 v[116:119], a[148:151], v[168:171], v[116:119]
    v_mfma_f32_16x16x32_bf16 v[120:123], a[148:151], v[172:175], v[120:123]
    s_waitcnt lgkmcnt(0)
    v_mfma_f32_16x16x32_bf16 v[100:103], a[152:155], v[160:163], v[100:103]
    ds_read_b128 v[168:171], v253 offset:22528
    v_mfma_f32_16x16x32_bf16 v[104:107], a[152:155], v[164:167], v[104:107]
    ds_read_b128 v[172:175], v253 offset:23552
    v_mfma_f32_16x16x32_bf16 v[108:111], a[156:159], v[160:163], v[108:111]
    v_mfma_f32_16x16x32_bf16 v[112:115], a[156:159], v[164:167], v[112:115]
    buffer_load_dwordx4 v[56:59], v186, s[48:51], s23 offen offset:2048 sc1
    v_mfma_f32_16x16x32_bf16 v[116:119], a[0:3], v[160:163], v[116:119]
    v_mfma_f32_16x16x32_bf16 v[120:123], a[0:3], v[164:167], v[120:123]
    s_waitcnt lgkmcnt(0)
    v_mfma_f32_16x16x32_bf16 v[100:103], a[4:7], v[168:171], v[100:103]
    ds_read_b128 v[160:163], v253 offset:24576
    v_mfma_f32_16x16x32_bf16 v[104:107], a[4:7], v[172:175], v[104:107]
    ds_read_b128 v[164:167], v253 offset:25600
    v_mfma_f32_16x16x32_bf16 v[108:111], a[8:11], v[168:171], v[108:111]
    v_mfma_f32_16x16x32_bf16 v[112:115], a[8:11], v[172:175], v[112:115]
    buffer_load_dwordx4 v[60:63], v186, s[48:51], s23 offen offset:3072 sc1
    v_mfma_f32_16x16x32_bf16 v[116:119], a[12:15], v[168:171], v[116:119]
    v_mfma_f32_16x16x32_bf16 v[120:123], a[12:15], v[172:175], v[120:123]
    s_waitcnt lgkmcnt(0)
    v_mfma_f32_16x16x32_bf16 v[100:103], a[16:19], v[160:163], v[100:103]
    ds_read_b128 v[168:171], v253 offset:26624
    v_mfma_f32_16x16x32_bf16 v[104:107], a[16:19], v[164:167], v[104:107]
    ds_read_b128 v[172:175], v253 offset:27648
    v_mfma_f32_16x16x32_bf16 v[108:111], a[20:23], v[160:163], v[108:111]
    v_mfma_f32_16x16x32_bf16 v[112:115], a[20:23], v[164:167], v[112:115]
    buffer_load_dwordx4 v[64:67], v187, s[48:51], s23 offen offset:0 sc1
    v_mfma_f32_16x16x32_bf16 v[116:119], a[24:27], v[160:163], v[116:119]
    v_mfma_f32_16x16x32_bf16 v[120:123], a[24:27], v[164:167], v[120:123]
    s_waitcnt lgkmcnt(0)
    v_mfma_f32_16x16x32_bf16 v[100:103], a[28:31], v[168:171], v[100:103]
    ds_read_b128 v[160:163], v253 offset:28672
    v_mfma_f32_16x16x32_bf16 v[104:107], a[28:31], v[172:175], v[104:107]
    ds_read_b128 v[164:167], v253 offset:29696
    v_mfma_f32_16x16x32_bf16 v[108:111], a[32:35], v[168:171], v[108:111]
    v_mfma_f32_16x16x32_bf16 v[112:115], a[32:35], v[172:175], v[112:115]
    buffer_load_dwordx4 v[68:71], v187, s[48:51], s23 offen offset:1024 sc1
    v_mfma_f32_16x16x32_bf16 v[116:119], a[36:39], v[168:171], v[116:119]
    v_mfma_f32_16x16x32_bf16 v[120:123], a[36:39], v[172:175], v[120:123]
    s_waitcnt lgkmcnt(0)
    v_mfma_f32_16x16x32_bf16 v[100:103], a[40:43], v[160:163], v[100:103]
    ds_read_b128 v[168:171], v253 offset:30720
    v_mfma_f32_16x16x32_bf16 v[104:107], a[40:43], v[164:167], v[104:107]
    ds_read_b128 v[172:175], v253 offset:31744
    v_mfma_f32_16x16x32_bf16 v[108:111], a[44:47], v[160:163], v[108:111]
    v_mfma_f32_16x16x32_bf16 v[112:115], a[44:47], v[164:167], v[112:115]
    buffer_load_dwordx4 v[72:75], v187, s[48:51], s23 offen offset:2048 sc1
    v_mfma_f32_16x16x32_bf16 v[116:119], a[48:51], v[160:163], v[116:119]
    v_mfma_f32_16x16x32_bf16 v[120:123], a[48:51], v[164:167], v[120:123]
    s_waitcnt lgkmcnt(0)
    v_mfma_f32_16x16x32_bf16 v[100:103], a[52:55], v[168:171], v[100:103]
    ds_read_b128 v[160:163], v253 offset:32768
    v_mfma_f32_16x16x32_bf16 v[104:107], a[52:55], v[172:175], v[104:107]
    ds_read_b128 v[164:167], v253 offset:33792
    v_mfma_f32_16x16x32_bf16 v[108:111], a[56:59], v[168:171], v[108:111]
    v_mfma_f32_16x16x32_bf16 v[112:115], a[56:59], v[172:175], v[112:115]
    v_mfma_f32_16x16x32_bf16 v[116:119], a[60:63], v[168:171], v[116:119]
    v_mfma_f32_16x16x32_bf16 v[120:123], a[60:63], v[172:175], v[120:123]
    s_waitcnt lgkmcnt(0)
    v_mfma_f32_16x16x32_bf16 v[100:103], a[64:67], v[160:163], v[100:103]
    ds_read_b128 v[168:171], v253 offset:34816
    v_mfma_f32_16x16x32_bf16 v[104:107], a[64:67], v[164:167], v[104:107]
    ds_read_b128 v[172:175], v253 offset:35840
    v_mfma_f32_16x16x32_bf16 v[108:111], a[68:71], v[160:163], v[108:111]
    v_mfma_f32_16x16x32_bf16 v[112:115], a[68:71], v[164:167], v[112:115]
    v_mfma_f32_16x16x32_bf16 v[116:119], a[72:75], v[160:163], v[116:119]
    v_mfma_f32_16x16x32_bf16 v[120:123], a[72:75], v[164:167], v[120:123]
    s_waitcnt lgkmcnt(0)
    v_mfma_f32_16x16x32_bf16 v[100:103], a[76:79], v[168:171], v[100:103]
    v_mfma_f32_16x16x32_bf16 v[104:107], a[76:79], v[172:175], v[104:107]
    v_mfma_f32_16x16x32_bf16 v[108:111], a[80:83], v[168:171], v[108:111]
    v_mfma_f32_16x16x32_bf16 v[112:115], a[80:83], v[172:175], v[112:115]
    v_mfma_f32_16x16x32_bf16 v[116:119], a[84:87], v[168:171], v[116:119]
    v_mfma_f32_16x16x32_bf16 v[120:123], a[84:87], v[172:175], v[120:123]
    s_nop 3
    v_permlane16_swap_b32 v100, v104
    v_permlane16_swap_b32 v101, v105
    v_permlane16_swap_b32 v102, v106
    v_permlane16_swap_b32 v103, v107
    v_add_f32 v12, v116, v117
    v_add_f32 v13, v120, v121
    ds_write_b32 v10, v12
    ds_write_b32 v10, v13 offset:64
    v_permlane16_swap_b32 v108, v112
    v_permlane16_swap_b32 v109, v113
    v_permlane16_swap_b32 v110, v114
    v_permlane16_swap_b32 v111, v115
    v_permlane16_swap_b32 v116, v120
    v_permlane16_swap_b32 v117, v121
    v_permlane16_swap_b32 v118, v122
    v_permlane16_swap_b32 v119, v123
    s_waitcnt lgkmcnt(0)
    s_barrier
    ds_read_b32 v12, v11 offset:40960
    v_pk_add_f32 v[124:125], v[124:125], v[100:101]
    v_pk_add_f32 v[126:127], v[126:127], v[102:103]
    v_pk_add_f32 v[128:129], v[128:129], v[104:105]
    v_pk_add_f32 v[130:131], v[130:131], v[106:107]
    v_pk_add_f32 v[132:133], v[132:133], v[108:109]
    v_pk_add_f32 v[134:135], v[134:135], v[110:111]
    v_pk_add_f32 v[136:137], v[136:137], v[112:113]
    v_pk_add_f32 v[138:139], v[138:139], v[114:115]
    v_pk_add_f32 v[140:141], v[140:141], v[116:117]
    v_pk_add_f32 v[142:143], v[142:143], v[118:119]
    v_pk_add_f32 v[144:145], v[144:145], v[120:121]
    v_pk_add_f32 v[146:147], v[146:147], v[122:123]
    v_mov_b32 v14, 0
    v_mov_b32 v15, 0
    s_waitcnt lgkmcnt(0)
    v_add_f32 v12, v12, v252
    v_pk_add_f32 v[100:101], v[124:125], v[12:13] op_sel_hi:[1,0] neg_lo:[0,1] neg_hi:[0,1]
    v_pk_add_f32 v[102:103], v[126:127], v[12:13] op_sel_hi:[1,0] neg_lo:[0,1] neg_hi:[0,1]
    v_pk_add_f32 v[104:105], v[128:129], v[12:13] op_sel_hi:[1,0] neg_lo:[0,1] neg_hi:[0,1]
    v_pk_add_f32 v[106:107], v[130:131], v[12:13] op_sel_hi:[1,0] neg_lo:[0,1] neg_hi:[0,1]
    v_cvt_pk_bf16_f32 v148, v100, v101
    v_cvt_pk_bf16_f32 v149, v102, v103
    v_cvt_pk_bf16_f32 v150, v104, v105
    v_cvt_pk_bf16_f32 v151, v106, v107
    buffer_store_dwordx4 v[148:151], v9, s[8:11], s46 offen offset:0 sc1
    v_pk_add_f32 v[108:109], v[132:133], v[12:13] op_sel_hi:[1,0] neg_lo:[0,1] neg_hi:[0,1]
    v_pk_add_f32 v[110:111], v[134:135], v[12:13] op_sel_hi:[1,0] neg_lo:[0,1] neg_hi:[0,1]
    v_pk_add_f32 v[112:113], v[136:137], v[12:13] op_sel_hi:[1,0] neg_lo:[0,1] neg_hi:[0,1]
    v_pk_add_f32 v[114:115], v[138:139], v[12:13] op_sel_hi:[1,0] neg_lo:[0,1] neg_hi:[0,1]
    v_cvt_pk_bf16_f32 v152, v108, v109
    v_cvt_pk_bf16_f32 v153, v110, v111
    v_cvt_pk_bf16_f32 v154, v112, v113
    v_cvt_pk_bf16_f32 v155, v114, v115
    buffer_store_dwordx4 v[152:155], v9, s[8:11], s46 offen offset:1024 sc1
    v_pk_add_f32 v[116:117], v[140:141], v[12:13] op_sel_hi:[1,0] neg_lo:[0,1] neg_hi:[0,1]
    v_pk_add_f32 v[118:119], v[142:143], v[12:13] op_sel_hi:[1,0] neg_lo:[0,1] neg_hi:[0,1]
    v_pk_add_f32 v[120:121], v[144:145], v[12:13] op_sel_hi:[1,0] neg_lo:[0,1] neg_hi:[0,1]
    v_pk_add_f32 v[122:123], v[146:147], v[12:13] op_sel_hi:[1,0] neg_lo:[0,1] neg_hi:[0,1]
    v_cvt_pk_bf16_f32 v156, v116, v117
    v_cvt_pk_bf16_f32 v157, v118, v119
    v_cvt_pk_bf16_f32 v158, v120, v121
    v_cvt_pk_bf16_f32 v159, v122, v123
    buffer_store_dwordx4 v[156:159], v7, s[8:11], s46 offen offset:2048 sc1
    v_dot2c_f32_bf16 v14, v148, v148
    v_dot2c_f32_bf16 v14, v149, v149
    v_dot2c_f32_bf16 v14, v150, v150
    v_dot2c_f32_bf16 v14, v151, v151
    v_dot2c_f32_bf16 v14, v152, v152
    v_dot2c_f32_bf16 v14, v153, v153
    v_dot2c_f32_bf16 v14, v154, v154
    v_dot2c_f32_bf16 v14, v155, v155
    v_dot2c_f32_bf16 v15, v156, v156
    v_dot2c_f32_bf16 v15, v157, v157
    v_dot2c_f32_bf16 v15, v158, v158
    v_dot2c_f32_bf16 v15, v159, v159
    buffer_store_dword v12, v6, s[8:11], s36 offen sc1
    s_nop 1
    v_fma_f32 v14, v15, s35, v14
    v_mov_b32 v15, v14
    s_nop 1
    v_permlane32_swap_b32 v14, v15
    v_add_f32 v14, v14, v15
    buffer_store_dword v14, v8, s[8:11], s45 offen sc1
    v_lshlrev_b32 v15, 7, v0
    s_lshl_b32 s6, s40, 2
    s_add_u32 s6, s6, s44
    s_add_u32 s6, s6, 32768
    v_mov_b32 v1, s76
    s_mov_b64 vcc, 0xff
    s_waitcnt vmcnt(0)
    s_barrier
    s_cmp_lg_u32 s3, 0
    s_cbranch_scc1 L_pub_25
    s_mov_b64 exec, vcc
    buffer_store_dword v1, v15, s[8:11], s6 offen sc1
L_pub_25:
    s_mov_b64 exec, -1
    s_lshl_b32 s7, s41, 2
    s_add_u32 s7, s7, s3
    s_mul_i32 s22, s7, 18432
    s_add_u32 s22, s22, s43
    s_add_u32 s22, s22, 45875200
    s_mul_i32 s24, s3, 18432
    s_lshl_b32 s25, s41, 12
    s_add_u32 s25, s25, s43
    s_add_u32 s25, s25, 48300032
    v_lshrrev_b32 v3, 5, v0
    v_and_b32 v10, 31, v0
    v_lshlrev_b32 v10, 2, v10
    v_lshl_add_u32 v3, v3, 11, v10
    v_add_u32 v11, 36864, v184
    s_mov_b32 s16, 0xffff0000
    s_lshl_b32 s7, s3, 10
    v_add_u32 v172, s7, v253
    v_add_u32 v174, 5120, v172
    v_and_b32 v178, 7, v0
    v_mul_u32_u24 v178, 1152, v178
    v_lshrrev_b32 v179, 3, v0
    v_lshl_add_u32 v178, v179, 4, v178
    s_lshl_b32 s7, s3, 7
    v_add_u32 v175, s7, v178
    v_add_u32 v177, 640, v175
    s_cmp_eq_u32 s3, 0
    s_mov_b32 s17, 1073741824
    s_cmov_b32 s17, 4096
    v_add_u32 v173, s17, v172
    s_mov_b32 s17, 1073741824
    s_cmov_b32 s17, 512
    v_add_u32 v176, s17, v175
    s_lshl_b32 s21, s41, 3
    s_add_u32 s21, s21, s40
    s_mul_i32 s18, s21, 9216
    s_mul_i32 s20, s21, 73728
    s_add_u32 s20, s20, 19922944
    s_mov_b32 s19, s20
    v_bfe_u32 v1, v0, 3, 2
    s_mov_b32 s7, 73728
    v_mul_lo_u32 v178, v1, s7
    v_lshrrev_b32 v1, 5, v0
    v_lshl_add_u32 v178, v1, 7, v178
    v_and_b32 v1, 7, v0
    v_lshl_add_u32 v178, v1, 4, v178
    v_add_u32 v179, 294912, v178
    s_mul_i32 s26, s41, 589824
    s_mul_i32 s7, s40, 9216
    s_add_u32 s26, s26, s7
    s_lshl_b32 s7, s3, 8
    s_add_u32 s27, s26, s7
    s_add_u32 s27, s27, 19921920
    s_mov_b32 s74, 0
    s_mul_i32 s7, s42, 98304
    s_sub_u32 s29, s44, s7
    s_add_u32 s29, s29, 360448
    s_lshl_b32 s7, s40, 7
    s_add_u32 s7, s7, s29
    s_add_u32 s38, s4, s7
    s_addc_u32 s39, s5, 0
    s_lshl_b32 s7, s40, 2
    s_add_u32 s29, s29, s7
    s_add_u32 s50, s23, 497664
    s_cmp_lg_u32 s42, 0
    s_cbranch_scc1 L_ring_26
    s_cmp_lg_u32 s3, 0
    s_cbranch_scc1 L_ring_27
    s_lshl_b32 s7, s41, 3
    s_add_u32 s7, s7, s40
    s_lshl_b32 s7, s7, 7
    s_add_u32 s7, s7, 19464192
    s_add_u32 s68, s4, s7
    s_addc_u32 s69, s5, 0
    s_mov_b32 s6, 0
    s_mov_b32 s7, 0
L_cpoll_28:
    s_load_dwordx16 s[52:67], s[68:69], s7 glc
    s_add_u32 s6, s6, 1
    s_waitcnt lgkmcnt(0)
    s_xor_b64 s[52:53], s[52:53], s[76:77]
    s_xor_b64 s[54:55], s[54:55], s[76:77]
    s_xor_b64 s[56:57], s[56:57], s[76:77]
    s_xor_b64 s[58:59], s[58:59], s[76:77]
    s_xor_b64 s[60:61], s[60:61], s[76:77]
    s_xor_b64 s[62:63], s[62:63], s[76:77]
    s_xor_b64 s[64:65], s[64:65], s[76:77]
    s_xor_b64 s[66:67], s[66:67], s[76:77]
    s_or_b64 s[52:53], s[52:53], s[60:61]
    s_or_b64 s[54:55], s[54:55], s[62:63]
    s_or_b64 s[56:57], s[56:57], s[64:65]
    s_or_b64 s[58:59], s[58:59], s[66:67]
    s_or_b64 s[52:53], s[52:53], s[56:57]
    s_or_b64 s[54:55], s[54:55], s[58:59]
    s_or_b64 s[52:53], s[52:53], s[54:55]
    s_cbranch_scc1 L_cpoll_29
    s_add_u32 s7, s7, 64
    s_cmp_eq_u32 s7, 128
    s_cbranch_scc1 L_cpolled_30
L_cpoll_29:
    s_cmp_lt_u32 s6, 1048576
    s_cbranch_scc1 L_cpoll_28
    s_branch L_main_end
L_cpolled_30:
L_ring_27:
    s_barrier
    buffer_load_dwordx4 v[16:19], v184, s[48:51], s23 offen offset:0 sc1
    buffer_load_dwordx4 v[20:23], v184, s[48:51], s23 offen offset:1024 sc1
    buffer_load_dwordx4 v[24:27], v184, s[48:51], s23 offen offset:2048 sc1
    buffer_load_dwordx4 v[28:31], v184, s[48:51], s23 offen offset:3072 sc1
    buffer_load_dwordx4 v[32:35], v185, s[48:51], s23 offen offset:0 sc1
    buffer_load_dwordx4 v[36:39], v185, s[48:51], s23 offen offset:1024 sc1
    buffer_load_dwordx4 v[40:43], v185, s[48:51], s23 offen offset:2048 sc1
    buffer_load_dwordx4 v[44:47], v185, s[48:51], s23 offen offset:3072 sc1
    buffer_load_dwordx4 v[48:51], v186, s[48:51], s23 offen offset:0 sc1
    buffer_load_dwordx4 v[52:55], v186, s[48:51], s23 offen offset:1024 sc1
    buffer_load_dwordx4 v[56:59], v186, s[48:51], s23 offen offset:2048 sc1
    buffer_load_dwordx4 v[60:63], v186, s[48:51], s23 offen offset:3072 sc1
    buffer_load_dwordx4 v[64:67], v187, s[48:51], s23 offen offset:0 sc1
    buffer_load_dwordx4 v[68:71], v187, s[48:51], s23 offen offset:1024 sc1
    buffer_load_dwordx4 v[72:75], v187, s[48:51], s23 offen offset:2048 sc1
L_ring_26:
    s_cmp_lg_u32 s3, 3
    s_cbranch_scc1 L_pollout_33
    s_lshl_b32 s7, s40, 7
    s_add_u32 s7, s7, s44
    s_add_u32 s7, s7, 32768
    s_add_u32 s52, s4, s7
    s_addc_u32 s53, s5, 0
    s_mov_b32 s6, 0
L_poll_31:
    s_load_dwordx8 s[56:63], s[52:53], 0 glc
    s_add_u32 s6, s6, 1
    s_waitcnt lgkmcnt(0)
    s_xor_b64 s[56:57], s[56:57], s[76:77]
    s_xor_b64 s[58:59], s[58:59], s[76:77]
    s_xor_b64 s[60:61], s[60:61], s[76:77]
    s_xor_b64 s[62:63], s[62:63], s[76:77]
    s_or_b64 s[56:57], s[56:57], s[58:59]
    s_or_b64 s[60:61], s[60:61], s[62:63]
    s_or_b64 s[56:57], s[56:57], s[60:61]
    s_cbranch_scc0 L_polled_32
    s_cmp_lt_u32 s6, 1048576
    s_cbranch_scc1 L_poll_31
    s_branch L_main_end
L_polled_32:
L_pollout_33:
    s_barrier
    s_add_u32 m0, s24, 0
    s_nop 0
    buffer_load_dwordx4 v2, s[8:11], s22 offen offset:0 sc1 lds
    s_add_u32 m0, s24, 512
    s_nop 0
    buffer_load_dwordx4 v2, s[8:11], s22 offen offset:512 sc1 lds
    s_add_u32 m0, s24, 1024
    s_nop 0
    buffer_load_dwordx4 v2, s[8:11], s22 offen offset:1024 sc1 lds
    s_add_u32 m0, s24, 1536
    s_nop 0
    buffer_load_dwordx4 v2, s[8:11], s22 offen offset:1536 sc1 lds
    s_add_u32 m0, s24, 2048
    s_nop 0
    buffer_load_dwordx4 v2, s[8:11], s22 offen offset:2048 sc1 lds
    s_add_u32 m0, s24, 2560
    s_nop 0
    buffer_load_dwordx4 v2, s[8:11], s22 offen offset:2560 sc1 lds
    s_add_u32 m0, s24, 3072
    s_nop 0
    buffer_load_dwordx4 v2, s[8:11], s22 offen offset:3072 sc1 lds
    s_add_u32 m0, s24, 3584
    s_nop 0
    buffer_load_dwordx4 v2, s[8:11], s22 offen offset:3584 sc1 lds
    s_add_u32 m0, s24, 8192
    s_add_u32 s22, s22, 4096
    buffer_load_dwordx4 v2, s[8:11], s22 offen offset:0 sc1 lds
    s_add_u32 m0, s24, 8704
    s_nop 0
    buffer_load_dwordx4 v2, s[8:11], s22 offen offset:512 sc1 lds
    s_add_u32 m0, s24, 9216
    s_nop 0
    buffer_load_dwordx4 v2, s[8:11], s22 offen offset:1024 sc1 lds
    s_add_u32 m0, s24, 9728
    s_nop 0
    buffer_load_dwordx4 v2, s[8:11], s22 offen offset:1536 sc1 lds
    s_add_u32 s23, s23, 15360
    s_lshr_b32 s7, s3, 1
    s_lshl_b32 s7, s7, 10
    s_and_b32 s6, s3, 1
    s_lshl_b32 s6, s6, 3
    s_add_u32 s28, s7, s6
    s_add_u32 s28, s28, 73728
    s_waitcnt vmcnt(6)
    s_barrier
    ds_read_b128 a[0:3], v184 offset:0
    ds_read_b128 a[72:75], v184 offset:18432
    ds_read_b128 a[144:147], v11 offset:0
    ds_read_b128 a[216:219], v11 offset:18432
    ds_read_b128 a[4:7], v184 offset:1024
    ds_read_b128 a[76:79], v184 offset:19456
    ds_read_b128 a[148:151], v11 offset:1024
    ds_read_b128 a[220:223], v11 offset:19456
    ds_read_b128 a[8:11], v184 offset:2048
    ds_read_b128 a[80:83], v184 offset:20480
    ds_read_b128 a[152:155], v11 offset:2048
    ds_read_b128 a[224:227], v11 offset:20480
    s_waitcnt vmcnt(24) lgkmcnt(0)
    v_mfma_f32_16x16x32_bf16 v[88:91], v[16:19], a[0:3], 0
    ds_read_b128 a[12:15], v184 offset:3072
    v_mfma_f32_16x16x32_bf16 v[88:91], v[20:23], a[4:7], v[88:91]
    buffer_load_dwordx4 v[76:79], v184, s[48:51], s23 offen offset:0 sc1
    v_mfma_f32_16x16x32_bf16 v[88:91], v[24:27], a[8:11], v[88:91]
    ds_read_b128 a[84:87], v184 offset:21504
    v_mfma_f32_16x16x32_bf16 v[92:95], v[16:19], a[72:75], 0
    s_add_u32 m0, s24, 10240
    s_nop 0
    buffer_load_dwordx4 v2, s[8:11], s22 offen offset:2048 sc1 lds
    v_mfma_f32_16x16x32_bf16 v[92:95], v[20:23], a[76:79], v[92:95]
    ds_read_b128 a[156:159], v11 offset:3072
    ds_read_b128 a[228:231], v11 offset:21504
    v_mfma_f32_16x16x32_bf16 v[92:95], v[24:27], a[80:83], v[92:95]
    buffer_load_dwordx4 v[80:83], v184, s[48:51], s23 offen offset:1024 sc1
    v_mfma_f32_16x16x32_bf16 v[96:99], v[16:19], a[144:147], 0
    ds_read_b128 a[16:19], v184 offset:4096
    v_mfma_f32_16x16x32_bf16 v[96:99], v[20:23], a[148:151], v[96:99]
    s_add_u32 m0, s24, 10752
    s_nop 0
    buffer_load_dwordx4 v2, s[8:11], s22 offen offset:2560 sc1 lds
    v_mfma_f32_16x16x32_bf16 v[96:99], v[24:27], a[152:155], v[96:99]
    ds_read_b128 a[88:91], v184 offset:22528
    v_mfma_f32_16x16x32_bf16 v[100:103], v[16:19], a[216:219], 0
    buffer_load_dwordx4 v[84:87], v184, s[48:51], s23 offen offset:2048 sc1
    v_mfma_f32_16x16x32_bf16 v[100:103], v[20:23], a[220:223], v[100:103]
    ds_read_b128 a[160:163], v11 offset:4096
    ds_read_b128 a[232:235], v11 offset:22528
    v_mfma_f32_16x16x32_bf16 v[100:103], v[24:27], a[224:227], v[100:103]
    s_add_u32 m0, s24, 11264
    s_nop 0
    buffer_load_dwordx4 v2, s[8:11], s22 offen offset:3072 sc1 lds
    s_waitcnt vmcnt(27) lgkmcnt(8)
    v_mfma_f32_16x16x32_bf16 v[104:107], v[28:31], a[0:3], 0
    ds_read_b128 a[20:23], v184 offset:5120
    v_mfma_f32_16x16x32_bf16 v[104:107], v[32:35], a[4:7], v[104:107]
    buffer_load_dwordx4 v[16:19], v184, s[48:51], s23 offen offset:3072 sc1
    v_mfma_f32_16x16x32_bf16 v[104:107], v[36:39], a[8:11], v[104:107]
    ds_read_b128 a[92:95], v184 offset:23552
    v_mfma_f32_16x16x32_bf16 v[108:111], v[28:31], a[72:75], 0
    s_add_u32 m0, s24, 11776
    s_nop 0
    buffer_load_dwordx4 v2, s[8:11], s22 offen offset:3584 sc1 lds
    v_mfma_f32_16x16x32_bf16 v[108:111], v[32:35], a[76:79], v[108:111]
    ds_read_b128 a[164:167], v11 offset:5120
    ds_read_b128 a[236:239], v11 offset:23552
    v_mfma_f32_16x16x32_bf16 v[108:111], v[36:39], a[80:83], v[108:111]
    buffer_load_dwordx4 v[20:23], v185, s[48:51], s23 offen offset:0 sc1
    v_mfma_f32_16x16x32_bf16 v[112:115], v[28:31], a[144:147], 0
    v_mfma_f32_16x16x32_bf16 v[112:115], v[32:35], a[148:151], v[112:115]
    s_add_u32 m0, s24, 16384
    s_add_u32 s22, s22, 4096
    buffer_load_dwordx4 v2, s[8:11], s22 offen offset:0 sc1 lds
    v_mfma_f32_16x16x32_bf16 v[112:115], v[36:39], a[152:155], v[112:115]
    v_mfma_f32_16x16x32_bf16 v[116:119], v[28:31], a[216:219], 0
    buffer_load_dwordx4 v[24:27], v185, s[48:51], s23 offen offset:1024 sc1
    v_mfma_f32_16x16x32_bf16 v[116:119], v[32:35], a[220:223], v[116:119]
    v_mfma_f32_16x16x32_bf16 v[116:119], v[36:39], a[224:227], v[116:119]
    s_add_u32 m0, s24, 16896
    s_nop 0
    buffer_load_dwordx4 v2, s[8:11], s22 offen offset:512 sc1 lds
    s_waitcnt vmcnt(12) lgkmcnt(0)
    s_barrier
    v_mfma_f32_16x16x32_bf16 v[88:91], v[40:43], a[12:15], v[88:91]
    ds_read_b128 a[24:27], v184 offset:6144
    v_mfma_f32_16x16x32_bf16 v[88:91], v[44:47], a[16:19], v[88:91]
    buffer_load_dwordx4 v[28:31], v185, s[48:51], s23 offen offset:2048 sc1
    v_mfma_f32_16x16x32_bf16 v[88:91], v[48:51], a[20:23], v[88:91]
    ds_read_b128 a[96:99], v184 offset:24576
    v_mfma_f32_16x16x32_bf16 v[92:95], v[40:43], a[84:87], v[92:95]
    buffer_load_dword v136, v3, s[8:11], s25 offen offset:0 sc1
    v_mfma_f32_16x16x32_bf16 v[92:95], v[44:47], a[88:91], v[92:95]
    ds_read_b128 a[168:171], v11 offset:6144
    ds_read_b128 a[240:243], v11 offset:24576
    v_mfma_f32_16x16x32_bf16 v[92:95], v[48:51], a[92:95], v[92:95]
    buffer_load_dwordx4 v[32:35], v185, s[48:51], s23 offen offset:3072 sc1
    v_mfma_f32_16x16x32_bf16 v[96:99], v[40:43], a[156:159], v[96:99]
    buffer_load_dword v137, v3, s[8:11], s25 offen offset:128 sc1
    v_mfma_f32_16x16x32_bf16 v[96:99], v[44:47], a[160:163], v[96:99]
    buffer_load_dword v138, v3, s[8:11], s25 offen offset:256 sc1
    v_mfma_f32_16x16x32_bf16 v[96:99], v[48:51], a[164:167], v[96:99]
    ds_read_b128 a[28:31], v184 offset:7168
    ds_read_b128 a[100:103], v184 offset:25600
    v_mfma_f32_16x16x32_bf16 v[100:103], v[40:43], a[228:231], v[100:103]
    buffer_load_dwordx4 v[36:39], v186, s[48:51], s23 offen offset:0 sc1
    v_mfma_f32_16x16x32_bf16 v[100:103], v[44:47], a[232:235], v[100:103]
    buffer_load_dword v139, v3, s[8:11], s25 offen offset:384 sc1
    v_mfma_f32_16x16x32_bf16 v[100:103], v[48:51], a[236:239], v[100:103]
    buffer_load_dword v140, v3, s[8:11], s25 offen offset:512 sc1
    s_waitcnt vmcnt(35) lgkmcnt(6)
    v_mfma_f32_16x16x32_bf16 v[104:107], v[52:55], a[12:15], v[104:107]
    ds_read_b128 a[172:175], v11 offset:7168
    ds_read_b128 a[244:247], v11 offset:25600
    v_mfma_f32_16x16x32_bf16 v[104:107], v[56:59], a[16:19], v[104:107]
    buffer_load_dwordx4 v[40:43], v186, s[48:51], s23 offen offset:1024 sc1
    v_mfma_f32_16x16x32_bf16 v[104:107], v[60:63], a[20:23], v[104:107]
    ds_read_b128 a[32:35], v184 offset:8192
    ds_read_b128 a[104:107], v184 offset:26624
    v_mfma_f32_16x16x32_bf16 v[108:111], v[52:55], a[84:87], v[108:111]
    buffer_load_dword v141, v3, s[8:11], s25 offen offset:640 sc1
    v_mfma_f32_16x16x32_bf16 v[108:111], v[56:59], a[88:91], v[108:111]
    ds_read_b128 a[176:179], v11 offset:8192
    ds_read_b128 a[248:251], v11 offset:26624
    v_mfma_f32_16x16x32_bf16 v[108:111], v[60:63], a[92:95], v[108:111]
    buffer_load_dwordx4 v[44:47], v186, s[48:51], s23 offen offset:2048 sc1
    v_mfma_f32_16x16x32_bf16 v[112:115], v[52:55], a[156:159], v[112:115]
    buffer_load_dword v142, v3, s[8:11], s25 offen offset:768 sc1
    v_mfma_f32_16x16x32_bf16 v[112:115], v[56:59], a[160:163], v[112:115]
    buffer_load_dword v143, v3, s[8:11], s25 offen offset:896 sc1
    v_mfma_f32_16x16x32_bf16 v[112:115], v[60:63], a[164:167], v[112:115]
    v_mfma_f32_16x16x32_bf16 v[116:119], v[52:55], a[228:231], v[116:119]
    buffer_load_dwordx4 v[48:51], v186, s[48:51], s23 offen offset:3072 sc1
    v_mfma_f32_16x16x32_bf16 v[116:119], v[56:59], a[232:235], v[116:119]
    buffer_load_dword v144, v3, s[8:11], s25 offen offset:1024 sc1
    v_mfma_f32_16x16x32_bf16 v[116:119], v[60:63], a[236:239], v[116:119]
    buffer_load_dword v145, v3, s[8:11], s25 offen offset:1152 sc1
    s_waitcnt vmcnt(40) lgkmcnt(0)
    v_mfma_f32_16x16x32_bf16 v[88:91], v[64:67], a[24:27], v[88:91]
    ds_read_b128 a[36:39], v184 offset:9216
    v_mfma_f32_16x16x32_bf16 v[88:91], v[68:71], a[28:31], v[88:91]
    buffer_load_dwordx4 v[52:55], v187, s[48:51], s23 offen offset:0 sc1
    v_mfma_f32_16x16x32_bf16 v[88:91], v[72:75], a[32:35], v[88:91]
    ds_read_b128 a[108:111], v184 offset:27648
    v_mfma_f32_16x16x32_bf16 v[92:95], v[64:67], a[96:99], v[92:95]
    buffer_load_dword v146, v3, s[8:11], s25 offen offset:1280 sc1
    v_mfma_f32_16x16x32_bf16 v[92:95], v[68:71], a[100:103], v[92:95]
    ds_read_b128 a[180:183], v11 offset:9216
    ds_read_b128 a[252:255], v11 offset:27648
    v_mfma_f32_16x16x32_bf16 v[92:95], v[72:75], a[104:107], v[92:95]
    buffer_load_dwordx4 v[56:59], v187, s[48:51], s23 offen offset:1024 sc1
    v_mfma_f32_16x16x32_bf16 v[96:99], v[64:67], a[168:171], v[96:99]
    buffer_load_dword v147, v3, s[8:11], s25 offen offset:1408 sc1
    v_mfma_f32_16x16x32_bf16 v[96:99], v[68:71], a[172:175], v[96:99]
    buffer_load_dword v148, v3, s[8:11], s25 offen offset:1536 sc1
    v_mfma_f32_16x16x32_bf16 v[96:99], v[72:75], a[176:179], v[96:99]
    ds_read_b128 a[40:43], v184 offset:10240
    ds_read_b128 a[112:115], v184 offset:28672
    v_mfma_f32_16x16x32_bf16 v[100:103], v[64:67], a[240:243], v[100:103]
    buffer_load_dwordx4 v[60:63], v187, s[48:51], s23 offen offset:2048 sc1
    v_mfma_f32_16x16x32_bf16 v[100:103], v[68:71], a[244:247], v[100:103]
    buffer_load_dword v149, v3, s[8:11], s25 offen offset:1664 sc1
    v_mfma_f32_16x16x32_bf16 v[100:103], v[72:75], a[248:251], v[100:103]
    buffer_load_dword v150, v3, s[8:11], s25 offen offset:1792 sc1
    s_waitcnt vmcnt(31) lgkmcnt(6)
    v_mfma_f32_16x16x32_bf16 v[104:107], v[76:79], a[24:27], v[104:107]
    ds_read_b128 a[184:187], v11 offset:10240
    ds_read_b128 v[220:223], v11 offset:28672
    v_mfma_f32_16x16x32_bf16 v[104:107], v[80:83], a[28:31], v[104:107]
    buffer_load_dwordx4 v[64:67], v187, s[48:51], s23 offen offset:3072 sc1
    v_mfma_f32_16x16x32_bf16 v[104:107], v[84:87], a[32:35], v[104:107]
    ds_read_b128 a[44:47], v184 offset:11264
    ds_read_b128 a[116:119], v184 offset:29696
    v_mfma_f32_16x16x32_bf16 v[108:111], v[76:79], a[96:99], v[108:111]
    buffer_load_dword v151, v3, s[8:11], s25 offen offset:1920 sc1
    v_mfma_f32_16x16x32_bf16 v[108:111], v[80:83], a[100:103], v[108:111]
    ds_read_b128 a[188:191], v11 offset:11264
    ds_read_b128 v[224:227], v11 offset:29696
    v_mfma_f32_16x16x32_bf16 v[108:111], v[84:87], a[104:107], v[108:111]
    buffer_load_dwordx4 v[68:71], v188, s[48:51], s23 offen offset:0 sc1
    v_mfma_f32_16x16x32_bf16 v[112:115], v[76:79], a[168:171], v[112:115]
    v_mfma_f32_16x16x32_bf16 v[112:115], v[80:83], a[172:175], v[112:115]
    v_mfma_f32_16x16x32_bf16 v[112:115], v[84:87], a[176:179], v[112:115]
    v_mfma_f32_16x16x32_bf16 v[116:119], v[76:79], a[240:243], v[116:119]
    buffer_load_dwordx4 v[72:75], v188, s[48:51], s23 offen offset:1024 sc1
    v_mfma_f32_16x16x32_bf16 v[116:119], v[80:83], a[244:247], v[116:119]
    v_mfma_f32_16x16x32_bf16 v[116:119], v[84:87], a[248:251], v[116:119]
    s_waitcnt vmcnt(28) lgkmcnt(0)
    s_barrier
    v_mfma_f32_16x16x32_bf16 v[88:91], v[16:19], a[36:39], v[88:91]
    ds_read_b128 a[48:51], v184 offset:12288
    v_mfma_f32_16x16x32_bf16 v[88:91], v[20:23], a[40:43], v[88:91]
    buffer_load_dwordx4 v[76:79], v188, s[48:51], s23 offen offset:2048 sc1
    v_mfma_f32_16x16x32_bf16 v[88:91], v[24:27], a[44:47], v[88:91]
    ds_read_b128 a[120:123], v184 offset:30720
    v_mfma_f32_16x16x32_bf16 v[92:95], v[16:19], a[108:111], v[92:95]
    ds_read_b128 a[192:195], v11 offset:12288
    v_mfma_f32_16x16x32_bf16 v[92:95], v[20:23], a[112:115], v[92:95]
    ds_read_b128 v[228:231], v11 offset:30720
    v_mfma_f32_16x16x32_bf16 v[92:95], v[24:27], a[116:119], v[92:95]
    buffer_load_dwordx4 v[80:83], v188, s[48:51], s23 offen offset:3072 sc1
    v_mfma_f32_16x16x32_bf16 v[96:99], v[16:19], a[180:183], v[96:99]
    ds_read_b128 a[52:55], v184 offset:13312
    v_mfma_f32_16x16x32_bf16 v[96:99], v[20:23], a[184:187], v[96:99]
    ds_read_b128 a[124:127], v184 offset:31744
    v_mfma_f32_16x16x32_bf16 v[96:99], v[24:27], a[188:191], v[96:99]
    v_mfma_f32_16x16x32_bf16 v[100:103], v[16:19], a[252:255], v[100:103]
    buffer_load_dwordx4 v[84:87], v189, s[48:51], s23 offen offset:0 sc1
    v_mfma_f32_16x16x32_bf16 v[100:103], v[20:23], v[220:223], v[100:103]
    ds_read_b128 a[196:199], v11 offset:13312
    ds_read_b128 v[232:235], v11 offset:31744
    v_mfma_f32_16x16x32_bf16 v[100:103], v[24:27], v[224:227], v[100:103]
    s_waitcnt vmcnt(25) lgkmcnt(8)
    v_mfma_f32_16x16x32_bf16 v[104:107], v[28:31], a[36:39], v[104:107]
    ds_read_b128 a[56:59], v184 offset:14336
    v_mfma_f32_16x16x32_bf16 v[104:107], v[32:35], a[40:43], v[104:107]
    buffer_load_dwordx4 v[16:19], v189, s[48:51], s23 offen offset:1024 sc1
    v_mfma_f32_16x16x32_bf16 v[104:107], v[36:39], a[44:47], v[104:107]
    ds_read_b128 a[128:131], v184 offset:32768
    v_mfma_f32_16x16x32_bf16 v[108:111], v[28:31], a[108:111], v[108:111]
    ds_read_b128 a[200:203], v11 offset:14336
    v_mfma_f32_16x16x32_bf16 v[108:111], v[32:35], a[112:115], v[108:111]
    ds_read_b128 v[236:239], v11 offset:32768
    v_mfma_f32_16x16x32_bf16 v[108:111], v[36:39], a[116:119], v[108:111]
    buffer_load_dwordx4 v[20:23], v189, s[48:51], s23 offen offset:2048 sc1
    v_mfma_f32_16x16x32_bf16 v[112:115], v[28:31], a[180:183], v[112:115]
    v_mfma_f32_16x16x32_bf16 v[112:115], v[32:35], a[184:187], v[112:115]
    v_mfma_f32_16x16x32_bf16 v[112:115], v[36:39], a[188:191], v[112:115]
    v_mfma_f32_16x16x32_bf16 v[116:119], v[28:31], a[252:255], v[116:119]
    buffer_load_dwordx4 v[24:27], v189, s[48:51], s23 offen offset:3072 sc1
    v_mfma_f32_16x16x32_bf16 v[116:119], v[32:35], v[220:223], v[116:119]
    v_mfma_f32_16x16x32_bf16 v[116:119], v[36:39], v[224:227], v[116:119]
    s_waitcnt vmcnt(8) lgkmcnt(0)
    v_mfma_f32_16x16x32_bf16 v[88:91], v[40:43], a[48:51], v[88:91]
    ds_read_b128 a[60:63], v184 offset:15360
    v_add_f32 v136, v136, v144
    v_mfma_f32_16x16x32_bf16 v[88:91], v[44:47], a[52:55], v[88:91]
    buffer_load_dwordx4 v[28:31], v190, s[48:51], s23 offen offset:0 sc1
    v_mfma_f32_16x16x32_bf16 v[88:91], v[48:51], a[56:59], v[88:91]
    ds_read_b128 a[132:135], v184 offset:33792
    v_add_f32 v137, v137, v145
    v_mfma_f32_16x16x32_bf16 v[92:95], v[40:43], a[120:123], v[92:95]
    ds_read_b128 a[204:207], v11 offset:15360
    v_add_f32 v138, v138, v146
    v_mfma_f32_16x16x32_bf16 v[92:95], v[44:47], a[124:127], v[92:95]
    ds_read_b128 v[240:243], v11 offset:33792
    v_add_f32 v139, v139, v147
    v_mfma_f32_16x16x32_bf16 v[92:95], v[48:51], a[128:131], v[92:95]
    buffer_load_dwordx4 v[32:35], v190, s[48:51], s23 offen offset:1024 sc1
    v_mfma_f32_16x16x32_bf16 v[96:99], v[40:43], a[192:195], v[96:99]
    ds_read_b128 a[64:67], v184 offset:16384
    v_add_f32 v140, v140, v148
    v_mfma_f32_16x16x32_bf16 v[96:99], v[44:47], a[196:199], v[96:99]
    ds_read_b128 a[136:139], v184 offset:34816
    v_add_f32 v141, v141, v149
    v_mfma_f32_16x16x32_bf16 v[96:99], v[48:51], a[200:203], v[96:99]
    v_add_f32 v142, v142, v150
    v_add_f32 v143, v143, v151
    v_mfma_f32_16x16x32_bf16 v[100:103], v[40:43], v[228:231], v[100:103]
    buffer_load_dwordx4 v[36:39], v190, s[48:51], s23 offen offset:2048 sc1
    v_mfma_f32_16x16x32_bf16 v[100:103], v[44:47], v[232:235], v[100:103]
    ds_read_b128 a[208:211], v11 offset:16384
    ds_read_b128 v[244:247], v11 offset:34816
    v_mfma_f32_16x16x32_bf16 v[100:103], v[48:51], v[236:239], v[100:103]
    v_add_f32 v136, v136, v140
    v_add_f32 v137, v137, v141
    s_waitcnt vmcnt(15) lgkmcnt(8)
    v_mfma_f32_16x16x32_bf16 v[104:107], v[52:55], a[48:51], v[104:107]
    ds_read_b128 a[68:71], v184 offset:17408
    v_add_f32 v138, v138, v142
    v_mfma_f32_16x16x32_bf16 v[104:107], v[56:59], a[52:55], v[104:107]
    buffer_load_dwordx4 v[40:43], v190, s[48:51], s23 offen offset:3072 sc1
    v_mfma_f32_16x16x32_bf16 v[104:107], v[60:63], a[56:59], v[104:107]
    ds_read_b128 a[140:143], v184 offset:35840
    v_add_f32 v139, v139, v143
    v_mfma_f32_16x16x32_bf16 v[108:111], v[52:55], a[120:123], v[108:111]
    ds_read_b128 a[212:215], v11 offset:17408
    v_add_f32 v136, v136, v138
    v_mfma_f32_16x16x32_bf16 v[108:111], v[56:59], a[124:127], v[108:111]
    ds_read_b128 v[248:251], v11 offset:35840
    v_add_f32 v137, v137, v139
    v_mfma_f32_16x16x32_bf16 v[108:111], v[60:63], a[128:131], v[108:111]
    buffer_load_dwordx4 v[44:47], v191, s[48:51], s23 offen offset:0 sc1
    v_mfma_f32_16x16x32_bf16 v[112:115], v[52:55], a[192:195], v[112:115]
    v_add_f32 v136, v136, v137
    v_mov_b32 v137, 0x3727c5ac
    v_mfma_f32_16x16x32_bf16 v[112:115], v[56:59], a[196:199], v[112:115]
    v_fmac_f32 v137, 0x3ae38e39, v136
    v_mov_b32 v193, v137
    v_mfma_f32_16x16x32_bf16 v[112:115], v[60:63], a[200:203], v[112:115]
    s_nop 0
    v_permlane16_swap_b32 v193, v137
    v_mfma_f32_16x16x32_bf16 v[116:119], v[52:55], v[228:231], v[116:119]
    buffer_load_dwordx4 v[48:51], v191, s[48:51], s23 offen offset:1024 sc1
    v_mfma_f32_16x16x32_bf16 v[116:119], v[56:59], v[232:235], v[116:119]
    v_mov_b32 v195, v193
    v_mov_b32 v194, v137
    v_mfma_f32_16x16x32_bf16 v[116:119], v[60:63], v[236:239], v[116:119]
    v_mov_b32 v252, v137
    s_waitcnt vmcnt(12) lgkmcnt(0)
    v_mfma_f32_16x16x32_bf16 v[88:91], v[64:67], a[60:63], v[88:91]
    s_nop 0
    v_permlane32_swap_b32 v193, v195
    v_mfma_f32_16x16x32_bf16 v[88:91], v[68:71], a[64:67], v[88:91]
    buffer_load_dwordx4 v[52:55], v191, s[48:51], s23 offen offset:2048 sc1
    v_mfma_f32_16x16x32_bf16 v[120:123], v[72:75], a[68:71], v[88:91]
    v_permlane32_swap_b32 v194, v252
    v_mfma_f32_16x16x32_bf16 v[92:95], v[64:67], a[132:135], v[92:95]
    v_rsq_f32 v4, v193
    v_mfma_f32_16x16x32_bf16 v[92:95], v[68:71], a[136:139], v[92:95]
    v_rsq_f32 v5, v194
    v_mfma_f32_16x16x32_bf16 v[124:127], v[72:75], a[140:143], v[92:95]
    buffer_load_dwordx4 v[56:59], v191, s[48:51], s23 offen offset:3072 sc1
    v_mfma_f32_16x16x32_bf16 v[96:99], v[64:67], a[204:207], v[96:99]
    v_rsq_f32 v6, v195
    v_mfma_f32_16x16x32_bf16 v[96:99], v[68:71], a[208:211], v[96:99]
    v_rsq_f32 v7, v252
    v_mfma_f32_16x16x32_bf16 v[128:131], v[72:75], a[212:215], v[96:99]
    v_mul_f32 v8, v4, v4
    v_mul_f32 v9, v5, v5
    v_mfma_f32_16x16x32_bf16 v[100:103], v[64:67], v[240:243], v[100:103]
    buffer_load_dwordx4 v[60:63], v192, s[48:51], s23 offen offset:0 sc1
    v_mfma_f32_16x16x32_bf16 v[100:103], v[68:71], v[244:247], v[100:103]
    v_mul_f32 v13, v6, v6
    v_mul_f32 v14, v7, v7
    v_mfma_f32_16x16x32_bf16 v[132:135], v[72:75], v[248:251], v[100:103]
    v_mul_f32 v4, 0xc0135761, v4
    v_mul_f32 v5, 0xc0135761, v5
    s_waitcnt vmcnt(12) lgkmcnt(0)
    v_mfma_f32_16x16x32_bf16 v[104:107], v[76:79], a[60:63], v[104:107]
    v_mul_f32 v6, 0xc0135761, v6
    v_mul_f32 v7, 0xc0135761, v7
    v_mfma_f32_16x16x32_bf16 v[104:107], v[80:83], a[64:67], v[104:107]
    buffer_load_dwordx4 v[64:67], v192, s[48:51], s23 offen offset:1024 sc1
    v_mfma_f32_16x16x32_bf16 v[136:139], v[84:87], a[68:71], v[104:107]
    v_mul_f32 v8, 0x3d372713, v8
    v_mul_f32 v9, 0x3d372713, v9
    v_mfma_f32_16x16x32_bf16 v[108:111], v[76:79], a[132:135], v[108:111]
    v_mul_f32 v13, 0x3d372713, v13
    v_mul_f32 v14, 0x3d372713, v14
    v_mfma_f32_16x16x32_bf16 v[108:111], v[80:83], a[136:139], v[108:111]
    v_mul_f32 v8, v8, v4
    v_mul_f32 v9, v9, v5
    v_mfma_f32_16x16x32_bf16 v[140:143], v[84:87], a[140:143], v[108:111]
    buffer_load_dwordx4 v[68:71], v192, s[48:51], s23 offen offset:2048 sc1
    v_mfma_f32_16x16x32_bf16 v[112:115], v[76:79], a[204:207], v[112:115]
    v_mul_f32 v13, v13, v6
    v_mul_f32 v14, v14, v7
    v_mfma_f32_16x16x32_bf16 v[112:115], v[80:83], a[208:211], v[112:115]
    s_mov_b32 s25, 0
    v_mfma_f32_16x16x32_bf16 v[144:147], v[84:87], a[212:215], v[112:115]
    s_mov_b32 s7, s28
    v_mfma_f32_16x16x32_bf16 v[116:119], v[76:79], v[240:243], v[116:119]
    buffer_load_dwordx4 v[72:75], v192, s[48:51], s23 offen offset:3072 sc1
    v_mfma_f32_16x16x32_bf16 v[116:119], v[80:83], v[244:247], v[116:119]
    s_add_u32 s23, s23, 36864
    v_mfma_f32_16x16x32_bf16 v[148:151], v[84:87], v[248:251], v[116:119]
    v_add_u32 v12, s7, v184
    s_add_u32 s25, s25, 1
L_ffn_gu_34:
    s_waitcnt vmcnt(12)
    v_mfma_f32_16x16x32_bf16 v[88:91], v[16:19], a[0:3], 0
    v_mfma_f32_16x16x32_bf16 v[88:91], v[20:23], a[4:7], v[88:91]
    buffer_load_dwordx4 v[76:79], v184, s[48:51], s23 offen offset:0 sc1
    v_mfma_f32_16x16x32_bf16 v[88:91], v[24:27], a[8:11], v[88:91]
    v_mul_f32 v152, v120, v120
    v_mul_f32 v153, v121, v121
    v_mfma_f32_16x16x32_bf16 v[92:95], v[16:19], a[72:75], 0
    v_mul_f32 v154, v122, v122
    v_mul_f32 v155, v123, v123
    v_mfma_f32_16x16x32_bf16 v[92:95], v[20:23], a[76:79], v[92:95]
    v_fma_f32 v152, v152, v8, v4
    v_fma_f32 v153, v153, v8, v4
    v_mfma_f32_16x16x32_bf16 v[92:95], v[24:27], a[80:83], v[92:95]
    buffer_load_dwordx4 v[80:83], v184, s[48:51], s23 offen offset:1024 sc1
    v_mfma_f32_16x16x32_bf16 v[96:99], v[16:19], a[144:147], 0
    v_fma_f32 v154, v154, v8, v4
    v_fma_f32 v155, v155, v8, v4
    v_mfma_f32_16x16x32_bf16 v[96:99], v[20:23], a[148:151], v[96:99]
    v_mul_f32 v152, v120, v152
    v_mul_f32 v153, v121, v153
    v_mfma_f32_16x16x32_bf16 v[96:99], v[24:27], a[152:155], v[96:99]
    v_mul_f32 v154, v122, v154
    v_mul_f32 v155, v123, v155
    v_mfma_f32_16x16x32_bf16 v[100:103], v[16:19], a[216:219], 0
    buffer_load_dwordx4 v[84:87], v184, s[48:51], s23 offen offset:2048 sc1
    v_mfma_f32_16x16x32_bf16 v[100:103], v[20:23], a[220:223], v[100:103]
    v_exp_f32 v152, v152
    v_mfma_f32_16x16x32_bf16 v[100:103], v[24:27], a[224:227], v[100:103]
    v_exp_f32 v153, v153
    s_waitcnt vmcnt(12)
    v_mfma_f32_16x16x32_bf16 v[104:107], v[28:31], a[0:3], 0
    v_exp_f32 v154, v154
    v_mfma_f32_16x16x32_bf16 v[104:107], v[32:35], a[4:7], v[104:107]
    buffer_load_dwordx4 v[16:19], v184, s[48:51], s23 offen offset:3072 sc1
    v_mfma_f32_16x16x32_bf16 v[104:107], v[36:39], a[8:11], v[104:107]
    v_exp_f32 v155, v155
    v_mfma_f32_16x16x32_bf16 v[108:111], v[28:31], a[72:75], 0
    v_mul_f32 v156, v120, v136
    v_mul_f32 v157, v121, v137
    v_mfma_f32_16x16x32_bf16 v[108:111], v[32:35], a[76:79], v[108:111]
    v_mul_f32 v158, v122, v138
    v_mul_f32 v159, v123, v139
    v_mfma_f32_16x16x32_bf16 v[108:111], v[36:39], a[80:83], v[108:111]
    buffer_load_dwordx4 v[20:23], v185, s[48:51], s23 offen offset:0 sc1
    v_mfma_f32_16x16x32_bf16 v[112:115], v[28:31], a[144:147], 0
    v_fma_f32 v152, v152, v193, v193
    v_fma_f32 v153, v153, v193, v193
    v_mfma_f32_16x16x32_bf16 v[112:115], v[32:35], a[148:151], v[112:115]
    v_fma_f32 v154, v154, v193, v193
    v_fma_f32 v155, v155, v193, v193
    v_mfma_f32_16x16x32_bf16 v[112:115], v[36:39], a[152:155], v[112:115]
    v_rcp_f32 v152, v152
    v_mfma_f32_16x16x32_bf16 v[116:119], v[28:31], a[216:219], 0
    buffer_load_dwordx4 v[24:27], v185, s[48:51], s23 offen offset:1024 sc1
    v_mfma_f32_16x16x32_bf16 v[116:119], v[32:35], a[220:223], v[116:119]
    v_rcp_f32 v153, v153
    v_mfma_f32_16x16x32_bf16 v[116:119], v[36:39], a[224:227], v[116:119]
    v_rcp_f32 v154, v154
    s_waitcnt vmcnt(12)
    v_mfma_f32_16x16x32_bf16 v[88:91], v[40:43], a[12:15], v[88:91]
    v_rcp_f32 v155, v155
    v_mfma_f32_16x16x32_bf16 v[88:91], v[44:47], a[16:19], v[88:91]
    buffer_load_dwordx4 v[28:31], v185, s[48:51], s23 offen offset:2048 sc1
    v_mfma_f32_16x16x32_bf16 v[88:91], v[48:51], a[20:23], v[88:91]
    v_mul_f32 v156, v156, v152
    v_mul_f32 v157, v157, v153
    v_mfma_f32_16x16x32_bf16 v[92:95], v[40:43], a[84:87], v[92:95]
    v_mul_f32 v158, v158, v154
    v_mul_f32 v159, v159, v155
    v_mfma_f32_16x16x32_bf16 v[92:95], v[44:47], a[88:91], v[92:95]
    v_cvt_pk_bf16_f32 v160, v156, v157
    v_cvt_pk_bf16_f32 v161, v158, v159
    v_mfma_f32_16x16x32_bf16 v[92:95], v[48:51], a[92:95], v[92:95]
    buffer_load_dwordx4 v[32:35], v185, s[48:51], s23 offen offset:3072 sc1
    v_mfma_f32_16x16x32_bf16 v[96:99], v[40:43], a[156:159], v[96:99]
    ds_write_b64 v12, v[160:161] offset:0
    v_mfma_f32_16x16x32_bf16 v[96:99], v[44:47], a[160:163], v[96:99]
    v_mul_f32 v162, v124, v124
    v_mul_f32 v163, v125, v125
    v_mfma_f32_16x16x32_bf16 v[96:99], v[48:51], a[164:167], v[96:99]
    v_mul_f32 v164, v126, v126
    v_mul_f32 v165, v127, v127
    v_mfma_f32_16x16x32_bf16 v[100:103], v[40:43], a[228:231], v[100:103]
    buffer_load_dwordx4 v[36:39], v186, s[48:51], s23 offen offset:0 sc1
    v_mfma_f32_16x16x32_bf16 v[100:103], v[44:47], a[232:235], v[100:103]
    v_fma_f32 v162, v162, v9, v5
    v_fma_f32 v163, v163, v9, v5
    v_mfma_f32_16x16x32_bf16 v[100:103], v[48:51], a[236:239], v[100:103]
    v_fma_f32 v164, v164, v9, v5
    v_fma_f32 v165, v165, v9, v5
    s_waitcnt vmcnt(12)
    v_mfma_f32_16x16x32_bf16 v[104:107], v[52:55], a[12:15], v[104:107]
    v_mul_f32 v162, v124, v162
    v_mul_f32 v163, v125, v163
    v_mfma_f32_16x16x32_bf16 v[104:107], v[56:59], a[16:19], v[104:107]
    buffer_load_dwordx4 v[40:43], v186, s[48:51], s23 offen offset:1024 sc1
    v_mfma_f32_16x16x32_bf16 v[104:107], v[60:63], a[20:23], v[104:107]
    v_mul_f32 v164, v126, v164
    v_mul_f32 v165, v127, v165
    v_mfma_f32_16x16x32_bf16 v[108:111], v[52:55], a[84:87], v[108:111]
    v_exp_f32 v162, v162
    v_mfma_f32_16x16x32_bf16 v[108:111], v[56:59], a[88:91], v[108:111]
    v_exp_f32 v163, v163
    v_mfma_f32_16x16x32_bf16 v[108:111], v[60:63], a[92:95], v[108:111]
    buffer_load_dwordx4 v[44:47], v186, s[48:51], s23 offen offset:2048 sc1
    v_mfma_f32_16x16x32_bf16 v[112:115], v[52:55], a[156:159], v[112:115]
    v_exp_f32 v164, v164
    v_mfma_f32_16x16x32_bf16 v[112:115], v[56:59], a[160:163], v[112:115]
    v_exp_f32 v165, v165
    v_mfma_f32_16x16x32_bf16 v[112:115], v[60:63], a[164:167], v[112:115]
    v_mul_f32 v166, v124, v140
    v_mul_f32 v167, v125, v141
    v_mfma_f32_16x16x32_bf16 v[116:119], v[52:55], a[228:231], v[116:119]
    buffer_load_dwordx4 v[48:51], v186, s[48:51], s23 offen offset:3072 sc1
    v_mfma_f32_16x16x32_bf16 v[116:119], v[56:59], a[232:235], v[116:119]
    v_mul_f32 v168, v126, v142
    v_mul_f32 v169, v127, v143
    v_mfma_f32_16x16x32_bf16 v[116:119], v[60:63], a[236:239], v[116:119]
    v_fma_f32 v162, v162, v194, v194
    v_fma_f32 v163, v163, v194, v194
    s_waitcnt vmcnt(12)
    v_mfma_f32_16x16x32_bf16 v[88:91], v[64:67], a[24:27], v[88:91]
    v_fma_f32 v164, v164, v194, v194
    v_fma_f32 v165, v165, v194, v194
    v_mfma_f32_16x16x32_bf16 v[88:91], v[68:71], a[28:31], v[88:91]
    buffer_load_dwordx4 v[52:55], v187, s[48:51], s23 offen offset:0 sc1
    v_mfma_f32_16x16x32_bf16 v[88:91], v[72:75], a[32:35], v[88:91]
    v_rcp_f32 v162, v162
    v_mfma_f32_16x16x32_bf16 v[92:95], v[64:67], a[96:99], v[92:95]
    v_rcp_f32 v163, v163
    v_mfma_f32_16x16x32_bf16 v[92:95], v[68:71], a[100:103], v[92:95]
    v_rcp_f32 v164, v164
    v_mfma_f32_16x16x32_bf16 v[92:95], v[72:75], a[104:107], v[92:95]
    buffer_load_dwordx4 v[56:59], v187, s[48:51], s23 offen offset:1024 sc1
    v_mfma_f32_16x16x32_bf16 v[96:99], v[64:67], a[168:171], v[96:99]
    v_rcp_f32 v165, v165
    v_mfma_f32_16x16x32_bf16 v[96:99], v[68:71], a[172:175], v[96:99]
    v_mul_f32 v166, v166, v162
    v_mul_f32 v167, v167, v163
    v_mfma_f32_16x16x32_bf16 v[96:99], v[72:75], a[176:179], v[96:99]
    v_mul_f32 v168, v168, v164
    v_mul_f32 v169, v169, v165
    v_mfma_f32_16x16x32_bf16 v[100:103], v[64:67], a[240:243], v[100:103]
    buffer_load_dwordx4 v[60:63], v187, s[48:51], s23 offen offset:2048 sc1
    v_mfma_f32_16x16x32_bf16 v[100:103], v[68:71], a[244:247], v[100:103]
    v_cvt_pk_bf16_f32 v170, v166, v167
    v_cvt_pk_bf16_f32 v171, v168, v169
    v_mfma_f32_16x16x32_bf16 v[100:103], v[72:75], a[248:251], v[100:103]
    ds_write_b64 v12, v[170:171] offset:18432
    s_waitcnt vmcnt(12)
    v_mfma_f32_16x16x32_bf16 v[104:107], v[76:79], a[24:27], v[104:107]
    v_mul_f32 v152, v128, v128
    v_mul_f32 v153, v129, v129
    v_mfma_f32_16x16x32_bf16 v[104:107], v[80:83], a[28:31], v[104:107]
    buffer_load_dwordx4 v[64:67], v187, s[48:51], s23 offen offset:3072 sc1
    v_mfma_f32_16x16x32_bf16 v[104:107], v[84:87], a[32:35], v[104:107]
    v_mul_f32 v154, v130, v130
    v_mul_f32 v155, v131, v131
    v_mfma_f32_16x16x32_bf16 v[108:111], v[76:79], a[96:99], v[108:111]
    v_fma_f32 v152, v152, v13, v6
    v_fma_f32 v153, v153, v13, v6
    v_mfma_f32_16x16x32_bf16 v[108:111], v[80:83], a[100:103], v[108:111]
    v_fma_f32 v154, v154, v13, v6
    v_fma_f32 v155, v155, v13, v6
    v_mfma_f32_16x16x32_bf16 v[108:111], v[84:87], a[104:107], v[108:111]
    buffer_load_dwordx4 v[68:71], v188, s[48:51], s23 offen offset:0 sc1
    v_mfma_f32_16x16x32_bf16 v[112:115], v[76:79], a[168:171], v[112:115]
    v_mul_f32 v152, v128, v152
    v_mul_f32 v153, v129, v153
    v_mfma_f32_16x16x32_bf16 v[112:115], v[80:83], a[172:175], v[112:115]
    v_mul_f32 v154, v130, v154
    v_mul_f32 v155, v131, v155
    v_mfma_f32_16x16x32_bf16 v[112:115], v[84:87], a[176:179], v[112:115]
    v_exp_f32 v152, v152
    v_mfma_f32_16x16x32_bf16 v[116:119], v[76:79], a[240:243], v[116:119]
    buffer_load_dwordx4 v[72:75], v188, s[48:51], s23 offen offset:1024 sc1
    v_mfma_f32_16x16x32_bf16 v[116:119], v[80:83], a[244:247], v[116:119]
    v_exp_f32 v153, v153
    v_mfma_f32_16x16x32_bf16 v[116:119], v[84:87], a[248:251], v[116:119]
    v_exp_f32 v154, v154
    s_waitcnt vmcnt(12)
    v_mfma_f32_16x16x32_bf16 v[88:91], v[16:19], a[36:39], v[88:91]
    v_exp_f32 v155, v155
    v_mfma_f32_16x16x32_bf16 v[88:91], v[20:23], a[40:43], v[88:91]
    buffer_load_dwordx4 v[76:79], v188, s[48:51], s23 offen offset:2048 sc1
    v_mfma_f32_16x16x32_bf16 v[88:91], v[24:27], a[44:47], v[88:91]
    v_mul_f32 v156, v128, v144
    v_mul_f32 v157, v129, v145
    v_mfma_f32_16x16x32_bf16 v[92:95], v[16:19], a[108:111], v[92:95]
    v_mul_f32 v158, v130, v146
    v_mul_f32 v159, v131, v147
    v_mfma_f32_16x16x32_bf16 v[92:95], v[20:23], a[112:115], v[92:95]
    v_fma_f32 v152, v152, v195, v195
    v_fma_f32 v153, v153, v195, v195
    v_mfma_f32_16x16x32_bf16 v[92:95], v[24:27], a[116:119], v[92:95]
    buffer_load_dwordx4 v[80:83], v188, s[48:51], s23 offen offset:3072 sc1
    v_mfma_f32_16x16x32_bf16 v[96:99], v[16:19], a[180:183], v[96:99]
    v_fma_f32 v154, v154, v195, v195
    v_fma_f32 v155, v155, v195, v195
    v_mfma_f32_16x16x32_bf16 v[96:99], v[20:23], a[184:187], v[96:99]
    v_rcp_f32 v152, v152
    v_mfma_f32_16x16x32_bf16 v[96:99], v[24:27], a[188:191], v[96:99]
    v_rcp_f32 v153, v153
    v_mfma_f32_16x16x32_bf16 v[100:103], v[16:19], a[252:255], v[100:103]
    buffer_load_dwordx4 v[84:87], v189, s[48:51], s23 offen offset:0 sc1
    v_mfma_f32_16x16x32_bf16 v[100:103], v[20:23], v[220:223], v[100:103]
    v_rcp_f32 v154, v154
    v_mfma_f32_16x16x32_bf16 v[100:103], v[24:27], v[224:227], v[100:103]
    v_rcp_f32 v155, v155
    s_waitcnt vmcnt(12)
    v_mfma_f32_16x16x32_bf16 v[104:107], v[28:31], a[36:39], v[104:107]
    v_mul_f32 v156, v156, v152
    v_mul_f32 v157, v157, v153
    v_mfma_f32_16x16x32_bf16 v[104:107], v[32:35], a[40:43], v[104:107]
    buffer_load_dwordx4 v[16:19], v189, s[48:51], s23 offen offset:1024 sc1
    v_mfma_f32_16x16x32_bf16 v[104:107], v[36:39], a[44:47], v[104:107]
    v_mul_f32 v158, v158, v154
    v_mul_f32 v159, v159, v155
    v_mfma_f32_16x16x32_bf16 v[108:111], v[28:31], a[108:111], v[108:111]
    v_cvt_pk_bf16_f32 v160, v156, v157
    v_cvt_pk_bf16_f32 v161, v158, v159
    v_mfma_f32_16x16x32_bf16 v[108:111], v[32:35], a[112:115], v[108:111]
    ds_write_b64 v12, v[160:161] offset:36864
    v_mfma_f32_16x16x32_bf16 v[108:111], v[36:39], a[116:119], v[108:111]
    buffer_load_dwordx4 v[20:23], v189, s[48:51], s23 offen offset:2048 sc1
    v_mfma_f32_16x16x32_bf16 v[112:115], v[28:31], a[180:183], v[112:115]
    v_mul_f32 v162, v132, v132
    v_mul_f32 v163, v133, v133
    v_mfma_f32_16x16x32_bf16 v[112:115], v[32:35], a[184:187], v[112:115]
    v_mul_f32 v164, v134, v134
    v_mul_f32 v165, v135, v135
    v_mfma_f32_16x16x32_bf16 v[112:115], v[36:39], a[188:191], v[112:115]
    v_fma_f32 v162, v162, v14, v7
    v_fma_f32 v163, v163, v14, v7
    v_mfma_f32_16x16x32_bf16 v[116:119], v[28:31], a[252:255], v[116:119]
    buffer_load_dwordx4 v[24:27], v189, s[48:51], s23 offen offset:3072 sc1
    v_mfma_f32_16x16x32_bf16 v[116:119], v[32:35], v[220:223], v[116:119]
    v_fma_f32 v164, v164, v14, v7
    v_fma_f32 v165, v165, v14, v7
    v_mfma_f32_16x16x32_bf16 v[116:119], v[36:39], v[224:227], v[116:119]
    v_mul_f32 v162, v132, v162
    v_mul_f32 v163, v133, v163
    s_waitcnt vmcnt(12)
    v_mfma_f32_16x16x32_bf16 v[88:91], v[40:43], a[48:51], v[88:91]
    v_mul_f32 v164, v134, v164
    v_mul_f32 v165, v135, v165
    v_mfma_f32_16x16x32_bf16 v[88:91], v[44:47], a[52:55], v[88:91]
    buffer_load_dwordx4 v[28:31], v190, s[48:51], s23 offen offset:0 sc1
    v_mfma_f32_16x16x32_bf16 v[88:91], v[48:51], a[56:59], v[88:91]
    v_exp_f32 v162, v162
    v_mfma_f32_16x16x32_bf16 v[92:95], v[40:43], a[120:123], v[92:95]
    v_exp_f32 v163, v163
    v_mfma_f32_16x16x32_bf16 v[92:95], v[44:47], a[124:127], v[92:95]
    v_exp_f32 v164, v164
    v_mfma_f32_16x16x32_bf16 v[92:95], v[48:51], a[128:131], v[92:95]
    buffer_load_dwordx4 v[32:35], v190, s[48:51], s23 offen offset:1024 sc1
    v_mfma_f32_16x16x32_bf16 v[96:99], v[40:43], a[192:195], v[96:99]
    v_exp_f32 v165, v165
    v_mfma_f32_16x16x32_bf16 v[96:99], v[44:47], a[196:199], v[96:99]
    v_mul_f32 v166, v132, v148
    v_mul_f32 v167, v133, v149
    v_mfma_f32_16x16x32_bf16 v[96:99], v[48:51], a[200:203], v[96:99]
    v_mul_f32 v168, v134, v150
    v_mul_f32 v169, v135, v151
    v_mfma_f32_16x16x32_bf16 v[100:103], v[40:43], v[228:231], v[100:103]
    buffer_load_dwordx4 v[36:39], v190, s[48:51], s23 offen offset:2048 sc1
    v_mfma_f32_16x16x32_bf16 v[100:103], v[44:47], v[232:235], v[100:103]
    v_fma_f32 v162, v162, v252, v252
    v_fma_f32 v163, v163, v252, v252
    v_mfma_f32_16x16x32_bf16 v[100:103], v[48:51], v[236:239], v[100:103]
    v_fma_f32 v164, v164, v252, v252
    v_fma_f32 v165, v165, v252, v252
    s_waitcnt vmcnt(12)
    v_mfma_f32_16x16x32_bf16 v[104:107], v[52:55], a[48:51], v[104:107]
    v_rcp_f32 v162, v162
    v_mfma_f32_16x16x32_bf16 v[104:107], v[56:59], a[52:55], v[104:107]
    buffer_load_dwordx4 v[40:43], v190, s[48:51], s23 offen offset:3072 sc1
    v_mfma_f32_16x16x32_bf16 v[104:107], v[60:63], a[56:59], v[104:107]
    v_rcp_f32 v163, v163
    v_mfma_f32_16x16x32_bf16 v[108:111], v[52:55], a[120:123], v[108:111]
    v_rcp_f32 v164, v164
    v_mfma_f32_16x16x32_bf16 v[108:111], v[56:59], a[124:127], v[108:111]
    v_rcp_f32 v165, v165
    v_mfma_f32_16x16x32_bf16 v[108:111], v[60:63], a[128:131], v[108:111]
    buffer_load_dwordx4 v[44:47], v191, s[48:51], s23 offen offset:0 sc1
    v_mfma_f32_16x16x32_bf16 v[112:115], v[52:55], a[192:195], v[112:115]
    v_mul_f32 v166, v166, v162
    v_mul_f32 v167, v167, v163
    v_mfma_f32_16x16x32_bf16 v[112:115], v[56:59], a[196:199], v[112:115]
    v_mul_f32 v168, v168, v164
    v_mul_f32 v169, v169, v165
    v_mfma_f32_16x16x32_bf16 v[112:115], v[60:63], a[200:203], v[112:115]
    v_cvt_pk_bf16_f32 v170, v166, v167
    v_cvt_pk_bf16_f32 v171, v168, v169
    v_mfma_f32_16x16x32_bf16 v[116:119], v[52:55], v[228:231], v[116:119]
    buffer_load_dwordx4 v[48:51], v191, s[48:51], s23 offen offset:1024 sc1
    v_mfma_f32_16x16x32_bf16 v[116:119], v[56:59], v[232:235], v[116:119]
    ds_write_b64 v12, v[170:171] offset:55296
    v_mfma_f32_16x16x32_bf16 v[116:119], v[60:63], v[236:239], v[116:119]
    s_waitcnt vmcnt(12)
    v_mfma_f32_16x16x32_bf16 v[88:91], v[64:67], a[60:63], v[88:91]
    v_mfma_f32_16x16x32_bf16 v[88:91], v[68:71], a[64:67], v[88:91]
    buffer_load_dwordx4 v[52:55], v191, s[48:51], s23 offen offset:2048 sc1
    v_mfma_f32_16x16x32_bf16 v[120:123], v[72:75], a[68:71], v[88:91]
    v_mfma_f32_16x16x32_bf16 v[92:95], v[64:67], a[132:135], v[92:95]
    v_mfma_f32_16x16x32_bf16 v[92:95], v[68:71], a[136:139], v[92:95]
    v_mfma_f32_16x16x32_bf16 v[124:127], v[72:75], a[140:143], v[92:95]
    buffer_load_dwordx4 v[56:59], v191, s[48:51], s23 offen offset:3072 sc1
    v_mfma_f32_16x16x32_bf16 v[96:99], v[64:67], a[204:207], v[96:99]
    v_mfma_f32_16x16x32_bf16 v[96:99], v[68:71], a[208:211], v[96:99]
    v_mfma_f32_16x16x32_bf16 v[128:131], v[72:75], a[212:215], v[96:99]
    v_mfma_f32_16x16x32_bf16 v[100:103], v[64:67], v[240:243], v[100:103]
    buffer_load_dwordx4 v[60:63], v192, s[48:51], s23 offen offset:0 sc1
    v_mfma_f32_16x16x32_bf16 v[100:103], v[68:71], v[244:247], v[100:103]
    v_mfma_f32_16x16x32_bf16 v[132:135], v[72:75], v[248:251], v[100:103]
    s_waitcnt vmcnt(12)
    v_mfma_f32_16x16x32_bf16 v[104:107], v[76:79], a[60:63], v[104:107]
    v_mfma_f32_16x16x32_bf16 v[104:107], v[80:83], a[64:67], v[104:107]
    buffer_load_dwordx4 v[64:67], v192, s[48:51], s23 offen offset:1024 sc1
    v_mfma_f32_16x16x32_bf16 v[136:139], v[84:87], a[68:71], v[104:107]
    v_mfma_f32_16x16x32_bf16 v[108:111], v[76:79], a[132:135], v[108:111]
    v_mfma_f32_16x16x32_bf16 v[108:111], v[80:83], a[136:139], v[108:111]
    v_mfma_f32_16x16x32_bf16 v[140:143], v[84:87], a[140:143], v[108:111]
    buffer_load_dwordx4 v[68:71], v192, s[48:51], s23 offen offset:2048 sc1
    v_mfma_f32_16x16x32_bf16 v[112:115], v[76:79], a[204:207], v[112:115]
    v_mfma_f32_16x16x32_bf16 v[112:115], v[80:83], a[208:211], v[112:115]
    s_lshl_b32 s7, s25, 11
    v_mfma_f32_16x16x32_bf16 v[144:147], v[84:87], a[212:215], v[112:115]
    s_add_u32 s7, s7, s28
    v_mfma_f32_16x16x32_bf16 v[116:119], v[76:79], v[240:243], v[116:119]
    buffer_load_dwordx4 v[72:75], v192, s[48:51], s23 offen offset:3072 sc1
    v_mfma_f32_16x16x32_bf16 v[116:119], v[80:83], v[244:247], v[116:119]
    s_add_u32 s23, s23, 36864
    v_mfma_f32_16x16x32_bf16 v[148:151], v[84:87], v[248:251], v[116:119]
    v_add_u32 v12, s7, v184
    s_add_u32 s25, s25, 1
    s_cmp_lt_u32 s25, 8
    s_cbranch_scc1 L_ffn_gu_34
    v_add_u32 v10, 73728, v184
    v_add_u32 v11, 110592, v184
    s_lshr_b32 s7, s2, 3
    s_lshl_b32 s7, s7, 2
    s_add_u32 s7, s7, s3
    s_lshl_b32 s7, s7, 9
    v_lshrrev_b32 v1, 1, v253
    v_add_u32 v1, s7, v1
    buffer_load_dwordx2 v[2:3], v1, s[96:99], 0 offen
    s_waitcnt lgkmcnt(0)
    s_barrier
    s_waitcnt vmcnt(12)
    v_mfma_f32_16x16x32_bf16 v[88:91], v[16:19], a[0:3], 0
    v_mfma_f32_16x16x32_bf16 v[88:91], v[20:23], a[4:7], v[88:91]
    buffer_load_dwordx4 v[76:79], v184, s[48:51], s23 offen offset:0 sc1
    v_mfma_f32_16x16x32_bf16 v[88:91], v[24:27], a[8:11], v[88:91]
    v_mul_f32 v152, v120, v120
    v_mul_f32 v153, v121, v121
    v_mfma_f32_16x16x32_bf16 v[92:95], v[16:19], a[72:75], 0
    v_mul_f32 v154, v122, v122
    v_mul_f32 v155, v123, v123
    v_mfma_f32_16x16x32_bf16 v[92:95], v[20:23], a[76:79], v[92:95]
    v_fma_f32 v152, v152, v8, v4
    v_fma_f32 v153, v153, v8, v4
    v_mfma_f32_16x16x32_bf16 v[92:95], v[24:27], a[80:83], v[92:95]
    buffer_load_dwordx4 v[80:83], v184, s[48:51], s23 offen offset:1024 sc1
    v_mfma_f32_16x16x32_bf16 v[96:99], v[16:19], a[144:147], 0
    v_fma_f32 v154, v154, v8, v4
    v_fma_f32 v155, v155, v8, v4
    v_mfma_f32_16x16x32_bf16 v[96:99], v[20:23], a[148:151], v[96:99]
    v_mul_f32 v152, v120, v152
    v_mul_f32 v153, v121, v153
    v_mfma_f32_16x16x32_bf16 v[96:99], v[24:27], a[152:155], v[96:99]
    v_mul_f32 v154, v122, v154
    v_mul_f32 v155, v123, v155
    v_mfma_f32_16x16x32_bf16 v[100:103], v[16:19], a[216:219], 0
    buffer_load_dwordx4 v[84:87], v184, s[48:51], s23 offen offset:2048 sc1
    v_mfma_f32_16x16x32_bf16 v[100:103], v[20:23], a[220:223], v[100:103]
    v_exp_f32 v152, v152
    v_mfma_f32_16x16x32_bf16 v[100:103], v[24:27], a[224:227], v[100:103]
    v_exp_f32 v153, v153
    s_waitcnt vmcnt(12)
    v_mfma_f32_16x16x32_bf16 v[104:107], v[28:31], a[0:3], 0
    v_exp_f32 v154, v154
    ds_read_b128 a[0:3], v10 offset:0
    v_mfma_f32_16x16x32_bf16 v[104:107], v[32:35], a[4:7], v[104:107]
    buffer_load_dwordx4 v[16:19], v184, s[48:51], s23 offen offset:3072 sc1
    v_mfma_f32_16x16x32_bf16 v[104:107], v[36:39], a[8:11], v[104:107]
    v_exp_f32 v155, v155
    v_mfma_f32_16x16x32_bf16 v[108:111], v[28:31], a[72:75], 0
    v_mul_f32 v156, v120, v136
    v_mul_f32 v157, v121, v137
    ds_read_b128 a[72:75], v10 offset:18432
    v_mfma_f32_16x16x32_bf16 v[108:111], v[32:35], a[76:79], v[108:111]
    v_mul_f32 v158, v122, v138
    v_mul_f32 v159, v123, v139
    v_mfma_f32_16x16x32_bf16 v[108:111], v[36:39], a[80:83], v[108:111]
    buffer_load_dwordx4 v[20:23], v185, s[48:51], s23 offen offset:0 sc1
    v_mfma_f32_16x16x32_bf16 v[112:115], v[28:31], a[144:147], 0
    v_fma_f32 v152, v152, v193, v193
    v_fma_f32 v153, v153, v193, v193
    ds_read_b128 a[144:147], v11 offset:0
    v_mfma_f32_16x16x32_bf16 v[112:115], v[32:35], a[148:151], v[112:115]
    v_fma_f32 v154, v154, v193, v193
    v_fma_f32 v155, v155, v193, v193
    v_mfma_f32_16x16x32_bf16 v[112:115], v[36:39], a[152:155], v[112:115]
    v_rcp_f32 v152, v152
    v_mfma_f32_16x16x32_bf16 v[116:119], v[28:31], a[216:219], 0
    buffer_load_dwordx4 v[24:27], v185, s[48:51], s23 offen offset:1024 sc1
    v_mfma_f32_16x16x32_bf16 v[116:119], v[32:35], a[220:223], v[116:119]
    v_rcp_f32 v153, v153
    ds_read_b128 a[216:219], v11 offset:18432
    v_mfma_f32_16x16x32_bf16 v[116:119], v[36:39], a[224:227], v[116:119]
    v_rcp_f32 v154, v154
    ds_read_b128 a[4:7], v10 offset:1024
    s_waitcnt vmcnt(12)
    v_mfma_f32_16x16x32_bf16 v[88:91], v[40:43], a[12:15], v[88:91]
    v_rcp_f32 v155, v155
    ds_read_b128 a[76:79], v10 offset:19456
    v_mfma_f32_16x16x32_bf16 v[88:91], v[44:47], a[16:19], v[88:91]
    buffer_load_dwordx4 v[28:31], v185, s[48:51], s23 offen offset:2048 sc1
    v_mfma_f32_16x16x32_bf16 v[88:91], v[48:51], a[20:23], v[88:91]
    v_mul_f32 v156, v156, v152
    v_mul_f32 v157, v157, v153
    ds_read_b128 a[148:151], v11 offset:1024
    v_mfma_f32_16x16x32_bf16 v[92:95], v[40:43], a[84:87], v[92:95]
    v_mul_f32 v158, v158, v154
    v_mul_f32 v159, v159, v155
    ds_read_b128 a[220:223], v11 offset:19456
    v_mfma_f32_16x16x32_bf16 v[92:95], v[44:47], a[88:91], v[92:95]
    v_cvt_pk_bf16_f32 v160, v156, v157
    v_cvt_pk_bf16_f32 v161, v158, v159
    ds_read_b128 a[8:11], v10 offset:2048
    v_mfma_f32_16x16x32_bf16 v[92:95], v[48:51], a[92:95], v[92:95]
    buffer_load_dwordx4 v[32:35], v185, s[48:51], s23 offen offset:3072 sc1
    v_mfma_f32_16x16x32_bf16 v[96:99], v[40:43], a[156:159], v[96:99]
    ds_write_b64 v12, v[160:161] offset:0
    v_mfma_f32_16x16x32_bf16 v[96:99], v[44:47], a[160:163], v[96:99]
    v_mul_f32 v162, v124, v124
    v_mul_f32 v163, v125, v125
    ds_read_b128 a[80:83], v10 offset:20480
    v_mfma_f32_16x16x32_bf16 v[96:99], v[48:51], a[164:167], v[96:99]
    v_mul_f32 v164, v126, v126
    v_mul_f32 v165, v127, v127
    ds_read_b128 a[152:155], v11 offset:2048
    v_mfma_f32_16x16x32_bf16 v[100:103], v[40:43], a[228:231], v[100:103]
    buffer_load_dwordx4 v[36:39], v186, s[48:51], s23 offen offset:0 sc1
    v_mfma_f32_16x16x32_bf16 v[100:103], v[44:47], a[232:235], v[100:103]
    v_fma_f32 v162, v162, v9, v5
    v_fma_f32 v163, v163, v9, v5
    ds_read_b128 a[224:227], v11 offset:20480
    v_mfma_f32_16x16x32_bf16 v[100:103], v[48:51], a[236:239], v[100:103]
    v_fma_f32 v164, v164, v9, v5
    v_fma_f32 v165, v165, v9, v5
    s_waitcnt vmcnt(12)
    v_mfma_f32_16x16x32_bf16 v[104:107], v[52:55], a[12:15], v[104:107]
    v_mul_f32 v162, v124, v162
    v_mul_f32 v163, v125, v163
    ds_read_b128 a[12:15], v10 offset:3072
    v_mfma_f32_16x16x32_bf16 v[104:107], v[56:59], a[16:19], v[104:107]
    buffer_load_dwordx4 v[40:43], v186, s[48:51], s23 offen offset:1024 sc1
    v_mfma_f32_16x16x32_bf16 v[104:107], v[60:63], a[20:23], v[104:107]
    v_mul_f32 v164, v126, v164
    v_mul_f32 v165, v127, v165
    v_mfma_f32_16x16x32_bf16 v[108:111], v[52:55], a[84:87], v[108:111]
    v_exp_f32 v162, v162
    ds_read_b128 a[84:87], v10 offset:21504
    v_mfma_f32_16x16x32_bf16 v[108:111], v[56:59], a[88:91], v[108:111]
    v_exp_f32 v163, v163
    v_mfma_f32_16x16x32_bf16 v[108:111], v[60:63], a[92:95], v[108:111]
    buffer_load_dwordx4 v[44:47], v186, s[48:51], s23 offen offset:2048 sc1
    v_mfma_f32_16x16x32_bf16 v[112:115], v[52:55], a[156:159], v[112:115]
    v_exp_f32 v164, v164
    ds_read_b128 a[156:159], v11 offset:3072
    v_mfma_f32_16x16x32_bf16 v[112:115], v[56:59], a[160:163], v[112:115]
    v_exp_f32 v165, v165
    v_mfma_f32_16x16x32_bf16 v[112:115], v[60:63], a[164:167], v[112:115]
    v_mul_f32 v166, v124, v140
    v_mul_f32 v167, v125, v141
    v_mfma_f32_16x16x32_bf16 v[116:119], v[52:55], a[228:231], v[116:119]
    buffer_load_dwordx4 v[48:51], v186, s[48:51], s23 offen offset:3072 sc1
    v_mfma_f32_16x16x32_bf16 v[116:119], v[56:59], a[232:235], v[116:119]
    v_mul_f32 v168, v126, v142
    v_mul_f32 v169, v127, v143
    ds_read_b128 a[228:231], v11 offset:21504
    v_mfma_f32_16x16x32_bf16 v[116:119], v[60:63], a[236:239], v[116:119]
    v_fma_f32 v162, v162, v194, v194
    v_fma_f32 v163, v163, v194, v194
    ds_read_b128 a[16:19], v10 offset:4096
    s_waitcnt vmcnt(12)
    v_mfma_f32_16x16x32_bf16 v[88:91], v[64:67], a[24:27], v[88:91]
    v_fma_f32 v164, v164, v194, v194
    v_fma_f32 v165, v165, v194, v194
    ds_read_b128 a[88:91], v10 offset:22528
    v_mfma_f32_16x16x32_bf16 v[88:91], v[68:71], a[28:31], v[88:91]
    buffer_load_dwordx4 v[52:55], v187, s[48:51], s23 offen offset:0 sc1
    v_mfma_f32_16x16x32_bf16 v[88:91], v[72:75], a[32:35], v[88:91]
    v_rcp_f32 v162, v162
    ds_read_b128 a[160:163], v11 offset:4096
    v_mfma_f32_16x16x32_bf16 v[92:95], v[64:67], a[96:99], v[92:95]
    v_rcp_f32 v163, v163
    ds_read_b128 a[232:235], v11 offset:22528
    v_mfma_f32_16x16x32_bf16 v[92:95], v[68:71], a[100:103], v[92:95]
    v_rcp_f32 v164, v164
    ds_read_b128 a[20:23], v10 offset:5120
    v_mfma_f32_16x16x32_bf16 v[92:95], v[72:75], a[104:107], v[92:95]
    buffer_load_dwordx4 v[56:59], v187, s[48:51], s23 offen offset:1024 sc1
    v_mfma_f32_16x16x32_bf16 v[96:99], v[64:67], a[168:171], v[96:99]
    v_rcp_f32 v165, v165
    ds_read_b128 a[92:95], v10 offset:23552
    v_mfma_f32_16x16x32_bf16 v[96:99], v[68:71], a[172:175], v[96:99]
    v_mul_f32 v166, v166, v162
    v_mul_f32 v167, v167, v163
    ds_read_b128 a[164:167], v11 offset:5120
    v_mfma_f32_16x16x32_bf16 v[96:99], v[72:75], a[176:179], v[96:99]
    v_mul_f32 v168, v168, v164
    v_mul_f32 v169, v169, v165
    ds_read_b128 a[236:239], v11 offset:23552
    v_mfma_f32_16x16x32_bf16 v[100:103], v[64:67], a[240:243], v[100:103]
    buffer_load_dwordx4 v[60:63], v187, s[48:51], s23 offen offset:2048 sc1
    v_mfma_f32_16x16x32_bf16 v[100:103], v[68:71], a[244:247], v[100:103]
    v_cvt_pk_bf16_f32 v170, v166, v167
    v_cvt_pk_bf16_f32 v171, v168, v169
    v_mfma_f32_16x16x32_bf16 v[100:103], v[72:75], a[248:251], v[100:103]
    ds_write_b64 v12, v[170:171] offset:18432
    s_waitcnt vmcnt(12)
    v_mfma_f32_16x16x32_bf16 v[104:107], v[76:79], a[24:27], v[104:107]
    v_mul_f32 v152, v128, v128
    v_mul_f32 v153, v129, v129
    ds_read_b128 a[24:27], v10 offset:6144
    v_mfma_f32_16x16x32_bf16 v[104:107], v[80:83], a[28:31], v[104:107]
    buffer_load_dwordx4 v[64:67], v187, s[48:51], s23 offen offset:3072 sc1
    v_mfma_f32_16x16x32_bf16 v[104:107], v[84:87], a[32:35], v[104:107]
    v_mul_f32 v154, v130, v130
    v_mul_f32 v155, v131, v131
    v_mfma_f32_16x16x32_bf16 v[108:111], v[76:79], a[96:99], v[108:111]
    v_fma_f32 v152, v152, v13, v6
    v_fma_f32 v153, v153, v13, v6
    ds_read_b128 a[96:99], v10 offset:24576
    v_mfma_f32_16x16x32_bf16 v[108:111], v[80:83], a[100:103], v[108:111]
    v_fma_f32 v154, v154, v13, v6
    v_fma_f32 v155, v155, v13, v6
    v_mfma_f32_16x16x32_bf16 v[108:111], v[84:87], a[104:107], v[108:111]
    buffer_load_dwordx4 v[68:71], v188, s[48:51], s23 offen offset:0 sc1
    v_mfma_f32_16x16x32_bf16 v[112:115], v[76:79], a[168:171], v[112:115]
    v_mul_f32 v152, v128, v152
    v_mul_f32 v153, v129, v153
    ds_read_b128 a[168:171], v11 offset:6144
    v_mfma_f32_16x16x32_bf16 v[112:115], v[80:83], a[172:175], v[112:115]
    v_mul_f32 v154, v130, v154
    v_mul_f32 v155, v131, v155
    v_mfma_f32_16x16x32_bf16 v[112:115], v[84:87], a[176:179], v[112:115]
    v_exp_f32 v152, v152
    v_mfma_f32_16x16x32_bf16 v[116:119], v[76:79], a[240:243], v[116:119]
    buffer_load_dwordx4 v[72:75], v188, s[48:51], s23 offen offset:1024 sc1
    v_mfma_f32_16x16x32_bf16 v[116:119], v[80:83], a[244:247], v[116:119]
    v_exp_f32 v153, v153
    ds_read_b128 a[240:243], v11 offset:24576
    v_mfma_f32_16x16x32_bf16 v[116:119], v[84:87], a[248:251], v[116:119]
    v_exp_f32 v154, v154
    ds_read_b128 a[28:31], v10 offset:7168
    s_waitcnt vmcnt(12)
    v_mfma_f32_16x16x32_bf16 v[88:91], v[16:19], a[36:39], v[88:91]
    v_exp_f32 v155, v155
    ds_read_b128 a[100:103], v10 offset:25600
    v_mfma_f32_16x16x32_bf16 v[88:91], v[20:23], a[40:43], v[88:91]
    buffer_load_dwordx4 v[76:79], v188, s[48:51], s23 offen offset:2048 sc1
    v_mfma_f32_16x16x32_bf16 v[88:91], v[24:27], a[44:47], v[88:91]
    v_mul_f32 v156, v128, v144
    v_mul_f32 v157, v129, v145
    ds_read_b128 a[172:175], v11 offset:7168
    v_mfma_f32_16x16x32_bf16 v[92:95], v[16:19], a[108:111], v[92:95]
    v_mul_f32 v158, v130, v146
    v_mul_f32 v159, v131, v147
    ds_read_b128 a[244:247], v11 offset:25600
    v_mfma_f32_16x16x32_bf16 v[92:95], v[20:23], a[112:115], v[92:95]
    v_fma_f32 v152, v152, v195, v195
    v_fma_f32 v153, v153, v195, v195
    ds_read_b128 a[32:35], v10 offset:8192
    v_mfma_f32_16x16x32_bf16 v[92:95], v[24:27], a[116:119], v[92:95]
    buffer_load_dwordx4 v[80:83], v188, s[48:51], s23 offen offset:3072 sc1
    v_mfma_f32_16x16x32_bf16 v[96:99], v[16:19], a[180:183], v[96:99]
    v_fma_f32 v154, v154, v195, v195
    v_fma_f32 v155, v155, v195, v195
    ds_read_b128 a[104:107], v10 offset:26624
    v_mfma_f32_16x16x32_bf16 v[96:99], v[20:23], a[184:187], v[96:99]
    v_rcp_f32 v152, v152
    ds_read_b128 a[176:179], v11 offset:8192
    v_mfma_f32_16x16x32_bf16 v[96:99], v[24:27], a[188:191], v[96:99]
    v_rcp_f32 v153, v153
    ds_read_b128 a[248:251], v11 offset:26624
    v_mfma_f32_16x16x32_bf16 v[100:103], v[16:19], a[252:255], v[100:103]
    buffer_load_dwordx4 v[84:87], v189, s[48:51], s23 offen offset:0 sc1
    v_mfma_f32_16x16x32_bf16 v[100:103], v[20:23], v[220:223], v[100:103]
    v_rcp_f32 v154, v154
    v_mfma_f32_16x16x32_bf16 v[100:103], v[24:27], v[224:227], v[100:103]
    v_rcp_f32 v155, v155
    s_waitcnt vmcnt(12)
    v_mfma_f32_16x16x32_bf16 v[104:107], v[28:31], a[36:39], v[104:107]
    v_mul_f32 v156, v156, v152
    v_mul_f32 v157, v157, v153
    ds_read_b128 a[36:39], v10 offset:9216
    v_mfma_f32_16x16x32_bf16 v[104:107], v[32:35], a[40:43], v[104:107]
    buffer_load_dwordx4 v[16:19], v189, s[48:51], s23 offen offset:1024 sc1
    v_mfma_f32_16x16x32_bf16 v[104:107], v[36:39], a[44:47], v[104:107]
    v_mul_f32 v158, v158, v154
    v_mul_f32 v159, v159, v155
    v_mfma_f32_16x16x32_bf16 v[108:111], v[28:31], a[108:111], v[108:111]
    v_cvt_pk_bf16_f32 v160, v156, v157
    v_cvt_pk_bf16_f32 v161, v158, v159
    ds_read_b128 a[108:111], v10 offset:27648
    v_mfma_f32_16x16x32_bf16 v[108:111], v[32:35], a[112:115], v[108:111]
    ds_write_b64 v12, v[160:161] offset:36864
    v_mfma_f32_16x16x32_bf16 v[108:111], v[36:39], a[116:119], v[108:111]
    buffer_load_dwordx4 v[20:23], v189, s[48:51], s23 offen offset:2048 sc1
    v_mfma_f32_16x16x32_bf16 v[112:115], v[28:31], a[180:183], v[112:115]
    v_mul_f32 v162, v132, v132
    v_mul_f32 v163, v133, v133
    ds_read_b128 a[180:183], v11 offset:9216
    v_mfma_f32_16x16x32_bf16 v[112:115], v[32:35], a[184:187], v[112:115]
    v_mul_f32 v164, v134, v134
    v_mul_f32 v165, v135, v135
    v_mfma_f32_16x16x32_bf16 v[112:115], v[36:39], a[188:191], v[112:115]
    v_fma_f32 v162, v162, v14, v7
    v_fma_f32 v163, v163, v14, v7
    v_mfma_f32_16x16x32_bf16 v[116:119], v[28:31], a[252:255], v[116:119]
    buffer_load_dwordx4 v[24:27], v189, s[48:51], s23 offen offset:3072 sc1
    v_mfma_f32_16x16x32_bf16 v[116:119], v[32:35], v[220:223], v[116:119]
    v_fma_f32 v164, v164, v14, v7
    v_fma_f32 v165, v165, v14, v7
    ds_read_b128 a[252:255], v11 offset:27648
    v_mfma_f32_16x16x32_bf16 v[116:119], v[36:39], v[224:227], v[116:119]
    v_mul_f32 v162, v132, v162
    v_mul_f32 v163, v133, v163
    ds_read_b128 a[40:43], v10 offset:10240
    s_waitcnt vmcnt(12)
    v_mfma_f32_16x16x32_bf16 v[88:91], v[40:43], a[48:51], v[88:91]
    v_mul_f32 v164, v134, v164
    v_mul_f32 v165, v135, v165
    ds_read_b128 a[112:115], v10 offset:28672
    v_mfma_f32_16x16x32_bf16 v[88:91], v[44:47], a[52:55], v[88:91]
    buffer_load_dwordx4 v[28:31], v190, s[48:51], s23 offen offset:0 sc1
    v_mfma_f32_16x16x32_bf16 v[88:91], v[48:51], a[56:59], v[88:91]
    v_exp_f32 v162, v162
    ds_read_b128 a[184:187], v11 offset:10240
    v_mfma_f32_16x16x32_bf16 v[92:95], v[40:43], a[120:123], v[92:95]
    v_exp_f32 v163, v163
    ds_read_b128 v[220:223], v11 offset:28672
    v_mfma_f32_16x16x32_bf16 v[92:95], v[44:47], a[124:127], v[92:95]
    v_exp_f32 v164, v164
    ds_read_b128 a[44:47], v10 offset:11264
    v_mfma_f32_16x16x32_bf16 v[92:95], v[48:51], a[128:131], v[92:95]
    buffer_load_dwordx4 v[32:35], v190, s[48:51], s23 offen offset:1024 sc1
    v_mfma_f32_16x16x32_bf16 v[96:99], v[40:43], a[192:195], v[96:99]
    v_exp_f32 v165, v165
    ds_read_b128 a[116:119], v10 offset:29696
    v_mfma_f32_16x16x32_bf16 v[96:99], v[44:47], a[196:199], v[96:99]
    v_mul_f32 v166, v132, v148
    v_mul_f32 v167, v133, v149
    ds_read_b128 a[188:191], v11 offset:11264
    v_mfma_f32_16x16x32_bf16 v[96:99], v[48:51], a[200:203], v[96:99]
    v_mul_f32 v168, v134, v150
    v_mul_f32 v169, v135, v151
    ds_read_b128 v[224:227], v11 offset:29696
    v_mfma_f32_16x16x32_bf16 v[100:103], v[40:43], v[228:231], v[100:103]
    buffer_load_dwordx4 v[36:39], v190, s[48:51], s23 offen offset:2048 sc1
    v_mfma_f32_16x16x32_bf16 v[100:103], v[44:47], v[232:235], v[100:103]
    v_fma_f32 v162, v162, v252, v252
    v_fma_f32 v163, v163, v252, v252
    v_mfma_f32_16x16x32_bf16 v[100:103], v[48:51], v[236:239], v[100:103]
    v_fma_f32 v164, v164, v252, v252
    v_fma_f32 v165, v165, v252, v252
    s_waitcnt vmcnt(12)
    v_mfma_f32_16x16x32_bf16 v[104:107], v[52:55], a[48:51], v[104:107]
    v_rcp_f32 v162, v162
    ds_read_b128 a[48:51], v10 offset:12288
    v_mfma_f32_16x16x32_bf16 v[104:107], v[56:59], a[52:55], v[104:107]
    buffer_load_dwordx4 v[40:43], v190, s[48:51], s23 offen offset:3072 sc1
    v_mfma_f32_16x16x32_bf16 v[104:107], v[60:63], a[56:59], v[104:107]
    v_rcp_f32 v163, v163
    v_mfma_f32_16x16x32_bf16 v[108:111], v[52:55], a[120:123], v[108:111]
    v_rcp_f32 v164, v164
    ds_read_b128 a[120:123], v10 offset:30720
    v_mfma_f32_16x16x32_bf16 v[108:111], v[56:59], a[124:127], v[108:111]
    v_rcp_f32 v165, v165
    v_mfma_f32_16x16x32_bf16 v[108:111], v[60:63], a[128:131], v[108:111]
    buffer_load_dwordx4 v[44:47], v191, s[48:51], s23 offen offset:0 sc1
    v_mfma_f32_16x16x32_bf16 v[112:115], v[52:55], a[192:195], v[112:115]
    v_mul_f32 v166, v166, v162
    v_mul_f32 v167, v167, v163
    ds_read_b128 a[192:195], v11 offset:12288
    v_mfma_f32_16x16x32_bf16 v[112:115], v[56:59], a[196:199], v[112:115]
    v_mul_f32 v168, v168, v164
    v_mul_f32 v169, v169, v165
    v_mfma_f32_16x16x32_bf16 v[112:115], v[60:63], a[200:203], v[112:115]
    v_cvt_pk_bf16_f32 v170, v166, v167
    v_cvt_pk_bf16_f32 v171, v168, v169
    v_mfma_f32_16x16x32_bf16 v[116:119], v[52:55], v[228:231], v[116:119]
    buffer_load_dwordx4 v[48:51], v191, s[48:51], s23 offen offset:1024 sc1
    v_mfma_f32_16x16x32_bf16 v[116:119], v[56:59], v[232:235], v[116:119]
    ds_write_b64 v12, v[170:171] offset:55296
    v_mfma_f32_16x16x32_bf16 v[116:119], v[60:63], v[236:239], v[116:119]
    ds_read_b128 v[228:231], v11 offset:30720
    s_waitcnt vmcnt(12)
    v_mfma_f32_16x16x32_bf16 v[88:91], v[64:67], a[60:63], v[88:91]
    ds_read_b128 a[52:55], v10 offset:13312
    v_mfma_f32_16x16x32_bf16 v[88:91], v[68:71], a[64:67], v[88:91]
    buffer_load_dwordx4 v[52:55], v191, s[48:51], s23 offen offset:2048 sc1
    v_mfma_f32_16x16x32_bf16 v[120:123], v[72:75], a[68:71], v[88:91]
    ds_read_b128 a[124:127], v10 offset:31744
    v_mfma_f32_16x16x32_bf16 v[92:95], v[64:67], a[132:135], v[92:95]
    ds_read_b128 a[196:199], v11 offset:13312
    v_mfma_f32_16x16x32_bf16 v[92:95], v[68:71], a[136:139], v[92:95]
    ds_read_b128 v[232:235], v11 offset:31744
    v_mfma_f32_16x16x32_bf16 v[124:127], v[72:75], a[140:143], v[92:95]
    buffer_load_dwordx4 v[56:59], v191, s[48:51], s23 offen offset:3072 sc1
    v_mfma_f32_16x16x32_bf16 v[96:99], v[64:67], a[204:207], v[96:99]
    v_mfma_f32_16x16x32_bf16 v[96:99], v[68:71], a[208:211], v[96:99]
    v_mfma_f32_16x16x32_bf16 v[128:131], v[72:75], a[212:215], v[96:99]
    v_mfma_f32_16x16x32_bf16 v[100:103], v[64:67], v[240:243], v[100:103]
    buffer_load_dwordx4 v[60:63], v192, s[48:51], s23 offen offset:0 sc1
    v_mfma_f32_16x16x32_bf16 v[100:103], v[68:71], v[244:247], v[100:103]
    v_mfma_f32_16x16x32_bf16 v[132:135], v[72:75], v[248:251], v[100:103]
    s_waitcnt vmcnt(12)
    v_mfma_f32_16x16x32_bf16 v[104:107], v[76:79], a[60:63], v[104:107]
    v_mfma_f32_16x16x32_bf16 v[104:107], v[80:83], a[64:67], v[104:107]
    buffer_load_dwordx4 v[64:67], v192, s[48:51], s23 offen offset:1024 sc1
    v_mfma_f32_16x16x32_bf16 v[136:139], v[84:87], a[68:71], v[104:107]
    v_mfma_f32_16x16x32_bf16 v[108:111], v[76:79], a[132:135], v[108:111]
    v_mfma_f32_16x16x32_bf16 v[108:111], v[80:83], a[136:139], v[108:111]
    v_mfma_f32_16x16x32_bf16 v[140:143], v[84:87], a[140:143], v[108:111]
    buffer_load_dwordx4 v[68:71], v192, s[48:51], s23 offen offset:2048 sc1
    v_mfma_f32_16x16x32_bf16 v[112:115], v[76:79], a[204:207], v[112:115]
    v_mfma_f32_16x16x32_bf16 v[112:115], v[80:83], a[208:211], v[112:115]
    s_lshl_b32 s7, s25, 11
    v_mfma_f32_16x16x32_bf16 v[144:147], v[84:87], a[212:215], v[112:115]
    s_add_u32 s7, s7, s28
    v_mfma_f32_16x16x32_bf16 v[116:119], v[76:79], v[240:243], v[116:119]
    buffer_load_dwordx4 v[72:75], v192, s[48:51], s23 offen offset:3072 sc1
    v_mfma_f32_16x16x32_bf16 v[116:119], v[80:83], v[244:247], v[116:119]
    s_add_u32 s23, s23, 36864
    v_mfma_f32_16x16x32_bf16 v[148:151], v[84:87], v[248:251], v[116:119]
    v_add_u32 v12, s7, v184
    s_add_u32 s25, s25, 1
    s_waitcnt lgkmcnt(0)
    s_barrier
    v_pk_mul_f32 v[152:153], v[120:121], v[120:121]
    ds_read_b128 a[56:59], v10 offset:14336
    v_pk_mul_f32 v[154:155], v[122:123], v[122:123]
    ds_read_b128 a[128:131], v10 offset:32768
    v_pk_fma_f32 v[152:153], v[152:153], v[8:9], v[4:5] op_sel:[0,0,0] op_sel_hi:[1,0,0]
    ds_read_b128 a[200:203], v11 offset:14336
    v_pk_fma_f32 v[154:155], v[154:155], v[8:9], v[4:5] op_sel:[0,0,0] op_sel_hi:[1,0,0]
    v_pk_mul_f32 v[152:153], v[120:121], v[152:153]
    ds_read_b128 v[236:239], v11 offset:32768
    v_pk_mul_f32 v[154:155], v[122:123], v[154:155]
    ds_read_b128 a[60:63], v10 offset:15360
    buffer_load_dwordx4 v[76:79], v184, s[48:51], s23 offen offset:0 sc1
    v_exp_f32 v152, v152
    ds_read_b128 a[132:135], v10 offset:33792
    v_exp_f32 v153, v153
    v_exp_f32 v154, v154
    ds_read_b128 a[204:207], v11 offset:15360
    v_exp_f32 v155, v155
    ds_read_b128 v[240:243], v11 offset:33792
    v_pk_mul_f32 v[156:157], v[120:121], v[136:137]
    v_pk_mul_f32 v[158:159], v[122:123], v[138:139]
    buffer_load_dwordx4 v[80:83], v184, s[48:51], s23 offen offset:1024 sc1
    v_pk_fma_f32 v[152:153], v[152:153], v[192:193], v[192:193] op_sel:[0,1,1] op_sel_hi:[1,1,1]
    v_pk_fma_f32 v[154:155], v[154:155], v[192:193], v[192:193] op_sel:[0,1,1] op_sel_hi:[1,1,1]
    v_rcp_f32 v152, v152
    v_rcp_f32 v153, v153
    v_rcp_f32 v154, v154
    v_rcp_f32 v155, v155
    buffer_load_dwordx4 v[84:87], v184, s[48:51], s23 offen offset:2048 sc1
    s_nop 0
    v_pk_mul_f32 v[156:157], v[156:157], v[152:153]
    v_pk_mul_f32 v[158:159], v[158:159], v[154:155]
    v_cvt_pk_bf16_f32 v160, v156, v157
    v_cvt_pk_bf16_f32 v161, v158, v159
    ds_write_b64 v12, v[160:161] offset:0
    buffer_load_dwordx4 v[104:107], v184, s[48:51], s23 offen offset:3072 sc1
    v_pk_mul_f32 v[162:163], v[124:125], v[124:125]
    v_pk_mul_f32 v[164:165], v[126:127], v[126:127]
    v_pk_fma_f32 v[162:163], v[162:163], v[8:9], v[4:5] op_sel:[0,1,1] op_sel_hi:[1,1,1]
    v_pk_fma_f32 v[164:165], v[164:165], v[8:9], v[4:5] op_sel:[0,1,1] op_sel_hi:[1,1,1]
    v_pk_mul_f32 v[162:163], v[124:125], v[162:163]
    v_pk_mul_f32 v[164:165], v[126:127], v[164:165]
    buffer_load_dwordx4 v[108:111], v185, s[48:51], s23 offen offset:0 sc1
    v_exp_f32 v162, v162
    v_exp_f32 v163, v163
    v_exp_f32 v164, v164
    v_exp_f32 v165, v165
    v_pk_mul_f32 v[166:167], v[124:125], v[140:141]
    v_pk_mul_f32 v[168:169], v[126:127], v[142:143]
    buffer_load_dwordx4 v[112:115], v185, s[48:51], s23 offen offset:1024 sc1
    v_pk_fma_f32 v[162:163], v[162:163], v[194:195], v[194:195] op_sel:[0,0,0] op_sel_hi:[1,0,0]
    v_pk_fma_f32 v[164:165], v[164:165], v[194:195], v[194:195] op_sel:[0,0,0] op_sel_hi:[1,0,0]
    v_rcp_f32 v162, v162
    v_rcp_f32 v163, v163
    v_rcp_f32 v164, v164
    v_rcp_f32 v165, v165
    buffer_load_dwordx4 v[116:119], v185, s[48:51], s23 offen offset:2048 sc1
    s_nop 0
    v_pk_mul_f32 v[166:167], v[166:167], v[162:163]
    v_pk_mul_f32 v[168:169], v[168:169], v[164:165]
    v_cvt_pk_bf16_f32 v170, v166, v167
    v_cvt_pk_bf16_f32 v171, v168, v169
    ds_write_b64 v12, v[170:171] offset:18432
    buffer_load_dwordx4 v[180:183], v185, s[48:51], s23 offen offset:3072 sc1
    v_pk_mul_f32 v[152:153], v[128:129], v[128:129]
    v_pk_mul_f32 v[154:155], v[130:131], v[130:131]
    v_pk_fma_f32 v[152:153], v[152:153], v[12:13], v[6:7] op_sel:[0,1,0] op_sel_hi:[1,1,0]
    v_pk_fma_f32 v[154:155], v[154:155], v[12:13], v[6:7] op_sel:[0,1,0] op_sel_hi:[1,1,0]
    v_pk_mul_f32 v[152:153], v[128:129], v[152:153]
    v_pk_mul_f32 v[154:155], v[130:131], v[154:155]
    buffer_load_dwordx4 v[196:199], v186, s[48:51], s23 offen offset:0 sc1
    v_exp_f32 v152, v152
    v_exp_f32 v153, v153
    v_exp_f32 v154, v154
    v_exp_f32 v155, v155
    v_pk_mul_f32 v[156:157], v[128:129], v[144:145]
    v_pk_mul_f32 v[158:159], v[130:131], v[146:147]
    buffer_load_dwordx4 v[200:203], v186, s[48:51], s23 offen offset:1024 sc1
    v_pk_fma_f32 v[152:153], v[152:153], v[194:195], v[194:195] op_sel:[0,1,1] op_sel_hi:[1,1,1]
    v_pk_fma_f32 v[154:155], v[154:155], v[194:195], v[194:195] op_sel:[0,1,1] op_sel_hi:[1,1,1]
    v_rcp_f32 v152, v152
    v_rcp_f32 v153, v153
    v_rcp_f32 v154, v154
    v_rcp_f32 v155, v155
    buffer_load_dwordx4 v[204:207], v186, s[48:51], s23 offen offset:2048 sc1
    s_nop 0
    v_pk_mul_f32 v[156:157], v[156:157], v[152:153]
    v_pk_mul_f32 v[158:159], v[158:159], v[154:155]
    v_cvt_pk_bf16_f32 v160, v156, v157
    v_cvt_pk_bf16_f32 v161, v158, v159
    ds_write_b64 v12, v[160:161] offset:36864
    buffer_load_dwordx4 v[208:211], v186, s[48:51], s23 offen offset:3072 sc1
    v_pk_mul_f32 v[162:163], v[132:133], v[132:133]
    v_pk_mul_f32 v[164:165], v[134:135], v[134:135]
    v_pk_fma_f32 v[162:163], v[162:163], v[14:15], v[6:7] op_sel:[0,0,1] op_sel_hi:[1,0,1]
    v_pk_fma_f32 v[164:165], v[164:165], v[14:15], v[6:7] op_sel:[0,0,1] op_sel_hi:[1,0,1]
    v_pk_mul_f32 v[162:163], v[132:133], v[162:163]
    v_pk_mul_f32 v[164:165], v[134:135], v[164:165]
    buffer_load_dwordx4 v[212:215], v187, s[48:51], s23 offen offset:0 sc1
    v_exp_f32 v162, v162
    v_exp_f32 v163, v163
    v_exp_f32 v164, v164
    v_exp_f32 v165, v165
    v_pk_mul_f32 v[166:167], v[132:133], v[148:149]
    v_pk_mul_f32 v[168:169], v[134:135], v[150:151]
    buffer_load_dwordx4 v[216:219], v187, s[48:51], s23 offen offset:1024 sc1
    v_pk_fma_f32 v[162:163], v[162:163], v[252:253], v[252:253] op_sel:[0,0,0] op_sel_hi:[1,0,0]
    v_pk_fma_f32 v[164:165], v[164:165], v[252:253], v[252:253] op_sel:[0,0,0] op_sel_hi:[1,0,0]
    v_rcp_f32 v162, v162
    v_rcp_f32 v163, v163
    v_rcp_f32 v164, v164
    v_rcp_f32 v165, v165
    s_nop 0
    v_pk_mul_f32 v[166:167], v[166:167], v[162:163]
    v_pk_mul_f32 v[168:169], v[168:169], v[164:165]
    v_cvt_pk_bf16_f32 v170, v166, v167
    v_cvt_pk_bf16_f32 v171, v168, v169
    ds_write_b64 v12, v[170:171] offset:55296
    buffer_load_dwordx4 v[136:139], v187, s[48:51], s23 offen offset:2048 sc1
    buffer_load_dwordx4 v[140:143], v187, s[48:51], s23 offen offset:3072 sc1
    buffer_load_dwordx4 v[144:147], v188, s[48:51], s23 offen offset:0 sc1
    buffer_load_dwordx4 v[148:151], v188, s[48:51], s23 offen offset:1024 sc1
    s_add_u32 s23, s23, 18432
    s_waitcnt lgkmcnt(0)
    s_barrier
    ds_read_b128 a[64:67], v10 offset:16384
    ds_read_b128 a[136:139], v10 offset:34816
    ds_read_b128 a[208:211], v11 offset:16384
    ds_read_b128 v[244:247], v11 offset:34816
    ds_read_b128 a[68:71], v10 offset:17408
    ds_read_b128 a[140:143], v10 offset:35840
    ds_read_b128 a[212:215], v11 offset:17408
    ds_read_b128 v[248:251], v11 offset:35840
    s_mov_b32 s25, 0
    s_waitcnt lgkmcnt(0)
    s_branch L_ffn_dn_mid_36
L_ffn_dn_35:
    s_waitcnt vmcnt(32)
    v_mfma_f32_16x16x32_bf16 v[88:91], v[104:107], a[0:3], 0
    v_mfma_f32_16x16x32_bf16 v[88:91], v[108:111], a[4:7], v[88:91]
    buffer_load_dwordx4 v[76:79], v184, s[48:51], s23 offen offset:0 sc1
    v_mfma_f32_16x16x32_bf16 v[88:91], v[112:115], a[8:11], v[88:91]
    v_mfma_f32_16x16x32_bf16 v[92:95], v[104:107], a[72:75], 0
    v_mfma_f32_16x16x32_bf16 v[92:95], v[108:111], a[76:79], v[92:95]
    v_mfma_f32_16x16x32_bf16 v[92:95], v[112:115], a[80:83], v[92:95]
    buffer_load_dwordx4 v[80:83], v184, s[48:51], s23 offen offset:1024 sc1
    v_mfma_f32_16x16x32_bf16 v[96:99], v[104:107], a[144:147], 0
    v_cvt_pk_bf16_f32 v152, v120, v121
    v_cvt_pk_bf16_f32 v153, v122, v123
    v_mfma_f32_16x16x32_bf16 v[96:99], v[108:111], a[148:151], v[96:99]
    v_cvt_pk_bf16_f32 v154, v124, v125
    v_cvt_pk_bf16_f32 v155, v126, v127
    v_mfma_f32_16x16x32_bf16 v[96:99], v[112:115], a[152:155], v[96:99]
    v_cvt_pk_bf16_f32 v156, v128, v129
    v_cvt_pk_bf16_f32 v157, v130, v131
    v_mfma_f32_16x16x32_bf16 v[100:103], v[104:107], a[216:219], 0
    buffer_load_dwordx4 v[84:87], v184, s[48:51], s23 offen offset:2048 sc1
    v_mfma_f32_16x16x32_bf16 v[100:103], v[108:111], a[220:223], v[100:103]
    v_cvt_pk_bf16_f32 v158, v132, v133
    v_cvt_pk_bf16_f32 v159, v134, v135
    v_mfma_f32_16x16x32_bf16 v[100:103], v[112:115], a[224:227], v[100:103]
    v_permlane16_swap_b32 v152, v154
    s_waitcnt vmcnt(32)
    v_mfma_f32_16x16x32_bf16 v[88:91], v[116:119], a[12:15], v[88:91]
    v_permlane16_swap_b32 v153, v155
    v_mfma_f32_16x16x32_bf16 v[88:91], v[180:183], a[16:19], v[88:91]
    buffer_load_dwordx4 v[104:107], v184, s[48:51], s23 offen offset:3072 sc1
    v_mfma_f32_16x16x32_bf16 v[88:91], v[196:199], a[20:23], v[88:91]
    v_permlane16_swap_b32 v156, v158
    v_mfma_f32_16x16x32_bf16 v[92:95], v[116:119], a[84:87], v[92:95]
    v_permlane16_swap_b32 v157, v159
    v_mfma_f32_16x16x32_bf16 v[92:95], v[180:183], a[88:91], v[92:95]
    buffer_store_dwordx4 v[152:155], v178, s[72:75], s27 offen sc1
    v_mfma_f32_16x16x32_bf16 v[92:95], v[196:199], a[92:95], v[92:95]
    buffer_load_dwordx4 v[108:111], v185, s[48:51], s23 offen offset:0 sc1
    v_mfma_f32_16x16x32_bf16 v[96:99], v[116:119], a[156:159], v[96:99]
    buffer_store_dwordx4 v[156:159], v179, s[72:75], s27 offen sc1
    v_mfma_f32_16x16x32_bf16 v[96:99], v[180:183], a[160:163], v[96:99]
    v_mfma_f32_16x16x32_bf16 v[96:99], v[196:199], a[164:167], v[96:99]
    v_mfma_f32_16x16x32_bf16 v[100:103], v[116:119], a[228:231], v[100:103]
    buffer_load_dwordx4 v[112:115], v185, s[48:51], s23 offen offset:1024 sc1
    v_mfma_f32_16x16x32_bf16 v[100:103], v[180:183], a[232:235], v[100:103]
    v_mfma_f32_16x16x32_bf16 v[100:103], v[196:199], a[236:239], v[100:103]
    s_waitcnt vmcnt(34)
    v_mfma_f32_16x16x32_bf16 v[88:91], v[200:203], a[24:27], v[88:91]
    v_mfma_f32_16x16x32_bf16 v[88:91], v[204:207], a[28:31], v[88:91]
    buffer_load_dwordx4 v[116:119], v185, s[48:51], s23 offen offset:2048 sc1
    v_mfma_f32_16x16x32_bf16 v[88:91], v[208:211], a[32:35], v[88:91]
    v_mfma_f32_16x16x32_bf16 v[92:95], v[200:203], a[96:99], v[92:95]
    v_mfma_f32_16x16x32_bf16 v[92:95], v[204:207], a[100:103], v[92:95]
    v_mfma_f32_16x16x32_bf16 v[92:95], v[208:211], a[104:107], v[92:95]
    buffer_load_dwordx4 v[180:183], v185, s[48:51], s23 offen offset:3072 sc1
    v_mfma_f32_16x16x32_bf16 v[96:99], v[200:203], a[168:171], v[96:99]
    v_mfma_f32_16x16x32_bf16 v[96:99], v[204:207], a[172:175], v[96:99]
    v_mfma_f32_16x16x32_bf16 v[96:99], v[208:211], a[176:179], v[96:99]
    v_mfma_f32_16x16x32_bf16 v[100:103], v[200:203], a[240:243], v[100:103]
    buffer_load_dwordx4 v[196:199], v186, s[48:51], s23 offen offset:0 sc1
    v_mfma_f32_16x16x32_bf16 v[100:103], v[204:207], a[244:247], v[100:103]
    v_mfma_f32_16x16x32_bf16 v[100:103], v[208:211], a[248:251], v[100:103]
    s_waitcnt vmcnt(34)
    v_mfma_f32_16x16x32_bf16 v[88:91], v[212:215], a[36:39], v[88:91]
    v_mfma_f32_16x16x32_bf16 v[88:91], v[216:219], a[40:43], v[88:91]
    buffer_load_dwordx4 v[200:203], v186, s[48:51], s23 offen offset:1024 sc1
    v_mfma_f32_16x16x32_bf16 v[88:91], v[136:139], a[44:47], v[88:91]
    v_mfma_f32_16x16x32_bf16 v[92:95], v[212:215], a[108:111], v[92:95]
    v_mfma_f32_16x16x32_bf16 v[92:95], v[216:219], a[112:115], v[92:95]
    v_mfma_f32_16x16x32_bf16 v[92:95], v[136:139], a[116:119], v[92:95]
    buffer_load_dwordx4 v[204:207], v186, s[48:51], s23 offen offset:2048 sc1
    v_mfma_f32_16x16x32_bf16 v[96:99], v[212:215], a[180:183], v[96:99]
    v_mfma_f32_16x16x32_bf16 v[96:99], v[216:219], a[184:187], v[96:99]
    v_mfma_f32_16x16x32_bf16 v[96:99], v[136:139], a[188:191], v[96:99]
    v_mfma_f32_16x16x32_bf16 v[100:103], v[212:215], a[252:255], v[100:103]
    buffer_load_dwordx4 v[208:211], v186, s[48:51], s23 offen offset:3072 sc1
    v_mfma_f32_16x16x32_bf16 v[100:103], v[216:219], v[220:223], v[100:103]
    v_mfma_f32_16x16x32_bf16 v[100:103], v[136:139], v[224:227], v[100:103]
    s_waitcnt vmcnt(34)
    v_mfma_f32_16x16x32_bf16 v[88:91], v[140:143], a[48:51], v[88:91]
    v_mfma_f32_16x16x32_bf16 v[88:91], v[144:147], a[52:55], v[88:91]
    buffer_load_dwordx4 v[212:215], v187, s[48:51], s23 offen offset:0 sc1
    v_mfma_f32_16x16x32_bf16 v[88:91], v[148:151], a[56:59], v[88:91]
    v_mfma_f32_16x16x32_bf16 v[92:95], v[140:143], a[120:123], v[92:95]
    v_mfma_f32_16x16x32_bf16 v[92:95], v[144:147], a[124:127], v[92:95]
    v_mfma_f32_16x16x32_bf16 v[92:95], v[148:151], a[128:131], v[92:95]
    buffer_load_dwordx4 v[216:219], v187, s[48:51], s23 offen offset:1024 sc1
    v_mfma_f32_16x16x32_bf16 v[96:99], v[140:143], a[192:195], v[96:99]
    v_mfma_f32_16x16x32_bf16 v[96:99], v[144:147], a[196:199], v[96:99]
    v_mfma_f32_16x16x32_bf16 v[96:99], v[148:151], a[200:203], v[96:99]
    v_mfma_f32_16x16x32_bf16 v[100:103], v[140:143], v[228:231], v[100:103]
    buffer_load_dwordx4 v[136:139], v187, s[48:51], s23 offen offset:2048 sc1
    v_mfma_f32_16x16x32_bf16 v[100:103], v[144:147], v[232:235], v[100:103]
    v_mfma_f32_16x16x32_bf16 v[100:103], v[148:151], v[236:239], v[100:103]
    s_waitcnt vmcnt(34)
    v_mfma_f32_16x16x32_bf16 v[88:91], v[160:163], a[60:63], v[88:91]
    v_mfma_f32_16x16x32_bf16 v[88:91], v[164:167], a[64:67], v[88:91]
    buffer_load_dwordx4 v[140:143], v187, s[48:51], s23 offen offset:3072 sc1
    v_mfma_f32_16x16x32_bf16 v[120:123], v[168:171], a[68:71], v[88:91]
    v_mfma_f32_16x16x32_bf16 v[92:95], v[160:163], a[132:135], v[92:95]
    v_mfma_f32_16x16x32_bf16 v[92:95], v[164:167], a[136:139], v[92:95]
    v_mfma_f32_16x16x32_bf16 v[124:127], v[168:171], a[140:143], v[92:95]
    buffer_load_dwordx4 v[144:147], v188, s[48:51], s23 offen offset:0 sc1
    v_mfma_f32_16x16x32_bf16 v[96:99], v[160:163], a[204:207], v[96:99]
    s_mov_b32 s74, 268435456
    v_mfma_f32_16x16x32_bf16 v[96:99], v[164:167], a[208:211], v[96:99]
    s_add_u32 s27, s27, 1024
    v_mfma_f32_16x16x32_bf16 v[128:131], v[168:171], a[212:215], v[96:99]
    s_add_u32 s25, s25, 1
    v_mfma_f32_16x16x32_bf16 v[100:103], v[160:163], v[240:243], v[100:103]
    buffer_load_dwordx4 v[148:151], v188, s[48:51], s23 offen offset:1024 sc1
    v_mfma_f32_16x16x32_bf16 v[100:103], v[164:167], v[244:247], v[100:103]
    s_add_u32 s23, s23, 18432
    v_mfma_f32_16x16x32_bf16 v[132:135], v[168:171], v[248:251], v[100:103]
L_ffn_dn_mid_36:
    s_waitcnt vmcnt(30)
    v_mfma_f32_16x16x32_bf16 v[88:91], v[16:19], a[0:3], 0
    v_mfma_f32_16x16x32_bf16 v[88:91], v[20:23], a[4:7], v[88:91]
    buffer_load_dwordx4 v[160:163], v184, s[48:51], s23 offen offset:0 sc1
    v_mfma_f32_16x16x32_bf16 v[88:91], v[24:27], a[8:11], v[88:91]
    v_mfma_f32_16x16x32_bf16 v[92:95], v[16:19], a[72:75], 0
    v_mfma_f32_16x16x32_bf16 v[92:95], v[20:23], a[76:79], v[92:95]
    v_mfma_f32_16x16x32_bf16 v[92:95], v[24:27], a[80:83], v[92:95]
    buffer_load_dwordx4 v[164:167], v184, s[48:51], s23 offen offset:1024 sc1
    v_mfma_f32_16x16x32_bf16 v[96:99], v[16:19], a[144:147], 0
    v_cvt_pk_bf16_f32 v152, v120, v121
    v_cvt_pk_bf16_f32 v153, v122, v123
    v_mfma_f32_16x16x32_bf16 v[96:99], v[20:23], a[148:151], v[96:99]
    v_cvt_pk_bf16_f32 v154, v124, v125
    v_cvt_pk_bf16_f32 v155, v126, v127
    v_mfma_f32_16x16x32_bf16 v[96:99], v[24:27], a[152:155], v[96:99]
    v_cvt_pk_bf16_f32 v156, v128, v129
    v_cvt_pk_bf16_f32 v157, v130, v131
    v_mfma_f32_16x16x32_bf16 v[100:103], v[16:19], a[216:219], 0
    buffer_load_dwordx4 v[168:171], v184, s[48:51], s23 offen offset:2048 sc1
    v_mfma_f32_16x16x32_bf16 v[100:103], v[20:23], a[220:223], v[100:103]
    v_cvt_pk_bf16_f32 v158, v132, v133
    v_cvt_pk_bf16_f32 v159, v134, v135
    v_mfma_f32_16x16x32_bf16 v[100:103], v[24:27], a[224:227], v[100:103]
    v_permlane16_swap_b32 v152, v154
    s_waitcnt vmcnt(30)
    v_mfma_f32_16x16x32_bf16 v[88:91], v[28:31], a[12:15], v[88:91]
    v_permlane16_swap_b32 v153, v155
    v_mfma_f32_16x16x32_bf16 v[88:91], v[32:35], a[16:19], v[88:91]
    buffer_load_dwordx4 v[16:19], v184, s[48:51], s23 offen offset:3072 sc1
    v_mfma_f32_16x16x32_bf16 v[88:91], v[36:39], a[20:23], v[88:91]
    v_permlane16_swap_b32 v156, v158
    v_mfma_f32_16x16x32_bf16 v[92:95], v[28:31], a[84:87], v[92:95]
    v_permlane16_swap_b32 v157, v159
    v_mfma_f32_16x16x32_bf16 v[92:95], v[32:35], a[88:91], v[92:95]
    buffer_store_dwordx4 v[152:155], v178, s[72:75], s27 offen sc1
    v_mfma_f32_16x16x32_bf16 v[92:95], v[36:39], a[92:95], v[92:95]
    buffer_load_dwordx4 v[20:23], v185, s[48:51], s23 offen offset:0 sc1
    v_mfma_f32_16x16x32_bf16 v[96:99], v[28:31], a[156:159], v[96:99]
    buffer_store_dwordx4 v[156:159], v179, s[72:75], s27 offen sc1
    v_mfma_f32_16x16x32_bf16 v[96:99], v[32:35], a[160:163], v[96:99]
    v_mfma_f32_16x16x32_bf16 v[96:99], v[36:39], a[164:167], v[96:99]
    v_mfma_f32_16x16x32_bf16 v[100:103], v[28:31], a[228:231], v[100:103]
    buffer_load_dwordx4 v[24:27], v185, s[48:51], s23 offen offset:1024 sc1
    v_mfma_f32_16x16x32_bf16 v[100:103], v[32:35], a[232:235], v[100:103]
    v_mfma_f32_16x16x32_bf16 v[100:103], v[36:39], a[236:239], v[100:103]
    s_waitcnt vmcnt(32)
    v_mfma_f32_16x16x32_bf16 v[88:91], v[40:43], a[24:27], v[88:91]
    v_mfma_f32_16x16x32_bf16 v[88:91], v[44:47], a[28:31], v[88:91]
    buffer_load_dwordx4 v[28:31], v185, s[48:51], s23 offen offset:2048 sc1
    v_mfma_f32_16x16x32_bf16 v[88:91], v[48:51], a[32:35], v[88:91]
    v_mfma_f32_16x16x32_bf16 v[92:95], v[40:43], a[96:99], v[92:95]
    v_mfma_f32_16x16x32_bf16 v[92:95], v[44:47], a[100:103], v[92:95]
    v_mfma_f32_16x16x32_bf16 v[92:95], v[48:51], a[104:107], v[92:95]
    buffer_load_dwordx4 v[32:35], v185, s[48:51], s23 offen offset:3072 sc1
    v_mfma_f32_16x16x32_bf16 v[96:99], v[40:43], a[168:171], v[96:99]
    v_mfma_f32_16x16x32_bf16 v[96:99], v[44:47], a[172:175], v[96:99]
    v_mfma_f32_16x16x32_bf16 v[96:99], v[48:51], a[176:179], v[96:99]
    v_mfma_f32_16x16x32_bf16 v[100:103], v[40:43], a[240:243], v[100:103]
    buffer_load_dwordx4 v[36:39], v186, s[48:51], s23 offen offset:0 sc1
    v_mfma_f32_16x16x32_bf16 v[100:103], v[44:47], a[244:247], v[100:103]
    v_mfma_f32_16x16x32_bf16 v[100:103], v[48:51], a[248:251], v[100:103]
    s_waitcnt vmcnt(32)
    s_cmp_lg_u32 s25, 6
    s_cbranch_scc1 L_early_37
    s_waitcnt vmcnt(24)
    s_barrier
    s_cmp_lg_u32 s3, 0
    s_cbranch_scc1 L_early_37
    v_lshlrev_b32 v15, 7, v0
    v_mov_b32 v1, s76
    s_mov_b64 exec, 0xff
    buffer_store_dword v1, v15, s[8:11], s29 offen sc1
    s_mov_b64 exec, -1
L_early_37:
    v_mfma_f32_16x16x32_bf16 v[88:91], v[52:55], a[36:39], v[88:91]
    v_mfma_f32_16x16x32_bf16 v[88:91], v[56:59], a[40:43], v[88:91]
    buffer_load_dwordx4 v[40:43], v186, s[48:51], s23 offen offset:1024 sc1
    v_mfma_f32_16x16x32_bf16 v[88:91], v[60:63], a[44:47], v[88:91]
    v_mfma_f32_16x16x32_bf16 v[92:95], v[52:55], a[108:111], v[92:95]
    v_mfma_f32_16x16x32_bf16 v[92:95], v[56:59], a[112:115], v[92:95]
    v_mfma_f32_16x16x32_bf16 v[92:95], v[60:63], a[116:119], v[92:95]
    buffer_load_dwordx4 v[44:47], v186, s[48:51], s23 offen offset:2048 sc1
    v_mfma_f32_16x16x32_bf16 v[96:99], v[52:55], a[180:183], v[96:99]
    v_mfma_f32_16x16x32_bf16 v[96:99], v[56:59], a[184:187], v[96:99]
    v_mfma_f32_16x16x32_bf16 v[96:99], v[60:63], a[188:191], v[96:99]
    v_mfma_f32_16x16x32_bf16 v[100:103], v[52:55], a[252:255], v[100:103]
    buffer_load_dwordx4 v[48:51], v186, s[48:51], s23 offen offset:3072 sc1
    v_mfma_f32_16x16x32_bf16 v[100:103], v[56:59], v[220:223], v[100:103]
    v_mfma_f32_16x16x32_bf16 v[100:103], v[60:63], v[224:227], v[100:103]
    s_waitcnt vmcnt(32)
    v_mfma_f32_16x16x32_bf16 v[88:91], v[64:67], a[48:51], v[88:91]
    v_mfma_f32_16x16x32_bf16 v[88:91], v[68:71], a[52:55], v[88:91]
    buffer_load_dwordx4 v[52:55], v187, s[48:51], s23 offen offset:0 sc1
    v_mfma_f32_16x16x32_bf16 v[88:91], v[72:75], a[56:59], v[88:91]
    v_mfma_f32_16x16x32_bf16 v[92:95], v[64:67], a[120:123], v[92:95]
    v_mfma_f32_16x16x32_bf16 v[92:95], v[68:71], a[124:127], v[92:95]
    v_mfma_f32_16x16x32_bf16 v[92:95], v[72:75], a[128:131], v[92:95]
    buffer_load_dwordx4 v[56:59], v187, s[48:51], s23 offen offset:1024 sc1
    v_mfma_f32_16x16x32_bf16 v[96:99], v[64:67], a[192:195], v[96:99]
    v_mfma_f32_16x16x32_bf16 v[96:99], v[68:71], a[196:199], v[96:99]
    v_mfma_f32_16x16x32_bf16 v[96:99], v[72:75], a[200:203], v[96:99]
    v_mfma_f32_16x16x32_bf16 v[100:103], v[64:67], v[228:231], v[100:103]
    buffer_load_dwordx4 v[60:63], v187, s[48:51], s23 offen offset:2048 sc1
    v_mfma_f32_16x16x32_bf16 v[100:103], v[68:71], v[232:235], v[100:103]
    v_mfma_f32_16x16x32_bf16 v[100:103], v[72:75], v[236:239], v[100:103]
    s_waitcnt vmcnt(32)
    v_mfma_f32_16x16x32_bf16 v[88:91], v[76:79], a[60:63], v[88:91]
    v_mfma_f32_16x16x32_bf16 v[88:91], v[80:83], a[64:67], v[88:91]
    buffer_load_dwordx4 v[64:67], v187, s[48:51], s23 offen offset:3072 sc1
    v_mfma_f32_16x16x32_bf16 v[120:123], v[84:87], a[68:71], v[88:91]
    v_mfma_f32_16x16x32_bf16 v[92:95], v[76:79], a[132:135], v[92:95]
    v_mfma_f32_16x16x32_bf16 v[92:95], v[80:83], a[136:139], v[92:95]
    v_mfma_f32_16x16x32_bf16 v[124:127], v[84:87], a[140:143], v[92:95]
    buffer_load_dwordx4 v[68:71], v188, s[48:51], s23 offen offset:0 sc1
    v_mfma_f32_16x16x32_bf16 v[96:99], v[76:79], a[204:207], v[96:99]
    s_mov_b32 s74, 268435456
    v_mfma_f32_16x16x32_bf16 v[96:99], v[80:83], a[208:211], v[96:99]
    s_add_u32 s27, s27, 1024
    v_mfma_f32_16x16x32_bf16 v[128:131], v[84:87], a[212:215], v[96:99]
    s_add_u32 s25, s25, 1
    v_mfma_f32_16x16x32_bf16 v[100:103], v[76:79], v[240:243], v[100:103]
    buffer_load_dwordx4 v[72:75], v188, s[48:51], s23 offen offset:1024 sc1
    v_mfma_f32_16x16x32_bf16 v[100:103], v[80:83], v[244:247], v[100:103]
    s_add_u32 s23, s23, 18432
    v_mfma_f32_16x16x32_bf16 v[132:135], v[84:87], v[248:251], v[100:103]
    s_cmp_lt_u32 s25, 7
    s_cbranch_scc1 L_ffn_dn_35
    s_waitcnt vmcnt(32)
    v_mfma_f32_16x16x32_bf16 v[88:91], v[104:107], a[0:3], 0
    v_mfma_f32_16x16x32_bf16 v[88:91], v[108:111], a[4:7], v[88:91]
    buffer_load_dwordx4 v[76:79], v184, s[48:51], s23 offen offset:0 sc1
    v_mfma_f32_16x16x32_bf16 v[88:91], v[112:115], a[8:11], v[88:91]
    v_mfma_f32_16x16x32_bf16 v[92:95], v[104:107], a[72:75], 0
    v_mfma_f32_16x16x32_bf16 v[92:95], v[108:111], a[76:79], v[92:95]
    v_mfma_f32_16x16x32_bf16 v[92:95], v[112:115], a[80:83], v[92:95]
    buffer_load_dwordx4 v[80:83], v184, s[48:51], s23 offen offset:1024 sc1
    v_mfma_f32_16x16x32_bf16 v[96:99], v[104:107], a[144:147], 0
    v_cvt_pk_bf16_f32 v152, v120, v121
    v_cvt_pk_bf16_f32 v153, v122, v123
    v_mfma_f32_16x16x32_bf16 v[96:99], v[108:111], a[148:151], v[96:99]
    v_cvt_pk_bf16_f32 v154, v124, v125
    v_cvt_pk_bf16_f32 v155, v126, v127
    v_mfma_f32_16x16x32_bf16 v[96:99], v[112:115], a[152:155], v[96:99]
    v_cvt_pk_bf16_f32 v156, v128, v129
    v_cvt_pk_bf16_f32 v157, v130, v131
    v_mfma_f32_16x16x32_bf16 v[100:103], v[104:107], a[216:219], 0
    buffer_load_dwordx4 v[84:87], v184, s[48:51], s23 offen offset:2048 sc1
    v_mfma_f32_16x16x32_bf16 v[100:103], v[108:111], a[220:223], v[100:103]
    v_cvt_pk_bf16_f32 v158, v132, v133
    v_cvt_pk_bf16_f32 v159, v134, v135
    v_mfma_f32_16x16x32_bf16 v[100:103], v[112:115], a[224:227], v[100:103]
    v_permlane16_swap_b32 v152, v154
    s_waitcnt vmcnt(32)
    v_mfma_f32_16x16x32_bf16 v[88:91], v[116:119], a[12:15], v[88:91]
    v_permlane16_swap_b32 v153, v155
    v_mfma_f32_16x16x32_bf16 v[88:91], v[180:183], a[16:19], v[88:91]
    v_permlane16_swap_b32 v156, v158
    v_mfma_f32_16x16x32_bf16 v[88:91], v[196:199], a[20:23], v[88:91]
    v_permlane16_swap_b32 v157, v159
    s_load_dwordx8 s[56:63], s[38:39], 0 glc
    v_mfma_f32_16x16x32_bf16 v[92:95], v[116:119], a[84:87], v[92:95]
    buffer_store_dwordx4 v[152:155], v178, s[72:75], s27 offen sc1
    s_mov_b32 s6, 0
    v_mfma_f32_16x16x32_bf16 v[92:95], v[180:183], a[88:91], v[92:95]
    buffer_store_dwordx4 v[156:159], v179, s[72:75], s27 offen sc1
    v_mfma_f32_16x16x32_bf16 v[92:95], v[196:199], a[92:95], v[92:95]
    v_mfma_f32_16x16x32_bf16 v[96:99], v[116:119], a[156:159], v[96:99]
    v_mfma_f32_16x16x32_bf16 v[96:99], v[180:183], a[160:163], v[96:99]
    v_mfma_f32_16x16x32_bf16 v[96:99], v[196:199], a[164:167], v[96:99]
    v_mfma_f32_16x16x32_bf16 v[100:103], v[116:119], a[228:231], v[100:103]
    v_mfma_f32_16x16x32_bf16 v[100:103], v[180:183], a[232:235], v[100:103]
    v_mfma_f32_16x16x32_bf16 v[100:103], v[196:199], a[236:239], v[100:103]
    s_waitcnt vmcnt(31)
L_epoll_38:
    s_waitcnt lgkmcnt(0)
    s_xor_b64 s[56:57], s[56:57], s[76:77]
    s_xor_b64 s[58:59], s[58:59], s[76:77]
    s_xor_b64 s[60:61], s[60:61], s[76:77]
    s_xor_b64 s[62:63], s[62:63], s[76:77]
    s_or_b64 s[56:57], s[56:57], s[58:59]
    s_or_b64 s[60:61], s[60:61], s[62:63]
    s_or_b64 s[56:57], s[56:57], s[60:61]
    s_cbranch_scc0 L_epolled_39
    s_load_dwordx8 s[56:63], s[38:39], 0 glc
    s_add_u32 s6, s6, 1
    s_cmp_lt_u32 s6, 1048576
    s_cbranch_scc1 L_epoll_38
    s_branch L_main_end
L_epolled_39:
    v_mfma_f32_16x16x32_bf16 v[88:91], v[200:203], a[24:27], v[88:91]
    v_mfma_f32_16x16x32_bf16 v[88:91], v[204:207], a[28:31], v[88:91]
    buffer_load_dwordx4 v[104:107], v172, s[8:11], s19 offen sc1
    v_mfma_f32_16x16x32_bf16 v[88:91], v[208:211], a[32:35], v[88:91]
    v_mfma_f32_16x16x32_bf16 v[92:95], v[200:203], a[96:99], v[92:95]
    v_mfma_f32_16x16x32_bf16 v[92:95], v[204:207], a[100:103], v[92:95]
    v_mfma_f32_16x16x32_bf16 v[92:95], v[208:211], a[104:107], v[92:95]
    buffer_load_dwordx4 v[108:111], v173, s[8:11], s19 offen sc1
    s_add_u32 s19, s19, 9216
    v_mfma_f32_16x16x32_bf16 v[96:99], v[200:203], a[168:171], v[96:99]
    v_mfma_f32_16x16x32_bf16 v[96:99], v[204:207], a[172:175], v[96:99]
    v_mfma_f32_16x16x32_bf16 v[96:99], v[208:211], a[176:179], v[96:99]
    v_mfma_f32_16x16x32_bf16 v[100:103], v[200:203], a[240:243], v[100:103]
    buffer_load_dwordx4 v[112:115], v172, s[8:11], s19 offen sc1
    v_mfma_f32_16x16x32_bf16 v[100:103], v[204:207], a[244:247], v[100:103]
    v_mfma_f32_16x16x32_bf16 v[100:103], v[208:211], a[248:251], v[100:103]
    s_waitcnt vmcnt(31)
    v_mfma_f32_16x16x32_bf16 v[88:91], v[212:215], a[36:39], v[88:91]
    v_mfma_f32_16x16x32_bf16 v[88:91], v[216:219], a[40:43], v[88:91]
    buffer_load_dwordx4 v[116:119], v173, s[8:11], s19 offen sc1
    s_add_u32 s19, s19, 9216
    v_mfma_f32_16x16x32_bf16 v[88:91], v[136:139], a[44:47], v[88:91]
    v_mfma_f32_16x16x32_bf16 v[92:95], v[212:215], a[108:111], v[92:95]
    v_mfma_f32_16x16x32_bf16 v[92:95], v[216:219], a[112:115], v[92:95]
    v_mfma_f32_16x16x32_bf16 v[92:95], v[136:139], a[116:119], v[92:95]
    buffer_load_dwordx4 v[180:183], v172, s[8:11], s19 offen sc1
    v_mfma_f32_16x16x32_bf16 v[96:99], v[212:215], a[180:183], v[96:99]
    v_mfma_f32_16x16x32_bf16 v[96:99], v[216:219], a[184:187], v[96:99]
    v_mfma_f32_16x16x32_bf16 v[96:99], v[136:139], a[188:191], v[96:99]
    v_mfma_f32_16x16x32_bf16 v[100:103], v[212:215], a[252:255], v[100:103]
    buffer_load_dwordx4 v[196:199], v173, s[8:11], s19 offen sc1
    s_add_u32 s19, s19, 9216
    v_mfma_f32_16x16x32_bf16 v[100:103], v[216:219], v[220:223], v[100:103]
    v_mfma_f32_16x16x32_bf16 v[100:103], v[136:139], v[224:227], v[100:103]
    s_waitcnt vmcnt(31)
    v_mfma_f32_16x16x32_bf16 v[88:91], v[140:143], a[48:51], v[88:91]
    v_mfma_f32_16x16x32_bf16 v[88:91], v[144:147], a[52:55], v[88:91]
    buffer_load_dwordx4 v[200:203], v172, s[8:11], s19 offen sc1
    v_mfma_f32_16x16x32_bf16 v[88:91], v[148:151], a[56:59], v[88:91]
    v_mfma_f32_16x16x32_bf16 v[92:95], v[140:143], a[120:123], v[92:95]
    v_mfma_f32_16x16x32_bf16 v[92:95], v[144:147], a[124:127], v[92:95]
    v_mfma_f32_16x16x32_bf16 v[92:95], v[148:151], a[128:131], v[92:95]
    buffer_load_dwordx4 v[204:207], v173, s[8:11], s19 offen sc1
    s_add_u32 s19, s19, 9216
    v_mfma_f32_16x16x32_bf16 v[96:99], v[140:143], a[192:195], v[96:99]
    v_mfma_f32_16x16x32_bf16 v[96:99], v[144:147], a[196:199], v[96:99]
    v_mfma_f32_16x16x32_bf16 v[96:99], v[148:151], a[200:203], v[96:99]
    v_mfma_f32_16x16x32_bf16 v[100:103], v[140:143], v[228:231], v[100:103]
    buffer_load_dwordx4 v[208:211], v172, s[8:11], s19 offen sc1
    v_mfma_f32_16x16x32_bf16 v[100:103], v[144:147], v[232:235], v[100:103]
    v_mfma_f32_16x16x32_bf16 v[100:103], v[148:151], v[236:239], v[100:103]
    s_waitcnt vmcnt(31)
    v_mfma_f32_16x16x32_bf16 v[88:91], v[160:163], a[60:63], v[88:91]
    v_mfma_f32_16x16x32_bf16 v[88:91], v[164:167], a[64:67], v[88:91]
    buffer_load_dwordx4 v[212:215], v173, s[8:11], s19 offen sc1
    s_add_u32 s19, s19, 9216
    v_mfma_f32_16x16x32_bf16 v[120:123], v[168:171], a[68:71], v[88:91]
    v_mfma_f32_16x16x32_bf16 v[92:95], v[160:163], a[132:135], v[92:95]
    v_mfma_f32_16x16x32_bf16 v[92:95], v[164:167], a[136:139], v[92:95]
    v_mfma_f32_16x16x32_bf16 v[124:127], v[168:171], a[140:143], v[92:95]
    buffer_load_dwordx4 v[216:219], v172, s[8:11], s19 offen sc1
    v_mfma_f32_16x16x32_bf16 v[96:99], v[160:163], a[204:207], v[96:99]
    s_mov_b32 s74, 268435456
    v_mfma_f32_16x16x32_bf16 v[96:99], v[164:167], a[208:211], v[96:99]
    s_add_u32 s27, s27, 1024
    v_mfma_f32_16x16x32_bf16 v[128:131], v[168:171], a[212:215], v[96:99]
    s_add_u32 s25, s25, 1
    v_mfma_f32_16x16x32_bf16 v[100:103], v[160:163], v[240:243], v[100:103]
    buffer_load_dwordx4 v[136:139], v173, s[8:11], s19 offen sc1
    s_add_u32 s19, s19, 9216
    v_mfma_f32_16x16x32_bf16 v[100:103], v[164:167], v[244:247], v[100:103]
    s_add_u32 s23, s23, 18432
    v_mfma_f32_16x16x32_bf16 v[132:135], v[168:171], v[248:251], v[100:103]
    s_waitcnt vmcnt(29)
    v_mfma_f32_16x16x32_bf16 v[88:91], v[16:19], a[0:3], 0
    v_mfma_f32_16x16x32_bf16 v[88:91], v[20:23], a[4:7], v[88:91]
    buffer_load_dwordx4 v[140:143], v172, s[8:11], s19 offen sc1
    v_mfma_f32_16x16x32_bf16 v[88:91], v[24:27], a[8:11], v[88:91]
    v_mfma_f32_16x16x32_bf16 v[92:95], v[16:19], a[72:75], 0
    v_mfma_f32_16x16x32_bf16 v[92:95], v[20:23], a[76:79], v[92:95]
    v_mfma_f32_16x16x32_bf16 v[92:95], v[24:27], a[80:83], v[92:95]
    buffer_load_dwordx4 v[144:147], v173, s[8:11], s19 offen sc1
    s_add_u32 s19, s19, 9216
    v_mfma_f32_16x16x32_bf16 v[96:99], v[16:19], a[144:147], 0
    v_cvt_pk_bf16_f32 v152, v120, v121
    v_cvt_pk_bf16_f32 v153, v122, v123
    v_mfma_f32_16x16x32_bf16 v[96:99], v[20:23], a[148:151], v[96:99]
    v_cvt_pk_bf16_f32 v154, v124, v125
    v_cvt_pk_bf16_f32 v155, v126, v127
    v_mfma_f32_16x16x32_bf16 v[96:99], v[24:27], a[152:155], v[96:99]
    v_cvt_pk_bf16_f32 v156, v128, v129
    v_cvt_pk_bf16_f32 v157, v130, v131
    v_mfma_f32_16x16x32_bf16 v[100:103], v[16:19], a[216:219], 0
    buffer_load_dwordx4 v[148:151], v172, s[8:11], s19 offen sc1
    v_mfma_f32_16x16x32_bf16 v[100:103], v[20:23], a[220:223], v[100:103]
    v_cvt_pk_bf16_f32 v158, v132, v133
    v_cvt_pk_bf16_f32 v159, v134, v135
    v_mfma_f32_16x16x32_bf16 v[100:103], v[24:27], a[224:227], v[100:103]
    v_permlane16_swap_b32 v152, v154
    s_waitcnt vmcnt(29)
    v_mfma_f32_16x16x32_bf16 v[88:91], v[28:31], a[12:15], v[88:91]
    v_permlane16_swap_b32 v153, v155
    v_mfma_f32_16x16x32_bf16 v[88:91], v[32:35], a[16:19], v[88:91]
    buffer_load_dwordx4 v[160:163], v173, s[8:11], s19 offen sc1
    v_mfma_f32_16x16x32_bf16 v[88:91], v[36:39], a[20:23], v[88:91]
    v_permlane16_swap_b32 v156, v158
    v_mfma_f32_16x16x32_bf16 v[92:95], v[28:31], a[84:87], v[92:95]
    v_permlane16_swap_b32 v157, v159
    v_mfma_f32_16x16x32_bf16 v[92:95], v[32:35], a[88:91], v[92:95]
    buffer_store_dwordx4 v[152:155], v178, s[72:75], s27 offen sc1
    v_mfma_f32_16x16x32_bf16 v[92:95], v[36:39], a[92:95], v[92:95]
    buffer_store_dwordx4 v[156:159], v179, s[72:75], s27 offen sc1
    v_mfma_f32_16x16x32_bf16 v[96:99], v[28:31], a[156:159], v[96:99]
    v_mfma_f32_16x16x32_bf16 v[96:99], v[32:35], a[160:163], v[96:99]
    v_mfma_f32_16x16x32_bf16 v[96:99], v[36:39], a[164:167], v[96:99]
    v_mfma_f32_16x16x32_bf16 v[100:103], v[28:31], a[228:231], v[100:103]
    v_mfma_f32_16x16x32_bf16 v[100:103], v[32:35], a[232:235], v[100:103]
    v_mfma_f32_16x16x32_bf16 v[100:103], v[36:39], a[236:239], v[100:103]
    s_waitcnt vmcnt(29)
    v_mfma_f32_16x16x32_bf16 v[88:91], v[40:43], a[24:27], v[88:91]
    v_mfma_f32_16x16x32_bf16 v[88:91], v[44:47], a[28:31], v[88:91]
    v_mfma_f32_16x16x32_bf16 v[88:91], v[48:51], a[32:35], v[88:91]
    v_mfma_f32_16x16x32_bf16 v[92:95], v[40:43], a[96:99], v[92:95]
    v_mfma_f32_16x16x32_bf16 v[92:95], v[44:47], a[100:103], v[92:95]
    v_mfma_f32_16x16x32_bf16 v[92:95], v[48:51], a[104:107], v[92:95]
    v_mfma_f32_16x16x32_bf16 v[96:99], v[40:43], a[168:171], v[96:99]
    v_mfma_f32_16x16x32_bf16 v[96:99], v[44:47], a[172:175], v[96:99]
    v_mfma_f32_16x16x32_bf16 v[96:99], v[48:51], a[176:179], v[96:99]
    v_mfma_f32_16x16x32_bf16 v[100:103], v[40:43], a[240:243], v[100:103]
    v_mfma_f32_16x16x32_bf16 v[100:103], v[44:47], a[244:247], v[100:103]
    v_mfma_f32_16x16x32_bf16 v[100:103], v[48:51], a[248:251], v[100:103]
    s_waitcnt vmcnt(26)
    v_mfma_f32_16x16x32_bf16 v[88:91], v[52:55], a[36:39], v[88:91]
    v_mfma_f32_16x16x32_bf16 v[88:91], v[56:59], a[40:43], v[88:91]
    v_mfma_f32_16x16x32_bf16 v[88:91], v[60:63], a[44:47], v[88:91]
    v_mfma_f32_16x16x32_bf16 v[92:95], v[52:55], a[108:111], v[92:95]
    v_mfma_f32_16x16x32_bf16 v[92:95], v[56:59], a[112:115], v[92:95]
    v_mfma_f32_16x16x32_bf16 v[92:95], v[60:63], a[116:119], v[92:95]
    v_mfma_f32_16x16x32_bf16 v[96:99], v[52:55], a[180:183], v[96:99]
    v_mfma_f32_16x16x32_bf16 v[96:99], v[56:59], a[184:187], v[96:99]
    v_mfma_f32_16x16x32_bf16 v[96:99], v[60:63], a[188:191], v[96:99]
    v_mfma_f32_16x16x32_bf16 v[100:103], v[52:55], a[252:255], v[100:103]
    v_mfma_f32_16x16x32_bf16 v[100:103], v[56:59], v[220:223], v[100:103]
    v_mfma_f32_16x16x32_bf16 v[100:103], v[60:63], v[224:227], v[100:103]
    s_waitcnt vmcnt(23)
    v_mfma_f32_16x16x32_bf16 v[88:91], v[64:67], a[48:51], v[88:91]
    v_mfma_f32_16x16x32_bf16 v[88:91], v[68:71], a[52:55], v[88:91]
    v_mfma_f32_16x16x32_bf16 v[88:91], v[72:75], a[56:59], v[88:91]
    v_mfma_f32_16x16x32_bf16 v[92:95], v[64:67], a[120:123], v[92:95]
    v_mfma_f32_16x16x32_bf16 v[92:95], v[68:71], a[124:127], v[92:95]
    v_mfma_f32_16x16x32_bf16 v[92:95], v[72:75], a[128:131], v[92:95]
    v_mfma_f32_16x16x32_bf16 v[96:99], v[64:67], a[192:195], v[96:99]
    v_mfma_f32_16x16x32_bf16 v[96:99], v[68:71], a[196:199], v[96:99]
    v_mfma_f32_16x16x32_bf16 v[96:99], v[72:75], a[200:203], v[96:99]
    v_mfma_f32_16x16x32_bf16 v[100:103], v[64:67], v[228:231], v[100:103]
    v_mfma_f32_16x16x32_bf16 v[100:103], v[68:71], v[232:235], v[100:103]
    v_mfma_f32_16x16x32_bf16 v[100:103], v[72:75], v[236:239], v[100:103]
    s_waitcnt vmcnt(20)
    v_mfma_f32_16x16x32_bf16 v[88:91], v[76:79], a[60:63], v[88:91]
    v_mfma_f32_16x16x32_bf16 v[88:91], v[80:83], a[64:67], v[88:91]
    v_mfma_f32_16x16x32_bf16 v[120:123], v[84:87], a[68:71], v[88:91]
    v_mfma_f32_16x16x32_bf16 v[92:95], v[76:79], a[132:135], v[92:95]
    v_mfma_f32_16x16x32_bf16 v[92:95], v[80:83], a[136:139], v[92:95]
    v_mfma_f32_16x16x32_bf16 v[124:127], v[84:87], a[140:143], v[92:95]
    v_mfma_f32_16x16x32_bf16 v[96:99], v[76:79], a[204:207], v[96:99]
    s_mov_b32 s74, 268435456
    v_mfma_f32_16x16x32_bf16 v[96:99], v[80:83], a[208:211], v[96:99]
    s_add_u32 s27, s27, 1024
    v_mfma_f32_16x16x32_bf16 v[128:131], v[84:87], a[212:215], v[96:99]
    s_add_u32 s25, s25, 1
    v_mfma_f32_16x16x32_bf16 v[100:103], v[76:79], v[240:243], v[100:103]
    v_mfma_f32_16x16x32_bf16 v[100:103], v[80:83], v[244:247], v[100:103]
    s_add_u32 s23, s23, 18432
    v_mfma_f32_16x16x32_bf16 v[132:135], v[84:87], v[248:251], v[100:103]
    s_nop 7
    v_cvt_pk_bf16_f32 v152, v120, v121
    v_cvt_pk_bf16_f32 v153, v122, v123
    v_cvt_pk_bf16_f32 v154, v124, v125
    v_cvt_pk_bf16_f32 v155, v126, v127
    v_cvt_pk_bf16_f32 v156, v128, v129
    v_cvt_pk_bf16_f32 v157, v130, v131
    v_cvt_pk_bf16_f32 v158, v132, v133
    v_cvt_pk_bf16_f32 v159, v134, v135
    s_nop 1
    v_permlane16_swap_b32 v152, v154
    v_permlane16_swap_b32 v153, v155
    v_permlane16_swap_b32 v156, v158
    v_permlane16_swap_b32 v157, v159
    buffer_store_dwordx4 v[152:155], v178, s[72:75], s27 offen sc1
    buffer_store_dwordx4 v[156:159], v179, s[72:75], s27 offen sc1
    v_lshlrev_b32 v15, 7, v0
    s_lshl_b32 s6, s40, 2
    s_add_u32 s6, s6, s44
    s_add_u32 s6, s6, 65536
    v_mov_b32 v1, s76
    s_mov_b64 vcc, 0xff
    s_waitcnt vmcnt(0)
    s_barrier
    s_cmp_lg_u32 s3, 0
    s_cbranch_scc1 L_pub_40
    s_mov_b64 exec, vcc
    buffer_store_dword v1, v15, s[8:11], s6 offen sc1
L_pub_40:
    s_mov_b64 exec, -1
    s_add_u32 s19, s18, s43
    s_add_u32 s22, s19, 45875200
    s_lshl_b32 s23, s21, 5
    s_add_u32 s23, s23, s43
    s_add_u32 s23, s23, 48431104
    v_and_b32 v12, 7, v0
    v_lshlrev_b32 v12, 2, v12
    buffer_load_dword v10, v12, s[8:11], s23 offen sc1
    buffer_load_dwordx4 v[92:95], v172, s[8:11], s22 offen sc1
    buffer_load_dwordx4 v[96:99], v173, s[8:11], s22 offen sc1
    buffer_load_dwordx4 v[100:103], v174, s[8:11], s22 offen sc1
    v_lshlrev_b32 v16, 16, v104
    v_and_b32 v17, s16, v104
    v_lshlrev_b32 v18, 16, v105
    v_and_b32 v19, s16, v105
    v_lshlrev_b32 v20, 16, v106
    v_and_b32 v21, s16, v106
    v_lshlrev_b32 v22, 16, v107
    v_and_b32 v23, s16, v107
    v_lshlrev_b32 v24, 16, v108
    v_and_b32 v25, s16, v108
    v_lshlrev_b32 v26, 16, v109
    v_and_b32 v27, s16, v109
    v_lshlrev_b32 v28, 16, v110
    v_and_b32 v29, s16, v110
    v_lshlrev_b32 v30, 16, v111
    v_and_b32 v31, s16, v111
    v_lshlrev_b32 v40, 16, v112
    v_and_b32 v41, s16, v112
    v_lshlrev_b32 v42, 16, v113
    v_and_b32 v43, s16, v113
    v_lshlrev_b32 v44, 16, v114
    v_and_b32 v45, s16, v114
    v_lshlrev_b32 v46, 16, v115
    v_and_b32 v47, s16, v115
    v_pk_add_f32 v[16:17], v[16:17], v[40:41]
    v_pk_add_f32 v[18:19], v[18:19], v[42:43]
    v_pk_add_f32 v[20:21], v[20:21], v[44:45]
    v_pk_add_f32 v[22:23], v[22:23], v[46:47]
    v_lshlrev_b32 v40, 16, v116
    v_and_b32 v41, s16, v116
    v_lshlrev_b32 v42, 16, v117
    v_and_b32 v43, s16, v117
    v_lshlrev_b32 v44, 16, v118
    v_and_b32 v45, s16, v118
    v_lshlrev_b32 v46, 16, v119
    v_and_b32 v47, s16, v119
    v_pk_add_f32 v[24:25], v[24:25], v[40:41]
    v_pk_add_f32 v[26:27], v[26:27], v[42:43]
    v_pk_add_f32 v[28:29], v[28:29], v[44:45]
    v_pk_add_f32 v[30:31], v[30:31], v[46:47]
    v_lshlrev_b32 v40, 16, v180
    v_and_b32 v41, s16, v180
    v_lshlrev_b32 v42, 16, v181
    v_and_b32 v43, s16, v181
    v_lshlrev_b32 v44, 16, v182
    v_and_b32 v45, s16, v182
    v_lshlrev_b32 v46, 16, v183
    v_and_b32 v47, s16, v183
    v_pk_add_f32 v[16:17], v[16:17], v[40:41]
    v_pk_add_f32 v[18:19], v[18:19], v[42:43]
    v_pk_add_f32 v[20:21], v[20:21], v[44:45]
    v_pk_add_f32 v[22:23], v[22:23], v[46:47]
    v_lshlrev_b32 v40, 16, v196
    v_and_b32 v41, s16, v196
    v_lshlrev_b32 v42, 16, v197
    v_and_b32 v43, s16, v197
    v_lshlrev_b32 v44, 16, v198
    v_and_b32 v45, s16, v198
    v_lshlrev_b32 v46, 16, v199
    v_and_b32 v47, s16, v199
    v_pk_add_f32 v[24:25], v[24:25], v[40:41]
    v_pk_add_f32 v[26:27], v[26:27], v[42:43]
    v_pk_add_f32 v[28:29], v[28:29], v[44:45]
    v_pk_add_f32 v[30:31], v[30:31], v[46:47]
    v_lshlrev_b32 v40, 16, v200
    v_and_b32 v41, s16, v200
    v_lshlrev_b32 v42, 16, v201
    v_and_b32 v43, s16, v201
    v_lshlrev_b32 v44, 16, v202
    v_and_b32 v45, s16, v202
    v_lshlrev_b32 v46, 16, v203
    v_and_b32 v47, s16, v203
    v_pk_add_f32 v[16:17], v[16:17], v[40:41]
    v_pk_add_f32 v[18:19], v[18:19], v[42:43]
    v_pk_add_f32 v[20:21], v[20:21], v[44:45]
    v_pk_add_f32 v[22:23], v[22:23], v[46:47]
    v_lshlrev_b32 v40, 16, v204
    v_and_b32 v41, s16, v204
    v_lshlrev_b32 v42, 16, v205
    v_and_b32 v43, s16, v205
    v_lshlrev_b32 v44, 16, v206
    v_and_b32 v45, s16, v206
    v_lshlrev_b32 v46, 16, v207
    v_and_b32 v47, s16, v207
    v_pk_add_f32 v[24:25], v[24:25], v[40:41]
    v_pk_add_f32 v[26:27], v[26:27], v[42:43]
    v_pk_add_f32 v[28:29], v[28:29], v[44:45]
    v_pk_add_f32 v[30:31], v[30:31], v[46:47]
    s_cmp_lg_u32 s3, 3
    s_cbranch_scc1 L_pollout_43
    s_lshl_b32 s7, s40, 7
    s_add_u32 s7, s7, s44
    s_add_u32 s7, s7, 65536
    s_add_u32 s52, s4, s7
    s_addc_u32 s53, s5, 0
    s_mov_b32 s6, 0
L_poll_41:
    s_load_dwordx8 s[56:63], s[52:53], 0 glc
    s_add_u32 s6, s6, 1
    s_waitcnt lgkmcnt(0)
    s_xor_b64 s[56:57], s[56:57], s[76:77]
    s_xor_b64 s[58:59], s[58:59], s[76:77]
    s_xor_b64 s[60:61], s[60:61], s[76:77]
    s_xor_b64 s[62:63], s[62:63], s[76:77]
    s_or_b64 s[56:57], s[56:57], s[58:59]
    s_or_b64 s[60:61], s[60:61], s[62:63]
    s_or_b64 s[56:57], s[56:57], s[60:61]
    s_cbranch_scc0 L_polled_42
    s_cmp_lt_u32 s6, 1048576
    s_cbranch_scc1 L_poll_41
    s_branch L_main_end
L_polled_42:
L_pollout_43:
    s_barrier
    buffer_load_dwordx4 v[60:63], v174, s[8:11], s20 offen sc1
    s_add_u32 s20, s20, 9216
    buffer_load_dwordx4 v[64:67], v174, s[8:11], s20 offen sc1
    s_add_u32 s20, s20, 9216
    buffer_load_dwordx4 v[68:71], v174, s[8:11], s20 offen sc1
    s_add_u32 s20, s20, 9216
    buffer_load_dwordx4 v[72:75], v174, s[8:11], s20 offen sc1
    s_add_u32 s20, s20, 9216
    buffer_load_dwordx4 v[76:79], v174, s[8:11], s20 offen sc1
    s_add_u32 s20, s20, 9216
    buffer_load_dwordx4 v[80:83], v174, s[8:11], s20 offen sc1
    s_add_u32 s20, s20, 9216
    buffer_load_dwordx4 v[84:87], v174, s[8:11], s20 offen sc1
    s_add_u32 s20, s20, 9216
    buffer_load_dwordx4 v[88:91], v174, s[8:11], s20 offen sc1
    v_lshlrev_b32 v40, 16, v208
    v_and_b32 v41, s16, v208
    v_lshlrev_b32 v42, 16, v209
    v_and_b32 v43, s16, v209
    v_lshlrev_b32 v44, 16, v210
    v_and_b32 v45, s16, v210
    v_lshlrev_b32 v46, 16, v211
    v_and_b32 v47, s16, v211
    v_pk_add_f32 v[16:17], v[16:17], v[40:41]
    v_pk_add_f32 v[18:19], v[18:19], v[42:43]
    v_pk_add_f32 v[20:21], v[20:21], v[44:45]
    v_pk_add_f32 v[22:23], v[22:23], v[46:47]
    v_lshlrev_b32 v40, 16, v212
    v_and_b32 v41, s16, v212
    v_lshlrev_b32 v42, 16, v213
    v_and_b32 v43, s16, v213
    v_lshlrev_b32 v44, 16, v214
    v_and_b32 v45, s16, v214
    v_lshlrev_b32 v46, 16, v215
    v_and_b32 v47, s16, v215
    v_pk_add_f32 v[24:25], v[24:25], v[40:41]
    v_pk_add_f32 v[26:27], v[26:27], v[42:43]
    v_pk_add_f32 v[28:29], v[28:29], v[44:45]
    v_pk_add_f32 v[30:31], v[30:31], v[46:47]
    v_lshlrev_b32 v40, 16, v216
    v_and_b32 v41, s16, v216
    v_lshlrev_b32 v42, 16, v217
    v_and_b32 v43, s16, v217
    v_lshlrev_b32 v44, 16, v218
    v_and_b32 v45, s16, v218
    v_lshlrev_b32 v46, 16, v219
    v_and_b32 v47, s16, v219
    v_pk_add_f32 v[16:17], v[16:17], v[40:41]
    v_pk_add_f32 v[18:19], v[18:19], v[42:43]
    v_pk_add_f32 v[20:21], v[20:21], v[44:45]
    v_pk_add_f32 v[22:23], v[22:23], v[46:47]
    v_lshlrev_b32 v40, 16, v136
    v_and_b32 v41, s16, v136
    v_lshlrev_b32 v42, 16, v137
    v_and_b32 v43, s16, v137
    v_lshlrev_b32 v44, 16, v138
    v_and_b32 v45, s16, v138
    v_lshlrev_b32 v46, 16, v139
    v_and_b32 v47, s16, v139
    v_pk_add_f32 v[24:25], v[24:25], v[40:41]
    v_pk_add_f32 v[26:27], v[26:27], v[42:43]
    v_pk_add_f32 v[28:29], v[28:29], v[44:45]
    v_pk_add_f32 v[30:31], v[30:31], v[46:47]
    v_lshlrev_b32 v40, 16, v140
    v_and_b32 v41, s16, v140
    v_lshlrev_b32 v42, 16, v141
    v_and_b32 v43, s16, v141
    v_lshlrev_b32 v44, 16, v142
    v_and_b32 v45, s16, v142
    v_lshlrev_b32 v46, 16, v143
    v_and_b32 v47, s16, v143
    v_pk_add_f32 v[16:17], v[16:17], v[40:41]
    v_pk_add_f32 v[18:19], v[18:19], v[42:43]
    v_pk_add_f32 v[20:21], v[20:21], v[44:45]
    v_pk_add_f32 v[22:23], v[22:23], v[46:47]
    v_lshlrev_b32 v40, 16, v144
    v_and_b32 v41, s16, v144
    v_lshlrev_b32 v42, 16, v145
    v_and_b32 v43, s16, v145
    v_lshlrev_b32 v44, 16, v146
    v_and_b32 v45, s16, v146
    v_lshlrev_b32 v46, 16, v147
    v_and_b32 v47, s16, v147
    v_pk_add_f32 v[24:25], v[24:25], v[40:41]
    v_pk_add_f32 v[26:27], v[26:27], v[42:43]
    v_pk_add_f32 v[28:29], v[28:29], v[44:45]
    v_pk_add_f32 v[30:31], v[30:31], v[46:47]
    v_lshlrev_b32 v40, 16, v148
    v_and_b32 v41, s16, v148
    v_lshlrev_b32 v42, 16, v149
    v_and_b32 v43, s16, v149
    v_lshlrev_b32 v44, 16, v150
    v_and_b32 v45, s16, v150
    v_lshlrev_b32 v46, 16, v151
    v_and_b32 v47, s16, v151
    v_pk_add_f32 v[16:17], v[16:17], v[40:41]
    v_pk_add_f32 v[18:19], v[18:19], v[42:43]
    v_pk_add_f32 v[20:21], v[20:21], v[44:45]
    v_pk_add_f32 v[22:23], v[22:23], v[46:47]
    v_lshlrev_b32 v40, 16, v160
    v_and_b32 v41, s16, v160
    v_lshlrev_b32 v42, 16, v161
    v_and_b32 v43, s16, v161
    v_lshlrev_b32 v44, 16, v162
    v_and_b32 v45, s16, v162
    v_lshlrev_b32 v46, 16, v163
    v_and_b32 v47, s16, v163
    v_pk_add_f32 v[24:25], v[24:25], v[40:41]
    v_pk_add_f32 v[26:27], v[26:27], v[42:43]
    v_pk_add_f32 v[28:29], v[28:29], v[44:45]
    v_pk_add_f32 v[30:31], v[30:31], v[46:47]
    s_cmp_eq_u32 s3, 0
    s_cselect_b32 s7, 1.0, 0
    s_waitcnt vmcnt(8)
    v_mul_f32 v11, s7, v10
    v_lshlrev_b32 v40, 16, v92
    v_and_b32 v41, s16, v92
    v_lshlrev_b32 v42, 16, v93
    v_and_b32 v43, s16, v93
    v_lshlrev_b32 v44, 16, v94
    v_and_b32 v45, s16, v94
    v_lshlrev_b32 v46, 16, v95
    v_and_b32 v47, s16, v95
    v_pk_add_f32 v[16:17], v[16:17], v[40:41]
    v_pk_add_f32 v[18:19], v[18:19], v[42:43]
    v_pk_add_f32 v[20:21], v[20:21], v[44:45]
    v_pk_add_f32 v[22:23], v[22:23], v[46:47]
    v_lshlrev_b32 v40, 16, v96
    v_and_b32 v41, s16, v96
    v_lshlrev_b32 v42, 16, v97
    v_and_b32 v43, s16, v97
    v_lshlrev_b32 v44, 16, v98
    v_and_b32 v45, s16, v98
    v_lshlrev_b32 v46, 16, v99
    v_and_b32 v47, s16, v99
    v_pk_add_f32 v[24:25], v[24:25], v[40:41]
    v_pk_add_f32 v[26:27], v[26:27], v[42:43]
    v_pk_add_f32 v[28:29], v[28:29], v[44:45]
    v_pk_add_f32 v[30:31], v[30:31], v[46:47]
    v_lshlrev_b32 v32, 16, v100
    v_and_b32 v33, s16, v100
    v_lshlrev_b32 v34, 16, v101
    v_and_b32 v35, s16, v101
    v_lshlrev_b32 v36, 16, v102
    v_and_b32 v37, s16, v102
    v_lshlrev_b32 v38, 16, v103
    v_and_b32 v39, s16, v103
    v_pk_add_f32 v[16:17], v[16:17], v[10:11] op_sel_hi:[1,0]
    v_pk_add_f32 v[18:19], v[18:19], v[10:11] op_sel_hi:[1,0]
    v_pk_add_f32 v[20:21], v[20:21], v[10:11] op_sel_hi:[1,0]
    v_pk_add_f32 v[22:23], v[22:23], v[10:11] op_sel_hi:[1,0]
    v_pk_add_f32 v[24:25], v[24:25], v[10:11] op_sel:[0,1] op_sel_hi:[1,1]
    v_pk_add_f32 v[26:27], v[26:27], v[10:11] op_sel:[0,1] op_sel_hi:[1,1]
    v_pk_add_f32 v[28:29], v[28:29], v[10:11] op_sel:[0,1] op_sel_hi:[1,1]
    v_pk_add_f32 v[30:31], v[30:31], v[10:11] op_sel:[0,1] op_sel_hi:[1,1]
    v_pk_add_f32 v[32:33], v[32:33], v[10:11] op_sel_hi:[1,0]
    v_pk_add_f32 v[34:35], v[34:35], v[10:11] op_sel_hi:[1,0]
    v_pk_add_f32 v[36:37], v[36:37], v[10:11] op_sel_hi:[1,0]
    v_pk_add_f32 v[38:39], v[38:39], v[10:11] op_sel_hi:[1,0]
    s_waitcnt vmcnt(7)
    s_lshl_b32 s28, s40, 2
    s_add_u32 s28, s28, s3
    s_mul_i32 s28, s28, 73728
    s_mul_i32 s7, s42, 1073741824
    v_add_u32 v1, s7, v253
    buffer_load_dwordx4 a[0:3], v1, s[8:11], s28 offen offset:0 sc1
    buffer_load_dwordx4 a[4:7], v1, s[8:11], s28 offen offset:1024 sc1
    v_lshlrev_b32 v40, 16, v60
    v_and_b32 v41, s16, v60
    v_lshlrev_b32 v42, 16, v61
    v_and_b32 v43, s16, v61
    v_lshlrev_b32 v44, 16, v62
    v_and_b32 v45, s16, v62
    v_lshlrev_b32 v46, 16, v63
    v_and_b32 v47, s16, v63
    v_pk_add_f32 v[32:33], v[32:33], v[40:41]
    v_pk_add_f32 v[34:35], v[34:35], v[42:43]
    v_pk_add_f32 v[36:37], v[36:37], v[44:45]
    v_pk_add_f32 v[38:39], v[38:39], v[46:47]
    s_waitcnt vmcnt(8)
    buffer_load_dwordx4 a[8:11], v1, s[8:11], s28 offen offset:2048 sc1
    buffer_load_dwordx4 a[12:15], v1, s[8:11], s28 offen offset:3072 sc1
    v_lshlrev_b32 v40, 16, v64
    v_and_b32 v41, s16, v64
    v_lshlrev_b32 v42, 16, v65
    v_and_b32 v43, s16, v65
    v_lshlrev_b32 v44, 16, v66
    v_and_b32 v45, s16, v66
    v_lshlrev_b32 v46, 16, v67
    v_and_b32 v47, s16, v67
    v_pk_add_f32 v[32:33], v[32:33], v[40:41]
    v_pk_add_f32 v[34:35], v[34:35], v[42:43]
    v_pk_add_f32 v[36:37], v[36:37], v[44:45]
    v_pk_add_f32 v[38:39], v[38:39], v[46:47]
    s_waitcnt vmcnt(9)
    s_add_u32 s28, s28, 4096
    buffer_load_dwordx4 a[16:19], v1, s[8:11], s28 offen offset:0 sc1
    buffer_load_dwordx4 a[20:23], v1, s[8:11], s28 offen offset:1024 sc1
    v_lshlrev_b32 v40, 16, v68
    v_and_b32 v41, s16, v68
    v_lshlrev_b32 v42, 16, v69
    v_and_b32 v43, s16, v69
    v_lshlrev_b32 v44, 16, v70
    v_and_b32 v45, s16, v70
    v_lshlrev_b32 v46, 16, v71
    v_and_b32 v47, s16, v71
    v_pk_add_f32 v[32:33], v[32:33], v[40:41]
    v_pk_add_f32 v[34:35], v[34:35], v[42:43]
    v_pk_add_f32 v[36:37], v[36:37], v[44:45]
    v_pk_add_f32 v[38:39], v[38:39], v[46:47]
    s_waitcnt vmcnt(10)
    buffer_load_dwordx4 a[24:27], v1, s[8:11], s28 offen offset:2048 sc1
    buffer_load_dwordx4 a[28:31], v1, s[8:11], s28 offen offset:3072 sc1
    v_lshlrev_b32 v40, 16, v72
    v_and_b32 v41, s16, v72
    v_lshlrev_b32 v42, 16, v73
    v_and_b32 v43, s16, v73
    v_lshlrev_b32 v44, 16, v74
    v_and_b32 v45, s16, v74
    v_lshlrev_b32 v46, 16, v75
    v_and_b32 v47, s16, v75
    v_pk_add_f32 v[32:33], v[32:33], v[40:41]
    v_pk_add_f32 v[34:35], v[34:35], v[42:43]
    v_pk_add_f32 v[36:37], v[36:37], v[44:45]
    v_pk_add_f32 v[38:39], v[38:39], v[46:47]
    s_waitcnt vmcnt(11)
    s_add_u32 s28, s28, 4096
    buffer_load_dwordx4 a[32:35], v1, s[8:11], s28 offen offset:0 sc1
    buffer_load_dwordx4 a[36:39], v1, s[8:11], s28 offen offset:1024 sc1
    v_lshlrev_b32 v40, 16, v76
    v_and_b32 v41, s16, v76
    v_lshlrev_b32 v42, 16, v77
    v_and_b32 v43, s16, v77
    v_lshlrev_b32 v44, 16, v78
    v_and_b32 v45, s16, v78
    v_lshlrev_b32 v46, 16, v79
    v_and_b32 v47, s16, v79
    v_pk_add_f32 v[32:33], v[32:33], v[40:41]
    v_pk_add_f32 v[34:35], v[34:35], v[42:43]
    v_pk_add_f32 v[36:37], v[36:37], v[44:45]
    v_pk_add_f32 v[38:39], v[38:39], v[46:47]
    s_waitcnt vmcnt(12)
    buffer_load_dwordx4 a[40:43], v1, s[8:11], s28 offen offset:2048 sc1
    buffer_load_dwordx4 a[44:47], v1, s[8:11], s28 offen offset:3072 sc1
    v_lshlrev_b32 v40, 16, v80
    v_and_b32 v41, s16, v80
    v_lshlrev_b32 v42, 16, v81
    v_and_b32 v43, s16, v81
    v_lshlrev_b32 v44, 16, v82
    v_and_b32 v45, s16, v82
    v_lshlrev_b32 v46, 16, v83
    v_and_b32 v47, s16, v83
    v_pk_add_f32 v[32:33], v[32:33], v[40:41]
    v_pk_add_f32 v[34:35], v[34:35], v[42:43]
    v_pk_add_f32 v[36:37], v[36:37], v[44:45]
    v_pk_add_f32 v[38:39], v[38:39], v[46:47]
    s_waitcnt vmcnt(13)
    s_add_u32 s28, s28, 4096
    buffer_load_dwordx4 a[48:51], v1, s[8:11], s28 offen offset:0 sc1
    buffer_load_dwordx4 a[52:55], v1, s[8:11], s28 offen offset:1024 sc1
    v_lshlrev_b32 v40, 16, v84
    v_and_b32 v41, s16, v84
    v_lshlrev_b32 v42, 16, v85
    v_and_b32 v43, s16, v85
    v_lshlrev_b32 v44, 16, v86
    v_and_b32 v45, s16, v86
    v_lshlrev_b32 v46, 16, v87
    v_and_b32 v47, s16, v87
    v_pk_add_f32 v[32:33], v[32:33], v[40:41]
    v_pk_add_f32 v[34:35], v[34:35], v[42:43]
    v_pk_add_f32 v[36:37], v[36:37], v[44:45]
    v_pk_add_f32 v[38:39], v[38:39], v[46:47]
    s_waitcnt vmcnt(14)
    buffer_load_dwordx4 a[56:59], v1, s[8:11], s28 offen offset:2048 sc1
    buffer_load_dwordx4 a[60:63], v1, s[8:11], s28 offen offset:3072 sc1
    v_lshlrev_b32 v40, 16, v88
    v_and_b32 v41, s16, v88
    v_lshlrev_b32 v42, 16, v89
    v_and_b32 v43, s16, v89
    v_lshlrev_b32 v44, 16, v90
    v_and_b32 v45, s16, v90
    v_lshlrev_b32 v46, 16, v91
    v_and_b32 v47, s16, v91
    v_pk_add_f32 v[32:33], v[32:33], v[40:41]
    v_pk_add_f32 v[34:35], v[34:35], v[42:43]
    v_pk_add_f32 v[36:37], v[36:37], v[44:45]
    v_pk_add_f32 v[38:39], v[38:39], v[46:47]
    s_add_u32 s28, s28, 4096
    buffer_load_dwordx4 a[64:67], v1, s[8:11], s28 offen offset:0 sc1
    buffer_load_dwordx4 a[68:71], v1, s[8:11], s28 offen offset:1024 sc1
    buffer_load_dwordx4 a[72:75], v1, s[8:11], s28 offen offset:2048 sc1
    buffer_load_dwordx4 a[76:79], v1, s[8:11], s28 offen offset:3072 sc1
    s_add_u32 s28, s28, 4096
    buffer_load_dwordx4 a[80:83], v1, s[8:11], s28 offen offset:0 sc1
    buffer_load_dwordx4 a[84:87], v1, s[8:11], s28 offen offset:1024 sc1
    buffer_load_dwordx4 a[88:91], v1, s[8:11], s28 offen offset:2048 sc1
    buffer_load_dwordx4 a[92:95], v1, s[8:11], s28 offen offset:3072 sc1
    s_add_u32 s28, s28, 4096
    v_cvt_pk_bf16_f32 v120, v16, v17
    v_cvt_pk_bf16_f32 v121, v18, v19
    v_cvt_pk_bf16_f32 v122, v20, v21
    v_cvt_pk_bf16_f32 v123, v22, v23
    v_cvt_pk_bf16_f32 v124, v24, v25
    v_cvt_pk_bf16_f32 v125, v26, v27
    v_cvt_pk_bf16_f32 v126, v28, v29
    v_cvt_pk_bf16_f32 v127, v30, v31
    v_cvt_pk_bf16_f32 v128, v32, v33
    v_cvt_pk_bf16_f32 v129, v34, v35
    v_cvt_pk_bf16_f32 v130, v36, v37
    v_cvt_pk_bf16_f32 v131, v38, v39
    s_cmp_lg_u32 s42, 0
    s_cbranch_scc1 L_main_last
    s_add_u32 s19, s18, 53215232
    s_add_u32 s20, s18, 48496640
    s_lshl_b32 s22, s21, 7
    s_add_u32 s22, s22, 57933824
    buffer_store_dwordx4 v[120:123], v172, s[8:11], s19 offen sc1
    buffer_store_dwordx4 v[124:127], v173, s[8:11], s19 offen sc1
    buffer_store_dwordx4 v[128:131], v174, s[8:11], s19 offen sc1
    s_mov_b32 s17, 0x3f803f80
    v_mov_b32 v8, 0
    v_mov_b32 v9, 0
    v_mov_b32 v10, 0
    v_mov_b32 v11, 0
    v_dot2c_f32_bf16 v8, s17, v120
    v_dot2c_f32_bf16 v9, v120, v120
    v_dot2c_f32_bf16 v10, s17, v121
    v_dot2c_f32_bf16 v11, v121, v121
    v_dot2c_f32_bf16 v8, s17, v122
    v_dot2c_f32_bf16 v9, v122, v122
    v_dot2c_f32_bf16 v10, s17, v123
    v_dot2c_f32_bf16 v11, v123, v123
    v_dot2c_f32_bf16 v8, s17, v124
    v_dot2c_f32_bf16 v9, v124, v124
    v_dot2c_f32_bf16 v10, s17, v125
    v_dot2c_f32_bf16 v11, v125, v125
    v_dot2c_f32_bf16 v8, s17, v126
    v_dot2c_f32_bf16 v9, v126, v126
    v_dot2c_f32_bf16 v10, s17, v127
    v_dot2c_f32_bf16 v11, v127, v127
    v_dot2c_f32_bf16 v8, s17, v128
    v_dot2c_f32_bf16 v9, v128, v128
    v_dot2c_f32_bf16 v10, s17, v129
    v_dot2c_f32_bf16 v11, v129, v129
    v_dot2c_f32_bf16 v8, s17, v130
    v_dot2c_f32_bf16 v9, v130, v130
    v_dot2c_f32_bf16 v10, s17, v131
    v_dot2c_f32_bf16 v11, v131, v131
    v_and_b32 v12, 7, v0
    v_lshlrev_b32 v12, 3, v12
    s_lshl_b32 s7, s3, 6
    v_add_u32 v13, s7, v12
    v_pk_add_f32 v[8:9], v[8:9], v[10:11]
    s_nop 1
    v_add_f32_dpp v8, v8, v8 row_ror:8 row_mask:0xf bank_mask:0xf
    v_add_f32_dpp v9, v9, v9 row_ror:8 row_mask:0xf bank_mask:0xf
    v_mov_b32 v10, v8
    v_mov_b32 v11, v9
    s_nop 1
    v_permlane32_swap_b32 v10, v8
    v_permlane32_swap_b32 v11, v9
    v_add_f32 v8, v8, v10
    v_add_f32 v9, v9, v11
    v_mov_b32 v10, v8
    v_mov_b32 v11, v9
    s_nop 1
    v_permlane16_swap_b32 v10, v8
    v_permlane16_swap_b32 v11, v9
    v_add_f32 v8, v8, v10
    v_add_f32 v9, v9, v11
    ds_write_b64 v13, v[8:9]
    s_waitcnt lgkmcnt(0)
    s_barrier
    ds_read_b64 v[40:41], v12 offset:0
    ds_read_b64 v[42:43], v12 offset:64
    ds_read_b64 v[44:45], v12 offset:128
    ds_read_b64 v[46:47], v12 offset:192
    s_waitcnt lgkmcnt(0)
    v_pk_add_f32 v[40:41], v[40:41], v[42:43]
    v_pk_add_f32 v[44:45], v[44:45], v[46:47]
    v_pk_add_f32 v[8:9], v[40:41], v[44:45]
    v_mul_f32 v8, 0x3ae38e39, v8
    v_mul_f32 v9, 0x3ae38e39, v9
    v_fma_f32 v9, -v8, v8, v9
    v_max_f32 v9, 0, v9
    v_add_f32 v9, 0x3727c5ac, v9
    v_rsq_f32 v10, v9
    s_nop 0
    v_mul_f32 v12, v8, v10
    v_mov_b32 v11, v10
    v_sub_f32 v12, 0, v12
    v_mov_b32 v13, v12
    s_cmp_eq_u32 s3, 0
    s_cselect_b32 s7, 32, 0
    v_lshlrev_b32 v14, 2, v0
    v_cmp_gt_u32 vcc, s7, v0
    v_mov_b32 v9, 1073741824
    s_nop 0
    v_cndmask_b32 v14, v9, v14, vcc
    buffer_store_dword v8, v14, s[8:11], s22 offen sc1
    v_lshlrev_b32 v40, 16, v120
    v_and_b32 v41, s16, v120
    v_lshlrev_b32 v42, 16, v121
    v_and_b32 v43, s16, v121
    v_lshlrev_b32 v44, 16, v122
    v_and_b32 v45, s16, v122
    v_lshlrev_b32 v46, 16, v123
    v_and_b32 v47, s16, v123
    v_pk_fma_f32 v[40:41], v[40:41], v[10:11], v[12:13]
    v_pk_fma_f32 v[42:43], v[42:43], v[10:11], v[12:13]
    v_pk_fma_f32 v[44:45], v[44:45], v[10:11], v[12:13]
    v_pk_fma_f32 v[46:47], v[46:47], v[10:11], v[12:13]
    v_cvt_pk_bf16_f32 v48, v40, v41
    v_cvt_pk_bf16_f32 v49, v42, v43
    v_cvt_pk_bf16_f32 v50, v44, v45
    v_cvt_pk_bf16_f32 v51, v46, v47
    v_lshlrev_b32 v40, 16, v124
    v_and_b32 v41, s16, v124
    v_lshlrev_b32 v42, 16, v125
    v_and_b32 v43, s16, v125
    v_lshlrev_b32 v44, 16, v126
    v_and_b32 v45, s16, v126
    v_lshlrev_b32 v46, 16, v127
    v_and_b32 v47, s16, v127
    v_pk_fma_f32 v[40:41], v[40:41], v[10:11], v[12:13]
    v_pk_fma_f32 v[42:43], v[42:43], v[10:11], v[12:13]
    v_pk_fma_f32 v[44:45], v[44:45], v[10:11], v[12:13]
    v_pk_fma_f32 v[46:47], v[46:47], v[10:11], v[12:13]
    v_cvt_pk_bf16_f32 v52, v40, v41
    v_cvt_pk_bf16_f32 v53, v42, v43
    v_cvt_pk_bf16_f32 v54, v44, v45
    v_cvt_pk_bf16_f32 v55, v46, v47
    v_lshlrev_b32 v40, 16, v128
    v_and_b32 v41, s16, v128
    v_lshlrev_b32 v42, 16, v129
    v_and_b32 v43, s16, v129
    v_lshlrev_b32 v44, 16, v130
    v_and_b32 v45, s16, v130
    v_lshlrev_b32 v46, 16, v131
    v_and_b32 v47, s16, v131
    v_pk_fma_f32 v[40:41], v[40:41], v[10:11], v[12:13]
    v_pk_fma_f32 v[42:43], v[42:43], v[10:11], v[12:13]
    v_pk_fma_f32 v[44:45], v[44:45], v[10:11], v[12:13]
    v_pk_fma_f32 v[46:47], v[46:47], v[10:11], v[12:13]
    v_cvt_pk_bf16_f32 v56, v40, v41
    v_cvt_pk_bf16_f32 v57, v42, v43
    v_cvt_pk_bf16_f32 v58, v44, v45
    v_cvt_pk_bf16_f32 v59, v46, v47
    buffer_store_dwordx4 v[48:51], v172, s[8:11], s20 offen sc1
    buffer_store_dwordx4 v[52:55], v173, s[8:11], s20 offen sc1
    buffer_store_dwordx4 v[56:59], v174, s[8:11], s20 offen sc1
    v_lshlrev_b32 v15, 7, v0
    s_lshl_b32 s6, s40, 2
    s_add_u32 s6, s6, s44
    s_add_u32 s6, s6, 98304
    v_mov_b32 v1, s76
    s_mov_b64 vcc, 0xff
    v_lshrrev_b32 v14, 3, v0
    v_lshl_add_u32 v15, v14, 3, v15
    s_cmp_ge_u32 s40, 6
    s_cselect_b32 s7, s41, 31
    s_cmp_lt_u32 s7, 31
    s_cmov_b64 vcc, 0xffff
    s_waitcnt vmcnt(0)
    s_barrier
    s_cmp_lg_u32 s3, 0
    s_cbranch_scc1 L_pub_44
    s_mov_b64 exec, vcc
    buffer_store_dword v1, v15, s[8:11], s6 offen sc1
L_pub_44:
    s_mov_b64 exec, -1
    s_mov_b32 s42, 1
    s_mov_b32 s43, 9699328
    s_add_u32 s44, s44, 131072
    s_mov_b32 s74, 0
    s_branch L_main_layer
L_main_last:
    buffer_store_dwordx4 v[120:123], v175, s[12:15], s18 offen
    buffer_store_dwordx4 v[124:127], v176, s[12:15], s18 offen
    buffer_store_dwordx4 v[128:131], v177, s[12:15], s18 offen
    s_or_b32 s7, s40, s41
    s_or_b32 s7, s7, s3
    s_cbranch_scc1 L_done_45
    v_mov_b32 v1, s76
    s_mov_b32 s7, 19660800
    s_mov_b64 exec, 1
    buffer_store_dword v1, off, s[8:11], s7 sc1
    s_mov_b64 exec, -1
L_done_45:
L_main_end:
    s_endpgm
L_main_code_end:
.section .rodata,"a"
.p2align 6
.amdhsa_kernel interleave_layers__sliding_local_dilated__glu_gated_geglu__prompt_kernel
.amdhsa_next_free_vgpr 512
.amdhsa_next_free_sgpr 102
.amdhsa_accum_offset 256
.amdhsa_group_segment_fixed_size 0
.amdhsa_kernarg_size 80
.amdhsa_user_sgpr_count 2
.amdhsa_user_sgpr_kernarg_segment_ptr 1
.amdhsa_system_sgpr_workgroup_id_x 1
.amdhsa_float_denorm_mode_32 3
.amdhsa_float_denorm_mode_16_64 3
.end_amdhsa_kernel
```

```asm
; @launch grid=(256,1,1) block=(256,1,1) lds=163840
.amdgcn_target "amdgcn-amd-amdhsa--gfx950"
.text
.globl interleave_layers__sliding_local_dilated__glu_gated_geglu__prompt_kernel
.p2align 8
.type interleave_layers__sliding_local_dilated__glu_gated_geglu__prompt_kernel,@function
interleave_layers__sliding_local_dilated__glu_gated_geglu__prompt_kernel:
    s_cmp_ge_u32 s2, 256
    s_cbranch_scc1 L_main_end
    s_load_dwordx2 s[4:5], s[0:1], 72
    s_load_dwordx4 s[16:19], s[0:1], 0
    s_load_dwordx2 s[22:23], s[0:1], 16
    s_load_dwordx8 s[24:31], s[0:1], 32
    v_lshrrev_b32 v1, 6, v0
    v_and_b32 v0, 63, v0
    v_readfirstlane_b32 s3, v1
    s_waitcnt lgkmcnt(0)
    s_mov_b32 s8, s4
    s_and_b32 s9, s5, 0xffff
    s_mov_b32 s10, 268435456
    s_mov_b32 s11, 0x20000
    s_mov_b32 s7, 19660800
    s_load_dword s76, s[4:5], s7
    s_mov_b64 s[20:21], s[18:19]
    s_mov_b64 s[18:19], s[16:17]
    s_mov_b32 s48, s4
    s_and_b32 s49, s5, 0xffff
    s_mov_b32 s50, 268435456
    s_mov_b32 s51, 0x20000
    s_and_b32 s40, s2, 3
    s_lshl_b32 s40, s40, 1
    s_bfe_u32 s7, s2, 65539
    s_add_u32 s40, s40, s7
    s_bfe_u32 s41, s2, 65538
    s_lshl_b32 s41, s41, 4
    s_lshr_b32 s7, s2, 4
    s_add_u32 s41, s41, s7
    s_mov_b32 s42, 0
    s_mov_b32 s43, 0
    s_lshl_b32 s44, s41, 10
    s_add_u32 s44, s44, 19169280
    v_lshlrev_b32 v253, 4, v0
    s_getpc_b64 s[96:97]
L_main_pc:
    s_sub_u32 s96, s96, L_main_pc-interleave_layers__sliding_local_dilated__glu_gated_geglu__prompt_kernel
    s_subb_u32 s97, s97, 0
    s_and_b32 s97, s97, 0xffff
    s_mov_b32 s98, L_main_code_end-interleave_layers__sliding_local_dilated__glu_gated_geglu__prompt_kernel
    s_mov_b32 s99, 0x20000
    s_lshr_b32 s7, s2, 3
    s_lshl_b32 s7, s7, 2
    s_add_u32 s7, s7, s3
    s_lshl_b32 s7, s7, 9
    v_lshrrev_b32 v1, 1, v253
    v_add_u32 v1, s7, v1
    buffer_load_dwordx2 v[2:3], v1, s[96:99], 0 offen
    s_mov_b32 s12, s18
    s_and_b32 s13, s19, 0xffff
    s_mov_b32 s14, 2359296
    s_mov_b32 s15, 0x20000
    s_mov_b32 s64, s20
    s_and_b32 s65, s21, 0xffff
    s_mov_b32 s66, 1990656
    s_mov_b32 s67, 0x20000
    s_mov_b32 s68, s22
    s_and_b32 s69, s23, 0xffff
    s_mov_b32 s70, 663552
    s_mov_b32 s71, 0x20000
    s_mov_b32 s16, 0xffff0000
    s_lshl_b32 s7, s3, 10
    v_add_u32 v172, s7, v253
    v_add_u32 v174, 5120, v172
    v_and_b32 v178, 7, v0
    v_mul_u32_u24 v178, 1152, v178
    v_lshrrev_b32 v179, 3, v0
    v_lshl_add_u32 v178, v179, 4, v178
    s_lshl_b32 s7, s3, 7
    v_add_u32 v175, s7, v178
    v_add_u32 v177, 640, v175
    s_cmp_eq_u32 s3, 0
    s_mov_b32 s17, 1073741824
    s_cmov_b32 s17, 4096
    v_add_u32 v173, s17, v172
    s_mov_b32 s17, 1073741824
    s_cmov_b32 s17, 512
    v_add_u32 v176, s17, v175
    s_lshl_b32 s21, s41, 3
    s_add_u32 s21, s21, s40
    s_mul_i32 s18, s21, 9216
    buffer_load_dwordx4 v[16:19], v175, s[12:15], s18 offen
    buffer_load_dwordx4 v[20:23], v176, s[12:15], s18 offen
    buffer_load_dwordx4 v[24:27], v177, s[12:15], s18 offen
    s_mov_b32 s12, s30
    s_and_b32 s13, s31, 0xffff
    s_mov_b32 s14, 2359296
    s_mov_b32 s15, 0x20000
    s_lshl_b32 s79, s3, 14
    s_add_u32 s79, s79, 98304
    s_sub_u32 s36, s21, 144
    s_cmp_ge_u32 s41, 18
    s_cbranch_scc1 L_prep_o_1
    s_mul_i32 s35, s41, 110592
    s_mul_i32 s7, s40, 144
    s_and_b32 s46, s7, 127
    s_sub_u32 s7, s7, s46
    s_add_u32 s35, s35, s7
    s_mul_i32 s7, s3, 13824
    s_add_u32 s35, s35, s7
    v_lshrrev_b32 v8, 4, v0
    v_mul_u32_u24 v8, 3456, v8
    v_and_b32 v9, 15, v0
    v_lshl_add_u32 v8, v9, 4, v8
    s_lshl_b32 s34, s3, 10
    s_add_u32 m0, s34, 8192
    s_add_u32 s7, s35, 0
    buffer_load_dwordx4 v8, s[64:67], s7 offen lds
    s_add_u32 m0, s34, 12288
    s_add_u32 s7, s35, 55296
    buffer_load_dwordx4 v8, s[64:67], s7 offen lds
    s_add_u32 m0, s34, 16384
    s_add_u32 s7, s35, 1152
    buffer_load_dwordx4 v8, s[64:67], s7 offen lds
    s_add_u32 m0, s34, 20480
    s_add_u32 s7, s35, 56448
    buffer_load_dwordx4 v8, s[64:67], s7 offen lds
    s_add_u32 m0, s34, 24576
    s_add_u32 s7, s35, 2304
    buffer_load_dwordx4 v8, s[64:67], s7 offen lds
    s_add_u32 m0, s34, 28672
    s_add_u32 s7, s35, 57600
    buffer_load_dwordx4 v8, s[64:67], s7 offen lds
    s_branch L_prep_go_3
L_prep_o_1:
    s_cmp_ge_u32 s36, 54
    s_cbranch_scc1 L_prep_m_2
    s_mul_i32 s33, s36, 349526
    s_lshr_b32 s33, s33, 20
    s_mul_i32 s34, s33, 3
    s_sub_u32 s34, s36, s34
    s_lshl_b32 s7, s33, 2
    s_add_u32 s7, s7, s3
    v_mov_b32 v8, s7
    v_lshrrev_b32 v9, 3, v0
    v_mul_u32_u24 v11, 7282, v8
    v_lshrrev_b32 v11, 16, v11
    v_mul_u32_u24 v12, 9, v11
    v_sub_u32 v12, v8, v12
    v_mul_u32_u24 v11, 72, v11
    v_cmp_eq_u32 vcc, 8, v12
    v_lshrrev_b32 v10, 1, v12
    v_mad_u32_u24 v10, v10, 18, v11
    v_and_b32 v12, 1, v12
    v_lshl_add_u32 v10, v12, 3, v10
    v_add_u32 v10, v10, v9
    v_lshrrev_b32 v12, 1, v9
    v_mad_u32_u24 v11, v12, 18, v11
    v_and_b32 v12, 1, v9
    v_add3_u32 v11, v11, v12, 16
    v_cndmask_b32 v10, v10, v11, vcc
    v_mul_u32_u24 v10, 1152, v10
    v_and_b32 v9, 7, v0
    v_lshl_add_u32 v10, v9, 4, v10
    s_mul_i32 s35, s34, 384
    s_lshl_b32 s6, s3, 10
    s_add_u32 m0, s6, 8192
    s_add_u32 s7, s35, 0
    buffer_load_dwordx4 v10, s[68:71], s7 offen lds
    s_add_u32 m0, s6, 12288
    s_add_u32 s7, s35, 128
    buffer_load_dwordx4 v10, s[68:71], s7 offen lds
    s_add_u32 m0, s6, 16384
    s_add_u32 s7, s35, 256
    buffer_load_dwordx4 v10, s[68:71], s7 offen lds
    s_branch L_prep_go_3
L_prep_m_2:
    s_sub_u32 s37, s36, 54
    s_lshl_b32 s7, s3, 6
    s_add_u32 s37, s37, s7
    s_cmp_ge_u32 s37, 36
    s_cbranch_scc1 L_prep_go_3
    s_lshl_b32 s7, s37, 1
    v_bfe_u32 v8, v0, 3, 1
    v_add_u32 v8, s7, v8
    v_and_b32 v9, 7, v0
    v_mul_u32_u24 v11, 7282, v8
    v_lshrrev_b32 v11, 16, v11
    v_mul_u32_u24 v12, 9, v11
    v_sub_u32 v12, v8, v12
    v_mul_u32_u24 v11, 72, v11
    v_cmp_eq_u32 vcc, 8, v12
    v_lshrrev_b32 v10, 1, v12
    v_mad_u32_u24 v10, v10, 18, v11
    v_and_b32 v12, 1, v12
    v_lshl_add_u32 v10, v12, 3, v10
    v_add_u32 v10, v10, v9
    v_lshrrev_b32 v12, 1, v9
    v_mad_u32_u24 v11, v12, 18, v11
    v_and_b32 v12, 1, v9
    v_add3_u32 v11, v11, v12, 16
    v_cndmask_b32 v10, v10, v11, vcc
    v_mul_u32_u24 v10, 1152, v10
    v_lshrrev_b32 v9, 4, v0
    v_lshl_add_u32 v10, v9, 4, v10
    buffer_load_dwordx4 v[64:67], v10, s[68:71], 0 offen offset:0
    buffer_load_dwordx4 v[68:71], v10, s[68:71], 0 offen offset:64
    buffer_load_dwordx4 v[72:75], v10, s[68:71], 0 offen offset:128
    buffer_load_dwordx4 v[76:79], v10, s[68:71], 0 offen offset:192
    buffer_load_dwordx4 v[80:83], v10, s[68:71], 0 offen offset:256
    buffer_load_dwordx4 v[84:87], v10, s[68:71], 0 offen offset:320
    buffer_load_dwordx4 v[88:91], v10, s[68:71], 0 offen offset:384
    buffer_load_dwordx4 v[92:95], v10, s[68:71], 0 offen offset:448
    buffer_load_dwordx4 v[96:99], v10, s[68:71], 0 offen offset:512
    buffer_load_dwordx4 v[100:103], v10, s[68:71], 0 offen offset:576
    buffer_load_dwordx4 v[104:107], v10, s[68:71], 0 offen offset:640
    buffer_load_dwordx4 v[108:111], v10, s[68:71], 0 offen offset:704
    buffer_load_dwordx4 v[112:115], v10, s[68:71], 0 offen offset:768
    buffer_load_dwordx4 v[116:119], v10, s[68:71], 0 offen offset:832
    buffer_load_dwordx4 v[120:123], v10, s[68:71], 0 offen offset:896
    buffer_load_dwordx4 v[124:127], v10, s[68:71], 0 offen offset:960
    buffer_load_dwordx4 v[128:131], v10, s[68:71], 0 offen offset:1024
    buffer_load_dwordx4 v[132:135], v10, s[68:71], 0 offen offset:1088
L_prep_go_3:
    s_lshl_b32 s7, s41, 2
    s_add_u32 s7, s7, s3
    s_mul_i32 s93, s7, 25576
    s_lshr_b32 s93, s93, 20
    s_min_u32 s93, s93, 2
    s_mul_i32 s6, s93, 41
    s_sub_u32 s7, s7, s6
    s_lshl_b32 s17, s7, 2
    s_cmp_eq_u32 s93, 1
    s_cselect_b32 s72, s26, s24
    s_cselect_b32 s73, s27, s25
    s_cmp_eq_u32 s93, 2
    s_cselect_b32 s72, s28, s72
    s_cselect_b32 s73, s29, s73
    s_mov_b32 s92, 73728
    s_cmov_b32 s92, 9216
    s_mov_b32 s47, 1152
    s_cmov_b32 s47, 663552
    s_and_b32 s73, s73, 0xffff
    s_mov_b32 s74, 5308416
    s_mov_b32 s75, 0x20000
    s_mul_i32 s47, s47, s40
    s_add_u32 s7, s17, 0
    s_min_u32 s7, s7, 161
    s_mul_i32 s84, s7, 116509
    s_lshr_b32 s84, s84, 20
    s_mul_i32 s88, s84, 9
    s_sub_u32 s88, s7, s88
    s_mul_i32 s7, s84, s92
    s_lshl_b32 s7, s7, 2
    s_add_u32 s7, s7, s47
    s_lshl_b32 s6, s88, 7
    s_add_u32 s80, s7, s6
    s_add_u32 s7, s17, 1
    s_min_u32 s7, s7, 161
    s_mul_i32 s85, s7, 116509
    s_lshr_b32 s85, s85, 20
    s_mul_i32 s89, s85, 9
    s_sub_u32 s89, s7, s89
    s_mul_i32 s7, s85, s92
    s_lshl_b32 s7, s7, 2
    s_add_u32 s7, s7, s47
    s_lshl_b32 s6, s89, 7
    s_add_u32 s81, s7, s6
    s_add_u32 s7, s17, 2
    s_min_u32 s7, s7, 161
    s_mul_i32 s86, s7, 116509
    s_lshr_b32 s86, s86, 20
    s_mul_i32 s90, s86, 9
    s_sub_u32 s90, s7, s90
    s_mul_i32 s7, s86, s92
    s_lshl_b32 s7, s7, 2
    s_add_u32 s7, s7, s47
    s_lshl_b32 s6, s90, 7
    s_add_u32 s82, s7, s6
    s_add_u32 s7, s17, 3
    s_min_u32 s7, s7, 161
    s_mul_i32 s87, s7, 116509
    s_lshr_b32 s87, s87, 20
    s_mul_i32 s91, s87, 9
    s_sub_u32 s91, s7, s91
    s_mul_i32 s7, s87, s92
    s_lshl_b32 s7, s7, 2
    s_add_u32 s7, s7, s47
    s_lshl_b32 s6, s91, 7
    s_add_u32 s83, s7, s6
    s_lshr_b32 s7, s92, 3
    v_lshrrev_b32 v224, 3, v0
    v_mul_lo_u32 v224, v224, s7
    v_and_b32 v8, 7, v0
    v_lshl_add_u32 v224, v8, 4, v224
    s_waitcnt lgkmcnt(0)
    s_mul_i32 s76, s76, 0x9e3779b1
    s_add_u32 s76, s76, 0x7f4a7c15
    s_mov_b32 s77, s76
    s_add_u32 m0, s79, 0
    s_mov_b32 s71, s80
    buffer_load_dwordx4 v224, s[72:75], s71 offen nt lds
    s_add_u32 m0, s79, 1024
    s_add_u32 s71, s71, s92
    buffer_load_dwordx4 v224, s[72:75], s71 offen nt lds
    s_add_u32 m0, s79, 2048
    s_add_u32 s71, s71, s92
    buffer_load_dwordx4 v224, s[72:75], s71 offen nt lds
    s_waitcnt vmcnt(3)
    s_barrier
    s_cmp_ge_u32 s41, 18
    s_cbranch_scc1 L_prep_o_4
    s_mul_i32 s7, s3, 36
    s_add_u32 s7, s7, s46
    v_lshrrev_b32 v8, 4, v0
    v_lshlrev_b32 v8, 11, v8
    v_add_u32 v8, s7, v8
    v_and_b32 v9, 15, v0
    v_cmp_gt_u32 s[22:23], 6, v9
    v_lshrrev_b32 v10, 1, v9
    v_min_u32 v10, 2, v10
    v_lshl_add_u32 v10, v10, 13, v8
    v_and_b32 v11, 1, v0
    v_lshl_add_u32 v10, v11, 1, v10
    v_lshl_add_u32 v8, v9, 1, v8
    ds_read_u16 v136, v8 offset:8192
    ds_read_u16 v137, v8 offset:8448
    ds_read_u16 v138, v8 offset:8704
    ds_read_u16 v139, v8 offset:8960
    ds_read_u16 v140, v8 offset:9216
    ds_read_u16 v141, v8 offset:9472
    ds_read_u16 v142, v8 offset:9728
    ds_read_u16 v143, v8 offset:9984
    s_lshl_b32 s33, s40, 2
    s_add_u32 s33, s33, s3
    s_mul_i32 s33, s33, 18
    s_add_u32 s33, s33, s41
    s_lshl_b32 s33, s33, 12
    ds_read_u16 v144, v8 offset:16384
    ds_read_u16 v145, v8 offset:16640
    ds_read_u16 v146, v8 offset:16896
    ds_read_u16 v147, v8 offset:17152
    ds_read_u16 v148, v8 offset:17408
    ds_read_u16 v149, v8 offset:17664
    ds_read_u16 v150, v8 offset:17920
    ds_read_u16 v151, v8 offset:18176
    s_waitcnt lgkmcnt(8)
    v_lshl_or_b32 v32, v137, 16, v136
    v_lshl_or_b32 v33, v139, 16, v138
    v_lshl_or_b32 v34, v141, 16, v140
    v_lshl_or_b32 v35, v143, 16, v142
    buffer_store_dwordx4 v[32:35], v253, s[8:11], s33 offen offset:0 sc1
    ds_read_u16 v152, v8 offset:24576
    ds_read_u16 v153, v8 offset:24832
    ds_read_u16 v154, v8 offset:25088
    ds_read_u16 v155, v8 offset:25344
    ds_read_u16 v156, v8 offset:25600
    ds_read_u16 v157, v8 offset:25856
    ds_read_u16 v158, v8 offset:26112
    ds_read_u16 v159, v8 offset:26368
    s_waitcnt lgkmcnt(8)
    v_lshl_or_b32 v36, v145, 16, v144
    v_lshl_or_b32 v37, v147, 16, v146
    v_lshl_or_b32 v38, v149, 16, v148
    v_lshl_or_b32 v39, v151, 16, v150
    buffer_store_dwordx4 v[36:39], v253, s[8:11], s33 offen offset:1024 sc1
    ds_read_u16 v160, v10 offset:8224
    ds_read_u16 v161, v10 offset:8480
    ds_read_u16 v162, v10 offset:8736
    ds_read_u16 v163, v10 offset:8992
    ds_read_u16 v164, v10 offset:9248
    ds_read_u16 v165, v10 offset:9504
    ds_read_u16 v166, v10 offset:9760
    ds_read_u16 v167, v10 offset:10016
    s_waitcnt lgkmcnt(8)
    v_lshl_or_b32 v40, v153, 16, v152
    v_lshl_or_b32 v41, v155, 16, v154
    v_lshl_or_b32 v42, v157, 16, v156
    v_lshl_or_b32 v43, v159, 16, v158
    buffer_store_dwordx4 v[40:43], v253, s[8:11], s33 offen offset:2048 sc1
    s_waitcnt lgkmcnt(0)
    v_lshl_or_b32 v44, v161, 16, v160
    v_cndmask_b32 v44, 0, v44, s[22:23]
    v_lshl_or_b32 v45, v163, 16, v162
    v_cndmask_b32 v45, 0, v45, s[22:23]
    v_lshl_or_b32 v46, v165, 16, v164
    v_cndmask_b32 v46, 0, v46, s[22:23]
    v_lshl_or_b32 v47, v167, 16, v166
    v_cndmask_b32 v47, 0, v47, s[22:23]
    buffer_store_dwordx4 v[44:47], v253, s[8:11], s33 offen offset:3072 sc1
    s_branch L_prep_done_6
L_prep_o_4:
    s_cmp_ge_u32 s36, 54
    s_cbranch_scc1 L_prep_m_5
    v_lshrrev_b32 v8, 4, v0
    v_lshlrev_b32 v8, 3, v8
    v_bfe_u32 v9, v0, 2, 2
    v_add_u32 v8, v8, v9
    v_mul_u32_u24 v8, 128, v8
    v_and_b32 v9, 3, v0
    v_lshl_add_u32 v8, v9, 3, v8
    s_lshl_b32 s7, s3, 5
    v_add_u32 v8, s7, v8
    ds_read_b64_tr_b16 v[32:33], v8 offset:8192
    ds_read_b64_tr_b16 v[34:35], v8 offset:8704
    ds_read_b64_tr_b16 v[36:37], v8 offset:12288
    ds_read_b64_tr_b16 v[38:39], v8 offset:12800
    ds_read_b64_tr_b16 v[40:41], v8 offset:16384
    ds_read_b64_tr_b16 v[42:43], v8 offset:16896
    s_mul_i32 s34, s34, 12
    s_add_u32 s34, s34, s3
    s_mul_i32 s34, s34, 18
    s_add_u32 s34, s34, s33
    s_lshl_b32 s34, s34, 10
    s_add_u32 s7, s34, 2359296
    s_waitcnt lgkmcnt(4)
    buffer_store_dwordx4 v[32:35], v253, s[8:11], s7 offen sc1
    s_add_u32 s7, s34, 2433024
    s_waitcnt lgkmcnt(2)
    buffer_store_dwordx4 v[36:39], v253, s[8:11], s7 offen sc1
    s_add_u32 s7, s34, 2506752
    s_waitcnt lgkmcnt(0)
    buffer_store_dwordx4 v[40:43], v253, s[8:11], s7 offen sc1
    s_branch L_prep_done_6
L_prep_m_5:
    s_cmp_ge_u32 s37, 36
    s_cbranch_scc1 L_prep_done_6
    v_mov_b32 v28, 0x3f803f80
    v_mov_b32 v29, 0x3f803f80
    v_mov_b32 v30, 0x3f803f80
    v_mov_b32 v31, 0x3f803f80
    v_and_b32 v9, 15, v0
    v_cmp_eq_u32 vcc, 0, v9
    v_cmp_eq_u32 s[22:23], 1, v9
    v_mfma_f32_16x16x32_bf16 v[32:35], v[64:67], v[28:31], 0
    v_mfma_f32_16x16x32_bf16 v[32:35], v[68:71], v[28:31], v[32:35]
    v_mfma_f32_16x16x32_bf16 v[32:35], v[72:75], v[28:31], v[32:35]
    v_mfma_f32_16x16x32_bf16 v[32:35], v[76:79], v[28:31], v[32:35]
    v_mfma_f32_16x16x32_bf16 v[32:35], v[80:83], v[28:31], v[32:35]
    v_mfma_f32_16x16x32_bf16 v[32:35], v[84:87], v[28:31], v[32:35]
    v_mfma_f32_16x16x32_bf16 v[32:35], v[88:91], v[28:31], v[32:35]
    v_mfma_f32_16x16x32_bf16 v[32:35], v[92:95], v[28:31], v[32:35]
    v_mfma_f32_16x16x32_bf16 v[32:35], v[96:99], v[28:31], v[32:35]
    v_mfma_f32_16x16x32_bf16 v[32:35], v[100:103], v[28:31], v[32:35]
    v_mfma_f32_16x16x32_bf16 v[32:35], v[104:107], v[28:31], v[32:35]
    v_mfma_f32_16x16x32_bf16 v[32:35], v[108:111], v[28:31], v[32:35]
    v_mfma_f32_16x16x32_bf16 v[32:35], v[112:115], v[28:31], v[32:35]
    v_mfma_f32_16x16x32_bf16 v[32:35], v[116:119], v[28:31], v[32:35]
    v_mfma_f32_16x16x32_bf16 v[32:35], v[120:123], v[28:31], v[32:35]
    v_mfma_f32_16x16x32_bf16 v[32:35], v[124:127], v[28:31], v[32:35]
    v_mfma_f32_16x16x32_bf16 v[32:35], v[128:131], v[28:31], v[32:35]
    v_mfma_f32_16x16x32_bf16 v[32:35], v[132:135], v[28:31], v[32:35]
    v_lshrrev_b32 v10, 5, v0
    v_lshlrev_b32 v10, 8, v10
    v_lshl_add_u32 v10, v9, 4, v10
    v_bfe_u32 v9, v0, 4, 1
    v_lshl_add_u32 v10, v9, 3, v10
    s_lshl_b32 s7, s37, 9
    s_add_u32 s7, s7, 3022848
    s_nop 0
    v_mul_f32 v32, 0x3ae38e39, v32
    v_mul_f32 v33, 0x3ae38e39, v33
    v_mul_f32 v34, 0x3ae38e39, v34
    v_mul_f32 v35, 0x3ae38e39, v35
    v_cvt_pk_bf16_f32 v36, v32, v33
    v_cvt_pk_bf16_f32 v37, v34, v35
    v_lshlrev_b32 v38, 16, v36
    v_and_b32 v39, s16, v36
    v_sub_f32 v38, v32, v38
    v_sub_f32 v39, v33, v39
    v_cvt_pk_bf16_f32 v28, v38, v39
    v_cndmask_b32 v28, 0, v28, s[22:23]
    v_cndmask_b32 v28, v28, v36, vcc
    v_lshlrev_b32 v38, 16, v37
    v_and_b32 v39, s16, v37
    v_sub_f32 v38, v34, v38
    v_sub_f32 v39, v35, v39
    v_cvt_pk_bf16_f32 v29, v38, v39
    v_cndmask_b32 v29, 0, v29, s[22:23]
    v_cndmask_b32 v29, v29, v37, vcc
    buffer_store_dwordx2 v[28:29], v10, s[8:11], s7 offen sc1
L_prep_done_6:
    s_add_u32 s19, s18, 43515904
    s_add_u32 s20, s18, 38797312
    s_lshl_b32 s22, s21, 7
    s_add_u32 s22, s22, 48234496
    buffer_store_dwordx4 v[16:19], v172, s[8:11], s19 offen sc1
    buffer_store_dwordx4 v[20:23], v173, s[8:11], s19 offen sc1
    buffer_store_dwordx4 v[24:27], v174, s[8:11], s19 offen sc1
    s_mov_b32 s17, 0x3f803f80
    v_mov_b32 v8, 0
    v_mov_b32 v9, 0
    v_mov_b32 v10, 0
    v_mov_b32 v11, 0
    v_dot2c_f32_bf16 v8, s17, v16
    v_dot2c_f32_bf16 v9, v16, v16
    v_dot2c_f32_bf16 v10, s17, v17
    v_dot2c_f32_bf16 v11, v17, v17
    v_dot2c_f32_bf16 v8, s17, v18
    v_dot2c_f32_bf16 v9, v18, v18
    v_dot2c_f32_bf16 v10, s17, v19
    v_dot2c_f32_bf16 v11, v19, v19
    v_dot2c_f32_bf16 v8, s17, v20
    v_dot2c_f32_bf16 v9, v20, v20
    v_dot2c_f32_bf16 v10, s17, v21
    v_dot2c_f32_bf16 v11, v21, v21
    v_dot2c_f32_bf16 v8, s17, v22
    v_dot2c_f32_bf16 v9, v22, v22
    v_dot2c_f32_bf16 v10, s17, v23
    v_dot2c_f32_bf16 v11, v23, v23
    v_dot2c_f32_bf16 v8, s17, v24
    v_dot2c_f32_bf16 v9, v24, v24
    v_dot2c_f32_bf16 v10, s17, v25
    v_dot2c_f32_bf16 v11, v25, v25
    v_dot2c_f32_bf16 v8, s17, v26
    v_dot2c_f32_bf16 v9, v26, v26
    v_dot2c_f32_bf16 v10, s17, v27
    v_dot2c_f32_bf16 v11, v27, v27
    v_and_b32 v12, 7, v0
    v_lshlrev_b32 v12, 3, v12
    s_lshl_b32 s7, s3, 6
    v_add_u32 v13, s7, v12
    v_pk_add_f32 v[8:9], v[8:9], v[10:11]
    s_nop 1
    v_add_f32_dpp v8, v8, v8 row_ror:8 row_mask:0xf bank_mask:0xf
    v_add_f32_dpp v9, v9, v9 row_ror:8 row_mask:0xf bank_mask:0xf
    v_mov_b32 v10, v8
    v_mov_b32 v11, v9
    s_nop 1
    v_permlane32_swap_b32 v10, v8
    v_permlane32_swap_b32 v11, v9
    v_add_f32 v8, v8, v10
    v_add_f32 v9, v9, v11
    v_mov_b32 v10, v8
    v_mov_b32 v11, v9
    s_nop 1
    v_permlane16_swap_b32 v10, v8
    v_permlane16_swap_b32 v11, v9
    v_add_f32 v8, v8, v10
    v_add_f32 v9, v9, v11
    ds_write_b64 v13, v[8:9]
    s_waitcnt lgkmcnt(0)
    s_barrier
    ds_read_b64 v[40:41], v12 offset:0
    ds_read_b64 v[42:43], v12 offset:64
    ds_read_b64 v[44:45], v12 offset:128
    ds_read_b64 v[46:47], v12 offset:192
    s_waitcnt lgkmcnt(0)
    v_pk_add_f32 v[40:41], v[40:41], v[42:43]
    v_pk_add_f32 v[44:45], v[44:45], v[46:47]
    v_pk_add_f32 v[8:9], v[40:41], v[44:45]
    v_mul_f32 v8, 0x3ae38e39, v8
    v_mul_f32 v9, 0x3ae38e39, v9
    v_fma_f32 v9, -v8, v8, v9
    v_max_f32 v9, 0, v9
    v_add_f32 v9, 0x3727c5ac, v9
    v_rsq_f32 v10, v9
    s_nop 0
    v_mul_f32 v12, v8, v10
    v_mov_b32 v11, v10
    v_sub_f32 v12, 0, v12
    v_mov_b32 v13, v12
    s_cmp_eq_u32 s3, 0
    s_cselect_b32 s7, 32, 0
    v_lshlrev_b32 v14, 2, v0
    v_cmp_gt_u32 vcc, s7, v0
    v_mov_b32 v9, 1073741824
    s_nop 0
    v_cndmask_b32 v14, v9, v14, vcc
    buffer_store_dword v8, v14, s[8:11], s22 offen sc1
    v_lshlrev_b32 v40, 16, v16
    v_and_b32 v41, s16, v16
    v_lshlrev_b32 v42, 16, v17
    v_and_b32 v43, s16, v17
    v_lshlrev_b32 v44, 16, v18
    v_and_b32 v45, s16, v18
    v_lshlrev_b32 v46, 16, v19
    v_and_b32 v47, s16, v19
    v_pk_fma_f32 v[40:41], v[40:41], v[10:11], v[12:13]
    v_pk_fma_f32 v[42:43], v[42:43], v[10:11], v[12:13]
    v_pk_fma_f32 v[44:45], v[44:45], v[10:11], v[12:13]
    v_pk_fma_f32 v[46:47], v[46:47], v[10:11], v[12:13]
    v_cvt_pk_bf16_f32 v48, v40, v41
    v_cvt_pk_bf16_f32 v49, v42, v43
    v_cvt_pk_bf16_f32 v50, v44, v45
    v_cvt_pk_bf16_f32 v51, v46, v47
    v_lshlrev_b32 v40, 16, v20
    v_and_b32 v41, s16, v20
    v_lshlrev_b32 v42, 16, v21
    v_and_b32 v43, s16, v21
    v_lshlrev_b32 v44, 16, v22
    v_and_b32 v45, s16, v22
    v_lshlrev_b32 v46, 16, v23
    v_and_b32 v47, s16, v23
    v_pk_fma_f32 v[40:41], v[40:41], v[10:11], v[12:13]
    v_pk_fma_f32 v[42:43], v[42:43], v[10:11], v[12:13]
    v_pk_fma_f32 v[44:45], v[44:45], v[10:11], v[12:13]
    v_pk_fma_f32 v[46:47], v[46:47], v[10:11], v[12:13]
    v_cvt_pk_bf16_f32 v52, v40, v41
    v_cvt_pk_bf16_f32 v53, v42, v43
    v_cvt_pk_bf16_f32 v54, v44, v45
    v_cvt_pk_bf16_f32 v55, v46, v47
    v_lshlrev_b32 v40, 16, v24
    v_and_b32 v41, s16, v24
    v_lshlrev_b32 v42, 16, v25
    v_and_b32 v43, s16, v25
    v_lshlrev_b32 v44, 16, v26
    v_and_b32 v45, s16, v26
    v_lshlrev_b32 v46, 16, v27
    v_and_b32 v47, s16, v27
    v_pk_fma_f32 v[40:41], v[40:41], v[10:11], v[12:13]
    v_pk_fma_f32 v[42:43], v[42:43], v[10:11], v[12:13]
    v_pk_fma_f32 v[44:45], v[44:45], v[10:11], v[12:13]
    v_pk_fma_f32 v[46:47], v[46:47], v[10:11], v[12:13]
    v_cvt_pk_bf16_f32 v56, v40, v41
    v_cvt_pk_bf16_f32 v57, v42, v43
    v_cvt_pk_bf16_f32 v58, v44, v45
    v_cvt_pk_bf16_f32 v59, v46, v47
    buffer_store_dwordx4 v[48:51], v172, s[8:11], s20 offen sc1
    buffer_store_dwordx4 v[52:55], v173, s[8:11], s20 offen sc1
    buffer_store_dwordx4 v[56:59], v174, s[8:11], s20 offen sc1
    v_lshlrev_b32 v15, 7, v0
    s_lshl_b32 s6, s40, 2
    s_add_u32 s6, s6, s44
    s_sub_u32 s6, s6, 32768
    v_mov_b32 v1, s76
    s_mov_b64 vcc, 0xff
    v_lshrrev_b32 v14, 3, v0
    v_lshl_add_u32 v15, v14, 3, v15
    s_cmp_ge_u32 s40, 6
    s_cselect_b32 s7, s41, 31
    s_cmp_lt_u32 s7, 31
    s_cmov_b64 vcc, 0xffff
    s_waitcnt vmcnt(0)
    s_barrier
    s_cmp_lg_u32 s3, 0
    s_cbranch_scc1 L_pub_7
    s_mov_b64 exec, vcc
    buffer_store_dword v1, v15, s[8:11], s6 offen sc1
    v_lshlrev_b32 v15, 10, v0
    s_lshl_b32 s6, s40, 7
    s_lshl_b32 s7, s41, 2
    s_add_u32 s6, s6, s7
    s_add_u32 s6, s6, 19431424
    s_mov_b64 exec, 0xffffffff
    v_lshlrev_b32 v15, 10, v0
    v_mov_b32 v1, s76
    buffer_store_dword v1, v15, s[8:11], s6 offen sc1
    s_cmp_lt_u32 s41, 18
    s_cbranch_scc1 L_pub_7
    s_lshl_b32 s6, s36, 2
    s_add_u32 s6, s6, 19496960
    s_mov_b64 exec, 1
    buffer_store_dword v1, off, s[8:11], s6 sc1
L_pub_7:
    s_mov_b64 exec, -1
    s_add_u32 m0, s79, 3072
    s_add_u32 s71, s71, s92
    buffer_load_dwordx4 v224, s[72:75], s71 offen nt lds
    s_add_u32 m0, s79, 4096
    s_mov_b32 s71, s81
    buffer_load_dwordx4 v224, s[72:75], s71 offen nt lds
    s_add_u32 m0, s79, 5120
    s_add_u32 s71, s71, s92
    buffer_load_dwordx4 v224, s[72:75], s71 offen nt lds
    s_add_u32 m0, s79, 6144
    s_add_u32 s71, s71, s92
    buffer_load_dwordx4 v224, s[72:75], s71 offen nt lds
    s_add_u32 m0, s79, 7168
    s_add_u32 s71, s71, s92
    buffer_load_dwordx4 v224, s[72:75], s71 offen nt lds
    s_add_u32 m0, s79, 8192
    s_mov_b32 s71, s82
    buffer_load_dwordx4 v224, s[72:75], s71 offen nt lds
    s_add_u32 m0, s79, 9216
    s_add_u32 s71, s71, s92
    buffer_load_dwordx4 v224, s[72:75], s71 offen nt lds
    s_add_u32 m0, s79, 10240
    s_add_u32 s71, s71, s92
    buffer_load_dwordx4 v224, s[72:75], s71 offen nt lds
    s_add_u32 m0, s79, 11264
    s_add_u32 s71, s71, s92
    buffer_load_dwordx4 v224, s[72:75], s71 offen nt lds
    s_add_u32 m0, s79, 12288
    s_mov_b32 s71, s83
    buffer_load_dwordx4 v224, s[72:75], s71 offen nt lds
    s_add_u32 m0, s79, 13312
    s_add_u32 s71, s71, s92
    buffer_load_dwordx4 v224, s[72:75], s71 offen nt lds
    s_add_u32 m0, s79, 14336
    s_add_u32 s71, s71, s92
    buffer_load_dwordx4 v224, s[72:75], s71 offen nt lds
    s_add_u32 m0, s79, 15360
    s_add_u32 s71, s71, s92
    buffer_load_dwordx4 v224, s[72:75], s71 offen nt lds
    s_cmp_lg_u32 s3, 0
    s_cbranch_scc1 L_wq_ready_8
    s_lshl_b32 s7, s41, 3
    s_add_u32 s7, s7, s40
    s_lshl_b32 s7, s7, 7
    s_add_u32 s7, s7, 19431424
    s_add_u32 s68, s4, s7
    s_addc_u32 s69, s5, 0
    s_mov_b32 s6, 0
    s_mov_b32 s7, 0
L_cpoll_9:
    s_load_dwordx16 s[52:67], s[68:69], s7 glc
    s_add_u32 s6, s6, 1
    s_waitcnt lgkmcnt(0)
    s_xor_b64 s[52:53], s[52:53], s[76:77]
    s_xor_b64 s[54:55], s[54:55], s[76:77]
    s_xor_b64 s[56:57], s[56:57], s[76:77]
    s_xor_b64 s[58:59], s[58:59], s[76:77]
    s_xor_b64 s[60:61], s[60:61], s[76:77]
    s_xor_b64 s[62:63], s[62:63], s[76:77]
    s_xor_b64 s[64:65], s[64:65], s[76:77]
    s_xor_b64 s[66:67], s[66:67], s[76:77]
    s_or_b64 s[52:53], s[52:53], s[60:61]
    s_or_b64 s[54:55], s[54:55], s[62:63]
    s_or_b64 s[56:57], s[56:57], s[64:65]
    s_or_b64 s[58:59], s[58:59], s[66:67]
    s_or_b64 s[52:53], s[52:53], s[56:57]
    s_or_b64 s[54:55], s[54:55], s[58:59]
    s_or_b64 s[52:53], s[52:53], s[54:55]
    s_cbranch_scc1 L_cpoll_10
    s_add_u32 s7, s7, 64
    s_cmp_eq_u32 s7, 128
    s_cbranch_scc1 L_cpolled_11
L_cpoll_10:
    s_cmp_lt_u32 s6, 1048576
    s_cbranch_scc1 L_cpoll_9
    s_branch L_main_end
L_cpolled_11:
L_wq_ready_8:
    s_barrier
    s_lshl_b32 s28, s40, 2
    s_add_u32 s28, s28, s3
    s_mul_i32 s28, s28, 73728
    buffer_load_dwordx4 a[0:3], v253, s[8:11], s28 offen offset:0 sc1
    buffer_load_dwordx4 a[4:7], v253, s[8:11], s28 offen offset:1024 sc1
    buffer_load_dwordx4 a[8:11], v253, s[8:11], s28 offen offset:2048 sc1
    buffer_load_dwordx4 a[12:15], v253, s[8:11], s28 offen offset:3072 sc1
    s_add_u32 s28, s28, 4096
    buffer_load_dwordx4 a[16:19], v253, s[8:11], s28 offen offset:0 sc1
    buffer_load_dwordx4 a[20:23], v253, s[8:11], s28 offen offset:1024 sc1
    buffer_load_dwordx4 a[24:27], v253, s[8:11], s28 offen offset:2048 sc1
    buffer_load_dwordx4 a[28:31], v253, s[8:11], s28 offen offset:3072 sc1
    s_add_u32 s28, s28, 4096
    buffer_load_dwordx4 a[32:35], v253, s[8:11], s28 offen offset:0 sc1
    buffer_load_dwordx4 a[36:39], v253, s[8:11], s28 offen offset:1024 sc1
    buffer_load_dwordx4 a[40:43], v253, s[8:11], s28 offen offset:2048 sc1
    buffer_load_dwordx4 a[44:47], v253, s[8:11], s28 offen offset:3072 sc1
    s_add_u32 s28, s28, 4096
    buffer_load_dwordx4 a[48:51], v253, s[8:11], s28 offen offset:0 sc1
    buffer_load_dwordx4 a[52:55], v253, s[8:11], s28 offen offset:1024 sc1
    buffer_load_dwordx4 a[56:59], v253, s[8:11], s28 offen offset:2048 sc1
    buffer_load_dwordx4 a[60:63], v253, s[8:11], s28 offen offset:3072 sc1
    s_add_u32 s28, s28, 4096
    buffer_load_dwordx4 a[64:67], v253, s[8:11], s28 offen offset:0 sc1
    buffer_load_dwordx4 a[68:71], v253, s[8:11], s28 offen offset:1024 sc1
    buffer_load_dwordx4 a[72:75], v253, s[8:11], s28 offen offset:2048 sc1
    buffer_load_dwordx4 a[76:79], v253, s[8:11], s28 offen offset:3072 sc1
    s_add_u32 s28, s28, 4096
    buffer_load_dwordx4 a[80:83], v253, s[8:11], s28 offen offset:0 sc1
    buffer_load_dwordx4 a[84:87], v253, s[8:11], s28 offen offset:1024 sc1
    buffer_load_dwordx4 a[88:91], v253, s[8:11], s28 offen offset:2048 sc1
    buffer_load_dwordx4 a[92:95], v253, s[8:11], s28 offen offset:3072 sc1
    s_add_u32 s28, s28, 4096
    buffer_load_dwordx4 a[96:99], v253, s[8:11], s28 offen offset:0 sc1
    buffer_load_dwordx4 a[100:103], v253, s[8:11], s28 offen offset:1024 sc1
    buffer_load_dwordx4 a[104:107], v253, s[8:11], s28 offen offset:2048 sc1
    buffer_load_dwordx4 a[108:111], v253, s[8:11], s28 offen offset:3072 sc1
    s_add_u32 s28, s28, 4096
    buffer_load_dwordx4 a[112:115], v253, s[8:11], s28 offen offset:0 sc1
    buffer_load_dwordx4 a[116:119], v253, s[8:11], s28 offen offset:1024 sc1
    buffer_load_dwordx4 a[120:123], v253, s[8:11], s28 offen offset:2048 sc1
    buffer_load_dwordx4 a[124:127], v253, s[8:11], s28 offen offset:3072 sc1
    s_add_u32 s28, s28, 4096
    buffer_load_dwordx4 a[128:131], v253, s[8:11], s28 offen offset:0 sc1
    buffer_load_dwordx4 a[132:135], v253, s[8:11], s28 offen offset:1024 sc1
    buffer_load_dwordx4 a[136:139], v253, s[8:11], s28 offen offset:2048 sc1
    buffer_load_dwordx4 a[140:143], v253, s[8:11], s28 offen offset:3072 sc1
    s_add_u32 s28, s28, 4096
L_main_layer:
    v_bfe_u32 v3, v0, 3, 1
    v_mul_u32_u24 v2, 9216, v3
    v_lshrrev_b32 v3, 4, v0
    v_lshl_add_u32 v2, v3, 7, v2
    v_and_b32 v3, 7, v0
    v_lshl_add_u32 v2, v3, 4, v2
    v_bfe_u32 v3, v0, 3, 2
    s_mov_b32 s7, 9216
    v_mul_lo_u32 v9, v3, s7
    v_lshrrev_b32 v3, 5, v0
    v_lshl_add_u32 v9, v3, 7, v9
    v_and_b32 v3, 7, v0
    v_lshl_add_u32 v9, v3, 4, v9
    s_mul_i32 s22, s41, 73728
    s_add_u32 s22, s22, s43
    s_add_u32 s23, s22, 38797312
    s_mul_i32 s7, s3, 18432
    s_add_u32 s24, s23, s7
    s_cmp_eq_u32 s41, 0
    s_cselect_b32 s7, 0, 18432
    s_sub_u32 s23, s23, s7
    s_lshl_b32 s25, s3, 10
    s_add_u32 s25, s25, 1024
    s_mul_i32 s26, s3, 5120
    s_lshl_b32 s7, s3, 9
    s_add_u32 s27, s23, s7
    s_and_b32 s7, s3, 1
    s_add_u32 s7, s7, 4
    s_mul_i32 s29, s7, 5120
    s_lshl_b32 s7, s7, 9
    s_add_u32 s23, s23, s7
    s_cmp_lg_u32 s3, 3
    s_cbranch_scc1 L_pollout_14
    s_lshl_b32 s7, s40, 7
    s_add_u32 s7, s7, s44
    s_sub_u32 s7, s7, 32768
    s_add_u32 s52, s4, s7
    s_addc_u32 s53, s5, 0
    s_cmp_eq_u32 s41, 0
    s_cselect_b32 s7, 0, 32
    s_mov_b32 s6, 0
L_poll_12:
    s_load_dwordx8 s[56:63], s[52:53], 0 glc
    s_load_dwordx2 s[54:55], s[52:53], s7 glc
    s_add_u32 s6, s6, 1
    s_waitcnt lgkmcnt(0)
    s_xor_b64 s[54:55], s[54:55], s[76:77]
    s_xor_b64 s[56:57], s[56:57], s[76:77]
    s_xor_b64 s[58:59], s[58:59], s[76:77]
    s_xor_b64 s[60:61], s[60:61], s[76:77]
    s_xor_b64 s[62:63], s[62:63], s[76:77]
    s_or_b64 s[56:57], s[56:57], s[58:59]
    s_or_b64 s[60:61], s[60:61], s[62:63]
    s_or_b64 s[56:57], s[56:57], s[54:55]
    s_or_b64 s[56:57], s[56:57], s[60:61]
    s_cbranch_scc0 L_polled_13
    s_cmp_lt_u32 s6, 1048576
    s_cbranch_scc1 L_poll_12
    s_branch L_main_end
L_polled_13:
L_pollout_14:
    s_barrier
    s_add_u32 m0, s25, 0
    s_nop 0
    buffer_load_dwordx4 v2, s[8:11], s24 offen offset:0 sc1 lds
    s_add_u32 m0, s25, 4608
    s_nop 0
    buffer_load_dwordx4 v2, s[8:11], s24 offen offset:512 sc1 lds
    s_add_u32 m0, s25, 9216
    s_nop 0
    buffer_load_dwordx4 v2, s[8:11], s24 offen offset:1024 sc1 lds
    s_add_u32 m0, s25, 13824
    s_nop 0
    buffer_load_dwordx4 v2, s[8:11], s24 offen offset:1536 sc1 lds
    s_add_u32 m0, s25, 18432
    s_nop 0
    buffer_load_dwordx4 v2, s[8:11], s24 offen offset:2048 sc1 lds
    s_add_u32 m0, s25, 23040
    s_nop 0
    buffer_load_dwordx4 v2, s[8:11], s24 offen offset:2560 sc1 lds
    s_add_u32 m0, s26, 0
    s_add_u32 s7, s27, 0
    buffer_load_dwordx4 v2, s[8:11], s7 offen sc1 lds
    s_add_u32 m0, s29, 0
    s_add_u32 s7, s23, 0
    buffer_load_dwordx4 v2, s[8:11], s7 offen sc1 lds
    v_mov_b32 v132, 0
    v_mov_b32 v133, 0
    v_mov_b32 v192, 0
    v_mov_b32 v193, 0
    v_mov_b32 v195, 0
    v_mov_b32 v135, 0
    v_mov_b32 v139, 0
    v_mov_b32 v143, 0
    v_mov_b32 v147, 0
    v_mov_b32 v151, 0
    v_mov_b32 v155, 0
    v_mov_b32 v159, 0
    v_mov_b32 v163, 0
    v_mov_b32 v167, 0
    v_mov_b32 v171, 0
    v_cmp_eq_u32 vcc, 16, v0
    v_mov_b32 v10, 0x3f80
    v_cmp_eq_u32 s[20:21], 17, v0
    v_cndmask_b32 v194, 0, v10, vcc
    v_and_b32 v11, 3, v0
    v_cndmask_b32 v194, v194, 1.0, s[20:21]
    v_cmp_eq_u32 vcc, 2, v11
    v_and_b32 v10, 15, v0
    v_lshrrev_b32 v11, 4, v0
    v_cndmask_b32 v196, 0, 1.0, vcc
    v_cndmask_b32 v197, 0, 1.0, vcc
    v_cndmask_b32 v198, 0, 1.0, vcc
    v_cndmask_b32 v199, 0, 1.0, vcc
    v_lshlrev_b32 v11, 2, v11
    v_sub_u32 v10, v11, v10
    v_mov_b32 v12, 0xf149f2ca
    s_cmp_eq_u32 s41, 0
    s_cselect_b64 s[38:39], 0, -1
    v_add_u32 v11, 0, v10
    v_and_b32 v13, 1, v11
    v_cmp_eq_u32 s[20:21], 0, v13
    v_cmp_lt_i32 vcc, 1, v11
    v_cmp_gt_i32 s[18:19], 1, v11
    s_and_b64 vcc, vcc, s[20:21]
    s_and_b64 s[18:19], s[18:19], s[20:21]
    s_and_b64 s[20:21], vcc, s[38:39]
    v_cndmask_b32 v200, v12, 0, vcc
    v_cndmask_b32 v204, v12, 0, s[18:19]
    v_cndmask_b32 v208, v12, 0, s[20:21]
    v_add_u32 v11, 1, v10
    v_and_b32 v13, 1, v11
    v_cmp_eq_u32 s[20:21], 0, v13
    v_cmp_lt_i32 vcc, 1, v11
    v_cmp_gt_i32 s[18:19], 1, v11
    s_and_b64 vcc, vcc, s[20:21]
    s_and_b64 s[18:19], s[18:19], s[20:21]
    s_and_b64 s[20:21], vcc, s[38:39]
    v_cndmask_b32 v201, v12, 0, vcc
    v_cndmask_b32 v205, v12, 0, s[18:19]
    v_cndmask_b32 v209, v12, 0, s[20:21]
    v_add_u32 v11, 2, v10
    v_and_b32 v13, 1, v11
    v_cmp_eq_u32 s[20:21], 0, v13
    v_cmp_lt_i32 vcc, 1, v11
    v_cmp_gt_i32 s[18:19], 1, v11
    s_and_b64 vcc, vcc, s[20:21]
    s_and_b64 s[18:19], s[18:19], s[20:21]
    s_and_b64 s[20:21], vcc, s[38:39]
    v_cndmask_b32 v202, v12, 0, vcc
    v_cndmask_b32 v206, v12, 0, s[18:19]
    v_cndmask_b32 v210, v12, 0, s[20:21]
    v_add_u32 v11, 3, v10
    v_and_b32 v13, 1, v11
    v_cmp_eq_u32 s[20:21], 0, v13
    v_cmp_lt_i32 vcc, 1, v11
    v_cmp_gt_i32 s[18:19], 1, v11
    s_and_b64 vcc, vcc, s[20:21]
    s_and_b64 s[18:19], s[18:19], s[20:21]
    s_and_b64 s[20:21], vcc, s[38:39]
    v_cndmask_b32 v203, v12, 0, vcc
    v_cndmask_b32 v207, v12, 0, s[18:19]
    v_cndmask_b32 v211, v12, 0, s[20:21]
    s_lshl_b32 s45, s41, 1
    s_lshr_b32 s7, s40, 2
    s_add_u32 s45, s45, s7
    s_mul_i32 s30, s45, 36864
    s_add_u32 s30, s30, s43
    s_and_b32 s31, s40, 3
    s_mul_i32 s31, s31, 9
    s_add_u32 s31, s31, s3
    s_mul_i32 s32, s31, 18432
    s_add_u32 s32, s32, 2359296
    s_add_u32 s33, s32, 73728
    s_add_u32 s34, s32, 147456
    s_mov_b32 s39, 19496960
    v_min_u32 v228, 44, v0
    v_lshlrev_b32 v228, 3, v228
    s_cmp_eq_u32 s3, 1
    s_cmov_b32 s34, 3022848
    s_cmp_lt_u32 s3, 2
    s_cselect_b32 s35, 0, 1073741824
    v_add_u32 v5, s35, v253
    s_cmp_eq_u32 s3, 0
    s_cselect_b32 s35, 0, 1073741824
    v_add_u32 v7, s35, v9
    s_lshl_b32 s7, s31, 8
    s_add_u32 s36, s30, s7
    s_add_u32 s37, s36, 43515904
    s_add_u32 s46, s36, 45875200
    s_lshl_b32 s36, s45, 7
    s_add_u32 s36, s36, s43
    s_add_u32 s36, s36, 48431104
    s_lshl_b32 s47, s45, 9
    s_add_u32 s47, s47, s43
    s_add_u32 s47, s47, 48234496
    v_bfe_u32 v10, v0, 3, 2
    v_and_b32 v8, 7, v0
    v_lshlrev_b32 v8, 2, v8
    v_lshl_add_u32 v8, v10, 7, v8
    v_add_u32 v6, 46080, v253
    s_waitcnt vmcnt(0)
    s_barrier
    ds_read_b128 v[16:19], v253 offset:0
    ds_read_b128 v[20:23], v253 offset:1024
    ds_read_b128 v[24:27], v253 offset:2048
    ds_read_b128 v[28:31], v253 offset:3072
    ds_read_b128 v[32:35], v253 offset:4096
    s_waitcnt lgkmcnt(0)
    v_mfma_f32_16x16x32_bf16 v[56:59], a[0:3], v[20:23], 0
    ds_read_b128 v[36:39], v253 offset:5120
    v_mfma_f32_16x16x32_bf16 v[60:63], a[0:3], v[24:27], 0
    ds_read_b128 v[40:43], v253 offset:6144
    v_mfma_f32_16x16x32_bf16 v[64:67], a[0:3], v[28:31], 0
    ds_read_b128 v[44:47], v253 offset:7168
    v_mfma_f32_16x16x32_bf16 v[68:71], a[0:3], v[32:35], 0
    ds_read_b128 v[48:51], v253 offset:8192
    v_mfma_f32_16x16x32_bf16 v[72:75], a[4:7], v[16:19], 0
    ds_read_b128 v[52:55], v253 offset:9216
    v_mfma_f32_16x16x32_bf16 v[76:79], a[4:7], v[20:23], 0
    s_add_u32 m0, s25, 27648
    s_nop 0
    buffer_load_dwordx4 v2, s[8:11], s24 offen offset:3072 sc1 lds
    v_mfma_f32_16x16x32_bf16 v[80:83], a[4:7], v[24:27], 0
    v_mfma_f32_16x16x32_bf16 v[84:87], a[4:7], v[28:31], 0
    s_add_u32 m0, s25, 32256
    s_nop 0
    buffer_load_dwordx4 v2, s[8:11], s24 offen offset:3584 sc1 lds
    v_mfma_f32_16x16x32_bf16 v[88:91], a[4:7], v[32:35], 0
    v_mfma_f32_16x16x32_bf16 v[92:95], v[16:19], a[8:11], 0
    buffer_load_dwordx4 a[144:147], v253, s[8:11], s28 offen offset:0 sc1
    v_mfma_f32_16x16x32_bf16 v[96:99], v[20:23], a[8:11], 0
    v_mfma_f32_16x16x32_bf16 v[100:103], v[24:27], a[8:11], 0
    buffer_load_dwordx4 a[148:151], v253, s[8:11], s28 offen offset:1024 sc1
    v_mfma_f32_16x16x32_bf16 v[104:107], v[28:31], a[8:11], 0
    v_mfma_f32_16x16x32_bf16 v[108:111], v[32:35], a[8:11], 0
    buffer_load_dwordx4 a[152:155], v253, s[8:11], s28 offen offset:2048 sc1
    v_mfma_f32_16x16x32_bf16 v[112:115], a[12:15], v[16:19], 0
    v_mfma_f32_16x16x32_bf16 v[116:119], a[12:15], v[20:23], 0
    v_mfma_f32_16x16x32_bf16 v[120:123], a[12:15], v[24:27], 0
    v_mfma_f32_16x16x32_bf16 v[124:127], a[12:15], v[28:31], 0
    v_mfma_f32_16x16x32_bf16 v[128:131], a[12:15], v[32:35], 0
    s_waitcnt lgkmcnt(0)
    v_mfma_f32_16x16x32_bf16 v[56:59], a[16:19], v[40:43], v[56:59]
    ds_read_b128 v[16:19], v253 offset:10240
    v_mfma_f32_16x16x32_bf16 v[60:63], a[16:19], v[44:47], v[60:63]
    ds_read_b128 v[20:23], v253 offset:11264
    v_mfma_f32_16x16x32_bf16 v[64:67], a[16:19], v[48:51], v[64:67]
    ds_read_b128 v[24:27], v253 offset:12288
    v_mfma_f32_16x16x32_bf16 v[68:71], a[16:19], v[52:55], v[68:71]
    ds_read_b128 v[28:31], v253 offset:13312
    v_mfma_f32_16x16x32_bf16 v[72:75], a[20:23], v[36:39], v[72:75]
    ds_read_b128 v[32:35], v253 offset:14336
    v_mfma_f32_16x16x32_bf16 v[76:79], a[20:23], v[40:43], v[76:79]
    s_add_u32 m0, s25, 40960
    s_add_u32 s24, s24, 4096
    buffer_load_dwordx4 v2, s[8:11], s24 offen offset:0 sc1 lds
    v_mfma_f32_16x16x32_bf16 v[80:83], a[20:23], v[44:47], v[80:83]
    v_mfma_f32_16x16x32_bf16 v[84:87], a[20:23], v[48:51], v[84:87]
    s_add_u32 m0, s25, 45568
    s_nop 0
    buffer_load_dwordx4 v2, s[8:11], s24 offen offset:512 sc1 lds
    v_mfma_f32_16x16x32_bf16 v[88:91], a[20:23], v[52:55], v[88:91]
    v_mfma_f32_16x16x32_bf16 v[92:95], v[36:39], a[24:27], v[92:95]
    buffer_load_dwordx4 a[156:159], v253, s[8:11], s28 offen offset:3072 sc1
    s_add_u32 s28, s28, 4096
    v_mfma_f32_16x16x32_bf16 v[96:99], v[40:43], a[24:27], v[96:99]
    v_mfma_f32_16x16x32_bf16 v[100:103], v[44:47], a[24:27], v[100:103]
    buffer_load_dwordx4 a[0:3], v253, s[8:11], s28 offen offset:0 sc1
    v_mfma_f32_16x16x32_bf16 v[104:107], v[48:51], a[24:27], v[104:107]
    v_mfma_f32_16x16x32_bf16 v[108:111], v[52:55], a[24:27], v[108:111]
    buffer_load_dwordx4 a[4:7], v253, s[8:11], s28 offen offset:1024 sc1
    v_mfma_f32_16x16x32_bf16 v[112:115], a[28:31], v[36:39], v[112:115]
    v_mfma_f32_16x16x32_bf16 v[116:119], a[28:31], v[40:43], v[116:119]
    v_mfma_f32_16x16x32_bf16 v[120:123], a[28:31], v[44:47], v[120:123]
    v_mfma_f32_16x16x32_bf16 v[124:127], a[28:31], v[48:51], v[124:127]
    v_mfma_f32_16x16x32_bf16 v[128:131], a[28:31], v[52:55], v[128:131]
    s_waitcnt lgkmcnt(0)
    v_mfma_f32_16x16x32_bf16 v[56:59], a[32:35], v[20:23], v[56:59]
    ds_read_b128 v[36:39], v253 offset:15360
    v_mfma_f32_16x16x32_bf16 v[60:63], a[32:35], v[24:27], v[60:63]
    ds_read_b128 v[40:43], v253 offset:16384
    v_mfma_f32_16x16x32_bf16 v[64:67], a[32:35], v[28:31], v[64:67]
    ds_read_b128 v[44:47], v253 offset:17408
    v_mfma_f32_16x16x32_bf16 v[68:71], a[32:35], v[32:35], v[68:71]
    ds_read_b128 v[48:51], v253 offset:18432
    v_mfma_f32_16x16x32_bf16 v[72:75], a[36:39], v[16:19], v[72:75]
    ds_read_b128 v[52:55], v253 offset:19456
    v_mfma_f32_16x16x32_bf16 v[76:79], a[36:39], v[20:23], v[76:79]
    s_add_u32 m0, s25, 50176
    s_nop 0
    buffer_load_dwordx4 v2, s[8:11], s24 offen offset:1024 sc1 lds
    v_mfma_f32_16x16x32_bf16 v[80:83], a[36:39], v[24:27], v[80:83]
    v_mfma_f32_16x16x32_bf16 v[84:87], a[36:39], v[28:31], v[84:87]
    s_add_u32 m0, s25, 54784
    s_nop 0
    buffer_load_dwordx4 v2, s[8:11], s24 offen offset:1536 sc1 lds
    v_mfma_f32_16x16x32_bf16 v[88:91], a[36:39], v[32:35], v[88:91]
    v_mfma_f32_16x16x32_bf16 v[92:95], v[16:19], a[40:43], v[92:95]
    buffer_load_dwordx4 a[8:11], v253, s[8:11], s28 offen offset:2048 sc1
    v_mfma_f32_16x16x32_bf16 v[96:99], v[20:23], a[40:43], v[96:99]
    v_mfma_f32_16x16x32_bf16 v[100:103], v[24:27], a[40:43], v[100:103]
    buffer_load_dwordx4 a[12:15], v253, s[8:11], s28 offen offset:3072 sc1
    s_add_u32 s28, s28, 4096
    v_mfma_f32_16x16x32_bf16 v[104:107], v[28:31], a[40:43], v[104:107]
    v_mfma_f32_16x16x32_bf16 v[108:111], v[32:35], a[40:43], v[108:111]
    buffer_load_dwordx4 a[16:19], v253, s[8:11], s28 offen offset:0 sc1
    v_mfma_f32_16x16x32_bf16 v[112:115], a[44:47], v[16:19], v[112:115]
    v_mfma_f32_16x16x32_bf16 v[116:119], a[44:47], v[20:23], v[116:119]
    v_mfma_f32_16x16x32_bf16 v[120:123], a[44:47], v[24:27], v[120:123]
    v_mfma_f32_16x16x32_bf16 v[124:127], a[44:47], v[28:31], v[124:127]
    v_mfma_f32_16x16x32_bf16 v[128:131], a[44:47], v[32:35], v[128:131]
    s_waitcnt lgkmcnt(0)
    v_mfma_f32_16x16x32_bf16 v[56:59], a[48:51], v[40:43], v[56:59]
    ds_read_b128 v[16:19], v253 offset:20480
    v_mfma_f32_16x16x32_bf16 v[60:63], a[48:51], v[44:47], v[60:63]
    ds_read_b128 v[20:23], v253 offset:21504
    v_mfma_f32_16x16x32_bf16 v[64:67], a[48:51], v[48:51], v[64:67]
    ds_read_b128 v[24:27], v253 offset:22528
    v_mfma_f32_16x16x32_bf16 v[68:71], a[48:51], v[52:55], v[68:71]
    ds_read_b128 v[28:31], v253 offset:23552
    v_mfma_f32_16x16x32_bf16 v[72:75], a[52:55], v[36:39], v[72:75]
    ds_read_b128 v[32:35], v253 offset:24576
    v_mfma_f32_16x16x32_bf16 v[76:79], a[52:55], v[40:43], v[76:79]
    s_add_u32 m0, s26, 30720
    s_add_u32 s7, s27, 3072
    buffer_load_dwordx4 v2, s[8:11], s7 offen sc1 lds
    v_mfma_f32_16x16x32_bf16 v[80:83], a[52:55], v[44:47], v[80:83]
    v_mfma_f32_16x16x32_bf16 v[84:87], a[52:55], v[48:51], v[84:87]
    s_add_u32 m0, s29, 30720
    s_add_u32 s7, s23, 3072
    buffer_load_dwordx4 v2, s[8:11], s7 offen sc1 lds
    v_mfma_f32_16x16x32_bf16 v[88:91], a[52:55], v[52:55], v[88:91]
    v_mfma_f32_16x16x32_bf16 v[92:95], v[36:39], a[56:59], v[92:95]
    buffer_load_dwordx4 a[20:23], v253, s[8:11], s28 offen offset:1024 sc1
    v_mfma_f32_16x16x32_bf16 v[96:99], v[40:43], a[56:59], v[96:99]
    v_mfma_f32_16x16x32_bf16 v[100:103], v[44:47], a[56:59], v[100:103]
    buffer_load_dwordx4 a[24:27], v253, s[8:11], s28 offen offset:2048 sc1
    v_mfma_f32_16x16x32_bf16 v[104:107], v[48:51], a[56:59], v[104:107]
    v_mfma_f32_16x16x32_bf16 v[108:111], v[52:55], a[56:59], v[108:111]
    buffer_load_dwordx4 a[28:31], v253, s[8:11], s28 offen offset:3072 sc1
    s_add_u32 s28, s28, 4096
    v_mfma_f32_16x16x32_bf16 v[112:115], a[60:63], v[36:39], v[112:115]
    v_mfma_f32_16x16x32_bf16 v[116:119], a[60:63], v[40:43], v[116:119]
    v_mfma_f32_16x16x32_bf16 v[120:123], a[60:63], v[44:47], v[120:123]
    v_mfma_f32_16x16x32_bf16 v[124:127], a[60:63], v[48:51], v[124:127]
    v_mfma_f32_16x16x32_bf16 v[128:131], a[60:63], v[52:55], v[128:131]
    s_waitcnt lgkmcnt(0)
    v_mfma_f32_16x16x32_bf16 v[56:59], a[64:67], v[20:23], v[56:59]
    ds_read_b128 v[36:39], v253 offset:25600
    v_mfma_f32_16x16x32_bf16 v[60:63], a[64:67], v[24:27], v[60:63]
    ds_read_b128 v[40:43], v253 offset:26624
    v_mfma_f32_16x16x32_bf16 v[64:67], a[64:67], v[28:31], v[64:67]
    ds_read_b128 v[44:47], v253 offset:27648
    v_mfma_f32_16x16x32_bf16 v[68:71], a[64:67], v[32:35], v[68:71]
    ds_read_b128 v[48:51], v253 offset:28672
    v_mfma_f32_16x16x32_bf16 v[72:75], a[68:71], v[16:19], v[72:75]
    ds_read_b128 v[52:55], v253 offset:29696
    v_mfma_f32_16x16x32_bf16 v[76:79], a[68:71], v[20:23], v[76:79]
    buffer_load_dwordx4 a[32:35], v253, s[8:11], s28 offen offset:0 sc1
    v_mfma_f32_16x16x32_bf16 v[80:83], a[68:71], v[24:27], v[80:83]
    v_mfma_f32_16x16x32_bf16 v[84:87], a[68:71], v[28:31], v[84:87]
    buffer_load_dwordx4 a[36:39], v253, s[8:11], s28 offen offset:1024 sc1
    v_mfma_f32_16x16x32_bf16 v[88:91], a[68:71], v[32:35], v[88:91]
    v_mfma_f32_16x16x32_bf16 v[92:95], v[16:19], a[72:75], v[92:95]
    buffer_load_dwordx4 a[40:43], v253, s[8:11], s28 offen offset:2048 sc1
    v_mfma_f32_16x16x32_bf16 v[96:99], v[20:23], a[72:75], v[96:99]
    v_mfma_f32_16x16x32_bf16 v[100:103], v[24:27], a[72:75], v[100:103]
    buffer_load_dwordx2 v[226:227], v228, s[8:11], s39 offen sc1
    v_mfma_f32_16x16x32_bf16 v[104:107], v[28:31], a[72:75], v[104:107]
    v_mfma_f32_16x16x32_bf16 v[108:111], v[32:35], a[72:75], v[108:111]
    v_mfma_f32_16x16x32_bf16 v[112:115], a[76:79], v[16:19], v[112:115]
    v_mfma_f32_16x16x32_bf16 v[116:119], a[76:79], v[20:23], v[116:119]
    v_mfma_f32_16x16x32_bf16 v[120:123], a[76:79], v[24:27], v[120:123]
    v_mfma_f32_16x16x32_bf16 v[124:127], a[76:79], v[28:31], v[124:127]
    v_mfma_f32_16x16x32_bf16 v[128:131], a[76:79], v[32:35], v[128:131]
    s_waitcnt vmcnt(7) lgkmcnt(0)
    s_barrier
    v_mfma_f32_16x16x32_bf16 v[56:59], a[80:83], v[40:43], v[56:59]
    ds_read_b128 v[16:19], v253 offset:30720
    v_mfma_f32_16x16x32_bf16 v[60:63], a[80:83], v[44:47], v[60:63]
    ds_read_b128 v[20:23], v253 offset:31744
    v_mfma_f32_16x16x32_bf16 v[64:67], a[80:83], v[48:51], v[64:67]
    ds_read_b128 v[24:27], v253 offset:32768
    v_mfma_f32_16x16x32_bf16 v[68:71], a[80:83], v[52:55], v[68:71]
    ds_read_b128 v[28:31], v253 offset:33792
    v_mfma_f32_16x16x32_bf16 v[72:75], a[84:87], v[36:39], v[72:75]
    ds_read_b128 v[32:35], v253 offset:34816
    v_mfma_f32_16x16x32_bf16 v[76:79], a[84:87], v[40:43], v[76:79]
    s_add_u32 m0, s25, 59392
    s_nop 0
    buffer_load_dwordx4 v2, s[8:11], s24 offen offset:2048 sc1 lds
    v_mfma_f32_16x16x32_bf16 v[80:83], a[84:87], v[44:47], v[80:83]
    v_mfma_f32_16x16x32_bf16 v[84:87], a[84:87], v[48:51], v[84:87]
    s_add_u32 m0, s25, 64000
    s_nop 0
    buffer_load_dwordx4 v2, s[8:11], s24 offen offset:2560 sc1 lds
    v_mfma_f32_16x16x32_bf16 v[88:91], a[84:87], v[52:55], v[88:91]
    v_mfma_f32_16x16x32_bf16 v[92:95], v[36:39], a[88:91], v[92:95]
    buffer_load_dwordx4 a[44:47], v253, s[8:11], s28 offen offset:3072 sc1
    s_add_u32 s28, s28, 4096
    v_mfma_f32_16x16x32_bf16 v[96:99], v[40:43], a[88:91], v[96:99]
    v_mfma_f32_16x16x32_bf16 v[100:103], v[44:47], a[88:91], v[100:103]
    buffer_load_dwordx4 a[48:51], v253, s[8:11], s28 offen offset:0 sc1
    v_mfma_f32_16x16x32_bf16 v[104:107], v[48:51], a[88:91], v[104:107]
    v_mfma_f32_16x16x32_bf16 v[108:111], v[52:55], a[88:91], v[108:111]
    buffer_load_dwordx4 a[52:55], v253, s[8:11], s28 offen offset:1024 sc1
    v_mfma_f32_16x16x32_bf16 v[112:115], a[92:95], v[36:39], v[112:115]
    v_mfma_f32_16x16x32_bf16 v[116:119], a[92:95], v[40:43], v[116:119]
    v_mfma_f32_16x16x32_bf16 v[120:123], a[92:95], v[44:47], v[120:123]
    v_mfma_f32_16x16x32_bf16 v[124:127], a[92:95], v[48:51], v[124:127]
    v_mfma_f32_16x16x32_bf16 v[128:131], a[92:95], v[52:55], v[128:131]
    s_waitcnt lgkmcnt(0)
    v_mfma_f32_16x16x32_bf16 v[56:59], a[96:99], v[20:23], v[56:59]
    ds_read_b128 v[36:39], v253 offset:35840
    v_mfma_f32_16x16x32_bf16 v[60:63], a[96:99], v[24:27], v[60:63]
    ds_read_b128 v[40:43], v253 offset:36864
    v_mfma_f32_16x16x32_bf16 v[64:67], a[96:99], v[28:31], v[64:67]
    ds_read_b128 v[44:47], v253 offset:37888
    v_mfma_f32_16x16x32_bf16 v[68:71], a[96:99], v[32:35], v[68:71]
    ds_read_b128 v[48:51], v253 offset:38912
    v_mfma_f32_16x16x32_bf16 v[72:75], a[100:103], v[16:19], v[72:75]
    ds_read_b128 v[52:55], v253 offset:39936
    v_mfma_f32_16x16x32_bf16 v[76:79], a[100:103], v[20:23], v[76:79]
    s_add_u32 m0, s25, 68608
    s_nop 0
    buffer_load_dwordx4 v2, s[8:11], s24 offen offset:3072 sc1 lds
    v_mfma_f32_16x16x32_bf16 v[80:83], a[100:103], v[24:27], v[80:83]
    v_mfma_f32_16x16x32_bf16 v[84:87], a[100:103], v[28:31], v[84:87]
    s_add_u32 m0, s25, 73216
    s_nop 0
    buffer_load_dwordx4 v2, s[8:11], s24 offen offset:3584 sc1 lds
    v_mfma_f32_16x16x32_bf16 v[88:91], a[100:103], v[32:35], v[88:91]
    v_mfma_f32_16x16x32_bf16 v[92:95], v[16:19], a[104:107], v[92:95]
    buffer_load_dwordx4 a[56:59], v253, s[8:11], s28 offen offset:2048 sc1
    v_mfma_f32_16x16x32_bf16 v[96:99], v[20:23], a[104:107], v[96:99]
    v_mfma_f32_16x16x32_bf16 v[100:103], v[24:27], a[104:107], v[100:103]
    buffer_load_dwordx4 a[60:63], v253, s[8:11], s28 offen offset:3072 sc1
    s_add_u32 s28, s28, 4096
    v_mfma_f32_16x16x32_bf16 v[104:107], v[28:31], a[104:107], v[104:107]
    v_mfma_f32_16x16x32_bf16 v[108:111], v[32:35], a[104:107], v[108:111]
    buffer_load_dwordx4 a[64:67], v253, s[8:11], s28 offen offset:0 sc1
    v_mfma_f32_16x16x32_bf16 v[112:115], a[108:111], v[16:19], v[112:115]
    v_mfma_f32_16x16x32_bf16 v[116:119], a[108:111], v[20:23], v[116:119]
    v_mfma_f32_16x16x32_bf16 v[120:123], a[108:111], v[24:27], v[120:123]
    v_mfma_f32_16x16x32_bf16 v[124:127], a[108:111], v[28:31], v[124:127]
    v_mfma_f32_16x16x32_bf16 v[128:131], a[108:111], v[32:35], v[128:131]
    s_waitcnt lgkmcnt(0)
    v_mfma_f32_16x16x32_bf16 v[56:59], a[112:115], v[40:43], v[56:59]
    ds_read_b128 v[16:19], v253 offset:40960
    v_mfma_f32_16x16x32_bf16 v[60:63], a[112:115], v[44:47], v[60:63]
    ds_read_b128 v[20:23], v253 offset:41984
    v_mfma_f32_16x16x32_bf16 v[64:67], a[112:115], v[48:51], v[64:67]
    ds_read_b128 v[24:27], v253 offset:43008
    v_mfma_f32_16x16x32_bf16 v[68:71], a[112:115], v[52:55], v[68:71]
    ds_read_b128 v[28:31], v253 offset:44032
    v_mfma_f32_16x16x32_bf16 v[72:75], a[116:119], v[36:39], v[72:75]
    ds_read_b128 v[32:35], v253 offset:45056
    v_mfma_f32_16x16x32_bf16 v[76:79], a[116:119], v[40:43], v[76:79]
    s_add_u32 m0, s25, 81920
    s_add_u32 s24, s24, 4096
    buffer_load_dwordx4 v2, s[8:11], s24 offen offset:0 sc1 lds
    v_mfma_f32_16x16x32_bf16 v[80:83], a[116:119], v[44:47], v[80:83]
    v_mfma_f32_16x16x32_bf16 v[84:87], a[116:119], v[48:51], v[84:87]
    s_add_u32 m0, s25, 86528
    s_nop 0
    buffer_load_dwordx4 v2, s[8:11], s24 offen offset:512 sc1 lds
    v_mfma_f32_16x16x32_bf16 v[88:91], a[116:119], v[52:55], v[88:91]
    v_mfma_f32_16x16x32_bf16 v[92:95], v[36:39], a[120:123], v[92:95]
    buffer_load_dwordx4 a[68:71], v253, s[8:11], s28 offen offset:1024 sc1
    v_mfma_f32_16x16x32_bf16 v[96:99], v[40:43], a[120:123], v[96:99]
    v_mfma_f32_16x16x32_bf16 v[100:103], v[44:47], a[120:123], v[100:103]
    buffer_load_dwordx4 a[72:75], v253, s[8:11], s28 offen offset:2048 sc1
    v_mfma_f32_16x16x32_bf16 v[104:107], v[48:51], a[120:123], v[104:107]
    v_mfma_f32_16x16x32_bf16 v[108:111], v[52:55], a[120:123], v[108:111]
    buffer_load_dwordx4 a[76:79], v253, s[8:11], s28 offen offset:3072 sc1
    s_add_u32 s28, s28, 4096
    v_mfma_f32_16x16x32_bf16 v[112:115], a[124:127], v[36:39], v[112:115]
    v_mfma_f32_16x16x32_bf16 v[116:119], a[124:127], v[40:43], v[116:119]
    v_mfma_f32_16x16x32_bf16 v[120:123], a[124:127], v[44:47], v[120:123]
    v_mfma_f32_16x16x32_bf16 v[124:127], a[124:127], v[48:51], v[124:127]
    v_mfma_f32_16x16x32_bf16 v[128:131], a[124:127], v[52:55], v[128:131]
    s_waitcnt lgkmcnt(0)
    v_mfma_f32_16x16x32_bf16 v[56:59], a[128:131], v[20:23], v[56:59]
    ds_read_b128 v[36:39], v6 offset:0
    v_mfma_f32_16x16x32_bf16 v[60:63], a[128:131], v[24:27], v[60:63]
    ds_read_b128 v[40:43], v6 offset:1024
    v_mfma_f32_16x16x32_bf16 v[64:67], a[128:131], v[28:31], v[64:67]
    ds_read_b128 v[44:47], v6 offset:2048
    v_mfma_f32_16x16x32_bf16 v[68:71], a[128:131], v[32:35], v[68:71]
    ds_read_b128 v[48:51], v6 offset:3072
    v_mfma_f32_16x16x32_bf16 v[72:75], a[132:135], v[16:19], v[72:75]
    ds_read_b128 v[52:55], v6 offset:4096
    v_mfma_f32_16x16x32_bf16 v[76:79], a[132:135], v[20:23], v[76:79]
    s_add_u32 m0, s26, 61440
    s_add_u32 s7, s27, 6144
    buffer_load_dwordx4 v2, s[8:11], s7 offen sc1 lds
    v_mfma_f32_16x16x32_bf16 v[80:83], a[132:135], v[24:27], v[80:83]
    v_mfma_f32_16x16x32_bf16 v[84:87], a[132:135], v[28:31], v[84:87]
    s_add_u32 m0, s29, 61440
    s_add_u32 s7, s23, 6144
    buffer_load_dwordx4 v2, s[8:11], s7 offen sc1 lds
    v_mfma_f32_16x16x32_bf16 v[88:91], a[132:135], v[32:35], v[88:91]
    v_mfma_f32_16x16x32_bf16 v[92:95], v[16:19], a[136:139], v[92:95]
    buffer_load_dwordx4 a[80:83], v253, s[8:11], s28 offen offset:0 sc1
    v_mfma_f32_16x16x32_bf16 v[96:99], v[20:23], a[136:139], v[96:99]
    v_mfma_f32_16x16x32_bf16 v[100:103], v[24:27], a[136:139], v[100:103]
    buffer_load_dwordx4 a[84:87], v253, s[8:11], s28 offen offset:1024 sc1
    v_mfma_f32_16x16x32_bf16 v[104:107], v[28:31], a[136:139], v[104:107]
    v_mfma_f32_16x16x32_bf16 v[108:111], v[32:35], a[136:139], v[108:111]
    buffer_load_dwordx4 a[88:91], v253, s[8:11], s28 offen offset:2048 sc1
    v_mfma_f32_16x16x32_bf16 v[112:115], a[140:143], v[16:19], v[112:115]
    v_mfma_f32_16x16x32_bf16 v[116:119], a[140:143], v[20:23], v[116:119]
    v_mfma_f32_16x16x32_bf16 v[120:123], a[140:143], v[24:27], v[120:123]
    v_mfma_f32_16x16x32_bf16 v[124:127], a[140:143], v[28:31], v[124:127]
    v_mfma_f32_16x16x32_bf16 v[128:131], a[140:143], v[32:35], v[128:131]
    s_waitcnt vmcnt(20) lgkmcnt(0)
    s_mov_b32 s6, 0
L_wo_poll_15:
    v_cmp_eq_u32 vcc, s76, v226
    v_cmp_eq_u32 s[20:21], s76, v227
    s_and_b64 vcc, vcc, s[20:21]
    s_cmp_eq_u64 vcc, exec
    s_cbranch_scc1 L_wo_ready_16
    buffer_load_dwordx2 v[226:227], v228, s[8:11], s39 offen sc1
    s_add_u32 s6, s6, 1
    s_cmp_lt_u32 s6, 1048576
    s_waitcnt vmcnt(0)
    s_cbranch_scc1 L_wo_poll_15
    s_branch L_main_end
L_wo_ready_16:
    v_mfma_f32_16x16x32_bf16 v[56:59], a[144:147], v[40:43], v[56:59]
    ds_read_b128 v[16:19], v6 offset:5120
    v_mfma_f32_16x16x32_bf16 v[60:63], a[144:147], v[44:47], v[60:63]
    ds_read_b128 v[20:23], v6 offset:6144
    v_mfma_f32_16x16x32_bf16 v[64:67], a[144:147], v[48:51], v[64:67]
    ds_read_b128 v[24:27], v6 offset:7168
    v_mfma_f32_16x16x32_bf16 v[68:71], a[144:147], v[52:55], v[68:71]
    ds_read_b128 v[28:31], v6 offset:8192
    v_mfma_f32_16x16x32_bf16 v[72:75], a[148:151], v[36:39], v[72:75]
    ds_read_b128 v[32:35], v6 offset:9216
    v_mfma_f32_16x16x32_bf16 v[76:79], a[148:151], v[40:43], v[76:79]
    buffer_load_dwordx4 a[92:95], v253, s[8:11], s28 offen offset:3072 sc1
    s_add_u32 s28, s28, 4096
    v_mfma_f32_16x16x32_bf16 v[80:83], a[148:151], v[44:47], v[80:83]
    v_mfma_f32_16x16x32_bf16 v[84:87], a[148:151], v[48:51], v[84:87]
    buffer_load_dwordx4 a[96:99], v253, s[8:11], s28 offen offset:0 sc1
    v_mfma_f32_16x16x32_bf16 v[88:91], a[148:151], v[52:55], v[88:91]
    v_mfma_f32_16x16x32_bf16 v[92:95], v[36:39], a[152:155], v[92:95]
    buffer_load_dwordx4 a[100:103], v253, s[8:11], s28 offen offset:1024 sc1
    v_mfma_f32_16x16x32_bf16 v[96:99], v[40:43], a[152:155], v[96:99]
    v_mfma_f32_16x16x32_bf16 v[100:103], v[44:47], a[152:155], v[100:103]
    buffer_load_dwordx4 a[160:163], v253, s[8:11], s32 offen offset:0 sc1
    v_mfma_f32_16x16x32_bf16 v[104:107], v[48:51], a[152:155], v[104:107]
    v_mfma_f32_16x16x32_bf16 v[108:111], v[52:55], a[152:155], v[108:111]
    v_mfma_f32_16x16x32_bf16 v[112:115], a[156:159], v[36:39], v[112:115]
    v_mfma_f32_16x16x32_bf16 v[116:119], a[156:159], v[40:43], v[116:119]
    v_mfma_f32_16x16x32_bf16 v[120:123], a[156:159], v[44:47], v[120:123]
    v_mfma_f32_16x16x32_bf16 v[124:127], a[156:159], v[48:51], v[124:127]
    v_mfma_f32_16x16x32_bf16 v[128:131], a[156:159], v[52:55], v[128:131]
    s_waitcnt vmcnt(34) lgkmcnt(0)
    v_mfma_f32_16x16x32_bf16 v[56:59], a[0:3], v[20:23], v[56:59]
    ds_read_b128 v[36:39], v6 offset:10240
    v_mfma_f32_16x16x32_bf16 v[60:63], a[0:3], v[24:27], v[60:63]
    ds_read_b128 v[40:43], v6 offset:11264
    v_mfma_f32_16x16x32_bf16 v[64:67], a[0:3], v[28:31], v[64:67]
    ds_read_b128 v[44:47], v6 offset:12288
    v_mfma_f32_16x16x32_bf16 v[68:71], a[0:3], v[32:35], v[68:71]
    ds_read_b128 v[48:51], v6 offset:13312
    v_mfma_f32_16x16x32_bf16 v[72:75], a[4:7], v[16:19], v[72:75]
    ds_read_b128 v[52:55], v6 offset:14336
    v_mfma_f32_16x16x32_bf16 v[76:79], a[4:7], v[20:23], v[76:79]
    buffer_load_dwordx4 a[104:107], v253, s[8:11], s28 offen offset:2048 sc1
    v_mfma_f32_16x16x32_bf16 v[80:83], a[4:7], v[24:27], v[80:83]
    v_mfma_f32_16x16x32_bf16 v[84:87], a[4:7], v[28:31], v[84:87]
    buffer_load_dwordx4 a[108:111], v253, s[8:11], s28 offen offset:3072 sc1
    s_add_u32 s28, s28, 4096
    v_mfma_f32_16x16x32_bf16 v[88:91], a[4:7], v[32:35], v[88:91]
    v_mfma_f32_16x16x32_bf16 v[92:95], v[16:19], a[8:11], v[92:95]
    buffer_load_dwordx4 a[112:115], v253, s[8:11], s28 offen offset:0 sc1
    v_mfma_f32_16x16x32_bf16 v[96:99], v[20:23], a[8:11], v[96:99]
    v_mfma_f32_16x16x32_bf16 v[100:103], v[24:27], a[8:11], v[100:103]
    buffer_load_dwordx4 a[164:167], v253, s[8:11], s33 offen offset:0 sc1
    v_mfma_f32_16x16x32_bf16 v[104:107], v[28:31], a[8:11], v[104:107]
    v_mfma_f32_16x16x32_bf16 v[108:111], v[32:35], a[8:11], v[108:111]
    v_mfma_f32_16x16x32_bf16 v[112:115], a[12:15], v[16:19], v[112:115]
    v_mfma_f32_16x16x32_bf16 v[116:119], a[12:15], v[20:23], v[116:119]
    v_mfma_f32_16x16x32_bf16 v[120:123], a[12:15], v[24:27], v[120:123]
    v_mfma_f32_16x16x32_bf16 v[124:127], a[12:15], v[28:31], v[124:127]
    v_mfma_f32_16x16x32_bf16 v[128:131], a[12:15], v[32:35], v[128:131]
    s_waitcnt vmcnt(11) lgkmcnt(0)
    s_barrier
    v_mfma_f32_16x16x32_bf16 v[56:59], a[16:19], v[40:43], v[56:59]
    ds_read_b128 v[16:19], v6 offset:15360
    v_mfma_f32_16x16x32_bf16 v[60:63], a[16:19], v[44:47], v[60:63]
    ds_read_b128 v[20:23], v6 offset:16384
    v_mfma_f32_16x16x32_bf16 v[64:67], a[16:19], v[48:51], v[64:67]
    ds_read_b128 v[24:27], v6 offset:17408
    v_mfma_f32_16x16x32_bf16 v[68:71], a[16:19], v[52:55], v[68:71]
    ds_read_b128 v[28:31], v6 offset:18432
    v_mfma_f32_16x16x32_bf16 v[72:75], a[20:23], v[36:39], v[72:75]
    ds_read_b128 v[32:35], v6 offset:19456
    v_mfma_f32_16x16x32_bf16 v[76:79], a[20:23], v[40:43], v[76:79]
    buffer_load_dwordx4 a[116:119], v253, s[8:11], s28 offen offset:1024 sc1
    v_mfma_f32_16x16x32_bf16 v[80:83], a[20:23], v[44:47], v[80:83]
    v_mfma_f32_16x16x32_bf16 v[84:87], a[20:23], v[48:51], v[84:87]
    buffer_load_dwordx4 a[120:123], v253, s[8:11], s28 offen offset:2048 sc1
    v_mfma_f32_16x16x32_bf16 v[88:91], a[20:23], v[52:55], v[88:91]
    v_mfma_f32_16x16x32_bf16 v[92:95], v[36:39], a[24:27], v[92:95]
    buffer_load_dwordx4 a[124:127], v253, s[8:11], s28 offen offset:3072 sc1
    s_add_u32 s28, s28, 4096
    v_mfma_f32_16x16x32_bf16 v[96:99], v[40:43], a[24:27], v[96:99]
    v_mfma_f32_16x16x32_bf16 v[100:103], v[44:47], a[24:27], v[100:103]
    buffer_load_dwordx4 a[168:171], v5, s[8:11], s34 offen offset:0 sc1
    v_mfma_f32_16x16x32_bf16 v[104:107], v[48:51], a[24:27], v[104:107]
    v_mfma_f32_16x16x32_bf16 v[108:111], v[52:55], a[24:27], v[108:111]
    v_mfma_f32_16x16x32_bf16 v[112:115], a[28:31], v[36:39], v[112:115]
    v_mfma_f32_16x16x32_bf16 v[116:119], a[28:31], v[40:43], v[116:119]
    v_mfma_f32_16x16x32_bf16 v[120:123], a[28:31], v[44:47], v[120:123]
    v_mfma_f32_16x16x32_bf16 v[124:127], a[28:31], v[48:51], v[124:127]
    v_mfma_f32_16x16x32_bf16 v[128:131], a[28:31], v[52:55], v[128:131]
    s_waitcnt vmcnt(29) lgkmcnt(0)
    v_mfma_f32_16x16x32_bf16 v[56:59], a[32:35], v[20:23], v[56:59]
    ds_read_b128 v[36:39], v6 offset:20480
    v_mfma_f32_16x16x32_bf16 v[60:63], a[32:35], v[24:27], v[60:63]
    ds_read_b128 v[40:43], v6 offset:21504
    v_mfma_f32_16x16x32_bf16 v[64:67], a[32:35], v[28:31], v[64:67]
    ds_read_b128 v[44:47], v6 offset:22528
    v_mfma_f32_16x16x32_bf16 v[68:71], a[32:35], v[32:35], v[68:71]
    ds_read_b128 v[48:51], v6 offset:23552
    v_mfma_f32_16x16x32_bf16 v[72:75], a[36:39], v[16:19], v[72:75]
    ds_read_b128 v[52:55], v6 offset:24576
    v_mfma_f32_16x16x32_bf16 v[76:79], a[36:39], v[20:23], v[76:79]
    buffer_load_dwordx4 a[172:175], v253, s[8:11], s32 offen offset:1024 sc1
    v_mfma_f32_16x16x32_bf16 v[80:83], a[36:39], v[24:27], v[80:83]
    v_mfma_f32_16x16x32_bf16 v[84:87], a[36:39], v[28:31], v[84:87]
    buffer_load_dwordx4 a[176:179], v253, s[8:11], s33 offen offset:1024 sc1
    v_mfma_f32_16x16x32_bf16 v[88:91], a[36:39], v[32:35], v[88:91]
    v_mfma_f32_16x16x32_bf16 v[92:95], v[16:19], a[40:43], v[92:95]
    buffer_load_dwordx4 a[180:183], v5, s[8:11], s34 offen offset:1024 sc1
    v_mfma_f32_16x16x32_bf16 v[96:99], v[20:23], a[40:43], v[96:99]
    v_mfma_f32_16x16x32_bf16 v[100:103], v[24:27], a[40:43], v[100:103]
    buffer_load_dwordx4 a[184:187], v253, s[8:11], s32 offen offset:2048 sc1
    v_mfma_f32_16x16x32_bf16 v[104:107], v[28:31], a[40:43], v[104:107]
    v_mfma_f32_16x16x32_bf16 v[108:111], v[32:35], a[40:43], v[108:111]
    v_mfma_f32_16x16x32_bf16 v[112:115], a[44:47], v[16:19], v[112:115]
    v_mfma_f32_16x16x32_bf16 v[116:119], a[44:47], v[20:23], v[116:119]
    v_mfma_f32_16x16x32_bf16 v[120:123], a[44:47], v[24:27], v[120:123]
    v_mfma_f32_16x16x32_bf16 v[124:127], a[44:47], v[28:31], v[124:127]
    v_mfma_f32_16x16x32_bf16 v[128:131], a[44:47], v[32:35], v[128:131]
    s_waitcnt vmcnt(27) lgkmcnt(0)
    v_mfma_f32_16x16x32_bf16 v[56:59], a[48:51], v[40:43], v[56:59]
    ds_read_b128 v[16:19], v6 offset:25600
    v_mfma_f32_16x16x32_bf16 v[60:63], a[48:51], v[44:47], v[60:63]
    ds_read_b128 v[20:23], v6 offset:26624
    v_mfma_f32_16x16x32_bf16 v[64:67], a[48:51], v[48:51], v[64:67]
    ds_read_b128 v[24:27], v6 offset:27648
    v_mfma_f32_16x16x32_bf16 v[68:71], a[48:51], v[52:55], v[68:71]
    ds_read_b128 v[28:31], v6 offset:28672
    v_mfma_f32_16x16x32_bf16 v[72:75], a[52:55], v[36:39], v[72:75]
    ds_read_b128 v[32:35], v6 offset:29696
    v_mfma_f32_16x16x32_bf16 v[76:79], a[52:55], v[40:43], v[76:79]
    buffer_load_dwordx4 a[188:191], v253, s[8:11], s33 offen offset:2048 sc1
    v_mfma_f32_16x16x32_bf16 v[80:83], a[52:55], v[44:47], v[80:83]
    v_mfma_f32_16x16x32_bf16 v[84:87], a[52:55], v[48:51], v[84:87]
    buffer_load_dwordx4 a[192:195], v5, s[8:11], s34 offen offset:2048 sc1
    v_mfma_f32_16x16x32_bf16 v[88:91], a[52:55], v[52:55], v[88:91]
    v_mfma_f32_16x16x32_bf16 v[92:95], v[36:39], a[56:59], v[92:95]
    buffer_load_dwordx4 a[196:199], v253, s[8:11], s32 offen offset:3072 sc1
    s_add_u32 s32, s32, 4096
    v_mfma_f32_16x16x32_bf16 v[96:99], v[40:43], a[56:59], v[96:99]
    v_mfma_f32_16x16x32_bf16 v[100:103], v[44:47], a[56:59], v[100:103]
    buffer_load_dwordx4 a[200:203], v253, s[8:11], s33 offen offset:3072 sc1
    s_add_u32 s33, s33, 4096
    v_mfma_f32_16x16x32_bf16 v[104:107], v[48:51], a[56:59], v[104:107]
    v_mfma_f32_16x16x32_bf16 v[108:111], v[52:55], a[56:59], v[108:111]
    v_mfma_f32_16x16x32_bf16 v[112:115], a[60:63], v[36:39], v[112:115]
    v_mfma_f32_16x16x32_bf16 v[116:119], a[60:63], v[40:43], v[116:119]
    v_mfma_f32_16x16x32_bf16 v[120:123], a[60:63], v[44:47], v[120:123]
    v_mfma_f32_16x16x32_bf16 v[124:127], a[60:63], v[48:51], v[124:127]
    v_mfma_f32_16x16x32_bf16 v[128:131], a[60:63], v[52:55], v[128:131]
    s_waitcnt vmcnt(25) lgkmcnt(0)
    v_mfma_f32_16x16x32_bf16 v[56:59], a[64:67], v[20:23], v[56:59]
    ds_read_b128 v[36:39], v6 offset:30720
    v_mfma_f32_16x16x32_bf16 v[60:63], a[64:67], v[24:27], v[60:63]
    ds_read_b128 v[40:43], v6 offset:31744
    v_mfma_f32_16x16x32_bf16 v[64:67], a[64:67], v[28:31], v[64:67]
    ds_read_b128 v[44:47], v6 offset:32768
    v_mfma_f32_16x16x32_bf16 v[68:71], a[64:67], v[32:35], v[68:71]
    ds_read_b128 v[48:51], v6 offset:33792
    v_mfma_f32_16x16x32_bf16 v[72:75], a[68:71], v[16:19], v[72:75]
    ds_read_b128 v[52:55], v6 offset:34816
    v_mfma_f32_16x16x32_bf16 v[76:79], a[68:71], v[20:23], v[76:79]
    buffer_load_dwordx4 a[204:207], v5, s[8:11], s34 offen offset:3072 sc1
    s_add_u32 s34, s34, 4096
    v_mfma_f32_16x16x32_bf16 v[80:83], a[68:71], v[24:27], v[80:83]
    v_mfma_f32_16x16x32_bf16 v[84:87], a[68:71], v[28:31], v[84:87]
    buffer_load_dwordx4 a[208:211], v253, s[8:11], s32 offen offset:0 sc1
    v_mfma_f32_16x16x32_bf16 v[88:91], a[68:71], v[32:35], v[88:91]
    v_mfma_f32_16x16x32_bf16 v[92:95], v[16:19], a[72:75], v[92:95]
    buffer_load_dwordx4 a[212:215], v253, s[8:11], s33 offen offset:0 sc1
    v_mfma_f32_16x16x32_bf16 v[96:99], v[20:23], a[72:75], v[96:99]
    v_mfma_f32_16x16x32_bf16 v[100:103], v[24:27], a[72:75], v[100:103]
    buffer_load_dwordx4 a[216:219], v5, s[8:11], s34 offen offset:0 sc1
    v_mfma_f32_16x16x32_bf16 v[104:107], v[28:31], a[72:75], v[104:107]
    v_mfma_f32_16x16x32_bf16 v[108:111], v[32:35], a[72:75], v[108:111]
    v_mfma_f32_16x16x32_bf16 v[112:115], a[76:79], v[16:19], v[112:115]
    v_mfma_f32_16x16x32_bf16 v[116:119], a[76:79], v[20:23], v[116:119]
    v_mfma_f32_16x16x32_bf16 v[120:123], a[76:79], v[24:27], v[120:123]
    v_mfma_f32_16x16x32_bf16 v[124:127], a[76:79], v[28:31], v[124:127]
    v_mfma_f32_16x16x32_bf16 v[128:131], a[76:79], v[32:35], v[128:131]
    s_waitcnt vmcnt(23) lgkmcnt(0)
    v_mfma_f32_16x16x32_bf16 v[56:59], a[80:83], v[40:43], v[56:59]
    ds_read_b128 v[16:19], v6 offset:35840
    v_mfma_f32_16x16x32_bf16 v[60:63], a[80:83], v[44:47], v[60:63]
    ds_read_b128 v[20:23], v6 offset:36864
    v_mfma_f32_16x16x32_bf16 v[64:67], a[80:83], v[48:51], v[64:67]
    ds_read_b128 v[24:27], v6 offset:37888
    v_mfma_f32_16x16x32_bf16 v[68:71], a[80:83], v[52:55], v[68:71]
    ds_read_b128 v[28:31], v6 offset:38912
    v_mfma_f32_16x16x32_bf16 v[72:75], a[84:87], v[36:39], v[72:75]
    ds_read_b128 v[32:35], v6 offset:39936
    v_mfma_f32_16x16x32_bf16 v[76:79], a[84:87], v[40:43], v[76:79]
    buffer_load_dwordx4 a[220:223], v253, s[8:11], s32 offen offset:1024 sc1
    v_mfma_f32_16x16x32_bf16 v[80:83], a[84:87], v[44:47], v[80:83]
    v_mfma_f32_16x16x32_bf16 v[84:87], a[84:87], v[48:51], v[84:87]
    buffer_load_dwordx4 a[224:227], v253, s[8:11], s33 offen offset:1024 sc1
    v_mfma_f32_16x16x32_bf16 v[88:91], a[84:87], v[52:55], v[88:91]
    v_mfma_f32_16x16x32_bf16 v[92:95], v[36:39], a[88:91], v[92:95]
    buffer_load_dwordx4 a[228:231], v5, s[8:11], s34 offen offset:1024 sc1
    v_mfma_f32_16x16x32_bf16 v[96:99], v[40:43], a[88:91], v[96:99]
    v_mfma_f32_16x16x32_bf16 v[100:103], v[44:47], a[88:91], v[100:103]
    buffer_load_dwordx4 a[232:235], v253, s[8:11], s32 offen offset:2048 sc1
    v_mfma_f32_16x16x32_bf16 v[104:107], v[48:51], a[88:91], v[104:107]
    v_mfma_f32_16x16x32_bf16 v[108:111], v[52:55], a[88:91], v[108:111]
    v_mfma_f32_16x16x32_bf16 v[112:115], a[92:95], v[36:39], v[112:115]
    v_mfma_f32_16x16x32_bf16 v[116:119], a[92:95], v[40:43], v[116:119]
    v_mfma_f32_16x16x32_bf16 v[120:123], a[92:95], v[44:47], v[120:123]
    v_mfma_f32_16x16x32_bf16 v[124:127], a[92:95], v[48:51], v[124:127]
    v_mfma_f32_16x16x32_bf16 v[128:131], a[92:95], v[52:55], v[128:131]
    s_waitcnt vmcnt(22) lgkmcnt(0)
    v_mfma_f32_16x16x32_bf16 v[56:59], a[96:99], v[20:23], v[56:59]
    ds_read_b128 v[36:39], v6 offset:40960
    v_mfma_f32_16x16x32_bf16 v[60:63], a[96:99], v[24:27], v[60:63]
    ds_read_b128 v[40:43], v6 offset:41984
    v_mfma_f32_16x16x32_bf16 v[64:67], a[96:99], v[28:31], v[64:67]
    ds_read_b128 v[44:47], v6 offset:43008
    v_mfma_f32_16x16x32_bf16 v[68:71], a[96:99], v[32:35], v[68:71]
    ds_read_b128 v[48:51], v6 offset:44032
    v_mfma_f32_16x16x32_bf16 v[72:75], a[100:103], v[16:19], v[72:75]
    ds_read_b128 v[52:55], v6 offset:45056
    v_mfma_f32_16x16x32_bf16 v[76:79], a[100:103], v[20:23], v[76:79]
    buffer_load_dwordx4 a[236:239], v253, s[8:11], s33 offen offset:2048 sc1
    v_mfma_f32_16x16x32_bf16 v[80:83], a[100:103], v[24:27], v[80:83]
    v_mfma_f32_16x16x32_bf16 v[84:87], a[100:103], v[28:31], v[84:87]
    buffer_load_dwordx4 a[240:243], v5, s[8:11], s34 offen offset:2048 sc1
    v_mfma_f32_16x16x32_bf16 v[88:91], a[100:103], v[32:35], v[88:91]
    v_mfma_f32_16x16x32_bf16 v[92:95], v[16:19], a[104:107], v[92:95]
    buffer_load_dwordx4 a[244:247], v253, s[8:11], s32 offen offset:3072 sc1
    s_add_u32 s32, s32, 4096
    v_mfma_f32_16x16x32_bf16 v[96:99], v[20:23], a[104:107], v[96:99]
    v_mfma_f32_16x16x32_bf16 v[100:103], v[24:27], a[104:107], v[100:103]
    buffer_load_dwordx4 a[248:251], v253, s[8:11], s33 offen offset:3072 sc1
    s_add_u32 s33, s33, 4096
    v_mfma_f32_16x16x32_bf16 v[104:107], v[28:31], a[104:107], v[104:107]
    v_mfma_f32_16x16x32_bf16 v[108:111], v[32:35], a[104:107], v[108:111]
    v_mfma_f32_16x16x32_bf16 v[112:115], a[108:111], v[16:19], v[112:115]
    v_mfma_f32_16x16x32_bf16 v[116:119], a[108:111], v[20:23], v[116:119]
    v_mfma_f32_16x16x32_bf16 v[120:123], a[108:111], v[24:27], v[120:123]
    v_mfma_f32_16x16x32_bf16 v[124:127], a[108:111], v[28:31], v[124:127]
    v_mfma_f32_16x16x32_bf16 v[128:131], a[108:111], v[32:35], v[128:131]
    s_waitcnt vmcnt(21) lgkmcnt(0)
    v_mfma_f32_16x16x32_bf16 v[56:59], a[112:115], v[40:43], v[56:59]
    v_mfma_f32_16x16x32_bf16 v[60:63], a[112:115], v[44:47], v[60:63]
    v_mfma_f32_16x16x32_bf16 v[64:67], a[112:115], v[48:51], v[64:67]
    v_mfma_f32_16x16x32_bf16 v[68:71], a[112:115], v[52:55], v[68:71]
    v_mfma_f32_16x16x32_bf16 v[72:75], a[116:119], v[36:39], v[72:75]
    v_mfma_f32_16x16x32_bf16 v[76:79], a[116:119], v[40:43], v[76:79]
    buffer_load_dwordx4 a[252:255], v5, s[8:11], s34 offen offset:3072 sc1
    s_add_u32 s34, s34, 4096
    v_mfma_f32_16x16x32_bf16 v[80:83], a[116:119], v[44:47], v[80:83]
    v_mfma_f32_16x16x32_bf16 v[84:87], a[116:119], v[48:51], v[84:87]
    buffer_load_dwordx4 a[128:131], v253, s[8:11], s32 offen offset:0 sc1
    v_mfma_f32_16x16x32_bf16 v[88:91], a[116:119], v[52:55], v[88:91]
    v_mfma_f32_16x16x32_bf16 v[92:95], v[36:39], a[120:123], v[92:95]
    buffer_load_dwordx4 a[132:135], v253, s[8:11], s33 offen offset:0 sc1
    v_mfma_f32_16x16x32_bf16 v[96:99], v[40:43], a[120:123], v[96:99]
    v_mfma_f32_16x16x32_bf16 v[100:103], v[44:47], a[120:123], v[100:103]
    buffer_load_dwordx4 a[136:139], v5, s[8:11], s34 offen offset:0 sc1
    v_mfma_f32_16x16x32_bf16 v[104:107], v[48:51], a[120:123], v[104:107]
    v_mfma_f32_16x16x32_bf16 v[108:111], v[52:55], a[120:123], v[108:111]
    v_mfma_f32_16x16x32_bf16 v[112:115], a[124:127], v[36:39], v[112:115]
    v_mfma_f32_16x16x32_bf16 v[116:119], a[124:127], v[40:43], v[116:119]
    v_mfma_f32_16x16x32_bf16 v[120:123], a[124:127], v[44:47], v[120:123]
    v_mfma_f32_16x16x32_bf16 v[124:127], a[124:127], v[48:51], v[124:127]
    v_mfma_f32_16x16x32_bf16 v[128:131], a[124:127], v[52:55], v[128:131]
    v_cvt_pk_bf16_f32 v136, v56, v57
    v_cvt_pk_bf16_f32 v137, v58, v59
    v_cvt_pk_bf16_f32 v140, v60, v61
    v_cvt_pk_bf16_f32 v141, v62, v63
    v_cvt_pk_bf16_f32 v144, v64, v65
    v_cvt_pk_bf16_f32 v145, v66, v67
    v_cvt_pk_bf16_f32 v148, v68, v69
    v_cvt_pk_bf16_f32 v149, v70, v71
    v_cvt_pk_bf16_f32 v152, v72, v73
    buffer_load_dwordx4 a[140:143], v253, s[8:11], s32 offen offset:1024 sc1
    v_cvt_pk_bf16_f32 v153, v74, v75
    v_cvt_pk_bf16_f32 v156, v76, v77
    v_cvt_pk_bf16_f32 v157, v78, v79
    v_cvt_pk_bf16_f32 v160, v80, v81
    v_cvt_pk_bf16_f32 v161, v82, v83
    v_cvt_pk_bf16_f32 v164, v84, v85
    v_cvt_pk_bf16_f32 v165, v86, v87
    v_cvt_pk_bf16_f32 v168, v88, v89
    v_cvt_pk_bf16_f32 v169, v90, v91
    buffer_load_dwordx4 a[144:147], v253, s[8:11], s33 offen offset:1024 sc1
    v_cvt_pk_bf16_f32 v134, v112, v113
    v_cvt_pk_bf16_f32 v154, v114, v115
    v_cvt_pk_bf16_f32 v138, v116, v117
    v_cvt_pk_bf16_f32 v158, v118, v119
    v_cvt_pk_bf16_f32 v142, v120, v121
    v_cvt_pk_bf16_f32 v162, v122, v123
    v_cvt_pk_bf16_f32 v146, v124, v125
    v_cvt_pk_bf16_f32 v166, v126, v127
    v_cvt_pk_bf16_f32 v150, v128, v129
    buffer_load_dwordx4 a[148:151], v5, s[8:11], s34 offen offset:1024 sc1
    v_cvt_pk_bf16_f32 v170, v130, v131
    v_cvt_pk_bf16_f32 v172, v92, v93
    v_cvt_pk_bf16_f32 v173, v94, v95
    v_cvt_pk_bf16_f32 v174, v96, v97
    v_cvt_pk_bf16_f32 v175, v98, v99
    v_cvt_pk_bf16_f32 v176, v100, v101
    v_cvt_pk_bf16_f32 v177, v102, v103
    v_cvt_pk_bf16_f32 v178, v104, v105
    v_cvt_pk_bf16_f32 v179, v106, v107
    buffer_load_dwordx4 a[152:155], v253, s[8:11], s32 offen offset:2048 sc1
    v_cvt_pk_bf16_f32 v180, v108, v109
    v_cvt_pk_bf16_f32 v181, v110, v111
    v_mfma_f32_16x16x32_bf16 v[16:19], v[152:155], v[136:139], v[208:211]
    v_mfma_f32_16x16x32_bf16 v[20:23], v[156:159], v[136:139], v[204:207]
    v_mfma_f32_16x16x32_bf16 v[24:27], v[156:159], v[140:143], v[200:203]
    v_mfma_f32_16x16x32_bf16 v[28:31], v[160:163], v[140:143], v[204:207]
    v_mfma_f32_16x16x32_bf16 v[32:35], v[160:163], v[144:147], v[200:203]
    v_mfma_f32_16x16x32_bf16 v[36:39], v[164:167], v[144:147], v[204:207]
    v_mfma_f32_16x16x32_bf16 v[40:43], v[164:167], v[148:151], v[200:203]
    buffer_load_dwordx4 a[156:159], v253, s[8:11], s33 offen offset:2048 sc1
    v_mfma_f32_16x16x32_bf16 v[44:47], v[168:171], v[148:151], v[204:207]
    v_mfma_f32_16x16x32_bf16 v[56:59], v[132:135], v[192:195], v[196:199]
    v_mfma_f32_16x16x32_bf16 v[60:63], v[136:139], v[192:195], v[196:199]
    v_mfma_f32_16x16x32_bf16 v[64:67], v[140:143], v[192:195], v[196:199]
    v_mfma_f32_16x16x32_bf16 v[68:71], v[144:147], v[192:195], v[196:199]
    v_mfma_f32_16x16x32_bf16 v[72:75], v[148:151], v[192:195], v[196:199]
    v_max3_f32 v92, v16, v17, v18
    v_max3_f32 v96, v19, v20, v21
    v_max3_f32 v93, v24, v25, v26
    buffer_load_dwordx4 a[0:3], v5, s[8:11], s34 offen offset:2048 sc1
    v_max3_f32 v97, v27, v28, v29
    v_max3_f32 v94, v32, v33, v34
    v_max3_f32 v98, v35, v36, v37
    v_max3_f32 v95, v40, v41, v42
    v_max3_f32 v99, v43, v44, v45
    v_max3_f32 v92, v92, v22, v23
    v_max3_f32 v93, v93, v30, v31
    v_max3_f32 v94, v94, v38, v39
    v_max3_f32 v95, v95, v46, v47
    buffer_load_dwordx4 a[4:7], v253, s[8:11], s32 offen offset:3072 sc1
    s_add_u32 s32, s32, 4096
    v_max_f32 v92, v92, v96
    v_max_f32 v93, v93, v97
    v_max_f32 v94, v94, v98
    v_max_f32 v95, v95, v99
    s_mov_b32 s18, 0x3eae1a93
    v_cvt_pk_bf16_f32 v182, v56, v57
    v_permlane32_swap_b32 v92, v93
    v_permlane32_swap_b32 v94, v95
    v_max_f32 v92, v92, v93
    buffer_load_dwordx4 a[8:11], v253, s[8:11], s33 offen offset:3072 sc1
    s_add_u32 s33, s33, 4096
    v_max_f32 v94, v94, v95
    v_cvt_pk_bf16_f32 v183, v58, v59
    v_cvt_pk_bf16_f32 v184, v60, v61
    v_permlane16_swap_b32 v92, v94
    v_max_f32 v92, v92, v94
    v_mul_f32 v92, 0xbeae1a93, v92
    v_mov_b32 v94, v92
    v_cvt_pk_bf16_f32 v185, v62, v63
    v_cvt_pk_bf16_f32 v186, v64, v65
    buffer_load_dwordx4 a[12:15], v5, s[8:11], s34 offen offset:3072 sc1
    s_add_u32 s34, s34, 4096
    v_permlane16_swap_b32 v92, v94
    v_mov_b32 v93, v92
    v_mov_b32 v95, v94
    v_cvt_pk_bf16_f32 v187, v66, v67
    v_cvt_pk_bf16_f32 v188, v68, v69
    v_permlane32_swap_b32 v92, v93
    v_permlane32_swap_b32 v94, v95
    v_cvt_pk_bf16_f32 v189, v70, v71
    v_cvt_pk_bf16_f32 v190, v72, v73
    buffer_load_dwordx4 a[16:19], v253, s[8:11], s32 offen offset:0 sc1
    v_cvt_pk_bf16_f32 v191, v74, v75
    v_fma_f32 v16, v16, s18, v92
    v_fma_f32 v17, v17, s18, v92
    v_fma_f32 v18, v18, s18, v92
    v_fma_f32 v19, v19, s18, v92
    v_fma_f32 v20, v20, s18, v92
    v_fma_f32 v21, v21, s18, v92
    v_fma_f32 v22, v22, s18, v92
    v_fma_f32 v23, v23, s18, v92
    buffer_load_dwordx4 a[20:23], v253, s[8:11], s33 offen offset:0 sc1
    v_exp_f32 v16, v16
    v_exp_f32 v17, v17
    v_exp_f32 v18, v18
    v_exp_f32 v19, v19
    v_exp_f32 v20, v20
    v_exp_f32 v21, v21
    v_exp_f32 v22, v22
    v_exp_f32 v23, v23
    s_nop 0
    buffer_load_dwordx4 a[24:27], v5, s[8:11], s34 offen offset:0 sc1
    v_cvt_pk_bf16_f32 v76, v16, v17
    v_cvt_pk_bf16_f32 v77, v18, v19
    v_cvt_pk_bf16_f32 v78, v20, v21
    v_cvt_pk_bf16_f32 v79, v22, v23
    v_fma_f32 v24, v24, s18, v93
    v_fma_f32 v25, v25, s18, v93
    v_fma_f32 v26, v26, s18, v93
    v_fma_f32 v27, v27, s18, v93
    v_fma_f32 v28, v28, s18, v93
    buffer_load_dwordx4 a[28:31], v253, s[8:11], s32 offen offset:1024 sc1
    v_fma_f32 v29, v29, s18, v93
    v_fma_f32 v30, v30, s18, v93
    v_fma_f32 v31, v31, s18, v93
    v_exp_f32 v24, v24
    v_exp_f32 v25, v25
    v_exp_f32 v26, v26
    v_exp_f32 v27, v27
    v_exp_f32 v28, v28
    v_exp_f32 v29, v29
    buffer_load_dwordx4 a[32:35], v253, s[8:11], s33 offen offset:1024 sc1
    v_exp_f32 v30, v30
    v_exp_f32 v31, v31
    v_mfma_f32_16x16x32_bf16 v[100:103], v[172:175], v[76:79], 0
    v_mfma_f32_16x16x32_bf16 v[116:119], v[182:185], v[76:79], 0
    v_cvt_pk_bf16_f32 v80, v24, v25
    v_cvt_pk_bf16_f32 v81, v26, v27
    v_cvt_pk_bf16_f32 v82, v28, v29
    v_cvt_pk_bf16_f32 v83, v30, v31
    v_fma_f32 v32, v32, s18, v94
    buffer_load_dwordx4 a[36:39], v5, s[8:11], s34 offen offset:1024 sc1
    v_fma_f32 v33, v33, s18, v94
    v_fma_f32 v34, v34, s18, v94
    v_fma_f32 v35, v35, s18, v94
    v_fma_f32 v36, v36, s18, v94
    v_fma_f32 v37, v37, s18, v94
    v_fma_f32 v38, v38, s18, v94
    v_fma_f32 v39, v39, s18, v94
    v_exp_f32 v32, v32
    v_exp_f32 v33, v33
    buffer_load_dwordx4 a[40:43], v253, s[8:11], s32 offen offset:2048 sc1
    v_exp_f32 v34, v34
    v_exp_f32 v35, v35
    v_exp_f32 v36, v36
    v_exp_f32 v37, v37
    v_exp_f32 v38, v38
    v_exp_f32 v39, v39
    v_mfma_f32_16x16x32_bf16 v[104:107], v[174:177], v[80:83], 0
    v_mfma_f32_16x16x32_bf16 v[120:123], v[184:187], v[80:83], 0
    v_cvt_pk_bf16_f32 v84, v32, v33
    buffer_load_dwordx4 a[44:47], v253, s[8:11], s33 offen offset:2048 sc1
    v_cvt_pk_bf16_f32 v85, v34, v35
    v_cvt_pk_bf16_f32 v86, v36, v37
    v_cvt_pk_bf16_f32 v87, v38, v39
    v_fma_f32 v40, v40, s18, v95
    v_fma_f32 v41, v41, s18, v95
    v_fma_f32 v42, v42, s18, v95
    v_fma_f32 v43, v43, s18, v95
    v_fma_f32 v44, v44, s18, v95
    v_fma_f32 v45, v45, s18, v95
    buffer_load_dwordx4 a[48:51], v5, s[8:11], s34 offen offset:2048 sc1
    v_fma_f32 v46, v46, s18, v95
    v_fma_f32 v47, v47, s18, v95
    v_exp_f32 v40, v40
    v_exp_f32 v41, v41
    v_exp_f32 v42, v42
    v_exp_f32 v43, v43
    v_exp_f32 v44, v44
    v_exp_f32 v45, v45
    v_exp_f32 v46, v46
    buffer_load_dwordx4 a[52:55], v253, s[8:11], s32 offen offset:3072 sc1
    s_add_u32 s32, s32, 4096
    v_exp_f32 v47, v47
    v_mfma_f32_16x16x32_bf16 v[108:111], v[176:179], v[84:87], 0
    v_mfma_f32_16x16x32_bf16 v[124:127], v[186:189], v[84:87], 0
    v_cvt_pk_bf16_f32 v88, v40, v41
    v_cvt_pk_bf16_f32 v89, v42, v43
    v_cvt_pk_bf16_f32 v90, v44, v45
    v_cvt_pk_bf16_f32 v91, v46, v47
    v_rcp_f32 v96, v118
    v_rcp_f32 v97, v122
    buffer_load_dwordx4 v[240:243], v9, s[8:11], s37 offen offset:0 sc1
    v_mfma_f32_16x16x32_bf16 v[112:115], v[178:181], v[88:91], 0
    v_mfma_f32_16x16x32_bf16 v[128:131], v[188:191], v[88:91], 0
    v_pk_mul_f32 v[100:101], v[96:97], v[100:101] op_sel:[0,0] op_sel_hi:[0,1]
    v_pk_mul_f32 v[102:103], v[96:97], v[102:103] op_sel:[0,0] op_sel_hi:[0,1]
    v_pk_mul_f32 v[116:117], v[96:97], v[116:117] op_sel:[0,0] op_sel_hi:[0,1]
    v_cvt_pk_bf16_f32 v212, v100, v101
    v_cvt_pk_bf16_f32 v213, v102, v103
    v_cvt_pk_bf16_f32 v220, v116, v117
    v_rcp_f32 v98, v126
    buffer_load_dwordx4 v[244:247], v9, s[8:11], s37 offen offset:1024 sc1
    v_pk_mul_f32 v[104:105], v[96:97], v[104:105] op_sel:[1,0] op_sel_hi:[1,1]
    v_pk_mul_f32 v[106:107], v[96:97], v[106:107] op_sel:[1,0] op_sel_hi:[1,1]
    v_pk_mul_f32 v[120:121], v[96:97], v[120:121] op_sel:[1,0] op_sel_hi:[1,1]
    v_cvt_pk_bf16_f32 v214, v104, v105
    v_cvt_pk_bf16_f32 v215, v106, v107
    v_cvt_pk_bf16_f32 v221, v120, v121
    v_rcp_f32 v99, v130
    v_permlane16_swap_b32 v212, v214
    v_permlane16_swap_b32 v213, v215
    buffer_load_dwordx4 v[248:251], v7, s[8:11], s37 offen offset:2048 sc1
    v_pk_mul_f32 v[108:109], v[98:99], v[108:109] op_sel:[0,0] op_sel_hi:[0,1]
    v_pk_mul_f32 v[110:111], v[98:99], v[110:111] op_sel:[0,0] op_sel_hi:[0,1]
    v_pk_mul_f32 v[124:125], v[98:99], v[124:125] op_sel:[0,0] op_sel_hi:[0,1]
    v_cvt_pk_bf16_f32 v216, v108, v109
    v_cvt_pk_bf16_f32 v217, v110, v111
    v_cvt_pk_bf16_f32 v222, v124, v125
    v_pk_mul_f32 v[112:113], v[98:99], v[112:113] op_sel:[1,0] op_sel_hi:[1,1]
    v_pk_mul_f32 v[114:115], v[98:99], v[114:115] op_sel:[1,0] op_sel_hi:[1,1]
    v_pk_mul_f32 v[128:129], v[98:99], v[128:129] op_sel:[1,0] op_sel_hi:[1,1]
    buffer_load_dword v252, v8, s[8:11], s47 offen sc1
    v_cvt_pk_bf16_f32 v218, v112, v113
    v_cvt_pk_bf16_f32 v219, v114, v115
    v_cvt_pk_bf16_f32 v223, v128, v129
    s_lshl_b32 s7, s3, 2
    s_add_u32 s7, s7, 94208
    v_permlane16_swap_b32 v220, v221
    v_permlane16_swap_b32 v222, v223
    v_add_u32 v11, s7, v253
    v_lshrrev_b32 v10, 3, v0
    v_permlane32_swap_b32 v220, v222
    v_mul_u32_u24 v10, 9216, v10
    ds_write_b32 v11, v220
    v_permlane16_swap_b32 v216, v218
    v_permlane16_swap_b32 v217, v219
    s_mul_i32 s7, s40, 1152
    s_add_u32 s22, s22, s7
    s_add_u32 s22, s22, 41156608
    s_lshl_b32 s7, s3, 8
    s_add_u32 s23, s22, s7
    s_add_u32 s24, s23, 36864
    buffer_store_dwordx4 v[212:215], v9, s[8:11], s23 offen sc1
    buffer_store_dwordx4 v[216:219], v9, s[8:11], s24 offen sc1
    v_and_b32 v11, 7, v0
    v_lshl_add_u32 v10, v11, 4, v10
    s_cmp_eq_u32 s3, 3
    s_cselect_b32 s7, 0, 1073741824
    v_add_u32 v10, s7, v10
    v_add_u32 v11, 94208, v253
    s_waitcnt lgkmcnt(0)
    s_barrier
    ds_read_b128 v[220:223], v11
    s_waitcnt lgkmcnt(0)
    buffer_store_dwordx4 v[220:223], v10, s[8:11], s22 offen offset:1024 sc1
    v_lshlrev_b32 v15, 7, v0
    s_lshl_b32 s6, s40, 2
    s_add_u32 s6, s6, s44
    v_mov_b32 v1, s76
    s_mov_b64 vcc, 0xff
    s_waitcnt vmcnt(0)
    s_barrier
    s_cmp_lg_u32 s3, 0
    s_cbranch_scc1 L_pub_17
    s_mov_b64 exec, vcc
    buffer_store_dword v1, v15, s[8:11], s6 offen sc1
L_pub_17:
    s_mov_b64 exec, -1
    buffer_load_dwordx4 a[56:59], v253, s[8:11], s33 offen offset:3072 sc1
    s_add_u32 s33, s33, 4096
    buffer_load_dwordx4 a[60:63], v5, s[8:11], s34 offen offset:3072 sc1
    s_add_u32 s34, s34, 4096
    buffer_load_dwordx4 a[64:67], v253, s[8:11], s32 offen offset:0 sc1
    buffer_load_dwordx4 a[68:71], v253, s[8:11], s33 offen offset:0 sc1
    buffer_load_dwordx4 a[72:75], v5, s[8:11], s34 offen offset:0 sc1
    buffer_load_dwordx4 a[76:79], v253, s[8:11], s32 offen offset:1024 sc1
    buffer_load_dwordx4 a[80:83], v253, s[8:11], s33 offen offset:1024 sc1
    buffer_load_dwordx4 a[84:87], v5, s[8:11], s34 offen offset:1024 sc1
    s_cmp_lg_u32 s42, 0
    s_cbranch_scc1 L_swz_18
    s_cmp_eq_u32 s93, 2
    s_cselect_b32 s6, 2, 3
    s_mov_b32 s7, 512
    s_cmov_b32 s7, 2048
    v_lshrrev_b32 v14, 4, v0
    v_lshlrev_b32 v14, s6, v14
    v_bfe_u32 v15, v0, 2, 2
    v_add_u32 v14, v14, v15
    v_mul_u32_u24 v14, 128, v14
    v_and_b32 v15, 3, v0
    v_lshl_add_u32 v14, v15, 3, v14
    v_add_u32 v14, s79, v14
    v_add_u32 v15, s7, v14
    ds_read_b64_tr_b16 v[76:77], v14 offset:0
    ds_read_b64_tr_b16 v[78:79], v15 offset:0
    ds_read_b64_tr_b16 v[80:81], v14 offset:32
    ds_read_b64_tr_b16 v[82:83], v15 offset:32
    ds_read_b64_tr_b16 v[84:85], v14 offset:64
    ds_read_b64_tr_b16 v[86:87], v15 offset:64
    ds_read_b64_tr_b16 v[88:89], v14 offset:96
    ds_read_b64_tr_b16 v[90:91], v15 offset:96
    ds_read_b64_tr_b16 v[92:93], v14 offset:4096
    ds_read_b64_tr_b16 v[94:95], v15 offset:4096
    ds_read_b64_tr_b16 v[96:97], v14 offset:4128
    ds_read_b64_tr_b16 v[98:99], v15 offset:4128
    ds_read_b64_tr_b16 v[176:177], v14 offset:4160
    ds_read_b64_tr_b16 v[178:179], v15 offset:4160
    ds_read_b64_tr_b16 v[180:181], v14 offset:4192
    ds_read_b64_tr_b16 v[182:183], v15 offset:4192
    ds_read_b64_tr_b16 v[196:197], v14 offset:8192
    ds_read_b64_tr_b16 v[198:199], v15 offset:8192
    ds_read_b64_tr_b16 v[200:201], v14 offset:8224
    ds_read_b64_tr_b16 v[202:203], v15 offset:8224
    ds_read_b64_tr_b16 v[204:205], v14 offset:8256
    ds_read_b64_tr_b16 v[206:207], v15 offset:8256
    ds_read_b64_tr_b16 v[208:209], v14 offset:8288
    ds_read_b64_tr_b16 v[210:211], v15 offset:8288
    ds_read_b64_tr_b16 v[212:213], v14 offset:12288
    ds_read_b64_tr_b16 v[214:215], v15 offset:12288
    ds_read_b64_tr_b16 v[216:217], v14 offset:12320
    ds_read_b64_tr_b16 v[218:219], v15 offset:12320
    ds_read_b64_tr_b16 v[220:221], v14 offset:12352
    ds_read_b64_tr_b16 v[222:223], v15 offset:12352
    ds_read_b64_tr_b16 v[228:229], v14 offset:12384
    ds_read_b64_tr_b16 v[230:231], v15 offset:12384
    s_mul_i32 s68, s40, 1990656
    s_add_u32 s68, s68, 3145728
    s_cmp_eq_u32 s93, 2
    s_cbranch_scc1 L_swz_down_19
    s_mul_i32 s6, s84, 349526
    s_lshr_b32 s6, s6, 20
    s_mul_i32 s7, s6, 3
    s_sub_u32 s7, s84, s7
    s_mul_i32 s6, s6, 6
    s_add_u32 s7, s7, s6
    s_mul_i32 s6, s88, 36
    s_add_u32 s7, s7, s6
    s_mul_i32 s6, s93, 3
    s_add_u32 s7, s7, s6
    s_lshl_b32 s7, s7, 10
    s_add_u32 s7, s7, s68
    s_add_u32 s80, s7, 0
    s_add_u32 s81, s7, 497664
    s_add_u32 s82, s7, 995328
    s_add_u32 s83, s7, 1492992
    s_mul_i32 s6, s85, 349526
    s_lshr_b32 s6, s6, 20
    s_mul_i32 s7, s6, 3
    s_sub_u32 s7, s85, s7
    s_mul_i32 s6, s6, 6
    s_add_u32 s7, s7, s6
    s_mul_i32 s6, s89, 36
    s_add_u32 s7, s7, s6
    s_mul_i32 s6, s93, 3
    s_add_u32 s7, s7, s6
    s_lshl_b32 s7, s7, 10
    s_add_u32 s7, s7, s68
    s_add_u32 s64, s7, 0
    s_add_u32 s65, s7, 497664
    s_add_u32 s18, s7, 995328
    s_add_u32 s19, s7, 1492992
    s_mul_i32 s6, s86, 349526
    s_lshr_b32 s6, s6, 20
    s_mul_i32 s7, s6, 3
    s_sub_u32 s7, s86, s7
    s_mul_i32 s6, s6, 6
    s_add_u32 s7, s7, s6
    s_mul_i32 s6, s90, 36
    s_add_u32 s7, s7, s6
    s_mul_i32 s6, s93, 3
    s_add_u32 s7, s7, s6
    s_lshl_b32 s7, s7, 10
    s_add_u32 s7, s7, s68
    s_add_u32 s20, s7, 0
    s_add_u32 s21, s7, 497664
    s_add_u32 s22, s7, 995328
    s_add_u32 s25, s7, 1492992
    s_mul_i32 s6, s87, 349526
    s_lshr_b32 s6, s6, 20
    s_mul_i32 s7, s6, 3
    s_sub_u32 s7, s87, s7
    s_mul_i32 s6, s6, 6
    s_add_u32 s7, s7, s6
    s_mul_i32 s6, s91, 36
    s_add_u32 s7, s7, s6
    s_mul_i32 s6, s93, 3
    s_add_u32 s7, s7, s6
    s_lshl_b32 s7, s7, 10
    s_add_u32 s7, s7, s68
    s_add_u32 s26, s7, 0
    s_add_u32 s27, s7, 497664
    s_add_u32 s28, s7, 995328
    s_add_u32 s29, s7, 1492992
    s_branch L_swz_dest_20
L_swz_down_19:
    s_mul_i32 s7, s88, 18
    s_add_u32 s7, s7, s84
    s_add_u32 s7, s7, 324
    s_lshl_b32 s7, s7, 10
    s_add_u32 s7, s7, s68
    s_add_u32 s80, s7, 0
    s_add_u32 s81, s7, 497664
    s_add_u32 s82, s7, 995328
    s_add_u32 s83, s7, 1492992
    s_mul_i32 s7, s89, 18
    s_add_u32 s7, s7, s85
    s_add_u32 s7, s7, 324
    s_lshl_b32 s7, s7, 10
    s_add_u32 s7, s7, s68
    s_add_u32 s64, s7, 0
    s_add_u32 s65, s7, 497664
    s_add_u32 s18, s7, 995328
    s_add_u32 s19, s7, 1492992
    s_mul_i32 s7, s90, 18
    s_add_u32 s7, s7, s86
    s_add_u32 s7, s7, 324
    s_lshl_b32 s7, s7, 10
    s_add_u32 s7, s7, s68
    s_add_u32 s20, s7, 0
    s_add_u32 s21, s7, 497664
    s_add_u32 s22, s7, 995328
    s_add_u32 s25, s7, 1492992
    s_mul_i32 s7, s91, 18
    s_add_u32 s7, s7, s87
    s_add_u32 s7, s7, 324
    s_lshl_b32 s7, s7, 10
    s_add_u32 s7, s7, s68
    s_add_u32 s26, s7, 0
    s_add_u32 s27, s7, 497664
    s_add_u32 s28, s7, 995328
    s_add_u32 s29, s7, 1492992
L_swz_dest_20:
    s_mov_b32 s72, s8
    s_mov_b32 s73, s9
    s_mov_b32 s74, 268435456
    s_waitcnt lgkmcnt(0)
    buffer_store_dwordx4 v[76:79], v253, s[72:75], s80 offen sc1
    buffer_store_dwordx4 v[80:83], v253, s[72:75], s81 offen sc1
    buffer_store_dwordx4 v[84:87], v253, s[72:75], s82 offen sc1
    buffer_store_dwordx4 v[88:91], v253, s[72:75], s83 offen sc1
    buffer_store_dwordx4 v[92:95], v253, s[72:75], s64 offen sc1
    buffer_store_dwordx4 v[96:99], v253, s[72:75], s65 offen sc1
    buffer_store_dwordx4 v[176:179], v253, s[72:75], s18 offen sc1
    buffer_store_dwordx4 v[180:183], v253, s[72:75], s19 offen sc1
    buffer_store_dwordx4 v[196:199], v253, s[72:75], s20 offen sc1
    buffer_store_dwordx4 v[200:203], v253, s[72:75], s21 offen sc1
    buffer_store_dwordx4 v[204:207], v253, s[72:75], s22 offen sc1
    buffer_store_dwordx4 v[208:211], v253, s[72:75], s25 offen sc1
    buffer_store_dwordx4 v[212:215], v253, s[72:75], s26 offen sc1
    buffer_store_dwordx4 v[216:219], v253, s[72:75], s27 offen sc1
    buffer_store_dwordx4 v[220:223], v253, s[72:75], s28 offen sc1
    buffer_store_dwordx4 v[228:231], v253, s[72:75], s29 offen sc1
    s_lshr_b32 s7, s2, 3
    s_lshl_b32 s7, s7, 2
    s_add_u32 s7, s7, s3
    s_lshl_b32 s7, s7, 9
    v_lshrrev_b32 v1, 1, v253
    v_add_u32 v1, s7, v1
    buffer_load_dwordx2 v[14:15], v1, s[96:99], 0 offen
L_swz_18:
    s_and_b32 s7, s3, 1
    s_mul_i32 s7, s7, 18432
    s_add_u32 s24, s30, s7
    s_lshr_b32 s7, s3, 1
    s_lshl_b32 s7, s7, 9
    s_add_u32 s24, s24, s7
    s_add_u32 s24, s24, 41156608
    s_mov_b32 s16, 0xffff0000
    v_lshlrev_b32 v124, 16, v240
    v_and_b32 v125, s16, v240
    v_lshlrev_b32 v126, 16, v241
    v_and_b32 v127, s16, v241
    v_lshlrev_b32 v128, 16, v242
    v_and_b32 v129, s16, v242
    v_lshlrev_b32 v130, 16, v243
    v_and_b32 v131, s16, v243
    v_lshlrev_b32 v132, 16, v244
    v_and_b32 v133, s16, v244
    v_lshlrev_b32 v134, 16, v245
    v_and_b32 v135, s16, v245
    v_lshlrev_b32 v136, 16, v246
    v_and_b32 v137, s16, v246
    v_lshlrev_b32 v138, 16, v247
    v_and_b32 v139, s16, v247
    v_lshlrev_b32 v140, 16, v248
    v_and_b32 v141, s16, v248
    v_lshlrev_b32 v142, 16, v249
    v_and_b32 v143, s16, v249
    v_lshlrev_b32 v144, 16, v250
    v_and_b32 v145, s16, v250
    v_lshlrev_b32 v146, 16, v251
    v_and_b32 v147, s16, v251
    s_cmp_eq_u32 s3, 1
    s_cselect_b32 s7, 16, 0
    v_lshlrev_b32 v12, 2, v0
    v_cmp_gt_u32 vcc, s7, v0
    v_add_u32 v10, 40960, v12
    v_add_u32 v11, 41472, v12
    v_cndmask_b32 v10, v11, v10, vcc
    v_and_b32 v11, 0x7c, v12
    v_cmp_gt_u32 vcc, 32, v0
    v_mov_b32 v13, 1073741824
    s_and_b32 s7, s40, 3
    s_lshl_b32 s45, s45, 2
    v_cndmask_b32 v8, v13, v12, vcc
    s_add_u32 s6, s7, s3
    s_cmp_eq_u32 s6, 0
    s_cselect_b32 s6, 0, 1073741824
    v_add_u32 v6, s6, v8
    s_add_u32 s45, s45, s7
    s_lshl_b32 s45, s45, 2
    s_add_u32 s45, s45, s3
    s_lshl_b32 s45, s45, 7
    s_add_u32 s45, s45, s43
    s_add_u32 s45, s45, 48300032
    s_cmp_eq_u32 s3, 0
    s_cselect_b32 s35, 1.0, 0
    s_lshl_b32 s7, s40, 2
    s_add_u32 s7, s7, s3
    s_mul_i32 s23, s7, 497664
    s_add_u32 s23, s23, 3145728
    s_add_u32 s50, s23, 497664
    s_mul_i32 s50, s50, s42
    v_mov_b32 v184, v253
    v_add_u32 v185, 4096, v253
    v_add_u32 v186, 8192, v253
    v_add_u32 v187, 12288, v253
    v_add_u32 v188, 16384, v253
    v_add_u32 v189, 20480, v253
    v_add_u32 v190, 24576, v253
    v_add_u32 v191, 28672, v253
    v_add_u32 v192, 32768, v253
    s_cmp_lg_u32 s3, 3
    s_cbranch_scc1 L_pollout_23
    s_lshl_b32 s7, s40, 7
    s_add_u32 s7, s7, s44
    s_add_u32 s52, s4, s7
    s_addc_u32 s53, s5, 0
    s_mov_b32 s6, 0
L_poll_21:
    s_load_dwordx8 s[56:63], s[52:53], 0 glc
    s_add_u32 s6, s6, 1
    s_waitcnt lgkmcnt(0)
    s_xor_b64 s[56:57], s[56:57], s[76:77]
    s_xor_b64 s[58:59], s[58:59], s[76:77]
    s_xor_b64 s[60:61], s[60:61], s[76:77]
    s_xor_b64 s[62:63], s[62:63], s[76:77]
    s_or_b64 s[56:57], s[56:57], s[58:59]
    s_or_b64 s[60:61], s[60:61], s[62:63]
    s_or_b64 s[56:57], s[56:57], s[60:61]
    s_cbranch_scc0 L_polled_22
    s_cmp_lt_u32 s6, 1048576
    s_cbranch_scc1 L_poll_21
    s_branch L_main_end
L_polled_22:
L_pollout_23:
    s_barrier
    s_lshl_b32 m0, s3, 10
    s_nop 0
    buffer_load_dwordx4 v2, s[8:11], s24 offen sc1 lds
    s_add_u32 m0, m0, 4096
    s_add_u32 s24, s24, 1024
    buffer_load_dwordx4 v2, s[8:11], s24 offen sc1 lds
    s_add_u32 m0, m0, 4096
    s_add_u32 s24, s24, 1024
    buffer_load_dwordx4 v2, s[8:11], s24 offen sc1 lds
    s_add_u32 m0, m0, 4096
    s_add_u32 s24, s24, 1024
    buffer_load_dwordx4 v2, s[8:11], s24 offen sc1 lds
    s_add_u32 m0, m0, 4096
    s_add_u32 s24, s24, 1024
    buffer_load_dwordx4 v2, s[8:11], s24 offen sc1 lds
    s_add_u32 m0, m0, 4096
    s_add_u32 s24, s24, 1024
    buffer_load_dwordx4 v2, s[8:11], s24 offen sc1 lds
    s_add_u32 m0, m0, 4096
    s_add_u32 s24, s24, 1024
    buffer_load_dwordx4 v2, s[8:11], s24 offen sc1 lds
    s_add_u32 m0, m0, 4096
    s_add_u32 s24, s24, 1024
    buffer_load_dwordx4 v2, s[8:11], s24 offen sc1 lds
    s_add_u32 m0, m0, 4096
    s_add_u32 s24, s24, 1024
    buffer_load_dwordx4 v2, s[8:11], s24 offen sc1 lds
    s_waitcnt vmcnt(4)
    s_barrier
    ds_read_b128 v[160:163], v253 offset:0
    ds_read_b128 v[164:167], v253 offset:1024
    s_waitcnt lgkmcnt(0)
    v_mfma_f32_16x16x32_bf16 v[100:103], a[160:163], v[160:163], 0
    ds_read_b128 v[168:171], v253 offset:2048
    v_mfma_f32_16x16x32_bf16 v[104:107], a[160:163], v[164:167], 0
    ds_read_b128 v[172:175], v253 offset:3072
    v_mfma_f32_16x16x32_bf16 v[108:111], a[164:167], v[160:163], 0
    v_mfma_f32_16x16x32_bf16 v[112:115], a[164:167], v[164:167], 0
    buffer_load_dwordx4 v[16:19], v184, s[48:51], s23 offen offset:0 sc1
    v_mfma_f32_16x16x32_bf16 v[116:119], a[168:171], v[160:163], 0
    v_mfma_f32_16x16x32_bf16 v[120:123], a[168:171], v[164:167], 0
    s_waitcnt lgkmcnt(0)
    v_mfma_f32_16x16x32_bf16 v[100:103], a[172:175], v[168:171], v[100:103]
    ds_read_b128 v[160:163], v253 offset:4096
    v_mfma_f32_16x16x32_bf16 v[104:107], a[172:175], v[172:175], v[104:107]
    ds_read_b128 v[164:167], v253 offset:5120
    v_mfma_f32_16x16x32_bf16 v[108:111], a[176:179], v[168:171], v[108:111]
    v_mfma_f32_16x16x32_bf16 v[112:115], a[176:179], v[172:175], v[112:115]
    buffer_load_dwordx4 v[20:23], v184, s[48:51], s23 offen offset:1024 sc1
    v_mfma_f32_16x16x32_bf16 v[116:119], a[180:183], v[168:171], v[116:119]
    v_mfma_f32_16x16x32_bf16 v[120:123], a[180:183], v[172:175], v[120:123]
    s_waitcnt lgkmcnt(0)
    v_mfma_f32_16x16x32_bf16 v[100:103], a[184:187], v[160:163], v[100:103]
    ds_read_b128 v[168:171], v253 offset:6144
    v_mfma_f32_16x16x32_bf16 v[104:107], a[184:187], v[164:167], v[104:107]
    ds_read_b128 v[172:175], v253 offset:7168
    v_mfma_f32_16x16x32_bf16 v[108:111], a[188:191], v[160:163], v[108:111]
    v_mfma_f32_16x16x32_bf16 v[112:115], a[188:191], v[164:167], v[112:115]
    buffer_load_dwordx4 v[24:27], v184, s[48:51], s23 offen offset:2048 sc1
    v_mfma_f32_16x16x32_bf16 v[116:119], a[192:195], v[160:163], v[116:119]
    v_mfma_f32_16x16x32_bf16 v[120:123], a[192:195], v[164:167], v[120:123]
    s_waitcnt lgkmcnt(0)
    v_mfma_f32_16x16x32_bf16 v[100:103], a[196:199], v[168:171], v[100:103]
    ds_read_b128 v[160:163], v253 offset:8192
    v_mfma_f32_16x16x32_bf16 v[104:107], a[196:199], v[172:175], v[104:107]
    ds_read_b128 v[164:167], v253 offset:9216
    v_mfma_f32_16x16x32_bf16 v[108:111], a[200:203], v[168:171], v[108:111]
    v_mfma_f32_16x16x32_bf16 v[112:115], a[200:203], v[172:175], v[112:115]
    buffer_load_dwordx4 v[28:31], v184, s[48:51], s23 offen offset:3072 sc1
    v_mfma_f32_16x16x32_bf16 v[116:119], a[204:207], v[168:171], v[116:119]
    v_mfma_f32_16x16x32_bf16 v[120:123], a[204:207], v[172:175], v[120:123]
    s_waitcnt lgkmcnt(0)
    v_mfma_f32_16x16x32_bf16 v[100:103], a[208:211], v[160:163], v[100:103]
    ds_read_b128 v[168:171], v253 offset:10240
    v_mfma_f32_16x16x32_bf16 v[104:107], a[208:211], v[164:167], v[104:107]
    ds_read_b128 v[172:175], v253 offset:11264
    v_mfma_f32_16x16x32_bf16 v[108:111], a[212:215], v[160:163], v[108:111]
    v_mfma_f32_16x16x32_bf16 v[112:115], a[212:215], v[164:167], v[112:115]
    buffer_load_dwordx4 v[32:35], v185, s[48:51], s23 offen offset:0 sc1
    v_mfma_f32_16x16x32_bf16 v[116:119], a[216:219], v[160:163], v[116:119]
    v_mfma_f32_16x16x32_bf16 v[120:123], a[216:219], v[164:167], v[120:123]
    s_waitcnt lgkmcnt(0)
    v_mfma_f32_16x16x32_bf16 v[100:103], a[220:223], v[168:171], v[100:103]
    ds_read_b128 v[160:163], v253 offset:12288
    v_mfma_f32_16x16x32_bf16 v[104:107], a[220:223], v[172:175], v[104:107]
    ds_read_b128 v[164:167], v253 offset:13312
    v_mfma_f32_16x16x32_bf16 v[108:111], a[224:227], v[168:171], v[108:111]
    v_mfma_f32_16x16x32_bf16 v[112:115], a[224:227], v[172:175], v[112:115]
    buffer_load_dwordx4 v[36:39], v185, s[48:51], s23 offen offset:1024 sc1
    v_mfma_f32_16x16x32_bf16 v[116:119], a[228:231], v[168:171], v[116:119]
    v_mfma_f32_16x16x32_bf16 v[120:123], a[228:231], v[172:175], v[120:123]
    s_waitcnt lgkmcnt(0)
    v_mfma_f32_16x16x32_bf16 v[100:103], a[232:235], v[160:163], v[100:103]
    ds_read_b128 v[168:171], v253 offset:14336
    v_mfma_f32_16x16x32_bf16 v[104:107], a[232:235], v[164:167], v[104:107]
    ds_read_b128 v[172:175], v253 offset:15360
    v_mfma_f32_16x16x32_bf16 v[108:111], a[236:239], v[160:163], v[108:111]
    v_mfma_f32_16x16x32_bf16 v[112:115], a[236:239], v[164:167], v[112:115]
    buffer_load_dwordx4 v[40:43], v185, s[48:51], s23 offen offset:2048 sc1
    v_mfma_f32_16x16x32_bf16 v[116:119], a[240:243], v[160:163], v[116:119]
    v_mfma_f32_16x16x32_bf16 v[120:123], a[240:243], v[164:167], v[120:123]
    s_waitcnt lgkmcnt(0)
    v_mfma_f32_16x16x32_bf16 v[100:103], a[244:247], v[168:171], v[100:103]
    ds_read_b128 v[160:163], v253 offset:16384
    v_mfma_f32_16x16x32_bf16 v[104:107], a[244:247], v[172:175], v[104:107]
    ds_read_b128 v[164:167], v253 offset:17408
    v_mfma_f32_16x16x32_bf16 v[108:111], a[248:251], v[168:171], v[108:111]
    v_mfma_f32_16x16x32_bf16 v[112:115], a[248:251], v[172:175], v[112:115]
    buffer_load_dwordx4 v[44:47], v185, s[48:51], s23 offen offset:3072 sc1
    v_mfma_f32_16x16x32_bf16 v[116:119], a[252:255], v[168:171], v[116:119]
    v_mfma_f32_16x16x32_bf16 v[120:123], a[252:255], v[172:175], v[120:123]
    s_waitcnt lgkmcnt(0)
    v_mfma_f32_16x16x32_bf16 v[100:103], a[128:131], v[160:163], v[100:103]
    ds_read_b128 v[168:171], v253 offset:18432
    v_mfma_f32_16x16x32_bf16 v[104:107], a[128:131], v[164:167], v[104:107]
    ds_read_b128 v[172:175], v253 offset:19456
    v_mfma_f32_16x16x32_bf16 v[108:111], a[132:135], v[160:163], v[108:111]
    v_mfma_f32_16x16x32_bf16 v[112:115], a[132:135], v[164:167], v[112:115]
    buffer_load_dwordx4 v[48:51], v186, s[48:51], s23 offen offset:0 sc1
    v_mfma_f32_16x16x32_bf16 v[116:119], a[136:139], v[160:163], v[116:119]
    v_mfma_f32_16x16x32_bf16 v[120:123], a[136:139], v[164:167], v[120:123]
    s_waitcnt vmcnt(9) lgkmcnt(0)
    s_barrier
    s_xor_b32 s7, s3, 0
    s_or_b32 s7, s7, s42
    s_cbranch_scc1 L_swz_24
    v_lshlrev_b32 v15, 10, v0
    s_lshl_b32 s6, s40, 7
    s_lshl_b32 s7, s41, 2
    s_add_u32 s6, s6, s7
    s_add_u32 s6, s6, 19464192
    s_mov_b64 exec, 0xffffffff
    v_lshlrev_b32 v15, 10, v0
    v_mov_b32 v1, s76
    buffer_store_dword v1, v15, s[8:11], s6 offen sc1
    s_mov_b64 exec, -1
L_swz_24:
    v_mfma_f32_16x16x32_bf16 v[100:103], a[140:143], v[168:171], v[100:103]
    ds_read_b128 v[160:163], v253 offset:20480
    v_mfma_f32_16x16x32_bf16 v[104:107], a[140:143], v[172:175], v[104:107]
    ds_read_b128 v[164:167], v253 offset:21504
    v_mfma_f32_16x16x32_bf16 v[108:111], a[144:147], v[168:171], v[108:111]
    v_mfma_f32_16x16x32_bf16 v[112:115], a[144:147], v[172:175], v[112:115]
    buffer_load_dwordx4 v[52:55], v186, s[48:51], s23 offen offset:1024 sc1
    v_mfma_f32_16x16x32_bf16 v[116:119], a[148:151], v[168:171], v[116:119]
    v_mfma_f32_16x16x32_bf16 v[120:123], a[148:151], v[172:175], v[120:123]
    s_waitcnt lgkmcnt(0)
    v_mfma_f32_16x16x32_bf16 v[100:103], a[152:155], v[160:163], v[100:103]
    ds_read_b128 v[168:171], v253 offset:22528
    v_mfma_f32_16x16x32_bf16 v[104:107], a[152:155], v[164:167], v[104:107]
    ds_read_b128 v[172:175], v253 offset:23552
    v_mfma_f32_16x16x32_bf16 v[108:111], a[156:159], v[160:163], v[108:111]
    v_mfma_f32_16x16x32_bf16 v[112:115], a[156:159], v[164:167], v[112:115]
    buffer_load_dwordx4 v[56:59], v186, s[48:51], s23 offen offset:2048 sc1
    v_mfma_f32_16x16x32_bf16 v[116:119], a[0:3], v[160:163], v[116:119]
    v_mfma_f32_16x16x32_bf16 v[120:123], a[0:3], v[164:167], v[120:123]
    s_waitcnt lgkmcnt(0)
    v_mfma_f32_16x16x32_bf16 v[100:103], a[4:7], v[168:171], v[100:103]
    ds_read_b128 v[160:163], v253 offset:24576
    v_mfma_f32_16x16x32_bf16 v[104:107], a[4:7], v[172:175], v[104:107]
    ds_read_b128 v[164:167], v253 offset:25600
    v_mfma_f32_16x16x32_bf16 v[108:111], a[8:11], v[168:171], v[108:111]
    v_mfma_f32_16x16x32_bf16 v[112:115], a[8:11], v[172:175], v[112:115]
    buffer_load_dwordx4 v[60:63], v186, s[48:51], s23 offen offset:3072 sc1
    v_mfma_f32_16x16x32_bf16 v[116:119], a[12:15], v[168:171], v[116:119]
    v_mfma_f32_16x16x32_bf16 v[120:123], a[12:15], v[172:175], v[120:123]
    s_waitcnt lgkmcnt(0)
    v_mfma_f32_16x16x32_bf16 v[100:103], a[16:19], v[160:163], v[100:103]
    ds_read_b128 v[168:171], v253 offset:26624
    v_mfma_f32_16x16x32_bf16 v[104:107], a[16:19], v[164:167], v[104:107]
    ds_read_b128 v[172:175], v253 offset:27648
    v_mfma_f32_16x16x32_bf16 v[108:111], a[20:23], v[160:163], v[108:111]
    v_mfma_f32_16x16x32_bf16 v[112:115], a[20:23], v[164:167], v[112:115]
    buffer_load_dwordx4 v[64:67], v187, s[48:51], s23 offen offset:0 sc1
    v_mfma_f32_16x16x32_bf16 v[116:119], a[24:27], v[160:163], v[116:119]
    v_mfma_f32_16x16x32_bf16 v[120:123], a[24:27], v[164:167], v[120:123]
    s_waitcnt lgkmcnt(0)
    v_mfma_f32_16x16x32_bf16 v[100:103], a[28:31], v[168:171], v[100:103]
    ds_read_b128 v[160:163], v253 offset:28672
    v_mfma_f32_16x16x32_bf16 v[104:107], a[28:31], v[172:175], v[104:107]
    ds_read_b128 v[164:167], v253 offset:29696
    v_mfma_f32_16x16x32_bf16 v[108:111], a[32:35], v[168:171], v[108:111]
    v_mfma_f32_16x16x32_bf16 v[112:115], a[32:35], v[172:175], v[112:115]
    buffer_load_dwordx4 v[68:71], v187, s[48:51], s23 offen offset:1024 sc1
    v_mfma_f32_16x16x32_bf16 v[116:119], a[36:39], v[168:171], v[116:119]
    v_mfma_f32_16x16x32_bf16 v[120:123], a[36:39], v[172:175], v[120:123]
    s_waitcnt lgkmcnt(0)
    v_mfma_f32_16x16x32_bf16 v[100:103], a[40:43], v[160:163], v[100:103]
    ds_read_b128 v[168:171], v253 offset:30720
    v_mfma_f32_16x16x32_bf16 v[104:107], a[40:43], v[164:167], v[104:107]
    ds_read_b128 v[172:175], v253 offset:31744
    v_mfma_f32_16x16x32_bf16 v[108:111], a[44:47], v[160:163], v[108:111]
    v_mfma_f32_16x16x32_bf16 v[112:115], a[44:47], v[164:167], v[112:115]
    buffer_load_dwordx4 v[72:75], v187, s[48:51], s23 offen offset:2048 sc1
    v_mfma_f32_16x16x32_bf16 v[116:119], a[48:51], v[160:163], v[116:119]
    v_mfma_f32_16x16x32_bf16 v[120:123], a[48:51], v[164:167], v[120:123]
    s_waitcnt lgkmcnt(0)
    v_mfma_f32_16x16x32_bf16 v[100:103], a[52:55], v[168:171], v[100:103]
    ds_read_b128 v[160:163], v253 offset:32768
    v_mfma_f32_16x16x32_bf16 v[104:107], a[52:55], v[172:175], v[104:107]
    ds_read_b128 v[164:167], v253 offset:33792
    v_mfma_f32_16x16x32_bf16 v[108:111], a[56:59], v[168:171], v[108:111]
    v_mfma_f32_16x16x32_bf16 v[112:115], a[56:59], v[172:175], v[112:115]
    v_mfma_f32_16x16x32_bf16 v[116:119], a[60:63], v[168:171], v[116:119]
    v_mfma_f32_16x16x32_bf16 v[120:123], a[60:63], v[172:175], v[120:123]
    s_waitcnt lgkmcnt(0)
    v_mfma_f32_16x16x32_bf16 v[100:103], a[64:67], v[160:163], v[100:103]
    ds_read_b128 v[168:171], v253 offset:34816
    v_mfma_f32_16x16x32_bf16 v[104:107], a[64:67], v[164:167], v[104:107]
    ds_read_b128 v[172:175], v253 offset:35840
    v_mfma_f32_16x16x32_bf16 v[108:111], a[68:71], v[160:163], v[108:111]
    v_mfma_f32_16x16x32_bf16 v[112:115], a[68:71], v[164:167], v[112:115]
    v_mfma_f32_16x16x32_bf16 v[116:119], a[72:75], v[160:163], v[116:119]
    v_mfma_f32_16x16x32_bf16 v[120:123], a[72:75], v[164:167], v[120:123]
    s_waitcnt lgkmcnt(0)
    v_mfma_f32_16x16x32_bf16 v[100:103], a[76:79], v[168:171], v[100:103]
    v_mfma_f32_16x16x32_bf16 v[104:107], a[76:79], v[172:175], v[104:107]
    v_mfma_f32_16x16x32_bf16 v[108:111], a[80:83], v[168:171], v[108:111]
    v_mfma_f32_16x16x32_bf16 v[112:115], a[80:83], v[172:175], v[112:115]
    v_mfma_f32_16x16x32_bf16 v[116:119], a[84:87], v[168:171], v[116:119]
    v_mfma_f32_16x16x32_bf16 v[120:123], a[84:87], v[172:175], v[120:123]
    s_nop 3
    v_permlane16_swap_b32 v100, v104
    v_permlane16_swap_b32 v101, v105
    v_permlane16_swap_b32 v102, v106
    v_permlane16_swap_b32 v103, v107
    v_add_f32 v12, v116, v117
    v_add_f32 v13, v120, v121
    ds_write_b32 v10, v12
    ds_write_b32 v10, v13 offset:64
    v_permlane16_swap_b32 v108, v112
    v_permlane16_swap_b32 v109, v113
    v_permlane16_swap_b32 v110, v114
    v_permlane16_swap_b32 v111, v115
    v_permlane16_swap_b32 v116, v120
    v_permlane16_swap_b32 v117, v121
    v_permlane16_swap_b32 v118, v122
    v_permlane16_swap_b32 v119, v123
    s_waitcnt lgkmcnt(0)
    s_barrier
    ds_read_b32 v12, v11 offset:40960
    v_pk_add_f32 v[124:125], v[124:125], v[100:101]
    v_pk_add_f32 v[126:127], v[126:127], v[102:103]
    v_pk_add_f32 v[128:129], v[128:129], v[104:105]
    v_pk_add_f32 v[130:131], v[130:131], v[106:107]
    v_pk_add_f32 v[132:133], v[132:133], v[108:109]
    v_pk_add_f32 v[134:135], v[134:135], v[110:111]
    v_pk_add_f32 v[136:137], v[136:137], v[112:113]
    v_pk_add_f32 v[138:139], v[138:139], v[114:115]
    v_pk_add_f32 v[140:141], v[140:141], v[116:117]
    v_pk_add_f32 v[142:143], v[142:143], v[118:119]
    v_pk_add_f32 v[144:145], v[144:145], v[120:121]
    v_pk_add_f32 v[146:147], v[146:147], v[122:123]
    v_mov_b32 v14, 0
    v_mov_b32 v15, 0
    s_waitcnt lgkmcnt(0)
    v_add_f32 v12, v12, v252
    v_pk_add_f32 v[100:101], v[124:125], v[12:13] op_sel_hi:[1,0] neg_lo:[0,1] neg_hi:[0,1]
    v_pk_add_f32 v[102:103], v[126:127], v[12:13] op_sel_hi:[1,0] neg_lo:[0,1] neg_hi:[0,1]
    v_pk_add_f32 v[104:105], v[128:129], v[12:13] op_sel_hi:[1,0] neg_lo:[0,1] neg_hi:[0,1]
    v_pk_add_f32 v[106:107], v[130:131], v[12:13] op_sel_hi:[1,0] neg_lo:[0,1] neg_hi:[0,1]
    v_cvt_pk_bf16_f32 v148, v100, v101
    v_cvt_pk_bf16_f32 v149, v102, v103
    v_cvt_pk_bf16_f32 v150, v104, v105
    v_cvt_pk_bf16_f32 v151, v106, v107
    buffer_store_dwordx4 v[148:151], v9, s[8:11], s46 offen offset:0 sc1
    v_pk_add_f32 v[108:109], v[132:133], v[12:13] op_sel_hi:[1,0] neg_lo:[0,1] neg_hi:[0,1]
    v_pk_add_f32 v[110:111], v[134:135], v[12:13] op_sel_hi:[1,0] neg_lo:[0,1] neg_hi:[0,1]
    v_pk_add_f32 v[112:113], v[136:137], v[12:13] op_sel_hi:[1,0] neg_lo:[0,1] neg_hi:[0,1]
    v_pk_add_f32 v[114:115], v[138:139], v[12:13] op_sel_hi:[1,0] neg_lo:[0,1] neg_hi:[0,1]
    v_cvt_pk_bf16_f32 v152, v108, v109
    v_cvt_pk_bf16_f32 v153, v110, v111
    v_cvt_pk_bf16_f32 v154, v112, v113
    v_cvt_pk_bf16_f32 v155, v114, v115
    buffer_store_dwordx4 v[152:155], v9, s[8:11], s46 offen offset:1024 sc1
    v_pk_add_f32 v[116:117], v[140:141], v[12:13] op_sel_hi:[1,0] neg_lo:[0,1] neg_hi:[0,1]
    v_pk_add_f32 v[118:119], v[142:143], v[12:13] op_sel_hi:[1,0] neg_lo:[0,1] neg_hi:[0,1]
    v_pk_add_f32 v[120:121], v[144:145], v[12:13] op_sel_hi:[1,0] neg_lo:[0,1] neg_hi:[0,1]
    v_pk_add_f32 v[122:123], v[146:147], v[12:13] op_sel_hi:[1,0] neg_lo:[0,1] neg_hi:[0,1]
    v_cvt_pk_bf16_f32 v156, v116, v117
    v_cvt_pk_bf16_f32 v157, v118, v119
    v_cvt_pk_bf16_f32 v158, v120, v121
    v_cvt_pk_bf16_f32 v159, v122, v123
    buffer_store_dwordx4 v[156:159], v7, s[8:11], s46 offen offset:2048 sc1
    v_dot2c_f32_bf16 v14, v148, v148
    v_dot2c_f32_bf16 v14, v149, v149
    v_dot2c_f32_bf16 v14, v150, v150
    v_dot2c_f32_bf16 v14, v151, v151
    v_dot2c_f32_bf16 v14, v152, v152
    v_dot2c_f32_bf16 v14, v153, v153
    v_dot2c_f32_bf16 v14, v154, v154
    v_dot2c_f32_bf16 v14, v155, v155
    v_dot2c_f32_bf16 v15, v156, v156
    v_dot2c_f32_bf16 v15, v157, v157
    v_dot2c_f32_bf16 v15, v158, v158
    v_dot2c_f32_bf16 v15, v159, v159
    buffer_store_dword v12, v6, s[8:11], s36 offen sc1
    s_nop 1
    v_fma_f32 v14, v15, s35, v14
    v_mov_b32 v15, v14
    s_nop 1
    v_permlane32_swap_b32 v14, v15
    v_add_f32 v14, v14, v15
    buffer_store_dword v14, v8, s[8:11], s45 offen sc1
    v_lshlrev_b32 v15, 7, v0
    s_lshl_b32 s6, s40, 2
    s_add_u32 s6, s6, s44
    s_add_u32 s6, s6, 32768
    v_mov_b32 v1, s76
    s_mov_b64 vcc, 0xff
    s_waitcnt vmcnt(0)
    s_barrier
    s_cmp_lg_u32 s3, 0
    s_cbranch_scc1 L_pub_25
    s_mov_b64 exec, vcc
    buffer_store_dword v1, v15, s[8:11], s6 offen sc1
L_pub_25:
    s_mov_b64 exec, -1
    s_lshl_b32 s7, s41, 2
    s_add_u32 s7, s7, s3
    s_mul_i32 s22, s7, 18432
    s_add_u32 s22, s22, s43
    s_add_u32 s22, s22, 45875200
    s_mul_i32 s24, s3, 18432
    s_lshl_b32 s25, s41, 12
    s_add_u32 s25, s25, s43
    s_add_u32 s25, s25, 48300032
    v_lshrrev_b32 v3, 5, v0
    v_and_b32 v10, 31, v0
    v_lshlrev_b32 v10, 2, v10
    v_lshl_add_u32 v3, v3, 11, v10
    v_add_u32 v11, 36864, v184
    s_mov_b32 s16, 0xffff0000
    s_lshl_b32 s7, s3, 10
    v_add_u32 v172, s7, v253
    v_add_u32 v174, 5120, v172
    v_and_b32 v178, 7, v0
    v_mul_u32_u24 v178, 1152, v178
    v_lshrrev_b32 v179, 3, v0
    v_lshl_add_u32 v178, v179, 4, v178
    s_lshl_b32 s7, s3, 7
    v_add_u32 v175, s7, v178
    v_add_u32 v177, 640, v175
    s_cmp_eq_u32 s3, 0
    s_mov_b32 s17, 1073741824
    s_cmov_b32 s17, 4096
    v_add_u32 v173, s17, v172
    s_mov_b32 s17, 1073741824
    s_cmov_b32 s17, 512
    v_add_u32 v176, s17, v175
    s_lshl_b32 s21, s41, 3
    s_add_u32 s21, s21, s40
    s_mul_i32 s18, s21, 9216
    s_mul_i32 s20, s21, 73728
    s_add_u32 s20, s20, 19922944
    v_bfe_u32 v1, v0, 3, 2
    s_mov_b32 s7, 73728
    v_mul_lo_u32 v178, v1, s7
    v_lshrrev_b32 v1, 5, v0
    v_lshl_add_u32 v178, v1, 7, v178
    v_and_b32 v1, 7, v0
    v_lshl_add_u32 v178, v1, 4, v178
    v_add_u32 v179, 294912, v178
    v_lshrrev_b32 v1, 5, v0
    v_and_b32 v15, 7, v0
    v_lshlrev_b32 v15, 4, v15
    v_lshl_add_u32 v15, v1, 7, v15
    s_lshl_b32 s7, s3, 8
    s_add_u32 s7, s7, 3072
    v_add_u32 v15, s7, v15
    v_bfe_u32 v1, v0, 3, 2
    v_mov_b32 v182, 1073741824
    v_add_u32 v183, 14336, v253
    s_sub_u32 s7, s40, 0
    v_cmp_eq_u32 vcc, s7, v1
    s_nop 1
    v_cndmask_b32 v178, v178, v182, vcc
    v_cndmask_b32 v216, v183, v15, vcc
    v_cndmask_b32 v218, 0, 1, vcc
    v_lshlrev_b32 v218, 10, v218
    s_sub_u32 s7, s40, 4
    v_cmp_eq_u32 vcc, s7, v1
    s_nop 1
    v_cndmask_b32 v179, v179, v182, vcc
    v_cndmask_b32 v217, v183, v15, vcc
    v_cndmask_b32 v219, 0, 1, vcc
    v_lshlrev_b32 v219, 10, v219
    s_mul_i32 s26, s41, 589824
    s_mul_i32 s7, s40, 9216
    s_add_u32 s26, s26, s7
    s_lshl_b32 s7, s3, 8
    s_add_u32 s27, s26, s7
    s_add_u32 s27, s27, 19921920
    s_mov_b32 s74, 0
    s_mul_i32 s7, s42, 98304
    s_sub_u32 s29, s44, s7
    s_add_u32 s29, s29, 360448
    s_lshl_b32 s7, s40, 7
    s_add_u32 s7, s7, s29
    s_add_u32 s38, s4, s7
    s_addc_u32 s39, s5, 0
    s_lshl_b32 s7, s40, 2
    s_add_u32 s29, s29, s7
    s_add_u32 s50, s23, 497664
    s_cmp_lg_u32 s42, 0
    s_cbranch_scc1 L_ring_26
    s_cmp_lg_u32 s3, 0
    s_cbranch_scc1 L_ring_27
    s_lshl_b32 s7, s41, 3
    s_add_u32 s7, s7, s40
    s_lshl_b32 s7, s7, 7
    s_add_u32 s7, s7, 19464192
    s_add_u32 s68, s4, s7
    s_addc_u32 s69, s5, 0
    s_mov_b32 s6, 0
    s_mov_b32 s7, 0
L_cpoll_28:
    s_load_dwordx16 s[52:67], s[68:69], s7 glc
    s_add_u32 s6, s6, 1
    s_waitcnt lgkmcnt(0)
    s_xor_b64 s[52:53], s[52:53], s[76:77]
    s_xor_b64 s[54:55], s[54:55], s[76:77]
    s_xor_b64 s[56:57], s[56:57], s[76:77]
    s_xor_b64 s[58:59], s[58:59], s[76:77]
    s_xor_b64 s[60:61], s[60:61], s[76:77]
    s_xor_b64 s[62:63], s[62:63], s[76:77]
    s_xor_b64 s[64:65], s[64:65], s[76:77]
    s_xor_b64 s[66:67], s[66:67], s[76:77]
    s_or_b64 s[52:53], s[52:53], s[60:61]
    s_or_b64 s[54:55], s[54:55], s[62:63]
    s_or_b64 s[56:57], s[56:57], s[64:65]
    s_or_b64 s[58:59], s[58:59], s[66:67]
    s_or_b64 s[52:53], s[52:53], s[56:57]
    s_or_b64 s[54:55], s[54:55], s[58:59]
    s_or_b64 s[52:53], s[52:53], s[54:55]
    s_cbranch_scc1 L_cpoll_29
    s_add_u32 s7, s7, 64
    s_cmp_eq_u32 s7, 128
    s_cbranch_scc1 L_cpolled_30
L_cpoll_29:
    s_cmp_lt_u32 s6, 1048576
    s_cbranch_scc1 L_cpoll_28
    s_branch L_main_end
L_cpolled_30:
L_ring_27:
    s_barrier
    buffer_load_dwordx4 v[16:19], v184, s[48:51], s23 offen offset:0 sc1
    buffer_load_dwordx4 v[20:23], v184, s[48:51], s23 offen offset:1024 sc1
    buffer_load_dwordx4 v[24:27], v184, s[48:51], s23 offen offset:2048 sc1
    buffer_load_dwordx4 v[28:31], v184, s[48:51], s23 offen offset:3072 sc1
    buffer_load_dwordx4 v[32:35], v185, s[48:51], s23 offen offset:0 sc1
    buffer_load_dwordx4 v[36:39], v185, s[48:51], s23 offen offset:1024 sc1
    buffer_load_dwordx4 v[40:43], v185, s[48:51], s23 offen offset:2048 sc1
    buffer_load_dwordx4 v[44:47], v185, s[48:51], s23 offen offset:3072 sc1
    buffer_load_dwordx4 v[48:51], v186, s[48:51], s23 offen offset:0 sc1
    buffer_load_dwordx4 v[52:55], v186, s[48:51], s23 offen offset:1024 sc1
    buffer_load_dwordx4 v[56:59], v186, s[48:51], s23 offen offset:2048 sc1
    buffer_load_dwordx4 v[60:63], v186, s[48:51], s23 offen offset:3072 sc1
    buffer_load_dwordx4 v[64:67], v187, s[48:51], s23 offen offset:0 sc1
    buffer_load_dwordx4 v[68:71], v187, s[48:51], s23 offen offset:1024 sc1
    buffer_load_dwordx4 v[72:75], v187, s[48:51], s23 offen offset:2048 sc1
L_ring_26:
    s_cmp_lg_u32 s3, 3
    s_cbranch_scc1 L_pollout_33
    s_lshl_b32 s7, s40, 7
    s_add_u32 s7, s7, s44
    s_add_u32 s7, s7, 32768
    s_add_u32 s52, s4, s7
    s_addc_u32 s53, s5, 0
    s_mov_b32 s6, 0
L_poll_31:
    s_load_dwordx8 s[56:63], s[52:53], 0 glc
    s_add_u32 s6, s6, 1
    s_waitcnt lgkmcnt(0)
    s_xor_b64 s[56:57], s[56:57], s[76:77]
    s_xor_b64 s[58:59], s[58:59], s[76:77]
    s_xor_b64 s[60:61], s[60:61], s[76:77]
    s_xor_b64 s[62:63], s[62:63], s[76:77]
    s_or_b64 s[56:57], s[56:57], s[58:59]
    s_or_b64 s[60:61], s[60:61], s[62:63]
    s_or_b64 s[56:57], s[56:57], s[60:61]
    s_cbranch_scc0 L_polled_32
    s_cmp_lt_u32 s6, 1048576
    s_cbranch_scc1 L_poll_31
    s_branch L_main_end
L_polled_32:
L_pollout_33:
    s_barrier
    s_add_u32 m0, s24, 0
    s_nop 0
    buffer_load_dwordx4 v2, s[8:11], s22 offen offset:0 sc1 lds
    s_add_u32 m0, s24, 512
    s_nop 0
    buffer_load_dwordx4 v2, s[8:11], s22 offen offset:512 sc1 lds
    s_add_u32 m0, s24, 1024
    s_nop 0
    buffer_load_dwordx4 v2, s[8:11], s22 offen offset:1024 sc1 lds
    s_add_u32 m0, s24, 1536
    s_nop 0
    buffer_load_dwordx4 v2, s[8:11], s22 offen offset:1536 sc1 lds
    s_add_u32 m0, s24, 2048
    s_nop 0
    buffer_load_dwordx4 v2, s[8:11], s22 offen offset:2048 sc1 lds
    s_add_u32 m0, s24, 2560
    s_nop 0
    buffer_load_dwordx4 v2, s[8:11], s22 offen offset:2560 sc1 lds
    s_add_u32 m0, s24, 3072
    s_nop 0
    buffer_load_dwordx4 v2, s[8:11], s22 offen offset:3072 sc1 lds
    s_add_u32 m0, s24, 3584
    s_nop 0
    buffer_load_dwordx4 v2, s[8:11], s22 offen offset:3584 sc1 lds
    s_add_u32 m0, s24, 8192
    s_add_u32 s22, s22, 4096
    buffer_load_dwordx4 v2, s[8:11], s22 offen offset:0 sc1 lds
    s_add_u32 m0, s24, 8704
    s_nop 0
    buffer_load_dwordx4 v2, s[8:11], s22 offen offset:512 sc1 lds
    s_add_u32 m0, s24, 9216
    s_nop 0
    buffer_load_dwordx4 v2, s[8:11], s22 offen offset:1024 sc1 lds
    s_add_u32 m0, s24, 9728
    s_nop 0
    buffer_load_dwordx4 v2, s[8:11], s22 offen offset:1536 sc1 lds
    s_add_u32 s23, s23, 15360
    s_lshr_b32 s7, s3, 1
    s_lshl_b32 s7, s7, 10
    s_and_b32 s6, s3, 1
    s_lshl_b32 s6, s6, 3
    s_add_u32 s28, s7, s6
    s_add_u32 s28, s28, 73728
    s_waitcnt vmcnt(6)
    s_barrier
    ds_read_b128 a[0:3], v184 offset:0
    ds_read_b128 a[72:75], v184 offset:18432
    ds_read_b128 a[144:147], v11 offset:0
    ds_read_b128 a[216:219], v11 offset:18432
    ds_read_b128 a[4:7], v184 offset:1024
    ds_read_b128 a[76:79], v184 offset:19456
    ds_read_b128 a[148:151], v11 offset:1024
    ds_read_b128 a[220:223], v11 offset:19456
    ds_read_b128 a[8:11], v184 offset:2048
    ds_read_b128 a[80:83], v184 offset:20480
    ds_read_b128 a[152:155], v11 offset:2048
    ds_read_b128 a[224:227], v11 offset:20480
    s_waitcnt vmcnt(24) lgkmcnt(0)
    v_mfma_f32_16x16x32_bf16 v[88:91], v[16:19], a[0:3], 0
    ds_read_b128 a[12:15], v184 offset:3072
    v_mfma_f32_16x16x32_bf16 v[88:91], v[20:23], a[4:7], v[88:91]
    buffer_load_dwordx4 v[76:79], v184, s[48:51], s23 offen offset:0 sc1
    v_mfma_f32_16x16x32_bf16 v[88:91], v[24:27], a[8:11], v[88:91]
    ds_read_b128 a[84:87], v184 offset:21504
    v_mfma_f32_16x16x32_bf16 v[92:95], v[16:19], a[72:75], 0
    s_add_u32 m0, s24, 10240
    s_nop 0
    buffer_load_dwordx4 v2, s[8:11], s22 offen offset:2048 sc1 lds
    v_mfma_f32_16x16x32_bf16 v[92:95], v[20:23], a[76:79], v[92:95]
    ds_read_b128 a[156:159], v11 offset:3072
    ds_read_b128 a[228:231], v11 offset:21504
    v_mfma_f32_16x16x32_bf16 v[92:95], v[24:27], a[80:83], v[92:95]
    buffer_load_dwordx4 v[80:83], v184, s[48:51], s23 offen offset:1024 sc1
    v_mfma_f32_16x16x32_bf16 v[96:99], v[16:19], a[144:147], 0
    ds_read_b128 a[16:19], v184 offset:4096
    v_mfma_f32_16x16x32_bf16 v[96:99], v[20:23], a[148:151], v[96:99]
    s_add_u32 m0, s24, 10752
    s_nop 0
    buffer_load_dwordx4 v2, s[8:11], s22 offen offset:2560 sc1 lds
    v_mfma_f32_16x16x32_bf16 v[96:99], v[24:27], a[152:155], v[96:99]
    ds_read_b128 a[88:91], v184 offset:22528
    v_mfma_f32_16x16x32_bf16 v[100:103], v[16:19], a[216:219], 0
    buffer_load_dwordx4 v[84:87], v184, s[48:51], s23 offen offset:2048 sc1
    v_mfma_f32_16x16x32_bf16 v[100:103], v[20:23], a[220:223], v[100:103]
    ds_read_b128 a[160:163], v11 offset:4096
    ds_read_b128 a[232:235], v11 offset:22528
    v_mfma_f32_16x16x32_bf16 v[100:103], v[24:27], a[224:227], v[100:103]
    s_add_u32 m0, s24, 11264
    s_nop 0
    buffer_load_dwordx4 v2, s[8:11], s22 offen offset:3072 sc1 lds
    s_waitcnt vmcnt(27) lgkmcnt(8)
    v_mfma_f32_16x16x32_bf16 v[104:107], v[28:31], a[0:3], 0
    ds_read_b128 a[20:23], v184 offset:5120
    v_mfma_f32_16x16x32_bf16 v[104:107], v[32:35], a[4:7], v[104:107]
    buffer_load_dwordx4 v[16:19], v184, s[48:51], s23 offen offset:3072 sc1
    v_mfma_f32_16x16x32_bf16 v[104:107], v[36:39], a[8:11], v[104:107]
    ds_read_b128 a[92:95], v184 offset:23552
    v_mfma_f32_16x16x32_bf16 v[108:111], v[28:31], a[72:75], 0
    s_add_u32 m0, s24, 11776
    s_nop 0
    buffer_load_dwordx4 v2, s[8:11], s22 offen offset:3584 sc1 lds
    v_mfma_f32_16x16x32_bf16 v[108:111], v[32:35], a[76:79], v[108:111]
    ds_read_b128 a[164:167], v11 offset:5120
    ds_read_b128 a[236:239], v11 offset:23552
    v_mfma_f32_16x16x32_bf16 v[108:111], v[36:39], a[80:83], v[108:111]
    buffer_load_dwordx4 v[20:23], v185, s[48:51], s23 offen offset:0 sc1
    v_mfma_f32_16x16x32_bf16 v[112:115], v[28:31], a[144:147], 0
    v_mfma_f32_16x16x32_bf16 v[112:115], v[32:35], a[148:151], v[112:115]
    s_add_u32 m0, s24, 16384
    s_add_u32 s22, s22, 4096
    buffer_load_dwordx4 v2, s[8:11], s22 offen offset:0 sc1 lds
    v_mfma_f32_16x16x32_bf16 v[112:115], v[36:39], a[152:155], v[112:115]
    v_mfma_f32_16x16x32_bf16 v[116:119], v[28:31], a[216:219], 0
    buffer_load_dwordx4 v[24:27], v185, s[48:51], s23 offen offset:1024 sc1
    v_mfma_f32_16x16x32_bf16 v[116:119], v[32:35], a[220:223], v[116:119]
    v_mfma_f32_16x16x32_bf16 v[116:119], v[36:39], a[224:227], v[116:119]
    s_add_u32 m0, s24, 16896
    s_nop 0
    buffer_load_dwordx4 v2, s[8:11], s22 offen offset:512 sc1 lds
    s_waitcnt vmcnt(12) lgkmcnt(0)
    s_barrier
    v_mfma_f32_16x16x32_bf16 v[88:91], v[40:43], a[12:15], v[88:91]
    ds_read_b128 a[24:27], v184 offset:6144
    v_mfma_f32_16x16x32_bf16 v[88:91], v[44:47], a[16:19], v[88:91]
    buffer_load_dwordx4 v[28:31], v185, s[48:51], s23 offen offset:2048 sc1
    v_mfma_f32_16x16x32_bf16 v[88:91], v[48:51], a[20:23], v[88:91]
    ds_read_b128 a[96:99], v184 offset:24576
    v_mfma_f32_16x16x32_bf16 v[92:95], v[40:43], a[84:87], v[92:95]
    buffer_load_dword v136, v3, s[8:11], s25 offen offset:0 sc1
    v_mfma_f32_16x16x32_bf16 v[92:95], v[44:47], a[88:91], v[92:95]
    ds_read_b128 a[168:171], v11 offset:6144
    ds_read_b128 a[240:243], v11 offset:24576
    v_mfma_f32_16x16x32_bf16 v[92:95], v[48:51], a[92:95], v[92:95]
    buffer_load_dwordx4 v[32:35], v185, s[48:51], s23 offen offset:3072 sc1
    v_mfma_f32_16x16x32_bf16 v[96:99], v[40:43], a[156:159], v[96:99]
    buffer_load_dword v137, v3, s[8:11], s25 offen offset:128 sc1
    v_mfma_f32_16x16x32_bf16 v[96:99], v[44:47], a[160:163], v[96:99]
    buffer_load_dword v138, v3, s[8:11], s25 offen offset:256 sc1
    v_mfma_f32_16x16x32_bf16 v[96:99], v[48:51], a[164:167], v[96:99]
    ds_read_b128 a[28:31], v184 offset:7168
    ds_read_b128 a[100:103], v184 offset:25600
    v_mfma_f32_16x16x32_bf16 v[100:103], v[40:43], a[228:231], v[100:103]
    buffer_load_dwordx4 v[36:39], v186, s[48:51], s23 offen offset:0 sc1
    v_mfma_f32_16x16x32_bf16 v[100:103], v[44:47], a[232:235], v[100:103]
    buffer_load_dword v139, v3, s[8:11], s25 offen offset:384 sc1
    v_mfma_f32_16x16x32_bf16 v[100:103], v[48:51], a[236:239], v[100:103]
    buffer_load_dword v140, v3, s[8:11], s25 offen offset:512 sc1
    s_waitcnt vmcnt(35) lgkmcnt(6)
    v_mfma_f32_16x16x32_bf16 v[104:107], v[52:55], a[12:15], v[104:107]
    ds_read_b128 a[172:175], v11 offset:7168
    ds_read_b128 a[244:247], v11 offset:25600
    v_mfma_f32_16x16x32_bf16 v[104:107], v[56:59], a[16:19], v[104:107]
    buffer_load_dwordx4 v[40:43], v186, s[48:51], s23 offen offset:1024 sc1
    v_mfma_f32_16x16x32_bf16 v[104:107], v[60:63], a[20:23], v[104:107]
    ds_read_b128 a[32:35], v184 offset:8192
    ds_read_b128 a[104:107], v184 offset:26624
    v_mfma_f32_16x16x32_bf16 v[108:111], v[52:55], a[84:87], v[108:111]
    buffer_load_dword v141, v3, s[8:11], s25 offen offset:640 sc1
    v_mfma_f32_16x16x32_bf16 v[108:111], v[56:59], a[88:91], v[108:111]
    ds_read_b128 a[176:179], v11 offset:8192
    ds_read_b128 a[248:251], v11 offset:26624
    v_mfma_f32_16x16x32_bf16 v[108:111], v[60:63], a[92:95], v[108:111]
    buffer_load_dwordx4 v[44:47], v186, s[48:51], s23 offen offset:2048 sc1
    v_mfma_f32_16x16x32_bf16 v[112:115], v[52:55], a[156:159], v[112:115]
    buffer_load_dword v142, v3, s[8:11], s25 offen offset:768 sc1
    v_mfma_f32_16x16x32_bf16 v[112:115], v[56:59], a[160:163], v[112:115]
    buffer_load_dword v143, v3, s[8:11], s25 offen offset:896 sc1
    v_mfma_f32_16x16x32_bf16 v[112:115], v[60:63], a[164:167], v[112:115]
    v_mfma_f32_16x16x32_bf16 v[116:119], v[52:55], a[228:231], v[116:119]
    buffer_load_dwordx4 v[48:51], v186, s[48:51], s23 offen offset:3072 sc1
    v_mfma_f32_16x16x32_bf16 v[116:119], v[56:59], a[232:235], v[116:119]
    buffer_load_dword v144, v3, s[8:11], s25 offen offset:1024 sc1
    v_mfma_f32_16x16x32_bf16 v[116:119], v[60:63], a[236:239], v[116:119]
    buffer_load_dword v145, v3, s[8:11], s25 offen offset:1152 sc1
    s_waitcnt vmcnt(40) lgkmcnt(0)
    v_mfma_f32_16x16x32_bf16 v[88:91], v[64:67], a[24:27], v[88:91]
    ds_read_b128 a[36:39], v184 offset:9216
    v_mfma_f32_16x16x32_bf16 v[88:91], v[68:71], a[28:31], v[88:91]
    buffer_load_dwordx4 v[52:55], v187, s[48:51], s23 offen offset:0 sc1
    v_mfma_f32_16x16x32_bf16 v[88:91], v[72:75], a[32:35], v[88:91]
    ds_read_b128 a[108:111], v184 offset:27648
    v_mfma_f32_16x16x32_bf16 v[92:95], v[64:67], a[96:99], v[92:95]
    buffer_load_dword v146, v3, s[8:11], s25 offen offset:1280 sc1
    v_mfma_f32_16x16x32_bf16 v[92:95], v[68:71], a[100:103], v[92:95]
    ds_read_b128 a[180:183], v11 offset:9216
    ds_read_b128 a[252:255], v11 offset:27648
    v_mfma_f32_16x16x32_bf16 v[92:95], v[72:75], a[104:107], v[92:95]
    buffer_load_dwordx4 v[56:59], v187, s[48:51], s23 offen offset:1024 sc1
    v_mfma_f32_16x16x32_bf16 v[96:99], v[64:67], a[168:171], v[96:99]
    buffer_load_dword v147, v3, s[8:11], s25 offen offset:1408 sc1
    v_mfma_f32_16x16x32_bf16 v[96:99], v[68:71], a[172:175], v[96:99]
    buffer_load_dword v148, v3, s[8:11], s25 offen offset:1536 sc1
    v_mfma_f32_16x16x32_bf16 v[96:99], v[72:75], a[176:179], v[96:99]
    ds_read_b128 a[40:43], v184 offset:10240
    ds_read_b128 a[112:115], v184 offset:28672
    v_mfma_f32_16x16x32_bf16 v[100:103], v[64:67], a[240:243], v[100:103]
    buffer_load_dwordx4 v[60:63], v187, s[48:51], s23 offen offset:2048 sc1
    v_mfma_f32_16x16x32_bf16 v[100:103], v[68:71], a[244:247], v[100:103]
    buffer_load_dword v149, v3, s[8:11], s25 offen offset:1664 sc1
    v_mfma_f32_16x16x32_bf16 v[100:103], v[72:75], a[248:251], v[100:103]
    buffer_load_dword v150, v3, s[8:11], s25 offen offset:1792 sc1
    s_waitcnt vmcnt(31) lgkmcnt(6)
    v_mfma_f32_16x16x32_bf16 v[104:107], v[76:79], a[24:27], v[104:107]
    ds_read_b128 a[184:187], v11 offset:10240
    ds_read_b128 v[220:223], v11 offset:28672
    v_mfma_f32_16x16x32_bf16 v[104:107], v[80:83], a[28:31], v[104:107]
    buffer_load_dwordx4 v[64:67], v187, s[48:51], s23 offen offset:3072 sc1
    v_mfma_f32_16x16x32_bf16 v[104:107], v[84:87], a[32:35], v[104:107]
    ds_read_b128 a[44:47], v184 offset:11264
    ds_read_b128 a[116:119], v184 offset:29696
    v_mfma_f32_16x16x32_bf16 v[108:111], v[76:79], a[96:99], v[108:111]
    buffer_load_dword v151, v3, s[8:11], s25 offen offset:1920 sc1
    v_mfma_f32_16x16x32_bf16 v[108:111], v[80:83], a[100:103], v[108:111]
    ds_read_b128 a[188:191], v11 offset:11264
    ds_read_b128 v[224:227], v11 offset:29696
    v_mfma_f32_16x16x32_bf16 v[108:111], v[84:87], a[104:107], v[108:111]
    buffer_load_dwordx4 v[68:71], v188, s[48:51], s23 offen offset:0 sc1
    v_mfma_f32_16x16x32_bf16 v[112:115], v[76:79], a[168:171], v[112:115]
    v_mfma_f32_16x16x32_bf16 v[112:115], v[80:83], a[172:175], v[112:115]
    v_mfma_f32_16x16x32_bf16 v[112:115], v[84:87], a[176:179], v[112:115]
    v_mfma_f32_16x16x32_bf16 v[116:119], v[76:79], a[240:243], v[116:119]
    buffer_load_dwordx4 v[72:75], v188, s[48:51], s23 offen offset:1024 sc1
    v_mfma_f32_16x16x32_bf16 v[116:119], v[80:83], a[244:247], v[116:119]
    v_mfma_f32_16x16x32_bf16 v[116:119], v[84:87], a[248:251], v[116:119]
    s_waitcnt vmcnt(28) lgkmcnt(0)
    s_barrier
    v_mfma_f32_16x16x32_bf16 v[88:91], v[16:19], a[36:39], v[88:91]
    ds_read_b128 a[48:51], v184 offset:12288
    v_mfma_f32_16x16x32_bf16 v[88:91], v[20:23], a[40:43], v[88:91]
    buffer_load_dwordx4 v[76:79], v188, s[48:51], s23 offen offset:2048 sc1
    v_mfma_f32_16x16x32_bf16 v[88:91], v[24:27], a[44:47], v[88:91]
    ds_read_b128 a[120:123], v184 offset:30720
    v_mfma_f32_16x16x32_bf16 v[92:95], v[16:19], a[108:111], v[92:95]
    ds_read_b128 a[192:195], v11 offset:12288
    v_mfma_f32_16x16x32_bf16 v[92:95], v[20:23], a[112:115], v[92:95]
    ds_read_b128 v[228:231], v11 offset:30720
    v_mfma_f32_16x16x32_bf16 v[92:95], v[24:27], a[116:119], v[92:95]
    buffer_load_dwordx4 v[80:83], v188, s[48:51], s23 offen offset:3072 sc1
    v_mfma_f32_16x16x32_bf16 v[96:99], v[16:19], a[180:183], v[96:99]
    ds_read_b128 a[52:55], v184 offset:13312
    v_mfma_f32_16x16x32_bf16 v[96:99], v[20:23], a[184:187], v[96:99]
    ds_read_b128 a[124:127], v184 offset:31744
    v_mfma_f32_16x16x32_bf16 v[96:99], v[24:27], a[188:191], v[96:99]
    v_mfma_f32_16x16x32_bf16 v[100:103], v[16:19], a[252:255], v[100:103]
    buffer_load_dwordx4 v[84:87], v189, s[48:51], s23 offen offset:0 sc1
    v_mfma_f32_16x16x32_bf16 v[100:103], v[20:23], v[220:223], v[100:103]
    ds_read_b128 a[196:199], v11 offset:13312
    ds_read_b128 v[232:235], v11 offset:31744
    v_mfma_f32_16x16x32_bf16 v[100:103], v[24:27], v[224:227], v[100:103]
    s_waitcnt vmcnt(25) lgkmcnt(8)
    v_mfma_f32_16x16x32_bf16 v[104:107], v[28:31], a[36:39], v[104:107]
    ds_read_b128 a[56:59], v184 offset:14336
    v_mfma_f32_16x16x32_bf16 v[104:107], v[32:35], a[40:43], v[104:107]
    buffer_load_dwordx4 v[16:19], v189, s[48:51], s23 offen offset:1024 sc1
    v_mfma_f32_16x16x32_bf16 v[104:107], v[36:39], a[44:47], v[104:107]
    ds_read_b128 a[128:131], v184 offset:32768
    v_mfma_f32_16x16x32_bf16 v[108:111], v[28:31], a[108:111], v[108:111]
    ds_read_b128 a[200:203], v11 offset:14336
    v_mfma_f32_16x16x32_bf16 v[108:111], v[32:35], a[112:115], v[108:111]
    ds_read_b128 v[236:239], v11 offset:32768
    v_mfma_f32_16x16x32_bf16 v[108:111], v[36:39], a[116:119], v[108:111]
    buffer_load_dwordx4 v[20:23], v189, s[48:51], s23 offen offset:2048 sc1
    v_mfma_f32_16x16x32_bf16 v[112:115], v[28:31], a[180:183], v[112:115]
    v_mfma_f32_16x16x32_bf16 v[112:115], v[32:35], a[184:187], v[112:115]
    v_mfma_f32_16x16x32_bf16 v[112:115], v[36:39], a[188:191], v[112:115]
    v_mfma_f32_16x16x32_bf16 v[116:119], v[28:31], a[252:255], v[116:119]
    buffer_load_dwordx4 v[24:27], v189, s[48:51], s23 offen offset:3072 sc1
    v_mfma_f32_16x16x32_bf16 v[116:119], v[32:35], v[220:223], v[116:119]
    v_mfma_f32_16x16x32_bf16 v[116:119], v[36:39], v[224:227], v[116:119]
    s_waitcnt vmcnt(8) lgkmcnt(0)
    v_mfma_f32_16x16x32_bf16 v[88:91], v[40:43], a[48:51], v[88:91]
    ds_read_b128 a[60:63], v184 offset:15360
    v_add_f32 v136, v136, v144
    v_mfma_f32_16x16x32_bf16 v[88:91], v[44:47], a[52:55], v[88:91]
    buffer_load_dwordx4 v[28:31], v190, s[48:51], s23 offen offset:0 sc1
    v_mfma_f32_16x16x32_bf16 v[88:91], v[48:51], a[56:59], v[88:91]
    ds_read_b128 a[132:135], v184 offset:33792
    v_add_f32 v137, v137, v145
    v_mfma_f32_16x16x32_bf16 v[92:95], v[40:43], a[120:123], v[92:95]
    ds_read_b128 a[204:207], v11 offset:15360
    v_add_f32 v138, v138, v146
    v_mfma_f32_16x16x32_bf16 v[92:95], v[44:47], a[124:127], v[92:95]
    ds_read_b128 v[240:243], v11 offset:33792
    v_add_f32 v139, v139, v147
    v_mfma_f32_16x16x32_bf16 v[92:95], v[48:51], a[128:131], v[92:95]
    buffer_load_dwordx4 v[32:35], v190, s[48:51], s23 offen offset:1024 sc1
    v_mfma_f32_16x16x32_bf16 v[96:99], v[40:43], a[192:195], v[96:99]
    ds_read_b128 a[64:67], v184 offset:16384
    v_add_f32 v140, v140, v148
    v_mfma_f32_16x16x32_bf16 v[96:99], v[44:47], a[196:199], v[96:99]
    ds_read_b128 a[136:139], v184 offset:34816
    v_add_f32 v141, v141, v149
    v_mfma_f32_16x16x32_bf16 v[96:99], v[48:51], a[200:203], v[96:99]
    v_add_f32 v142, v142, v150
    v_add_f32 v143, v143, v151
    v_mfma_f32_16x16x32_bf16 v[100:103], v[40:43], v[228:231], v[100:103]
    buffer_load_dwordx4 v[36:39], v190, s[48:51], s23 offen offset:2048 sc1
    v_mfma_f32_16x16x32_bf16 v[100:103], v[44:47], v[232:235], v[100:103]
    ds_read_b128 a[208:211], v11 offset:16384
    ds_read_b128 v[244:247], v11 offset:34816
    v_mfma_f32_16x16x32_bf16 v[100:103], v[48:51], v[236:239], v[100:103]
    v_add_f32 v136, v136, v140
    v_add_f32 v137, v137, v141
    s_waitcnt vmcnt(15) lgkmcnt(8)
    v_mfma_f32_16x16x32_bf16 v[104:107], v[52:55], a[48:51], v[104:107]
    ds_read_b128 a[68:71], v184 offset:17408
    v_add_f32 v138, v138, v142
    v_mfma_f32_16x16x32_bf16 v[104:107], v[56:59], a[52:55], v[104:107]
    buffer_load_dwordx4 v[40:43], v190, s[48:51], s23 offen offset:3072 sc1
    v_mfma_f32_16x16x32_bf16 v[104:107], v[60:63], a[56:59], v[104:107]
    ds_read_b128 a[140:143], v184 offset:35840
    v_add_f32 v139, v139, v143
    v_mfma_f32_16x16x32_bf16 v[108:111], v[52:55], a[120:123], v[108:111]
    ds_read_b128 a[212:215], v11 offset:17408
    v_add_f32 v136, v136, v138
    v_mfma_f32_16x16x32_bf16 v[108:111], v[56:59], a[124:127], v[108:111]
    ds_read_b128 v[248:251], v11 offset:35840
    v_add_f32 v137, v137, v139
    v_mfma_f32_16x16x32_bf16 v[108:111], v[60:63], a[128:131], v[108:111]
    buffer_load_dwordx4 v[44:47], v191, s[48:51], s23 offen offset:0 sc1
    v_mfma_f32_16x16x32_bf16 v[112:115], v[52:55], a[192:195], v[112:115]
    v_add_f32 v136, v136, v137
    v_mov_b32 v137, 0x3727c5ac
    v_mfma_f32_16x16x32_bf16 v[112:115], v[56:59], a[196:199], v[112:115]
    v_fmac_f32 v137, 0x3ae38e39, v136
    v_mov_b32 v193, v137
    v_mfma_f32_16x16x32_bf16 v[112:115], v[60:63], a[200:203], v[112:115]
    s_nop 0
    v_permlane16_swap_b32 v193, v137
    v_mfma_f32_16x16x32_bf16 v[116:119], v[52:55], v[228:231], v[116:119]
    buffer_load_dwordx4 v[48:51], v191, s[48:51], s23 offen offset:1024 sc1
    v_mfma_f32_16x16x32_bf16 v[116:119], v[56:59], v[232:235], v[116:119]
    v_mov_b32 v195, v193
    v_mov_b32 v194, v137
    v_mfma_f32_16x16x32_bf16 v[116:119], v[60:63], v[236:239], v[116:119]
    v_mov_b32 v252, v137
    s_waitcnt vmcnt(12) lgkmcnt(0)
    v_mfma_f32_16x16x32_bf16 v[88:91], v[64:67], a[60:63], v[88:91]
    s_nop 0
    v_permlane32_swap_b32 v193, v195
    v_mfma_f32_16x16x32_bf16 v[88:91], v[68:71], a[64:67], v[88:91]
    buffer_load_dwordx4 v[52:55], v191, s[48:51], s23 offen offset:2048 sc1
    v_mfma_f32_16x16x32_bf16 v[120:123], v[72:75], a[68:71], v[88:91]
    v_permlane32_swap_b32 v194, v252
    v_mfma_f32_16x16x32_bf16 v[92:95], v[64:67], a[132:135], v[92:95]
    v_rsq_f32 v4, v193
    v_mfma_f32_16x16x32_bf16 v[92:95], v[68:71], a[136:139], v[92:95]
    v_rsq_f32 v5, v194
    v_mfma_f32_16x16x32_bf16 v[124:127], v[72:75], a[140:143], v[92:95]
    buffer_load_dwordx4 v[56:59], v191, s[48:51], s23 offen offset:3072 sc1
    v_mfma_f32_16x16x32_bf16 v[96:99], v[64:67], a[204:207], v[96:99]
    v_rsq_f32 v6, v195
    v_mfma_f32_16x16x32_bf16 v[96:99], v[68:71], a[208:211], v[96:99]
    v_rsq_f32 v7, v252
    v_mfma_f32_16x16x32_bf16 v[128:131], v[72:75], a[212:215], v[96:99]
    v_mul_f32 v8, v4, v4
    v_mul_f32 v9, v5, v5
    v_mfma_f32_16x16x32_bf16 v[100:103], v[64:67], v[240:243], v[100:103]
    buffer_load_dwordx4 v[60:63], v192, s[48:51], s23 offen offset:0 sc1
    v_mfma_f32_16x16x32_bf16 v[100:103], v[68:71], v[244:247], v[100:103]
    v_mul_f32 v13, v6, v6
    v_mul_f32 v14, v7, v7
    v_mfma_f32_16x16x32_bf16 v[132:135], v[72:75], v[248:251], v[100:103]
    v_mul_f32 v4, 0xc0135761, v4
    v_mul_f32 v5, 0xc0135761, v5
    s_waitcnt vmcnt(12) lgkmcnt(0)
    v_mfma_f32_16x16x32_bf16 v[104:107], v[76:79], a[60:63], v[104:107]
    v_mul_f32 v6, 0xc0135761, v6
    v_mul_f32 v7, 0xc0135761, v7
    v_mfma_f32_16x16x32_bf16 v[104:107], v[80:83], a[64:67], v[104:107]
    buffer_load_dwordx4 v[64:67], v192, s[48:51], s23 offen offset:1024 sc1
    v_mfma_f32_16x16x32_bf16 v[136:139], v[84:87], a[68:71], v[104:107]
    v_mul_f32 v8, 0x3d372713, v8
    v_mul_f32 v9, 0x3d372713, v9
    v_mfma_f32_16x16x32_bf16 v[108:111], v[76:79], a[132:135], v[108:111]
    v_mul_f32 v13, 0x3d372713, v13
    v_mul_f32 v14, 0x3d372713, v14
    v_mfma_f32_16x16x32_bf16 v[108:111], v[80:83], a[136:139], v[108:111]
    v_mul_f32 v8, v8, v4
    v_mul_f32 v9, v9, v5
    v_mfma_f32_16x16x32_bf16 v[140:143], v[84:87], a[140:143], v[108:111]
    buffer_load_dwordx4 v[68:71], v192, s[48:51], s23 offen offset:2048 sc1
    v_mfma_f32_16x16x32_bf16 v[112:115], v[76:79], a[204:207], v[112:115]
    v_mul_f32 v13, v13, v6
    v_mul_f32 v14, v14, v7
    v_mfma_f32_16x16x32_bf16 v[112:115], v[80:83], a[208:211], v[112:115]
    s_mov_b32 s25, 0
    v_mfma_f32_16x16x32_bf16 v[144:147], v[84:87], a[212:215], v[112:115]
    s_mov_b32 s7, s28
    v_mfma_f32_16x16x32_bf16 v[116:119], v[76:79], v[240:243], v[116:119]
    buffer_load_dwordx4 v[72:75], v192, s[48:51], s23 offen offset:3072 sc1
    v_mfma_f32_16x16x32_bf16 v[116:119], v[80:83], v[244:247], v[116:119]
    s_add_u32 s23, s23, 36864
    v_mfma_f32_16x16x32_bf16 v[148:151], v[84:87], v[248:251], v[116:119]
    v_add_u32 v12, s7, v184
    s_add_u32 s25, s25, 1
L_ffn_gu_34:
    s_waitcnt vmcnt(12)
    v_mfma_f32_16x16x32_bf16 v[88:91], v[16:19], a[0:3], 0
    v_mfma_f32_16x16x32_bf16 v[88:91], v[20:23], a[4:7], v[88:91]
    buffer_load_dwordx4 v[76:79], v184, s[48:51], s23 offen offset:0 sc1
    v_mfma_f32_16x16x32_bf16 v[88:91], v[24:27], a[8:11], v[88:91]
    v_mul_f32 v152, v120, v120
    v_mul_f32 v153, v121, v121
    v_mfma_f32_16x16x32_bf16 v[92:95], v[16:19], a[72:75], 0
    v_mul_f32 v154, v122, v122
    v_mul_f32 v155, v123, v123
    v_mfma_f32_16x16x32_bf16 v[92:95], v[20:23], a[76:79], v[92:95]
    v_fma_f32 v152, v152, v8, v4
    v_fma_f32 v153, v153, v8, v4
    v_mfma_f32_16x16x32_bf16 v[92:95], v[24:27], a[80:83], v[92:95]
    buffer_load_dwordx4 v[80:83], v184, s[48:51], s23 offen offset:1024 sc1
    v_mfma_f32_16x16x32_bf16 v[96:99], v[16:19], a[144:147], 0
    v_fma_f32 v154, v154, v8, v4
    v_fma_f32 v155, v155, v8, v4
    v_mfma_f32_16x16x32_bf16 v[96:99], v[20:23], a[148:151], v[96:99]
    v_mul_f32 v152, v120, v152
    v_mul_f32 v153, v121, v153
    v_mfma_f32_16x16x32_bf16 v[96:99], v[24:27], a[152:155], v[96:99]
    v_mul_f32 v154, v122, v154
    v_mul_f32 v155, v123, v155
    v_mfma_f32_16x16x32_bf16 v[100:103], v[16:19], a[216:219], 0
    buffer_load_dwordx4 v[84:87], v184, s[48:51], s23 offen offset:2048 sc1
    v_mfma_f32_16x16x32_bf16 v[100:103], v[20:23], a[220:223], v[100:103]
    v_exp_f32 v152, v152
    v_mfma_f32_16x16x32_bf16 v[100:103], v[24:27], a[224:227], v[100:103]
    v_exp_f32 v153, v153
    s_waitcnt vmcnt(12)
    v_mfma_f32_16x16x32_bf16 v[104:107], v[28:31], a[0:3], 0
    v_exp_f32 v154, v154
    v_mfma_f32_16x16x32_bf16 v[104:107], v[32:35], a[4:7], v[104:107]
    buffer_load_dwordx4 v[16:19], v184, s[48:51], s23 offen offset:3072 sc1
    v_mfma_f32_16x16x32_bf16 v[104:107], v[36:39], a[8:11], v[104:107]
    v_exp_f32 v155, v155
    v_mfma_f32_16x16x32_bf16 v[108:111], v[28:31], a[72:75], 0
    v_mul_f32 v156, v120, v136
    v_mul_f32 v157, v121, v137
    v_mfma_f32_16x16x32_bf16 v[108:111], v[32:35], a[76:79], v[108:111]
    v_mul_f32 v158, v122, v138
    v_mul_f32 v159, v123, v139
    v_mfma_f32_16x16x32_bf16 v[108:111], v[36:39], a[80:83], v[108:111]
    buffer_load_dwordx4 v[20:23], v185, s[48:51], s23 offen offset:0 sc1
    v_mfma_f32_16x16x32_bf16 v[112:115], v[28:31], a[144:147], 0
    v_fma_f32 v152, v152, v193, v193
    v_fma_f32 v153, v153, v193, v193
    v_mfma_f32_16x16x32_bf16 v[112:115], v[32:35], a[148:151], v[112:115]
    v_fma_f32 v154, v154, v193, v193
    v_fma_f32 v155, v155, v193, v193
    v_mfma_f32_16x16x32_bf16 v[112:115], v[36:39], a[152:155], v[112:115]
    v_rcp_f32 v152, v152
    v_mfma_f32_16x16x32_bf16 v[116:119], v[28:31], a[216:219], 0
    buffer_load_dwordx4 v[24:27], v185, s[48:51], s23 offen offset:1024 sc1
    v_mfma_f32_16x16x32_bf16 v[116:119], v[32:35], a[220:223], v[116:119]
    v_rcp_f32 v153, v153
    v_mfma_f32_16x16x32_bf16 v[116:119], v[36:39], a[224:227], v[116:119]
    v_rcp_f32 v154, v154
    s_waitcnt vmcnt(12)
    v_mfma_f32_16x16x32_bf16 v[88:91], v[40:43], a[12:15], v[88:91]
    v_rcp_f32 v155, v155
    v_mfma_f32_16x16x32_bf16 v[88:91], v[44:47], a[16:19], v[88:91]
    buffer_load_dwordx4 v[28:31], v185, s[48:51], s23 offen offset:2048 sc1
    v_mfma_f32_16x16x32_bf16 v[88:91], v[48:51], a[20:23], v[88:91]
    v_mul_f32 v156, v156, v152
    v_mul_f32 v157, v157, v153
    v_mfma_f32_16x16x32_bf16 v[92:95], v[40:43], a[84:87], v[92:95]
    v_mul_f32 v158, v158, v154
    v_mul_f32 v159, v159, v155
    v_mfma_f32_16x16x32_bf16 v[92:95], v[44:47], a[88:91], v[92:95]
    v_cvt_pk_bf16_f32 v160, v156, v157
    v_cvt_pk_bf16_f32 v161, v158, v159
    v_mfma_f32_16x16x32_bf16 v[92:95], v[48:51], a[92:95], v[92:95]
    buffer_load_dwordx4 v[32:35], v185, s[48:51], s23 offen offset:3072 sc1
    v_mfma_f32_16x16x32_bf16 v[96:99], v[40:43], a[156:159], v[96:99]
    ds_write_b64 v12, v[160:161] offset:0
    v_mfma_f32_16x16x32_bf16 v[96:99], v[44:47], a[160:163], v[96:99]
    v_mul_f32 v162, v124, v124
    v_mul_f32 v163, v125, v125
    v_mfma_f32_16x16x32_bf16 v[96:99], v[48:51], a[164:167], v[96:99]
    v_mul_f32 v164, v126, v126
    v_mul_f32 v165, v127, v127
    v_mfma_f32_16x16x32_bf16 v[100:103], v[40:43], a[228:231], v[100:103]
    buffer_load_dwordx4 v[36:39], v186, s[48:51], s23 offen offset:0 sc1
    v_mfma_f32_16x16x32_bf16 v[100:103], v[44:47], a[232:235], v[100:103]
    v_fma_f32 v162, v162, v9, v5
    v_fma_f32 v163, v163, v9, v5
    v_mfma_f32_16x16x32_bf16 v[100:103], v[48:51], a[236:239], v[100:103]
    v_fma_f32 v164, v164, v9, v5
    v_fma_f32 v165, v165, v9, v5
    s_waitcnt vmcnt(12)
    v_mfma_f32_16x16x32_bf16 v[104:107], v[52:55], a[12:15], v[104:107]
    v_mul_f32 v162, v124, v162
    v_mul_f32 v163, v125, v163
    v_mfma_f32_16x16x32_bf16 v[104:107], v[56:59], a[16:19], v[104:107]
    buffer_load_dwordx4 v[40:43], v186, s[48:51], s23 offen offset:1024 sc1
    v_mfma_f32_16x16x32_bf16 v[104:107], v[60:63], a[20:23], v[104:107]
    v_mul_f32 v164, v126, v164
    v_mul_f32 v165, v127, v165
    v_mfma_f32_16x16x32_bf16 v[108:111], v[52:55], a[84:87], v[108:111]
    v_exp_f32 v162, v162
    v_mfma_f32_16x16x32_bf16 v[108:111], v[56:59], a[88:91], v[108:111]
    v_exp_f32 v163, v163
    v_mfma_f32_16x16x32_bf16 v[108:111], v[60:63], a[92:95], v[108:111]
    buffer_load_dwordx4 v[44:47], v186, s[48:51], s23 offen offset:2048 sc1
    v_mfma_f32_16x16x32_bf16 v[112:115], v[52:55], a[156:159], v[112:115]
    v_exp_f32 v164, v164
    v_mfma_f32_16x16x32_bf16 v[112:115], v[56:59], a[160:163], v[112:115]
    v_exp_f32 v165, v165
    v_mfma_f32_16x16x32_bf16 v[112:115], v[60:63], a[164:167], v[112:115]
    v_mul_f32 v166, v124, v140
    v_mul_f32 v167, v125, v141
    v_mfma_f32_16x16x32_bf16 v[116:119], v[52:55], a[228:231], v[116:119]
    buffer_load_dwordx4 v[48:51], v186, s[48:51], s23 offen offset:3072 sc1
    v_mfma_f32_16x16x32_bf16 v[116:119], v[56:59], a[232:235], v[116:119]
    v_mul_f32 v168, v126, v142
    v_mul_f32 v169, v127, v143
    v_mfma_f32_16x16x32_bf16 v[116:119], v[60:63], a[236:239], v[116:119]
    v_fma_f32 v162, v162, v194, v194
    v_fma_f32 v163, v163, v194, v194
    s_waitcnt vmcnt(12)
    v_mfma_f32_16x16x32_bf16 v[88:91], v[64:67], a[24:27], v[88:91]
    v_fma_f32 v164, v164, v194, v194
    v_fma_f32 v165, v165, v194, v194
    v_mfma_f32_16x16x32_bf16 v[88:91], v[68:71], a[28:31], v[88:91]
    buffer_load_dwordx4 v[52:55], v187, s[48:51], s23 offen offset:0 sc1
    v_mfma_f32_16x16x32_bf16 v[88:91], v[72:75], a[32:35], v[88:91]
    v_rcp_f32 v162, v162
    v_mfma_f32_16x16x32_bf16 v[92:95], v[64:67], a[96:99], v[92:95]
    v_rcp_f32 v163, v163
    v_mfma_f32_16x16x32_bf16 v[92:95], v[68:71], a[100:103], v[92:95]
    v_rcp_f32 v164, v164
    v_mfma_f32_16x16x32_bf16 v[92:95], v[72:75], a[104:107], v[92:95]
    buffer_load_dwordx4 v[56:59], v187, s[48:51], s23 offen offset:1024 sc1
    v_mfma_f32_16x16x32_bf16 v[96:99], v[64:67], a[168:171], v[96:99]
    v_rcp_f32 v165, v165
    v_mfma_f32_16x16x32_bf16 v[96:99], v[68:71], a[172:175], v[96:99]
    v_mul_f32 v166, v166, v162
    v_mul_f32 v167, v167, v163
    v_mfma_f32_16x16x32_bf16 v[96:99], v[72:75], a[176:179], v[96:99]
    v_mul_f32 v168, v168, v164
    v_mul_f32 v169, v169, v165
    v_mfma_f32_16x16x32_bf16 v[100:103], v[64:67], a[240:243], v[100:103]
    buffer_load_dwordx4 v[60:63], v187, s[48:51], s23 offen offset:2048 sc1
    v_mfma_f32_16x16x32_bf16 v[100:103], v[68:71], a[244:247], v[100:103]
    v_cvt_pk_bf16_f32 v170, v166, v167
    v_cvt_pk_bf16_f32 v171, v168, v169
    v_mfma_f32_16x16x32_bf16 v[100:103], v[72:75], a[248:251], v[100:103]
    ds_write_b64 v12, v[170:171] offset:18432
    s_waitcnt vmcnt(12)
    v_mfma_f32_16x16x32_bf16 v[104:107], v[76:79], a[24:27], v[104:107]
    v_mul_f32 v152, v128, v128
    v_mul_f32 v153, v129, v129
    v_mfma_f32_16x16x32_bf16 v[104:107], v[80:83], a[28:31], v[104:107]
    buffer_load_dwordx4 v[64:67], v187, s[48:51], s23 offen offset:3072 sc1
    v_mfma_f32_16x16x32_bf16 v[104:107], v[84:87], a[32:35], v[104:107]
    v_mul_f32 v154, v130, v130
    v_mul_f32 v155, v131, v131
    v_mfma_f32_16x16x32_bf16 v[108:111], v[76:79], a[96:99], v[108:111]
    v_fma_f32 v152, v152, v13, v6
    v_fma_f32 v153, v153, v13, v6
    v_mfma_f32_16x16x32_bf16 v[108:111], v[80:83], a[100:103], v[108:111]
    v_fma_f32 v154, v154, v13, v6
    v_fma_f32 v155, v155, v13, v6
    v_mfma_f32_16x16x32_bf16 v[108:111], v[84:87], a[104:107], v[108:111]
    buffer_load_dwordx4 v[68:71], v188, s[48:51], s23 offen offset:0 sc1
    v_mfma_f32_16x16x32_bf16 v[112:115], v[76:79], a[168:171], v[112:115]
    v_mul_f32 v152, v128, v152
    v_mul_f32 v153, v129, v153
    v_mfma_f32_16x16x32_bf16 v[112:115], v[80:83], a[172:175], v[112:115]
    v_mul_f32 v154, v130, v154
    v_mul_f32 v155, v131, v155
    v_mfma_f32_16x16x32_bf16 v[112:115], v[84:87], a[176:179], v[112:115]
    v_exp_f32 v152, v152
    v_mfma_f32_16x16x32_bf16 v[116:119], v[76:79], a[240:243], v[116:119]
    buffer_load_dwordx4 v[72:75], v188, s[48:51], s23 offen offset:1024 sc1
    v_mfma_f32_16x16x32_bf16 v[116:119], v[80:83], a[244:247], v[116:119]
    v_exp_f32 v153, v153
    v_mfma_f32_16x16x32_bf16 v[116:119], v[84:87], a[248:251], v[116:119]
    v_exp_f32 v154, v154
    s_waitcnt vmcnt(12)
    v_mfma_f32_16x16x32_bf16 v[88:91], v[16:19], a[36:39], v[88:91]
    v_exp_f32 v155, v155
    v_mfma_f32_16x16x32_bf16 v[88:91], v[20:23], a[40:43], v[88:91]
    buffer_load_dwordx4 v[76:79], v188, s[48:51], s23 offen offset:2048 sc1
    v_mfma_f32_16x16x32_bf16 v[88:91], v[24:27], a[44:47], v[88:91]
    v_mul_f32 v156, v128, v144
    v_mul_f32 v157, v129, v145
    v_mfma_f32_16x16x32_bf16 v[92:95], v[16:19], a[108:111], v[92:95]
    v_mul_f32 v158, v130, v146
    v_mul_f32 v159, v131, v147
    v_mfma_f32_16x16x32_bf16 v[92:95], v[20:23], a[112:115], v[92:95]
    v_fma_f32 v152, v152, v195, v195
    v_fma_f32 v153, v153, v195, v195
    v_mfma_f32_16x16x32_bf16 v[92:95], v[24:27], a[116:119], v[92:95]
    buffer_load_dwordx4 v[80:83], v188, s[48:51], s23 offen offset:3072 sc1
    v_mfma_f32_16x16x32_bf16 v[96:99], v[16:19], a[180:183], v[96:99]
    v_fma_f32 v154, v154, v195, v195
    v_fma_f32 v155, v155, v195, v195
    v_mfma_f32_16x16x32_bf16 v[96:99], v[20:23], a[184:187], v[96:99]
    v_rcp_f32 v152, v152
    v_mfma_f32_16x16x32_bf16 v[96:99], v[24:27], a[188:191], v[96:99]
    v_rcp_f32 v153, v153
    v_mfma_f32_16x16x32_bf16 v[100:103], v[16:19], a[252:255], v[100:103]
    buffer_load_dwordx4 v[84:87], v189, s[48:51], s23 offen offset:0 sc1
    v_mfma_f32_16x16x32_bf16 v[100:103], v[20:23], v[220:223], v[100:103]
    v_rcp_f32 v154, v154
    v_mfma_f32_16x16x32_bf16 v[100:103], v[24:27], v[224:227], v[100:103]
    v_rcp_f32 v155, v155
    s_waitcnt vmcnt(12)
    v_mfma_f32_16x16x32_bf16 v[104:107], v[28:31], a[36:39], v[104:107]
    v_mul_f32 v156, v156, v152
    v_mul_f32 v157, v157, v153
    v_mfma_f32_16x16x32_bf16 v[104:107], v[32:35], a[40:43], v[104:107]
    buffer_load_dwordx4 v[16:19], v189, s[48:51], s23 offen offset:1024 sc1
    v_mfma_f32_16x16x32_bf16 v[104:107], v[36:39], a[44:47], v[104:107]
    v_mul_f32 v158, v158, v154
    v_mul_f32 v159, v159, v155
    v_mfma_f32_16x16x32_bf16 v[108:111], v[28:31], a[108:111], v[108:111]
    v_cvt_pk_bf16_f32 v160, v156, v157
    v_cvt_pk_bf16_f32 v161, v158, v159
    v_mfma_f32_16x16x32_bf16 v[108:111], v[32:35], a[112:115], v[108:111]
    ds_write_b64 v12, v[160:161] offset:36864
    v_mfma_f32_16x16x32_bf16 v[108:111], v[36:39], a[116:119], v[108:111]
    buffer_load_dwordx4 v[20:23], v189, s[48:51], s23 offen offset:2048 sc1
    v_mfma_f32_16x16x32_bf16 v[112:115], v[28:31], a[180:183], v[112:115]
    v_mul_f32 v162, v132, v132
    v_mul_f32 v163, v133, v133
    v_mfma_f32_16x16x32_bf16 v[112:115], v[32:35], a[184:187], v[112:115]
    v_mul_f32 v164, v134, v134
    v_mul_f32 v165, v135, v135
    v_mfma_f32_16x16x32_bf16 v[112:115], v[36:39], a[188:191], v[112:115]
    v_fma_f32 v162, v162, v14, v7
    v_fma_f32 v163, v163, v14, v7
    v_mfma_f32_16x16x32_bf16 v[116:119], v[28:31], a[252:255], v[116:119]
    buffer_load_dwordx4 v[24:27], v189, s[48:51], s23 offen offset:3072 sc1
    v_mfma_f32_16x16x32_bf16 v[116:119], v[32:35], v[220:223], v[116:119]
    v_fma_f32 v164, v164, v14, v7
    v_fma_f32 v165, v165, v14, v7
    v_mfma_f32_16x16x32_bf16 v[116:119], v[36:39], v[224:227], v[116:119]
    v_mul_f32 v162, v132, v162
    v_mul_f32 v163, v133, v163
    s_waitcnt vmcnt(12)
    v_mfma_f32_16x16x32_bf16 v[88:91], v[40:43], a[48:51], v[88:91]
    v_mul_f32 v164, v134, v164
    v_mul_f32 v165, v135, v165
    v_mfma_f32_16x16x32_bf16 v[88:91], v[44:47], a[52:55], v[88:91]
    buffer_load_dwordx4 v[28:31], v190, s[48:51], s23 offen offset:0 sc1
    v_mfma_f32_16x16x32_bf16 v[88:91], v[48:51], a[56:59], v[88:91]
    v_exp_f32 v162, v162
    v_mfma_f32_16x16x32_bf16 v[92:95], v[40:43], a[120:123], v[92:95]
    v_exp_f32 v163, v163
    v_mfma_f32_16x16x32_bf16 v[92:95], v[44:47], a[124:127], v[92:95]
    v_exp_f32 v164, v164
    v_mfma_f32_16x16x32_bf16 v[92:95], v[48:51], a[128:131], v[92:95]
    buffer_load_dwordx4 v[32:35], v190, s[48:51], s23 offen offset:1024 sc1
    v_mfma_f32_16x16x32_bf16 v[96:99], v[40:43], a[192:195], v[96:99]
    v_exp_f32 v165, v165
    v_mfma_f32_16x16x32_bf16 v[96:99], v[44:47], a[196:199], v[96:99]
    v_mul_f32 v166, v132, v148
    v_mul_f32 v167, v133, v149
    v_mfma_f32_16x16x32_bf16 v[96:99], v[48:51], a[200:203], v[96:99]
    v_mul_f32 v168, v134, v150
    v_mul_f32 v169, v135, v151
    v_mfma_f32_16x16x32_bf16 v[100:103], v[40:43], v[228:231], v[100:103]
    buffer_load_dwordx4 v[36:39], v190, s[48:51], s23 offen offset:2048 sc1
    v_mfma_f32_16x16x32_bf16 v[100:103], v[44:47], v[232:235], v[100:103]
    v_fma_f32 v162, v162, v252, v252
    v_fma_f32 v163, v163, v252, v252
    v_mfma_f32_16x16x32_bf16 v[100:103], v[48:51], v[236:239], v[100:103]
    v_fma_f32 v164, v164, v252, v252
    v_fma_f32 v165, v165, v252, v252
    s_waitcnt vmcnt(12)
    v_mfma_f32_16x16x32_bf16 v[104:107], v[52:55], a[48:51], v[104:107]
    v_rcp_f32 v162, v162
    v_mfma_f32_16x16x32_bf16 v[104:107], v[56:59], a[52:55], v[104:107]
    buffer_load_dwordx4 v[40:43], v190, s[48:51], s23 offen offset:3072 sc1
    v_mfma_f32_16x16x32_bf16 v[104:107], v[60:63], a[56:59], v[104:107]
    v_rcp_f32 v163, v163
    v_mfma_f32_16x16x32_bf16 v[108:111], v[52:55], a[120:123], v[108:111]
    v_rcp_f32 v164, v164
    v_mfma_f32_16x16x32_bf16 v[108:111], v[56:59], a[124:127], v[108:111]
    v_rcp_f32 v165, v165
    v_mfma_f32_16x16x32_bf16 v[108:111], v[60:63], a[128:131], v[108:111]
    buffer_load_dwordx4 v[44:47], v191, s[48:51], s23 offen offset:0 sc1
    v_mfma_f32_16x16x32_bf16 v[112:115], v[52:55], a[192:195], v[112:115]
    v_mul_f32 v166, v166, v162
    v_mul_f32 v167, v167, v163
    v_mfma_f32_16x16x32_bf16 v[112:115], v[56:59], a[196:199], v[112:115]
    v_mul_f32 v168, v168, v164
    v_mul_f32 v169, v169, v165
    v_mfma_f32_16x16x32_bf16 v[112:115], v[60:63], a[200:203], v[112:115]
    v_cvt_pk_bf16_f32 v170, v166, v167
    v_cvt_pk_bf16_f32 v171, v168, v169
    v_mfma_f32_16x16x32_bf16 v[116:119], v[52:55], v[228:231], v[116:119]
    buffer_load_dwordx4 v[48:51], v191, s[48:51], s23 offen offset:1024 sc1
    v_mfma_f32_16x16x32_bf16 v[116:119], v[56:59], v[232:235], v[116:119]
    ds_write_b64 v12, v[170:171] offset:55296
    v_mfma_f32_16x16x32_bf16 v[116:119], v[60:63], v[236:239], v[116:119]
    s_waitcnt vmcnt(12)
    v_mfma_f32_16x16x32_bf16 v[88:91], v[64:67], a[60:63], v[88:91]
    v_mfma_f32_16x16x32_bf16 v[88:91], v[68:71], a[64:67], v[88:91]
    buffer_load_dwordx4 v[52:55], v191, s[48:51], s23 offen offset:2048 sc1
    v_mfma_f32_16x16x32_bf16 v[120:123], v[72:75], a[68:71], v[88:91]
    v_mfma_f32_16x16x32_bf16 v[92:95], v[64:67], a[132:135], v[92:95]
    v_mfma_f32_16x16x32_bf16 v[92:95], v[68:71], a[136:139], v[92:95]
    v_mfma_f32_16x16x32_bf16 v[124:127], v[72:75], a[140:143], v[92:95]
    buffer_load_dwordx4 v[56:59], v191, s[48:51], s23 offen offset:3072 sc1
    v_mfma_f32_16x16x32_bf16 v[96:99], v[64:67], a[204:207], v[96:99]
    v_mfma_f32_16x16x32_bf16 v[96:99], v[68:71], a[208:211], v[96:99]
    v_mfma_f32_16x16x32_bf16 v[128:131], v[72:75], a[212:215], v[96:99]
    v_mfma_f32_16x16x32_bf16 v[100:103], v[64:67], v[240:243], v[100:103]
    buffer_load_dwordx4 v[60:63], v192, s[48:51], s23 offen offset:0 sc1
    v_mfma_f32_16x16x32_bf16 v[100:103], v[68:71], v[244:247], v[100:103]
    v_mfma_f32_16x16x32_bf16 v[132:135], v[72:75], v[248:251], v[100:103]
    s_waitcnt vmcnt(12)
    v_mfma_f32_16x16x32_bf16 v[104:107], v[76:79], a[60:63], v[104:107]
    v_mfma_f32_16x16x32_bf16 v[104:107], v[80:83], a[64:67], v[104:107]
    buffer_load_dwordx4 v[64:67], v192, s[48:51], s23 offen offset:1024 sc1
    v_mfma_f32_16x16x32_bf16 v[136:139], v[84:87], a[68:71], v[104:107]
    v_mfma_f32_16x16x32_bf16 v[108:111], v[76:79], a[132:135], v[108:111]
    v_mfma_f32_16x16x32_bf16 v[108:111], v[80:83], a[136:139], v[108:111]
    v_mfma_f32_16x16x32_bf16 v[140:143], v[84:87], a[140:143], v[108:111]
    buffer_load_dwordx4 v[68:71], v192, s[48:51], s23 offen offset:2048 sc1
    v_mfma_f32_16x16x32_bf16 v[112:115], v[76:79], a[204:207], v[112:115]
    v_mfma_f32_16x16x32_bf16 v[112:115], v[80:83], a[208:211], v[112:115]
    s_lshl_b32 s7, s25, 11
    v_mfma_f32_16x16x32_bf16 v[144:147], v[84:87], a[212:215], v[112:115]
    s_add_u32 s7, s7, s28
    v_mfma_f32_16x16x32_bf16 v[116:119], v[76:79], v[240:243], v[116:119]
    buffer_load_dwordx4 v[72:75], v192, s[48:51], s23 offen offset:3072 sc1
    v_mfma_f32_16x16x32_bf16 v[116:119], v[80:83], v[244:247], v[116:119]
    s_add_u32 s23, s23, 36864
    v_mfma_f32_16x16x32_bf16 v[148:151], v[84:87], v[248:251], v[116:119]
    v_add_u32 v12, s7, v184
    s_add_u32 s25, s25, 1
    s_cmp_lt_u32 s25, 8
    s_cbranch_scc1 L_ffn_gu_34
    v_add_u32 v10, 73728, v184
    v_add_u32 v11, 110592, v184
    s_lshr_b32 s7, s2, 3
    s_lshl_b32 s7, s7, 2
    s_add_u32 s7, s7, s3
    s_lshl_b32 s7, s7, 9
    v_lshrrev_b32 v1, 1, v253
    v_add_u32 v1, s7, v1
    buffer_load_dwordx2 v[2:3], v1, s[96:99], 0 offen
    s_waitcnt lgkmcnt(0)
    s_barrier
    s_waitcnt vmcnt(12)
    v_mfma_f32_16x16x32_bf16 v[88:91], v[16:19], a[0:3], 0
    v_mfma_f32_16x16x32_bf16 v[88:91], v[20:23], a[4:7], v[88:91]
    buffer_load_dwordx4 v[76:79], v184, s[48:51], s23 offen offset:0 sc1
    v_mfma_f32_16x16x32_bf16 v[88:91], v[24:27], a[8:11], v[88:91]
    v_mul_f32 v152, v120, v120
    v_mul_f32 v153, v121, v121
    v_mfma_f32_16x16x32_bf16 v[92:95], v[16:19], a[72:75], 0
    v_mul_f32 v154, v122, v122
    v_mul_f32 v155, v123, v123
    v_mfma_f32_16x16x32_bf16 v[92:95], v[20:23], a[76:79], v[92:95]
    v_fma_f32 v152, v152, v8, v4
    v_fma_f32 v153, v153, v8, v4
    v_mfma_f32_16x16x32_bf16 v[92:95], v[24:27], a[80:83], v[92:95]
    buffer_load_dwordx4 v[80:83], v184, s[48:51], s23 offen offset:1024 sc1
    v_mfma_f32_16x16x32_bf16 v[96:99], v[16:19], a[144:147], 0
    v_fma_f32 v154, v154, v8, v4
    v_fma_f32 v155, v155, v8, v4
    v_mfma_f32_16x16x32_bf16 v[96:99], v[20:23], a[148:151], v[96:99]
    v_mul_f32 v152, v120, v152
    v_mul_f32 v153, v121, v153
    v_mfma_f32_16x16x32_bf16 v[96:99], v[24:27], a[152:155], v[96:99]
    v_mul_f32 v154, v122, v154
    v_mul_f32 v155, v123, v155
    v_mfma_f32_16x16x32_bf16 v[100:103], v[16:19], a[216:219], 0
    buffer_load_dwordx4 v[84:87], v184, s[48:51], s23 offen offset:2048 sc1
    v_mfma_f32_16x16x32_bf16 v[100:103], v[20:23], a[220:223], v[100:103]
    v_exp_f32 v152, v152
    v_mfma_f32_16x16x32_bf16 v[100:103], v[24:27], a[224:227], v[100:103]
    v_exp_f32 v153, v153
    s_waitcnt vmcnt(12)
    v_mfma_f32_16x16x32_bf16 v[104:107], v[28:31], a[0:3], 0
    v_exp_f32 v154, v154
    ds_read_b128 a[0:3], v10 offset:0
    v_mfma_f32_16x16x32_bf16 v[104:107], v[32:35], a[4:7], v[104:107]
    buffer_load_dwordx4 v[16:19], v184, s[48:51], s23 offen offset:3072 sc1
    v_mfma_f32_16x16x32_bf16 v[104:107], v[36:39], a[8:11], v[104:107]
    v_exp_f32 v155, v155
    v_mfma_f32_16x16x32_bf16 v[108:111], v[28:31], a[72:75], 0
    v_mul_f32 v156, v120, v136
    v_mul_f32 v157, v121, v137
    ds_read_b128 a[72:75], v10 offset:18432
    v_mfma_f32_16x16x32_bf16 v[108:111], v[32:35], a[76:79], v[108:111]
    v_mul_f32 v158, v122, v138
    v_mul_f32 v159, v123, v139
    v_mfma_f32_16x16x32_bf16 v[108:111], v[36:39], a[80:83], v[108:111]
    buffer_load_dwordx4 v[20:23], v185, s[48:51], s23 offen offset:0 sc1
    v_mfma_f32_16x16x32_bf16 v[112:115], v[28:31], a[144:147], 0
    v_fma_f32 v152, v152, v193, v193
    v_fma_f32 v153, v153, v193, v193
    ds_read_b128 a[144:147], v11 offset:0
    v_mfma_f32_16x16x32_bf16 v[112:115], v[32:35], a[148:151], v[112:115]
    v_fma_f32 v154, v154, v193, v193
    v_fma_f32 v155, v155, v193, v193
    v_mfma_f32_16x16x32_bf16 v[112:115], v[36:39], a[152:155], v[112:115]
    v_rcp_f32 v152, v152
    v_mfma_f32_16x16x32_bf16 v[116:119], v[28:31], a[216:219], 0
    buffer_load_dwordx4 v[24:27], v185, s[48:51], s23 offen offset:1024 sc1
    v_mfma_f32_16x16x32_bf16 v[116:119], v[32:35], a[220:223], v[116:119]
    v_rcp_f32 v153, v153
    ds_read_b128 a[216:219], v11 offset:18432
    v_mfma_f32_16x16x32_bf16 v[116:119], v[36:39], a[224:227], v[116:119]
    v_rcp_f32 v154, v154
    ds_read_b128 a[4:7], v10 offset:1024
    s_waitcnt vmcnt(12)
    v_mfma_f32_16x16x32_bf16 v[88:91], v[40:43], a[12:15], v[88:91]
    v_rcp_f32 v155, v155
    ds_read_b128 a[76:79], v10 offset:19456
    v_mfma_f32_16x16x32_bf16 v[88:91], v[44:47], a[16:19], v[88:91]
    buffer_load_dwordx4 v[28:31], v185, s[48:51], s23 offen offset:2048 sc1
    v_mfma_f32_16x16x32_bf16 v[88:91], v[48:51], a[20:23], v[88:91]
    v_mul_f32 v156, v156, v152
    v_mul_f32 v157, v157, v153
    ds_read_b128 a[148:151], v11 offset:1024
    v_mfma_f32_16x16x32_bf16 v[92:95], v[40:43], a[84:87], v[92:95]
    v_mul_f32 v158, v158, v154
    v_mul_f32 v159, v159, v155
    ds_read_b128 a[220:223], v11 offset:19456
    v_mfma_f32_16x16x32_bf16 v[92:95], v[44:47], a[88:91], v[92:95]
    v_cvt_pk_bf16_f32 v160, v156, v157
    v_cvt_pk_bf16_f32 v161, v158, v159
    ds_read_b128 a[8:11], v10 offset:2048
    v_mfma_f32_16x16x32_bf16 v[92:95], v[48:51], a[92:95], v[92:95]
    buffer_load_dwordx4 v[32:35], v185, s[48:51], s23 offen offset:3072 sc1
    v_mfma_f32_16x16x32_bf16 v[96:99], v[40:43], a[156:159], v[96:99]
    ds_write_b64 v12, v[160:161] offset:0
    v_mfma_f32_16x16x32_bf16 v[96:99], v[44:47], a[160:163], v[96:99]
    v_mul_f32 v162, v124, v124
    v_mul_f32 v163, v125, v125
    ds_read_b128 a[80:83], v10 offset:20480
    v_mfma_f32_16x16x32_bf16 v[96:99], v[48:51], a[164:167], v[96:99]
    v_mul_f32 v164, v126, v126
    v_mul_f32 v165, v127, v127
    ds_read_b128 a[152:155], v11 offset:2048
    v_mfma_f32_16x16x32_bf16 v[100:103], v[40:43], a[228:231], v[100:103]
    buffer_load_dwordx4 v[36:39], v186, s[48:51], s23 offen offset:0 sc1
    v_mfma_f32_16x16x32_bf16 v[100:103], v[44:47], a[232:235], v[100:103]
    v_fma_f32 v162, v162, v9, v5
    v_fma_f32 v163, v163, v9, v5
    ds_read_b128 a[224:227], v11 offset:20480
    v_mfma_f32_16x16x32_bf16 v[100:103], v[48:51], a[236:239], v[100:103]
    v_fma_f32 v164, v164, v9, v5
    v_fma_f32 v165, v165, v9, v5
    s_waitcnt vmcnt(12)
    v_mfma_f32_16x16x32_bf16 v[104:107], v[52:55], a[12:15], v[104:107]
    v_mul_f32 v162, v124, v162
    v_mul_f32 v163, v125, v163
    ds_read_b128 a[12:15], v10 offset:3072
    v_mfma_f32_16x16x32_bf16 v[104:107], v[56:59], a[16:19], v[104:107]
    buffer_load_dwordx4 v[40:43], v186, s[48:51], s23 offen offset:1024 sc1
    v_mfma_f32_16x16x32_bf16 v[104:107], v[60:63], a[20:23], v[104:107]
    v_mul_f32 v164, v126, v164
    v_mul_f32 v165, v127, v165
    v_mfma_f32_16x16x32_bf16 v[108:111], v[52:55], a[84:87], v[108:111]
    v_exp_f32 v162, v162
    ds_read_b128 a[84:87], v10 offset:21504
    v_mfma_f32_16x16x32_bf16 v[108:111], v[56:59], a[88:91], v[108:111]
    v_exp_f32 v163, v163
    v_mfma_f32_16x16x32_bf16 v[108:111], v[60:63], a[92:95], v[108:111]
    buffer_load_dwordx4 v[44:47], v186, s[48:51], s23 offen offset:2048 sc1
    v_mfma_f32_16x16x32_bf16 v[112:115], v[52:55], a[156:159], v[112:115]
    v_exp_f32 v164, v164
    ds_read_b128 a[156:159], v11 offset:3072
    v_mfma_f32_16x16x32_bf16 v[112:115], v[56:59], a[160:163], v[112:115]
    v_exp_f32 v165, v165
    v_mfma_f32_16x16x32_bf16 v[112:115], v[60:63], a[164:167], v[112:115]
    v_mul_f32 v166, v124, v140
    v_mul_f32 v167, v125, v141
    v_mfma_f32_16x16x32_bf16 v[116:119], v[52:55], a[228:231], v[116:119]
    buffer_load_dwordx4 v[48:51], v186, s[48:51], s23 offen offset:3072 sc1
    v_mfma_f32_16x16x32_bf16 v[116:119], v[56:59], a[232:235], v[116:119]
    v_mul_f32 v168, v126, v142
    v_mul_f32 v169, v127, v143
    ds_read_b128 a[228:231], v11 offset:21504
    v_mfma_f32_16x16x32_bf16 v[116:119], v[60:63], a[236:239], v[116:119]
    v_fma_f32 v162, v162, v194, v194
    v_fma_f32 v163, v163, v194, v194
    ds_read_b128 a[16:19], v10 offset:4096
    s_waitcnt vmcnt(12)
    v_mfma_f32_16x16x32_bf16 v[88:91], v[64:67], a[24:27], v[88:91]
    v_fma_f32 v164, v164, v194, v194
    v_fma_f32 v165, v165, v194, v194
    ds_read_b128 a[88:91], v10 offset:22528
    v_mfma_f32_16x16x32_bf16 v[88:91], v[68:71], a[28:31], v[88:91]
    buffer_load_dwordx4 v[52:55], v187, s[48:51], s23 offen offset:0 sc1
    v_mfma_f32_16x16x32_bf16 v[88:91], v[72:75], a[32:35], v[88:91]
    v_rcp_f32 v162, v162
    ds_read_b128 a[160:163], v11 offset:4096
    v_mfma_f32_16x16x32_bf16 v[92:95], v[64:67], a[96:99], v[92:95]
    v_rcp_f32 v163, v163
    ds_read_b128 a[232:235], v11 offset:22528
    v_mfma_f32_16x16x32_bf16 v[92:95], v[68:71], a[100:103], v[92:95]
    v_rcp_f32 v164, v164
    ds_read_b128 a[20:23], v10 offset:5120
    v_mfma_f32_16x16x32_bf16 v[92:95], v[72:75], a[104:107], v[92:95]
    buffer_load_dwordx4 v[56:59], v187, s[48:51], s23 offen offset:1024 sc1
    v_mfma_f32_16x16x32_bf16 v[96:99], v[64:67], a[168:171], v[96:99]
    v_rcp_f32 v165, v165
    ds_read_b128 a[92:95], v10 offset:23552
    v_mfma_f32_16x16x32_bf16 v[96:99], v[68:71], a[172:175], v[96:99]
    v_mul_f32 v166, v166, v162
    v_mul_f32 v167, v167, v163
    ds_read_b128 a[164:167], v11 offset:5120
    v_mfma_f32_16x16x32_bf16 v[96:99], v[72:75], a[176:179], v[96:99]
    v_mul_f32 v168, v168, v164
    v_mul_f32 v169, v169, v165
    ds_read_b128 a[236:239], v11 offset:23552
    v_mfma_f32_16x16x32_bf16 v[100:103], v[64:67], a[240:243], v[100:103]
    buffer_load_dwordx4 v[60:63], v187, s[48:51], s23 offen offset:2048 sc1
    v_mfma_f32_16x16x32_bf16 v[100:103], v[68:71], a[244:247], v[100:103]
    v_cvt_pk_bf16_f32 v170, v166, v167
    v_cvt_pk_bf16_f32 v171, v168, v169
    v_mfma_f32_16x16x32_bf16 v[100:103], v[72:75], a[248:251], v[100:103]
    ds_write_b64 v12, v[170:171] offset:18432
    s_waitcnt vmcnt(12)
    v_mfma_f32_16x16x32_bf16 v[104:107], v[76:79], a[24:27], v[104:107]
    v_mul_f32 v152, v128, v128
    v_mul_f32 v153, v129, v129
    ds_read_b128 a[24:27], v10 offset:6144
    v_mfma_f32_16x16x32_bf16 v[104:107], v[80:83], a[28:31], v[104:107]
    buffer_load_dwordx4 v[64:67], v187, s[48:51], s23 offen offset:3072 sc1
    v_mfma_f32_16x16x32_bf16 v[104:107], v[84:87], a[32:35], v[104:107]
    v_mul_f32 v154, v130, v130
    v_mul_f32 v155, v131, v131
    v_mfma_f32_16x16x32_bf16 v[108:111], v[76:79], a[96:99], v[108:111]
    v_fma_f32 v152, v152, v13, v6
    v_fma_f32 v153, v153, v13, v6
    ds_read_b128 a[96:99], v10 offset:24576
    v_mfma_f32_16x16x32_bf16 v[108:111], v[80:83], a[100:103], v[108:111]
    v_fma_f32 v154, v154, v13, v6
    v_fma_f32 v155, v155, v13, v6
    v_mfma_f32_16x16x32_bf16 v[108:111], v[84:87], a[104:107], v[108:111]
    buffer_load_dwordx4 v[68:71], v188, s[48:51], s23 offen offset:0 sc1
    v_mfma_f32_16x16x32_bf16 v[112:115], v[76:79], a[168:171], v[112:115]
    v_mul_f32 v152, v128, v152
    v_mul_f32 v153, v129, v153
    ds_read_b128 a[168:171], v11 offset:6144
    v_mfma_f32_16x16x32_bf16 v[112:115], v[80:83], a[172:175], v[112:115]
    v_mul_f32 v154, v130, v154
    v_mul_f32 v155, v131, v155
    v_mfma_f32_16x16x32_bf16 v[112:115], v[84:87], a[176:179], v[112:115]
    v_exp_f32 v152, v152
    v_mfma_f32_16x16x32_bf16 v[116:119], v[76:79], a[240:243], v[116:119]
    buffer_load_dwordx4 v[72:75], v188, s[48:51], s23 offen offset:1024 sc1
    v_mfma_f32_16x16x32_bf16 v[116:119], v[80:83], a[244:247], v[116:119]
    v_exp_f32 v153, v153
    ds_read_b128 a[240:243], v11 offset:24576
    v_mfma_f32_16x16x32_bf16 v[116:119], v[84:87], a[248:251], v[116:119]
    v_exp_f32 v154, v154
    ds_read_b128 a[28:31], v10 offset:7168
    s_waitcnt vmcnt(12)
    v_mfma_f32_16x16x32_bf16 v[88:91], v[16:19], a[36:39], v[88:91]
    v_exp_f32 v155, v155
    ds_read_b128 a[100:103], v10 offset:25600
    v_mfma_f32_16x16x32_bf16 v[88:91], v[20:23], a[40:43], v[88:91]
    buffer_load_dwordx4 v[76:79], v188, s[48:51], s23 offen offset:2048 sc1
    v_mfma_f32_16x16x32_bf16 v[88:91], v[24:27], a[44:47], v[88:91]
    v_mul_f32 v156, v128, v144
    v_mul_f32 v157, v129, v145
    ds_read_b128 a[172:175], v11 offset:7168
    v_mfma_f32_16x16x32_bf16 v[92:95], v[16:19], a[108:111], v[92:95]
    v_mul_f32 v158, v130, v146
    v_mul_f32 v159, v131, v147
    ds_read_b128 a[244:247], v11 offset:25600
    v_mfma_f32_16x16x32_bf16 v[92:95], v[20:23], a[112:115], v[92:95]
    v_fma_f32 v152, v152, v195, v195
    v_fma_f32 v153, v153, v195, v195
    ds_read_b128 a[32:35], v10 offset:8192
    v_mfma_f32_16x16x32_bf16 v[92:95], v[24:27], a[116:119], v[92:95]
    buffer_load_dwordx4 v[80:83], v188, s[48:51], s23 offen offset:3072 sc1
    v_mfma_f32_16x16x32_bf16 v[96:99], v[16:19], a[180:183], v[96:99]
    v_fma_f32 v154, v154, v195, v195
    v_fma_f32 v155, v155, v195, v195
    ds_read_b128 a[104:107], v10 offset:26624
    v_mfma_f32_16x16x32_bf16 v[96:99], v[20:23], a[184:187], v[96:99]
    v_rcp_f32 v152, v152
    ds_read_b128 a[176:179], v11 offset:8192
    v_mfma_f32_16x16x32_bf16 v[96:99], v[24:27], a[188:191], v[96:99]
    v_rcp_f32 v153, v153
    ds_read_b128 a[248:251], v11 offset:26624
    v_mfma_f32_16x16x32_bf16 v[100:103], v[16:19], a[252:255], v[100:103]
    buffer_load_dwordx4 v[84:87], v189, s[48:51], s23 offen offset:0 sc1
    v_mfma_f32_16x16x32_bf16 v[100:103], v[20:23], v[220:223], v[100:103]
    v_rcp_f32 v154, v154
    v_mfma_f32_16x16x32_bf16 v[100:103], v[24:27], v[224:227], v[100:103]
    v_rcp_f32 v155, v155
    s_waitcnt vmcnt(12)
    v_mfma_f32_16x16x32_bf16 v[104:107], v[28:31], a[36:39], v[104:107]
    v_mul_f32 v156, v156, v152
    v_mul_f32 v157, v157, v153
    ds_read_b128 a[36:39], v10 offset:9216
    v_mfma_f32_16x16x32_bf16 v[104:107], v[32:35], a[40:43], v[104:107]
    buffer_load_dwordx4 v[16:19], v189, s[48:51], s23 offen offset:1024 sc1
    v_mfma_f32_16x16x32_bf16 v[104:107], v[36:39], a[44:47], v[104:107]
    v_mul_f32 v158, v158, v154
    v_mul_f32 v159, v159, v155
    v_mfma_f32_16x16x32_bf16 v[108:111], v[28:31], a[108:111], v[108:111]
    v_cvt_pk_bf16_f32 v160, v156, v157
    v_cvt_pk_bf16_f32 v161, v158, v159
    ds_read_b128 a[108:111], v10 offset:27648
    v_mfma_f32_16x16x32_bf16 v[108:111], v[32:35], a[112:115], v[108:111]
    ds_write_b64 v12, v[160:161] offset:36864
    v_mfma_f32_16x16x32_bf16 v[108:111], v[36:39], a[116:119], v[108:111]
    buffer_load_dwordx4 v[20:23], v189, s[48:51], s23 offen offset:2048 sc1
    v_mfma_f32_16x16x32_bf16 v[112:115], v[28:31], a[180:183], v[112:115]
    v_mul_f32 v162, v132, v132
    v_mul_f32 v163, v133, v133
    ds_read_b128 a[180:183], v11 offset:9216
    v_mfma_f32_16x16x32_bf16 v[112:115], v[32:35], a[184:187], v[112:115]
    v_mul_f32 v164, v134, v134
    v_mul_f32 v165, v135, v135
    v_mfma_f32_16x16x32_bf16 v[112:115], v[36:39], a[188:191], v[112:115]
    v_fma_f32 v162, v162, v14, v7
    v_fma_f32 v163, v163, v14, v7
    v_mfma_f32_16x16x32_bf16 v[116:119], v[28:31], a[252:255], v[116:119]
    buffer_load_dwordx4 v[24:27], v189, s[48:51], s23 offen offset:3072 sc1
    v_mfma_f32_16x16x32_bf16 v[116:119], v[32:35], v[220:223], v[116:119]
    v_fma_f32 v164, v164, v14, v7
    v_fma_f32 v165, v165, v14, v7
    ds_read_b128 a[252:255], v11 offset:27648
    v_mfma_f32_16x16x32_bf16 v[116:119], v[36:39], v[224:227], v[116:119]
    v_mul_f32 v162, v132, v162
    v_mul_f32 v163, v133, v163
    ds_read_b128 a[40:43], v10 offset:10240
    s_waitcnt vmcnt(12)
    v_mfma_f32_16x16x32_bf16 v[88:91], v[40:43], a[48:51], v[88:91]
    v_mul_f32 v164, v134, v164
    v_mul_f32 v165, v135, v165
    ds_read_b128 a[112:115], v10 offset:28672
    v_mfma_f32_16x16x32_bf16 v[88:91], v[44:47], a[52:55], v[88:91]
    buffer_load_dwordx4 v[28:31], v190, s[48:51], s23 offen offset:0 sc1
    v_mfma_f32_16x16x32_bf16 v[88:91], v[48:51], a[56:59], v[88:91]
    v_exp_f32 v162, v162
    ds_read_b128 a[184:187], v11 offset:10240
    v_mfma_f32_16x16x32_bf16 v[92:95], v[40:43], a[120:123], v[92:95]
    v_exp_f32 v163, v163
    ds_read_b128 v[220:223], v11 offset:28672
    v_mfma_f32_16x16x32_bf16 v[92:95], v[44:47], a[124:127], v[92:95]
    v_exp_f32 v164, v164
    ds_read_b128 a[44:47], v10 offset:11264
    v_mfma_f32_16x16x32_bf16 v[92:95], v[48:51], a[128:131], v[92:95]
    buffer_load_dwordx4 v[32:35], v190, s[48:51], s23 offen offset:1024 sc1
    v_mfma_f32_16x16x32_bf16 v[96:99], v[40:43], a[192:195], v[96:99]
    v_exp_f32 v165, v165
    ds_read_b128 a[116:119], v10 offset:29696
    v_mfma_f32_16x16x32_bf16 v[96:99], v[44:47], a[196:199], v[96:99]
    v_mul_f32 v166, v132, v148
    v_mul_f32 v167, v133, v149
    ds_read_b128 a[188:191], v11 offset:11264
    v_mfma_f32_16x16x32_bf16 v[96:99], v[48:51], a[200:203], v[96:99]
    v_mul_f32 v168, v134, v150
    v_mul_f32 v169, v135, v151
    ds_read_b128 v[224:227], v11 offset:29696
    v_mfma_f32_16x16x32_bf16 v[100:103], v[40:43], v[228:231], v[100:103]
    buffer_load_dwordx4 v[36:39], v190, s[48:51], s23 offen offset:2048 sc1
    v_mfma_f32_16x16x32_bf16 v[100:103], v[44:47], v[232:235], v[100:103]
    v_fma_f32 v162, v162, v252, v252
    v_fma_f32 v163, v163, v252, v252
    v_mfma_f32_16x16x32_bf16 v[100:103], v[48:51], v[236:239], v[100:103]
    v_fma_f32 v164, v164, v252, v252
    v_fma_f32 v165, v165, v252, v252
    s_waitcnt vmcnt(12)
    v_mfma_f32_16x16x32_bf16 v[104:107], v[52:55], a[48:51], v[104:107]
    v_rcp_f32 v162, v162
    ds_read_b128 a[48:51], v10 offset:12288
    v_mfma_f32_16x16x32_bf16 v[104:107], v[56:59], a[52:55], v[104:107]
    buffer_load_dwordx4 v[40:43], v190, s[48:51], s23 offen offset:3072 sc1
    v_mfma_f32_16x16x32_bf16 v[104:107], v[60:63], a[56:59], v[104:107]
    v_rcp_f32 v163, v163
    v_mfma_f32_16x16x32_bf16 v[108:111], v[52:55], a[120:123], v[108:111]
    v_rcp_f32 v164, v164
    ds_read_b128 a[120:123], v10 offset:30720
    v_mfma_f32_16x16x32_bf16 v[108:111], v[56:59], a[124:127], v[108:111]
    v_rcp_f32 v165, v165
    v_mfma_f32_16x16x32_bf16 v[108:111], v[60:63], a[128:131], v[108:111]
    buffer_load_dwordx4 v[44:47], v191, s[48:51], s23 offen offset:0 sc1
    v_mfma_f32_16x16x32_bf16 v[112:115], v[52:55], a[192:195], v[112:115]
    v_mul_f32 v166, v166, v162
    v_mul_f32 v167, v167, v163
    ds_read_b128 a[192:195], v11 offset:12288
    v_mfma_f32_16x16x32_bf16 v[112:115], v[56:59], a[196:199], v[112:115]
    v_mul_f32 v168, v168, v164
    v_mul_f32 v169, v169, v165
    v_mfma_f32_16x16x32_bf16 v[112:115], v[60:63], a[200:203], v[112:115]
    v_cvt_pk_bf16_f32 v170, v166, v167
    v_cvt_pk_bf16_f32 v171, v168, v169
    v_mfma_f32_16x16x32_bf16 v[116:119], v[52:55], v[228:231], v[116:119]
    buffer_load_dwordx4 v[48:51], v191, s[48:51], s23 offen offset:1024 sc1
    v_mfma_f32_16x16x32_bf16 v[116:119], v[56:59], v[232:235], v[116:119]
    ds_write_b64 v12, v[170:171] offset:55296
    v_mfma_f32_16x16x32_bf16 v[116:119], v[60:63], v[236:239], v[116:119]
    ds_read_b128 v[228:231], v11 offset:30720
    s_waitcnt vmcnt(12)
    v_mfma_f32_16x16x32_bf16 v[88:91], v[64:67], a[60:63], v[88:91]
    ds_read_b128 a[52:55], v10 offset:13312
    v_mfma_f32_16x16x32_bf16 v[88:91], v[68:71], a[64:67], v[88:91]
    buffer_load_dwordx4 v[52:55], v191, s[48:51], s23 offen offset:2048 sc1
    v_mfma_f32_16x16x32_bf16 v[120:123], v[72:75], a[68:71], v[88:91]
    ds_read_b128 a[124:127], v10 offset:31744
    v_mfma_f32_16x16x32_bf16 v[92:95], v[64:67], a[132:135], v[92:95]
    ds_read_b128 a[196:199], v11 offset:13312
    v_mfma_f32_16x16x32_bf16 v[92:95], v[68:71], a[136:139], v[92:95]
    ds_read_b128 v[232:235], v11 offset:31744
    v_mfma_f32_16x16x32_bf16 v[124:127], v[72:75], a[140:143], v[92:95]
    buffer_load_dwordx4 v[56:59], v191, s[48:51], s23 offen offset:3072 sc1
    v_mfma_f32_16x16x32_bf16 v[96:99], v[64:67], a[204:207], v[96:99]
    v_mfma_f32_16x16x32_bf16 v[96:99], v[68:71], a[208:211], v[96:99]
    v_mfma_f32_16x16x32_bf16 v[128:131], v[72:75], a[212:215], v[96:99]
    v_mfma_f32_16x16x32_bf16 v[100:103], v[64:67], v[240:243], v[100:103]
    buffer_load_dwordx4 v[60:63], v192, s[48:51], s23 offen offset:0 sc1
    v_mfma_f32_16x16x32_bf16 v[100:103], v[68:71], v[244:247], v[100:103]
    v_mfma_f32_16x16x32_bf16 v[132:135], v[72:75], v[248:251], v[100:103]
    s_waitcnt vmcnt(12)
    v_mfma_f32_16x16x32_bf16 v[104:107], v[76:79], a[60:63], v[104:107]
    v_mfma_f32_16x16x32_bf16 v[104:107], v[80:83], a[64:67], v[104:107]
    buffer_load_dwordx4 v[64:67], v192, s[48:51], s23 offen offset:1024 sc1
    v_mfma_f32_16x16x32_bf16 v[136:139], v[84:87], a[68:71], v[104:107]
    v_mfma_f32_16x16x32_bf16 v[108:111], v[76:79], a[132:135], v[108:111]
    v_mfma_f32_16x16x32_bf16 v[108:111], v[80:83], a[136:139], v[108:111]
    v_mfma_f32_16x16x32_bf16 v[140:143], v[84:87], a[140:143], v[108:111]
    buffer_load_dwordx4 v[68:71], v192, s[48:51], s23 offen offset:2048 sc1
    v_mfma_f32_16x16x32_bf16 v[112:115], v[76:79], a[204:207], v[112:115]
    v_mfma_f32_16x16x32_bf16 v[112:115], v[80:83], a[208:211], v[112:115]
    s_lshl_b32 s7, s25, 11
    v_mfma_f32_16x16x32_bf16 v[144:147], v[84:87], a[212:215], v[112:115]
    s_add_u32 s7, s7, s28
    v_mfma_f32_16x16x32_bf16 v[116:119], v[76:79], v[240:243], v[116:119]
    buffer_load_dwordx4 v[72:75], v192, s[48:51], s23 offen offset:3072 sc1
    v_mfma_f32_16x16x32_bf16 v[116:119], v[80:83], v[244:247], v[116:119]
    s_add_u32 s23, s23, 36864
    v_mfma_f32_16x16x32_bf16 v[148:151], v[84:87], v[248:251], v[116:119]
    v_add_u32 v12, s7, v184
    s_add_u32 s25, s25, 1
    s_waitcnt lgkmcnt(0)
    s_barrier
    v_pk_mul_f32 v[152:153], v[120:121], v[120:121]
    ds_read_b128 a[56:59], v10 offset:14336
    v_pk_mul_f32 v[154:155], v[122:123], v[122:123]
    ds_read_b128 a[128:131], v10 offset:32768
    v_pk_fma_f32 v[152:153], v[152:153], v[8:9], v[4:5] op_sel:[0,0,0] op_sel_hi:[1,0,0]
    ds_read_b128 a[200:203], v11 offset:14336
    v_pk_fma_f32 v[154:155], v[154:155], v[8:9], v[4:5] op_sel:[0,0,0] op_sel_hi:[1,0,0]
    v_pk_mul_f32 v[152:153], v[120:121], v[152:153]
    ds_read_b128 v[236:239], v11 offset:32768
    v_pk_mul_f32 v[154:155], v[122:123], v[154:155]
    ds_read_b128 a[60:63], v10 offset:15360
    buffer_load_dwordx4 v[76:79], v184, s[48:51], s23 offen offset:0 sc1
    v_exp_f32 v152, v152
    ds_read_b128 a[132:135], v10 offset:33792
    v_exp_f32 v153, v153
    v_exp_f32 v154, v154
    ds_read_b128 a[204:207], v11 offset:15360
    v_exp_f32 v155, v155
    ds_read_b128 v[240:243], v11 offset:33792
    v_pk_mul_f32 v[156:157], v[120:121], v[136:137]
    v_pk_mul_f32 v[158:159], v[122:123], v[138:139]
    buffer_load_dwordx4 v[80:83], v184, s[48:51], s23 offen offset:1024 sc1
    v_pk_fma_f32 v[152:153], v[152:153], v[192:193], v[192:193] op_sel:[0,1,1] op_sel_hi:[1,1,1]
    v_pk_fma_f32 v[154:155], v[154:155], v[192:193], v[192:193] op_sel:[0,1,1] op_sel_hi:[1,1,1]
    v_rcp_f32 v152, v152
    v_rcp_f32 v153, v153
    v_rcp_f32 v154, v154
    v_rcp_f32 v155, v155
    buffer_load_dwordx4 v[84:87], v184, s[48:51], s23 offen offset:2048 sc1
    s_nop 0
    v_pk_mul_f32 v[156:157], v[156:157], v[152:153]
    v_pk_mul_f32 v[158:159], v[158:159], v[154:155]
    v_cvt_pk_bf16_f32 v160, v156, v157
    v_cvt_pk_bf16_f32 v161, v158, v159
    ds_write_b64 v12, v[160:161] offset:0
    buffer_load_dwordx4 v[104:107], v184, s[48:51], s23 offen offset:3072 sc1
    v_pk_mul_f32 v[162:163], v[124:125], v[124:125]
    v_pk_mul_f32 v[164:165], v[126:127], v[126:127]
    v_pk_fma_f32 v[162:163], v[162:163], v[8:9], v[4:5] op_sel:[0,1,1] op_sel_hi:[1,1,1]
    v_pk_fma_f32 v[164:165], v[164:165], v[8:9], v[4:5] op_sel:[0,1,1] op_sel_hi:[1,1,1]
    v_pk_mul_f32 v[162:163], v[124:125], v[162:163]
    v_pk_mul_f32 v[164:165], v[126:127], v[164:165]
    buffer_load_dwordx4 v[108:111], v185, s[48:51], s23 offen offset:0 sc1
    v_exp_f32 v162, v162
    v_exp_f32 v163, v163
    v_exp_f32 v164, v164
    v_exp_f32 v165, v165
    v_pk_mul_f32 v[166:167], v[124:125], v[140:141]
    v_pk_mul_f32 v[168:169], v[126:127], v[142:143]
    buffer_load_dwordx4 v[112:115], v185, s[48:51], s23 offen offset:1024 sc1
    v_pk_fma_f32 v[162:163], v[162:163], v[194:195], v[194:195] op_sel:[0,0,0] op_sel_hi:[1,0,0]
    v_pk_fma_f32 v[164:165], v[164:165], v[194:195], v[194:195] op_sel:[0,0,0] op_sel_hi:[1,0,0]
    v_rcp_f32 v162, v162
    v_rcp_f32 v163, v163
    v_rcp_f32 v164, v164
    v_rcp_f32 v165, v165
    buffer_load_dwordx4 v[116:119], v185, s[48:51], s23 offen offset:2048 sc1
    s_nop 0
    v_pk_mul_f32 v[166:167], v[166:167], v[162:163]
    v_pk_mul_f32 v[168:169], v[168:169], v[164:165]
    v_cvt_pk_bf16_f32 v170, v166, v167
    v_cvt_pk_bf16_f32 v171, v168, v169
    ds_write_b64 v12, v[170:171] offset:18432
    buffer_load_dwordx4 v[180:183], v185, s[48:51], s23 offen offset:3072 sc1
    v_pk_mul_f32 v[152:153], v[128:129], v[128:129]
    v_pk_mul_f32 v[154:155], v[130:131], v[130:131]
    v_pk_fma_f32 v[152:153], v[152:153], v[12:13], v[6:7] op_sel:[0,1,0] op_sel_hi:[1,1,0]
    v_pk_fma_f32 v[154:155], v[154:155], v[12:13], v[6:7] op_sel:[0,1,0] op_sel_hi:[1,1,0]
    v_pk_mul_f32 v[152:153], v[128:129], v[152:153]
    v_pk_mul_f32 v[154:155], v[130:131], v[154:155]
    buffer_load_dwordx4 v[196:199], v186, s[48:51], s23 offen offset:0 sc1
    v_exp_f32 v152, v152
    v_exp_f32 v153, v153
    v_exp_f32 v154, v154
    v_exp_f32 v155, v155
    v_pk_mul_f32 v[156:157], v[128:129], v[144:145]
    v_pk_mul_f32 v[158:159], v[130:131], v[146:147]
    buffer_load_dwordx4 v[200:203], v186, s[48:51], s23 offen offset:1024 sc1
    v_pk_fma_f32 v[152:153], v[152:153], v[194:195], v[194:195] op_sel:[0,1,1] op_sel_hi:[1,1,1]
    v_pk_fma_f32 v[154:155], v[154:155], v[194:195], v[194:195] op_sel:[0,1,1] op_sel_hi:[1,1,1]
    v_rcp_f32 v152, v152
    v_rcp_f32 v153, v153
    v_rcp_f32 v154, v154
    v_rcp_f32 v155, v155
    buffer_load_dwordx4 v[204:207], v186, s[48:51], s23 offen offset:2048 sc1
    s_nop 0
    v_pk_mul_f32 v[156:157], v[156:157], v[152:153]
    v_pk_mul_f32 v[158:159], v[158:159], v[154:155]
    v_cvt_pk_bf16_f32 v160, v156, v157
    v_cvt_pk_bf16_f32 v161, v158, v159
    ds_write_b64 v12, v[160:161] offset:36864
    buffer_load_dwordx4 v[208:211], v186, s[48:51], s23 offen offset:3072 sc1
    v_pk_mul_f32 v[162:163], v[132:133], v[132:133]
    v_pk_mul_f32 v[164:165], v[134:135], v[134:135]
    v_pk_fma_f32 v[162:163], v[162:163], v[14:15], v[6:7] op_sel:[0,0,1] op_sel_hi:[1,0,1]
    v_pk_fma_f32 v[164:165], v[164:165], v[14:15], v[6:7] op_sel:[0,0,1] op_sel_hi:[1,0,1]
    v_pk_mul_f32 v[162:163], v[132:133], v[162:163]
    v_pk_mul_f32 v[164:165], v[134:135], v[164:165]
    buffer_load_dwordx4 v[212:215], v187, s[48:51], s23 offen offset:0 sc1
    v_exp_f32 v162, v162
    v_exp_f32 v163, v163
    v_exp_f32 v164, v164
    v_exp_f32 v165, v165
    v_pk_mul_f32 v[166:167], v[132:133], v[148:149]
    v_pk_mul_f32 v[168:169], v[134:135], v[150:151]
    v_pk_fma_f32 v[162:163], v[162:163], v[252:253], v[252:253] op_sel:[0,0,0] op_sel_hi:[1,0,0]
    v_pk_fma_f32 v[164:165], v[164:165], v[252:253], v[252:253] op_sel:[0,0,0] op_sel_hi:[1,0,0]
    v_rcp_f32 v162, v162
    v_rcp_f32 v163, v163
    v_rcp_f32 v164, v164
    v_rcp_f32 v165, v165
    s_nop 0
    v_pk_mul_f32 v[166:167], v[166:167], v[162:163]
    v_pk_mul_f32 v[168:169], v[168:169], v[164:165]
    v_cvt_pk_bf16_f32 v170, v166, v167
    v_cvt_pk_bf16_f32 v171, v168, v169
    ds_write_b64 v12, v[170:171] offset:55296
    buffer_load_dwordx4 v[136:139], v187, s[48:51], s23 offen offset:1024 sc1
    buffer_load_dwordx4 v[140:143], v187, s[48:51], s23 offen offset:2048 sc1
    buffer_load_dwordx4 v[144:147], v187, s[48:51], s23 offen offset:3072 sc1
    buffer_load_dwordx4 v[160:163], v188, s[48:51], s23 offen offset:0 sc1
    buffer_load_dwordx4 v[164:167], v188, s[48:51], s23 offen offset:1024 sc1
    s_add_u32 s23, s23, 18432
    s_waitcnt lgkmcnt(0)
    s_barrier
    ds_read_b128 a[64:67], v10 offset:16384
    ds_read_b128 a[136:139], v10 offset:34816
    ds_read_b128 a[208:211], v11 offset:16384
    ds_read_b128 v[244:247], v11 offset:34816
    ds_read_b128 a[68:71], v10 offset:17408
    ds_read_b128 a[140:143], v10 offset:35840
    ds_read_b128 a[212:215], v11 offset:17408
    ds_read_b128 v[248:251], v11 offset:35840
    s_mov_b32 s25, 0
    s_waitcnt lgkmcnt(0)
    s_branch L_ffn_dn_mid_36
L_ffn_dn_35:
    s_waitcnt vmcnt(32)
    v_mfma_f32_16x16x32_bf16 v[88:91], v[104:107], a[0:3], 0
    v_mfma_f32_16x16x32_bf16 v[88:91], v[108:111], a[4:7], v[88:91]
    buffer_load_dwordx4 v[76:79], v184, s[48:51], s23 offen offset:0 sc1
    v_mfma_f32_16x16x32_bf16 v[88:91], v[112:115], a[8:11], v[88:91]
    v_mfma_f32_16x16x32_bf16 v[92:95], v[104:107], a[72:75], 0
    v_mfma_f32_16x16x32_bf16 v[92:95], v[108:111], a[76:79], v[92:95]
    v_mfma_f32_16x16x32_bf16 v[92:95], v[112:115], a[80:83], v[92:95]
    buffer_load_dwordx4 v[80:83], v184, s[48:51], s23 offen offset:1024 sc1
    v_mfma_f32_16x16x32_bf16 v[96:99], v[104:107], a[144:147], 0
    v_cvt_pk_bf16_f32 v152, v120, v121
    v_cvt_pk_bf16_f32 v153, v122, v123
    v_mfma_f32_16x16x32_bf16 v[96:99], v[108:111], a[148:151], v[96:99]
    v_cvt_pk_bf16_f32 v154, v124, v125
    v_cvt_pk_bf16_f32 v155, v126, v127
    v_mfma_f32_16x16x32_bf16 v[96:99], v[112:115], a[152:155], v[96:99]
    v_cvt_pk_bf16_f32 v156, v128, v129
    v_cvt_pk_bf16_f32 v157, v130, v131
    v_mfma_f32_16x16x32_bf16 v[100:103], v[104:107], a[216:219], 0
    buffer_load_dwordx4 v[84:87], v184, s[48:51], s23 offen offset:2048 sc1
    v_mfma_f32_16x16x32_bf16 v[100:103], v[108:111], a[220:223], v[100:103]
    v_cvt_pk_bf16_f32 v158, v132, v133
    v_cvt_pk_bf16_f32 v159, v134, v135
    v_mfma_f32_16x16x32_bf16 v[100:103], v[112:115], a[224:227], v[100:103]
    v_permlane16_swap_b32 v152, v154
    s_waitcnt vmcnt(32)
    v_mfma_f32_16x16x32_bf16 v[88:91], v[116:119], a[12:15], v[88:91]
    v_permlane16_swap_b32 v153, v155
    v_mfma_f32_16x16x32_bf16 v[88:91], v[180:183], a[16:19], v[88:91]
    buffer_load_dwordx4 v[104:107], v184, s[48:51], s23 offen offset:3072 sc1
    v_mfma_f32_16x16x32_bf16 v[88:91], v[196:199], a[20:23], v[88:91]
    v_permlane16_swap_b32 v156, v158
    v_mfma_f32_16x16x32_bf16 v[92:95], v[116:119], a[84:87], v[92:95]
    v_permlane16_swap_b32 v157, v159
    v_mfma_f32_16x16x32_bf16 v[92:95], v[180:183], a[88:91], v[92:95]
    buffer_store_dwordx4 v[152:155], v178, s[72:75], s27 offen sc1
    v_mfma_f32_16x16x32_bf16 v[92:95], v[196:199], a[92:95], v[92:95]
    buffer_load_dwordx4 v[108:111], v185, s[48:51], s23 offen offset:0 sc1
    v_mfma_f32_16x16x32_bf16 v[96:99], v[116:119], a[156:159], v[96:99]
    buffer_store_dwordx4 v[156:159], v179, s[72:75], s27 offen sc1
    v_mfma_f32_16x16x32_bf16 v[96:99], v[180:183], a[160:163], v[96:99]
    ds_write_b128 v216, v[152:155]
    v_mfma_f32_16x16x32_bf16 v[96:99], v[196:199], a[164:167], v[96:99]
    v_add_u32 v216, v216, v218
    v_mfma_f32_16x16x32_bf16 v[100:103], v[116:119], a[228:231], v[100:103]
    buffer_load_dwordx4 v[112:115], v185, s[48:51], s23 offen offset:1024 sc1
    v_mfma_f32_16x16x32_bf16 v[100:103], v[180:183], a[232:235], v[100:103]
    ds_write_b128 v217, v[156:159]
    v_mfma_f32_16x16x32_bf16 v[100:103], v[196:199], a[236:239], v[100:103]
    v_add_u32 v217, v217, v219
    s_waitcnt vmcnt(34)
    v_mfma_f32_16x16x32_bf16 v[88:91], v[200:203], a[24:27], v[88:91]
    v_mfma_f32_16x16x32_bf16 v[88:91], v[204:207], a[28:31], v[88:91]
    buffer_load_dwordx4 v[116:119], v185, s[48:51], s23 offen offset:2048 sc1
    v_mfma_f32_16x16x32_bf16 v[88:91], v[208:211], a[32:35], v[88:91]
    v_mfma_f32_16x16x32_bf16 v[92:95], v[200:203], a[96:99], v[92:95]
    v_mfma_f32_16x16x32_bf16 v[92:95], v[204:207], a[100:103], v[92:95]
    v_mfma_f32_16x16x32_bf16 v[92:95], v[208:211], a[104:107], v[92:95]
    buffer_load_dwordx4 v[180:183], v185, s[48:51], s23 offen offset:3072 sc1
    v_mfma_f32_16x16x32_bf16 v[96:99], v[200:203], a[168:171], v[96:99]
    v_mfma_f32_16x16x32_bf16 v[96:99], v[204:207], a[172:175], v[96:99]
    v_mfma_f32_16x16x32_bf16 v[96:99], v[208:211], a[176:179], v[96:99]
    v_mfma_f32_16x16x32_bf16 v[100:103], v[200:203], a[240:243], v[100:103]
    buffer_load_dwordx4 v[196:199], v186, s[48:51], s23 offen offset:0 sc1
    v_mfma_f32_16x16x32_bf16 v[100:103], v[204:207], a[244:247], v[100:103]
    v_mfma_f32_16x16x32_bf16 v[100:103], v[208:211], a[248:251], v[100:103]
    s_waitcnt vmcnt(34)
    v_mfma_f32_16x16x32_bf16 v[88:91], v[212:215], a[36:39], v[88:91]
    v_mfma_f32_16x16x32_bf16 v[88:91], v[136:139], a[40:43], v[88:91]
    buffer_load_dwordx4 v[200:203], v186, s[48:51], s23 offen offset:1024 sc1
    v_mfma_f32_16x16x32_bf16 v[88:91], v[140:143], a[44:47], v[88:91]
    v_mfma_f32_16x16x32_bf16 v[92:95], v[212:215], a[108:111], v[92:95]
    v_mfma_f32_16x16x32_bf16 v[92:95], v[136:139], a[112:115], v[92:95]
    v_mfma_f32_16x16x32_bf16 v[92:95], v[140:143], a[116:119], v[92:95]
    buffer_load_dwordx4 v[204:207], v186, s[48:51], s23 offen offset:2048 sc1
    v_mfma_f32_16x16x32_bf16 v[96:99], v[212:215], a[180:183], v[96:99]
    v_mfma_f32_16x16x32_bf16 v[96:99], v[136:139], a[184:187], v[96:99]
    v_mfma_f32_16x16x32_bf16 v[96:99], v[140:143], a[188:191], v[96:99]
    v_mfma_f32_16x16x32_bf16 v[100:103], v[212:215], a[252:255], v[100:103]
    buffer_load_dwordx4 v[208:211], v186, s[48:51], s23 offen offset:3072 sc1
    v_mfma_f32_16x16x32_bf16 v[100:103], v[136:139], v[220:223], v[100:103]
    v_mfma_f32_16x16x32_bf16 v[100:103], v[140:143], v[224:227], v[100:103]
    s_waitcnt vmcnt(34)
    v_mfma_f32_16x16x32_bf16 v[88:91], v[144:147], a[48:51], v[88:91]
    v_mfma_f32_16x16x32_bf16 v[88:91], v[160:163], a[52:55], v[88:91]
    buffer_load_dwordx4 v[212:215], v187, s[48:51], s23 offen offset:0 sc1
    v_mfma_f32_16x16x32_bf16 v[88:91], v[164:167], a[56:59], v[88:91]
    v_mfma_f32_16x16x32_bf16 v[92:95], v[144:147], a[120:123], v[92:95]
    v_mfma_f32_16x16x32_bf16 v[92:95], v[160:163], a[124:127], v[92:95]
    v_mfma_f32_16x16x32_bf16 v[92:95], v[164:167], a[128:131], v[92:95]
    buffer_load_dwordx4 v[136:139], v187, s[48:51], s23 offen offset:1024 sc1
    v_mfma_f32_16x16x32_bf16 v[96:99], v[144:147], a[192:195], v[96:99]
    v_mfma_f32_16x16x32_bf16 v[96:99], v[160:163], a[196:199], v[96:99]
    v_mfma_f32_16x16x32_bf16 v[96:99], v[164:167], a[200:203], v[96:99]
    v_mfma_f32_16x16x32_bf16 v[100:103], v[144:147], v[228:231], v[100:103]
    buffer_load_dwordx4 v[140:143], v187, s[48:51], s23 offen offset:2048 sc1
    v_mfma_f32_16x16x32_bf16 v[100:103], v[160:163], v[232:235], v[100:103]
    v_mfma_f32_16x16x32_bf16 v[100:103], v[164:167], v[236:239], v[100:103]
    s_waitcnt vmcnt(34)
    v_mfma_f32_16x16x32_bf16 v[88:91], v[168:171], a[60:63], v[88:91]
    v_mfma_f32_16x16x32_bf16 v[88:91], v[148:151], a[64:67], v[88:91]
    buffer_load_dwordx4 v[144:147], v187, s[48:51], s23 offen offset:3072 sc1
    v_mfma_f32_16x16x32_bf16 v[120:123], v[4:7], a[68:71], v[88:91]
    v_mfma_f32_16x16x32_bf16 v[92:95], v[168:171], a[132:135], v[92:95]
    v_mfma_f32_16x16x32_bf16 v[92:95], v[148:151], a[136:139], v[92:95]
    v_mfma_f32_16x16x32_bf16 v[124:127], v[4:7], a[140:143], v[92:95]
    buffer_load_dwordx4 v[160:163], v188, s[48:51], s23 offen offset:0 sc1
    v_mfma_f32_16x16x32_bf16 v[96:99], v[168:171], a[204:207], v[96:99]
    s_mov_b32 s74, 268435456
    v_mfma_f32_16x16x32_bf16 v[96:99], v[148:151], a[208:211], v[96:99]
    s_add_u32 s27, s27, 1024
    v_mfma_f32_16x16x32_bf16 v[128:131], v[4:7], a[212:215], v[96:99]
    s_add_u32 s25, s25, 1
    v_mfma_f32_16x16x32_bf16 v[100:103], v[168:171], v[240:243], v[100:103]
    buffer_load_dwordx4 v[164:167], v188, s[48:51], s23 offen offset:1024 sc1
    v_mfma_f32_16x16x32_bf16 v[100:103], v[148:151], v[244:247], v[100:103]
    s_add_u32 s23, s23, 18432
    v_mfma_f32_16x16x32_bf16 v[132:135], v[4:7], v[248:251], v[100:103]
L_ffn_dn_mid_36:
    s_waitcnt vmcnt(30)
    v_mfma_f32_16x16x32_bf16 v[88:91], v[16:19], a[0:3], 0
    v_mfma_f32_16x16x32_bf16 v[88:91], v[20:23], a[4:7], v[88:91]
    buffer_load_dwordx4 v[168:171], v184, s[48:51], s23 offen offset:0 sc1
    v_mfma_f32_16x16x32_bf16 v[88:91], v[24:27], a[8:11], v[88:91]
    v_mfma_f32_16x16x32_bf16 v[92:95], v[16:19], a[72:75], 0
    v_mfma_f32_16x16x32_bf16 v[92:95], v[20:23], a[76:79], v[92:95]
    v_mfma_f32_16x16x32_bf16 v[92:95], v[24:27], a[80:83], v[92:95]
    buffer_load_dwordx4 v[148:151], v184, s[48:51], s23 offen offset:1024 sc1
    v_mfma_f32_16x16x32_bf16 v[96:99], v[16:19], a[144:147], 0
    v_cvt_pk_bf16_f32 v152, v120, v121
    v_cvt_pk_bf16_f32 v153, v122, v123
    v_mfma_f32_16x16x32_bf16 v[96:99], v[20:23], a[148:151], v[96:99]
    v_cvt_pk_bf16_f32 v154, v124, v125
    v_cvt_pk_bf16_f32 v155, v126, v127
    v_mfma_f32_16x16x32_bf16 v[96:99], v[24:27], a[152:155], v[96:99]
    v_cvt_pk_bf16_f32 v156, v128, v129
    v_cvt_pk_bf16_f32 v157, v130, v131
    v_mfma_f32_16x16x32_bf16 v[100:103], v[16:19], a[216:219], 0
    buffer_load_dwordx4 v[4:7], v184, s[48:51], s23 offen offset:2048 sc1
    v_mfma_f32_16x16x32_bf16 v[100:103], v[20:23], a[220:223], v[100:103]
    v_cvt_pk_bf16_f32 v158, v132, v133
    v_cvt_pk_bf16_f32 v159, v134, v135
    v_mfma_f32_16x16x32_bf16 v[100:103], v[24:27], a[224:227], v[100:103]
    v_permlane16_swap_b32 v152, v154
    s_waitcnt vmcnt(30)
    v_mfma_f32_16x16x32_bf16 v[88:91], v[28:31], a[12:15], v[88:91]
    v_permlane16_swap_b32 v153, v155
    v_mfma_f32_16x16x32_bf16 v[88:91], v[32:35], a[16:19], v[88:91]
    buffer_load_dwordx4 v[16:19], v184, s[48:51], s23 offen offset:3072 sc1
    v_mfma_f32_16x16x32_bf16 v[88:91], v[36:39], a[20:23], v[88:91]
    v_permlane16_swap_b32 v156, v158
    v_mfma_f32_16x16x32_bf16 v[92:95], v[28:31], a[84:87], v[92:95]
    v_permlane16_swap_b32 v157, v159
    v_mfma_f32_16x16x32_bf16 v[92:95], v[32:35], a[88:91], v[92:95]
    buffer_store_dwordx4 v[152:155], v178, s[72:75], s27 offen sc1
    v_mfma_f32_16x16x32_bf16 v[92:95], v[36:39], a[92:95], v[92:95]
    buffer_load_dwordx4 v[20:23], v185, s[48:51], s23 offen offset:0 sc1
    v_mfma_f32_16x16x32_bf16 v[96:99], v[28:31], a[156:159], v[96:99]
    buffer_store_dwordx4 v[156:159], v179, s[72:75], s27 offen sc1
    v_mfma_f32_16x16x32_bf16 v[96:99], v[32:35], a[160:163], v[96:99]
    ds_write_b128 v216, v[152:155]
    v_mfma_f32_16x16x32_bf16 v[96:99], v[36:39], a[164:167], v[96:99]
    v_add_u32 v216, v216, v218
    v_mfma_f32_16x16x32_bf16 v[100:103], v[28:31], a[228:231], v[100:103]
    buffer_load_dwordx4 v[24:27], v185, s[48:51], s23 offen offset:1024 sc1
    v_mfma_f32_16x16x32_bf16 v[100:103], v[32:35], a[232:235], v[100:103]
    ds_write_b128 v217, v[156:159]
    v_mfma_f32_16x16x32_bf16 v[100:103], v[36:39], a[236:239], v[100:103]
    v_add_u32 v217, v217, v219
    s_waitcnt vmcnt(32)
    v_mfma_f32_16x16x32_bf16 v[88:91], v[40:43], a[24:27], v[88:91]
    v_mfma_f32_16x16x32_bf16 v[88:91], v[44:47], a[28:31], v[88:91]
    buffer_load_dwordx4 v[28:31], v185, s[48:51], s23 offen offset:2048 sc1
    v_mfma_f32_16x16x32_bf16 v[88:91], v[48:51], a[32:35], v[88:91]
    v_mfma_f32_16x16x32_bf16 v[92:95], v[40:43], a[96:99], v[92:95]
    v_mfma_f32_16x16x32_bf16 v[92:95], v[44:47], a[100:103], v[92:95]
    v_mfma_f32_16x16x32_bf16 v[92:95], v[48:51], a[104:107], v[92:95]
    buffer_load_dwordx4 v[32:35], v185, s[48:51], s23 offen offset:3072 sc1
    v_mfma_f32_16x16x32_bf16 v[96:99], v[40:43], a[168:171], v[96:99]
    v_mfma_f32_16x16x32_bf16 v[96:99], v[44:47], a[172:175], v[96:99]
    v_mfma_f32_16x16x32_bf16 v[96:99], v[48:51], a[176:179], v[96:99]
    v_mfma_f32_16x16x32_bf16 v[100:103], v[40:43], a[240:243], v[100:103]
    buffer_load_dwordx4 v[36:39], v186, s[48:51], s23 offen offset:0 sc1
    v_mfma_f32_16x16x32_bf16 v[100:103], v[44:47], a[244:247], v[100:103]
    v_mfma_f32_16x16x32_bf16 v[100:103], v[48:51], a[248:251], v[100:103]
    s_waitcnt vmcnt(32)
    s_cmp_lg_u32 s25, 6
    s_cbranch_scc1 L_early_37
    s_waitcnt vmcnt(24)
    s_barrier
    s_cmp_lg_u32 s3, 0
    s_cbranch_scc1 L_early_37
    v_lshlrev_b32 v15, 7, v0
    v_mov_b32 v1, s76
    s_mov_b64 exec, 0xff
    buffer_store_dword v1, v15, s[8:11], s29 offen sc1
    s_mov_b64 exec, -1
L_early_37:
    v_mfma_f32_16x16x32_bf16 v[88:91], v[52:55], a[36:39], v[88:91]
    v_mfma_f32_16x16x32_bf16 v[88:91], v[56:59], a[40:43], v[88:91]
    buffer_load_dwordx4 v[40:43], v186, s[48:51], s23 offen offset:1024 sc1
    v_mfma_f32_16x16x32_bf16 v[88:91], v[60:63], a[44:47], v[88:91]
    v_mfma_f32_16x16x32_bf16 v[92:95], v[52:55], a[108:111], v[92:95]
    v_mfma_f32_16x16x32_bf16 v[92:95], v[56:59], a[112:115], v[92:95]
    v_mfma_f32_16x16x32_bf16 v[92:95], v[60:63], a[116:119], v[92:95]
    buffer_load_dwordx4 v[44:47], v186, s[48:51], s23 offen offset:2048 sc1
    v_mfma_f32_16x16x32_bf16 v[96:99], v[52:55], a[180:183], v[96:99]
    v_mfma_f32_16x16x32_bf16 v[96:99], v[56:59], a[184:187], v[96:99]
    v_mfma_f32_16x16x32_bf16 v[96:99], v[60:63], a[188:191], v[96:99]
    v_mfma_f32_16x16x32_bf16 v[100:103], v[52:55], a[252:255], v[100:103]
    buffer_load_dwordx4 v[48:51], v186, s[48:51], s23 offen offset:3072 sc1
    v_mfma_f32_16x16x32_bf16 v[100:103], v[56:59], v[220:223], v[100:103]
    v_mfma_f32_16x16x32_bf16 v[100:103], v[60:63], v[224:227], v[100:103]
    s_waitcnt vmcnt(32)
    v_mfma_f32_16x16x32_bf16 v[88:91], v[64:67], a[48:51], v[88:91]
    v_mfma_f32_16x16x32_bf16 v[88:91], v[68:71], a[52:55], v[88:91]
    buffer_load_dwordx4 v[52:55], v187, s[48:51], s23 offen offset:0 sc1
    v_mfma_f32_16x16x32_bf16 v[88:91], v[72:75], a[56:59], v[88:91]
    v_mfma_f32_16x16x32_bf16 v[92:95], v[64:67], a[120:123], v[92:95]
    v_mfma_f32_16x16x32_bf16 v[92:95], v[68:71], a[124:127], v[92:95]
    v_mfma_f32_16x16x32_bf16 v[92:95], v[72:75], a[128:131], v[92:95]
    buffer_load_dwordx4 v[56:59], v187, s[48:51], s23 offen offset:1024 sc1
    v_mfma_f32_16x16x32_bf16 v[96:99], v[64:67], a[192:195], v[96:99]
    v_mfma_f32_16x16x32_bf16 v[96:99], v[68:71], a[196:199], v[96:99]
    v_mfma_f32_16x16x32_bf16 v[96:99], v[72:75], a[200:203], v[96:99]
    v_mfma_f32_16x16x32_bf16 v[100:103], v[64:67], v[228:231], v[100:103]
    buffer_load_dwordx4 v[60:63], v187, s[48:51], s23 offen offset:2048 sc1
    v_mfma_f32_16x16x32_bf16 v[100:103], v[68:71], v[232:235], v[100:103]
    v_mfma_f32_16x16x32_bf16 v[100:103], v[72:75], v[236:239], v[100:103]
    s_waitcnt vmcnt(32)
    v_mfma_f32_16x16x32_bf16 v[88:91], v[76:79], a[60:63], v[88:91]
    v_mfma_f32_16x16x32_bf16 v[88:91], v[80:83], a[64:67], v[88:91]
    buffer_load_dwordx4 v[64:67], v187, s[48:51], s23 offen offset:3072 sc1
    v_mfma_f32_16x16x32_bf16 v[120:123], v[84:87], a[68:71], v[88:91]
    v_mfma_f32_16x16x32_bf16 v[92:95], v[76:79], a[132:135], v[92:95]
    v_mfma_f32_16x16x32_bf16 v[92:95], v[80:83], a[136:139], v[92:95]
    v_mfma_f32_16x16x32_bf16 v[124:127], v[84:87], a[140:143], v[92:95]
    buffer_load_dwordx4 v[68:71], v188, s[48:51], s23 offen offset:0 sc1
    v_mfma_f32_16x16x32_bf16 v[96:99], v[76:79], a[204:207], v[96:99]
    s_mov_b32 s74, 268435456
    v_mfma_f32_16x16x32_bf16 v[96:99], v[80:83], a[208:211], v[96:99]
    s_add_u32 s27, s27, 1024
    v_mfma_f32_16x16x32_bf16 v[128:131], v[84:87], a[212:215], v[96:99]
    s_add_u32 s25, s25, 1
    v_mfma_f32_16x16x32_bf16 v[100:103], v[76:79], v[240:243], v[100:103]
    buffer_load_dwordx4 v[72:75], v188, s[48:51], s23 offen offset:1024 sc1
    v_mfma_f32_16x16x32_bf16 v[100:103], v[80:83], v[244:247], v[100:103]
    s_add_u32 s23, s23, 18432
    v_mfma_f32_16x16x32_bf16 v[132:135], v[84:87], v[248:251], v[100:103]
    s_cmp_lt_u32 s25, 7
    s_cbranch_scc1 L_ffn_dn_35
    s_waitcnt vmcnt(32)
    v_mfma_f32_16x16x32_bf16 v[88:91], v[104:107], a[0:3], 0
    v_mfma_f32_16x16x32_bf16 v[88:91], v[108:111], a[4:7], v[88:91]
    buffer_load_dwordx4 v[76:79], v184, s[48:51], s23 offen offset:0 sc1
    v_mfma_f32_16x16x32_bf16 v[88:91], v[112:115], a[8:11], v[88:91]
    v_mfma_f32_16x16x32_bf16 v[92:95], v[104:107], a[72:75], 0
    v_mfma_f32_16x16x32_bf16 v[92:95], v[108:111], a[76:79], v[92:95]
    v_mfma_f32_16x16x32_bf16 v[92:95], v[112:115], a[80:83], v[92:95]
    buffer_load_dwordx4 v[80:83], v184, s[48:51], s23 offen offset:1024 sc1
    v_mfma_f32_16x16x32_bf16 v[96:99], v[104:107], a[144:147], 0
    v_cvt_pk_bf16_f32 v152, v120, v121
    v_cvt_pk_bf16_f32 v153, v122, v123
    v_mfma_f32_16x16x32_bf16 v[96:99], v[108:111], a[148:151], v[96:99]
    v_cvt_pk_bf16_f32 v154, v124, v125
    v_cvt_pk_bf16_f32 v155, v126, v127
    v_mfma_f32_16x16x32_bf16 v[96:99], v[112:115], a[152:155], v[96:99]
    v_cvt_pk_bf16_f32 v156, v128, v129
    v_cvt_pk_bf16_f32 v157, v130, v131
    v_mfma_f32_16x16x32_bf16 v[100:103], v[104:107], a[216:219], 0
    buffer_load_dwordx4 v[84:87], v184, s[48:51], s23 offen offset:2048 sc1
    v_mfma_f32_16x16x32_bf16 v[100:103], v[108:111], a[220:223], v[100:103]
    v_cvt_pk_bf16_f32 v158, v132, v133
    v_cvt_pk_bf16_f32 v159, v134, v135
    v_mfma_f32_16x16x32_bf16 v[100:103], v[112:115], a[224:227], v[100:103]
    v_permlane16_swap_b32 v152, v154
    s_waitcnt vmcnt(32)
    v_mfma_f32_16x16x32_bf16 v[88:91], v[116:119], a[12:15], v[88:91]
    v_permlane16_swap_b32 v153, v155
    v_mfma_f32_16x16x32_bf16 v[88:91], v[180:183], a[16:19], v[88:91]
    v_permlane16_swap_b32 v156, v158
    v_mfma_f32_16x16x32_bf16 v[88:91], v[196:199], a[20:23], v[88:91]
    v_permlane16_swap_b32 v157, v159
    s_load_dwordx8 s[56:63], s[38:39], 0 glc
    v_mfma_f32_16x16x32_bf16 v[92:95], v[116:119], a[84:87], v[92:95]
    buffer_store_dwordx4 v[152:155], v178, s[72:75], s27 offen sc1
    s_mov_b32 s6, 0
    v_mfma_f32_16x16x32_bf16 v[92:95], v[180:183], a[88:91], v[92:95]
    buffer_store_dwordx4 v[156:159], v179, s[72:75], s27 offen sc1
    v_mfma_f32_16x16x32_bf16 v[92:95], v[196:199], a[92:95], v[92:95]
    ds_write_b128 v216, v[152:155]
    v_mfma_f32_16x16x32_bf16 v[96:99], v[116:119], a[156:159], v[96:99]
    v_add_u32 v216, v216, v218
    v_mfma_f32_16x16x32_bf16 v[96:99], v[180:183], a[160:163], v[96:99]
    ds_write_b128 v217, v[156:159]
    v_mfma_f32_16x16x32_bf16 v[96:99], v[196:199], a[164:167], v[96:99]
    v_add_u32 v217, v217, v219
    v_mfma_f32_16x16x32_bf16 v[100:103], v[116:119], a[228:231], v[100:103]
    v_mfma_f32_16x16x32_bf16 v[100:103], v[180:183], a[232:235], v[100:103]
    v_mfma_f32_16x16x32_bf16 v[100:103], v[196:199], a[236:239], v[100:103]
    s_waitcnt vmcnt(31)
L_epoll_38:
    s_waitcnt lgkmcnt(0)
    s_xor_b64 s[56:57], s[56:57], s[76:77]
    s_xor_b64 s[58:59], s[58:59], s[76:77]
    s_xor_b64 s[60:61], s[60:61], s[76:77]
    s_xor_b64 s[62:63], s[62:63], s[76:77]
    s_or_b64 s[56:57], s[56:57], s[58:59]
    s_or_b64 s[60:61], s[60:61], s[62:63]
    s_or_b64 s[56:57], s[56:57], s[60:61]
    s_cbranch_scc0 L_epolled_39
    s_load_dwordx8 s[56:63], s[38:39], 0 glc
    s_add_u32 s6, s6, 1
    s_cmp_lt_u32 s6, 1048576
    s_cbranch_scc1 L_epoll_38
    s_branch L_main_end
L_epolled_39:
    v_mfma_f32_16x16x32_bf16 v[88:91], v[200:203], a[24:27], v[88:91]
    v_mfma_f32_16x16x32_bf16 v[88:91], v[204:207], a[28:31], v[88:91]
    s_add_u32 s7, s40, 1
    s_and_b32 s7, s7, 7
    s_mul_i32 s7, s7, 9216
    s_add_u32 s19, s7, s20
    buffer_load_dwordx4 v[104:107], v172, s[8:11], s19 offen sc1
    v_mfma_f32_16x16x32_bf16 v[88:91], v[208:211], a[32:35], v[88:91]
    v_mfma_f32_16x16x32_bf16 v[92:95], v[200:203], a[96:99], v[92:95]
    v_mfma_f32_16x16x32_bf16 v[92:95], v[204:207], a[100:103], v[92:95]
    v_mfma_f32_16x16x32_bf16 v[92:95], v[208:211], a[104:107], v[92:95]
    buffer_load_dwordx4 v[108:111], v173, s[8:11], s19 offen sc1
    v_mfma_f32_16x16x32_bf16 v[96:99], v[200:203], a[168:171], v[96:99]
    v_mfma_f32_16x16x32_bf16 v[96:99], v[204:207], a[172:175], v[96:99]
    v_mfma_f32_16x16x32_bf16 v[96:99], v[208:211], a[176:179], v[96:99]
    v_mfma_f32_16x16x32_bf16 v[100:103], v[200:203], a[240:243], v[100:103]
    s_add_u32 s7, s40, 2
    s_and_b32 s7, s7, 7
    s_mul_i32 s7, s7, 9216
    s_add_u32 s19, s7, s20
    buffer_load_dwordx4 v[112:115], v172, s[8:11], s19 offen sc1
    v_mfma_f32_16x16x32_bf16 v[100:103], v[204:207], a[244:247], v[100:103]
    v_mfma_f32_16x16x32_bf16 v[100:103], v[208:211], a[248:251], v[100:103]
    s_waitcnt vmcnt(31)
    v_mfma_f32_16x16x32_bf16 v[88:91], v[212:215], a[36:39], v[88:91]
    v_mfma_f32_16x16x32_bf16 v[88:91], v[136:139], a[40:43], v[88:91]
    buffer_load_dwordx4 v[116:119], v173, s[8:11], s19 offen sc1
    v_mfma_f32_16x16x32_bf16 v[88:91], v[140:143], a[44:47], v[88:91]
    v_mfma_f32_16x16x32_bf16 v[92:95], v[212:215], a[108:111], v[92:95]
    v_mfma_f32_16x16x32_bf16 v[92:95], v[136:139], a[112:115], v[92:95]
    v_mfma_f32_16x16x32_bf16 v[92:95], v[140:143], a[116:119], v[92:95]
    s_add_u32 s7, s40, 3
    s_and_b32 s7, s7, 7
    s_mul_i32 s7, s7, 9216
    s_add_u32 s19, s7, s20
    buffer_load_dwordx4 v[180:183], v172, s[8:11], s19 offen sc1
    v_mfma_f32_16x16x32_bf16 v[96:99], v[212:215], a[180:183], v[96:99]
    v_mfma_f32_16x16x32_bf16 v[96:99], v[136:139], a[184:187], v[96:99]
    v_mfma_f32_16x16x32_bf16 v[96:99], v[140:143], a[188:191], v[96:99]
    v_mfma_f32_16x16x32_bf16 v[100:103], v[212:215], a[252:255], v[100:103]
    buffer_load_dwordx4 v[196:199], v173, s[8:11], s19 offen sc1
    v_mfma_f32_16x16x32_bf16 v[100:103], v[136:139], v[220:223], v[100:103]
    v_mfma_f32_16x16x32_bf16 v[100:103], v[140:143], v[224:227], v[100:103]
    s_waitcnt vmcnt(31)
    v_mfma_f32_16x16x32_bf16 v[88:91], v[144:147], a[48:51], v[88:91]
    v_mfma_f32_16x16x32_bf16 v[88:91], v[160:163], a[52:55], v[88:91]
    s_add_u32 s7, s40, 4
    s_and_b32 s7, s7, 7
    s_mul_i32 s7, s7, 9216
    s_add_u32 s19, s7, s20
    buffer_load_dwordx4 v[200:203], v172, s[8:11], s19 offen sc1
    v_mfma_f32_16x16x32_bf16 v[88:91], v[164:167], a[56:59], v[88:91]
    v_mfma_f32_16x16x32_bf16 v[92:95], v[144:147], a[120:123], v[92:95]
    v_mfma_f32_16x16x32_bf16 v[92:95], v[160:163], a[124:127], v[92:95]
    v_mfma_f32_16x16x32_bf16 v[92:95], v[164:167], a[128:131], v[92:95]
    buffer_load_dwordx4 v[204:207], v173, s[8:11], s19 offen sc1
    v_mfma_f32_16x16x32_bf16 v[96:99], v[144:147], a[192:195], v[96:99]
    v_mfma_f32_16x16x32_bf16 v[96:99], v[160:163], a[196:199], v[96:99]
    v_mfma_f32_16x16x32_bf16 v[96:99], v[164:167], a[200:203], v[96:99]
    v_mfma_f32_16x16x32_bf16 v[100:103], v[144:147], v[228:231], v[100:103]
    s_add_u32 s7, s40, 5
    s_and_b32 s7, s7, 7
    s_mul_i32 s7, s7, 9216
    s_add_u32 s19, s7, s20
    buffer_load_dwordx4 v[208:211], v172, s[8:11], s19 offen sc1
    v_mfma_f32_16x16x32_bf16 v[100:103], v[160:163], v[232:235], v[100:103]
    v_mfma_f32_16x16x32_bf16 v[100:103], v[164:167], v[236:239], v[100:103]
    s_waitcnt vmcnt(31)
    v_mfma_f32_16x16x32_bf16 v[88:91], v[168:171], a[60:63], v[88:91]
    v_mfma_f32_16x16x32_bf16 v[88:91], v[148:151], a[64:67], v[88:91]
    buffer_load_dwordx4 v[212:215], v173, s[8:11], s19 offen sc1
    v_mfma_f32_16x16x32_bf16 v[120:123], v[4:7], a[68:71], v[88:91]
    v_mfma_f32_16x16x32_bf16 v[92:95], v[168:171], a[132:135], v[92:95]
    v_mfma_f32_16x16x32_bf16 v[92:95], v[148:151], a[136:139], v[92:95]
    v_mfma_f32_16x16x32_bf16 v[124:127], v[4:7], a[140:143], v[92:95]
    s_add_u32 s7, s40, 6
    s_and_b32 s7, s7, 7
    s_mul_i32 s7, s7, 9216
    s_add_u32 s19, s7, s20
    buffer_load_dwordx4 v[136:139], v172, s[8:11], s19 offen sc1
    v_mfma_f32_16x16x32_bf16 v[96:99], v[168:171], a[204:207], v[96:99]
    s_mov_b32 s74, 268435456
    v_mfma_f32_16x16x32_bf16 v[96:99], v[148:151], a[208:211], v[96:99]
    s_add_u32 s27, s27, 1024
    v_mfma_f32_16x16x32_bf16 v[128:131], v[4:7], a[212:215], v[96:99]
    s_add_u32 s25, s25, 1
    v_mfma_f32_16x16x32_bf16 v[100:103], v[168:171], v[240:243], v[100:103]
    buffer_load_dwordx4 v[140:143], v173, s[8:11], s19 offen sc1
    v_mfma_f32_16x16x32_bf16 v[100:103], v[148:151], v[244:247], v[100:103]
    s_add_u32 s23, s23, 18432
    v_mfma_f32_16x16x32_bf16 v[132:135], v[4:7], v[248:251], v[100:103]
    s_waitcnt vmcnt(29)
    v_mfma_f32_16x16x32_bf16 v[88:91], v[16:19], a[0:3], 0
    v_mfma_f32_16x16x32_bf16 v[88:91], v[20:23], a[4:7], v[88:91]
    s_add_u32 s7, s40, 7
    s_and_b32 s7, s7, 7
    s_mul_i32 s7, s7, 9216
    s_add_u32 s19, s7, s20
    buffer_load_dwordx4 v[144:147], v172, s[8:11], s19 offen sc1
    v_mfma_f32_16x16x32_bf16 v[88:91], v[24:27], a[8:11], v[88:91]
    v_mfma_f32_16x16x32_bf16 v[92:95], v[16:19], a[72:75], 0
    v_mfma_f32_16x16x32_bf16 v[92:95], v[20:23], a[76:79], v[92:95]
    v_mfma_f32_16x16x32_bf16 v[92:95], v[24:27], a[80:83], v[92:95]
    buffer_load_dwordx4 v[160:163], v173, s[8:11], s19 offen sc1
    v_mfma_f32_16x16x32_bf16 v[96:99], v[16:19], a[144:147], 0
    v_cvt_pk_bf16_f32 v152, v120, v121
    v_cvt_pk_bf16_f32 v153, v122, v123
    v_mfma_f32_16x16x32_bf16 v[96:99], v[20:23], a[148:151], v[96:99]
    v_cvt_pk_bf16_f32 v154, v124, v125
    v_cvt_pk_bf16_f32 v155, v126, v127
    v_mfma_f32_16x16x32_bf16 v[96:99], v[24:27], a[152:155], v[96:99]
    v_cvt_pk_bf16_f32 v156, v128, v129
    v_cvt_pk_bf16_f32 v157, v130, v131
    v_mfma_f32_16x16x32_bf16 v[100:103], v[16:19], a[216:219], 0
    v_cvt_pk_bf16_f32 v158, v132, v133
    v_cvt_pk_bf16_f32 v159, v134, v135
    v_mfma_f32_16x16x32_bf16 v[100:103], v[20:23], a[220:223], v[100:103]
    v_permlane16_swap_b32 v152, v154
    v_mfma_f32_16x16x32_bf16 v[100:103], v[24:27], a[224:227], v[100:103]
    v_permlane16_swap_b32 v153, v155
    s_waitcnt vmcnt(28)
    v_mfma_f32_16x16x32_bf16 v[88:91], v[28:31], a[12:15], v[88:91]
    v_permlane16_swap_b32 v156, v158
    v_mfma_f32_16x16x32_bf16 v[88:91], v[32:35], a[16:19], v[88:91]
    v_permlane16_swap_b32 v157, v159
    v_mfma_f32_16x16x32_bf16 v[88:91], v[36:39], a[20:23], v[88:91]
    buffer_store_dwordx4 v[152:155], v178, s[72:75], s27 offen sc1
    v_mfma_f32_16x16x32_bf16 v[92:95], v[28:31], a[84:87], v[92:95]
    buffer_store_dwordx4 v[156:159], v179, s[72:75], s27 offen sc1
    v_mfma_f32_16x16x32_bf16 v[92:95], v[32:35], a[88:91], v[92:95]
    ds_write_b128 v216, v[152:155]
    v_mfma_f32_16x16x32_bf16 v[92:95], v[36:39], a[92:95], v[92:95]
    v_add_u32 v216, v216, v218
    v_mfma_f32_16x16x32_bf16 v[96:99], v[28:31], a[156:159], v[96:99]
    ds_write_b128 v217, v[156:159]
    v_mfma_f32_16x16x32_bf16 v[96:99], v[32:35], a[160:163], v[96:99]
    v_add_u32 v217, v217, v219
    v_mfma_f32_16x16x32_bf16 v[96:99], v[36:39], a[164:167], v[96:99]
    v_mfma_f32_16x16x32_bf16 v[100:103], v[28:31], a[228:231], v[100:103]
    v_mfma_f32_16x16x32_bf16 v[100:103], v[32:35], a[232:235], v[100:103]
    v_mfma_f32_16x16x32_bf16 v[100:103], v[36:39], a[236:239], v[100:103]
    s_waitcnt vmcnt(27)
    v_mfma_f32_16x16x32_bf16 v[88:91], v[40:43], a[24:27], v[88:91]
    v_mfma_f32_16x16x32_bf16 v[88:91], v[44:47], a[28:31], v[88:91]
    v_mfma_f32_16x16x32_bf16 v[88:91], v[48:51], a[32:35], v[88:91]
    v_mfma_f32_16x16x32_bf16 v[92:95], v[40:43], a[96:99], v[92:95]
    v_mfma_f32_16x16x32_bf16 v[92:95], v[44:47], a[100:103], v[92:95]
    v_mfma_f32_16x16x32_bf16 v[92:95], v[48:51], a[104:107], v[92:95]
    v_mfma_f32_16x16x32_bf16 v[96:99], v[40:43], a[168:171], v[96:99]
    v_mfma_f32_16x16x32_bf16 v[96:99], v[44:47], a[172:175], v[96:99]
    v_mfma_f32_16x16x32_bf16 v[96:99], v[48:51], a[176:179], v[96:99]
    v_mfma_f32_16x16x32_bf16 v[100:103], v[40:43], a[240:243], v[100:103]
    v_mfma_f32_16x16x32_bf16 v[100:103], v[44:47], a[244:247], v[100:103]
    v_mfma_f32_16x16x32_bf16 v[100:103], v[48:51], a[248:251], v[100:103]
    s_waitcnt vmcnt(24)
    v_mfma_f32_16x16x32_bf16 v[88:91], v[52:55], a[36:39], v[88:91]
    v_mfma_f32_16x16x32_bf16 v[88:91], v[56:59], a[40:43], v[88:91]
    v_mfma_f32_16x16x32_bf16 v[88:91], v[60:63], a[44:47], v[88:91]
    v_mfma_f32_16x16x32_bf16 v[92:95], v[52:55], a[108:111], v[92:95]
    v_mfma_f32_16x16x32_bf16 v[92:95], v[56:59], a[112:115], v[92:95]
    v_mfma_f32_16x16x32_bf16 v[92:95], v[60:63], a[116:119], v[92:95]
    v_mfma_f32_16x16x32_bf16 v[96:99], v[52:55], a[180:183], v[96:99]
    v_mfma_f32_16x16x32_bf16 v[96:99], v[56:59], a[184:187], v[96:99]
    v_mfma_f32_16x16x32_bf16 v[96:99], v[60:63], a[188:191], v[96:99]
    v_mfma_f32_16x16x32_bf16 v[100:103], v[52:55], a[252:255], v[100:103]
    v_mfma_f32_16x16x32_bf16 v[100:103], v[56:59], v[220:223], v[100:103]
    v_mfma_f32_16x16x32_bf16 v[100:103], v[60:63], v[224:227], v[100:103]
    s_waitcnt vmcnt(21)
    v_mfma_f32_16x16x32_bf16 v[88:91], v[64:67], a[48:51], v[88:91]
    v_mfma_f32_16x16x32_bf16 v[88:91], v[68:71], a[52:55], v[88:91]
    v_mfma_f32_16x16x32_bf16 v[88:91], v[72:75], a[56:59], v[88:91]
    v_mfma_f32_16x16x32_bf16 v[92:95], v[64:67], a[120:123], v[92:95]
    v_mfma_f32_16x16x32_bf16 v[92:95], v[68:71], a[124:127], v[92:95]
    v_mfma_f32_16x16x32_bf16 v[92:95], v[72:75], a[128:131], v[92:95]
    v_mfma_f32_16x16x32_bf16 v[96:99], v[64:67], a[192:195], v[96:99]
    v_mfma_f32_16x16x32_bf16 v[96:99], v[68:71], a[196:199], v[96:99]
    v_mfma_f32_16x16x32_bf16 v[96:99], v[72:75], a[200:203], v[96:99]
    v_mfma_f32_16x16x32_bf16 v[100:103], v[64:67], v[228:231], v[100:103]
    v_mfma_f32_16x16x32_bf16 v[100:103], v[68:71], v[232:235], v[100:103]
    v_mfma_f32_16x16x32_bf16 v[100:103], v[72:75], v[236:239], v[100:103]
    s_waitcnt vmcnt(18)
    v_mfma_f32_16x16x32_bf16 v[88:91], v[76:79], a[60:63], v[88:91]
    v_mfma_f32_16x16x32_bf16 v[88:91], v[80:83], a[64:67], v[88:91]
    v_mfma_f32_16x16x32_bf16 v[120:123], v[84:87], a[68:71], v[88:91]
    v_mfma_f32_16x16x32_bf16 v[92:95], v[76:79], a[132:135], v[92:95]
    v_mfma_f32_16x16x32_bf16 v[92:95], v[80:83], a[136:139], v[92:95]
    v_mfma_f32_16x16x32_bf16 v[124:127], v[84:87], a[140:143], v[92:95]
    v_mfma_f32_16x16x32_bf16 v[96:99], v[76:79], a[204:207], v[96:99]
    s_mov_b32 s74, 268435456
    v_mfma_f32_16x16x32_bf16 v[96:99], v[80:83], a[208:211], v[96:99]
    s_add_u32 s27, s27, 1024
    v_mfma_f32_16x16x32_bf16 v[128:131], v[84:87], a[212:215], v[96:99]
    s_add_u32 s25, s25, 1
    v_mfma_f32_16x16x32_bf16 v[100:103], v[76:79], v[240:243], v[100:103]
    v_mfma_f32_16x16x32_bf16 v[100:103], v[80:83], v[244:247], v[100:103]
    s_add_u32 s23, s23, 18432
    v_mfma_f32_16x16x32_bf16 v[132:135], v[84:87], v[248:251], v[100:103]
    s_nop 7
    v_cvt_pk_bf16_f32 v152, v120, v121
    v_cvt_pk_bf16_f32 v153, v122, v123
    v_cvt_pk_bf16_f32 v154, v124, v125
    v_cvt_pk_bf16_f32 v155, v126, v127
    v_cvt_pk_bf16_f32 v156, v128, v129
    v_cvt_pk_bf16_f32 v157, v130, v131
    v_cvt_pk_bf16_f32 v158, v132, v133
    v_cvt_pk_bf16_f32 v159, v134, v135
    s_nop 1
    v_permlane16_swap_b32 v152, v154
    v_permlane16_swap_b32 v153, v155
    v_permlane16_swap_b32 v156, v158
    v_permlane16_swap_b32 v157, v159
    buffer_store_dwordx4 v[152:155], v178, s[72:75], s27 offen sc1
    buffer_store_dwordx4 v[156:159], v179, s[72:75], s27 offen sc1
    ds_write_b128 v216, v[152:155]
    v_add_u32 v216, v216, v218
    ds_write_b128 v217, v[156:159]
    v_add_u32 v217, v217, v219
    s_waitcnt lgkmcnt(0)
    v_lshlrev_b32 v15, 7, v0
    s_lshl_b32 s6, s40, 2
    s_add_u32 s6, s6, s44
    s_add_u32 s6, s6, 65536
    v_mov_b32 v1, s76
    s_mov_b64 vcc, 0xff
    s_waitcnt vmcnt(0)
    s_barrier
    s_cmp_lg_u32 s3, 0
    s_cbranch_scc1 L_pub_40
    s_mov_b64 exec, vcc
    buffer_store_dword v1, v15, s[8:11], s6 offen sc1
L_pub_40:
    s_mov_b64 exec, -1
    s_add_u32 s19, s18, s43
    s_add_u32 s22, s19, 45875200
    s_lshl_b32 s23, s21, 5
    s_add_u32 s23, s23, s43
    s_add_u32 s23, s23, 48431104
    v_and_b32 v12, 7, v0
    v_lshlrev_b32 v12, 2, v12
    buffer_load_dword v10, v12, s[8:11], s23 offen sc1
    buffer_load_dwordx4 v[92:95], v172, s[8:11], s22 offen sc1
    buffer_load_dwordx4 v[96:99], v173, s[8:11], s22 offen sc1
    buffer_load_dwordx4 v[100:103], v174, s[8:11], s22 offen sc1
    v_min_u32 v13, 9216, v173
    ds_read_b128 v[148:151], v172 offset:4096
    ds_read_b128 v[152:155], v13 offset:4096
    ds_read_b128 v[156:159], v174 offset:4096
    v_lshlrev_b32 v16, 16, v104
    v_and_b32 v17, s16, v104
    v_lshlrev_b32 v18, 16, v105
    v_and_b32 v19, s16, v105
    v_lshlrev_b32 v20, 16, v106
    v_and_b32 v21, s16, v106
    v_lshlrev_b32 v22, 16, v107
    v_and_b32 v23, s16, v107
    s_lshl_b32 s28, s40, 2
    s_add_u32 s28, s28, s3
    s_mul_i32 s28, s28, 73728
    s_mul_i32 s7, s42, 1073741824
    v_add_u32 v3, s7, v253
    buffer_load_dwordx4 a[0:3], v3, s[8:11], s28 offen offset:0 sc1
    buffer_load_dwordx4 a[4:7], v3, s[8:11], s28 offen offset:1024 sc1
    v_lshlrev_b32 v24, 16, v108
    v_and_b32 v25, s16, v108
    v_lshlrev_b32 v26, 16, v109
    v_and_b32 v27, s16, v109
    v_lshlrev_b32 v28, 16, v110
    v_and_b32 v29, s16, v110
    v_lshlrev_b32 v30, 16, v111
    v_and_b32 v31, s16, v111
    buffer_load_dwordx4 a[8:11], v3, s[8:11], s28 offen offset:2048 sc1
    buffer_load_dwordx4 a[12:15], v3, s[8:11], s28 offen offset:3072 sc1
    v_lshlrev_b32 v40, 16, v112
    v_and_b32 v41, s16, v112
    v_lshlrev_b32 v42, 16, v113
    v_and_b32 v43, s16, v113
    v_lshlrev_b32 v44, 16, v114
    v_and_b32 v45, s16, v114
    v_lshlrev_b32 v46, 16, v115
    v_and_b32 v47, s16, v115
    v_pk_add_f32 v[16:17], v[16:17], v[40:41]
    v_pk_add_f32 v[18:19], v[18:19], v[42:43]
    v_pk_add_f32 v[20:21], v[20:21], v[44:45]
    v_pk_add_f32 v[22:23], v[22:23], v[46:47]
    s_add_u32 s28, s28, 4096
    buffer_load_dwordx4 a[16:19], v3, s[8:11], s28 offen offset:0 sc1
    buffer_load_dwordx4 a[20:23], v3, s[8:11], s28 offen offset:1024 sc1
    v_lshlrev_b32 v40, 16, v116
    v_and_b32 v41, s16, v116
    v_lshlrev_b32 v42, 16, v117
    v_and_b32 v43, s16, v117
    v_lshlrev_b32 v44, 16, v118
    v_and_b32 v45, s16, v118
    v_lshlrev_b32 v46, 16, v119
    v_and_b32 v47, s16, v119
    v_pk_add_f32 v[24:25], v[24:25], v[40:41]
    v_pk_add_f32 v[26:27], v[26:27], v[42:43]
    v_pk_add_f32 v[28:29], v[28:29], v[44:45]
    v_pk_add_f32 v[30:31], v[30:31], v[46:47]
    buffer_load_dwordx4 a[24:27], v3, s[8:11], s28 offen offset:2048 sc1
    buffer_load_dwordx4 a[28:31], v3, s[8:11], s28 offen offset:3072 sc1
    v_lshlrev_b32 v40, 16, v180
    v_and_b32 v41, s16, v180
    v_lshlrev_b32 v42, 16, v181
    v_and_b32 v43, s16, v181
    v_lshlrev_b32 v44, 16, v182
    v_and_b32 v45, s16, v182
    v_lshlrev_b32 v46, 16, v183
    v_and_b32 v47, s16, v183
    v_pk_add_f32 v[16:17], v[16:17], v[40:41]
    v_pk_add_f32 v[18:19], v[18:19], v[42:43]
    v_pk_add_f32 v[20:21], v[20:21], v[44:45]
    v_pk_add_f32 v[22:23], v[22:23], v[46:47]
    s_add_u32 s28, s28, 4096
    buffer_load_dwordx4 a[32:35], v3, s[8:11], s28 offen offset:0 sc1
    buffer_load_dwordx4 a[36:39], v3, s[8:11], s28 offen offset:1024 sc1
    v_lshlrev_b32 v40, 16, v196
    v_and_b32 v41, s16, v196
    v_lshlrev_b32 v42, 16, v197
    v_and_b32 v43, s16, v197
    v_lshlrev_b32 v44, 16, v198
    v_and_b32 v45, s16, v198
    v_lshlrev_b32 v46, 16, v199
    v_and_b32 v47, s16, v199
    v_pk_add_f32 v[24:25], v[24:25], v[40:41]
    v_pk_add_f32 v[26:27], v[26:27], v[42:43]
    v_pk_add_f32 v[28:29], v[28:29], v[44:45]
    v_pk_add_f32 v[30:31], v[30:31], v[46:47]
    buffer_load_dwordx4 a[40:43], v3, s[8:11], s28 offen offset:2048 sc1
    buffer_load_dwordx4 a[44:47], v3, s[8:11], s28 offen offset:3072 sc1
    v_lshlrev_b32 v40, 16, v200
    v_and_b32 v41, s16, v200
    v_lshlrev_b32 v42, 16, v201
    v_and_b32 v43, s16, v201
    v_lshlrev_b32 v44, 16, v202
    v_and_b32 v45, s16, v202
    v_lshlrev_b32 v46, 16, v203
    v_and_b32 v47, s16, v203
    v_pk_add_f32 v[16:17], v[16:17], v[40:41]
    v_pk_add_f32 v[18:19], v[18:19], v[42:43]
    v_pk_add_f32 v[20:21], v[20:21], v[44:45]
    v_pk_add_f32 v[22:23], v[22:23], v[46:47]
    s_add_u32 s28, s28, 4096
    buffer_load_dwordx4 a[48:51], v3, s[8:11], s28 offen offset:0 sc1
    buffer_load_dwordx4 a[52:55], v3, s[8:11], s28 offen offset:1024 sc1
    v_lshlrev_b32 v40, 16, v204
    v_and_b32 v41, s16, v204
    v_lshlrev_b32 v42, 16, v205
    v_and_b32 v43, s16, v205
    v_lshlrev_b32 v44, 16, v206
    v_and_b32 v45, s16, v206
    v_lshlrev_b32 v46, 16, v207
    v_and_b32 v47, s16, v207
    v_pk_add_f32 v[24:25], v[24:25], v[40:41]
    v_pk_add_f32 v[26:27], v[26:27], v[42:43]
    v_pk_add_f32 v[28:29], v[28:29], v[44:45]
    v_pk_add_f32 v[30:31], v[30:31], v[46:47]
    buffer_load_dwordx4 a[56:59], v3, s[8:11], s28 offen offset:2048 sc1
    buffer_load_dwordx4 a[60:63], v3, s[8:11], s28 offen offset:3072 sc1
    s_cmp_lg_u32 s3, 3
    s_cbranch_scc1 L_pollout_43
    s_lshl_b32 s7, s40, 7
    s_add_u32 s7, s7, s44
    s_add_u32 s7, s7, 65536
    s_add_u32 s52, s4, s7
    s_addc_u32 s53, s5, 0
    s_mov_b32 s6, 0
L_poll_41:
    s_load_dwordx8 s[56:63], s[52:53], 0 glc
    s_add_u32 s6, s6, 1
    s_waitcnt lgkmcnt(0)
    s_xor_b64 s[56:57], s[56:57], s[76:77]
    s_xor_b64 s[58:59], s[58:59], s[76:77]
    s_xor_b64 s[60:61], s[60:61], s[76:77]
    s_xor_b64 s[62:63], s[62:63], s[76:77]
    s_or_b64 s[56:57], s[56:57], s[58:59]
    s_or_b64 s[60:61], s[60:61], s[62:63]
    s_or_b64 s[56:57], s[56:57], s[60:61]
    s_cbranch_scc0 L_polled_42
    s_cmp_lt_u32 s6, 1048576
    s_cbranch_scc1 L_poll_41
    s_branch L_main_end
L_polled_42:
L_pollout_43:
    s_barrier
    s_add_u32 s7, s40, 1
    s_and_b32 s7, s7, 7
    s_mul_i32 s7, s7, 9216
    s_add_u32 s19, s7, s20
    buffer_load_dwordx4 v[60:63], v174, s[8:11], s19 offen sc1
    s_add_u32 s7, s40, 2
    s_and_b32 s7, s7, 7
    s_mul_i32 s7, s7, 9216
    s_add_u32 s19, s7, s20
    buffer_load_dwordx4 v[64:67], v174, s[8:11], s19 offen sc1
    s_add_u32 s7, s40, 3
    s_and_b32 s7, s7, 7
    s_mul_i32 s7, s7, 9216
    s_add_u32 s19, s7, s20
    buffer_load_dwordx4 v[68:71], v174, s[8:11], s19 offen sc1
    s_add_u32 s7, s40, 4
    s_and_b32 s7, s7, 7
    s_mul_i32 s7, s7, 9216
    s_add_u32 s19, s7, s20
    buffer_load_dwordx4 v[72:75], v174, s[8:11], s19 offen sc1
    s_add_u32 s7, s40, 5
    s_and_b32 s7, s7, 7
    s_mul_i32 s7, s7, 9216
    s_add_u32 s19, s7, s20
    buffer_load_dwordx4 v[76:79], v174, s[8:11], s19 offen sc1
    s_add_u32 s7, s40, 6
    s_and_b32 s7, s7, 7
    s_mul_i32 s7, s7, 9216
    s_add_u32 s19, s7, s20
    buffer_load_dwordx4 v[80:83], v174, s[8:11], s19 offen sc1
    s_add_u32 s7, s40, 7
    s_and_b32 s7, s7, 7
    s_mul_i32 s7, s7, 9216
    s_add_u32 s19, s7, s20
    buffer_load_dwordx4 v[84:87], v174, s[8:11], s19 offen sc1
    v_lshlrev_b32 v40, 16, v208
    v_and_b32 v41, s16, v208
    v_lshlrev_b32 v42, 16, v209
    v_and_b32 v43, s16, v209
    v_lshlrev_b32 v44, 16, v210
    v_and_b32 v45, s16, v210
    v_lshlrev_b32 v46, 16, v211
    v_and_b32 v47, s16, v211
    v_pk_add_f32 v[16:17], v[16:17], v[40:41]
    v_pk_add_f32 v[18:19], v[18:19], v[42:43]
    v_pk_add_f32 v[20:21], v[20:21], v[44:45]
    v_pk_add_f32 v[22:23], v[22:23], v[46:47]
    v_lshlrev_b32 v40, 16, v212
    v_and_b32 v41, s16, v212
    v_lshlrev_b32 v42, 16, v213
    v_and_b32 v43, s16, v213
    v_lshlrev_b32 v44, 16, v214
    v_and_b32 v45, s16, v214
    v_lshlrev_b32 v46, 16, v215
    v_and_b32 v47, s16, v215
    v_pk_add_f32 v[24:25], v[24:25], v[40:41]
    v_pk_add_f32 v[26:27], v[26:27], v[42:43]
    v_pk_add_f32 v[28:29], v[28:29], v[44:45]
    v_pk_add_f32 v[30:31], v[30:31], v[46:47]
    v_lshlrev_b32 v40, 16, v136
    v_and_b32 v41, s16, v136
    v_lshlrev_b32 v42, 16, v137
    v_and_b32 v43, s16, v137
    v_lshlrev_b32 v44, 16, v138
    v_and_b32 v45, s16, v138
    v_lshlrev_b32 v46, 16, v139
    v_and_b32 v47, s16, v139
    v_pk_add_f32 v[16:17], v[16:17], v[40:41]
    v_pk_add_f32 v[18:19], v[18:19], v[42:43]
    v_pk_add_f32 v[20:21], v[20:21], v[44:45]
    v_pk_add_f32 v[22:23], v[22:23], v[46:47]
    v_lshlrev_b32 v40, 16, v140
    v_and_b32 v41, s16, v140
    v_lshlrev_b32 v42, 16, v141
    v_and_b32 v43, s16, v141
    v_lshlrev_b32 v44, 16, v142
    v_and_b32 v45, s16, v142
    v_lshlrev_b32 v46, 16, v143
    v_and_b32 v47, s16, v143
    v_pk_add_f32 v[24:25], v[24:25], v[40:41]
    v_pk_add_f32 v[26:27], v[26:27], v[42:43]
    v_pk_add_f32 v[28:29], v[28:29], v[44:45]
    v_pk_add_f32 v[30:31], v[30:31], v[46:47]
    v_lshlrev_b32 v40, 16, v144
    v_and_b32 v41, s16, v144
    v_lshlrev_b32 v42, 16, v145
    v_and_b32 v43, s16, v145
    v_lshlrev_b32 v44, 16, v146
    v_and_b32 v45, s16, v146
    v_lshlrev_b32 v46, 16, v147
    v_and_b32 v47, s16, v147
    v_pk_add_f32 v[16:17], v[16:17], v[40:41]
    v_pk_add_f32 v[18:19], v[18:19], v[42:43]
    v_pk_add_f32 v[20:21], v[20:21], v[44:45]
    v_pk_add_f32 v[22:23], v[22:23], v[46:47]
    v_lshlrev_b32 v40, 16, v160
    v_and_b32 v41, s16, v160
    v_lshlrev_b32 v42, 16, v161
    v_and_b32 v43, s16, v161
    v_lshlrev_b32 v44, 16, v162
    v_and_b32 v45, s16, v162
    v_lshlrev_b32 v46, 16, v163
    v_and_b32 v47, s16, v163
    v_pk_add_f32 v[24:25], v[24:25], v[40:41]
    v_pk_add_f32 v[26:27], v[26:27], v[42:43]
    v_pk_add_f32 v[28:29], v[28:29], v[44:45]
    v_pk_add_f32 v[30:31], v[30:31], v[46:47]
    s_cmp_eq_u32 s3, 0
    s_cselect_b32 s7, 1.0, 0
    s_cselect_b32 s6, -1, 0
    s_waitcnt vmcnt(7) lgkmcnt(0)
    v_and_b32 v152, s6, v152
    v_and_b32 v153, s6, v153
    v_and_b32 v154, s6, v154
    v_and_b32 v155, s6, v155
    v_mul_f32 v11, s7, v10
    v_lshlrev_b32 v40, 16, v92
    v_and_b32 v41, s16, v92
    v_lshlrev_b32 v42, 16, v93
    v_and_b32 v43, s16, v93
    v_lshlrev_b32 v44, 16, v94
    v_and_b32 v45, s16, v94
    v_lshlrev_b32 v46, 16, v95
    v_and_b32 v47, s16, v95
    v_pk_add_f32 v[16:17], v[16:17], v[40:41]
    v_pk_add_f32 v[18:19], v[18:19], v[42:43]
    v_pk_add_f32 v[20:21], v[20:21], v[44:45]
    v_pk_add_f32 v[22:23], v[22:23], v[46:47]
    v_lshlrev_b32 v40, 16, v96
    v_and_b32 v41, s16, v96
    v_lshlrev_b32 v42, 16, v97
    v_and_b32 v43, s16, v97
    v_lshlrev_b32 v44, 16, v98
    v_and_b32 v45, s16, v98
    v_lshlrev_b32 v46, 16, v99
    v_and_b32 v47, s16, v99
    v_pk_add_f32 v[24:25], v[24:25], v[40:41]
    v_pk_add_f32 v[26:27], v[26:27], v[42:43]
    v_pk_add_f32 v[28:29], v[28:29], v[44:45]
    v_pk_add_f32 v[30:31], v[30:31], v[46:47]
    v_lshlrev_b32 v32, 16, v100
    v_and_b32 v33, s16, v100
    v_lshlrev_b32 v34, 16, v101
    v_and_b32 v35, s16, v101
    v_lshlrev_b32 v36, 16, v102
    v_and_b32 v37, s16, v102
    v_lshlrev_b32 v38, 16, v103
    v_and_b32 v39, s16, v103
    v_lshlrev_b32 v40, 16, v148
    v_and_b32 v41, s16, v148
    v_lshlrev_b32 v42, 16, v149
    v_and_b32 v43, s16, v149
    v_lshlrev_b32 v44, 16, v150
    v_and_b32 v45, s16, v150
    v_lshlrev_b32 v46, 16, v151
    v_and_b32 v47, s16, v151
    v_pk_add_f32 v[16:17], v[16:17], v[40:41]
    v_pk_add_f32 v[18:19], v[18:19], v[42:43]
    v_pk_add_f32 v[20:21], v[20:21], v[44:45]
    v_pk_add_f32 v[22:23], v[22:23], v[46:47]
    v_lshlrev_b32 v40, 16, v152
    v_and_b32 v41, s16, v152
    v_lshlrev_b32 v42, 16, v153
    v_and_b32 v43, s16, v153
    v_lshlrev_b32 v44, 16, v154
    v_and_b32 v45, s16, v154
    v_lshlrev_b32 v46, 16, v155
    v_and_b32 v47, s16, v155
    v_pk_add_f32 v[24:25], v[24:25], v[40:41]
    v_pk_add_f32 v[26:27], v[26:27], v[42:43]
    v_pk_add_f32 v[28:29], v[28:29], v[44:45]
    v_pk_add_f32 v[30:31], v[30:31], v[46:47]
    v_lshlrev_b32 v40, 16, v156
    v_and_b32 v41, s16, v156
    v_lshlrev_b32 v42, 16, v157
    v_and_b32 v43, s16, v157
    v_lshlrev_b32 v44, 16, v158
    v_and_b32 v45, s16, v158
    v_lshlrev_b32 v46, 16, v159
    v_and_b32 v47, s16, v159
    v_pk_add_f32 v[32:33], v[32:33], v[40:41]
    v_pk_add_f32 v[34:35], v[34:35], v[42:43]
    v_pk_add_f32 v[36:37], v[36:37], v[44:45]
    v_pk_add_f32 v[38:39], v[38:39], v[46:47]
    v_pk_add_f32 v[16:17], v[16:17], v[10:11] op_sel_hi:[1,0]
    v_pk_add_f32 v[18:19], v[18:19], v[10:11] op_sel_hi:[1,0]
    v_pk_add_f32 v[20:21], v[20:21], v[10:11] op_sel_hi:[1,0]
    v_pk_add_f32 v[22:23], v[22:23], v[10:11] op_sel_hi:[1,0]
    v_pk_add_f32 v[24:25], v[24:25], v[10:11] op_sel:[0,1] op_sel_hi:[1,1]
    v_pk_add_f32 v[26:27], v[26:27], v[10:11] op_sel:[0,1] op_sel_hi:[1,1]
    v_pk_add_f32 v[28:29], v[28:29], v[10:11] op_sel:[0,1] op_sel_hi:[1,1]
    v_pk_add_f32 v[30:31], v[30:31], v[10:11] op_sel:[0,1] op_sel_hi:[1,1]
    v_pk_add_f32 v[32:33], v[32:33], v[10:11] op_sel_hi:[1,0]
    v_pk_add_f32 v[34:35], v[34:35], v[10:11] op_sel_hi:[1,0]
    v_pk_add_f32 v[36:37], v[36:37], v[10:11] op_sel_hi:[1,0]
    v_pk_add_f32 v[38:39], v[38:39], v[10:11] op_sel_hi:[1,0]
    s_waitcnt vmcnt(6)
    s_add_u32 s28, s28, 4096
    buffer_load_dwordx4 a[64:67], v3, s[8:11], s28 offen offset:0 sc1
    v_lshlrev_b32 v40, 16, v60
    v_and_b32 v41, s16, v60
    v_lshlrev_b32 v42, 16, v61
    v_and_b32 v43, s16, v61
    v_lshlrev_b32 v44, 16, v62
    v_and_b32 v45, s16, v62
    v_lshlrev_b32 v46, 16, v63
    v_and_b32 v47, s16, v63
    v_pk_add_f32 v[32:33], v[32:33], v[40:41]
    v_pk_add_f32 v[34:35], v[34:35], v[42:43]
    v_pk_add_f32 v[36:37], v[36:37], v[44:45]
    v_pk_add_f32 v[38:39], v[38:39], v[46:47]
    s_waitcnt vmcnt(6)
    buffer_load_dwordx4 a[68:71], v3, s[8:11], s28 offen offset:1024 sc1
    v_lshlrev_b32 v40, 16, v64
    v_and_b32 v41, s16, v64
    v_lshlrev_b32 v42, 16, v65
    v_and_b32 v43, s16, v65
    v_lshlrev_b32 v44, 16, v66
    v_and_b32 v45, s16, v66
    v_lshlrev_b32 v46, 16, v67
    v_and_b32 v47, s16, v67
    v_pk_add_f32 v[32:33], v[32:33], v[40:41]
    v_pk_add_f32 v[34:35], v[34:35], v[42:43]
    v_pk_add_f32 v[36:37], v[36:37], v[44:45]
    v_pk_add_f32 v[38:39], v[38:39], v[46:47]
    s_waitcnt vmcnt(6)
    buffer_load_dwordx4 a[72:75], v3, s[8:11], s28 offen offset:2048 sc1
    v_lshlrev_b32 v40, 16, v68
    v_and_b32 v41, s16, v68
    v_lshlrev_b32 v42, 16, v69
    v_and_b32 v43, s16, v69
    v_lshlrev_b32 v44, 16, v70
    v_and_b32 v45, s16, v70
    v_lshlrev_b32 v46, 16, v71
    v_and_b32 v47, s16, v71
    v_pk_add_f32 v[32:33], v[32:33], v[40:41]
    v_pk_add_f32 v[34:35], v[34:35], v[42:43]
    v_pk_add_f32 v[36:37], v[36:37], v[44:45]
    v_pk_add_f32 v[38:39], v[38:39], v[46:47]
    s_waitcnt vmcnt(6)
    buffer_load_dwordx4 a[76:79], v3, s[8:11], s28 offen offset:3072 sc1
    v_lshlrev_b32 v40, 16, v72
    v_and_b32 v41, s16, v72
    v_lshlrev_b32 v42, 16, v73
    v_and_b32 v43, s16, v73
    v_lshlrev_b32 v44, 16, v74
    v_and_b32 v45, s16, v74
    v_lshlrev_b32 v46, 16, v75
    v_and_b32 v47, s16, v75
    v_pk_add_f32 v[32:33], v[32:33], v[40:41]
    v_pk_add_f32 v[34:35], v[34:35], v[42:43]
    v_pk_add_f32 v[36:37], v[36:37], v[44:45]
    v_pk_add_f32 v[38:39], v[38:39], v[46:47]
    s_waitcnt vmcnt(6)
    s_add_u32 s28, s28, 4096
    buffer_load_dwordx4 a[80:83], v3, s[8:11], s28 offen offset:0 sc1
    v_lshlrev_b32 v40, 16, v76
    v_and_b32 v41, s16, v76
    v_lshlrev_b32 v42, 16, v77
    v_and_b32 v43, s16, v77
    v_lshlrev_b32 v44, 16, v78
    v_and_b32 v45, s16, v78
    v_lshlrev_b32 v46, 16, v79
    v_and_b32 v47, s16, v79
    v_pk_add_f32 v[32:33], v[32:33], v[40:41]
    v_pk_add_f32 v[34:35], v[34:35], v[42:43]
    v_pk_add_f32 v[36:37], v[36:37], v[44:45]
    v_pk_add_f32 v[38:39], v[38:39], v[46:47]
    s_waitcnt vmcnt(6)
    buffer_load_dwordx4 a[84:87], v3, s[8:11], s28 offen offset:1024 sc1
    v_lshlrev_b32 v40, 16, v80
    v_and_b32 v41, s16, v80
    v_lshlrev_b32 v42, 16, v81
    v_and_b32 v43, s16, v81
    v_lshlrev_b32 v44, 16, v82
    v_and_b32 v45, s16, v82
    v_lshlrev_b32 v46, 16, v83
    v_and_b32 v47, s16, v83
    v_pk_add_f32 v[32:33], v[32:33], v[40:41]
    v_pk_add_f32 v[34:35], v[34:35], v[42:43]
    v_pk_add_f32 v[36:37], v[36:37], v[44:45]
    v_pk_add_f32 v[38:39], v[38:39], v[46:47]
    s_waitcnt vmcnt(6)
    buffer_load_dwordx4 a[88:91], v3, s[8:11], s28 offen offset:2048 sc1
    v_lshlrev_b32 v40, 16, v84
    v_and_b32 v41, s16, v84
    v_lshlrev_b32 v42, 16, v85
    v_and_b32 v43, s16, v85
    v_lshlrev_b32 v44, 16, v86
    v_and_b32 v45, s16, v86
    v_lshlrev_b32 v46, 16, v87
    v_and_b32 v47, s16, v87
    v_pk_add_f32 v[32:33], v[32:33], v[40:41]
    v_pk_add_f32 v[34:35], v[34:35], v[42:43]
    v_pk_add_f32 v[36:37], v[36:37], v[44:45]
    v_pk_add_f32 v[38:39], v[38:39], v[46:47]
    buffer_load_dwordx4 a[92:95], v3, s[8:11], s28 offen offset:3072 sc1
    v_cvt_pk_bf16_f32 v120, v16, v17
    v_cvt_pk_bf16_f32 v121, v18, v19
    v_cvt_pk_bf16_f32 v122, v20, v21
    v_cvt_pk_bf16_f32 v123, v22, v23
    v_cvt_pk_bf16_f32 v124, v24, v25
    v_cvt_pk_bf16_f32 v125, v26, v27
    v_cvt_pk_bf16_f32 v126, v28, v29
    v_cvt_pk_bf16_f32 v127, v30, v31
    v_cvt_pk_bf16_f32 v128, v32, v33
    v_cvt_pk_bf16_f32 v129, v34, v35
    v_cvt_pk_bf16_f32 v130, v36, v37
    v_cvt_pk_bf16_f32 v131, v38, v39
    s_cmp_lg_u32 s42, 0
    s_cbranch_scc1 L_main_last
    s_add_u32 s19, s18, 53215232
    s_add_u32 s20, s18, 48496640
    s_lshl_b32 s22, s21, 7
    s_add_u32 s22, s22, 57933824
    buffer_store_dwordx4 v[120:123], v172, s[8:11], s19 offen sc1
    buffer_store_dwordx4 v[124:127], v173, s[8:11], s19 offen sc1
    buffer_store_dwordx4 v[128:131], v174, s[8:11], s19 offen sc1
    s_mov_b32 s17, 0x3f803f80
    v_mov_b32 v8, 0
    v_mov_b32 v9, 0
    v_mov_b32 v10, 0
    v_mov_b32 v11, 0
    v_dot2c_f32_bf16 v8, s17, v120
    v_dot2c_f32_bf16 v9, v120, v120
    v_dot2c_f32_bf16 v10, s17, v121
    v_dot2c_f32_bf16 v11, v121, v121
    v_dot2c_f32_bf16 v8, s17, v122
    v_dot2c_f32_bf16 v9, v122, v122
    v_dot2c_f32_bf16 v10, s17, v123
    v_dot2c_f32_bf16 v11, v123, v123
    v_dot2c_f32_bf16 v8, s17, v124
    v_dot2c_f32_bf16 v9, v124, v124
    v_dot2c_f32_bf16 v10, s17, v125
    v_dot2c_f32_bf16 v11, v125, v125
    v_dot2c_f32_bf16 v8, s17, v126
    v_dot2c_f32_bf16 v9, v126, v126
    v_dot2c_f32_bf16 v10, s17, v127
    v_dot2c_f32_bf16 v11, v127, v127
    v_dot2c_f32_bf16 v8, s17, v128
    v_dot2c_f32_bf16 v9, v128, v128
    v_dot2c_f32_bf16 v10, s17, v129
    v_dot2c_f32_bf16 v11, v129, v129
    v_dot2c_f32_bf16 v8, s17, v130
    v_dot2c_f32_bf16 v9, v130, v130
    v_dot2c_f32_bf16 v10, s17, v131
    v_dot2c_f32_bf16 v11, v131, v131
    v_and_b32 v12, 7, v0
    v_lshlrev_b32 v12, 3, v12
    s_lshl_b32 s7, s3, 6
    v_add_u32 v13, s7, v12
    v_pk_add_f32 v[8:9], v[8:9], v[10:11]
    s_nop 1
    v_add_f32_dpp v8, v8, v8 row_ror:8 row_mask:0xf bank_mask:0xf
    v_add_f32_dpp v9, v9, v9 row_ror:8 row_mask:0xf bank_mask:0xf
    v_mov_b32 v10, v8
    v_mov_b32 v11, v9
    s_nop 1
    v_permlane32_swap_b32 v10, v8
    v_permlane32_swap_b32 v11, v9
    v_add_f32 v8, v8, v10
    v_add_f32 v9, v9, v11
    v_mov_b32 v10, v8
    v_mov_b32 v11, v9
    s_nop 1
    v_permlane16_swap_b32 v10, v8
    v_permlane16_swap_b32 v11, v9
    v_add_f32 v8, v8, v10
    v_add_f32 v9, v9, v11
    ds_write_b64 v13, v[8:9]
    s_waitcnt lgkmcnt(0)
    s_barrier
    ds_read_b64 v[40:41], v12 offset:0
    ds_read_b64 v[42:43], v12 offset:64
    ds_read_b64 v[44:45], v12 offset:128
    ds_read_b64 v[46:47], v12 offset:192
    s_waitcnt lgkmcnt(0)
    v_pk_add_f32 v[40:41], v[40:41], v[42:43]
    v_pk_add_f32 v[44:45], v[44:45], v[46:47]
    v_pk_add_f32 v[8:9], v[40:41], v[44:45]
    v_mul_f32 v8, 0x3ae38e39, v8
    v_mul_f32 v9, 0x3ae38e39, v9
    v_fma_f32 v9, -v8, v8, v9
    v_max_f32 v9, 0, v9
    v_add_f32 v9, 0x3727c5ac, v9
    v_rsq_f32 v10, v9
    s_nop 0
    v_mul_f32 v12, v8, v10
    v_mov_b32 v11, v10
    v_sub_f32 v12, 0, v12
    v_mov_b32 v13, v12
    s_cmp_eq_u32 s3, 0
    s_cselect_b32 s7, 32, 0
    v_lshlrev_b32 v14, 2, v0
    v_cmp_gt_u32 vcc, s7, v0
    v_mov_b32 v9, 1073741824
    s_nop 0
    v_cndmask_b32 v14, v9, v14, vcc
    buffer_store_dword v8, v14, s[8:11], s22 offen sc1
    v_lshlrev_b32 v40, 16, v120
    v_and_b32 v41, s16, v120
    v_lshlrev_b32 v42, 16, v121
    v_and_b32 v43, s16, v121
    v_lshlrev_b32 v44, 16, v122
    v_and_b32 v45, s16, v122
    v_lshlrev_b32 v46, 16, v123
    v_and_b32 v47, s16, v123
    v_pk_fma_f32 v[40:41], v[40:41], v[10:11], v[12:13]
    v_pk_fma_f32 v[42:43], v[42:43], v[10:11], v[12:13]
    v_pk_fma_f32 v[44:45], v[44:45], v[10:11], v[12:13]
    v_pk_fma_f32 v[46:47], v[46:47], v[10:11], v[12:13]
    v_cvt_pk_bf16_f32 v48, v40, v41
    v_cvt_pk_bf16_f32 v49, v42, v43
    v_cvt_pk_bf16_f32 v50, v44, v45
    v_cvt_pk_bf16_f32 v51, v46, v47
    v_lshlrev_b32 v40, 16, v124
    v_and_b32 v41, s16, v124
    v_lshlrev_b32 v42, 16, v125
    v_and_b32 v43, s16, v125
    v_lshlrev_b32 v44, 16, v126
    v_and_b32 v45, s16, v126
    v_lshlrev_b32 v46, 16, v127
    v_and_b32 v47, s16, v127
    v_pk_fma_f32 v[40:41], v[40:41], v[10:11], v[12:13]
    v_pk_fma_f32 v[42:43], v[42:43], v[10:11], v[12:13]
    v_pk_fma_f32 v[44:45], v[44:45], v[10:11], v[12:13]
    v_pk_fma_f32 v[46:47], v[46:47], v[10:11], v[12:13]
    v_cvt_pk_bf16_f32 v52, v40, v41
    v_cvt_pk_bf16_f32 v53, v42, v43
    v_cvt_pk_bf16_f32 v54, v44, v45
    v_cvt_pk_bf16_f32 v55, v46, v47
    v_lshlrev_b32 v40, 16, v128
    v_and_b32 v41, s16, v128
    v_lshlrev_b32 v42, 16, v129
    v_and_b32 v43, s16, v129
    v_lshlrev_b32 v44, 16, v130
    v_and_b32 v45, s16, v130
    v_lshlrev_b32 v46, 16, v131
    v_and_b32 v47, s16, v131
    v_pk_fma_f32 v[40:41], v[40:41], v[10:11], v[12:13]
    v_pk_fma_f32 v[42:43], v[42:43], v[10:11], v[12:13]
    v_pk_fma_f32 v[44:45], v[44:45], v[10:11], v[12:13]
    v_pk_fma_f32 v[46:47], v[46:47], v[10:11], v[12:13]
    v_cvt_pk_bf16_f32 v56, v40, v41
    v_cvt_pk_bf16_f32 v57, v42, v43
    v_cvt_pk_bf16_f32 v58, v44, v45
    v_cvt_pk_bf16_f32 v59, v46, v47
    buffer_store_dwordx4 v[48:51], v172, s[8:11], s20 offen sc1
    buffer_store_dwordx4 v[52:55], v173, s[8:11], s20 offen sc1
    buffer_store_dwordx4 v[56:59], v174, s[8:11], s20 offen sc1
    v_lshlrev_b32 v15, 7, v0
    s_lshl_b32 s6, s40, 2
    s_add_u32 s6, s6, s44
    s_add_u32 s6, s6, 98304
    v_mov_b32 v1, s76
    s_mov_b64 vcc, 0xff
    v_lshrrev_b32 v14, 3, v0
    v_lshl_add_u32 v15, v14, 3, v15
    s_cmp_ge_u32 s40, 6
    s_cselect_b32 s7, s41, 31
    s_cmp_lt_u32 s7, 31
    s_cmov_b64 vcc, 0xffff
    s_waitcnt vmcnt(0)
    s_barrier
    s_cmp_lg_u32 s3, 0
    s_cbranch_scc1 L_pub_44
    s_mov_b64 exec, vcc
    buffer_store_dword v1, v15, s[8:11], s6 offen sc1
L_pub_44:
    s_mov_b64 exec, -1
    s_add_u32 s28, s28, 4096
    buffer_load_dwordx4 a[96:99], v3, s[8:11], s28 offen offset:0 sc1
    buffer_load_dwordx4 a[100:103], v3, s[8:11], s28 offen offset:1024 sc1
    buffer_load_dwordx4 a[104:107], v3, s[8:11], s28 offen offset:2048 sc1
    buffer_load_dwordx4 a[108:111], v3, s[8:11], s28 offen offset:3072 sc1
    s_add_u32 s28, s28, 4096
    buffer_load_dwordx4 a[112:115], v3, s[8:11], s28 offen offset:0 sc1
    buffer_load_dwordx4 a[116:119], v3, s[8:11], s28 offen offset:1024 sc1
    buffer_load_dwordx4 a[120:123], v3, s[8:11], s28 offen offset:2048 sc1
    buffer_load_dwordx4 a[124:127], v3, s[8:11], s28 offen offset:3072 sc1
    s_add_u32 s28, s28, 4096
    buffer_load_dwordx4 a[128:131], v3, s[8:11], s28 offen offset:0 sc1
    buffer_load_dwordx4 a[132:135], v3, s[8:11], s28 offen offset:1024 sc1
    buffer_load_dwordx4 a[136:139], v3, s[8:11], s28 offen offset:2048 sc1
    buffer_load_dwordx4 a[140:143], v3, s[8:11], s28 offen offset:3072 sc1
    s_add_u32 s28, s28, 4096
    s_mov_b32 s42, 1
    s_mov_b32 s43, 9699328
    s_add_u32 s44, s44, 131072
    s_mov_b32 s74, 0
    s_branch L_main_layer
L_main_last:
    buffer_store_dwordx4 v[120:123], v175, s[12:15], s18 offen sc0 sc1
    buffer_store_dwordx4 v[124:127], v176, s[12:15], s18 offen sc0 sc1
    buffer_store_dwordx4 v[128:131], v177, s[12:15], s18 offen sc0 sc1
    s_or_b32 s7, s40, s41
    s_or_b32 s7, s7, s3
    s_cbranch_scc1 L_done_45
    v_mov_b32 v1, s76
    s_mov_b32 s7, 19660800
    s_mov_b64 exec, 1
    buffer_store_dword v1, off, s[8:11], s7 sc1
    s_mov_b64 exec, -1
L_done_45:
L_main_end:
    s_endpgm
L_main_code_end:
.section .rodata,"a"
.p2align 6
.amdhsa_kernel interleave_layers__sliding_local_dilated__glu_gated_geglu__prompt_kernel
.amdhsa_next_free_vgpr 512
.amdhsa_next_free_sgpr 102
.amdhsa_accum_offset 256
.amdhsa_group_segment_fixed_size 0
.amdhsa_kernarg_size 80
.amdhsa_user_sgpr_count 2
.amdhsa_user_sgpr_kernarg_segment_ptr 1
.amdhsa_system_sgpr_workgroup_id_x 1
.amdhsa_float_denorm_mode_32 3
.amdhsa_float_denorm_mode_16_64 3
.end_amdhsa_kernel
```

```asm
; @launch grid=(256,1,1) block=(256,1,1) lds=163840
.amdgcn_target "amdgcn-amd-amdhsa--gfx950"
.text
.globl interleave_layers__sliding_local_dilated__glu_gated_geglu__prompt_kernel
.p2align 8
.type interleave_layers__sliding_local_dilated__glu_gated_geglu__prompt_kernel,@function
interleave_layers__sliding_local_dilated__glu_gated_geglu__prompt_kernel:
    s_cmp_ge_u32 s2, 256
    s_cbranch_scc1 L_main_end
    s_load_dwordx2 s[4:5], s[0:1], 72
    s_load_dwordx4 s[16:19], s[0:1], 0
    s_load_dwordx2 s[22:23], s[0:1], 16
    s_load_dwordx8 s[24:31], s[0:1], 32
    v_lshrrev_b32 v1, 6, v0
    v_and_b32 v0, 63, v0
    v_readfirstlane_b32 s3, v1
    s_waitcnt lgkmcnt(0)
    s_mov_b32 s8, s4
    s_and_b32 s9, s5, 0xffff
    s_mov_b32 s10, 268435456
    s_mov_b32 s11, 0x20000
    s_mov_b32 s7, 19660800
    s_load_dword s76, s[4:5], s7
    s_mov_b64 s[20:21], s[18:19]
    s_mov_b64 s[18:19], s[16:17]
    s_mov_b32 s48, s4
    s_and_b32 s49, s5, 0xffff
    s_mov_b32 s50, 268435456
    s_mov_b32 s51, 0x20000
    s_and_b32 s40, s2, 3
    s_lshl_b32 s40, s40, 1
    s_bfe_u32 s7, s2, 65539
    s_add_u32 s40, s40, s7
    s_bfe_u32 s41, s2, 65538
    s_lshl_b32 s41, s41, 4
    s_lshr_b32 s7, s2, 4
    s_add_u32 s41, s41, s7
    s_mov_b32 s42, 0
    s_mov_b32 s43, 0
    s_lshl_b32 s44, s41, 10
    s_add_u32 s44, s44, 19169280
    v_lshlrev_b32 v253, 4, v0
    s_getpc_b64 s[96:97]
L_main_pc:
    s_sub_u32 s96, s96, L_main_pc-interleave_layers__sliding_local_dilated__glu_gated_geglu__prompt_kernel
    s_subb_u32 s97, s97, 0
    s_and_b32 s97, s97, 0xffff
    s_mov_b32 s98, L_main_code_end-interleave_layers__sliding_local_dilated__glu_gated_geglu__prompt_kernel
    s_mov_b32 s99, 0x20000
    s_lshr_b32 s7, s2, 3
    s_lshl_b32 s7, s7, 2
    s_add_u32 s7, s7, s3
    s_lshl_b32 s7, s7, 9
    v_lshrrev_b32 v1, 1, v253
    v_add_u32 v1, s7, v1
    buffer_load_dwordx2 v[2:3], v1, s[96:99], 0 offen
    s_mov_b32 s12, s18
    s_and_b32 s13, s19, 0xffff
    s_mov_b32 s14, 2359296
    s_mov_b32 s15, 0x20000
    s_mov_b32 s64, s20
    s_and_b32 s65, s21, 0xffff
    s_mov_b32 s66, 1990656
    s_mov_b32 s67, 0x20000
    s_mov_b32 s68, s22
    s_and_b32 s69, s23, 0xffff
    s_mov_b32 s70, 663552
    s_mov_b32 s71, 0x20000
    s_mov_b32 s16, 0xffff0000
    s_lshl_b32 s7, s3, 10
    v_add_u32 v172, s7, v253
    v_add_u32 v174, 5120, v172
    v_and_b32 v178, 7, v0
    v_mul_u32_u24 v178, 1152, v178
    v_lshrrev_b32 v179, 3, v0
    v_lshl_add_u32 v178, v179, 4, v178
    s_lshl_b32 s7, s3, 7
    v_add_u32 v175, s7, v178
    v_add_u32 v177, 640, v175
    s_cmp_eq_u32 s3, 0
    s_mov_b32 s17, 1073741824
    s_cmov_b32 s17, 4096
    v_add_u32 v173, s17, v172
    s_mov_b32 s17, 1073741824
    s_cmov_b32 s17, 512
    v_add_u32 v176, s17, v175
    s_lshl_b32 s21, s41, 3
    s_add_u32 s21, s21, s40
    s_mul_i32 s18, s21, 9216
    buffer_load_dwordx4 v[16:19], v175, s[12:15], s18 offen
    buffer_load_dwordx4 v[20:23], v176, s[12:15], s18 offen
    buffer_load_dwordx4 v[24:27], v177, s[12:15], s18 offen
    s_mov_b32 s12, s30
    s_and_b32 s13, s31, 0xffff
    s_mov_b32 s14, 2359296
    s_mov_b32 s15, 0x20000
    s_lshl_b32 s79, s3, 14
    s_add_u32 s79, s79, 98304
    s_sub_u32 s36, s21, 144
    s_cmp_ge_u32 s41, 18
    s_cbranch_scc1 L_prep_o_1
    s_mul_i32 s35, s41, 110592
    s_mul_i32 s7, s40, 144
    s_and_b32 s46, s7, 127
    s_sub_u32 s7, s7, s46
    s_add_u32 s35, s35, s7
    s_mul_i32 s7, s3, 13824
    s_add_u32 s35, s35, s7
    v_lshrrev_b32 v8, 4, v0
    v_mul_u32_u24 v8, 3456, v8
    v_and_b32 v9, 15, v0
    v_lshl_add_u32 v8, v9, 4, v8
    s_lshl_b32 s34, s3, 10
    s_add_u32 m0, s34, 8192
    s_add_u32 s7, s35, 0
    buffer_load_dwordx4 v8, s[64:67], s7 offen lds
    s_add_u32 m0, s34, 12288
    s_add_u32 s7, s35, 55296
    buffer_load_dwordx4 v8, s[64:67], s7 offen lds
    s_add_u32 m0, s34, 16384
    s_add_u32 s7, s35, 1152
    buffer_load_dwordx4 v8, s[64:67], s7 offen lds
    s_add_u32 m0, s34, 20480
    s_add_u32 s7, s35, 56448
    buffer_load_dwordx4 v8, s[64:67], s7 offen lds
    s_add_u32 m0, s34, 24576
    s_add_u32 s7, s35, 2304
    buffer_load_dwordx4 v8, s[64:67], s7 offen lds
    s_add_u32 m0, s34, 28672
    s_add_u32 s7, s35, 57600
    buffer_load_dwordx4 v8, s[64:67], s7 offen lds
    s_branch L_prep_go_3
L_prep_o_1:
    s_cmp_ge_u32 s36, 54
    s_cbranch_scc1 L_prep_m_2
    s_mul_i32 s33, s36, 349526
    s_lshr_b32 s33, s33, 20
    s_mul_i32 s34, s33, 3
    s_sub_u32 s34, s36, s34
    s_lshl_b32 s7, s33, 2
    s_add_u32 s7, s7, s3
    v_mov_b32 v8, s7
    v_lshrrev_b32 v9, 3, v0
    v_mul_u32_u24 v11, 7282, v8
    v_lshrrev_b32 v11, 16, v11
    v_mul_u32_u24 v12, 9, v11
    v_sub_u32 v12, v8, v12
    v_mul_u32_u24 v11, 72, v11
    v_cmp_eq_u32 vcc, 8, v12
    v_lshrrev_b32 v10, 1, v12
    v_mad_u32_u24 v10, v10, 18, v11
    v_and_b32 v12, 1, v12
    v_lshl_add_u32 v10, v12, 3, v10
    v_add_u32 v10, v10, v9
    v_lshrrev_b32 v12, 1, v9
    v_mad_u32_u24 v11, v12, 18, v11
    v_and_b32 v12, 1, v9
    v_add3_u32 v11, v11, v12, 16
    v_cndmask_b32 v10, v10, v11, vcc
    v_mul_u32_u24 v10, 1152, v10
    v_and_b32 v9, 7, v0
    v_lshl_add_u32 v10, v9, 4, v10
    s_mul_i32 s35, s34, 384
    s_lshl_b32 s6, s3, 10
    s_add_u32 m0, s6, 8192
    s_add_u32 s7, s35, 0
    buffer_load_dwordx4 v10, s[68:71], s7 offen lds
    s_add_u32 m0, s6, 12288
    s_add_u32 s7, s35, 128
    buffer_load_dwordx4 v10, s[68:71], s7 offen lds
    s_add_u32 m0, s6, 16384
    s_add_u32 s7, s35, 256
    buffer_load_dwordx4 v10, s[68:71], s7 offen lds
    s_branch L_prep_go_3
L_prep_m_2:
    s_sub_u32 s37, s36, 54
    s_lshl_b32 s7, s3, 6
    s_add_u32 s37, s37, s7
    s_cmp_ge_u32 s37, 36
    s_cbranch_scc1 L_prep_go_3
    s_lshl_b32 s7, s37, 1
    v_bfe_u32 v8, v0, 3, 1
    v_add_u32 v8, s7, v8
    v_and_b32 v9, 7, v0
    v_mul_u32_u24 v11, 7282, v8
    v_lshrrev_b32 v11, 16, v11
    v_mul_u32_u24 v12, 9, v11
    v_sub_u32 v12, v8, v12
    v_mul_u32_u24 v11, 72, v11
    v_cmp_eq_u32 vcc, 8, v12
    v_lshrrev_b32 v10, 1, v12
    v_mad_u32_u24 v10, v10, 18, v11
    v_and_b32 v12, 1, v12
    v_lshl_add_u32 v10, v12, 3, v10
    v_add_u32 v10, v10, v9
    v_lshrrev_b32 v12, 1, v9
    v_mad_u32_u24 v11, v12, 18, v11
    v_and_b32 v12, 1, v9
    v_add3_u32 v11, v11, v12, 16
    v_cndmask_b32 v10, v10, v11, vcc
    v_mul_u32_u24 v10, 1152, v10
    v_lshrrev_b32 v9, 4, v0
    v_lshl_add_u32 v10, v9, 4, v10
    buffer_load_dwordx4 v[64:67], v10, s[68:71], 0 offen offset:0
    buffer_load_dwordx4 v[68:71], v10, s[68:71], 0 offen offset:64
    buffer_load_dwordx4 v[72:75], v10, s[68:71], 0 offen offset:128
    buffer_load_dwordx4 v[76:79], v10, s[68:71], 0 offen offset:192
    buffer_load_dwordx4 v[80:83], v10, s[68:71], 0 offen offset:256
    buffer_load_dwordx4 v[84:87], v10, s[68:71], 0 offen offset:320
    buffer_load_dwordx4 v[88:91], v10, s[68:71], 0 offen offset:384
    buffer_load_dwordx4 v[92:95], v10, s[68:71], 0 offen offset:448
    buffer_load_dwordx4 v[96:99], v10, s[68:71], 0 offen offset:512
    buffer_load_dwordx4 v[100:103], v10, s[68:71], 0 offen offset:576
    buffer_load_dwordx4 v[104:107], v10, s[68:71], 0 offen offset:640
    buffer_load_dwordx4 v[108:111], v10, s[68:71], 0 offen offset:704
    buffer_load_dwordx4 v[112:115], v10, s[68:71], 0 offen offset:768
    buffer_load_dwordx4 v[116:119], v10, s[68:71], 0 offen offset:832
    buffer_load_dwordx4 v[120:123], v10, s[68:71], 0 offen offset:896
    buffer_load_dwordx4 v[124:127], v10, s[68:71], 0 offen offset:960
    buffer_load_dwordx4 v[128:131], v10, s[68:71], 0 offen offset:1024
    buffer_load_dwordx4 v[132:135], v10, s[68:71], 0 offen offset:1088
L_prep_go_3:
    s_lshl_b32 s7, s41, 2
    s_add_u32 s7, s7, s3
    s_mul_i32 s93, s7, 25576
    s_lshr_b32 s93, s93, 20
    s_min_u32 s93, s93, 2
    s_mul_i32 s6, s93, 41
    s_sub_u32 s7, s7, s6
    s_lshl_b32 s17, s7, 2
    s_cmp_eq_u32 s93, 1
    s_cselect_b32 s72, s26, s24
    s_cselect_b32 s73, s27, s25
    s_cmp_eq_u32 s93, 2
    s_cselect_b32 s72, s28, s72
    s_cselect_b32 s73, s29, s73
    s_mov_b32 s92, 73728
    s_cmov_b32 s92, 9216
    s_mov_b32 s47, 1152
    s_cmov_b32 s47, 663552
    s_and_b32 s73, s73, 0xffff
    s_mov_b32 s74, 5308416
    s_mov_b32 s75, 0x20000
    s_mul_i32 s47, s47, s40
    s_add_u32 s7, s17, 0
    s_min_u32 s7, s7, 161
    s_mul_i32 s84, s7, 116509
    s_lshr_b32 s84, s84, 20
    s_mul_i32 s88, s84, 9
    s_sub_u32 s88, s7, s88
    s_mul_i32 s7, s84, s92
    s_lshl_b32 s7, s7, 2
    s_add_u32 s7, s7, s47
    s_lshl_b32 s6, s88, 7
    s_add_u32 s80, s7, s6
    s_add_u32 s7, s17, 1
    s_min_u32 s7, s7, 161
    s_mul_i32 s85, s7, 116509
    s_lshr_b32 s85, s85, 20
    s_mul_i32 s89, s85, 9
    s_sub_u32 s89, s7, s89
    s_mul_i32 s7, s85, s92
    s_lshl_b32 s7, s7, 2
    s_add_u32 s7, s7, s47
    s_lshl_b32 s6, s89, 7
    s_add_u32 s81, s7, s6
    s_add_u32 s7, s17, 2
    s_min_u32 s7, s7, 161
    s_mul_i32 s86, s7, 116509
    s_lshr_b32 s86, s86, 20
    s_mul_i32 s90, s86, 9
    s_sub_u32 s90, s7, s90
    s_mul_i32 s7, s86, s92
    s_lshl_b32 s7, s7, 2
    s_add_u32 s7, s7, s47
    s_lshl_b32 s6, s90, 7
    s_add_u32 s82, s7, s6
    s_add_u32 s7, s17, 3
    s_min_u32 s7, s7, 161
    s_mul_i32 s87, s7, 116509
    s_lshr_b32 s87, s87, 20
    s_mul_i32 s91, s87, 9
    s_sub_u32 s91, s7, s91
    s_mul_i32 s7, s87, s92
    s_lshl_b32 s7, s7, 2
    s_add_u32 s7, s7, s47
    s_lshl_b32 s6, s91, 7
    s_add_u32 s83, s7, s6
    s_lshr_b32 s7, s92, 3
    v_lshrrev_b32 v224, 3, v0
    v_mul_lo_u32 v224, v224, s7
    v_and_b32 v8, 7, v0
    v_lshl_add_u32 v224, v8, 4, v224
    s_waitcnt lgkmcnt(0)
    s_mul_i32 s76, s76, 0x9e3779b1
    s_add_u32 s76, s76, 0x7f4a7c15
    s_mov_b32 s77, s76
    s_add_u32 m0, s79, 0
    s_mov_b32 s71, s80
    buffer_load_dwordx4 v224, s[72:75], s71 offen nt lds
    s_add_u32 m0, s79, 1024
    s_add_u32 s71, s71, s92
    buffer_load_dwordx4 v224, s[72:75], s71 offen nt lds
    s_add_u32 m0, s79, 2048
    s_add_u32 s71, s71, s92
    buffer_load_dwordx4 v224, s[72:75], s71 offen nt lds
    s_waitcnt vmcnt(3)
    s_barrier
    s_cmp_ge_u32 s41, 18
    s_cbranch_scc1 L_prep_o_4
    s_mul_i32 s7, s3, 36
    s_add_u32 s7, s7, s46
    v_lshrrev_b32 v8, 4, v0
    v_lshlrev_b32 v8, 11, v8
    v_add_u32 v8, s7, v8
    v_and_b32 v9, 15, v0
    v_cmp_gt_u32 s[22:23], 6, v9
    v_lshrrev_b32 v10, 1, v9
    v_min_u32 v10, 2, v10
    v_lshl_add_u32 v10, v10, 13, v8
    v_and_b32 v11, 1, v0
    v_lshl_add_u32 v10, v11, 1, v10
    v_lshl_add_u32 v8, v9, 1, v8
    ds_read_u16 v136, v8 offset:8192
    ds_read_u16 v137, v8 offset:8448
    ds_read_u16 v138, v8 offset:8704
    ds_read_u16 v139, v8 offset:8960
    ds_read_u16 v140, v8 offset:9216
    ds_read_u16 v141, v8 offset:9472
    ds_read_u16 v142, v8 offset:9728
    ds_read_u16 v143, v8 offset:9984
    s_lshl_b32 s33, s40, 2
    s_add_u32 s33, s33, s3
    s_mul_i32 s33, s33, 18
    s_add_u32 s33, s33, s41
    s_lshl_b32 s33, s33, 12
    ds_read_u16 v144, v8 offset:16384
    ds_read_u16 v145, v8 offset:16640
    ds_read_u16 v146, v8 offset:16896
    ds_read_u16 v147, v8 offset:17152
    ds_read_u16 v148, v8 offset:17408
    ds_read_u16 v149, v8 offset:17664
    ds_read_u16 v150, v8 offset:17920
    ds_read_u16 v151, v8 offset:18176
    s_waitcnt lgkmcnt(8)
    v_lshl_or_b32 v32, v137, 16, v136
    v_lshl_or_b32 v33, v139, 16, v138
    v_lshl_or_b32 v34, v141, 16, v140
    v_lshl_or_b32 v35, v143, 16, v142
    buffer_store_dwordx4 v[32:35], v253, s[8:11], s33 offen offset:0 sc1
    ds_read_u16 v152, v8 offset:24576
    ds_read_u16 v153, v8 offset:24832
    ds_read_u16 v154, v8 offset:25088
    ds_read_u16 v155, v8 offset:25344
    ds_read_u16 v156, v8 offset:25600
    ds_read_u16 v157, v8 offset:25856
    ds_read_u16 v158, v8 offset:26112
    ds_read_u16 v159, v8 offset:26368
    s_waitcnt lgkmcnt(8)
    v_lshl_or_b32 v36, v145, 16, v144
    v_lshl_or_b32 v37, v147, 16, v146
    v_lshl_or_b32 v38, v149, 16, v148
    v_lshl_or_b32 v39, v151, 16, v150
    buffer_store_dwordx4 v[36:39], v253, s[8:11], s33 offen offset:1024 sc1
    ds_read_u16 v160, v10 offset:8224
    ds_read_u16 v161, v10 offset:8480
    ds_read_u16 v162, v10 offset:8736
    ds_read_u16 v163, v10 offset:8992
    ds_read_u16 v164, v10 offset:9248
    ds_read_u16 v165, v10 offset:9504
    ds_read_u16 v166, v10 offset:9760
    ds_read_u16 v167, v10 offset:10016
    s_waitcnt lgkmcnt(8)
    v_lshl_or_b32 v40, v153, 16, v152
    v_lshl_or_b32 v41, v155, 16, v154
    v_lshl_or_b32 v42, v157, 16, v156
    v_lshl_or_b32 v43, v159, 16, v158
    buffer_store_dwordx4 v[40:43], v253, s[8:11], s33 offen offset:2048 sc1
    s_waitcnt lgkmcnt(0)
    v_lshl_or_b32 v44, v161, 16, v160
    v_cndmask_b32 v44, 0, v44, s[22:23]
    v_lshl_or_b32 v45, v163, 16, v162
    v_cndmask_b32 v45, 0, v45, s[22:23]
    v_lshl_or_b32 v46, v165, 16, v164
    v_cndmask_b32 v46, 0, v46, s[22:23]
    v_lshl_or_b32 v47, v167, 16, v166
    v_cndmask_b32 v47, 0, v47, s[22:23]
    buffer_store_dwordx4 v[44:47], v253, s[8:11], s33 offen offset:3072 sc1
    s_branch L_prep_done_6
L_prep_o_4:
    s_cmp_ge_u32 s36, 54
    s_cbranch_scc1 L_prep_m_5
    v_lshrrev_b32 v8, 4, v0
    v_lshlrev_b32 v8, 3, v8
    v_bfe_u32 v9, v0, 2, 2
    v_add_u32 v8, v8, v9
    v_mul_u32_u24 v8, 128, v8
    v_and_b32 v9, 3, v0
    v_lshl_add_u32 v8, v9, 3, v8
    s_lshl_b32 s7, s3, 5
    v_add_u32 v8, s7, v8
    ds_read_b64_tr_b16 v[32:33], v8 offset:8192
    ds_read_b64_tr_b16 v[34:35], v8 offset:8704
    ds_read_b64_tr_b16 v[36:37], v8 offset:12288
    ds_read_b64_tr_b16 v[38:39], v8 offset:12800
    ds_read_b64_tr_b16 v[40:41], v8 offset:16384
    ds_read_b64_tr_b16 v[42:43], v8 offset:16896
    s_mul_i32 s34, s34, 12
    s_add_u32 s34, s34, s3
    s_mul_i32 s34, s34, 18
    s_add_u32 s34, s34, s33
    s_lshl_b32 s34, s34, 10
    s_add_u32 s7, s34, 2359296
    s_waitcnt lgkmcnt(4)
    buffer_store_dwordx4 v[32:35], v253, s[8:11], s7 offen sc1
    s_add_u32 s7, s34, 2433024
    s_waitcnt lgkmcnt(2)
    buffer_store_dwordx4 v[36:39], v253, s[8:11], s7 offen sc1
    s_add_u32 s7, s34, 2506752
    s_waitcnt lgkmcnt(0)
    buffer_store_dwordx4 v[40:43], v253, s[8:11], s7 offen sc1
    s_branch L_prep_done_6
L_prep_m_5:
    s_cmp_ge_u32 s37, 36
    s_cbranch_scc1 L_prep_done_6
    v_mov_b32 v28, 0x3f803f80
    v_mov_b32 v29, 0x3f803f80
    v_mov_b32 v30, 0x3f803f80
    v_mov_b32 v31, 0x3f803f80
    v_and_b32 v9, 15, v0
    v_cmp_eq_u32 vcc, 0, v9
    v_cmp_eq_u32 s[22:23], 1, v9
    v_mfma_f32_16x16x32_bf16 v[32:35], v[64:67], v[28:31], 0
    v_mfma_f32_16x16x32_bf16 v[32:35], v[68:71], v[28:31], v[32:35]
    v_mfma_f32_16x16x32_bf16 v[32:35], v[72:75], v[28:31], v[32:35]
    v_mfma_f32_16x16x32_bf16 v[32:35], v[76:79], v[28:31], v[32:35]
    v_mfma_f32_16x16x32_bf16 v[32:35], v[80:83], v[28:31], v[32:35]
    v_mfma_f32_16x16x32_bf16 v[32:35], v[84:87], v[28:31], v[32:35]
    v_mfma_f32_16x16x32_bf16 v[32:35], v[88:91], v[28:31], v[32:35]
    v_mfma_f32_16x16x32_bf16 v[32:35], v[92:95], v[28:31], v[32:35]
    v_mfma_f32_16x16x32_bf16 v[32:35], v[96:99], v[28:31], v[32:35]
    v_mfma_f32_16x16x32_bf16 v[32:35], v[100:103], v[28:31], v[32:35]
    v_mfma_f32_16x16x32_bf16 v[32:35], v[104:107], v[28:31], v[32:35]
    v_mfma_f32_16x16x32_bf16 v[32:35], v[108:111], v[28:31], v[32:35]
    v_mfma_f32_16x16x32_bf16 v[32:35], v[112:115], v[28:31], v[32:35]
    v_mfma_f32_16x16x32_bf16 v[32:35], v[116:119], v[28:31], v[32:35]
    v_mfma_f32_16x16x32_bf16 v[32:35], v[120:123], v[28:31], v[32:35]
    v_mfma_f32_16x16x32_bf16 v[32:35], v[124:127], v[28:31], v[32:35]
    v_mfma_f32_16x16x32_bf16 v[32:35], v[128:131], v[28:31], v[32:35]
    v_mfma_f32_16x16x32_bf16 v[32:35], v[132:135], v[28:31], v[32:35]
    v_lshrrev_b32 v10, 5, v0
    v_lshlrev_b32 v10, 8, v10
    v_lshl_add_u32 v10, v9, 4, v10
    v_bfe_u32 v9, v0, 4, 1
    v_lshl_add_u32 v10, v9, 3, v10
    s_lshl_b32 s7, s37, 9
    s_add_u32 s7, s7, 3022848
    s_nop 0
    v_mul_f32 v32, 0x3ae38e39, v32
    v_mul_f32 v33, 0x3ae38e39, v33
    v_mul_f32 v34, 0x3ae38e39, v34
    v_mul_f32 v35, 0x3ae38e39, v35
    v_cvt_pk_bf16_f32 v36, v32, v33
    v_cvt_pk_bf16_f32 v37, v34, v35
    v_lshlrev_b32 v38, 16, v36
    v_and_b32 v39, s16, v36
    v_sub_f32 v38, v32, v38
    v_sub_f32 v39, v33, v39
    v_cvt_pk_bf16_f32 v28, v38, v39
    v_cndmask_b32 v28, 0, v28, s[22:23]
    v_cndmask_b32 v28, v28, v36, vcc
    v_lshlrev_b32 v38, 16, v37
    v_and_b32 v39, s16, v37
    v_sub_f32 v38, v34, v38
    v_sub_f32 v39, v35, v39
    v_cvt_pk_bf16_f32 v29, v38, v39
    v_cndmask_b32 v29, 0, v29, s[22:23]
    v_cndmask_b32 v29, v29, v37, vcc
    buffer_store_dwordx2 v[28:29], v10, s[8:11], s7 offen sc1
L_prep_done_6:
    s_add_u32 s19, s18, 43515904
    s_add_u32 s20, s18, 38797312
    s_lshl_b32 s22, s21, 7
    s_add_u32 s22, s22, 48234496
    buffer_store_dwordx4 v[16:19], v172, s[8:11], s19 offen sc1
    buffer_store_dwordx4 v[20:23], v173, s[8:11], s19 offen sc1
    buffer_store_dwordx4 v[24:27], v174, s[8:11], s19 offen sc1
    s_mov_b32 s17, 0x3f803f80
    v_mov_b32 v8, 0
    v_mov_b32 v9, 0
    v_mov_b32 v10, 0
    v_mov_b32 v11, 0
    v_dot2c_f32_bf16 v8, s17, v16
    v_dot2c_f32_bf16 v9, v16, v16
    v_dot2c_f32_bf16 v10, s17, v17
    v_dot2c_f32_bf16 v11, v17, v17
    v_dot2c_f32_bf16 v8, s17, v18
    v_dot2c_f32_bf16 v9, v18, v18
    v_dot2c_f32_bf16 v10, s17, v19
    v_dot2c_f32_bf16 v11, v19, v19
    v_dot2c_f32_bf16 v8, s17, v20
    v_dot2c_f32_bf16 v9, v20, v20
    v_dot2c_f32_bf16 v10, s17, v21
    v_dot2c_f32_bf16 v11, v21, v21
    v_dot2c_f32_bf16 v8, s17, v22
    v_dot2c_f32_bf16 v9, v22, v22
    v_dot2c_f32_bf16 v10, s17, v23
    v_dot2c_f32_bf16 v11, v23, v23
    v_dot2c_f32_bf16 v8, s17, v24
    v_dot2c_f32_bf16 v9, v24, v24
    v_dot2c_f32_bf16 v10, s17, v25
    v_dot2c_f32_bf16 v11, v25, v25
    v_dot2c_f32_bf16 v8, s17, v26
    v_dot2c_f32_bf16 v9, v26, v26
    v_dot2c_f32_bf16 v10, s17, v27
    v_dot2c_f32_bf16 v11, v27, v27
    v_and_b32 v12, 7, v0
    v_lshlrev_b32 v12, 3, v12
    s_lshl_b32 s7, s3, 6
    v_add_u32 v13, s7, v12
    v_pk_add_f32 v[8:9], v[8:9], v[10:11]
    s_nop 1
    v_add_f32_dpp v8, v8, v8 row_ror:8 row_mask:0xf bank_mask:0xf
    v_add_f32_dpp v9, v9, v9 row_ror:8 row_mask:0xf bank_mask:0xf
    v_mov_b32 v10, v8
    v_mov_b32 v11, v9
    s_nop 1
    v_permlane32_swap_b32 v10, v8
    v_permlane32_swap_b32 v11, v9
    v_add_f32 v8, v8, v10
    v_add_f32 v9, v9, v11
    v_mov_b32 v10, v8
    v_mov_b32 v11, v9
    s_nop 1
    v_permlane16_swap_b32 v10, v8
    v_permlane16_swap_b32 v11, v9
    v_add_f32 v8, v8, v10
    v_add_f32 v9, v9, v11
    ds_write_b64 v13, v[8:9]
    s_waitcnt lgkmcnt(0)
    s_barrier
    ds_read_b64 v[40:41], v12 offset:0
    ds_read_b64 v[42:43], v12 offset:64
    ds_read_b64 v[44:45], v12 offset:128
    ds_read_b64 v[46:47], v12 offset:192
    s_waitcnt lgkmcnt(0)
    v_pk_add_f32 v[40:41], v[40:41], v[42:43]
    v_pk_add_f32 v[44:45], v[44:45], v[46:47]
    v_pk_add_f32 v[8:9], v[40:41], v[44:45]
    v_mul_f32 v8, 0x3ae38e39, v8
    v_mul_f32 v9, 0x3ae38e39, v9
    v_fma_f32 v9, -v8, v8, v9
    v_max_f32 v9, 0, v9
    v_add_f32 v9, 0x3727c5ac, v9
    v_rsq_f32 v10, v9
    s_nop 0
    v_mul_f32 v12, v8, v10
    v_mov_b32 v11, v10
    v_sub_f32 v12, 0, v12
    v_mov_b32 v13, v12
    s_cmp_eq_u32 s3, 0
    s_cselect_b32 s7, 32, 0
    v_lshlrev_b32 v14, 2, v0
    v_cmp_gt_u32 vcc, s7, v0
    v_mov_b32 v9, 1073741824
    s_nop 0
    v_cndmask_b32 v14, v9, v14, vcc
    buffer_store_dword v8, v14, s[8:11], s22 offen sc1
    v_lshlrev_b32 v40, 16, v16
    v_and_b32 v41, s16, v16
    v_lshlrev_b32 v42, 16, v17
    v_and_b32 v43, s16, v17
    v_lshlrev_b32 v44, 16, v18
    v_and_b32 v45, s16, v18
    v_lshlrev_b32 v46, 16, v19
    v_and_b32 v47, s16, v19
    v_pk_fma_f32 v[40:41], v[40:41], v[10:11], v[12:13]
    v_pk_fma_f32 v[42:43], v[42:43], v[10:11], v[12:13]
    v_pk_fma_f32 v[44:45], v[44:45], v[10:11], v[12:13]
    v_pk_fma_f32 v[46:47], v[46:47], v[10:11], v[12:13]
    v_cvt_pk_bf16_f32 v48, v40, v41
    v_cvt_pk_bf16_f32 v49, v42, v43
    v_cvt_pk_bf16_f32 v50, v44, v45
    v_cvt_pk_bf16_f32 v51, v46, v47
    v_lshlrev_b32 v40, 16, v20
    v_and_b32 v41, s16, v20
    v_lshlrev_b32 v42, 16, v21
    v_and_b32 v43, s16, v21
    v_lshlrev_b32 v44, 16, v22
    v_and_b32 v45, s16, v22
    v_lshlrev_b32 v46, 16, v23
    v_and_b32 v47, s16, v23
    v_pk_fma_f32 v[40:41], v[40:41], v[10:11], v[12:13]
    v_pk_fma_f32 v[42:43], v[42:43], v[10:11], v[12:13]
    v_pk_fma_f32 v[44:45], v[44:45], v[10:11], v[12:13]
    v_pk_fma_f32 v[46:47], v[46:47], v[10:11], v[12:13]
    v_cvt_pk_bf16_f32 v52, v40, v41
    v_cvt_pk_bf16_f32 v53, v42, v43
    v_cvt_pk_bf16_f32 v54, v44, v45
    v_cvt_pk_bf16_f32 v55, v46, v47
    v_lshlrev_b32 v40, 16, v24
    v_and_b32 v41, s16, v24
    v_lshlrev_b32 v42, 16, v25
    v_and_b32 v43, s16, v25
    v_lshlrev_b32 v44, 16, v26
    v_and_b32 v45, s16, v26
    v_lshlrev_b32 v46, 16, v27
    v_and_b32 v47, s16, v27
    v_pk_fma_f32 v[40:41], v[40:41], v[10:11], v[12:13]
    v_pk_fma_f32 v[42:43], v[42:43], v[10:11], v[12:13]
    v_pk_fma_f32 v[44:45], v[44:45], v[10:11], v[12:13]
    v_pk_fma_f32 v[46:47], v[46:47], v[10:11], v[12:13]
    v_cvt_pk_bf16_f32 v56, v40, v41
    v_cvt_pk_bf16_f32 v57, v42, v43
    v_cvt_pk_bf16_f32 v58, v44, v45
    v_cvt_pk_bf16_f32 v59, v46, v47
    buffer_store_dwordx4 v[48:51], v172, s[8:11], s20 offen sc1
    buffer_store_dwordx4 v[52:55], v173, s[8:11], s20 offen sc1
    buffer_store_dwordx4 v[56:59], v174, s[8:11], s20 offen sc1
    v_lshlrev_b32 v15, 7, v0
    s_lshl_b32 s6, s40, 2
    s_add_u32 s6, s6, s44
    s_sub_u32 s6, s6, 32768
    v_mov_b32 v1, s76
    s_mov_b64 vcc, 0xff
    v_lshrrev_b32 v14, 3, v0
    v_lshl_add_u32 v15, v14, 3, v15
    s_cmp_ge_u32 s40, 6
    s_cselect_b32 s7, s41, 31
    s_cmp_lt_u32 s7, 31
    s_cmov_b64 vcc, 0xffff
    s_waitcnt vmcnt(0)
    s_barrier
    s_cmp_lg_u32 s3, 0
    s_cbranch_scc1 L_pub_7
    s_mov_b64 exec, vcc
    buffer_store_dword v1, v15, s[8:11], s6 offen sc1
    v_lshlrev_b32 v15, 10, v0
    s_lshl_b32 s6, s40, 7
    s_lshl_b32 s7, s41, 2
    s_add_u32 s6, s6, s7
    s_add_u32 s6, s6, 19431424
    s_mov_b64 exec, 0xffffffff
    v_lshlrev_b32 v15, 10, v0
    v_mov_b32 v1, s76
    buffer_store_dword v1, v15, s[8:11], s6 offen sc1
    s_cmp_lt_u32 s41, 18
    s_cbranch_scc1 L_pub_7
    s_lshl_b32 s6, s36, 2
    s_add_u32 s6, s6, 19496960
    s_mov_b64 exec, 1
    buffer_store_dword v1, off, s[8:11], s6 sc1
L_pub_7:
    s_mov_b64 exec, -1
    s_add_u32 m0, s79, 3072
    s_add_u32 s71, s71, s92
    buffer_load_dwordx4 v224, s[72:75], s71 offen nt lds
    s_add_u32 m0, s79, 4096
    s_mov_b32 s71, s81
    buffer_load_dwordx4 v224, s[72:75], s71 offen nt lds
    s_add_u32 m0, s79, 5120
    s_add_u32 s71, s71, s92
    buffer_load_dwordx4 v224, s[72:75], s71 offen nt lds
    s_add_u32 m0, s79, 6144
    s_add_u32 s71, s71, s92
    buffer_load_dwordx4 v224, s[72:75], s71 offen nt lds
    s_add_u32 m0, s79, 7168
    s_add_u32 s71, s71, s92
    buffer_load_dwordx4 v224, s[72:75], s71 offen nt lds
    s_add_u32 m0, s79, 8192
    s_mov_b32 s71, s82
    buffer_load_dwordx4 v224, s[72:75], s71 offen nt lds
    s_add_u32 m0, s79, 9216
    s_add_u32 s71, s71, s92
    buffer_load_dwordx4 v224, s[72:75], s71 offen nt lds
    s_add_u32 m0, s79, 10240
    s_add_u32 s71, s71, s92
    buffer_load_dwordx4 v224, s[72:75], s71 offen nt lds
    s_add_u32 m0, s79, 11264
    s_add_u32 s71, s71, s92
    buffer_load_dwordx4 v224, s[72:75], s71 offen nt lds
    s_add_u32 m0, s79, 12288
    s_mov_b32 s71, s83
    buffer_load_dwordx4 v224, s[72:75], s71 offen nt lds
    s_add_u32 m0, s79, 13312
    s_add_u32 s71, s71, s92
    buffer_load_dwordx4 v224, s[72:75], s71 offen nt lds
    s_add_u32 m0, s79, 14336
    s_add_u32 s71, s71, s92
    buffer_load_dwordx4 v224, s[72:75], s71 offen nt lds
    s_add_u32 m0, s79, 15360
    s_add_u32 s71, s71, s92
    buffer_load_dwordx4 v224, s[72:75], s71 offen nt lds
    s_cmp_lg_u32 s3, 0
    s_cbranch_scc1 L_wq_ready_8
    s_lshl_b32 s7, s41, 3
    s_add_u32 s7, s7, s40
    s_lshl_b32 s7, s7, 7
    s_add_u32 s7, s7, 19431424
    s_add_u32 s68, s4, s7
    s_addc_u32 s69, s5, 0
    s_mov_b32 s6, 0
    s_mov_b32 s7, 0
L_cpoll_9:
    s_load_dwordx16 s[52:67], s[68:69], s7 glc
    s_add_u32 s6, s6, 1
    s_waitcnt lgkmcnt(0)
    s_xor_b64 s[52:53], s[52:53], s[76:77]
    s_xor_b64 s[54:55], s[54:55], s[76:77]
    s_xor_b64 s[56:57], s[56:57], s[76:77]
    s_xor_b64 s[58:59], s[58:59], s[76:77]
    s_xor_b64 s[60:61], s[60:61], s[76:77]
    s_xor_b64 s[62:63], s[62:63], s[76:77]
    s_xor_b64 s[64:65], s[64:65], s[76:77]
    s_xor_b64 s[66:67], s[66:67], s[76:77]
    s_or_b64 s[52:53], s[52:53], s[60:61]
    s_or_b64 s[54:55], s[54:55], s[62:63]
    s_or_b64 s[56:57], s[56:57], s[64:65]
    s_or_b64 s[58:59], s[58:59], s[66:67]
    s_or_b64 s[52:53], s[52:53], s[56:57]
    s_or_b64 s[54:55], s[54:55], s[58:59]
    s_or_b64 s[52:53], s[52:53], s[54:55]
    s_cbranch_scc1 L_cpoll_10
    s_add_u32 s7, s7, 64
    s_cmp_eq_u32 s7, 128
    s_cbranch_scc1 L_cpolled_11
L_cpoll_10:
    s_cmp_lt_u32 s6, 1048576
    s_cbranch_scc1 L_cpoll_9
    s_branch L_main_end
L_cpolled_11:
L_wq_ready_8:
    s_barrier
    s_lshl_b32 s28, s40, 2
    s_add_u32 s28, s28, s3
    s_mul_i32 s28, s28, 73728
    buffer_load_dwordx4 a[0:3], v253, s[8:11], s28 offen offset:0 sc1
    buffer_load_dwordx4 a[4:7], v253, s[8:11], s28 offen offset:1024 sc1
    buffer_load_dwordx4 a[8:11], v253, s[8:11], s28 offen offset:2048 sc1
    buffer_load_dwordx4 a[12:15], v253, s[8:11], s28 offen offset:3072 sc1
    s_add_u32 s28, s28, 4096
    buffer_load_dwordx4 a[16:19], v253, s[8:11], s28 offen offset:0 sc1
    buffer_load_dwordx4 a[20:23], v253, s[8:11], s28 offen offset:1024 sc1
    buffer_load_dwordx4 a[24:27], v253, s[8:11], s28 offen offset:2048 sc1
    buffer_load_dwordx4 a[28:31], v253, s[8:11], s28 offen offset:3072 sc1
    s_add_u32 s28, s28, 4096
    buffer_load_dwordx4 a[32:35], v253, s[8:11], s28 offen offset:0 sc1
    buffer_load_dwordx4 a[36:39], v253, s[8:11], s28 offen offset:1024 sc1
    buffer_load_dwordx4 a[40:43], v253, s[8:11], s28 offen offset:2048 sc1
    buffer_load_dwordx4 a[44:47], v253, s[8:11], s28 offen offset:3072 sc1
    s_add_u32 s28, s28, 4096
    buffer_load_dwordx4 a[48:51], v253, s[8:11], s28 offen offset:0 sc1
    buffer_load_dwordx4 a[52:55], v253, s[8:11], s28 offen offset:1024 sc1
    buffer_load_dwordx4 a[56:59], v253, s[8:11], s28 offen offset:2048 sc1
    buffer_load_dwordx4 a[60:63], v253, s[8:11], s28 offen offset:3072 sc1
    s_add_u32 s28, s28, 4096
    buffer_load_dwordx4 a[64:67], v253, s[8:11], s28 offen offset:0 sc1
    buffer_load_dwordx4 a[68:71], v253, s[8:11], s28 offen offset:1024 sc1
    buffer_load_dwordx4 a[72:75], v253, s[8:11], s28 offen offset:2048 sc1
    buffer_load_dwordx4 a[76:79], v253, s[8:11], s28 offen offset:3072 sc1
    s_add_u32 s28, s28, 4096
    buffer_load_dwordx4 a[80:83], v253, s[8:11], s28 offen offset:0 sc1
    buffer_load_dwordx4 a[84:87], v253, s[8:11], s28 offen offset:1024 sc1
    buffer_load_dwordx4 a[88:91], v253, s[8:11], s28 offen offset:2048 sc1
    buffer_load_dwordx4 a[92:95], v253, s[8:11], s28 offen offset:3072 sc1
    s_add_u32 s28, s28, 4096
    buffer_load_dwordx4 a[96:99], v253, s[8:11], s28 offen offset:0 sc1
    buffer_load_dwordx4 a[100:103], v253, s[8:11], s28 offen offset:1024 sc1
    buffer_load_dwordx4 a[104:107], v253, s[8:11], s28 offen offset:2048 sc1
    buffer_load_dwordx4 a[108:111], v253, s[8:11], s28 offen offset:3072 sc1
    s_add_u32 s28, s28, 4096
    buffer_load_dwordx4 a[112:115], v253, s[8:11], s28 offen offset:0 sc1
    buffer_load_dwordx4 a[116:119], v253, s[8:11], s28 offen offset:1024 sc1
    buffer_load_dwordx4 a[120:123], v253, s[8:11], s28 offen offset:2048 sc1
    buffer_load_dwordx4 a[124:127], v253, s[8:11], s28 offen offset:3072 sc1
    s_add_u32 s28, s28, 4096
    buffer_load_dwordx4 a[128:131], v253, s[8:11], s28 offen offset:0 sc1
    buffer_load_dwordx4 a[132:135], v253, s[8:11], s28 offen offset:1024 sc1
    buffer_load_dwordx4 a[136:139], v253, s[8:11], s28 offen offset:2048 sc1
    buffer_load_dwordx4 a[140:143], v253, s[8:11], s28 offen offset:3072 sc1
    s_add_u32 s28, s28, 4096
L_main_layer:
    v_bfe_u32 v3, v0, 3, 1
    v_mul_u32_u24 v2, 9216, v3
    v_lshrrev_b32 v3, 4, v0
    v_lshl_add_u32 v2, v3, 7, v2
    v_and_b32 v3, 7, v0
    v_lshl_add_u32 v2, v3, 4, v2
    v_bfe_u32 v3, v0, 3, 2
    s_mov_b32 s7, 9216
    v_mul_lo_u32 v9, v3, s7
    v_lshrrev_b32 v3, 5, v0
    v_lshl_add_u32 v9, v3, 7, v9
    v_and_b32 v3, 7, v0
    v_lshl_add_u32 v9, v3, 4, v9
    s_mul_i32 s22, s41, 73728
    s_add_u32 s22, s22, s43
    s_add_u32 s23, s22, 38797312
    s_mul_i32 s7, s3, 18432
    s_add_u32 s24, s23, s7
    s_cmp_eq_u32 s41, 0
    s_cselect_b32 s7, 0, 18432
    s_sub_u32 s23, s23, s7
    s_lshl_b32 s25, s3, 10
    s_add_u32 s25, s25, 1024
    s_mul_i32 s26, s3, 5120
    s_lshl_b32 s7, s3, 9
    s_add_u32 s27, s23, s7
    s_and_b32 s7, s3, 1
    s_add_u32 s7, s7, 4
    s_mul_i32 s29, s7, 5120
    s_lshl_b32 s7, s7, 9
    s_add_u32 s23, s23, s7
    s_cmp_lg_u32 s3, 3
    s_cbranch_scc1 L_pollout_14
    s_lshl_b32 s7, s40, 7
    s_add_u32 s7, s7, s44
    s_sub_u32 s7, s7, 32768
    s_add_u32 s52, s4, s7
    s_addc_u32 s53, s5, 0
    s_cmp_eq_u32 s41, 0
    s_cselect_b32 s7, 0, 32
    s_mov_b32 s6, 0
L_poll_12:
    s_load_dwordx8 s[56:63], s[52:53], 0 glc
    s_load_dwordx2 s[54:55], s[52:53], s7 glc
    s_add_u32 s6, s6, 1
    s_waitcnt lgkmcnt(0)
    s_xor_b64 s[54:55], s[54:55], s[76:77]
    s_xor_b64 s[56:57], s[56:57], s[76:77]
    s_xor_b64 s[58:59], s[58:59], s[76:77]
    s_xor_b64 s[60:61], s[60:61], s[76:77]
    s_xor_b64 s[62:63], s[62:63], s[76:77]
    s_or_b64 s[56:57], s[56:57], s[58:59]
    s_or_b64 s[60:61], s[60:61], s[62:63]
    s_or_b64 s[56:57], s[56:57], s[54:55]
    s_or_b64 s[56:57], s[56:57], s[60:61]
    s_cbranch_scc0 L_polled_13
    s_cmp_lt_u32 s6, 1048576
    s_cbranch_scc1 L_poll_12
    s_branch L_main_end
L_polled_13:
L_pollout_14:
    s_barrier
    s_add_u32 m0, s25, 0
    s_nop 0
    buffer_load_dwordx4 v2, s[8:11], s24 offen offset:0 sc1 lds
    s_add_u32 m0, s25, 4608
    s_nop 0
    buffer_load_dwordx4 v2, s[8:11], s24 offen offset:512 sc1 lds
    s_add_u32 m0, s25, 9216
    s_nop 0
    buffer_load_dwordx4 v2, s[8:11], s24 offen offset:1024 sc1 lds
    s_add_u32 m0, s25, 13824
    s_nop 0
    buffer_load_dwordx4 v2, s[8:11], s24 offen offset:1536 sc1 lds
    s_add_u32 m0, s25, 18432
    s_nop 0
    buffer_load_dwordx4 v2, s[8:11], s24 offen offset:2048 sc1 lds
    s_add_u32 m0, s25, 23040
    s_nop 0
    buffer_load_dwordx4 v2, s[8:11], s24 offen offset:2560 sc1 lds
    s_add_u32 m0, s26, 0
    s_add_u32 s7, s27, 0
    buffer_load_dwordx4 v2, s[8:11], s7 offen sc1 lds
    s_add_u32 m0, s29, 0
    s_add_u32 s7, s23, 0
    buffer_load_dwordx4 v2, s[8:11], s7 offen sc1 lds
    v_mov_b32 v132, 0
    v_mov_b32 v133, 0
    v_mov_b32 v192, 0
    v_mov_b32 v193, 0
    v_mov_b32 v195, 0
    v_mov_b32 v135, 0
    v_mov_b32 v139, 0
    v_mov_b32 v143, 0
    v_mov_b32 v147, 0
    v_mov_b32 v151, 0
    v_mov_b32 v155, 0
    v_mov_b32 v159, 0
    v_mov_b32 v163, 0
    v_mov_b32 v167, 0
    v_mov_b32 v171, 0
    v_cmp_eq_u32 vcc, 16, v0
    v_mov_b32 v10, 0x3f80
    v_cmp_eq_u32 s[20:21], 17, v0
    v_cndmask_b32 v194, 0, v10, vcc
    v_and_b32 v11, 3, v0
    v_cndmask_b32 v194, v194, 1.0, s[20:21]
    v_cmp_eq_u32 vcc, 2, v11
    v_and_b32 v10, 15, v0
    v_lshrrev_b32 v11, 4, v0
    v_cndmask_b32 v196, 0, 1.0, vcc
    v_cndmask_b32 v197, 0, 1.0, vcc
    v_cndmask_b32 v198, 0, 1.0, vcc
    v_cndmask_b32 v199, 0, 1.0, vcc
    v_lshlrev_b32 v11, 2, v11
    v_sub_u32 v10, v11, v10
    v_mov_b32 v12, 0xf149f2ca
    s_cmp_eq_u32 s41, 0
    s_cselect_b64 s[38:39], 0, -1
    v_add_u32 v11, 0, v10
    v_and_b32 v13, 1, v11
    v_cmp_eq_u32 s[20:21], 0, v13
    v_cmp_lt_i32 vcc, 1, v11
    v_cmp_gt_i32 s[18:19], 1, v11
    s_and_b64 vcc, vcc, s[20:21]
    s_and_b64 s[18:19], s[18:19], s[20:21]
    s_and_b64 s[20:21], vcc, s[38:39]
    v_cndmask_b32 v200, v12, 0, vcc
    v_cndmask_b32 v204, v12, 0, s[18:19]
    v_cndmask_b32 v208, v12, 0, s[20:21]
    v_add_u32 v11, 1, v10
    v_and_b32 v13, 1, v11
    v_cmp_eq_u32 s[20:21], 0, v13
    v_cmp_lt_i32 vcc, 1, v11
    v_cmp_gt_i32 s[18:19], 1, v11
    s_and_b64 vcc, vcc, s[20:21]
    s_and_b64 s[18:19], s[18:19], s[20:21]
    s_and_b64 s[20:21], vcc, s[38:39]
    v_cndmask_b32 v201, v12, 0, vcc
    v_cndmask_b32 v205, v12, 0, s[18:19]
    v_cndmask_b32 v209, v12, 0, s[20:21]
    v_add_u32 v11, 2, v10
    v_and_b32 v13, 1, v11
    v_cmp_eq_u32 s[20:21], 0, v13
    v_cmp_lt_i32 vcc, 1, v11
    v_cmp_gt_i32 s[18:19], 1, v11
    s_and_b64 vcc, vcc, s[20:21]
    s_and_b64 s[18:19], s[18:19], s[20:21]
    s_and_b64 s[20:21], vcc, s[38:39]
    v_cndmask_b32 v202, v12, 0, vcc
    v_cndmask_b32 v206, v12, 0, s[18:19]
    v_cndmask_b32 v210, v12, 0, s[20:21]
    v_add_u32 v11, 3, v10
    v_and_b32 v13, 1, v11
    v_cmp_eq_u32 s[20:21], 0, v13
    v_cmp_lt_i32 vcc, 1, v11
    v_cmp_gt_i32 s[18:19], 1, v11
    s_and_b64 vcc, vcc, s[20:21]
    s_and_b64 s[18:19], s[18:19], s[20:21]
    s_and_b64 s[20:21], vcc, s[38:39]
    v_cndmask_b32 v203, v12, 0, vcc
    v_cndmask_b32 v207, v12, 0, s[18:19]
    v_cndmask_b32 v211, v12, 0, s[20:21]
    s_lshl_b32 s45, s41, 1
    s_lshr_b32 s7, s40, 2
    s_add_u32 s45, s45, s7
    s_mul_i32 s30, s45, 36864
    s_add_u32 s30, s30, s43
    s_and_b32 s31, s40, 3
    s_mul_i32 s31, s31, 9
    s_add_u32 s31, s31, s3
    s_mul_i32 s32, s31, 18432
    s_add_u32 s32, s32, 2359296
    s_add_u32 s33, s32, 73728
    s_add_u32 s34, s32, 147456
    s_mov_b32 s39, 19496960
    v_min_u32 v228, 44, v0
    v_lshlrev_b32 v228, 3, v228
    s_cmp_eq_u32 s3, 1
    s_cmov_b32 s34, 3022848
    s_cmp_lt_u32 s3, 2
    s_cselect_b32 s35, 0, 1073741824
    v_add_u32 v5, s35, v253
    s_cmp_eq_u32 s3, 0
    s_cselect_b32 s35, 0, 1073741824
    v_add_u32 v7, s35, v9
    s_lshl_b32 s7, s31, 8
    s_add_u32 s36, s30, s7
    s_add_u32 s37, s36, 43515904
    s_add_u32 s46, s36, 45875200
    s_lshl_b32 s36, s45, 7
    s_add_u32 s36, s36, s43
    s_add_u32 s36, s36, 48431104
    s_lshl_b32 s47, s45, 9
    s_add_u32 s47, s47, s43
    s_add_u32 s47, s47, 48234496
    v_bfe_u32 v10, v0, 3, 2
    v_and_b32 v8, 7, v0
    v_lshlrev_b32 v8, 2, v8
    v_lshl_add_u32 v8, v10, 7, v8
    v_add_u32 v6, 46080, v253
    s_waitcnt vmcnt(0)
    s_barrier
    ds_read_b128 v[16:19], v253 offset:0
    ds_read_b128 v[20:23], v253 offset:1024
    ds_read_b128 v[24:27], v253 offset:2048
    ds_read_b128 v[28:31], v253 offset:3072
    ds_read_b128 v[32:35], v253 offset:4096
    s_waitcnt lgkmcnt(0)
    v_mfma_f32_16x16x32_bf16 v[56:59], a[0:3], v[20:23], 0
    ds_read_b128 v[36:39], v253 offset:5120
    v_mfma_f32_16x16x32_bf16 v[60:63], a[0:3], v[24:27], 0
    ds_read_b128 v[40:43], v253 offset:6144
    v_mfma_f32_16x16x32_bf16 v[64:67], a[0:3], v[28:31], 0
    ds_read_b128 v[44:47], v253 offset:7168
    v_mfma_f32_16x16x32_bf16 v[68:71], a[0:3], v[32:35], 0
    ds_read_b128 v[48:51], v253 offset:8192
    v_mfma_f32_16x16x32_bf16 v[72:75], a[4:7], v[16:19], 0
    ds_read_b128 v[52:55], v253 offset:9216
    v_mfma_f32_16x16x32_bf16 v[76:79], a[4:7], v[20:23], 0
    s_add_u32 m0, s25, 27648
    s_nop 0
    buffer_load_dwordx4 v2, s[8:11], s24 offen offset:3072 sc1 lds
    v_mfma_f32_16x16x32_bf16 v[80:83], a[4:7], v[24:27], 0
    v_mfma_f32_16x16x32_bf16 v[84:87], a[4:7], v[28:31], 0
    s_add_u32 m0, s25, 32256
    s_nop 0
    buffer_load_dwordx4 v2, s[8:11], s24 offen offset:3584 sc1 lds
    v_mfma_f32_16x16x32_bf16 v[88:91], a[4:7], v[32:35], 0
    v_mfma_f32_16x16x32_bf16 v[92:95], v[16:19], a[8:11], 0
    buffer_load_dwordx4 a[144:147], v253, s[8:11], s28 offen offset:0 sc1
    v_mfma_f32_16x16x32_bf16 v[96:99], v[20:23], a[8:11], 0
    v_mfma_f32_16x16x32_bf16 v[100:103], v[24:27], a[8:11], 0
    buffer_load_dwordx4 a[148:151], v253, s[8:11], s28 offen offset:1024 sc1
    v_mfma_f32_16x16x32_bf16 v[104:107], v[28:31], a[8:11], 0
    v_mfma_f32_16x16x32_bf16 v[108:111], v[32:35], a[8:11], 0
    buffer_load_dwordx4 a[152:155], v253, s[8:11], s28 offen offset:2048 sc1
    v_mfma_f32_16x16x32_bf16 v[112:115], a[12:15], v[16:19], 0
    v_mfma_f32_16x16x32_bf16 v[116:119], a[12:15], v[20:23], 0
    v_mfma_f32_16x16x32_bf16 v[120:123], a[12:15], v[24:27], 0
    v_mfma_f32_16x16x32_bf16 v[124:127], a[12:15], v[28:31], 0
    v_mfma_f32_16x16x32_bf16 v[128:131], a[12:15], v[32:35], 0
    s_waitcnt lgkmcnt(0)
    v_mfma_f32_16x16x32_bf16 v[56:59], a[16:19], v[40:43], v[56:59]
    ds_read_b128 v[16:19], v253 offset:10240
    v_mfma_f32_16x16x32_bf16 v[60:63], a[16:19], v[44:47], v[60:63]
    ds_read_b128 v[20:23], v253 offset:11264
    v_mfma_f32_16x16x32_bf16 v[64:67], a[16:19], v[48:51], v[64:67]
    ds_read_b128 v[24:27], v253 offset:12288
    v_mfma_f32_16x16x32_bf16 v[68:71], a[16:19], v[52:55], v[68:71]
    ds_read_b128 v[28:31], v253 offset:13312
    v_mfma_f32_16x16x32_bf16 v[72:75], a[20:23], v[36:39], v[72:75]
    ds_read_b128 v[32:35], v253 offset:14336
    v_mfma_f32_16x16x32_bf16 v[76:79], a[20:23], v[40:43], v[76:79]
    s_add_u32 m0, s25, 40960
    s_add_u32 s24, s24, 4096
    buffer_load_dwordx4 v2, s[8:11], s24 offen offset:0 sc1 lds
    v_mfma_f32_16x16x32_bf16 v[80:83], a[20:23], v[44:47], v[80:83]
    v_mfma_f32_16x16x32_bf16 v[84:87], a[20:23], v[48:51], v[84:87]
    s_add_u32 m0, s25, 45568
    s_nop 0
    buffer_load_dwordx4 v2, s[8:11], s24 offen offset:512 sc1 lds
    v_mfma_f32_16x16x32_bf16 v[88:91], a[20:23], v[52:55], v[88:91]
    v_mfma_f32_16x16x32_bf16 v[92:95], v[36:39], a[24:27], v[92:95]
    buffer_load_dwordx4 a[156:159], v253, s[8:11], s28 offen offset:3072 sc1
    s_add_u32 s28, s28, 4096
    v_mfma_f32_16x16x32_bf16 v[96:99], v[40:43], a[24:27], v[96:99]
    v_mfma_f32_16x16x32_bf16 v[100:103], v[44:47], a[24:27], v[100:103]
    buffer_load_dwordx4 a[0:3], v253, s[8:11], s28 offen offset:0 sc1
    v_mfma_f32_16x16x32_bf16 v[104:107], v[48:51], a[24:27], v[104:107]
    v_mfma_f32_16x16x32_bf16 v[108:111], v[52:55], a[24:27], v[108:111]
    buffer_load_dwordx4 a[4:7], v253, s[8:11], s28 offen offset:1024 sc1
    v_mfma_f32_16x16x32_bf16 v[112:115], a[28:31], v[36:39], v[112:115]
    v_mfma_f32_16x16x32_bf16 v[116:119], a[28:31], v[40:43], v[116:119]
    v_mfma_f32_16x16x32_bf16 v[120:123], a[28:31], v[44:47], v[120:123]
    v_mfma_f32_16x16x32_bf16 v[124:127], a[28:31], v[48:51], v[124:127]
    v_mfma_f32_16x16x32_bf16 v[128:131], a[28:31], v[52:55], v[128:131]
    s_waitcnt lgkmcnt(0)
    v_mfma_f32_16x16x32_bf16 v[56:59], a[32:35], v[20:23], v[56:59]
    ds_read_b128 v[36:39], v253 offset:15360
    v_mfma_f32_16x16x32_bf16 v[60:63], a[32:35], v[24:27], v[60:63]
    ds_read_b128 v[40:43], v253 offset:16384
    v_mfma_f32_16x16x32_bf16 v[64:67], a[32:35], v[28:31], v[64:67]
    ds_read_b128 v[44:47], v253 offset:17408
    v_mfma_f32_16x16x32_bf16 v[68:71], a[32:35], v[32:35], v[68:71]
    ds_read_b128 v[48:51], v253 offset:18432
    v_mfma_f32_16x16x32_bf16 v[72:75], a[36:39], v[16:19], v[72:75]
    ds_read_b128 v[52:55], v253 offset:19456
    v_mfma_f32_16x16x32_bf16 v[76:79], a[36:39], v[20:23], v[76:79]
    s_add_u32 m0, s25, 50176
    s_nop 0
    buffer_load_dwordx4 v2, s[8:11], s24 offen offset:1024 sc1 lds
    v_mfma_f32_16x16x32_bf16 v[80:83], a[36:39], v[24:27], v[80:83]
    v_mfma_f32_16x16x32_bf16 v[84:87], a[36:39], v[28:31], v[84:87]
    s_add_u32 m0, s25, 54784
    s_nop 0
    buffer_load_dwordx4 v2, s[8:11], s24 offen offset:1536 sc1 lds
    v_mfma_f32_16x16x32_bf16 v[88:91], a[36:39], v[32:35], v[88:91]
    v_mfma_f32_16x16x32_bf16 v[92:95], v[16:19], a[40:43], v[92:95]
    buffer_load_dwordx4 a[8:11], v253, s[8:11], s28 offen offset:2048 sc1
    v_mfma_f32_16x16x32_bf16 v[96:99], v[20:23], a[40:43], v[96:99]
    v_mfma_f32_16x16x32_bf16 v[100:103], v[24:27], a[40:43], v[100:103]
    buffer_load_dwordx4 a[12:15], v253, s[8:11], s28 offen offset:3072 sc1
    s_add_u32 s28, s28, 4096
    v_mfma_f32_16x16x32_bf16 v[104:107], v[28:31], a[40:43], v[104:107]
    v_mfma_f32_16x16x32_bf16 v[108:111], v[32:35], a[40:43], v[108:111]
    buffer_load_dwordx4 a[16:19], v253, s[8:11], s28 offen offset:0 sc1
    v_mfma_f32_16x16x32_bf16 v[112:115], a[44:47], v[16:19], v[112:115]
    v_mfma_f32_16x16x32_bf16 v[116:119], a[44:47], v[20:23], v[116:119]
    v_mfma_f32_16x16x32_bf16 v[120:123], a[44:47], v[24:27], v[120:123]
    v_mfma_f32_16x16x32_bf16 v[124:127], a[44:47], v[28:31], v[124:127]
    v_mfma_f32_16x16x32_bf16 v[128:131], a[44:47], v[32:35], v[128:131]
    s_waitcnt lgkmcnt(0)
    v_mfma_f32_16x16x32_bf16 v[56:59], a[48:51], v[40:43], v[56:59]
    ds_read_b128 v[16:19], v253 offset:20480
    v_mfma_f32_16x16x32_bf16 v[60:63], a[48:51], v[44:47], v[60:63]
    ds_read_b128 v[20:23], v253 offset:21504
    v_mfma_f32_16x16x32_bf16 v[64:67], a[48:51], v[48:51], v[64:67]
    ds_read_b128 v[24:27], v253 offset:22528
    v_mfma_f32_16x16x32_bf16 v[68:71], a[48:51], v[52:55], v[68:71]
    ds_read_b128 v[28:31], v253 offset:23552
    v_mfma_f32_16x16x32_bf16 v[72:75], a[52:55], v[36:39], v[72:75]
    ds_read_b128 v[32:35], v253 offset:24576
    v_mfma_f32_16x16x32_bf16 v[76:79], a[52:55], v[40:43], v[76:79]
    s_add_u32 m0, s26, 30720
    s_add_u32 s7, s27, 3072
    buffer_load_dwordx4 v2, s[8:11], s7 offen sc1 lds
    v_mfma_f32_16x16x32_bf16 v[80:83], a[52:55], v[44:47], v[80:83]
    v_mfma_f32_16x16x32_bf16 v[84:87], a[52:55], v[48:51], v[84:87]
    s_add_u32 m0, s29, 30720
    s_add_u32 s7, s23, 3072
    buffer_load_dwordx4 v2, s[8:11], s7 offen sc1 lds
    v_mfma_f32_16x16x32_bf16 v[88:91], a[52:55], v[52:55], v[88:91]
    v_mfma_f32_16x16x32_bf16 v[92:95], v[36:39], a[56:59], v[92:95]
    buffer_load_dwordx4 a[20:23], v253, s[8:11], s28 offen offset:1024 sc1
    v_mfma_f32_16x16x32_bf16 v[96:99], v[40:43], a[56:59], v[96:99]
    v_mfma_f32_16x16x32_bf16 v[100:103], v[44:47], a[56:59], v[100:103]
    buffer_load_dwordx4 a[24:27], v253, s[8:11], s28 offen offset:2048 sc1
    v_mfma_f32_16x16x32_bf16 v[104:107], v[48:51], a[56:59], v[104:107]
    v_mfma_f32_16x16x32_bf16 v[108:111], v[52:55], a[56:59], v[108:111]
    buffer_load_dwordx4 a[28:31], v253, s[8:11], s28 offen offset:3072 sc1
    s_add_u32 s28, s28, 4096
    v_mfma_f32_16x16x32_bf16 v[112:115], a[60:63], v[36:39], v[112:115]
    v_mfma_f32_16x16x32_bf16 v[116:119], a[60:63], v[40:43], v[116:119]
    v_mfma_f32_16x16x32_bf16 v[120:123], a[60:63], v[44:47], v[120:123]
    v_mfma_f32_16x16x32_bf16 v[124:127], a[60:63], v[48:51], v[124:127]
    v_mfma_f32_16x16x32_bf16 v[128:131], a[60:63], v[52:55], v[128:131]
    s_waitcnt lgkmcnt(0)
    v_mfma_f32_16x16x32_bf16 v[56:59], a[64:67], v[20:23], v[56:59]
    ds_read_b128 v[36:39], v253 offset:25600
    v_mfma_f32_16x16x32_bf16 v[60:63], a[64:67], v[24:27], v[60:63]
    ds_read_b128 v[40:43], v253 offset:26624
    v_mfma_f32_16x16x32_bf16 v[64:67], a[64:67], v[28:31], v[64:67]
    ds_read_b128 v[44:47], v253 offset:27648
    v_mfma_f32_16x16x32_bf16 v[68:71], a[64:67], v[32:35], v[68:71]
    ds_read_b128 v[48:51], v253 offset:28672
    v_mfma_f32_16x16x32_bf16 v[72:75], a[68:71], v[16:19], v[72:75]
    ds_read_b128 v[52:55], v253 offset:29696
    v_mfma_f32_16x16x32_bf16 v[76:79], a[68:71], v[20:23], v[76:79]
    buffer_load_dwordx4 a[32:35], v253, s[8:11], s28 offen offset:0 sc1
    v_mfma_f32_16x16x32_bf16 v[80:83], a[68:71], v[24:27], v[80:83]
    v_mfma_f32_16x16x32_bf16 v[84:87], a[68:71], v[28:31], v[84:87]
    buffer_load_dwordx4 a[36:39], v253, s[8:11], s28 offen offset:1024 sc1
    v_mfma_f32_16x16x32_bf16 v[88:91], a[68:71], v[32:35], v[88:91]
    v_mfma_f32_16x16x32_bf16 v[92:95], v[16:19], a[72:75], v[92:95]
    buffer_load_dwordx4 a[40:43], v253, s[8:11], s28 offen offset:2048 sc1
    v_mfma_f32_16x16x32_bf16 v[96:99], v[20:23], a[72:75], v[96:99]
    v_mfma_f32_16x16x32_bf16 v[100:103], v[24:27], a[72:75], v[100:103]
    buffer_load_dwordx2 v[226:227], v228, s[8:11], s39 offen sc1
    v_mfma_f32_16x16x32_bf16 v[104:107], v[28:31], a[72:75], v[104:107]
    v_mfma_f32_16x16x32_bf16 v[108:111], v[32:35], a[72:75], v[108:111]
    v_mfma_f32_16x16x32_bf16 v[112:115], a[76:79], v[16:19], v[112:115]
    v_mfma_f32_16x16x32_bf16 v[116:119], a[76:79], v[20:23], v[116:119]
    v_mfma_f32_16x16x32_bf16 v[120:123], a[76:79], v[24:27], v[120:123]
    v_mfma_f32_16x16x32_bf16 v[124:127], a[76:79], v[28:31], v[124:127]
    v_mfma_f32_16x16x32_bf16 v[128:131], a[76:79], v[32:35], v[128:131]
    s_waitcnt vmcnt(7) lgkmcnt(0)
    s_barrier
    v_mfma_f32_16x16x32_bf16 v[56:59], a[80:83], v[40:43], v[56:59]
    ds_read_b128 v[16:19], v253 offset:30720
    v_mfma_f32_16x16x32_bf16 v[60:63], a[80:83], v[44:47], v[60:63]
    ds_read_b128 v[20:23], v253 offset:31744
    v_mfma_f32_16x16x32_bf16 v[64:67], a[80:83], v[48:51], v[64:67]
    ds_read_b128 v[24:27], v253 offset:32768
    v_mfma_f32_16x16x32_bf16 v[68:71], a[80:83], v[52:55], v[68:71]
    ds_read_b128 v[28:31], v253 offset:33792
    v_mfma_f32_16x16x32_bf16 v[72:75], a[84:87], v[36:39], v[72:75]
    ds_read_b128 v[32:35], v253 offset:34816
    v_mfma_f32_16x16x32_bf16 v[76:79], a[84:87], v[40:43], v[76:79]
    s_add_u32 m0, s25, 59392
    s_nop 0
    buffer_load_dwordx4 v2, s[8:11], s24 offen offset:2048 sc1 lds
    v_mfma_f32_16x16x32_bf16 v[80:83], a[84:87], v[44:47], v[80:83]
    v_mfma_f32_16x16x32_bf16 v[84:87], a[84:87], v[48:51], v[84:87]
    s_add_u32 m0, s25, 64000
    s_nop 0
    buffer_load_dwordx4 v2, s[8:11], s24 offen offset:2560 sc1 lds
    v_mfma_f32_16x16x32_bf16 v[88:91], a[84:87], v[52:55], v[88:91]
    v_mfma_f32_16x16x32_bf16 v[92:95], v[36:39], a[88:91], v[92:95]
    buffer_load_dwordx4 a[44:47], v253, s[8:11], s28 offen offset:3072 sc1
    s_add_u32 s28, s28, 4096
    v_mfma_f32_16x16x32_bf16 v[96:99], v[40:43], a[88:91], v[96:99]
    v_mfma_f32_16x16x32_bf16 v[100:103], v[44:47], a[88:91], v[100:103]
    buffer_load_dwordx4 a[48:51], v253, s[8:11], s28 offen offset:0 sc1
    v_mfma_f32_16x16x32_bf16 v[104:107], v[48:51], a[88:91], v[104:107]
    v_mfma_f32_16x16x32_bf16 v[108:111], v[52:55], a[88:91], v[108:111]
    buffer_load_dwordx4 a[52:55], v253, s[8:11], s28 offen offset:1024 sc1
    v_mfma_f32_16x16x32_bf16 v[112:115], a[92:95], v[36:39], v[112:115]
    v_mfma_f32_16x16x32_bf16 v[116:119], a[92:95], v[40:43], v[116:119]
    v_mfma_f32_16x16x32_bf16 v[120:123], a[92:95], v[44:47], v[120:123]
    v_mfma_f32_16x16x32_bf16 v[124:127], a[92:95], v[48:51], v[124:127]
    v_mfma_f32_16x16x32_bf16 v[128:131], a[92:95], v[52:55], v[128:131]
    s_waitcnt lgkmcnt(0)
    v_mfma_f32_16x16x32_bf16 v[56:59], a[96:99], v[20:23], v[56:59]
    ds_read_b128 v[36:39], v253 offset:35840
    v_mfma_f32_16x16x32_bf16 v[60:63], a[96:99], v[24:27], v[60:63]
    ds_read_b128 v[40:43], v253 offset:36864
    v_mfma_f32_16x16x32_bf16 v[64:67], a[96:99], v[28:31], v[64:67]
    ds_read_b128 v[44:47], v253 offset:37888
    v_mfma_f32_16x16x32_bf16 v[68:71], a[96:99], v[32:35], v[68:71]
    ds_read_b128 v[48:51], v253 offset:38912
    v_mfma_f32_16x16x32_bf16 v[72:75], a[100:103], v[16:19], v[72:75]
    ds_read_b128 v[52:55], v253 offset:39936
    v_mfma_f32_16x16x32_bf16 v[76:79], a[100:103], v[20:23], v[76:79]
    s_add_u32 m0, s25, 68608
    s_nop 0
    buffer_load_dwordx4 v2, s[8:11], s24 offen offset:3072 sc1 lds
    v_mfma_f32_16x16x32_bf16 v[80:83], a[100:103], v[24:27], v[80:83]
    v_mfma_f32_16x16x32_bf16 v[84:87], a[100:103], v[28:31], v[84:87]
    s_add_u32 m0, s25, 73216
    s_nop 0
    buffer_load_dwordx4 v2, s[8:11], s24 offen offset:3584 sc1 lds
    v_mfma_f32_16x16x32_bf16 v[88:91], a[100:103], v[32:35], v[88:91]
    v_mfma_f32_16x16x32_bf16 v[92:95], v[16:19], a[104:107], v[92:95]
    buffer_load_dwordx4 a[56:59], v253, s[8:11], s28 offen offset:2048 sc1
    v_mfma_f32_16x16x32_bf16 v[96:99], v[20:23], a[104:107], v[96:99]
    v_mfma_f32_16x16x32_bf16 v[100:103], v[24:27], a[104:107], v[100:103]
    buffer_load_dwordx4 a[60:63], v253, s[8:11], s28 offen offset:3072 sc1
    s_add_u32 s28, s28, 4096
    v_mfma_f32_16x16x32_bf16 v[104:107], v[28:31], a[104:107], v[104:107]
    v_mfma_f32_16x16x32_bf16 v[108:111], v[32:35], a[104:107], v[108:111]
    buffer_load_dwordx4 a[64:67], v253, s[8:11], s28 offen offset:0 sc1
    v_mfma_f32_16x16x32_bf16 v[112:115], a[108:111], v[16:19], v[112:115]
    v_mfma_f32_16x16x32_bf16 v[116:119], a[108:111], v[20:23], v[116:119]
    v_mfma_f32_16x16x32_bf16 v[120:123], a[108:111], v[24:27], v[120:123]
    v_mfma_f32_16x16x32_bf16 v[124:127], a[108:111], v[28:31], v[124:127]
    v_mfma_f32_16x16x32_bf16 v[128:131], a[108:111], v[32:35], v[128:131]
    s_waitcnt lgkmcnt(0)
    v_mfma_f32_16x16x32_bf16 v[56:59], a[112:115], v[40:43], v[56:59]
    ds_read_b128 v[16:19], v253 offset:40960
    v_mfma_f32_16x16x32_bf16 v[60:63], a[112:115], v[44:47], v[60:63]
    ds_read_b128 v[20:23], v253 offset:41984
    v_mfma_f32_16x16x32_bf16 v[64:67], a[112:115], v[48:51], v[64:67]
    ds_read_b128 v[24:27], v253 offset:43008
    v_mfma_f32_16x16x32_bf16 v[68:71], a[112:115], v[52:55], v[68:71]
    ds_read_b128 v[28:31], v253 offset:44032
    v_mfma_f32_16x16x32_bf16 v[72:75], a[116:119], v[36:39], v[72:75]
    ds_read_b128 v[32:35], v253 offset:45056
    v_mfma_f32_16x16x32_bf16 v[76:79], a[116:119], v[40:43], v[76:79]
    s_add_u32 m0, s25, 81920
    s_add_u32 s24, s24, 4096
    buffer_load_dwordx4 v2, s[8:11], s24 offen offset:0 sc1 lds
    v_mfma_f32_16x16x32_bf16 v[80:83], a[116:119], v[44:47], v[80:83]
    v_mfma_f32_16x16x32_bf16 v[84:87], a[116:119], v[48:51], v[84:87]
    s_add_u32 m0, s25, 86528
    s_nop 0
    buffer_load_dwordx4 v2, s[8:11], s24 offen offset:512 sc1 lds
    v_mfma_f32_16x16x32_bf16 v[88:91], a[116:119], v[52:55], v[88:91]
    v_mfma_f32_16x16x32_bf16 v[92:95], v[36:39], a[120:123], v[92:95]
    buffer_load_dwordx4 a[68:71], v253, s[8:11], s28 offen offset:1024 sc1
    v_mfma_f32_16x16x32_bf16 v[96:99], v[40:43], a[120:123], v[96:99]
    v_mfma_f32_16x16x32_bf16 v[100:103], v[44:47], a[120:123], v[100:103]
    buffer_load_dwordx4 a[72:75], v253, s[8:11], s28 offen offset:2048 sc1
    v_mfma_f32_16x16x32_bf16 v[104:107], v[48:51], a[120:123], v[104:107]
    v_mfma_f32_16x16x32_bf16 v[108:111], v[52:55], a[120:123], v[108:111]
    buffer_load_dwordx4 a[76:79], v253, s[8:11], s28 offen offset:3072 sc1
    s_add_u32 s28, s28, 4096
    v_mfma_f32_16x16x32_bf16 v[112:115], a[124:127], v[36:39], v[112:115]
    v_mfma_f32_16x16x32_bf16 v[116:119], a[124:127], v[40:43], v[116:119]
    v_mfma_f32_16x16x32_bf16 v[120:123], a[124:127], v[44:47], v[120:123]
    v_mfma_f32_16x16x32_bf16 v[124:127], a[124:127], v[48:51], v[124:127]
    v_mfma_f32_16x16x32_bf16 v[128:131], a[124:127], v[52:55], v[128:131]
    s_waitcnt lgkmcnt(0)
    v_mfma_f32_16x16x32_bf16 v[56:59], a[128:131], v[20:23], v[56:59]
    ds_read_b128 v[36:39], v6 offset:0
    v_mfma_f32_16x16x32_bf16 v[60:63], a[128:131], v[24:27], v[60:63]
    ds_read_b128 v[40:43], v6 offset:1024
    v_mfma_f32_16x16x32_bf16 v[64:67], a[128:131], v[28:31], v[64:67]
    ds_read_b128 v[44:47], v6 offset:2048
    v_mfma_f32_16x16x32_bf16 v[68:71], a[128:131], v[32:35], v[68:71]
    ds_read_b128 v[48:51], v6 offset:3072
    v_mfma_f32_16x16x32_bf16 v[72:75], a[132:135], v[16:19], v[72:75]
    ds_read_b128 v[52:55], v6 offset:4096
    v_mfma_f32_16x16x32_bf16 v[76:79], a[132:135], v[20:23], v[76:79]
    s_add_u32 m0, s26, 61440
    s_add_u32 s7, s27, 6144
    buffer_load_dwordx4 v2, s[8:11], s7 offen sc1 lds
    v_mfma_f32_16x16x32_bf16 v[80:83], a[132:135], v[24:27], v[80:83]
    v_mfma_f32_16x16x32_bf16 v[84:87], a[132:135], v[28:31], v[84:87]
    s_add_u32 m0, s29, 61440
    s_add_u32 s7, s23, 6144
    buffer_load_dwordx4 v2, s[8:11], s7 offen sc1 lds
    v_mfma_f32_16x16x32_bf16 v[88:91], a[132:135], v[32:35], v[88:91]
    v_mfma_f32_16x16x32_bf16 v[92:95], v[16:19], a[136:139], v[92:95]
    buffer_load_dwordx4 a[80:83], v253, s[8:11], s28 offen offset:0 sc1
    v_mfma_f32_16x16x32_bf16 v[96:99], v[20:23], a[136:139], v[96:99]
    v_mfma_f32_16x16x32_bf16 v[100:103], v[24:27], a[136:139], v[100:103]
    buffer_load_dwordx4 a[84:87], v253, s[8:11], s28 offen offset:1024 sc1
    v_mfma_f32_16x16x32_bf16 v[104:107], v[28:31], a[136:139], v[104:107]
    v_mfma_f32_16x16x32_bf16 v[108:111], v[32:35], a[136:139], v[108:111]
    buffer_load_dwordx4 a[88:91], v253, s[8:11], s28 offen offset:2048 sc1
    v_mfma_f32_16x16x32_bf16 v[112:115], a[140:143], v[16:19], v[112:115]
    v_mfma_f32_16x16x32_bf16 v[116:119], a[140:143], v[20:23], v[116:119]
    v_mfma_f32_16x16x32_bf16 v[120:123], a[140:143], v[24:27], v[120:123]
    v_mfma_f32_16x16x32_bf16 v[124:127], a[140:143], v[28:31], v[124:127]
    v_mfma_f32_16x16x32_bf16 v[128:131], a[140:143], v[32:35], v[128:131]
    s_waitcnt vmcnt(20) lgkmcnt(0)
    s_mov_b32 s6, 0
L_wo_poll_15:
    v_cmp_eq_u32 vcc, s76, v226
    v_cmp_eq_u32 s[20:21], s76, v227
    s_and_b64 vcc, vcc, s[20:21]
    s_cmp_eq_u64 vcc, exec
    s_cbranch_scc1 L_wo_ready_16
    buffer_load_dwordx2 v[226:227], v228, s[8:11], s39 offen sc1
    s_add_u32 s6, s6, 1
    s_cmp_lt_u32 s6, 1048576
    s_waitcnt vmcnt(0)
    s_cbranch_scc1 L_wo_poll_15
    s_branch L_main_end
L_wo_ready_16:
    v_mfma_f32_16x16x32_bf16 v[56:59], a[144:147], v[40:43], v[56:59]
    ds_read_b128 v[16:19], v6 offset:5120
    v_mfma_f32_16x16x32_bf16 v[60:63], a[144:147], v[44:47], v[60:63]
    ds_read_b128 v[20:23], v6 offset:6144
    v_mfma_f32_16x16x32_bf16 v[64:67], a[144:147], v[48:51], v[64:67]
    ds_read_b128 v[24:27], v6 offset:7168
    v_mfma_f32_16x16x32_bf16 v[68:71], a[144:147], v[52:55], v[68:71]
    ds_read_b128 v[28:31], v6 offset:8192
    v_mfma_f32_16x16x32_bf16 v[72:75], a[148:151], v[36:39], v[72:75]
    ds_read_b128 v[32:35], v6 offset:9216
    v_mfma_f32_16x16x32_bf16 v[76:79], a[148:151], v[40:43], v[76:79]
    buffer_load_dwordx4 a[92:95], v253, s[8:11], s28 offen offset:3072 sc1
    s_add_u32 s28, s28, 4096
    v_mfma_f32_16x16x32_bf16 v[80:83], a[148:151], v[44:47], v[80:83]
    v_mfma_f32_16x16x32_bf16 v[84:87], a[148:151], v[48:51], v[84:87]
    buffer_load_dwordx4 a[96:99], v253, s[8:11], s28 offen offset:0 sc1
    v_mfma_f32_16x16x32_bf16 v[88:91], a[148:151], v[52:55], v[88:91]
    v_mfma_f32_16x16x32_bf16 v[92:95], v[36:39], a[152:155], v[92:95]
    buffer_load_dwordx4 a[100:103], v253, s[8:11], s28 offen offset:1024 sc1
    v_mfma_f32_16x16x32_bf16 v[96:99], v[40:43], a[152:155], v[96:99]
    v_mfma_f32_16x16x32_bf16 v[100:103], v[44:47], a[152:155], v[100:103]
    buffer_load_dwordx4 a[160:163], v253, s[8:11], s32 offen offset:0 sc1
    v_mfma_f32_16x16x32_bf16 v[104:107], v[48:51], a[152:155], v[104:107]
    v_mfma_f32_16x16x32_bf16 v[108:111], v[52:55], a[152:155], v[108:111]
    v_mfma_f32_16x16x32_bf16 v[112:115], a[156:159], v[36:39], v[112:115]
    v_mfma_f32_16x16x32_bf16 v[116:119], a[156:159], v[40:43], v[116:119]
    v_mfma_f32_16x16x32_bf16 v[120:123], a[156:159], v[44:47], v[120:123]
    v_mfma_f32_16x16x32_bf16 v[124:127], a[156:159], v[48:51], v[124:127]
    v_mfma_f32_16x16x32_bf16 v[128:131], a[156:159], v[52:55], v[128:131]
    s_waitcnt vmcnt(34) lgkmcnt(0)
    v_mfma_f32_16x16x32_bf16 v[56:59], a[0:3], v[20:23], v[56:59]
    ds_read_b128 v[36:39], v6 offset:10240
    v_mfma_f32_16x16x32_bf16 v[60:63], a[0:3], v[24:27], v[60:63]
    ds_read_b128 v[40:43], v6 offset:11264
    v_mfma_f32_16x16x32_bf16 v[64:67], a[0:3], v[28:31], v[64:67]
    ds_read_b128 v[44:47], v6 offset:12288
    v_mfma_f32_16x16x32_bf16 v[68:71], a[0:3], v[32:35], v[68:71]
    ds_read_b128 v[48:51], v6 offset:13312
    v_mfma_f32_16x16x32_bf16 v[72:75], a[4:7], v[16:19], v[72:75]
    ds_read_b128 v[52:55], v6 offset:14336
    v_mfma_f32_16x16x32_bf16 v[76:79], a[4:7], v[20:23], v[76:79]
    buffer_load_dwordx4 a[104:107], v253, s[8:11], s28 offen offset:2048 sc1
    v_mfma_f32_16x16x32_bf16 v[80:83], a[4:7], v[24:27], v[80:83]
    v_mfma_f32_16x16x32_bf16 v[84:87], a[4:7], v[28:31], v[84:87]
    buffer_load_dwordx4 a[108:111], v253, s[8:11], s28 offen offset:3072 sc1
    s_add_u32 s28, s28, 4096
    v_mfma_f32_16x16x32_bf16 v[88:91], a[4:7], v[32:35], v[88:91]
    v_mfma_f32_16x16x32_bf16 v[92:95], v[16:19], a[8:11], v[92:95]
    buffer_load_dwordx4 a[112:115], v253, s[8:11], s28 offen offset:0 sc1
    v_mfma_f32_16x16x32_bf16 v[96:99], v[20:23], a[8:11], v[96:99]
    v_mfma_f32_16x16x32_bf16 v[100:103], v[24:27], a[8:11], v[100:103]
    buffer_load_dwordx4 a[164:167], v253, s[8:11], s33 offen offset:0 sc1
    v_mfma_f32_16x16x32_bf16 v[104:107], v[28:31], a[8:11], v[104:107]
    v_mfma_f32_16x16x32_bf16 v[108:111], v[32:35], a[8:11], v[108:111]
    v_mfma_f32_16x16x32_bf16 v[112:115], a[12:15], v[16:19], v[112:115]
    v_mfma_f32_16x16x32_bf16 v[116:119], a[12:15], v[20:23], v[116:119]
    v_mfma_f32_16x16x32_bf16 v[120:123], a[12:15], v[24:27], v[120:123]
    v_mfma_f32_16x16x32_bf16 v[124:127], a[12:15], v[28:31], v[124:127]
    v_mfma_f32_16x16x32_bf16 v[128:131], a[12:15], v[32:35], v[128:131]
    s_waitcnt vmcnt(11) lgkmcnt(0)
    s_barrier
    v_mfma_f32_16x16x32_bf16 v[56:59], a[16:19], v[40:43], v[56:59]
    ds_read_b128 v[16:19], v6 offset:15360
    v_mfma_f32_16x16x32_bf16 v[60:63], a[16:19], v[44:47], v[60:63]
    ds_read_b128 v[20:23], v6 offset:16384
    v_mfma_f32_16x16x32_bf16 v[64:67], a[16:19], v[48:51], v[64:67]
    ds_read_b128 v[24:27], v6 offset:17408
    v_mfma_f32_16x16x32_bf16 v[68:71], a[16:19], v[52:55], v[68:71]
    ds_read_b128 v[28:31], v6 offset:18432
    v_mfma_f32_16x16x32_bf16 v[72:75], a[20:23], v[36:39], v[72:75]
    ds_read_b128 v[32:35], v6 offset:19456
    v_mfma_f32_16x16x32_bf16 v[76:79], a[20:23], v[40:43], v[76:79]
    buffer_load_dwordx4 a[116:119], v253, s[8:11], s28 offen offset:1024 sc1
    v_mfma_f32_16x16x32_bf16 v[80:83], a[20:23], v[44:47], v[80:83]
    v_mfma_f32_16x16x32_bf16 v[84:87], a[20:23], v[48:51], v[84:87]
    buffer_load_dwordx4 a[120:123], v253, s[8:11], s28 offen offset:2048 sc1
    v_mfma_f32_16x16x32_bf16 v[88:91], a[20:23], v[52:55], v[88:91]
    v_mfma_f32_16x16x32_bf16 v[92:95], v[36:39], a[24:27], v[92:95]
    buffer_load_dwordx4 a[124:127], v253, s[8:11], s28 offen offset:3072 sc1
    s_add_u32 s28, s28, 4096
    v_mfma_f32_16x16x32_bf16 v[96:99], v[40:43], a[24:27], v[96:99]
    v_mfma_f32_16x16x32_bf16 v[100:103], v[44:47], a[24:27], v[100:103]
    buffer_load_dwordx4 a[168:171], v5, s[8:11], s34 offen offset:0 sc1
    v_mfma_f32_16x16x32_bf16 v[104:107], v[48:51], a[24:27], v[104:107]
    v_mfma_f32_16x16x32_bf16 v[108:111], v[52:55], a[24:27], v[108:111]
    v_mfma_f32_16x16x32_bf16 v[112:115], a[28:31], v[36:39], v[112:115]
    v_mfma_f32_16x16x32_bf16 v[116:119], a[28:31], v[40:43], v[116:119]
    v_mfma_f32_16x16x32_bf16 v[120:123], a[28:31], v[44:47], v[120:123]
    v_mfma_f32_16x16x32_bf16 v[124:127], a[28:31], v[48:51], v[124:127]
    v_mfma_f32_16x16x32_bf16 v[128:131], a[28:31], v[52:55], v[128:131]
    s_waitcnt vmcnt(29) lgkmcnt(0)
    v_mfma_f32_16x16x32_bf16 v[56:59], a[32:35], v[20:23], v[56:59]
    ds_read_b128 v[36:39], v6 offset:20480
    v_mfma_f32_16x16x32_bf16 v[60:63], a[32:35], v[24:27], v[60:63]
    ds_read_b128 v[40:43], v6 offset:21504
    v_mfma_f32_16x16x32_bf16 v[64:67], a[32:35], v[28:31], v[64:67]
    ds_read_b128 v[44:47], v6 offset:22528
    v_mfma_f32_16x16x32_bf16 v[68:71], a[32:35], v[32:35], v[68:71]
    ds_read_b128 v[48:51], v6 offset:23552
    v_mfma_f32_16x16x32_bf16 v[72:75], a[36:39], v[16:19], v[72:75]
    ds_read_b128 v[52:55], v6 offset:24576
    v_mfma_f32_16x16x32_bf16 v[76:79], a[36:39], v[20:23], v[76:79]
    buffer_load_dwordx4 a[172:175], v253, s[8:11], s32 offen offset:1024 sc1
    v_mfma_f32_16x16x32_bf16 v[80:83], a[36:39], v[24:27], v[80:83]
    v_mfma_f32_16x16x32_bf16 v[84:87], a[36:39], v[28:31], v[84:87]
    buffer_load_dwordx4 a[176:179], v253, s[8:11], s33 offen offset:1024 sc1
    v_mfma_f32_16x16x32_bf16 v[88:91], a[36:39], v[32:35], v[88:91]
    v_mfma_f32_16x16x32_bf16 v[92:95], v[16:19], a[40:43], v[92:95]
    buffer_load_dwordx4 a[180:183], v5, s[8:11], s34 offen offset:1024 sc1
    v_mfma_f32_16x16x32_bf16 v[96:99], v[20:23], a[40:43], v[96:99]
    v_mfma_f32_16x16x32_bf16 v[100:103], v[24:27], a[40:43], v[100:103]
    buffer_load_dwordx4 a[184:187], v253, s[8:11], s32 offen offset:2048 sc1
    v_mfma_f32_16x16x32_bf16 v[104:107], v[28:31], a[40:43], v[104:107]
    v_mfma_f32_16x16x32_bf16 v[108:111], v[32:35], a[40:43], v[108:111]
    v_mfma_f32_16x16x32_bf16 v[112:115], a[44:47], v[16:19], v[112:115]
    v_mfma_f32_16x16x32_bf16 v[116:119], a[44:47], v[20:23], v[116:119]
    v_mfma_f32_16x16x32_bf16 v[120:123], a[44:47], v[24:27], v[120:123]
    v_mfma_f32_16x16x32_bf16 v[124:127], a[44:47], v[28:31], v[124:127]
    v_mfma_f32_16x16x32_bf16 v[128:131], a[44:47], v[32:35], v[128:131]
    s_waitcnt vmcnt(27) lgkmcnt(0)
    v_mfma_f32_16x16x32_bf16 v[56:59], a[48:51], v[40:43], v[56:59]
    ds_read_b128 v[16:19], v6 offset:25600
    v_mfma_f32_16x16x32_bf16 v[60:63], a[48:51], v[44:47], v[60:63]
    ds_read_b128 v[20:23], v6 offset:26624
    v_mfma_f32_16x16x32_bf16 v[64:67], a[48:51], v[48:51], v[64:67]
    ds_read_b128 v[24:27], v6 offset:27648
    v_mfma_f32_16x16x32_bf16 v[68:71], a[48:51], v[52:55], v[68:71]
    ds_read_b128 v[28:31], v6 offset:28672
    v_mfma_f32_16x16x32_bf16 v[72:75], a[52:55], v[36:39], v[72:75]
    ds_read_b128 v[32:35], v6 offset:29696
    v_mfma_f32_16x16x32_bf16 v[76:79], a[52:55], v[40:43], v[76:79]
    buffer_load_dwordx4 a[188:191], v253, s[8:11], s33 offen offset:2048 sc1
    v_mfma_f32_16x16x32_bf16 v[80:83], a[52:55], v[44:47], v[80:83]
    v_mfma_f32_16x16x32_bf16 v[84:87], a[52:55], v[48:51], v[84:87]
    buffer_load_dwordx4 a[192:195], v5, s[8:11], s34 offen offset:2048 sc1
    v_mfma_f32_16x16x32_bf16 v[88:91], a[52:55], v[52:55], v[88:91]
    v_mfma_f32_16x16x32_bf16 v[92:95], v[36:39], a[56:59], v[92:95]
    buffer_load_dwordx4 a[196:199], v253, s[8:11], s32 offen offset:3072 sc1
    s_add_u32 s32, s32, 4096
    v_mfma_f32_16x16x32_bf16 v[96:99], v[40:43], a[56:59], v[96:99]
    v_mfma_f32_16x16x32_bf16 v[100:103], v[44:47], a[56:59], v[100:103]
    buffer_load_dwordx4 a[200:203], v253, s[8:11], s33 offen offset:3072 sc1
    s_add_u32 s33, s33, 4096
    v_mfma_f32_16x16x32_bf16 v[104:107], v[48:51], a[56:59], v[104:107]
    v_mfma_f32_16x16x32_bf16 v[108:111], v[52:55], a[56:59], v[108:111]
    v_mfma_f32_16x16x32_bf16 v[112:115], a[60:63], v[36:39], v[112:115]
    v_mfma_f32_16x16x32_bf16 v[116:119], a[60:63], v[40:43], v[116:119]
    v_mfma_f32_16x16x32_bf16 v[120:123], a[60:63], v[44:47], v[120:123]
    v_mfma_f32_16x16x32_bf16 v[124:127], a[60:63], v[48:51], v[124:127]
    v_mfma_f32_16x16x32_bf16 v[128:131], a[60:63], v[52:55], v[128:131]
    s_waitcnt vmcnt(25) lgkmcnt(0)
    v_mfma_f32_16x16x32_bf16 v[56:59], a[64:67], v[20:23], v[56:59]
    ds_read_b128 v[36:39], v6 offset:30720
    v_mfma_f32_16x16x32_bf16 v[60:63], a[64:67], v[24:27], v[60:63]
    ds_read_b128 v[40:43], v6 offset:31744
    v_mfma_f32_16x16x32_bf16 v[64:67], a[64:67], v[28:31], v[64:67]
    ds_read_b128 v[44:47], v6 offset:32768
    v_mfma_f32_16x16x32_bf16 v[68:71], a[64:67], v[32:35], v[68:71]
    ds_read_b128 v[48:51], v6 offset:33792
    v_mfma_f32_16x16x32_bf16 v[72:75], a[68:71], v[16:19], v[72:75]
    ds_read_b128 v[52:55], v6 offset:34816
    v_mfma_f32_16x16x32_bf16 v[76:79], a[68:71], v[20:23], v[76:79]
    buffer_load_dwordx4 a[204:207], v5, s[8:11], s34 offen offset:3072 sc1
    s_add_u32 s34, s34, 4096
    v_mfma_f32_16x16x32_bf16 v[80:83], a[68:71], v[24:27], v[80:83]
    v_mfma_f32_16x16x32_bf16 v[84:87], a[68:71], v[28:31], v[84:87]
    buffer_load_dwordx4 a[208:211], v253, s[8:11], s32 offen offset:0 sc1
    v_mfma_f32_16x16x32_bf16 v[88:91], a[68:71], v[32:35], v[88:91]
    v_mfma_f32_16x16x32_bf16 v[92:95], v[16:19], a[72:75], v[92:95]
    buffer_load_dwordx4 a[212:215], v253, s[8:11], s33 offen offset:0 sc1
    v_mfma_f32_16x16x32_bf16 v[96:99], v[20:23], a[72:75], v[96:99]
    v_mfma_f32_16x16x32_bf16 v[100:103], v[24:27], a[72:75], v[100:103]
    buffer_load_dwordx4 a[216:219], v5, s[8:11], s34 offen offset:0 sc1
    v_mfma_f32_16x16x32_bf16 v[104:107], v[28:31], a[72:75], v[104:107]
    v_mfma_f32_16x16x32_bf16 v[108:111], v[32:35], a[72:75], v[108:111]
    v_mfma_f32_16x16x32_bf16 v[112:115], a[76:79], v[16:19], v[112:115]
    v_mfma_f32_16x16x32_bf16 v[116:119], a[76:79], v[20:23], v[116:119]
    v_mfma_f32_16x16x32_bf16 v[120:123], a[76:79], v[24:27], v[120:123]
    v_mfma_f32_16x16x32_bf16 v[124:127], a[76:79], v[28:31], v[124:127]
    v_mfma_f32_16x16x32_bf16 v[128:131], a[76:79], v[32:35], v[128:131]
    s_waitcnt vmcnt(23) lgkmcnt(0)
    v_mfma_f32_16x16x32_bf16 v[56:59], a[80:83], v[40:43], v[56:59]
    ds_read_b128 v[16:19], v6 offset:35840
    v_mfma_f32_16x16x32_bf16 v[60:63], a[80:83], v[44:47], v[60:63]
    ds_read_b128 v[20:23], v6 offset:36864
    v_mfma_f32_16x16x32_bf16 v[64:67], a[80:83], v[48:51], v[64:67]
    ds_read_b128 v[24:27], v6 offset:37888
    v_mfma_f32_16x16x32_bf16 v[68:71], a[80:83], v[52:55], v[68:71]
    ds_read_b128 v[28:31], v6 offset:38912
    v_mfma_f32_16x16x32_bf16 v[72:75], a[84:87], v[36:39], v[72:75]
    ds_read_b128 v[32:35], v6 offset:39936
    v_mfma_f32_16x16x32_bf16 v[76:79], a[84:87], v[40:43], v[76:79]
    buffer_load_dwordx4 a[220:223], v253, s[8:11], s32 offen offset:1024 sc1
    v_mfma_f32_16x16x32_bf16 v[80:83], a[84:87], v[44:47], v[80:83]
    v_mfma_f32_16x16x32_bf16 v[84:87], a[84:87], v[48:51], v[84:87]
    buffer_load_dwordx4 a[224:227], v253, s[8:11], s33 offen offset:1024 sc1
    v_mfma_f32_16x16x32_bf16 v[88:91], a[84:87], v[52:55], v[88:91]
    v_mfma_f32_16x16x32_bf16 v[92:95], v[36:39], a[88:91], v[92:95]
    buffer_load_dwordx4 a[228:231], v5, s[8:11], s34 offen offset:1024 sc1
    v_mfma_f32_16x16x32_bf16 v[96:99], v[40:43], a[88:91], v[96:99]
    v_mfma_f32_16x16x32_bf16 v[100:103], v[44:47], a[88:91], v[100:103]
    buffer_load_dwordx4 a[232:235], v253, s[8:11], s32 offen offset:2048 sc1
    v_mfma_f32_16x16x32_bf16 v[104:107], v[48:51], a[88:91], v[104:107]
    v_mfma_f32_16x16x32_bf16 v[108:111], v[52:55], a[88:91], v[108:111]
    v_mfma_f32_16x16x32_bf16 v[112:115], a[92:95], v[36:39], v[112:115]
    v_mfma_f32_16x16x32_bf16 v[116:119], a[92:95], v[40:43], v[116:119]
    v_mfma_f32_16x16x32_bf16 v[120:123], a[92:95], v[44:47], v[120:123]
    v_mfma_f32_16x16x32_bf16 v[124:127], a[92:95], v[48:51], v[124:127]
    v_mfma_f32_16x16x32_bf16 v[128:131], a[92:95], v[52:55], v[128:131]
    s_waitcnt vmcnt(22) lgkmcnt(0)
    v_mfma_f32_16x16x32_bf16 v[56:59], a[96:99], v[20:23], v[56:59]
    ds_read_b128 v[36:39], v6 offset:40960
    v_mfma_f32_16x16x32_bf16 v[60:63], a[96:99], v[24:27], v[60:63]
    ds_read_b128 v[40:43], v6 offset:41984
    v_mfma_f32_16x16x32_bf16 v[64:67], a[96:99], v[28:31], v[64:67]
    ds_read_b128 v[44:47], v6 offset:43008
    v_mfma_f32_16x16x32_bf16 v[68:71], a[96:99], v[32:35], v[68:71]
    ds_read_b128 v[48:51], v6 offset:44032
    v_mfma_f32_16x16x32_bf16 v[72:75], a[100:103], v[16:19], v[72:75]
    ds_read_b128 v[52:55], v6 offset:45056
    v_mfma_f32_16x16x32_bf16 v[76:79], a[100:103], v[20:23], v[76:79]
    buffer_load_dwordx4 a[236:239], v253, s[8:11], s33 offen offset:2048 sc1
    v_mfma_f32_16x16x32_bf16 v[80:83], a[100:103], v[24:27], v[80:83]
    v_mfma_f32_16x16x32_bf16 v[84:87], a[100:103], v[28:31], v[84:87]
    buffer_load_dwordx4 a[240:243], v5, s[8:11], s34 offen offset:2048 sc1
    v_mfma_f32_16x16x32_bf16 v[88:91], a[100:103], v[32:35], v[88:91]
    v_mfma_f32_16x16x32_bf16 v[92:95], v[16:19], a[104:107], v[92:95]
    buffer_load_dwordx4 a[244:247], v253, s[8:11], s32 offen offset:3072 sc1
    s_add_u32 s32, s32, 4096
    v_mfma_f32_16x16x32_bf16 v[96:99], v[20:23], a[104:107], v[96:99]
    v_mfma_f32_16x16x32_bf16 v[100:103], v[24:27], a[104:107], v[100:103]
    buffer_load_dwordx4 a[248:251], v253, s[8:11], s33 offen offset:3072 sc1
    s_add_u32 s33, s33, 4096
    v_mfma_f32_16x16x32_bf16 v[104:107], v[28:31], a[104:107], v[104:107]
    v_mfma_f32_16x16x32_bf16 v[108:111], v[32:35], a[104:107], v[108:111]
    v_mfma_f32_16x16x32_bf16 v[112:115], a[108:111], v[16:19], v[112:115]
    v_mfma_f32_16x16x32_bf16 v[116:119], a[108:111], v[20:23], v[116:119]
    v_mfma_f32_16x16x32_bf16 v[120:123], a[108:111], v[24:27], v[120:123]
    v_mfma_f32_16x16x32_bf16 v[124:127], a[108:111], v[28:31], v[124:127]
    v_mfma_f32_16x16x32_bf16 v[128:131], a[108:111], v[32:35], v[128:131]
    s_waitcnt vmcnt(21) lgkmcnt(0)
    v_mfma_f32_16x16x32_bf16 v[56:59], a[112:115], v[40:43], v[56:59]
    v_mfma_f32_16x16x32_bf16 v[60:63], a[112:115], v[44:47], v[60:63]
    v_mfma_f32_16x16x32_bf16 v[64:67], a[112:115], v[48:51], v[64:67]
    v_mfma_f32_16x16x32_bf16 v[68:71], a[112:115], v[52:55], v[68:71]
    v_mfma_f32_16x16x32_bf16 v[72:75], a[116:119], v[36:39], v[72:75]
    v_mfma_f32_16x16x32_bf16 v[76:79], a[116:119], v[40:43], v[76:79]
    buffer_load_dwordx4 a[252:255], v5, s[8:11], s34 offen offset:3072 sc1
    s_add_u32 s34, s34, 4096
    v_mfma_f32_16x16x32_bf16 v[80:83], a[116:119], v[44:47], v[80:83]
    v_mfma_f32_16x16x32_bf16 v[84:87], a[116:119], v[48:51], v[84:87]
    buffer_load_dwordx4 a[128:131], v253, s[8:11], s32 offen offset:0 sc1
    v_mfma_f32_16x16x32_bf16 v[88:91], a[116:119], v[52:55], v[88:91]
    v_mfma_f32_16x16x32_bf16 v[92:95], v[36:39], a[120:123], v[92:95]
    buffer_load_dwordx4 a[132:135], v253, s[8:11], s33 offen offset:0 sc1
    v_mfma_f32_16x16x32_bf16 v[96:99], v[40:43], a[120:123], v[96:99]
    v_mfma_f32_16x16x32_bf16 v[100:103], v[44:47], a[120:123], v[100:103]
    buffer_load_dwordx4 a[136:139], v5, s[8:11], s34 offen offset:0 sc1
    v_mfma_f32_16x16x32_bf16 v[104:107], v[48:51], a[120:123], v[104:107]
    v_mfma_f32_16x16x32_bf16 v[108:111], v[52:55], a[120:123], v[108:111]
    v_mfma_f32_16x16x32_bf16 v[112:115], a[124:127], v[36:39], v[112:115]
    v_mfma_f32_16x16x32_bf16 v[116:119], a[124:127], v[40:43], v[116:119]
    v_mfma_f32_16x16x32_bf16 v[120:123], a[124:127], v[44:47], v[120:123]
    v_mfma_f32_16x16x32_bf16 v[124:127], a[124:127], v[48:51], v[124:127]
    v_mfma_f32_16x16x32_bf16 v[128:131], a[124:127], v[52:55], v[128:131]
    v_cvt_pk_bf16_f32 v136, v56, v57
    v_cvt_pk_bf16_f32 v137, v58, v59
    v_cvt_pk_bf16_f32 v140, v60, v61
    v_cvt_pk_bf16_f32 v141, v62, v63
    v_cvt_pk_bf16_f32 v144, v64, v65
    v_cvt_pk_bf16_f32 v145, v66, v67
    v_cvt_pk_bf16_f32 v148, v68, v69
    v_cvt_pk_bf16_f32 v149, v70, v71
    v_cvt_pk_bf16_f32 v152, v72, v73
    buffer_load_dwordx4 a[140:143], v253, s[8:11], s32 offen offset:1024 sc1
    v_cvt_pk_bf16_f32 v153, v74, v75
    v_cvt_pk_bf16_f32 v156, v76, v77
    v_cvt_pk_bf16_f32 v157, v78, v79
    v_cvt_pk_bf16_f32 v160, v80, v81
    v_cvt_pk_bf16_f32 v161, v82, v83
    v_cvt_pk_bf16_f32 v164, v84, v85
    v_cvt_pk_bf16_f32 v165, v86, v87
    v_cvt_pk_bf16_f32 v168, v88, v89
    v_cvt_pk_bf16_f32 v169, v90, v91
    buffer_load_dwordx4 a[144:147], v253, s[8:11], s33 offen offset:1024 sc1
    v_cvt_pk_bf16_f32 v134, v112, v113
    v_cvt_pk_bf16_f32 v154, v114, v115
    v_cvt_pk_bf16_f32 v138, v116, v117
    v_cvt_pk_bf16_f32 v158, v118, v119
    v_cvt_pk_bf16_f32 v142, v120, v121
    v_cvt_pk_bf16_f32 v162, v122, v123
    v_cvt_pk_bf16_f32 v146, v124, v125
    v_cvt_pk_bf16_f32 v166, v126, v127
    v_cvt_pk_bf16_f32 v150, v128, v129
    buffer_load_dwordx4 a[148:151], v5, s[8:11], s34 offen offset:1024 sc1
    v_cvt_pk_bf16_f32 v170, v130, v131
    v_cvt_pk_bf16_f32 v172, v92, v93
    v_cvt_pk_bf16_f32 v173, v94, v95
    v_cvt_pk_bf16_f32 v174, v96, v97
    v_cvt_pk_bf16_f32 v175, v98, v99
    v_cvt_pk_bf16_f32 v176, v100, v101
    v_cvt_pk_bf16_f32 v177, v102, v103
    v_cvt_pk_bf16_f32 v178, v104, v105
    v_cvt_pk_bf16_f32 v179, v106, v107
    buffer_load_dwordx4 a[152:155], v253, s[8:11], s32 offen offset:2048 sc1
    v_cvt_pk_bf16_f32 v180, v108, v109
    v_cvt_pk_bf16_f32 v181, v110, v111
    v_mfma_f32_16x16x32_bf16 v[16:19], v[152:155], v[136:139], v[208:211]
    v_mfma_f32_16x16x32_bf16 v[20:23], v[156:159], v[136:139], v[204:207]
    v_mfma_f32_16x16x32_bf16 v[24:27], v[156:159], v[140:143], v[200:203]
    v_mfma_f32_16x16x32_bf16 v[28:31], v[160:163], v[140:143], v[204:207]
    v_mfma_f32_16x16x32_bf16 v[32:35], v[160:163], v[144:147], v[200:203]
    v_mfma_f32_16x16x32_bf16 v[36:39], v[164:167], v[144:147], v[204:207]
    v_mfma_f32_16x16x32_bf16 v[40:43], v[164:167], v[148:151], v[200:203]
    buffer_load_dwordx4 a[156:159], v253, s[8:11], s33 offen offset:2048 sc1
    v_mfma_f32_16x16x32_bf16 v[44:47], v[168:171], v[148:151], v[204:207]
    v_mfma_f32_16x16x32_bf16 v[56:59], v[132:135], v[192:195], v[196:199]
    v_mfma_f32_16x16x32_bf16 v[60:63], v[136:139], v[192:195], v[196:199]
    v_mfma_f32_16x16x32_bf16 v[64:67], v[140:143], v[192:195], v[196:199]
    v_mfma_f32_16x16x32_bf16 v[68:71], v[144:147], v[192:195], v[196:199]
    v_mfma_f32_16x16x32_bf16 v[72:75], v[148:151], v[192:195], v[196:199]
    v_max3_f32 v92, v16, v17, v18
    v_max3_f32 v96, v19, v20, v21
    v_max3_f32 v93, v24, v25, v26
    buffer_load_dwordx4 a[0:3], v5, s[8:11], s34 offen offset:2048 sc1
    v_max3_f32 v97, v27, v28, v29
    v_max3_f32 v94, v32, v33, v34
    v_max3_f32 v98, v35, v36, v37
    v_max3_f32 v95, v40, v41, v42
    v_max3_f32 v99, v43, v44, v45
    v_max3_f32 v92, v92, v22, v23
    v_max3_f32 v93, v93, v30, v31
    v_max3_f32 v94, v94, v38, v39
    v_max3_f32 v95, v95, v46, v47
    buffer_load_dwordx4 a[4:7], v253, s[8:11], s32 offen offset:3072 sc1
    s_add_u32 s32, s32, 4096
    v_max_f32 v92, v92, v96
    v_max_f32 v93, v93, v97
    v_max_f32 v94, v94, v98
    v_max_f32 v95, v95, v99
    s_mov_b32 s18, 0x3eae1a93
    v_cvt_pk_bf16_f32 v182, v56, v57
    v_permlane32_swap_b32 v92, v93
    v_permlane32_swap_b32 v94, v95
    v_max_f32 v92, v92, v93
    buffer_load_dwordx4 a[8:11], v253, s[8:11], s33 offen offset:3072 sc1
    s_add_u32 s33, s33, 4096
    v_max_f32 v94, v94, v95
    v_cvt_pk_bf16_f32 v183, v58, v59
    v_cvt_pk_bf16_f32 v184, v60, v61
    v_permlane16_swap_b32 v92, v94
    v_max_f32 v92, v92, v94
    v_mul_f32 v92, 0xbeae1a93, v92
    v_mov_b32 v94, v92
    v_cvt_pk_bf16_f32 v185, v62, v63
    v_cvt_pk_bf16_f32 v186, v64, v65
    buffer_load_dwordx4 a[12:15], v5, s[8:11], s34 offen offset:3072 sc1
    s_add_u32 s34, s34, 4096
    v_permlane16_swap_b32 v92, v94
    v_mov_b32 v93, v92
    v_mov_b32 v95, v94
    v_cvt_pk_bf16_f32 v187, v66, v67
    v_cvt_pk_bf16_f32 v188, v68, v69
    v_permlane32_swap_b32 v92, v93
    v_permlane32_swap_b32 v94, v95
    v_cvt_pk_bf16_f32 v189, v70, v71
    v_cvt_pk_bf16_f32 v190, v72, v73
    buffer_load_dwordx4 a[16:19], v253, s[8:11], s32 offen offset:0 sc1
    v_cvt_pk_bf16_f32 v191, v74, v75
    v_fma_f32 v16, v16, s18, v92
    v_fma_f32 v17, v17, s18, v92
    v_fma_f32 v18, v18, s18, v92
    v_fma_f32 v19, v19, s18, v92
    v_fma_f32 v20, v20, s18, v92
    v_fma_f32 v21, v21, s18, v92
    v_fma_f32 v22, v22, s18, v92
    v_fma_f32 v23, v23, s18, v92
    buffer_load_dwordx4 a[20:23], v253, s[8:11], s33 offen offset:0 sc1
    v_exp_f32 v16, v16
    v_exp_f32 v17, v17
    v_exp_f32 v18, v18
    v_exp_f32 v19, v19
    v_exp_f32 v20, v20
    v_exp_f32 v21, v21
    v_exp_f32 v22, v22
    v_exp_f32 v23, v23
    s_nop 0
    buffer_load_dwordx4 a[24:27], v5, s[8:11], s34 offen offset:0 sc1
    v_cvt_pk_bf16_f32 v76, v16, v17
    v_cvt_pk_bf16_f32 v77, v18, v19
    v_cvt_pk_bf16_f32 v78, v20, v21
    v_cvt_pk_bf16_f32 v79, v22, v23
    v_fma_f32 v24, v24, s18, v93
    v_fma_f32 v25, v25, s18, v93
    v_fma_f32 v26, v26, s18, v93
    v_fma_f32 v27, v27, s18, v93
    v_fma_f32 v28, v28, s18, v93
    buffer_load_dwordx4 a[28:31], v253, s[8:11], s32 offen offset:1024 sc1
    v_fma_f32 v29, v29, s18, v93
    v_fma_f32 v30, v30, s18, v93
    v_fma_f32 v31, v31, s18, v93
    v_exp_f32 v24, v24
    v_exp_f32 v25, v25
    v_exp_f32 v26, v26
    v_exp_f32 v27, v27
    v_exp_f32 v28, v28
    v_exp_f32 v29, v29
    buffer_load_dwordx4 a[32:35], v253, s[8:11], s33 offen offset:1024 sc1
    v_exp_f32 v30, v30
    v_exp_f32 v31, v31
    v_mfma_f32_16x16x32_bf16 v[100:103], v[172:175], v[76:79], 0
    v_mfma_f32_16x16x32_bf16 v[116:119], v[182:185], v[76:79], 0
    v_cvt_pk_bf16_f32 v80, v24, v25
    v_cvt_pk_bf16_f32 v81, v26, v27
    v_cvt_pk_bf16_f32 v82, v28, v29
    v_cvt_pk_bf16_f32 v83, v30, v31
    v_fma_f32 v32, v32, s18, v94
    buffer_load_dwordx4 a[36:39], v5, s[8:11], s34 offen offset:1024 sc1
    v_fma_f32 v33, v33, s18, v94
    v_fma_f32 v34, v34, s18, v94
    v_fma_f32 v35, v35, s18, v94
    v_fma_f32 v36, v36, s18, v94
    v_fma_f32 v37, v37, s18, v94
    v_fma_f32 v38, v38, s18, v94
    v_fma_f32 v39, v39, s18, v94
    v_exp_f32 v32, v32
    v_exp_f32 v33, v33
    buffer_load_dwordx4 a[40:43], v253, s[8:11], s32 offen offset:2048 sc1
    v_exp_f32 v34, v34
    v_exp_f32 v35, v35
    v_exp_f32 v36, v36
    v_exp_f32 v37, v37
    v_exp_f32 v38, v38
    v_exp_f32 v39, v39
    v_mfma_f32_16x16x32_bf16 v[104:107], v[174:177], v[80:83], 0
    v_mfma_f32_16x16x32_bf16 v[120:123], v[184:187], v[80:83], 0
    v_cvt_pk_bf16_f32 v84, v32, v33
    buffer_load_dwordx4 a[44:47], v253, s[8:11], s33 offen offset:2048 sc1
    v_cvt_pk_bf16_f32 v85, v34, v35
    v_cvt_pk_bf16_f32 v86, v36, v37
    v_cvt_pk_bf16_f32 v87, v38, v39
    v_fma_f32 v40, v40, s18, v95
    v_fma_f32 v41, v41, s18, v95
    v_fma_f32 v42, v42, s18, v95
    v_fma_f32 v43, v43, s18, v95
    v_fma_f32 v44, v44, s18, v95
    v_fma_f32 v45, v45, s18, v95
    buffer_load_dwordx4 a[48:51], v5, s[8:11], s34 offen offset:2048 sc1
    v_fma_f32 v46, v46, s18, v95
    v_fma_f32 v47, v47, s18, v95
    v_exp_f32 v40, v40
    v_exp_f32 v41, v41
    v_exp_f32 v42, v42
    v_exp_f32 v43, v43
    v_exp_f32 v44, v44
    v_exp_f32 v45, v45
    v_exp_f32 v46, v46
    buffer_load_dwordx4 a[52:55], v253, s[8:11], s32 offen offset:3072 sc1
    s_add_u32 s32, s32, 4096
    v_exp_f32 v47, v47
    v_mfma_f32_16x16x32_bf16 v[108:111], v[176:179], v[84:87], 0
    v_mfma_f32_16x16x32_bf16 v[124:127], v[186:189], v[84:87], 0
    v_cvt_pk_bf16_f32 v88, v40, v41
    v_cvt_pk_bf16_f32 v89, v42, v43
    v_cvt_pk_bf16_f32 v90, v44, v45
    v_cvt_pk_bf16_f32 v91, v46, v47
    v_rcp_f32 v96, v118
    v_rcp_f32 v97, v122
    buffer_load_dwordx4 v[240:243], v9, s[8:11], s37 offen offset:0 sc1
    v_mfma_f32_16x16x32_bf16 v[112:115], v[178:181], v[88:91], 0
    v_mfma_f32_16x16x32_bf16 v[128:131], v[188:191], v[88:91], 0
    v_pk_mul_f32 v[100:101], v[96:97], v[100:101] op_sel:[0,0] op_sel_hi:[0,1]
    v_pk_mul_f32 v[102:103], v[96:97], v[102:103] op_sel:[0,0] op_sel_hi:[0,1]
    v_pk_mul_f32 v[116:117], v[96:97], v[116:117] op_sel:[0,0] op_sel_hi:[0,1]
    v_cvt_pk_bf16_f32 v212, v100, v101
    v_cvt_pk_bf16_f32 v213, v102, v103
    v_cvt_pk_bf16_f32 v220, v116, v117
    v_rcp_f32 v98, v126
    buffer_load_dwordx4 v[244:247], v9, s[8:11], s37 offen offset:1024 sc1
    v_pk_mul_f32 v[104:105], v[96:97], v[104:105] op_sel:[1,0] op_sel_hi:[1,1]
    v_pk_mul_f32 v[106:107], v[96:97], v[106:107] op_sel:[1,0] op_sel_hi:[1,1]
    v_pk_mul_f32 v[120:121], v[96:97], v[120:121] op_sel:[1,0] op_sel_hi:[1,1]
    v_cvt_pk_bf16_f32 v214, v104, v105
    v_cvt_pk_bf16_f32 v215, v106, v107
    v_cvt_pk_bf16_f32 v221, v120, v121
    v_rcp_f32 v99, v130
    v_permlane16_swap_b32 v212, v214
    v_permlane16_swap_b32 v213, v215
    buffer_load_dwordx4 v[248:251], v7, s[8:11], s37 offen offset:2048 sc1
    v_pk_mul_f32 v[108:109], v[98:99], v[108:109] op_sel:[0,0] op_sel_hi:[0,1]
    v_pk_mul_f32 v[110:111], v[98:99], v[110:111] op_sel:[0,0] op_sel_hi:[0,1]
    v_pk_mul_f32 v[124:125], v[98:99], v[124:125] op_sel:[0,0] op_sel_hi:[0,1]
    v_cvt_pk_bf16_f32 v216, v108, v109
    v_cvt_pk_bf16_f32 v217, v110, v111
    v_cvt_pk_bf16_f32 v222, v124, v125
    v_pk_mul_f32 v[112:113], v[98:99], v[112:113] op_sel:[1,0] op_sel_hi:[1,1]
    v_pk_mul_f32 v[114:115], v[98:99], v[114:115] op_sel:[1,0] op_sel_hi:[1,1]
    v_pk_mul_f32 v[128:129], v[98:99], v[128:129] op_sel:[1,0] op_sel_hi:[1,1]
    buffer_load_dword v252, v8, s[8:11], s47 offen sc1
    v_cvt_pk_bf16_f32 v218, v112, v113
    v_cvt_pk_bf16_f32 v219, v114, v115
    v_cvt_pk_bf16_f32 v223, v128, v129
    s_lshl_b32 s7, s3, 2
    s_add_u32 s7, s7, 94208
    v_permlane16_swap_b32 v220, v221
    v_permlane16_swap_b32 v222, v223
    v_add_u32 v11, s7, v253
    v_lshrrev_b32 v10, 3, v0
    v_permlane32_swap_b32 v220, v222
    v_mul_u32_u24 v10, 9216, v10
    ds_write_b32 v11, v220
    v_permlane16_swap_b32 v216, v218
    v_permlane16_swap_b32 v217, v219
    s_mul_i32 s7, s40, 1152
    s_add_u32 s22, s22, s7
    s_add_u32 s22, s22, 41156608
    s_lshl_b32 s7, s3, 8
    s_add_u32 s23, s22, s7
    s_add_u32 s24, s23, 36864
    buffer_store_dwordx4 v[212:215], v9, s[8:11], s23 offen sc1
    buffer_store_dwordx4 v[216:219], v9, s[8:11], s24 offen sc1
    v_and_b32 v11, 7, v0
    v_lshl_add_u32 v10, v11, 4, v10
    s_cmp_eq_u32 s3, 3
    s_cselect_b32 s7, 0, 1073741824
    v_add_u32 v10, s7, v10
    v_add_u32 v11, 94208, v253
    s_waitcnt lgkmcnt(0)
    s_barrier
    ds_read_b128 v[220:223], v11
    s_waitcnt lgkmcnt(0)
    buffer_store_dwordx4 v[220:223], v10, s[8:11], s22 offen offset:1024 sc1
    v_lshlrev_b32 v15, 7, v0
    s_lshl_b32 s6, s40, 2
    s_add_u32 s6, s6, s44
    v_mov_b32 v1, s76
    s_mov_b64 vcc, 0xff
    s_waitcnt vmcnt(0)
    s_barrier
    s_cmp_lg_u32 s3, 0
    s_cbranch_scc1 L_pub_17
    s_mov_b64 exec, vcc
    buffer_store_dword v1, v15, s[8:11], s6 offen sc1
L_pub_17:
    s_mov_b64 exec, -1
    buffer_load_dwordx4 a[56:59], v253, s[8:11], s33 offen offset:3072 sc1
    s_add_u32 s33, s33, 4096
    buffer_load_dwordx4 a[60:63], v5, s[8:11], s34 offen offset:3072 sc1
    s_add_u32 s34, s34, 4096
    buffer_load_dwordx4 a[64:67], v253, s[8:11], s32 offen offset:0 sc1
    buffer_load_dwordx4 a[68:71], v253, s[8:11], s33 offen offset:0 sc1
    buffer_load_dwordx4 a[72:75], v5, s[8:11], s34 offen offset:0 sc1
    buffer_load_dwordx4 a[76:79], v253, s[8:11], s32 offen offset:1024 sc1
    buffer_load_dwordx4 a[80:83], v253, s[8:11], s33 offen offset:1024 sc1
    buffer_load_dwordx4 a[84:87], v5, s[8:11], s34 offen offset:1024 sc1
    s_cmp_lg_u32 s42, 0
    s_cbranch_scc1 L_swz_18
    s_cmp_eq_u32 s93, 2
    s_cselect_b32 s6, 2, 3
    s_mov_b32 s7, 512
    s_cmov_b32 s7, 2048
    v_lshrrev_b32 v14, 4, v0
    v_lshlrev_b32 v14, s6, v14
    v_bfe_u32 v15, v0, 2, 2
    v_add_u32 v14, v14, v15
    v_mul_u32_u24 v14, 128, v14
    v_and_b32 v15, 3, v0
    v_lshl_add_u32 v14, v15, 3, v14
    v_add_u32 v14, s79, v14
    v_add_u32 v15, s7, v14
    ds_read_b64_tr_b16 v[76:77], v14 offset:0
    ds_read_b64_tr_b16 v[78:79], v15 offset:0
    ds_read_b64_tr_b16 v[80:81], v14 offset:32
    ds_read_b64_tr_b16 v[82:83], v15 offset:32
    ds_read_b64_tr_b16 v[84:85], v14 offset:64
    ds_read_b64_tr_b16 v[86:87], v15 offset:64
    ds_read_b64_tr_b16 v[88:89], v14 offset:96
    ds_read_b64_tr_b16 v[90:91], v15 offset:96
    ds_read_b64_tr_b16 v[92:93], v14 offset:4096
    ds_read_b64_tr_b16 v[94:95], v15 offset:4096
    ds_read_b64_tr_b16 v[96:97], v14 offset:4128
    ds_read_b64_tr_b16 v[98:99], v15 offset:4128
    ds_read_b64_tr_b16 v[176:177], v14 offset:4160
    ds_read_b64_tr_b16 v[178:179], v15 offset:4160
    ds_read_b64_tr_b16 v[180:181], v14 offset:4192
    ds_read_b64_tr_b16 v[182:183], v15 offset:4192
    ds_read_b64_tr_b16 v[196:197], v14 offset:8192
    ds_read_b64_tr_b16 v[198:199], v15 offset:8192
    ds_read_b64_tr_b16 v[200:201], v14 offset:8224
    ds_read_b64_tr_b16 v[202:203], v15 offset:8224
    ds_read_b64_tr_b16 v[204:205], v14 offset:8256
    ds_read_b64_tr_b16 v[206:207], v15 offset:8256
    ds_read_b64_tr_b16 v[208:209], v14 offset:8288
    ds_read_b64_tr_b16 v[210:211], v15 offset:8288
    ds_read_b64_tr_b16 v[212:213], v14 offset:12288
    ds_read_b64_tr_b16 v[214:215], v15 offset:12288
    ds_read_b64_tr_b16 v[216:217], v14 offset:12320
    ds_read_b64_tr_b16 v[218:219], v15 offset:12320
    ds_read_b64_tr_b16 v[220:221], v14 offset:12352
    ds_read_b64_tr_b16 v[222:223], v15 offset:12352
    ds_read_b64_tr_b16 v[228:229], v14 offset:12384
    ds_read_b64_tr_b16 v[230:231], v15 offset:12384
    s_mul_i32 s68, s40, 1990656
    s_add_u32 s68, s68, 3145728
    s_cmp_eq_u32 s93, 2
    s_cbranch_scc1 L_swz_down_19
    s_mul_i32 s6, s84, 349526
    s_lshr_b32 s6, s6, 20
    s_mul_i32 s7, s6, 3
    s_sub_u32 s7, s84, s7
    s_mul_i32 s6, s6, 6
    s_add_u32 s7, s7, s6
    s_mul_i32 s6, s88, 36
    s_add_u32 s7, s7, s6
    s_mul_i32 s6, s93, 3
    s_add_u32 s7, s7, s6
    s_lshl_b32 s7, s7, 10
    s_add_u32 s7, s7, s68
    s_add_u32 s80, s7, 0
    s_add_u32 s81, s7, 497664
    s_add_u32 s82, s7, 995328
    s_add_u32 s83, s7, 1492992
    s_mul_i32 s6, s85, 349526
    s_lshr_b32 s6, s6, 20
    s_mul_i32 s7, s6, 3
    s_sub_u32 s7, s85, s7
    s_mul_i32 s6, s6, 6
    s_add_u32 s7, s7, s6
    s_mul_i32 s6, s89, 36
    s_add_u32 s7, s7, s6
    s_mul_i32 s6, s93, 3
    s_add_u32 s7, s7, s6
    s_lshl_b32 s7, s7, 10
    s_add_u32 s7, s7, s68
    s_add_u32 s64, s7, 0
    s_add_u32 s65, s7, 497664
    s_add_u32 s18, s7, 995328
    s_add_u32 s19, s7, 1492992
    s_mul_i32 s6, s86, 349526
    s_lshr_b32 s6, s6, 20
    s_mul_i32 s7, s6, 3
    s_sub_u32 s7, s86, s7
    s_mul_i32 s6, s6, 6
    s_add_u32 s7, s7, s6
    s_mul_i32 s6, s90, 36
    s_add_u32 s7, s7, s6
    s_mul_i32 s6, s93, 3
    s_add_u32 s7, s7, s6
    s_lshl_b32 s7, s7, 10
    s_add_u32 s7, s7, s68
    s_add_u32 s20, s7, 0
    s_add_u32 s21, s7, 497664
    s_add_u32 s22, s7, 995328
    s_add_u32 s25, s7, 1492992
    s_mul_i32 s6, s87, 349526
    s_lshr_b32 s6, s6, 20
    s_mul_i32 s7, s6, 3
    s_sub_u32 s7, s87, s7
    s_mul_i32 s6, s6, 6
    s_add_u32 s7, s7, s6
    s_mul_i32 s6, s91, 36
    s_add_u32 s7, s7, s6
    s_mul_i32 s6, s93, 3
    s_add_u32 s7, s7, s6
    s_lshl_b32 s7, s7, 10
    s_add_u32 s7, s7, s68
    s_add_u32 s26, s7, 0
    s_add_u32 s27, s7, 497664
    s_add_u32 s28, s7, 995328
    s_add_u32 s29, s7, 1492992
    s_branch L_swz_dest_20
L_swz_down_19:
    s_mul_i32 s7, s88, 18
    s_add_u32 s7, s7, s84
    s_add_u32 s7, s7, 324
    s_lshl_b32 s7, s7, 10
    s_add_u32 s7, s7, s68
    s_add_u32 s80, s7, 0
    s_add_u32 s81, s7, 497664
    s_add_u32 s82, s7, 995328
    s_add_u32 s83, s7, 1492992
    s_mul_i32 s7, s89, 18
    s_add_u32 s7, s7, s85
    s_add_u32 s7, s7, 324
    s_lshl_b32 s7, s7, 10
    s_add_u32 s7, s7, s68
    s_add_u32 s64, s7, 0
    s_add_u32 s65, s7, 497664
    s_add_u32 s18, s7, 995328
    s_add_u32 s19, s7, 1492992
    s_mul_i32 s7, s90, 18
    s_add_u32 s7, s7, s86
    s_add_u32 s7, s7, 324
    s_lshl_b32 s7, s7, 10
    s_add_u32 s7, s7, s68
    s_add_u32 s20, s7, 0
    s_add_u32 s21, s7, 497664
    s_add_u32 s22, s7, 995328
    s_add_u32 s25, s7, 1492992
    s_mul_i32 s7, s91, 18
    s_add_u32 s7, s7, s87
    s_add_u32 s7, s7, 324
    s_lshl_b32 s7, s7, 10
    s_add_u32 s7, s7, s68
    s_add_u32 s26, s7, 0
    s_add_u32 s27, s7, 497664
    s_add_u32 s28, s7, 995328
    s_add_u32 s29, s7, 1492992
L_swz_dest_20:
    s_mov_b32 s72, s8
    s_mov_b32 s73, s9
    s_mov_b32 s74, 268435456
    s_waitcnt lgkmcnt(0)
    buffer_store_dwordx4 v[76:79], v253, s[72:75], s80 offen sc1
    buffer_store_dwordx4 v[80:83], v253, s[72:75], s81 offen sc1
    buffer_store_dwordx4 v[84:87], v253, s[72:75], s82 offen sc1
    buffer_store_dwordx4 v[88:91], v253, s[72:75], s83 offen sc1
    buffer_store_dwordx4 v[92:95], v253, s[72:75], s64 offen sc1
    buffer_store_dwordx4 v[96:99], v253, s[72:75], s65 offen sc1
    buffer_store_dwordx4 v[176:179], v253, s[72:75], s18 offen sc1
    buffer_store_dwordx4 v[180:183], v253, s[72:75], s19 offen sc1
    buffer_store_dwordx4 v[196:199], v253, s[72:75], s20 offen sc1
    buffer_store_dwordx4 v[200:203], v253, s[72:75], s21 offen sc1
    buffer_store_dwordx4 v[204:207], v253, s[72:75], s22 offen sc1
    buffer_store_dwordx4 v[208:211], v253, s[72:75], s25 offen sc1
    buffer_store_dwordx4 v[212:215], v253, s[72:75], s26 offen sc1
    buffer_store_dwordx4 v[216:219], v253, s[72:75], s27 offen sc1
    buffer_store_dwordx4 v[220:223], v253, s[72:75], s28 offen sc1
    buffer_store_dwordx4 v[228:231], v253, s[72:75], s29 offen sc1
    s_lshr_b32 s7, s2, 3
    s_lshl_b32 s7, s7, 2
    s_add_u32 s7, s7, s3
    s_lshl_b32 s7, s7, 9
    v_lshrrev_b32 v1, 1, v253
    v_add_u32 v1, s7, v1
    buffer_load_dwordx2 v[14:15], v1, s[96:99], 0 offen
L_swz_18:
    s_and_b32 s7, s3, 1
    s_mul_i32 s7, s7, 18432
    s_add_u32 s24, s30, s7
    s_lshr_b32 s7, s3, 1
    s_lshl_b32 s7, s7, 9
    s_add_u32 s24, s24, s7
    s_add_u32 s24, s24, 41156608
    s_mov_b32 s16, 0xffff0000
    v_lshlrev_b32 v124, 16, v240
    v_and_b32 v125, s16, v240
    v_lshlrev_b32 v126, 16, v241
    v_and_b32 v127, s16, v241
    v_lshlrev_b32 v128, 16, v242
    v_and_b32 v129, s16, v242
    v_lshlrev_b32 v130, 16, v243
    v_and_b32 v131, s16, v243
    v_lshlrev_b32 v132, 16, v244
    v_and_b32 v133, s16, v244
    v_lshlrev_b32 v134, 16, v245
    v_and_b32 v135, s16, v245
    v_lshlrev_b32 v136, 16, v246
    v_and_b32 v137, s16, v246
    v_lshlrev_b32 v138, 16, v247
    v_and_b32 v139, s16, v247
    v_lshlrev_b32 v140, 16, v248
    v_and_b32 v141, s16, v248
    v_lshlrev_b32 v142, 16, v249
    v_and_b32 v143, s16, v249
    v_lshlrev_b32 v144, 16, v250
    v_and_b32 v145, s16, v250
    v_lshlrev_b32 v146, 16, v251
    v_and_b32 v147, s16, v251
    s_cmp_eq_u32 s3, 1
    s_cselect_b32 s7, 16, 0
    v_lshlrev_b32 v12, 2, v0
    v_cmp_gt_u32 vcc, s7, v0
    v_add_u32 v10, 40960, v12
    v_add_u32 v11, 41472, v12
    v_cndmask_b32 v10, v11, v10, vcc
    v_and_b32 v11, 0x7c, v12
    v_cmp_gt_u32 vcc, 32, v0
    v_mov_b32 v13, 1073741824
    s_and_b32 s7, s40, 3
    s_lshl_b32 s45, s45, 2
    v_cndmask_b32 v8, v13, v12, vcc
    s_add_u32 s6, s7, s3
    s_cmp_eq_u32 s6, 0
    s_cselect_b32 s6, 0, 1073741824
    v_add_u32 v6, s6, v8
    s_add_u32 s45, s45, s7
    s_lshl_b32 s45, s45, 2
    s_add_u32 s45, s45, s3
    s_lshl_b32 s45, s45, 7
    s_add_u32 s45, s45, s43
    s_add_u32 s45, s45, 48300032
    s_cmp_eq_u32 s3, 0
    s_cselect_b32 s35, 1.0, 0
    s_lshl_b32 s7, s40, 2
    s_add_u32 s7, s7, s3
    s_mul_i32 s23, s7, 497664
    s_add_u32 s23, s23, 3145728
    s_add_u32 s50, s23, 497664
    s_mul_i32 s50, s50, s42
    v_mov_b32 v184, v253
    v_add_u32 v185, 4096, v253
    v_add_u32 v186, 8192, v253
    v_add_u32 v187, 12288, v253
    v_add_u32 v188, 16384, v253
    v_add_u32 v189, 20480, v253
    v_add_u32 v190, 24576, v253
    v_add_u32 v191, 28672, v253
    v_add_u32 v192, 32768, v253
    s_cmp_lg_u32 s3, 3
    s_cbranch_scc1 L_pollout_23
    s_lshl_b32 s7, s40, 7
    s_add_u32 s7, s7, s44
    s_add_u32 s52, s4, s7
    s_addc_u32 s53, s5, 0
    s_mov_b32 s6, 0
L_poll_21:
    s_load_dwordx8 s[56:63], s[52:53], 0 glc
    s_add_u32 s6, s6, 1
    s_waitcnt lgkmcnt(0)
    s_xor_b64 s[56:57], s[56:57], s[76:77]
    s_xor_b64 s[58:59], s[58:59], s[76:77]
    s_xor_b64 s[60:61], s[60:61], s[76:77]
    s_xor_b64 s[62:63], s[62:63], s[76:77]
    s_or_b64 s[56:57], s[56:57], s[58:59]
    s_or_b64 s[60:61], s[60:61], s[62:63]
    s_or_b64 s[56:57], s[56:57], s[60:61]
    s_cbranch_scc0 L_polled_22
    s_cmp_lt_u32 s6, 1048576
    s_cbranch_scc1 L_poll_21
    s_branch L_main_end
L_polled_22:
L_pollout_23:
    s_barrier
    s_lshl_b32 m0, s3, 10
    s_nop 0
    buffer_load_dwordx4 v2, s[8:11], s24 offen sc1 lds
    s_add_u32 m0, m0, 4096
    s_add_u32 s24, s24, 1024
    buffer_load_dwordx4 v2, s[8:11], s24 offen sc1 lds
    s_add_u32 m0, m0, 4096
    s_add_u32 s24, s24, 1024
    buffer_load_dwordx4 v2, s[8:11], s24 offen sc1 lds
    s_add_u32 m0, m0, 4096
    s_add_u32 s24, s24, 1024
    buffer_load_dwordx4 v2, s[8:11], s24 offen sc1 lds
    s_add_u32 m0, m0, 4096
    s_add_u32 s24, s24, 1024
    buffer_load_dwordx4 v2, s[8:11], s24 offen sc1 lds
    s_add_u32 m0, m0, 4096
    s_add_u32 s24, s24, 1024
    buffer_load_dwordx4 v2, s[8:11], s24 offen sc1 lds
    s_add_u32 m0, m0, 4096
    s_add_u32 s24, s24, 1024
    buffer_load_dwordx4 v2, s[8:11], s24 offen sc1 lds
    s_add_u32 m0, m0, 4096
    s_add_u32 s24, s24, 1024
    buffer_load_dwordx4 v2, s[8:11], s24 offen sc1 lds
    s_add_u32 m0, m0, 4096
    s_add_u32 s24, s24, 1024
    buffer_load_dwordx4 v2, s[8:11], s24 offen sc1 lds
    s_waitcnt vmcnt(4)
    s_barrier
    ds_read_b128 v[160:163], v253 offset:0
    ds_read_b128 v[164:167], v253 offset:1024
    s_waitcnt lgkmcnt(0)
    v_mfma_f32_16x16x32_bf16 v[100:103], a[160:163], v[160:163], 0
    ds_read_b128 v[168:171], v253 offset:2048
    v_mfma_f32_16x16x32_bf16 v[104:107], a[160:163], v[164:167], 0
    ds_read_b128 v[172:175], v253 offset:3072
    v_mfma_f32_16x16x32_bf16 v[108:111], a[164:167], v[160:163], 0
    v_mfma_f32_16x16x32_bf16 v[112:115], a[164:167], v[164:167], 0
    buffer_load_dwordx4 v[16:19], v184, s[48:51], s23 offen offset:0 sc1
    v_mfma_f32_16x16x32_bf16 v[116:119], a[168:171], v[160:163], 0
    v_mfma_f32_16x16x32_bf16 v[120:123], a[168:171], v[164:167], 0
    s_waitcnt lgkmcnt(0)
    v_mfma_f32_16x16x32_bf16 v[100:103], a[172:175], v[168:171], v[100:103]
    ds_read_b128 v[160:163], v253 offset:4096
    v_mfma_f32_16x16x32_bf16 v[104:107], a[172:175], v[172:175], v[104:107]
    ds_read_b128 v[164:167], v253 offset:5120
    v_mfma_f32_16x16x32_bf16 v[108:111], a[176:179], v[168:171], v[108:111]
    v_mfma_f32_16x16x32_bf16 v[112:115], a[176:179], v[172:175], v[112:115]
    buffer_load_dwordx4 v[20:23], v184, s[48:51], s23 offen offset:1024 sc1
    v_mfma_f32_16x16x32_bf16 v[116:119], a[180:183], v[168:171], v[116:119]
    v_mfma_f32_16x16x32_bf16 v[120:123], a[180:183], v[172:175], v[120:123]
    s_waitcnt lgkmcnt(0)
    v_mfma_f32_16x16x32_bf16 v[100:103], a[184:187], v[160:163], v[100:103]
    ds_read_b128 v[168:171], v253 offset:6144
    v_mfma_f32_16x16x32_bf16 v[104:107], a[184:187], v[164:167], v[104:107]
    ds_read_b128 v[172:175], v253 offset:7168
    v_mfma_f32_16x16x32_bf16 v[108:111], a[188:191], v[160:163], v[108:111]
    v_mfma_f32_16x16x32_bf16 v[112:115], a[188:191], v[164:167], v[112:115]
    buffer_load_dwordx4 v[24:27], v184, s[48:51], s23 offen offset:2048 sc1
    v_mfma_f32_16x16x32_bf16 v[116:119], a[192:195], v[160:163], v[116:119]
    v_mfma_f32_16x16x32_bf16 v[120:123], a[192:195], v[164:167], v[120:123]
    s_waitcnt lgkmcnt(0)
    v_mfma_f32_16x16x32_bf16 v[100:103], a[196:199], v[168:171], v[100:103]
    ds_read_b128 v[160:163], v253 offset:8192
    v_mfma_f32_16x16x32_bf16 v[104:107], a[196:199], v[172:175], v[104:107]
    ds_read_b128 v[164:167], v253 offset:9216
    v_mfma_f32_16x16x32_bf16 v[108:111], a[200:203], v[168:171], v[108:111]
    v_mfma_f32_16x16x32_bf16 v[112:115], a[200:203], v[172:175], v[112:115]
    buffer_load_dwordx4 v[28:31], v184, s[48:51], s23 offen offset:3072 sc1
    v_mfma_f32_16x16x32_bf16 v[116:119], a[204:207], v[168:171], v[116:119]
    v_mfma_f32_16x16x32_bf16 v[120:123], a[204:207], v[172:175], v[120:123]
    s_waitcnt lgkmcnt(0)
    v_mfma_f32_16x16x32_bf16 v[100:103], a[208:211], v[160:163], v[100:103]
    ds_read_b128 v[168:171], v253 offset:10240
    v_mfma_f32_16x16x32_bf16 v[104:107], a[208:211], v[164:167], v[104:107]
    ds_read_b128 v[172:175], v253 offset:11264
    v_mfma_f32_16x16x32_bf16 v[108:111], a[212:215], v[160:163], v[108:111]
    v_mfma_f32_16x16x32_bf16 v[112:115], a[212:215], v[164:167], v[112:115]
    buffer_load_dwordx4 v[32:35], v185, s[48:51], s23 offen offset:0 sc1
    v_mfma_f32_16x16x32_bf16 v[116:119], a[216:219], v[160:163], v[116:119]
    v_mfma_f32_16x16x32_bf16 v[120:123], a[216:219], v[164:167], v[120:123]
    s_waitcnt lgkmcnt(0)
    v_mfma_f32_16x16x32_bf16 v[100:103], a[220:223], v[168:171], v[100:103]
    ds_read_b128 v[160:163], v253 offset:12288
    v_mfma_f32_16x16x32_bf16 v[104:107], a[220:223], v[172:175], v[104:107]
    ds_read_b128 v[164:167], v253 offset:13312
    v_mfma_f32_16x16x32_bf16 v[108:111], a[224:227], v[168:171], v[108:111]
    v_mfma_f32_16x16x32_bf16 v[112:115], a[224:227], v[172:175], v[112:115]
    buffer_load_dwordx4 v[36:39], v185, s[48:51], s23 offen offset:1024 sc1
    v_mfma_f32_16x16x32_bf16 v[116:119], a[228:231], v[168:171], v[116:119]
    v_mfma_f32_16x16x32_bf16 v[120:123], a[228:231], v[172:175], v[120:123]
    s_waitcnt lgkmcnt(0)
    v_mfma_f32_16x16x32_bf16 v[100:103], a[232:235], v[160:163], v[100:103]
    ds_read_b128 v[168:171], v253 offset:14336
    v_mfma_f32_16x16x32_bf16 v[104:107], a[232:235], v[164:167], v[104:107]
    ds_read_b128 v[172:175], v253 offset:15360
    v_mfma_f32_16x16x32_bf16 v[108:111], a[236:239], v[160:163], v[108:111]
    v_mfma_f32_16x16x32_bf16 v[112:115], a[236:239], v[164:167], v[112:115]
    buffer_load_dwordx4 v[40:43], v185, s[48:51], s23 offen offset:2048 sc1
    v_mfma_f32_16x16x32_bf16 v[116:119], a[240:243], v[160:163], v[116:119]
    v_mfma_f32_16x16x32_bf16 v[120:123], a[240:243], v[164:167], v[120:123]
    s_waitcnt lgkmcnt(0)
    v_mfma_f32_16x16x32_bf16 v[100:103], a[244:247], v[168:171], v[100:103]
    ds_read_b128 v[160:163], v253 offset:16384
    v_mfma_f32_16x16x32_bf16 v[104:107], a[244:247], v[172:175], v[104:107]
    ds_read_b128 v[164:167], v253 offset:17408
    v_mfma_f32_16x16x32_bf16 v[108:111], a[248:251], v[168:171], v[108:111]
    v_mfma_f32_16x16x32_bf16 v[112:115], a[248:251], v[172:175], v[112:115]
    buffer_load_dwordx4 v[44:47], v185, s[48:51], s23 offen offset:3072 sc1
    v_mfma_f32_16x16x32_bf16 v[116:119], a[252:255], v[168:171], v[116:119]
    v_mfma_f32_16x16x32_bf16 v[120:123], a[252:255], v[172:175], v[120:123]
    s_waitcnt lgkmcnt(0)
    v_mfma_f32_16x16x32_bf16 v[100:103], a[128:131], v[160:163], v[100:103]
    ds_read_b128 v[168:171], v253 offset:18432
    v_mfma_f32_16x16x32_bf16 v[104:107], a[128:131], v[164:167], v[104:107]
    ds_read_b128 v[172:175], v253 offset:19456
    v_mfma_f32_16x16x32_bf16 v[108:111], a[132:135], v[160:163], v[108:111]
    v_mfma_f32_16x16x32_bf16 v[112:115], a[132:135], v[164:167], v[112:115]
    buffer_load_dwordx4 v[48:51], v186, s[48:51], s23 offen offset:0 sc1
    v_mfma_f32_16x16x32_bf16 v[116:119], a[136:139], v[160:163], v[116:119]
    v_mfma_f32_16x16x32_bf16 v[120:123], a[136:139], v[164:167], v[120:123]
    s_waitcnt vmcnt(9) lgkmcnt(0)
    s_barrier
    s_xor_b32 s7, s3, 0
    s_or_b32 s7, s7, s42
    s_cbranch_scc1 L_swz_24
    v_lshlrev_b32 v15, 10, v0
    s_lshl_b32 s6, s40, 7
    s_lshl_b32 s7, s41, 2
    s_add_u32 s6, s6, s7
    s_add_u32 s6, s6, 19464192
    s_mov_b64 exec, 0xffffffff
    v_lshlrev_b32 v15, 10, v0
    v_mov_b32 v1, s76
    buffer_store_dword v1, v15, s[8:11], s6 offen sc1
    s_mov_b64 exec, -1
L_swz_24:
    v_mfma_f32_16x16x32_bf16 v[100:103], a[140:143], v[168:171], v[100:103]
    ds_read_b128 v[160:163], v253 offset:20480
    v_mfma_f32_16x16x32_bf16 v[104:107], a[140:143], v[172:175], v[104:107]
    ds_read_b128 v[164:167], v253 offset:21504
    v_mfma_f32_16x16x32_bf16 v[108:111], a[144:147], v[168:171], v[108:111]
    v_mfma_f32_16x16x32_bf16 v[112:115], a[144:147], v[172:175], v[112:115]
    buffer_load_dwordx4 v[52:55], v186, s[48:51], s23 offen offset:1024 sc1
    v_mfma_f32_16x16x32_bf16 v[116:119], a[148:151], v[168:171], v[116:119]
    v_mfma_f32_16x16x32_bf16 v[120:123], a[148:151], v[172:175], v[120:123]
    s_waitcnt lgkmcnt(0)
    v_mfma_f32_16x16x32_bf16 v[100:103], a[152:155], v[160:163], v[100:103]
    ds_read_b128 v[168:171], v253 offset:22528
    v_mfma_f32_16x16x32_bf16 v[104:107], a[152:155], v[164:167], v[104:107]
    ds_read_b128 v[172:175], v253 offset:23552
    v_mfma_f32_16x16x32_bf16 v[108:111], a[156:159], v[160:163], v[108:111]
    v_mfma_f32_16x16x32_bf16 v[112:115], a[156:159], v[164:167], v[112:115]
    buffer_load_dwordx4 v[56:59], v186, s[48:51], s23 offen offset:2048 sc1
    v_mfma_f32_16x16x32_bf16 v[116:119], a[0:3], v[160:163], v[116:119]
    v_mfma_f32_16x16x32_bf16 v[120:123], a[0:3], v[164:167], v[120:123]
    s_waitcnt lgkmcnt(0)
    v_mfma_f32_16x16x32_bf16 v[100:103], a[4:7], v[168:171], v[100:103]
    ds_read_b128 v[160:163], v253 offset:24576
    v_mfma_f32_16x16x32_bf16 v[104:107], a[4:7], v[172:175], v[104:107]
    ds_read_b128 v[164:167], v253 offset:25600
    v_mfma_f32_16x16x32_bf16 v[108:111], a[8:11], v[168:171], v[108:111]
    v_mfma_f32_16x16x32_bf16 v[112:115], a[8:11], v[172:175], v[112:115]
    buffer_load_dwordx4 v[60:63], v186, s[48:51], s23 offen offset:3072 sc1
    v_mfma_f32_16x16x32_bf16 v[116:119], a[12:15], v[168:171], v[116:119]
    v_mfma_f32_16x16x32_bf16 v[120:123], a[12:15], v[172:175], v[120:123]
    s_waitcnt lgkmcnt(0)
    v_mfma_f32_16x16x32_bf16 v[100:103], a[16:19], v[160:163], v[100:103]
    ds_read_b128 v[168:171], v253 offset:26624
    v_mfma_f32_16x16x32_bf16 v[104:107], a[16:19], v[164:167], v[104:107]
    ds_read_b128 v[172:175], v253 offset:27648
    v_mfma_f32_16x16x32_bf16 v[108:111], a[20:23], v[160:163], v[108:111]
    v_mfma_f32_16x16x32_bf16 v[112:115], a[20:23], v[164:167], v[112:115]
    buffer_load_dwordx4 v[64:67], v187, s[48:51], s23 offen offset:0 sc1
    v_mfma_f32_16x16x32_bf16 v[116:119], a[24:27], v[160:163], v[116:119]
    v_mfma_f32_16x16x32_bf16 v[120:123], a[24:27], v[164:167], v[120:123]
    s_waitcnt lgkmcnt(0)
    v_mfma_f32_16x16x32_bf16 v[100:103], a[28:31], v[168:171], v[100:103]
    ds_read_b128 v[160:163], v253 offset:28672
    v_mfma_f32_16x16x32_bf16 v[104:107], a[28:31], v[172:175], v[104:107]
    ds_read_b128 v[164:167], v253 offset:29696
    v_mfma_f32_16x16x32_bf16 v[108:111], a[32:35], v[168:171], v[108:111]
    v_mfma_f32_16x16x32_bf16 v[112:115], a[32:35], v[172:175], v[112:115]
    buffer_load_dwordx4 v[68:71], v187, s[48:51], s23 offen offset:1024 sc1
    v_mfma_f32_16x16x32_bf16 v[116:119], a[36:39], v[168:171], v[116:119]
    v_mfma_f32_16x16x32_bf16 v[120:123], a[36:39], v[172:175], v[120:123]
    s_waitcnt lgkmcnt(0)
    v_mfma_f32_16x16x32_bf16 v[100:103], a[40:43], v[160:163], v[100:103]
    ds_read_b128 v[168:171], v253 offset:30720
    v_mfma_f32_16x16x32_bf16 v[104:107], a[40:43], v[164:167], v[104:107]
    ds_read_b128 v[172:175], v253 offset:31744
    v_mfma_f32_16x16x32_bf16 v[108:111], a[44:47], v[160:163], v[108:111]
    v_mfma_f32_16x16x32_bf16 v[112:115], a[44:47], v[164:167], v[112:115]
    buffer_load_dwordx4 v[72:75], v187, s[48:51], s23 offen offset:2048 sc1
    v_mfma_f32_16x16x32_bf16 v[116:119], a[48:51], v[160:163], v[116:119]
    v_mfma_f32_16x16x32_bf16 v[120:123], a[48:51], v[164:167], v[120:123]
    s_waitcnt lgkmcnt(0)
    v_mfma_f32_16x16x32_bf16 v[100:103], a[52:55], v[168:171], v[100:103]
    ds_read_b128 v[160:163], v253 offset:32768
    v_mfma_f32_16x16x32_bf16 v[104:107], a[52:55], v[172:175], v[104:107]
    ds_read_b128 v[164:167], v253 offset:33792
    v_mfma_f32_16x16x32_bf16 v[108:111], a[56:59], v[168:171], v[108:111]
    v_mfma_f32_16x16x32_bf16 v[112:115], a[56:59], v[172:175], v[112:115]
    v_mfma_f32_16x16x32_bf16 v[116:119], a[60:63], v[168:171], v[116:119]
    v_mfma_f32_16x16x32_bf16 v[120:123], a[60:63], v[172:175], v[120:123]
    s_waitcnt lgkmcnt(0)
    v_mfma_f32_16x16x32_bf16 v[100:103], a[64:67], v[160:163], v[100:103]
    ds_read_b128 v[168:171], v253 offset:34816
    v_mfma_f32_16x16x32_bf16 v[104:107], a[64:67], v[164:167], v[104:107]
    ds_read_b128 v[172:175], v253 offset:35840
    v_mfma_f32_16x16x32_bf16 v[108:111], a[68:71], v[160:163], v[108:111]
    v_mfma_f32_16x16x32_bf16 v[112:115], a[68:71], v[164:167], v[112:115]
    v_mfma_f32_16x16x32_bf16 v[116:119], a[72:75], v[160:163], v[116:119]
    v_mfma_f32_16x16x32_bf16 v[120:123], a[72:75], v[164:167], v[120:123]
    s_waitcnt lgkmcnt(0)
    v_mfma_f32_16x16x32_bf16 v[100:103], a[76:79], v[168:171], v[100:103]
    v_mfma_f32_16x16x32_bf16 v[104:107], a[76:79], v[172:175], v[104:107]
    v_mfma_f32_16x16x32_bf16 v[108:111], a[80:83], v[168:171], v[108:111]
    v_mfma_f32_16x16x32_bf16 v[112:115], a[80:83], v[172:175], v[112:115]
    v_mfma_f32_16x16x32_bf16 v[116:119], a[84:87], v[168:171], v[116:119]
    v_mfma_f32_16x16x32_bf16 v[120:123], a[84:87], v[172:175], v[120:123]
    s_nop 3
    v_permlane16_swap_b32 v100, v104
    v_permlane16_swap_b32 v101, v105
    v_permlane16_swap_b32 v102, v106
    v_permlane16_swap_b32 v103, v107
    v_add_f32 v12, v116, v117
    v_add_f32 v13, v120, v121
    ds_write_b32 v10, v12
    ds_write_b32 v10, v13 offset:64
    v_permlane16_swap_b32 v108, v112
    v_permlane16_swap_b32 v109, v113
    v_permlane16_swap_b32 v110, v114
    v_permlane16_swap_b32 v111, v115
    v_permlane16_swap_b32 v116, v120
    v_permlane16_swap_b32 v117, v121
    v_permlane16_swap_b32 v118, v122
    v_permlane16_swap_b32 v119, v123
    s_waitcnt lgkmcnt(0)
    s_barrier
    ds_read_b32 v12, v11 offset:40960
    v_pk_add_f32 v[124:125], v[124:125], v[100:101]
    v_pk_add_f32 v[126:127], v[126:127], v[102:103]
    v_pk_add_f32 v[128:129], v[128:129], v[104:105]
    v_pk_add_f32 v[130:131], v[130:131], v[106:107]
    v_pk_add_f32 v[132:133], v[132:133], v[108:109]
    v_pk_add_f32 v[134:135], v[134:135], v[110:111]
    v_pk_add_f32 v[136:137], v[136:137], v[112:113]
    v_pk_add_f32 v[138:139], v[138:139], v[114:115]
    v_pk_add_f32 v[140:141], v[140:141], v[116:117]
    v_pk_add_f32 v[142:143], v[142:143], v[118:119]
    v_pk_add_f32 v[144:145], v[144:145], v[120:121]
    v_pk_add_f32 v[146:147], v[146:147], v[122:123]
    v_mov_b32 v14, 0
    v_mov_b32 v15, 0
    s_waitcnt lgkmcnt(0)
    v_add_f32 v12, v12, v252
    v_pk_add_f32 v[100:101], v[124:125], v[12:13] op_sel_hi:[1,0] neg_lo:[0,1] neg_hi:[0,1]
    v_pk_add_f32 v[102:103], v[126:127], v[12:13] op_sel_hi:[1,0] neg_lo:[0,1] neg_hi:[0,1]
    v_pk_add_f32 v[104:105], v[128:129], v[12:13] op_sel_hi:[1,0] neg_lo:[0,1] neg_hi:[0,1]
    v_pk_add_f32 v[106:107], v[130:131], v[12:13] op_sel_hi:[1,0] neg_lo:[0,1] neg_hi:[0,1]
    v_cvt_pk_bf16_f32 v148, v100, v101
    v_cvt_pk_bf16_f32 v149, v102, v103
    v_cvt_pk_bf16_f32 v150, v104, v105
    v_cvt_pk_bf16_f32 v151, v106, v107
    buffer_store_dwordx4 v[148:151], v9, s[8:11], s46 offen offset:0 sc1
    v_pk_add_f32 v[108:109], v[132:133], v[12:13] op_sel_hi:[1,0] neg_lo:[0,1] neg_hi:[0,1]
    v_pk_add_f32 v[110:111], v[134:135], v[12:13] op_sel_hi:[1,0] neg_lo:[0,1] neg_hi:[0,1]
    v_pk_add_f32 v[112:113], v[136:137], v[12:13] op_sel_hi:[1,0] neg_lo:[0,1] neg_hi:[0,1]
    v_pk_add_f32 v[114:115], v[138:139], v[12:13] op_sel_hi:[1,0] neg_lo:[0,1] neg_hi:[0,1]
    v_cvt_pk_bf16_f32 v152, v108, v109
    v_cvt_pk_bf16_f32 v153, v110, v111
    v_cvt_pk_bf16_f32 v154, v112, v113
    v_cvt_pk_bf16_f32 v155, v114, v115
    buffer_store_dwordx4 v[152:155], v9, s[8:11], s46 offen offset:1024 sc1
    v_pk_add_f32 v[116:117], v[140:141], v[12:13] op_sel_hi:[1,0] neg_lo:[0,1] neg_hi:[0,1]
    v_pk_add_f32 v[118:119], v[142:143], v[12:13] op_sel_hi:[1,0] neg_lo:[0,1] neg_hi:[0,1]
    v_pk_add_f32 v[120:121], v[144:145], v[12:13] op_sel_hi:[1,0] neg_lo:[0,1] neg_hi:[0,1]
    v_pk_add_f32 v[122:123], v[146:147], v[12:13] op_sel_hi:[1,0] neg_lo:[0,1] neg_hi:[0,1]
    v_cvt_pk_bf16_f32 v156, v116, v117
    v_cvt_pk_bf16_f32 v157, v118, v119
    v_cvt_pk_bf16_f32 v158, v120, v121
    v_cvt_pk_bf16_f32 v159, v122, v123
    buffer_store_dwordx4 v[156:159], v7, s[8:11], s46 offen offset:2048 sc1
    v_dot2c_f32_bf16 v14, v148, v148
    v_dot2c_f32_bf16 v14, v149, v149
    v_dot2c_f32_bf16 v14, v150, v150
    v_dot2c_f32_bf16 v14, v151, v151
    v_dot2c_f32_bf16 v14, v152, v152
    v_dot2c_f32_bf16 v14, v153, v153
    v_dot2c_f32_bf16 v14, v154, v154
    v_dot2c_f32_bf16 v14, v155, v155
    v_dot2c_f32_bf16 v15, v156, v156
    v_dot2c_f32_bf16 v15, v157, v157
    v_dot2c_f32_bf16 v15, v158, v158
    v_dot2c_f32_bf16 v15, v159, v159
    buffer_store_dword v12, v6, s[8:11], s36 offen sc1
    s_nop 1
    v_fma_f32 v14, v15, s35, v14
    v_mov_b32 v15, v14
    s_nop 1
    v_permlane32_swap_b32 v14, v15
    v_add_f32 v14, v14, v15
    buffer_store_dword v14, v8, s[8:11], s45 offen sc1
    v_lshlrev_b32 v15, 7, v0
    s_lshl_b32 s6, s40, 2
    s_add_u32 s6, s6, s44
    s_add_u32 s6, s6, 32768
    v_mov_b32 v1, s76
    s_mov_b64 vcc, 0xff
    s_waitcnt vmcnt(0)
    s_barrier
    s_cmp_lg_u32 s3, 0
    s_cbranch_scc1 L_pub_25
    s_mov_b64 exec, vcc
    buffer_store_dword v1, v15, s[8:11], s6 offen sc1
L_pub_25:
    s_mov_b64 exec, -1
    s_lshl_b32 s7, s41, 2
    s_add_u32 s7, s7, s3
    s_mul_i32 s22, s7, 18432
    s_add_u32 s22, s22, s43
    s_add_u32 s22, s22, 45875200
    s_mul_i32 s24, s3, 18432
    s_lshl_b32 s25, s41, 12
    s_add_u32 s25, s25, s43
    s_add_u32 s25, s25, 48300032
    v_lshrrev_b32 v3, 5, v0
    v_and_b32 v10, 31, v0
    v_lshlrev_b32 v10, 2, v10
    v_lshl_add_u32 v3, v3, 11, v10
    v_add_u32 v11, 36864, v184
    s_mov_b32 s16, 0xffff0000
    s_lshl_b32 s7, s3, 10
    v_add_u32 v172, s7, v253
    v_add_u32 v174, 5120, v172
    v_and_b32 v178, 7, v0
    v_mul_u32_u24 v178, 1152, v178
    v_lshrrev_b32 v179, 3, v0
    v_lshl_add_u32 v178, v179, 4, v178
    s_lshl_b32 s7, s3, 7
    v_add_u32 v175, s7, v178
    v_add_u32 v177, 640, v175
    s_cmp_eq_u32 s3, 0
    s_mov_b32 s17, 1073741824
    s_cmov_b32 s17, 4096
    v_add_u32 v173, s17, v172
    s_mov_b32 s17, 1073741824
    s_cmov_b32 s17, 512
    v_add_u32 v176, s17, v175
    s_lshl_b32 s21, s41, 3
    s_add_u32 s21, s21, s40
    s_mul_i32 s18, s21, 9216
    s_mul_i32 s20, s21, 73728
    s_add_u32 s20, s20, 19922944
    v_bfe_u32 v1, v0, 3, 2
    s_mov_b32 s7, 73728
    v_mul_lo_u32 v178, v1, s7
    v_lshrrev_b32 v1, 5, v0
    v_lshl_add_u32 v178, v1, 7, v178
    v_and_b32 v1, 7, v0
    v_lshl_add_u32 v178, v1, 4, v178
    v_add_u32 v179, 294912, v178
    v_lshrrev_b32 v1, 5, v0
    v_and_b32 v15, 7, v0
    v_lshlrev_b32 v15, 4, v15
    v_lshl_add_u32 v15, v1, 7, v15
    s_lshl_b32 s7, s3, 8
    s_add_u32 s7, s7, 3072
    v_add_u32 v15, s7, v15
    v_bfe_u32 v1, v0, 3, 2
    v_mov_b32 v182, 1073741824
    v_add_u32 v183, 14336, v253
    s_sub_u32 s7, s40, 0
    v_cmp_eq_u32 vcc, s7, v1
    s_nop 1
    v_cndmask_b32 v178, v178, v182, vcc
    v_cndmask_b32 v216, v183, v15, vcc
    v_cndmask_b32 v218, 0, 1, vcc
    v_lshlrev_b32 v218, 10, v218
    s_sub_u32 s7, s40, 4
    v_cmp_eq_u32 vcc, s7, v1
    s_nop 1
    v_cndmask_b32 v179, v179, v182, vcc
    v_cndmask_b32 v217, v183, v15, vcc
    v_cndmask_b32 v219, 0, 1, vcc
    v_lshlrev_b32 v219, 10, v219
    s_mul_i32 s26, s41, 589824
    s_mul_i32 s7, s40, 9216
    s_add_u32 s26, s26, s7
    s_lshl_b32 s7, s3, 8
    s_add_u32 s27, s26, s7
    s_add_u32 s27, s27, 19921920
    s_mov_b32 s74, 0
    s_mul_i32 s7, s42, 98304
    s_sub_u32 s29, s44, s7
    s_add_u32 s29, s29, 360448
    s_lshl_b32 s7, s40, 7
    s_add_u32 s7, s7, s29
    s_add_u32 s38, s4, s7
    s_addc_u32 s39, s5, 0
    s_lshl_b32 s7, s40, 2
    s_add_u32 s29, s29, s7
    s_add_u32 s50, s23, 497664
    s_cmp_lg_u32 s42, 0
    s_cbranch_scc1 L_ring_26
    s_cmp_lg_u32 s3, 0
    s_cbranch_scc1 L_ring_27
    s_lshl_b32 s7, s41, 3
    s_add_u32 s7, s7, s40
    s_lshl_b32 s7, s7, 7
    s_add_u32 s7, s7, 19464192
    s_add_u32 s68, s4, s7
    s_addc_u32 s69, s5, 0
    s_mov_b32 s6, 0
    s_mov_b32 s7, 0
L_cpoll_28:
    s_load_dwordx16 s[52:67], s[68:69], s7 glc
    s_add_u32 s6, s6, 1
    s_waitcnt lgkmcnt(0)
    s_xor_b64 s[52:53], s[52:53], s[76:77]
    s_xor_b64 s[54:55], s[54:55], s[76:77]
    s_xor_b64 s[56:57], s[56:57], s[76:77]
    s_xor_b64 s[58:59], s[58:59], s[76:77]
    s_xor_b64 s[60:61], s[60:61], s[76:77]
    s_xor_b64 s[62:63], s[62:63], s[76:77]
    s_xor_b64 s[64:65], s[64:65], s[76:77]
    s_xor_b64 s[66:67], s[66:67], s[76:77]
    s_or_b64 s[52:53], s[52:53], s[60:61]
    s_or_b64 s[54:55], s[54:55], s[62:63]
    s_or_b64 s[56:57], s[56:57], s[64:65]
    s_or_b64 s[58:59], s[58:59], s[66:67]
    s_or_b64 s[52:53], s[52:53], s[56:57]
    s_or_b64 s[54:55], s[54:55], s[58:59]
    s_or_b64 s[52:53], s[52:53], s[54:55]
    s_cbranch_scc1 L_cpoll_29
    s_add_u32 s7, s7, 64
    s_cmp_eq_u32 s7, 128
    s_cbranch_scc1 L_cpolled_30
L_cpoll_29:
    s_cmp_lt_u32 s6, 1048576
    s_cbranch_scc1 L_cpoll_28
    s_branch L_main_end
L_cpolled_30:
L_ring_27:
    s_barrier
    buffer_load_dwordx4 v[16:19], v184, s[48:51], s23 offen offset:0 sc1
    buffer_load_dwordx4 v[20:23], v184, s[48:51], s23 offen offset:1024 sc1
    buffer_load_dwordx4 v[24:27], v184, s[48:51], s23 offen offset:2048 sc1
    buffer_load_dwordx4 v[28:31], v184, s[48:51], s23 offen offset:3072 sc1
    buffer_load_dwordx4 v[32:35], v185, s[48:51], s23 offen offset:0 sc1
    buffer_load_dwordx4 v[36:39], v185, s[48:51], s23 offen offset:1024 sc1
    buffer_load_dwordx4 v[40:43], v185, s[48:51], s23 offen offset:2048 sc1
    buffer_load_dwordx4 v[44:47], v185, s[48:51], s23 offen offset:3072 sc1
    buffer_load_dwordx4 v[48:51], v186, s[48:51], s23 offen offset:0 sc1
    buffer_load_dwordx4 v[52:55], v186, s[48:51], s23 offen offset:1024 sc1
    buffer_load_dwordx4 v[56:59], v186, s[48:51], s23 offen offset:2048 sc1
    buffer_load_dwordx4 v[60:63], v186, s[48:51], s23 offen offset:3072 sc1
    buffer_load_dwordx4 v[64:67], v187, s[48:51], s23 offen offset:0 sc1
    buffer_load_dwordx4 v[68:71], v187, s[48:51], s23 offen offset:1024 sc1
    buffer_load_dwordx4 v[72:75], v187, s[48:51], s23 offen offset:2048 sc1
L_ring_26:
    s_cmp_lg_u32 s3, 3
    s_cbranch_scc1 L_pollout_33
    s_lshl_b32 s7, s40, 7
    s_add_u32 s7, s7, s44
    s_add_u32 s7, s7, 32768
    s_add_u32 s52, s4, s7
    s_addc_u32 s53, s5, 0
    s_mov_b32 s6, 0
L_poll_31:
    s_load_dwordx8 s[56:63], s[52:53], 0 glc
    s_add_u32 s6, s6, 1
    s_waitcnt lgkmcnt(0)
    s_xor_b64 s[56:57], s[56:57], s[76:77]
    s_xor_b64 s[58:59], s[58:59], s[76:77]
    s_xor_b64 s[60:61], s[60:61], s[76:77]
    s_xor_b64 s[62:63], s[62:63], s[76:77]
    s_or_b64 s[56:57], s[56:57], s[58:59]
    s_or_b64 s[60:61], s[60:61], s[62:63]
    s_or_b64 s[56:57], s[56:57], s[60:61]
    s_cbranch_scc0 L_polled_32
    s_cmp_lt_u32 s6, 1048576
    s_cbranch_scc1 L_poll_31
    s_branch L_main_end
L_polled_32:
L_pollout_33:
    s_barrier
    s_add_u32 m0, s24, 0
    s_nop 0
    buffer_load_dwordx4 v2, s[8:11], s22 offen offset:0 sc1 lds
    s_add_u32 m0, s24, 512
    s_nop 0
    buffer_load_dwordx4 v2, s[8:11], s22 offen offset:512 sc1 lds
    s_add_u32 m0, s24, 1024
    s_nop 0
    buffer_load_dwordx4 v2, s[8:11], s22 offen offset:1024 sc1 lds
    s_add_u32 m0, s24, 1536
    s_nop 0
    buffer_load_dwordx4 v2, s[8:11], s22 offen offset:1536 sc1 lds
    s_add_u32 m0, s24, 2048
    s_nop 0
    buffer_load_dwordx4 v2, s[8:11], s22 offen offset:2048 sc1 lds
    s_add_u32 m0, s24, 2560
    s_nop 0
    buffer_load_dwordx4 v2, s[8:11], s22 offen offset:2560 sc1 lds
    s_add_u32 m0, s24, 3072
    s_nop 0
    buffer_load_dwordx4 v2, s[8:11], s22 offen offset:3072 sc1 lds
    s_add_u32 m0, s24, 3584
    s_nop 0
    buffer_load_dwordx4 v2, s[8:11], s22 offen offset:3584 sc1 lds
    s_add_u32 m0, s24, 8192
    s_add_u32 s22, s22, 4096
    buffer_load_dwordx4 v2, s[8:11], s22 offen offset:0 sc1 lds
    s_add_u32 m0, s24, 8704
    s_nop 0
    buffer_load_dwordx4 v2, s[8:11], s22 offen offset:512 sc1 lds
    s_add_u32 m0, s24, 9216
    s_nop 0
    buffer_load_dwordx4 v2, s[8:11], s22 offen offset:1024 sc1 lds
    s_add_u32 m0, s24, 9728
    s_nop 0
    buffer_load_dwordx4 v2, s[8:11], s22 offen offset:1536 sc1 lds
    s_add_u32 s23, s23, 15360
    s_lshr_b32 s7, s3, 1
    s_lshl_b32 s7, s7, 10
    s_and_b32 s6, s3, 1
    s_lshl_b32 s6, s6, 3
    s_add_u32 s28, s7, s6
    s_add_u32 s28, s28, 73728
    s_waitcnt vmcnt(6)
    s_barrier
    ds_read_b128 a[0:3], v184 offset:0
    ds_read_b128 a[72:75], v184 offset:18432
    ds_read_b128 a[144:147], v11 offset:0
    ds_read_b128 a[216:219], v11 offset:18432
    ds_read_b128 a[4:7], v184 offset:1024
    ds_read_b128 a[76:79], v184 offset:19456
    ds_read_b128 a[148:151], v11 offset:1024
    ds_read_b128 a[220:223], v11 offset:19456
    ds_read_b128 a[8:11], v184 offset:2048
    ds_read_b128 a[80:83], v184 offset:20480
    ds_read_b128 a[152:155], v11 offset:2048
    ds_read_b128 a[224:227], v11 offset:20480
    s_waitcnt vmcnt(24) lgkmcnt(0)
    v_mfma_f32_16x16x32_bf16 v[88:91], v[16:19], a[0:3], 0
    ds_read_b128 a[12:15], v184 offset:3072
    v_mfma_f32_16x16x32_bf16 v[88:91], v[20:23], a[4:7], v[88:91]
    buffer_load_dwordx4 v[76:79], v184, s[48:51], s23 offen offset:0 sc1
    v_mfma_f32_16x16x32_bf16 v[88:91], v[24:27], a[8:11], v[88:91]
    ds_read_b128 a[84:87], v184 offset:21504
    v_mfma_f32_16x16x32_bf16 v[92:95], v[16:19], a[72:75], 0
    s_add_u32 m0, s24, 10240
    s_nop 0
    buffer_load_dwordx4 v2, s[8:11], s22 offen offset:2048 sc1 lds
    v_mfma_f32_16x16x32_bf16 v[92:95], v[20:23], a[76:79], v[92:95]
    ds_read_b128 a[156:159], v11 offset:3072
    ds_read_b128 a[228:231], v11 offset:21504
    v_mfma_f32_16x16x32_bf16 v[92:95], v[24:27], a[80:83], v[92:95]
    buffer_load_dwordx4 v[80:83], v184, s[48:51], s23 offen offset:1024 sc1
    v_mfma_f32_16x16x32_bf16 v[96:99], v[16:19], a[144:147], 0
    ds_read_b128 a[16:19], v184 offset:4096
    v_mfma_f32_16x16x32_bf16 v[96:99], v[20:23], a[148:151], v[96:99]
    s_add_u32 m0, s24, 10752
    s_nop 0
    buffer_load_dwordx4 v2, s[8:11], s22 offen offset:2560 sc1 lds
    v_mfma_f32_16x16x32_bf16 v[96:99], v[24:27], a[152:155], v[96:99]
    ds_read_b128 a[88:91], v184 offset:22528
    v_mfma_f32_16x16x32_bf16 v[100:103], v[16:19], a[216:219], 0
    buffer_load_dwordx4 v[84:87], v184, s[48:51], s23 offen offset:2048 sc1
    v_mfma_f32_16x16x32_bf16 v[100:103], v[20:23], a[220:223], v[100:103]
    ds_read_b128 a[160:163], v11 offset:4096
    ds_read_b128 a[232:235], v11 offset:22528
    v_mfma_f32_16x16x32_bf16 v[100:103], v[24:27], a[224:227], v[100:103]
    s_add_u32 m0, s24, 11264
    s_nop 0
    buffer_load_dwordx4 v2, s[8:11], s22 offen offset:3072 sc1 lds
    s_waitcnt vmcnt(27) lgkmcnt(8)
    v_mfma_f32_16x16x32_bf16 v[104:107], v[28:31], a[0:3], 0
    ds_read_b128 a[20:23], v184 offset:5120
    v_mfma_f32_16x16x32_bf16 v[104:107], v[32:35], a[4:7], v[104:107]
    buffer_load_dwordx4 v[16:19], v184, s[48:51], s23 offen offset:3072 sc1
    v_mfma_f32_16x16x32_bf16 v[104:107], v[36:39], a[8:11], v[104:107]
    ds_read_b128 a[92:95], v184 offset:23552
    v_mfma_f32_16x16x32_bf16 v[108:111], v[28:31], a[72:75], 0
    s_add_u32 m0, s24, 11776
    s_nop 0
    buffer_load_dwordx4 v2, s[8:11], s22 offen offset:3584 sc1 lds
    v_mfma_f32_16x16x32_bf16 v[108:111], v[32:35], a[76:79], v[108:111]
    ds_read_b128 a[164:167], v11 offset:5120
    ds_read_b128 a[236:239], v11 offset:23552
    v_mfma_f32_16x16x32_bf16 v[108:111], v[36:39], a[80:83], v[108:111]
    buffer_load_dwordx4 v[20:23], v185, s[48:51], s23 offen offset:0 sc1
    v_mfma_f32_16x16x32_bf16 v[112:115], v[28:31], a[144:147], 0
    v_mfma_f32_16x16x32_bf16 v[112:115], v[32:35], a[148:151], v[112:115]
    s_add_u32 m0, s24, 16384
    s_add_u32 s22, s22, 4096
    buffer_load_dwordx4 v2, s[8:11], s22 offen offset:0 sc1 lds
    v_mfma_f32_16x16x32_bf16 v[112:115], v[36:39], a[152:155], v[112:115]
    v_mfma_f32_16x16x32_bf16 v[116:119], v[28:31], a[216:219], 0
    buffer_load_dwordx4 v[24:27], v185, s[48:51], s23 offen offset:1024 sc1
    v_mfma_f32_16x16x32_bf16 v[116:119], v[32:35], a[220:223], v[116:119]
    v_mfma_f32_16x16x32_bf16 v[116:119], v[36:39], a[224:227], v[116:119]
    s_add_u32 m0, s24, 16896
    s_nop 0
    buffer_load_dwordx4 v2, s[8:11], s22 offen offset:512 sc1 lds
    s_waitcnt vmcnt(12) lgkmcnt(0)
    s_barrier
    v_mfma_f32_16x16x32_bf16 v[88:91], v[40:43], a[12:15], v[88:91]
    ds_read_b128 a[24:27], v184 offset:6144
    v_mfma_f32_16x16x32_bf16 v[88:91], v[44:47], a[16:19], v[88:91]
    buffer_load_dwordx4 v[28:31], v185, s[48:51], s23 offen offset:2048 sc1
    v_mfma_f32_16x16x32_bf16 v[88:91], v[48:51], a[20:23], v[88:91]
    ds_read_b128 a[96:99], v184 offset:24576
    v_mfma_f32_16x16x32_bf16 v[92:95], v[40:43], a[84:87], v[92:95]
    buffer_load_dword v136, v3, s[8:11], s25 offen offset:0 sc1
    v_mfma_f32_16x16x32_bf16 v[92:95], v[44:47], a[88:91], v[92:95]
    ds_read_b128 a[168:171], v11 offset:6144
    ds_read_b128 a[240:243], v11 offset:24576
    v_mfma_f32_16x16x32_bf16 v[92:95], v[48:51], a[92:95], v[92:95]
    buffer_load_dwordx4 v[32:35], v185, s[48:51], s23 offen offset:3072 sc1
    v_mfma_f32_16x16x32_bf16 v[96:99], v[40:43], a[156:159], v[96:99]
    buffer_load_dword v137, v3, s[8:11], s25 offen offset:128 sc1
    v_mfma_f32_16x16x32_bf16 v[96:99], v[44:47], a[160:163], v[96:99]
    buffer_load_dword v138, v3, s[8:11], s25 offen offset:256 sc1
    v_mfma_f32_16x16x32_bf16 v[96:99], v[48:51], a[164:167], v[96:99]
    ds_read_b128 a[28:31], v184 offset:7168
    ds_read_b128 a[100:103], v184 offset:25600
    v_mfma_f32_16x16x32_bf16 v[100:103], v[40:43], a[228:231], v[100:103]
    buffer_load_dwordx4 v[36:39], v186, s[48:51], s23 offen offset:0 sc1
    v_mfma_f32_16x16x32_bf16 v[100:103], v[44:47], a[232:235], v[100:103]
    buffer_load_dword v139, v3, s[8:11], s25 offen offset:384 sc1
    v_mfma_f32_16x16x32_bf16 v[100:103], v[48:51], a[236:239], v[100:103]
    buffer_load_dword v140, v3, s[8:11], s25 offen offset:512 sc1
    s_waitcnt vmcnt(35) lgkmcnt(6)
    v_mfma_f32_16x16x32_bf16 v[104:107], v[52:55], a[12:15], v[104:107]
    ds_read_b128 a[172:175], v11 offset:7168
    ds_read_b128 a[244:247], v11 offset:25600
    v_mfma_f32_16x16x32_bf16 v[104:107], v[56:59], a[16:19], v[104:107]
    buffer_load_dwordx4 v[40:43], v186, s[48:51], s23 offen offset:1024 sc1
    v_mfma_f32_16x16x32_bf16 v[104:107], v[60:63], a[20:23], v[104:107]
    ds_read_b128 a[32:35], v184 offset:8192
    ds_read_b128 a[104:107], v184 offset:26624
    v_mfma_f32_16x16x32_bf16 v[108:111], v[52:55], a[84:87], v[108:111]
    buffer_load_dword v141, v3, s[8:11], s25 offen offset:640 sc1
    v_mfma_f32_16x16x32_bf16 v[108:111], v[56:59], a[88:91], v[108:111]
    ds_read_b128 a[176:179], v11 offset:8192
    ds_read_b128 a[248:251], v11 offset:26624
    v_mfma_f32_16x16x32_bf16 v[108:111], v[60:63], a[92:95], v[108:111]
    buffer_load_dwordx4 v[44:47], v186, s[48:51], s23 offen offset:2048 sc1
    v_mfma_f32_16x16x32_bf16 v[112:115], v[52:55], a[156:159], v[112:115]
    buffer_load_dword v142, v3, s[8:11], s25 offen offset:768 sc1
    v_mfma_f32_16x16x32_bf16 v[112:115], v[56:59], a[160:163], v[112:115]
    buffer_load_dword v143, v3, s[8:11], s25 offen offset:896 sc1
    v_mfma_f32_16x16x32_bf16 v[112:115], v[60:63], a[164:167], v[112:115]
    v_mfma_f32_16x16x32_bf16 v[116:119], v[52:55], a[228:231], v[116:119]
    buffer_load_dwordx4 v[48:51], v186, s[48:51], s23 offen offset:3072 sc1
    v_mfma_f32_16x16x32_bf16 v[116:119], v[56:59], a[232:235], v[116:119]
    buffer_load_dword v144, v3, s[8:11], s25 offen offset:1024 sc1
    v_mfma_f32_16x16x32_bf16 v[116:119], v[60:63], a[236:239], v[116:119]
    buffer_load_dword v145, v3, s[8:11], s25 offen offset:1152 sc1
    s_waitcnt vmcnt(40) lgkmcnt(0)
    v_mfma_f32_16x16x32_bf16 v[88:91], v[64:67], a[24:27], v[88:91]
    ds_read_b128 a[36:39], v184 offset:9216
    v_mfma_f32_16x16x32_bf16 v[88:91], v[68:71], a[28:31], v[88:91]
    buffer_load_dwordx4 v[52:55], v187, s[48:51], s23 offen offset:0 sc1
    v_mfma_f32_16x16x32_bf16 v[88:91], v[72:75], a[32:35], v[88:91]
    ds_read_b128 a[108:111], v184 offset:27648
    v_mfma_f32_16x16x32_bf16 v[92:95], v[64:67], a[96:99], v[92:95]
    buffer_load_dword v146, v3, s[8:11], s25 offen offset:1280 sc1
    v_mfma_f32_16x16x32_bf16 v[92:95], v[68:71], a[100:103], v[92:95]
    ds_read_b128 a[180:183], v11 offset:9216
    ds_read_b128 a[252:255], v11 offset:27648
    v_mfma_f32_16x16x32_bf16 v[92:95], v[72:75], a[104:107], v[92:95]
    buffer_load_dwordx4 v[56:59], v187, s[48:51], s23 offen offset:1024 sc1
    v_mfma_f32_16x16x32_bf16 v[96:99], v[64:67], a[168:171], v[96:99]
    buffer_load_dword v147, v3, s[8:11], s25 offen offset:1408 sc1
    v_mfma_f32_16x16x32_bf16 v[96:99], v[68:71], a[172:175], v[96:99]
    buffer_load_dword v148, v3, s[8:11], s25 offen offset:1536 sc1
    v_mfma_f32_16x16x32_bf16 v[96:99], v[72:75], a[176:179], v[96:99]
    ds_read_b128 a[40:43], v184 offset:10240
    ds_read_b128 a[112:115], v184 offset:28672
    v_mfma_f32_16x16x32_bf16 v[100:103], v[64:67], a[240:243], v[100:103]
    buffer_load_dwordx4 v[60:63], v187, s[48:51], s23 offen offset:2048 sc1
    v_mfma_f32_16x16x32_bf16 v[100:103], v[68:71], a[244:247], v[100:103]
    buffer_load_dword v149, v3, s[8:11], s25 offen offset:1664 sc1
    v_mfma_f32_16x16x32_bf16 v[100:103], v[72:75], a[248:251], v[100:103]
    buffer_load_dword v150, v3, s[8:11], s25 offen offset:1792 sc1
    s_waitcnt vmcnt(31) lgkmcnt(6)
    v_mfma_f32_16x16x32_bf16 v[104:107], v[76:79], a[24:27], v[104:107]
    ds_read_b128 a[184:187], v11 offset:10240
    ds_read_b128 v[220:223], v11 offset:28672
    v_mfma_f32_16x16x32_bf16 v[104:107], v[80:83], a[28:31], v[104:107]
    buffer_load_dwordx4 v[64:67], v187, s[48:51], s23 offen offset:3072 sc1
    v_mfma_f32_16x16x32_bf16 v[104:107], v[84:87], a[32:35], v[104:107]
    ds_read_b128 a[44:47], v184 offset:11264
    ds_read_b128 a[116:119], v184 offset:29696
    v_mfma_f32_16x16x32_bf16 v[108:111], v[76:79], a[96:99], v[108:111]
    buffer_load_dword v151, v3, s[8:11], s25 offen offset:1920 sc1
    v_mfma_f32_16x16x32_bf16 v[108:111], v[80:83], a[100:103], v[108:111]
    ds_read_b128 a[188:191], v11 offset:11264
    ds_read_b128 v[224:227], v11 offset:29696
    v_mfma_f32_16x16x32_bf16 v[108:111], v[84:87], a[104:107], v[108:111]
    buffer_load_dwordx4 v[68:71], v188, s[48:51], s23 offen offset:0 sc1
    v_mfma_f32_16x16x32_bf16 v[112:115], v[76:79], a[168:171], v[112:115]
    v_mfma_f32_16x16x32_bf16 v[112:115], v[80:83], a[172:175], v[112:115]
    v_mfma_f32_16x16x32_bf16 v[112:115], v[84:87], a[176:179], v[112:115]
    v_mfma_f32_16x16x32_bf16 v[116:119], v[76:79], a[240:243], v[116:119]
    buffer_load_dwordx4 v[72:75], v188, s[48:51], s23 offen offset:1024 sc1
    v_mfma_f32_16x16x32_bf16 v[116:119], v[80:83], a[244:247], v[116:119]
    v_mfma_f32_16x16x32_bf16 v[116:119], v[84:87], a[248:251], v[116:119]
    s_waitcnt vmcnt(28) lgkmcnt(0)
    s_barrier
    v_mfma_f32_16x16x32_bf16 v[88:91], v[16:19], a[36:39], v[88:91]
    ds_read_b128 a[48:51], v184 offset:12288
    v_mfma_f32_16x16x32_bf16 v[88:91], v[20:23], a[40:43], v[88:91]
    buffer_load_dwordx4 v[76:79], v188, s[48:51], s23 offen offset:2048 sc1
    v_mfma_f32_16x16x32_bf16 v[88:91], v[24:27], a[44:47], v[88:91]
    ds_read_b128 a[120:123], v184 offset:30720
    v_mfma_f32_16x16x32_bf16 v[92:95], v[16:19], a[108:111], v[92:95]
    ds_read_b128 a[192:195], v11 offset:12288
    v_mfma_f32_16x16x32_bf16 v[92:95], v[20:23], a[112:115], v[92:95]
    ds_read_b128 v[228:231], v11 offset:30720
    v_mfma_f32_16x16x32_bf16 v[92:95], v[24:27], a[116:119], v[92:95]
    buffer_load_dwordx4 v[80:83], v188, s[48:51], s23 offen offset:3072 sc1
    v_mfma_f32_16x16x32_bf16 v[96:99], v[16:19], a[180:183], v[96:99]
    ds_read_b128 a[52:55], v184 offset:13312
    v_mfma_f32_16x16x32_bf16 v[96:99], v[20:23], a[184:187], v[96:99]
    ds_read_b128 a[124:127], v184 offset:31744
    v_mfma_f32_16x16x32_bf16 v[96:99], v[24:27], a[188:191], v[96:99]
    v_mfma_f32_16x16x32_bf16 v[100:103], v[16:19], a[252:255], v[100:103]
    buffer_load_dwordx4 v[84:87], v189, s[48:51], s23 offen offset:0 sc1
    v_mfma_f32_16x16x32_bf16 v[100:103], v[20:23], v[220:223], v[100:103]
    ds_read_b128 a[196:199], v11 offset:13312
    ds_read_b128 v[232:235], v11 offset:31744
    v_mfma_f32_16x16x32_bf16 v[100:103], v[24:27], v[224:227], v[100:103]
    s_waitcnt vmcnt(25) lgkmcnt(8)
    v_mfma_f32_16x16x32_bf16 v[104:107], v[28:31], a[36:39], v[104:107]
    ds_read_b128 a[56:59], v184 offset:14336
    v_mfma_f32_16x16x32_bf16 v[104:107], v[32:35], a[40:43], v[104:107]
    buffer_load_dwordx4 v[16:19], v189, s[48:51], s23 offen offset:1024 sc1
    v_mfma_f32_16x16x32_bf16 v[104:107], v[36:39], a[44:47], v[104:107]
    ds_read_b128 a[128:131], v184 offset:32768
    v_mfma_f32_16x16x32_bf16 v[108:111], v[28:31], a[108:111], v[108:111]
    ds_read_b128 a[200:203], v11 offset:14336
    v_mfma_f32_16x16x32_bf16 v[108:111], v[32:35], a[112:115], v[108:111]
    ds_read_b128 v[236:239], v11 offset:32768
    v_mfma_f32_16x16x32_bf16 v[108:111], v[36:39], a[116:119], v[108:111]
    buffer_load_dwordx4 v[20:23], v189, s[48:51], s23 offen offset:2048 sc1
    v_mfma_f32_16x16x32_bf16 v[112:115], v[28:31], a[180:183], v[112:115]
    v_mfma_f32_16x16x32_bf16 v[112:115], v[32:35], a[184:187], v[112:115]
    v_mfma_f32_16x16x32_bf16 v[112:115], v[36:39], a[188:191], v[112:115]
    v_mfma_f32_16x16x32_bf16 v[116:119], v[28:31], a[252:255], v[116:119]
    buffer_load_dwordx4 v[24:27], v189, s[48:51], s23 offen offset:3072 sc1
    v_mfma_f32_16x16x32_bf16 v[116:119], v[32:35], v[220:223], v[116:119]
    v_mfma_f32_16x16x32_bf16 v[116:119], v[36:39], v[224:227], v[116:119]
    s_waitcnt vmcnt(8) lgkmcnt(0)
    v_mfma_f32_16x16x32_bf16 v[88:91], v[40:43], a[48:51], v[88:91]
    ds_read_b128 a[60:63], v184 offset:15360
    v_add_f32 v136, v136, v144
    v_mfma_f32_16x16x32_bf16 v[88:91], v[44:47], a[52:55], v[88:91]
    buffer_load_dwordx4 v[28:31], v190, s[48:51], s23 offen offset:0 sc1
    v_mfma_f32_16x16x32_bf16 v[88:91], v[48:51], a[56:59], v[88:91]
    ds_read_b128 a[132:135], v184 offset:33792
    v_add_f32 v137, v137, v145
    v_mfma_f32_16x16x32_bf16 v[92:95], v[40:43], a[120:123], v[92:95]
    ds_read_b128 a[204:207], v11 offset:15360
    v_add_f32 v138, v138, v146
    v_mfma_f32_16x16x32_bf16 v[92:95], v[44:47], a[124:127], v[92:95]
    ds_read_b128 v[240:243], v11 offset:33792
    v_add_f32 v139, v139, v147
    v_mfma_f32_16x16x32_bf16 v[92:95], v[48:51], a[128:131], v[92:95]
    buffer_load_dwordx4 v[32:35], v190, s[48:51], s23 offen offset:1024 sc1
    v_mfma_f32_16x16x32_bf16 v[96:99], v[40:43], a[192:195], v[96:99]
    ds_read_b128 a[64:67], v184 offset:16384
    v_add_f32 v140, v140, v148
    v_mfma_f32_16x16x32_bf16 v[96:99], v[44:47], a[196:199], v[96:99]
    ds_read_b128 a[136:139], v184 offset:34816
    v_add_f32 v141, v141, v149
    v_mfma_f32_16x16x32_bf16 v[96:99], v[48:51], a[200:203], v[96:99]
    v_add_f32 v142, v142, v150
    v_add_f32 v143, v143, v151
    v_mfma_f32_16x16x32_bf16 v[100:103], v[40:43], v[228:231], v[100:103]
    buffer_load_dwordx4 v[36:39], v190, s[48:51], s23 offen offset:2048 sc1
    v_mfma_f32_16x16x32_bf16 v[100:103], v[44:47], v[232:235], v[100:103]
    ds_read_b128 a[208:211], v11 offset:16384
    ds_read_b128 v[244:247], v11 offset:34816
    v_mfma_f32_16x16x32_bf16 v[100:103], v[48:51], v[236:239], v[100:103]
    v_add_f32 v136, v136, v140
    v_add_f32 v137, v137, v141
    s_waitcnt vmcnt(15) lgkmcnt(8)
    v_mfma_f32_16x16x32_bf16 v[104:107], v[52:55], a[48:51], v[104:107]
    ds_read_b128 a[68:71], v184 offset:17408
    v_add_f32 v138, v138, v142
    v_mfma_f32_16x16x32_bf16 v[104:107], v[56:59], a[52:55], v[104:107]
    buffer_load_dwordx4 v[40:43], v190, s[48:51], s23 offen offset:3072 sc1
    v_mfma_f32_16x16x32_bf16 v[104:107], v[60:63], a[56:59], v[104:107]
    ds_read_b128 a[140:143], v184 offset:35840
    v_add_f32 v139, v139, v143
    v_mfma_f32_16x16x32_bf16 v[108:111], v[52:55], a[120:123], v[108:111]
    ds_read_b128 a[212:215], v11 offset:17408
    v_add_f32 v136, v136, v138
    v_mfma_f32_16x16x32_bf16 v[108:111], v[56:59], a[124:127], v[108:111]
    ds_read_b128 v[248:251], v11 offset:35840
    v_add_f32 v137, v137, v139
    v_mfma_f32_16x16x32_bf16 v[108:111], v[60:63], a[128:131], v[108:111]
    buffer_load_dwordx4 v[44:47], v191, s[48:51], s23 offen offset:0 sc1
    v_mfma_f32_16x16x32_bf16 v[112:115], v[52:55], a[192:195], v[112:115]
    v_add_f32 v136, v136, v137
    v_mov_b32 v137, 0x3727c5ac
    v_mfma_f32_16x16x32_bf16 v[112:115], v[56:59], a[196:199], v[112:115]
    v_fmac_f32 v137, 0x3ae38e39, v136
    v_mov_b32 v193, v137
    v_mfma_f32_16x16x32_bf16 v[112:115], v[60:63], a[200:203], v[112:115]
    s_nop 0
    v_permlane16_swap_b32 v193, v137
    v_mfma_f32_16x16x32_bf16 v[116:119], v[52:55], v[228:231], v[116:119]
    buffer_load_dwordx4 v[48:51], v191, s[48:51], s23 offen offset:1024 sc1
    v_mfma_f32_16x16x32_bf16 v[116:119], v[56:59], v[232:235], v[116:119]
    v_mov_b32 v195, v193
    v_mov_b32 v194, v137
    v_mfma_f32_16x16x32_bf16 v[116:119], v[60:63], v[236:239], v[116:119]
    v_mov_b32 v252, v137
    s_waitcnt vmcnt(12) lgkmcnt(0)
    v_mfma_f32_16x16x32_bf16 v[88:91], v[64:67], a[60:63], v[88:91]
    s_nop 0
    v_permlane32_swap_b32 v193, v195
    v_mfma_f32_16x16x32_bf16 v[88:91], v[68:71], a[64:67], v[88:91]
    buffer_load_dwordx4 v[52:55], v191, s[48:51], s23 offen offset:2048 sc1
    v_mfma_f32_16x16x32_bf16 v[120:123], v[72:75], a[68:71], v[88:91]
    v_permlane32_swap_b32 v194, v252
    v_mfma_f32_16x16x32_bf16 v[92:95], v[64:67], a[132:135], v[92:95]
    v_rsq_f32 v4, v193
    v_mfma_f32_16x16x32_bf16 v[92:95], v[68:71], a[136:139], v[92:95]
    v_rsq_f32 v5, v194
    v_mfma_f32_16x16x32_bf16 v[124:127], v[72:75], a[140:143], v[92:95]
    buffer_load_dwordx4 v[56:59], v191, s[48:51], s23 offen offset:3072 sc1
    v_mfma_f32_16x16x32_bf16 v[96:99], v[64:67], a[204:207], v[96:99]
    v_rsq_f32 v6, v195
    v_mfma_f32_16x16x32_bf16 v[96:99], v[68:71], a[208:211], v[96:99]
    v_rsq_f32 v7, v252
    v_mfma_f32_16x16x32_bf16 v[128:131], v[72:75], a[212:215], v[96:99]
    v_mul_f32 v8, v4, v4
    v_mul_f32 v9, v5, v5
    v_mfma_f32_16x16x32_bf16 v[100:103], v[64:67], v[240:243], v[100:103]
    buffer_load_dwordx4 v[60:63], v192, s[48:51], s23 offen offset:0 sc1
    v_mfma_f32_16x16x32_bf16 v[100:103], v[68:71], v[244:247], v[100:103]
    v_mul_f32 v13, v6, v6
    v_mul_f32 v14, v7, v7
    v_mfma_f32_16x16x32_bf16 v[132:135], v[72:75], v[248:251], v[100:103]
    v_mul_f32 v4, 0xc0135761, v4
    v_mul_f32 v5, 0xc0135761, v5
    s_waitcnt vmcnt(12) lgkmcnt(0)
    v_mfma_f32_16x16x32_bf16 v[104:107], v[76:79], a[60:63], v[104:107]
    v_mul_f32 v6, 0xc0135761, v6
    v_mul_f32 v7, 0xc0135761, v7
    v_mfma_f32_16x16x32_bf16 v[104:107], v[80:83], a[64:67], v[104:107]
    buffer_load_dwordx4 v[64:67], v192, s[48:51], s23 offen offset:1024 sc1
    v_mfma_f32_16x16x32_bf16 v[136:139], v[84:87], a[68:71], v[104:107]
    v_mul_f32 v8, 0x3d372713, v8
    v_mul_f32 v9, 0x3d372713, v9
    v_mfma_f32_16x16x32_bf16 v[108:111], v[76:79], a[132:135], v[108:111]
    v_mul_f32 v13, 0x3d372713, v13
    v_mul_f32 v14, 0x3d372713, v14
    v_mfma_f32_16x16x32_bf16 v[108:111], v[80:83], a[136:139], v[108:111]
    v_mul_f32 v8, v8, v4
    v_mul_f32 v9, v9, v5
    v_mfma_f32_16x16x32_bf16 v[140:143], v[84:87], a[140:143], v[108:111]
    buffer_load_dwordx4 v[68:71], v192, s[48:51], s23 offen offset:2048 sc1
    v_mfma_f32_16x16x32_bf16 v[112:115], v[76:79], a[204:207], v[112:115]
    v_mul_f32 v13, v13, v6
    v_mul_f32 v14, v14, v7
    v_mfma_f32_16x16x32_bf16 v[112:115], v[80:83], a[208:211], v[112:115]
    s_mov_b32 s25, 0
    v_mfma_f32_16x16x32_bf16 v[144:147], v[84:87], a[212:215], v[112:115]
    s_mov_b32 s7, s28
    v_mfma_f32_16x16x32_bf16 v[116:119], v[76:79], v[240:243], v[116:119]
    buffer_load_dwordx4 v[72:75], v192, s[48:51], s23 offen offset:3072 sc1
    v_mfma_f32_16x16x32_bf16 v[116:119], v[80:83], v[244:247], v[116:119]
    s_add_u32 s23, s23, 36864
    v_mfma_f32_16x16x32_bf16 v[148:151], v[84:87], v[248:251], v[116:119]
    v_add_u32 v12, s7, v184
    s_add_u32 s25, s25, 1
L_ffn_gu_34:
    s_waitcnt vmcnt(12)
    v_mfma_f32_16x16x32_bf16 v[88:91], v[16:19], a[0:3], 0
    v_mfma_f32_16x16x32_bf16 v[88:91], v[20:23], a[4:7], v[88:91]
    buffer_load_dwordx4 v[76:79], v184, s[48:51], s23 offen offset:0 sc1
    v_mfma_f32_16x16x32_bf16 v[88:91], v[24:27], a[8:11], v[88:91]
    v_mul_f32 v152, v120, v120
    v_mul_f32 v153, v121, v121
    v_mfma_f32_16x16x32_bf16 v[92:95], v[16:19], a[72:75], 0
    v_mul_f32 v154, v122, v122
    v_mul_f32 v155, v123, v123
    v_mfma_f32_16x16x32_bf16 v[92:95], v[20:23], a[76:79], v[92:95]
    v_fma_f32 v152, v152, v8, v4
    v_fma_f32 v153, v153, v8, v4
    v_mfma_f32_16x16x32_bf16 v[92:95], v[24:27], a[80:83], v[92:95]
    buffer_load_dwordx4 v[80:83], v184, s[48:51], s23 offen offset:1024 sc1
    v_mfma_f32_16x16x32_bf16 v[96:99], v[16:19], a[144:147], 0
    v_fma_f32 v154, v154, v8, v4
    v_fma_f32 v155, v155, v8, v4
    v_mfma_f32_16x16x32_bf16 v[96:99], v[20:23], a[148:151], v[96:99]
    v_mul_f32 v152, v120, v152
    v_mul_f32 v153, v121, v153
    v_mfma_f32_16x16x32_bf16 v[96:99], v[24:27], a[152:155], v[96:99]
    v_mul_f32 v154, v122, v154
    v_mul_f32 v155, v123, v155
    v_mfma_f32_16x16x32_bf16 v[100:103], v[16:19], a[216:219], 0
    buffer_load_dwordx4 v[84:87], v184, s[48:51], s23 offen offset:2048 sc1
    v_mfma_f32_16x16x32_bf16 v[100:103], v[20:23], a[220:223], v[100:103]
    v_exp_f32 v152, v152
    v_mfma_f32_16x16x32_bf16 v[100:103], v[24:27], a[224:227], v[100:103]
    v_exp_f32 v153, v153
    s_waitcnt vmcnt(12)
    v_mfma_f32_16x16x32_bf16 v[104:107], v[28:31], a[0:3], 0
    v_exp_f32 v154, v154
    v_mfma_f32_16x16x32_bf16 v[104:107], v[32:35], a[4:7], v[104:107]
    buffer_load_dwordx4 v[16:19], v184, s[48:51], s23 offen offset:3072 sc1
    v_mfma_f32_16x16x32_bf16 v[104:107], v[36:39], a[8:11], v[104:107]
    v_exp_f32 v155, v155
    v_mfma_f32_16x16x32_bf16 v[108:111], v[28:31], a[72:75], 0
    v_mul_f32 v156, v120, v136
    v_mul_f32 v157, v121, v137
    v_mfma_f32_16x16x32_bf16 v[108:111], v[32:35], a[76:79], v[108:111]
    v_mul_f32 v158, v122, v138
    v_mul_f32 v159, v123, v139
    v_mfma_f32_16x16x32_bf16 v[108:111], v[36:39], a[80:83], v[108:111]
    buffer_load_dwordx4 v[20:23], v185, s[48:51], s23 offen offset:0 sc1
    v_mfma_f32_16x16x32_bf16 v[112:115], v[28:31], a[144:147], 0
    v_fma_f32 v152, v152, v193, v193
    v_fma_f32 v153, v153, v193, v193
    v_mfma_f32_16x16x32_bf16 v[112:115], v[32:35], a[148:151], v[112:115]
    v_fma_f32 v154, v154, v193, v193
    v_fma_f32 v155, v155, v193, v193
    v_mfma_f32_16x16x32_bf16 v[112:115], v[36:39], a[152:155], v[112:115]
    v_rcp_f32 v152, v152
    v_mfma_f32_16x16x32_bf16 v[116:119], v[28:31], a[216:219], 0
    buffer_load_dwordx4 v[24:27], v185, s[48:51], s23 offen offset:1024 sc1
    v_mfma_f32_16x16x32_bf16 v[116:119], v[32:35], a[220:223], v[116:119]
    v_rcp_f32 v153, v153
    v_mfma_f32_16x16x32_bf16 v[116:119], v[36:39], a[224:227], v[116:119]
    v_rcp_f32 v154, v154
    s_waitcnt vmcnt(12)
    v_mfma_f32_16x16x32_bf16 v[88:91], v[40:43], a[12:15], v[88:91]
    v_rcp_f32 v155, v155
    v_mfma_f32_16x16x32_bf16 v[88:91], v[44:47], a[16:19], v[88:91]
    buffer_load_dwordx4 v[28:31], v185, s[48:51], s23 offen offset:2048 sc1
    v_mfma_f32_16x16x32_bf16 v[88:91], v[48:51], a[20:23], v[88:91]
    v_mul_f32 v156, v156, v152
    v_mul_f32 v157, v157, v153
    v_mfma_f32_16x16x32_bf16 v[92:95], v[40:43], a[84:87], v[92:95]
    v_mul_f32 v158, v158, v154
    v_mul_f32 v159, v159, v155
    v_mfma_f32_16x16x32_bf16 v[92:95], v[44:47], a[88:91], v[92:95]
    v_cvt_pk_bf16_f32 v160, v156, v157
    v_cvt_pk_bf16_f32 v161, v158, v159
    v_mfma_f32_16x16x32_bf16 v[92:95], v[48:51], a[92:95], v[92:95]
    buffer_load_dwordx4 v[32:35], v185, s[48:51], s23 offen offset:3072 sc1
    v_mfma_f32_16x16x32_bf16 v[96:99], v[40:43], a[156:159], v[96:99]
    ds_write_b64 v12, v[160:161] offset:0
    v_mfma_f32_16x16x32_bf16 v[96:99], v[44:47], a[160:163], v[96:99]
    v_mul_f32 v162, v124, v124
    v_mul_f32 v163, v125, v125
    v_mfma_f32_16x16x32_bf16 v[96:99], v[48:51], a[164:167], v[96:99]
    v_mul_f32 v164, v126, v126
    v_mul_f32 v165, v127, v127
    v_mfma_f32_16x16x32_bf16 v[100:103], v[40:43], a[228:231], v[100:103]
    buffer_load_dwordx4 v[36:39], v186, s[48:51], s23 offen offset:0 sc1
    v_mfma_f32_16x16x32_bf16 v[100:103], v[44:47], a[232:235], v[100:103]
    v_fma_f32 v162, v162, v9, v5
    v_fma_f32 v163, v163, v9, v5
    v_mfma_f32_16x16x32_bf16 v[100:103], v[48:51], a[236:239], v[100:103]
    v_fma_f32 v164, v164, v9, v5
    v_fma_f32 v165, v165, v9, v5
    s_waitcnt vmcnt(12)
    v_mfma_f32_16x16x32_bf16 v[104:107], v[52:55], a[12:15], v[104:107]
    v_mul_f32 v162, v124, v162
    v_mul_f32 v163, v125, v163
    v_mfma_f32_16x16x32_bf16 v[104:107], v[56:59], a[16:19], v[104:107]
    buffer_load_dwordx4 v[40:43], v186, s[48:51], s23 offen offset:1024 sc1
    v_mfma_f32_16x16x32_bf16 v[104:107], v[60:63], a[20:23], v[104:107]
    v_mul_f32 v164, v126, v164
    v_mul_f32 v165, v127, v165
    v_mfma_f32_16x16x32_bf16 v[108:111], v[52:55], a[84:87], v[108:111]
    v_exp_f32 v162, v162
    v_mfma_f32_16x16x32_bf16 v[108:111], v[56:59], a[88:91], v[108:111]
    v_exp_f32 v163, v163
    v_mfma_f32_16x16x32_bf16 v[108:111], v[60:63], a[92:95], v[108:111]
    buffer_load_dwordx4 v[44:47], v186, s[48:51], s23 offen offset:2048 sc1
    v_mfma_f32_16x16x32_bf16 v[112:115], v[52:55], a[156:159], v[112:115]
    v_exp_f32 v164, v164
    v_mfma_f32_16x16x32_bf16 v[112:115], v[56:59], a[160:163], v[112:115]
    v_exp_f32 v165, v165
    v_mfma_f32_16x16x32_bf16 v[112:115], v[60:63], a[164:167], v[112:115]
    v_mul_f32 v166, v124, v140
    v_mul_f32 v167, v125, v141
    v_mfma_f32_16x16x32_bf16 v[116:119], v[52:55], a[228:231], v[116:119]
    buffer_load_dwordx4 v[48:51], v186, s[48:51], s23 offen offset:3072 sc1
    v_mfma_f32_16x16x32_bf16 v[116:119], v[56:59], a[232:235], v[116:119]
    v_mul_f32 v168, v126, v142
    v_mul_f32 v169, v127, v143
    v_mfma_f32_16x16x32_bf16 v[116:119], v[60:63], a[236:239], v[116:119]
    v_fma_f32 v162, v162, v194, v194
    v_fma_f32 v163, v163, v194, v194
    s_waitcnt vmcnt(12)
    v_mfma_f32_16x16x32_bf16 v[88:91], v[64:67], a[24:27], v[88:91]
    v_fma_f32 v164, v164, v194, v194
    v_fma_f32 v165, v165, v194, v194
    v_mfma_f32_16x16x32_bf16 v[88:91], v[68:71], a[28:31], v[88:91]
    buffer_load_dwordx4 v[52:55], v187, s[48:51], s23 offen offset:0 sc1
    v_mfma_f32_16x16x32_bf16 v[88:91], v[72:75], a[32:35], v[88:91]
    v_rcp_f32 v162, v162
    v_mfma_f32_16x16x32_bf16 v[92:95], v[64:67], a[96:99], v[92:95]
    v_rcp_f32 v163, v163
    v_mfma_f32_16x16x32_bf16 v[92:95], v[68:71], a[100:103], v[92:95]
    v_rcp_f32 v164, v164
    v_mfma_f32_16x16x32_bf16 v[92:95], v[72:75], a[104:107], v[92:95]
    buffer_load_dwordx4 v[56:59], v187, s[48:51], s23 offen offset:1024 sc1
    v_mfma_f32_16x16x32_bf16 v[96:99], v[64:67], a[168:171], v[96:99]
    v_rcp_f32 v165, v165
    v_mfma_f32_16x16x32_bf16 v[96:99], v[68:71], a[172:175], v[96:99]
    v_mul_f32 v166, v166, v162
    v_mul_f32 v167, v167, v163
    v_mfma_f32_16x16x32_bf16 v[96:99], v[72:75], a[176:179], v[96:99]
    v_mul_f32 v168, v168, v164
    v_mul_f32 v169, v169, v165
    v_mfma_f32_16x16x32_bf16 v[100:103], v[64:67], a[240:243], v[100:103]
    buffer_load_dwordx4 v[60:63], v187, s[48:51], s23 offen offset:2048 sc1
    v_mfma_f32_16x16x32_bf16 v[100:103], v[68:71], a[244:247], v[100:103]
    v_cvt_pk_bf16_f32 v170, v166, v167
    v_cvt_pk_bf16_f32 v171, v168, v169
    v_mfma_f32_16x16x32_bf16 v[100:103], v[72:75], a[248:251], v[100:103]
    ds_write_b64 v12, v[170:171] offset:18432
    s_waitcnt vmcnt(12)
    v_mfma_f32_16x16x32_bf16 v[104:107], v[76:79], a[24:27], v[104:107]
    v_mul_f32 v152, v128, v128
    v_mul_f32 v153, v129, v129
    v_mfma_f32_16x16x32_bf16 v[104:107], v[80:83], a[28:31], v[104:107]
    buffer_load_dwordx4 v[64:67], v187, s[48:51], s23 offen offset:3072 sc1
    v_mfma_f32_16x16x32_bf16 v[104:107], v[84:87], a[32:35], v[104:107]
    v_mul_f32 v154, v130, v130
    v_mul_f32 v155, v131, v131
    v_mfma_f32_16x16x32_bf16 v[108:111], v[76:79], a[96:99], v[108:111]
    v_fma_f32 v152, v152, v13, v6
    v_fma_f32 v153, v153, v13, v6
    v_mfma_f32_16x16x32_bf16 v[108:111], v[80:83], a[100:103], v[108:111]
    v_fma_f32 v154, v154, v13, v6
    v_fma_f32 v155, v155, v13, v6
    v_mfma_f32_16x16x32_bf16 v[108:111], v[84:87], a[104:107], v[108:111]
    buffer_load_dwordx4 v[68:71], v188, s[48:51], s23 offen offset:0 sc1
    v_mfma_f32_16x16x32_bf16 v[112:115], v[76:79], a[168:171], v[112:115]
    v_mul_f32 v152, v128, v152
    v_mul_f32 v153, v129, v153
    v_mfma_f32_16x16x32_bf16 v[112:115], v[80:83], a[172:175], v[112:115]
    v_mul_f32 v154, v130, v154
    v_mul_f32 v155, v131, v155
    v_mfma_f32_16x16x32_bf16 v[112:115], v[84:87], a[176:179], v[112:115]
    v_exp_f32 v152, v152
    v_mfma_f32_16x16x32_bf16 v[116:119], v[76:79], a[240:243], v[116:119]
    buffer_load_dwordx4 v[72:75], v188, s[48:51], s23 offen offset:1024 sc1
    v_mfma_f32_16x16x32_bf16 v[116:119], v[80:83], a[244:247], v[116:119]
    v_exp_f32 v153, v153
    v_mfma_f32_16x16x32_bf16 v[116:119], v[84:87], a[248:251], v[116:119]
    v_exp_f32 v154, v154
    s_waitcnt vmcnt(12)
    v_mfma_f32_16x16x32_bf16 v[88:91], v[16:19], a[36:39], v[88:91]
    v_exp_f32 v155, v155
    v_mfma_f32_16x16x32_bf16 v[88:91], v[20:23], a[40:43], v[88:91]
    buffer_load_dwordx4 v[76:79], v188, s[48:51], s23 offen offset:2048 sc1
    v_mfma_f32_16x16x32_bf16 v[88:91], v[24:27], a[44:47], v[88:91]
    v_mul_f32 v156, v128, v144
    v_mul_f32 v157, v129, v145
    v_mfma_f32_16x16x32_bf16 v[92:95], v[16:19], a[108:111], v[92:95]
    v_mul_f32 v158, v130, v146
    v_mul_f32 v159, v131, v147
    v_mfma_f32_16x16x32_bf16 v[92:95], v[20:23], a[112:115], v[92:95]
    v_fma_f32 v152, v152, v195, v195
    v_fma_f32 v153, v153, v195, v195
    v_mfma_f32_16x16x32_bf16 v[92:95], v[24:27], a[116:119], v[92:95]
    buffer_load_dwordx4 v[80:83], v188, s[48:51], s23 offen offset:3072 sc1
    v_mfma_f32_16x16x32_bf16 v[96:99], v[16:19], a[180:183], v[96:99]
    v_fma_f32 v154, v154, v195, v195
    v_fma_f32 v155, v155, v195, v195
    v_mfma_f32_16x16x32_bf16 v[96:99], v[20:23], a[184:187], v[96:99]
    v_rcp_f32 v152, v152
    v_mfma_f32_16x16x32_bf16 v[96:99], v[24:27], a[188:191], v[96:99]
    v_rcp_f32 v153, v153
    v_mfma_f32_16x16x32_bf16 v[100:103], v[16:19], a[252:255], v[100:103]
    buffer_load_dwordx4 v[84:87], v189, s[48:51], s23 offen offset:0 sc1
    v_mfma_f32_16x16x32_bf16 v[100:103], v[20:23], v[220:223], v[100:103]
    v_rcp_f32 v154, v154
    v_mfma_f32_16x16x32_bf16 v[100:103], v[24:27], v[224:227], v[100:103]
    v_rcp_f32 v155, v155
    s_waitcnt vmcnt(12)
    v_mfma_f32_16x16x32_bf16 v[104:107], v[28:31], a[36:39], v[104:107]
    v_mul_f32 v156, v156, v152
    v_mul_f32 v157, v157, v153
    v_mfma_f32_16x16x32_bf16 v[104:107], v[32:35], a[40:43], v[104:107]
    buffer_load_dwordx4 v[16:19], v189, s[48:51], s23 offen offset:1024 sc1
    v_mfma_f32_16x16x32_bf16 v[104:107], v[36:39], a[44:47], v[104:107]
    v_mul_f32 v158, v158, v154
    v_mul_f32 v159, v159, v155
    v_mfma_f32_16x16x32_bf16 v[108:111], v[28:31], a[108:111], v[108:111]
    v_cvt_pk_bf16_f32 v160, v156, v157
    v_cvt_pk_bf16_f32 v161, v158, v159
    v_mfma_f32_16x16x32_bf16 v[108:111], v[32:35], a[112:115], v[108:111]
    ds_write_b64 v12, v[160:161] offset:36864
    v_mfma_f32_16x16x32_bf16 v[108:111], v[36:39], a[116:119], v[108:111]
    buffer_load_dwordx4 v[20:23], v189, s[48:51], s23 offen offset:2048 sc1
    v_mfma_f32_16x16x32_bf16 v[112:115], v[28:31], a[180:183], v[112:115]
    v_mul_f32 v162, v132, v132
    v_mul_f32 v163, v133, v133
    v_mfma_f32_16x16x32_bf16 v[112:115], v[32:35], a[184:187], v[112:115]
    v_mul_f32 v164, v134, v134
    v_mul_f32 v165, v135, v135
    v_mfma_f32_16x16x32_bf16 v[112:115], v[36:39], a[188:191], v[112:115]
    v_fma_f32 v162, v162, v14, v7
    v_fma_f32 v163, v163, v14, v7
    v_mfma_f32_16x16x32_bf16 v[116:119], v[28:31], a[252:255], v[116:119]
    buffer_load_dwordx4 v[24:27], v189, s[48:51], s23 offen offset:3072 sc1
    v_mfma_f32_16x16x32_bf16 v[116:119], v[32:35], v[220:223], v[116:119]
    v_fma_f32 v164, v164, v14, v7
    v_fma_f32 v165, v165, v14, v7
    v_mfma_f32_16x16x32_bf16 v[116:119], v[36:39], v[224:227], v[116:119]
    v_mul_f32 v162, v132, v162
    v_mul_f32 v163, v133, v163
    s_waitcnt vmcnt(12)
    v_mfma_f32_16x16x32_bf16 v[88:91], v[40:43], a[48:51], v[88:91]
    v_mul_f32 v164, v134, v164
    v_mul_f32 v165, v135, v165
    v_mfma_f32_16x16x32_bf16 v[88:91], v[44:47], a[52:55], v[88:91]
    buffer_load_dwordx4 v[28:31], v190, s[48:51], s23 offen offset:0 sc1
    v_mfma_f32_16x16x32_bf16 v[88:91], v[48:51], a[56:59], v[88:91]
    v_exp_f32 v162, v162
    v_mfma_f32_16x16x32_bf16 v[92:95], v[40:43], a[120:123], v[92:95]
    v_exp_f32 v163, v163
    v_mfma_f32_16x16x32_bf16 v[92:95], v[44:47], a[124:127], v[92:95]
    v_exp_f32 v164, v164
    v_mfma_f32_16x16x32_bf16 v[92:95], v[48:51], a[128:131], v[92:95]
    buffer_load_dwordx4 v[32:35], v190, s[48:51], s23 offen offset:1024 sc1
    v_mfma_f32_16x16x32_bf16 v[96:99], v[40:43], a[192:195], v[96:99]
    v_exp_f32 v165, v165
    v_mfma_f32_16x16x32_bf16 v[96:99], v[44:47], a[196:199], v[96:99]
    v_mul_f32 v166, v132, v148
    v_mul_f32 v167, v133, v149
    v_mfma_f32_16x16x32_bf16 v[96:99], v[48:51], a[200:203], v[96:99]
    v_mul_f32 v168, v134, v150
    v_mul_f32 v169, v135, v151
    v_mfma_f32_16x16x32_bf16 v[100:103], v[40:43], v[228:231], v[100:103]
    buffer_load_dwordx4 v[36:39], v190, s[48:51], s23 offen offset:2048 sc1
    v_mfma_f32_16x16x32_bf16 v[100:103], v[44:47], v[232:235], v[100:103]
    v_fma_f32 v162, v162, v252, v252
    v_fma_f32 v163, v163, v252, v252
    v_mfma_f32_16x16x32_bf16 v[100:103], v[48:51], v[236:239], v[100:103]
    v_fma_f32 v164, v164, v252, v252
    v_fma_f32 v165, v165, v252, v252
    s_waitcnt vmcnt(12)
    v_mfma_f32_16x16x32_bf16 v[104:107], v[52:55], a[48:51], v[104:107]
    v_rcp_f32 v162, v162
    v_mfma_f32_16x16x32_bf16 v[104:107], v[56:59], a[52:55], v[104:107]
    buffer_load_dwordx4 v[40:43], v190, s[48:51], s23 offen offset:3072 sc1
    v_mfma_f32_16x16x32_bf16 v[104:107], v[60:63], a[56:59], v[104:107]
    v_rcp_f32 v163, v163
    v_mfma_f32_16x16x32_bf16 v[108:111], v[52:55], a[120:123], v[108:111]
    v_rcp_f32 v164, v164
    v_mfma_f32_16x16x32_bf16 v[108:111], v[56:59], a[124:127], v[108:111]
    v_rcp_f32 v165, v165
    v_mfma_f32_16x16x32_bf16 v[108:111], v[60:63], a[128:131], v[108:111]
    buffer_load_dwordx4 v[44:47], v191, s[48:51], s23 offen offset:0 sc1
    v_mfma_f32_16x16x32_bf16 v[112:115], v[52:55], a[192:195], v[112:115]
    v_mul_f32 v166, v166, v162
    v_mul_f32 v167, v167, v163
    v_mfma_f32_16x16x32_bf16 v[112:115], v[56:59], a[196:199], v[112:115]
    v_mul_f32 v168, v168, v164
    v_mul_f32 v169, v169, v165
    v_mfma_f32_16x16x32_bf16 v[112:115], v[60:63], a[200:203], v[112:115]
    v_cvt_pk_bf16_f32 v170, v166, v167
    v_cvt_pk_bf16_f32 v171, v168, v169
    v_mfma_f32_16x16x32_bf16 v[116:119], v[52:55], v[228:231], v[116:119]
    buffer_load_dwordx4 v[48:51], v191, s[48:51], s23 offen offset:1024 sc1
    v_mfma_f32_16x16x32_bf16 v[116:119], v[56:59], v[232:235], v[116:119]
    ds_write_b64 v12, v[170:171] offset:55296
    v_mfma_f32_16x16x32_bf16 v[116:119], v[60:63], v[236:239], v[116:119]
    s_waitcnt vmcnt(12)
    v_mfma_f32_16x16x32_bf16 v[88:91], v[64:67], a[60:63], v[88:91]
    v_mfma_f32_16x16x32_bf16 v[88:91], v[68:71], a[64:67], v[88:91]
    buffer_load_dwordx4 v[52:55], v191, s[48:51], s23 offen offset:2048 sc1
    v_mfma_f32_16x16x32_bf16 v[120:123], v[72:75], a[68:71], v[88:91]
    v_mfma_f32_16x16x32_bf16 v[92:95], v[64:67], a[132:135], v[92:95]
    v_mfma_f32_16x16x32_bf16 v[92:95], v[68:71], a[136:139], v[92:95]
    v_mfma_f32_16x16x32_bf16 v[124:127], v[72:75], a[140:143], v[92:95]
    buffer_load_dwordx4 v[56:59], v191, s[48:51], s23 offen offset:3072 sc1
    v_mfma_f32_16x16x32_bf16 v[96:99], v[64:67], a[204:207], v[96:99]
    v_mfma_f32_16x16x32_bf16 v[96:99], v[68:71], a[208:211], v[96:99]
    v_mfma_f32_16x16x32_bf16 v[128:131], v[72:75], a[212:215], v[96:99]
    v_mfma_f32_16x16x32_bf16 v[100:103], v[64:67], v[240:243], v[100:103]
    buffer_load_dwordx4 v[60:63], v192, s[48:51], s23 offen offset:0 sc1
    v_mfma_f32_16x16x32_bf16 v[100:103], v[68:71], v[244:247], v[100:103]
    v_mfma_f32_16x16x32_bf16 v[132:135], v[72:75], v[248:251], v[100:103]
    s_waitcnt vmcnt(12)
    v_mfma_f32_16x16x32_bf16 v[104:107], v[76:79], a[60:63], v[104:107]
    v_mfma_f32_16x16x32_bf16 v[104:107], v[80:83], a[64:67], v[104:107]
    buffer_load_dwordx4 v[64:67], v192, s[48:51], s23 offen offset:1024 sc1
    v_mfma_f32_16x16x32_bf16 v[136:139], v[84:87], a[68:71], v[104:107]
    v_mfma_f32_16x16x32_bf16 v[108:111], v[76:79], a[132:135], v[108:111]
    v_mfma_f32_16x16x32_bf16 v[108:111], v[80:83], a[136:139], v[108:111]
    v_mfma_f32_16x16x32_bf16 v[140:143], v[84:87], a[140:143], v[108:111]
    buffer_load_dwordx4 v[68:71], v192, s[48:51], s23 offen offset:2048 sc1
    v_mfma_f32_16x16x32_bf16 v[112:115], v[76:79], a[204:207], v[112:115]
    v_mfma_f32_16x16x32_bf16 v[112:115], v[80:83], a[208:211], v[112:115]
    s_lshl_b32 s7, s25, 11
    v_mfma_f32_16x16x32_bf16 v[144:147], v[84:87], a[212:215], v[112:115]
    s_add_u32 s7, s7, s28
    v_mfma_f32_16x16x32_bf16 v[116:119], v[76:79], v[240:243], v[116:119]
    buffer_load_dwordx4 v[72:75], v192, s[48:51], s23 offen offset:3072 sc1
    v_mfma_f32_16x16x32_bf16 v[116:119], v[80:83], v[244:247], v[116:119]
    s_add_u32 s23, s23, 36864
    v_mfma_f32_16x16x32_bf16 v[148:151], v[84:87], v[248:251], v[116:119]
    v_add_u32 v12, s7, v184
    s_add_u32 s25, s25, 1
    s_cmp_lt_u32 s25, 8
    s_cbranch_scc1 L_ffn_gu_34
    v_add_u32 v10, 73728, v184
    v_add_u32 v11, 110592, v184
    s_lshr_b32 s7, s2, 3
    s_lshl_b32 s7, s7, 2
    s_add_u32 s7, s7, s3
    s_lshl_b32 s7, s7, 9
    v_lshrrev_b32 v1, 1, v253
    v_add_u32 v1, s7, v1
    buffer_load_dwordx2 v[2:3], v1, s[96:99], 0 offen
    s_waitcnt lgkmcnt(0)
    s_barrier
    s_waitcnt vmcnt(12)
    v_mfma_f32_16x16x32_bf16 v[88:91], v[16:19], a[0:3], 0
    v_mfma_f32_16x16x32_bf16 v[88:91], v[20:23], a[4:7], v[88:91]
    buffer_load_dwordx4 v[76:79], v184, s[48:51], s23 offen offset:0 sc1
    v_mfma_f32_16x16x32_bf16 v[88:91], v[24:27], a[8:11], v[88:91]
    v_mul_f32 v152, v120, v120
    v_mul_f32 v153, v121, v121
    v_mfma_f32_16x16x32_bf16 v[92:95], v[16:19], a[72:75], 0
    v_mul_f32 v154, v122, v122
    v_mul_f32 v155, v123, v123
    v_mfma_f32_16x16x32_bf16 v[92:95], v[20:23], a[76:79], v[92:95]
    v_fma_f32 v152, v152, v8, v4
    v_fma_f32 v153, v153, v8, v4
    v_mfma_f32_16x16x32_bf16 v[92:95], v[24:27], a[80:83], v[92:95]
    buffer_load_dwordx4 v[80:83], v184, s[48:51], s23 offen offset:1024 sc1
    v_mfma_f32_16x16x32_bf16 v[96:99], v[16:19], a[144:147], 0
    v_fma_f32 v154, v154, v8, v4
    v_fma_f32 v155, v155, v8, v4
    v_mfma_f32_16x16x32_bf16 v[96:99], v[20:23], a[148:151], v[96:99]
    v_mul_f32 v152, v120, v152
    v_mul_f32 v153, v121, v153
    v_mfma_f32_16x16x32_bf16 v[96:99], v[24:27], a[152:155], v[96:99]
    v_mul_f32 v154, v122, v154
    v_mul_f32 v155, v123, v155
    v_mfma_f32_16x16x32_bf16 v[100:103], v[16:19], a[216:219], 0
    buffer_load_dwordx4 v[84:87], v184, s[48:51], s23 offen offset:2048 sc1
    v_mfma_f32_16x16x32_bf16 v[100:103], v[20:23], a[220:223], v[100:103]
    v_exp_f32 v152, v152
    v_mfma_f32_16x16x32_bf16 v[100:103], v[24:27], a[224:227], v[100:103]
    v_exp_f32 v153, v153
    s_waitcnt vmcnt(12)
    v_mfma_f32_16x16x32_bf16 v[104:107], v[28:31], a[0:3], 0
    v_exp_f32 v154, v154
    ds_read_b128 a[0:3], v10 offset:0
    v_mfma_f32_16x16x32_bf16 v[104:107], v[32:35], a[4:7], v[104:107]
    buffer_load_dwordx4 v[16:19], v184, s[48:51], s23 offen offset:3072 sc1
    v_mfma_f32_16x16x32_bf16 v[104:107], v[36:39], a[8:11], v[104:107]
    v_exp_f32 v155, v155
    v_mfma_f32_16x16x32_bf16 v[108:111], v[28:31], a[72:75], 0
    v_mul_f32 v156, v120, v136
    v_mul_f32 v157, v121, v137
    ds_read_b128 a[72:75], v10 offset:18432
    v_mfma_f32_16x16x32_bf16 v[108:111], v[32:35], a[76:79], v[108:111]
    v_mul_f32 v158, v122, v138
    v_mul_f32 v159, v123, v139
    v_mfma_f32_16x16x32_bf16 v[108:111], v[36:39], a[80:83], v[108:111]
    buffer_load_dwordx4 v[20:23], v185, s[48:51], s23 offen offset:0 sc1
    v_mfma_f32_16x16x32_bf16 v[112:115], v[28:31], a[144:147], 0
    v_fma_f32 v152, v152, v193, v193
    v_fma_f32 v153, v153, v193, v193
    ds_read_b128 a[144:147], v11 offset:0
    v_mfma_f32_16x16x32_bf16 v[112:115], v[32:35], a[148:151], v[112:115]
    v_fma_f32 v154, v154, v193, v193
    v_fma_f32 v155, v155, v193, v193
    v_mfma_f32_16x16x32_bf16 v[112:115], v[36:39], a[152:155], v[112:115]
    v_rcp_f32 v152, v152
    v_mfma_f32_16x16x32_bf16 v[116:119], v[28:31], a[216:219], 0
    buffer_load_dwordx4 v[24:27], v185, s[48:51], s23 offen offset:1024 sc1
    v_mfma_f32_16x16x32_bf16 v[116:119], v[32:35], a[220:223], v[116:119]
    v_rcp_f32 v153, v153
    ds_read_b128 a[216:219], v11 offset:18432
    v_mfma_f32_16x16x32_bf16 v[116:119], v[36:39], a[224:227], v[116:119]
    v_rcp_f32 v154, v154
    ds_read_b128 a[4:7], v10 offset:1024
    s_waitcnt vmcnt(12)
    v_mfma_f32_16x16x32_bf16 v[88:91], v[40:43], a[12:15], v[88:91]
    v_rcp_f32 v155, v155
    ds_read_b128 a[76:79], v10 offset:19456
    v_mfma_f32_16x16x32_bf16 v[88:91], v[44:47], a[16:19], v[88:91]
    buffer_load_dwordx4 v[28:31], v185, s[48:51], s23 offen offset:2048 sc1
    v_mfma_f32_16x16x32_bf16 v[88:91], v[48:51], a[20:23], v[88:91]
    v_mul_f32 v156, v156, v152
    v_mul_f32 v157, v157, v153
    ds_read_b128 a[148:151], v11 offset:1024
    v_mfma_f32_16x16x32_bf16 v[92:95], v[40:43], a[84:87], v[92:95]
    v_mul_f32 v158, v158, v154
    v_mul_f32 v159, v159, v155
    ds_read_b128 a[220:223], v11 offset:19456
    v_mfma_f32_16x16x32_bf16 v[92:95], v[44:47], a[88:91], v[92:95]
    v_cvt_pk_bf16_f32 v160, v156, v157
    v_cvt_pk_bf16_f32 v161, v158, v159
    ds_read_b128 a[8:11], v10 offset:2048
    v_mfma_f32_16x16x32_bf16 v[92:95], v[48:51], a[92:95], v[92:95]
    buffer_load_dwordx4 v[32:35], v185, s[48:51], s23 offen offset:3072 sc1
    v_mfma_f32_16x16x32_bf16 v[96:99], v[40:43], a[156:159], v[96:99]
    ds_write_b64 v12, v[160:161] offset:0
    v_mfma_f32_16x16x32_bf16 v[96:99], v[44:47], a[160:163], v[96:99]
    v_mul_f32 v162, v124, v124
    v_mul_f32 v163, v125, v125
    ds_read_b128 a[80:83], v10 offset:20480
    v_mfma_f32_16x16x32_bf16 v[96:99], v[48:51], a[164:167], v[96:99]
    v_mul_f32 v164, v126, v126
    v_mul_f32 v165, v127, v127
    ds_read_b128 a[152:155], v11 offset:2048
    v_mfma_f32_16x16x32_bf16 v[100:103], v[40:43], a[228:231], v[100:103]
    buffer_load_dwordx4 v[36:39], v186, s[48:51], s23 offen offset:0 sc1
    v_mfma_f32_16x16x32_bf16 v[100:103], v[44:47], a[232:235], v[100:103]
    v_fma_f32 v162, v162, v9, v5
    v_fma_f32 v163, v163, v9, v5
    ds_read_b128 a[224:227], v11 offset:20480
    v_mfma_f32_16x16x32_bf16 v[100:103], v[48:51], a[236:239], v[100:103]
    v_fma_f32 v164, v164, v9, v5
    v_fma_f32 v165, v165, v9, v5
    s_waitcnt vmcnt(12)
    v_mfma_f32_16x16x32_bf16 v[104:107], v[52:55], a[12:15], v[104:107]
    v_mul_f32 v162, v124, v162
    v_mul_f32 v163, v125, v163
    ds_read_b128 a[12:15], v10 offset:3072
    v_mfma_f32_16x16x32_bf16 v[104:107], v[56:59], a[16:19], v[104:107]
    buffer_load_dwordx4 v[40:43], v186, s[48:51], s23 offen offset:1024 sc1
    v_mfma_f32_16x16x32_bf16 v[104:107], v[60:63], a[20:23], v[104:107]
    v_mul_f32 v164, v126, v164
    v_mul_f32 v165, v127, v165
    v_mfma_f32_16x16x32_bf16 v[108:111], v[52:55], a[84:87], v[108:111]
    v_exp_f32 v162, v162
    ds_read_b128 a[84:87], v10 offset:21504
    v_mfma_f32_16x16x32_bf16 v[108:111], v[56:59], a[88:91], v[108:111]
    v_exp_f32 v163, v163
    v_mfma_f32_16x16x32_bf16 v[108:111], v[60:63], a[92:95], v[108:111]
    buffer_load_dwordx4 v[44:47], v186, s[48:51], s23 offen offset:2048 sc1
    v_mfma_f32_16x16x32_bf16 v[112:115], v[52:55], a[156:159], v[112:115]
    v_exp_f32 v164, v164
    ds_read_b128 a[156:159], v11 offset:3072
    v_mfma_f32_16x16x32_bf16 v[112:115], v[56:59], a[160:163], v[112:115]
    v_exp_f32 v165, v165
    v_mfma_f32_16x16x32_bf16 v[112:115], v[60:63], a[164:167], v[112:115]
    v_mul_f32 v166, v124, v140
    v_mul_f32 v167, v125, v141
    v_mfma_f32_16x16x32_bf16 v[116:119], v[52:55], a[228:231], v[116:119]
    buffer_load_dwordx4 v[48:51], v186, s[48:51], s23 offen offset:3072 sc1
    v_mfma_f32_16x16x32_bf16 v[116:119], v[56:59], a[232:235], v[116:119]
    v_mul_f32 v168, v126, v142
    v_mul_f32 v169, v127, v143
    ds_read_b128 a[228:231], v11 offset:21504
    v_mfma_f32_16x16x32_bf16 v[116:119], v[60:63], a[236:239], v[116:119]
    v_fma_f32 v162, v162, v194, v194
    v_fma_f32 v163, v163, v194, v194
    ds_read_b128 a[16:19], v10 offset:4096
    s_waitcnt vmcnt(12)
    v_mfma_f32_16x16x32_bf16 v[88:91], v[64:67], a[24:27], v[88:91]
    v_fma_f32 v164, v164, v194, v194
    v_fma_f32 v165, v165, v194, v194
    ds_read_b128 a[88:91], v10 offset:22528
    v_mfma_f32_16x16x32_bf16 v[88:91], v[68:71], a[28:31], v[88:91]
    buffer_load_dwordx4 v[52:55], v187, s[48:51], s23 offen offset:0 sc1
    v_mfma_f32_16x16x32_bf16 v[88:91], v[72:75], a[32:35], v[88:91]
    v_rcp_f32 v162, v162
    ds_read_b128 a[160:163], v11 offset:4096
    v_mfma_f32_16x16x32_bf16 v[92:95], v[64:67], a[96:99], v[92:95]
    v_rcp_f32 v163, v163
    ds_read_b128 a[232:235], v11 offset:22528
    v_mfma_f32_16x16x32_bf16 v[92:95], v[68:71], a[100:103], v[92:95]
    v_rcp_f32 v164, v164
    ds_read_b128 a[20:23], v10 offset:5120
    v_mfma_f32_16x16x32_bf16 v[92:95], v[72:75], a[104:107], v[92:95]
    buffer_load_dwordx4 v[56:59], v187, s[48:51], s23 offen offset:1024 sc1
    v_mfma_f32_16x16x32_bf16 v[96:99], v[64:67], a[168:171], v[96:99]
    v_rcp_f32 v165, v165
    ds_read_b128 a[92:95], v10 offset:23552
    v_mfma_f32_16x16x32_bf16 v[96:99], v[68:71], a[172:175], v[96:99]
    v_mul_f32 v166, v166, v162
    v_mul_f32 v167, v167, v163
    ds_read_b128 a[164:167], v11 offset:5120
    v_mfma_f32_16x16x32_bf16 v[96:99], v[72:75], a[176:179], v[96:99]
    v_mul_f32 v168, v168, v164
    v_mul_f32 v169, v169, v165
    ds_read_b128 a[236:239], v11 offset:23552
    v_mfma_f32_16x16x32_bf16 v[100:103], v[64:67], a[240:243], v[100:103]
    buffer_load_dwordx4 v[60:63], v187, s[48:51], s23 offen offset:2048 sc1
    v_mfma_f32_16x16x32_bf16 v[100:103], v[68:71], a[244:247], v[100:103]
    v_cvt_pk_bf16_f32 v170, v166, v167
    v_cvt_pk_bf16_f32 v171, v168, v169
    v_mfma_f32_16x16x32_bf16 v[100:103], v[72:75], a[248:251], v[100:103]
    ds_write_b64 v12, v[170:171] offset:18432
    s_waitcnt vmcnt(12)
    v_mfma_f32_16x16x32_bf16 v[104:107], v[76:79], a[24:27], v[104:107]
    v_mul_f32 v152, v128, v128
    v_mul_f32 v153, v129, v129
    ds_read_b128 a[24:27], v10 offset:6144
    v_mfma_f32_16x16x32_bf16 v[104:107], v[80:83], a[28:31], v[104:107]
    buffer_load_dwordx4 v[64:67], v187, s[48:51], s23 offen offset:3072 sc1
    v_mfma_f32_16x16x32_bf16 v[104:107], v[84:87], a[32:35], v[104:107]
    v_mul_f32 v154, v130, v130
    v_mul_f32 v155, v131, v131
    v_mfma_f32_16x16x32_bf16 v[108:111], v[76:79], a[96:99], v[108:111]
    v_fma_f32 v152, v152, v13, v6
    v_fma_f32 v153, v153, v13, v6
    ds_read_b128 a[96:99], v10 offset:24576
    v_mfma_f32_16x16x32_bf16 v[108:111], v[80:83], a[100:103], v[108:111]
    v_fma_f32 v154, v154, v13, v6
    v_fma_f32 v155, v155, v13, v6
    v_mfma_f32_16x16x32_bf16 v[108:111], v[84:87], a[104:107], v[108:111]
    buffer_load_dwordx4 v[68:71], v188, s[48:51], s23 offen offset:0 sc1
    v_mfma_f32_16x16x32_bf16 v[112:115], v[76:79], a[168:171], v[112:115]
    v_mul_f32 v152, v128, v152
    v_mul_f32 v153, v129, v153
    ds_read_b128 a[168:171], v11 offset:6144
    v_mfma_f32_16x16x32_bf16 v[112:115], v[80:83], a[172:175], v[112:115]
    v_mul_f32 v154, v130, v154
    v_mul_f32 v155, v131, v155
    v_mfma_f32_16x16x32_bf16 v[112:115], v[84:87], a[176:179], v[112:115]
    v_exp_f32 v152, v152
    v_mfma_f32_16x16x32_bf16 v[116:119], v[76:79], a[240:243], v[116:119]
    buffer_load_dwordx4 v[72:75], v188, s[48:51], s23 offen offset:1024 sc1
    v_mfma_f32_16x16x32_bf16 v[116:119], v[80:83], a[244:247], v[116:119]
    v_exp_f32 v153, v153
    ds_read_b128 a[240:243], v11 offset:24576
    v_mfma_f32_16x16x32_bf16 v[116:119], v[84:87], a[248:251], v[116:119]
    v_exp_f32 v154, v154
    ds_read_b128 a[28:31], v10 offset:7168
    s_waitcnt vmcnt(12)
    v_mfma_f32_16x16x32_bf16 v[88:91], v[16:19], a[36:39], v[88:91]
    v_exp_f32 v155, v155
    ds_read_b128 a[100:103], v10 offset:25600
    v_mfma_f32_16x16x32_bf16 v[88:91], v[20:23], a[40:43], v[88:91]
    buffer_load_dwordx4 v[76:79], v188, s[48:51], s23 offen offset:2048 sc1
    v_mfma_f32_16x16x32_bf16 v[88:91], v[24:27], a[44:47], v[88:91]
    v_mul_f32 v156, v128, v144
    v_mul_f32 v157, v129, v145
    ds_read_b128 a[172:175], v11 offset:7168
    v_mfma_f32_16x16x32_bf16 v[92:95], v[16:19], a[108:111], v[92:95]
    v_mul_f32 v158, v130, v146
    v_mul_f32 v159, v131, v147
    ds_read_b128 a[244:247], v11 offset:25600
    v_mfma_f32_16x16x32_bf16 v[92:95], v[20:23], a[112:115], v[92:95]
    v_fma_f32 v152, v152, v195, v195
    v_fma_f32 v153, v153, v195, v195
    ds_read_b128 a[32:35], v10 offset:8192
    v_mfma_f32_16x16x32_bf16 v[92:95], v[24:27], a[116:119], v[92:95]
    buffer_load_dwordx4 v[80:83], v188, s[48:51], s23 offen offset:3072 sc1
    v_mfma_f32_16x16x32_bf16 v[96:99], v[16:19], a[180:183], v[96:99]
    v_fma_f32 v154, v154, v195, v195
    v_fma_f32 v155, v155, v195, v195
    ds_read_b128 a[104:107], v10 offset:26624
    v_mfma_f32_16x16x32_bf16 v[96:99], v[20:23], a[184:187], v[96:99]
    v_rcp_f32 v152, v152
    ds_read_b128 a[176:179], v11 offset:8192
    v_mfma_f32_16x16x32_bf16 v[96:99], v[24:27], a[188:191], v[96:99]
    v_rcp_f32 v153, v153
    ds_read_b128 a[248:251], v11 offset:26624
    v_mfma_f32_16x16x32_bf16 v[100:103], v[16:19], a[252:255], v[100:103]
    buffer_load_dwordx4 v[84:87], v189, s[48:51], s23 offen offset:0 sc1
    v_mfma_f32_16x16x32_bf16 v[100:103], v[20:23], v[220:223], v[100:103]
    v_rcp_f32 v154, v154
    v_mfma_f32_16x16x32_bf16 v[100:103], v[24:27], v[224:227], v[100:103]
    v_rcp_f32 v155, v155
    s_waitcnt vmcnt(12)
    v_mfma_f32_16x16x32_bf16 v[104:107], v[28:31], a[36:39], v[104:107]
    v_mul_f32 v156, v156, v152
    v_mul_f32 v157, v157, v153
    ds_read_b128 a[36:39], v10 offset:9216
    v_mfma_f32_16x16x32_bf16 v[104:107], v[32:35], a[40:43], v[104:107]
    buffer_load_dwordx4 v[16:19], v189, s[48:51], s23 offen offset:1024 sc1
    v_mfma_f32_16x16x32_bf16 v[104:107], v[36:39], a[44:47], v[104:107]
    v_mul_f32 v158, v158, v154
    v_mul_f32 v159, v159, v155
    v_mfma_f32_16x16x32_bf16 v[108:111], v[28:31], a[108:111], v[108:111]
    v_cvt_pk_bf16_f32 v160, v156, v157
    v_cvt_pk_bf16_f32 v161, v158, v159
    ds_read_b128 a[108:111], v10 offset:27648
    v_mfma_f32_16x16x32_bf16 v[108:111], v[32:35], a[112:115], v[108:111]
    ds_write_b64 v12, v[160:161] offset:36864
    v_mfma_f32_16x16x32_bf16 v[108:111], v[36:39], a[116:119], v[108:111]
    buffer_load_dwordx4 v[20:23], v189, s[48:51], s23 offen offset:2048 sc1
    v_mfma_f32_16x16x32_bf16 v[112:115], v[28:31], a[180:183], v[112:115]
    v_mul_f32 v162, v132, v132
    v_mul_f32 v163, v133, v133
    ds_read_b128 a[180:183], v11 offset:9216
    v_mfma_f32_16x16x32_bf16 v[112:115], v[32:35], a[184:187], v[112:115]
    v_mul_f32 v164, v134, v134
    v_mul_f32 v165, v135, v135
    v_mfma_f32_16x16x32_bf16 v[112:115], v[36:39], a[188:191], v[112:115]
    v_fma_f32 v162, v162, v14, v7
    v_fma_f32 v163, v163, v14, v7
    v_mfma_f32_16x16x32_bf16 v[116:119], v[28:31], a[252:255], v[116:119]
    buffer_load_dwordx4 v[24:27], v189, s[48:51], s23 offen offset:3072 sc1
    v_mfma_f32_16x16x32_bf16 v[116:119], v[32:35], v[220:223], v[116:119]
    v_fma_f32 v164, v164, v14, v7
    v_fma_f32 v165, v165, v14, v7
    ds_read_b128 a[252:255], v11 offset:27648
    v_mfma_f32_16x16x32_bf16 v[116:119], v[36:39], v[224:227], v[116:119]
    v_mul_f32 v162, v132, v162
    v_mul_f32 v163, v133, v163
    ds_read_b128 a[40:43], v10 offset:10240
    s_waitcnt vmcnt(12)
    v_mfma_f32_16x16x32_bf16 v[88:91], v[40:43], a[48:51], v[88:91]
    v_mul_f32 v164, v134, v164
    v_mul_f32 v165, v135, v165
    ds_read_b128 a[112:115], v10 offset:28672
    v_mfma_f32_16x16x32_bf16 v[88:91], v[44:47], a[52:55], v[88:91]
    buffer_load_dwordx4 v[28:31], v190, s[48:51], s23 offen offset:0 sc1
    v_mfma_f32_16x16x32_bf16 v[88:91], v[48:51], a[56:59], v[88:91]
    v_exp_f32 v162, v162
    ds_read_b128 a[184:187], v11 offset:10240
    v_mfma_f32_16x16x32_bf16 v[92:95], v[40:43], a[120:123], v[92:95]
    v_exp_f32 v163, v163
    ds_read_b128 v[220:223], v11 offset:28672
    v_mfma_f32_16x16x32_bf16 v[92:95], v[44:47], a[124:127], v[92:95]
    v_exp_f32 v164, v164
    ds_read_b128 a[44:47], v10 offset:11264
    v_mfma_f32_16x16x32_bf16 v[92:95], v[48:51], a[128:131], v[92:95]
    buffer_load_dwordx4 v[32:35], v190, s[48:51], s23 offen offset:1024 sc1
    v_mfma_f32_16x16x32_bf16 v[96:99], v[40:43], a[192:195], v[96:99]
    v_exp_f32 v165, v165
    ds_read_b128 a[116:119], v10 offset:29696
    v_mfma_f32_16x16x32_bf16 v[96:99], v[44:47], a[196:199], v[96:99]
    v_mul_f32 v166, v132, v148
    v_mul_f32 v167, v133, v149
    ds_read_b128 a[188:191], v11 offset:11264
    v_mfma_f32_16x16x32_bf16 v[96:99], v[48:51], a[200:203], v[96:99]
    v_mul_f32 v168, v134, v150
    v_mul_f32 v169, v135, v151
    ds_read_b128 v[224:227], v11 offset:29696
    v_mfma_f32_16x16x32_bf16 v[100:103], v[40:43], v[228:231], v[100:103]
    buffer_load_dwordx4 v[36:39], v190, s[48:51], s23 offen offset:2048 sc1
    v_mfma_f32_16x16x32_bf16 v[100:103], v[44:47], v[232:235], v[100:103]
    v_fma_f32 v162, v162, v252, v252
    v_fma_f32 v163, v163, v252, v252
    v_mfma_f32_16x16x32_bf16 v[100:103], v[48:51], v[236:239], v[100:103]
    v_fma_f32 v164, v164, v252, v252
    v_fma_f32 v165, v165, v252, v252
    s_waitcnt vmcnt(12)
    v_mfma_f32_16x16x32_bf16 v[104:107], v[52:55], a[48:51], v[104:107]
    v_rcp_f32 v162, v162
    ds_read_b128 a[48:51], v10 offset:12288
    v_mfma_f32_16x16x32_bf16 v[104:107], v[56:59], a[52:55], v[104:107]
    buffer_load_dwordx4 v[40:43], v190, s[48:51], s23 offen offset:3072 sc1
    v_mfma_f32_16x16x32_bf16 v[104:107], v[60:63], a[56:59], v[104:107]
    v_rcp_f32 v163, v163
    v_mfma_f32_16x16x32_bf16 v[108:111], v[52:55], a[120:123], v[108:111]
    v_rcp_f32 v164, v164
    ds_read_b128 a[120:123], v10 offset:30720
    v_mfma_f32_16x16x32_bf16 v[108:111], v[56:59], a[124:127], v[108:111]
    v_rcp_f32 v165, v165
    v_mfma_f32_16x16x32_bf16 v[108:111], v[60:63], a[128:131], v[108:111]
    buffer_load_dwordx4 v[44:47], v191, s[48:51], s23 offen offset:0 sc1
    v_mfma_f32_16x16x32_bf16 v[112:115], v[52:55], a[192:195], v[112:115]
    v_mul_f32 v166, v166, v162
    v_mul_f32 v167, v167, v163
    ds_read_b128 a[192:195], v11 offset:12288
    v_mfma_f32_16x16x32_bf16 v[112:115], v[56:59], a[196:199], v[112:115]
    v_mul_f32 v168, v168, v164
    v_mul_f32 v169, v169, v165
    v_mfma_f32_16x16x32_bf16 v[112:115], v[60:63], a[200:203], v[112:115]
    v_cvt_pk_bf16_f32 v170, v166, v167
    v_cvt_pk_bf16_f32 v171, v168, v169
    v_mfma_f32_16x16x32_bf16 v[116:119], v[52:55], v[228:231], v[116:119]
    buffer_load_dwordx4 v[48:51], v191, s[48:51], s23 offen offset:1024 sc1
    v_mfma_f32_16x16x32_bf16 v[116:119], v[56:59], v[232:235], v[116:119]
    ds_write_b64 v12, v[170:171] offset:55296
    v_mfma_f32_16x16x32_bf16 v[116:119], v[60:63], v[236:239], v[116:119]
    ds_read_b128 v[228:231], v11 offset:30720
    s_waitcnt vmcnt(12)
    v_mfma_f32_16x16x32_bf16 v[88:91], v[64:67], a[60:63], v[88:91]
    ds_read_b128 a[52:55], v10 offset:13312
    v_mfma_f32_16x16x32_bf16 v[88:91], v[68:71], a[64:67], v[88:91]
    buffer_load_dwordx4 v[52:55], v191, s[48:51], s23 offen offset:2048 sc1
    v_mfma_f32_16x16x32_bf16 v[120:123], v[72:75], a[68:71], v[88:91]
    ds_read_b128 a[124:127], v10 offset:31744
    v_mfma_f32_16x16x32_bf16 v[92:95], v[64:67], a[132:135], v[92:95]
    ds_read_b128 a[196:199], v11 offset:13312
    v_mfma_f32_16x16x32_bf16 v[92:95], v[68:71], a[136:139], v[92:95]
    ds_read_b128 v[232:235], v11 offset:31744
    v_mfma_f32_16x16x32_bf16 v[124:127], v[72:75], a[140:143], v[92:95]
    buffer_load_dwordx4 v[56:59], v191, s[48:51], s23 offen offset:3072 sc1
    v_mfma_f32_16x16x32_bf16 v[96:99], v[64:67], a[204:207], v[96:99]
    v_mfma_f32_16x16x32_bf16 v[96:99], v[68:71], a[208:211], v[96:99]
    v_mfma_f32_16x16x32_bf16 v[128:131], v[72:75], a[212:215], v[96:99]
    v_mfma_f32_16x16x32_bf16 v[100:103], v[64:67], v[240:243], v[100:103]
    buffer_load_dwordx4 v[60:63], v192, s[48:51], s23 offen offset:0 sc1
    v_mfma_f32_16x16x32_bf16 v[100:103], v[68:71], v[244:247], v[100:103]
    v_mfma_f32_16x16x32_bf16 v[132:135], v[72:75], v[248:251], v[100:103]
    s_waitcnt vmcnt(12)
    v_mfma_f32_16x16x32_bf16 v[104:107], v[76:79], a[60:63], v[104:107]
    v_mfma_f32_16x16x32_bf16 v[104:107], v[80:83], a[64:67], v[104:107]
    buffer_load_dwordx4 v[64:67], v192, s[48:51], s23 offen offset:1024 sc1
    v_mfma_f32_16x16x32_bf16 v[136:139], v[84:87], a[68:71], v[104:107]
    v_mfma_f32_16x16x32_bf16 v[108:111], v[76:79], a[132:135], v[108:111]
    v_mfma_f32_16x16x32_bf16 v[108:111], v[80:83], a[136:139], v[108:111]
    v_mfma_f32_16x16x32_bf16 v[140:143], v[84:87], a[140:143], v[108:111]
    buffer_load_dwordx4 v[68:71], v192, s[48:51], s23 offen offset:2048 sc1
    v_mfma_f32_16x16x32_bf16 v[112:115], v[76:79], a[204:207], v[112:115]
    v_mfma_f32_16x16x32_bf16 v[112:115], v[80:83], a[208:211], v[112:115]
    s_lshl_b32 s7, s25, 11
    v_mfma_f32_16x16x32_bf16 v[144:147], v[84:87], a[212:215], v[112:115]
    s_add_u32 s7, s7, s28
    v_mfma_f32_16x16x32_bf16 v[116:119], v[76:79], v[240:243], v[116:119]
    buffer_load_dwordx4 v[72:75], v192, s[48:51], s23 offen offset:3072 sc1
    v_mfma_f32_16x16x32_bf16 v[116:119], v[80:83], v[244:247], v[116:119]
    s_add_u32 s23, s23, 36864
    v_mfma_f32_16x16x32_bf16 v[148:151], v[84:87], v[248:251], v[116:119]
    v_add_u32 v12, s7, v184
    s_add_u32 s25, s25, 1
    s_waitcnt lgkmcnt(0)
    s_barrier
    v_pk_mul_f32 v[152:153], v[120:121], v[120:121]
    ds_read_b128 a[56:59], v10 offset:14336
    v_pk_mul_f32 v[154:155], v[122:123], v[122:123]
    ds_read_b128 a[128:131], v10 offset:32768
    v_pk_fma_f32 v[152:153], v[152:153], v[8:9], v[4:5] op_sel:[0,0,0] op_sel_hi:[1,0,0]
    ds_read_b128 a[200:203], v11 offset:14336
    v_pk_fma_f32 v[154:155], v[154:155], v[8:9], v[4:5] op_sel:[0,0,0] op_sel_hi:[1,0,0]
    v_pk_mul_f32 v[152:153], v[120:121], v[152:153]
    ds_read_b128 v[236:239], v11 offset:32768
    v_pk_mul_f32 v[154:155], v[122:123], v[154:155]
    ds_read_b128 a[60:63], v10 offset:15360
    buffer_load_dwordx4 v[76:79], v184, s[48:51], s23 offen offset:0 sc1
    v_exp_f32 v152, v152
    ds_read_b128 a[132:135], v10 offset:33792
    v_exp_f32 v153, v153
    v_exp_f32 v154, v154
    ds_read_b128 a[204:207], v11 offset:15360
    v_exp_f32 v155, v155
    ds_read_b128 v[240:243], v11 offset:33792
    v_pk_mul_f32 v[156:157], v[120:121], v[136:137]
    v_pk_mul_f32 v[158:159], v[122:123], v[138:139]
    buffer_load_dwordx4 v[80:83], v184, s[48:51], s23 offen offset:1024 sc1
    v_pk_fma_f32 v[152:153], v[152:153], v[192:193], v[192:193] op_sel:[0,1,1] op_sel_hi:[1,1,1]
    v_pk_fma_f32 v[154:155], v[154:155], v[192:193], v[192:193] op_sel:[0,1,1] op_sel_hi:[1,1,1]
    v_rcp_f32 v152, v152
    v_rcp_f32 v153, v153
    v_rcp_f32 v154, v154
    v_rcp_f32 v155, v155
    buffer_load_dwordx4 v[84:87], v184, s[48:51], s23 offen offset:2048 sc1
    s_nop 0
    v_pk_mul_f32 v[156:157], v[156:157], v[152:153]
    v_pk_mul_f32 v[158:159], v[158:159], v[154:155]
    v_cvt_pk_bf16_f32 v160, v156, v157
    v_cvt_pk_bf16_f32 v161, v158, v159
    ds_write_b64 v12, v[160:161] offset:0
    buffer_load_dwordx4 v[104:107], v184, s[48:51], s23 offen offset:3072 sc1
    v_pk_mul_f32 v[162:163], v[124:125], v[124:125]
    v_pk_mul_f32 v[164:165], v[126:127], v[126:127]
    v_pk_fma_f32 v[162:163], v[162:163], v[8:9], v[4:5] op_sel:[0,1,1] op_sel_hi:[1,1,1]
    v_pk_fma_f32 v[164:165], v[164:165], v[8:9], v[4:5] op_sel:[0,1,1] op_sel_hi:[1,1,1]
    v_pk_mul_f32 v[162:163], v[124:125], v[162:163]
    v_pk_mul_f32 v[164:165], v[126:127], v[164:165]
    buffer_load_dwordx4 v[108:111], v185, s[48:51], s23 offen offset:0 sc1
    v_exp_f32 v162, v162
    v_exp_f32 v163, v163
    v_exp_f32 v164, v164
    v_exp_f32 v165, v165
    v_pk_mul_f32 v[166:167], v[124:125], v[140:141]
    v_pk_mul_f32 v[168:169], v[126:127], v[142:143]
    buffer_load_dwordx4 v[112:115], v185, s[48:51], s23 offen offset:1024 sc1
    v_pk_fma_f32 v[162:163], v[162:163], v[194:195], v[194:195] op_sel:[0,0,0] op_sel_hi:[1,0,0]
    v_pk_fma_f32 v[164:165], v[164:165], v[194:195], v[194:195] op_sel:[0,0,0] op_sel_hi:[1,0,0]
    v_rcp_f32 v162, v162
    v_rcp_f32 v163, v163
    v_rcp_f32 v164, v164
    v_rcp_f32 v165, v165
    buffer_load_dwordx4 v[116:119], v185, s[48:51], s23 offen offset:2048 sc1
    s_nop 0
    v_pk_mul_f32 v[166:167], v[166:167], v[162:163]
    v_pk_mul_f32 v[168:169], v[168:169], v[164:165]
    v_cvt_pk_bf16_f32 v170, v166, v167
    v_cvt_pk_bf16_f32 v171, v168, v169
    ds_write_b64 v12, v[170:171] offset:18432
    buffer_load_dwordx4 v[180:183], v185, s[48:51], s23 offen offset:3072 sc1
    v_pk_mul_f32 v[152:153], v[128:129], v[128:129]
    v_pk_mul_f32 v[154:155], v[130:131], v[130:131]
    v_pk_fma_f32 v[152:153], v[152:153], v[12:13], v[6:7] op_sel:[0,1,0] op_sel_hi:[1,1,0]
    v_pk_fma_f32 v[154:155], v[154:155], v[12:13], v[6:7] op_sel:[0,1,0] op_sel_hi:[1,1,0]
    v_pk_mul_f32 v[152:153], v[128:129], v[152:153]
    v_pk_mul_f32 v[154:155], v[130:131], v[154:155]
    buffer_load_dwordx4 v[196:199], v186, s[48:51], s23 offen offset:0 sc1
    v_exp_f32 v152, v152
    v_exp_f32 v153, v153
    v_exp_f32 v154, v154
    v_exp_f32 v155, v155
    v_pk_mul_f32 v[156:157], v[128:129], v[144:145]
    v_pk_mul_f32 v[158:159], v[130:131], v[146:147]
    buffer_load_dwordx4 v[200:203], v186, s[48:51], s23 offen offset:1024 sc1
    v_pk_fma_f32 v[152:153], v[152:153], v[194:195], v[194:195] op_sel:[0,1,1] op_sel_hi:[1,1,1]
    v_pk_fma_f32 v[154:155], v[154:155], v[194:195], v[194:195] op_sel:[0,1,1] op_sel_hi:[1,1,1]
    v_rcp_f32 v152, v152
    v_rcp_f32 v153, v153
    v_rcp_f32 v154, v154
    v_rcp_f32 v155, v155
    buffer_load_dwordx4 v[204:207], v186, s[48:51], s23 offen offset:2048 sc1
    s_nop 0
    v_pk_mul_f32 v[156:157], v[156:157], v[152:153]
    v_pk_mul_f32 v[158:159], v[158:159], v[154:155]
    v_cvt_pk_bf16_f32 v160, v156, v157
    v_cvt_pk_bf16_f32 v161, v158, v159
    ds_write_b64 v12, v[160:161] offset:36864
    buffer_load_dwordx4 v[208:211], v186, s[48:51], s23 offen offset:3072 sc1
    v_pk_mul_f32 v[162:163], v[132:133], v[132:133]
    v_pk_mul_f32 v[164:165], v[134:135], v[134:135]
    v_pk_fma_f32 v[162:163], v[162:163], v[14:15], v[6:7] op_sel:[0,0,1] op_sel_hi:[1,0,1]
    v_pk_fma_f32 v[164:165], v[164:165], v[14:15], v[6:7] op_sel:[0,0,1] op_sel_hi:[1,0,1]
    v_pk_mul_f32 v[162:163], v[132:133], v[162:163]
    v_pk_mul_f32 v[164:165], v[134:135], v[164:165]
    buffer_load_dwordx4 v[212:215], v187, s[48:51], s23 offen offset:0 sc1
    v_exp_f32 v162, v162
    v_exp_f32 v163, v163
    v_exp_f32 v164, v164
    v_exp_f32 v165, v165
    v_pk_mul_f32 v[166:167], v[132:133], v[148:149]
    v_pk_mul_f32 v[168:169], v[134:135], v[150:151]
    v_pk_fma_f32 v[162:163], v[162:163], v[252:253], v[252:253] op_sel:[0,0,0] op_sel_hi:[1,0,0]
    v_pk_fma_f32 v[164:165], v[164:165], v[252:253], v[252:253] op_sel:[0,0,0] op_sel_hi:[1,0,0]
    v_rcp_f32 v162, v162
    v_rcp_f32 v163, v163
    v_rcp_f32 v164, v164
    v_rcp_f32 v165, v165
    s_nop 0
    v_pk_mul_f32 v[166:167], v[166:167], v[162:163]
    v_pk_mul_f32 v[168:169], v[168:169], v[164:165]
    v_cvt_pk_bf16_f32 v170, v166, v167
    v_cvt_pk_bf16_f32 v171, v168, v169
    ds_write_b64 v12, v[170:171] offset:55296
    buffer_load_dwordx4 v[136:139], v187, s[48:51], s23 offen offset:1024 sc1
    buffer_load_dwordx4 v[140:143], v187, s[48:51], s23 offen offset:2048 sc1
    buffer_load_dwordx4 v[144:147], v187, s[48:51], s23 offen offset:3072 sc1
    buffer_load_dwordx4 v[160:163], v188, s[48:51], s23 offen offset:0 sc1
    buffer_load_dwordx4 v[164:167], v188, s[48:51], s23 offen offset:1024 sc1
    s_add_u32 s23, s23, 18432
    s_waitcnt lgkmcnt(0)
    s_barrier
    ds_read_b128 a[64:67], v10 offset:16384
    ds_read_b128 a[136:139], v10 offset:34816
    ds_read_b128 a[208:211], v11 offset:16384
    ds_read_b128 v[244:247], v11 offset:34816
    ds_read_b128 a[68:71], v10 offset:17408
    ds_read_b128 a[140:143], v10 offset:35840
    ds_read_b128 a[212:215], v11 offset:17408
    ds_read_b128 v[248:251], v11 offset:35840
    s_mov_b32 s25, 0
    s_waitcnt lgkmcnt(0)
    s_branch L_ffn_dn_mid_36
L_ffn_dn_35:
    s_waitcnt vmcnt(32)
    v_mfma_f32_16x16x32_bf16 v[88:91], v[104:107], a[0:3], 0
    v_mfma_f32_16x16x32_bf16 v[88:91], v[108:111], a[4:7], v[88:91]
    buffer_load_dwordx4 v[76:79], v184, s[48:51], s23 offen offset:0 sc1
    v_mfma_f32_16x16x32_bf16 v[88:91], v[112:115], a[8:11], v[88:91]
    v_mfma_f32_16x16x32_bf16 v[92:95], v[104:107], a[72:75], 0
    v_mfma_f32_16x16x32_bf16 v[92:95], v[108:111], a[76:79], v[92:95]
    v_mfma_f32_16x16x32_bf16 v[92:95], v[112:115], a[80:83], v[92:95]
    buffer_load_dwordx4 v[80:83], v184, s[48:51], s23 offen offset:1024 sc1
    v_mfma_f32_16x16x32_bf16 v[96:99], v[104:107], a[144:147], 0
    v_cvt_pk_bf16_f32 v152, v120, v121
    v_cvt_pk_bf16_f32 v153, v122, v123
    v_mfma_f32_16x16x32_bf16 v[96:99], v[108:111], a[148:151], v[96:99]
    v_cvt_pk_bf16_f32 v154, v124, v125
    v_cvt_pk_bf16_f32 v155, v126, v127
    v_mfma_f32_16x16x32_bf16 v[96:99], v[112:115], a[152:155], v[96:99]
    v_cvt_pk_bf16_f32 v156, v128, v129
    v_cvt_pk_bf16_f32 v157, v130, v131
    v_mfma_f32_16x16x32_bf16 v[100:103], v[104:107], a[216:219], 0
    buffer_load_dwordx4 v[84:87], v184, s[48:51], s23 offen offset:2048 sc1
    v_mfma_f32_16x16x32_bf16 v[100:103], v[108:111], a[220:223], v[100:103]
    v_cvt_pk_bf16_f32 v158, v132, v133
    v_cvt_pk_bf16_f32 v159, v134, v135
    v_mfma_f32_16x16x32_bf16 v[100:103], v[112:115], a[224:227], v[100:103]
    v_permlane16_swap_b32 v152, v154
    s_waitcnt vmcnt(32)
    v_mfma_f32_16x16x32_bf16 v[88:91], v[116:119], a[12:15], v[88:91]
    v_permlane16_swap_b32 v153, v155
    v_mfma_f32_16x16x32_bf16 v[88:91], v[180:183], a[16:19], v[88:91]
    buffer_load_dwordx4 v[104:107], v184, s[48:51], s23 offen offset:3072 sc1
    v_mfma_f32_16x16x32_bf16 v[88:91], v[196:199], a[20:23], v[88:91]
    v_permlane16_swap_b32 v156, v158
    v_mfma_f32_16x16x32_bf16 v[92:95], v[116:119], a[84:87], v[92:95]
    v_permlane16_swap_b32 v157, v159
    v_mfma_f32_16x16x32_bf16 v[92:95], v[180:183], a[88:91], v[92:95]
    buffer_store_dwordx4 v[152:155], v178, s[72:75], s27 offen sc1
    v_mfma_f32_16x16x32_bf16 v[92:95], v[196:199], a[92:95], v[92:95]
    buffer_load_dwordx4 v[108:111], v185, s[48:51], s23 offen offset:0 sc1
    v_mfma_f32_16x16x32_bf16 v[96:99], v[116:119], a[156:159], v[96:99]
    buffer_store_dwordx4 v[156:159], v179, s[72:75], s27 offen sc1
    v_mfma_f32_16x16x32_bf16 v[96:99], v[180:183], a[160:163], v[96:99]
    ds_write_b128 v216, v[152:155]
    v_mfma_f32_16x16x32_bf16 v[96:99], v[196:199], a[164:167], v[96:99]
    v_add_u32 v216, v216, v218
    v_mfma_f32_16x16x32_bf16 v[100:103], v[116:119], a[228:231], v[100:103]
    buffer_load_dwordx4 v[112:115], v185, s[48:51], s23 offen offset:1024 sc1
    v_mfma_f32_16x16x32_bf16 v[100:103], v[180:183], a[232:235], v[100:103]
    ds_write_b128 v217, v[156:159]
    v_mfma_f32_16x16x32_bf16 v[100:103], v[196:199], a[236:239], v[100:103]
    v_add_u32 v217, v217, v219
    s_waitcnt vmcnt(34)
    v_mfma_f32_16x16x32_bf16 v[88:91], v[200:203], a[24:27], v[88:91]
    v_mfma_f32_16x16x32_bf16 v[88:91], v[204:207], a[28:31], v[88:91]
    buffer_load_dwordx4 v[116:119], v185, s[48:51], s23 offen offset:2048 sc1
    v_mfma_f32_16x16x32_bf16 v[88:91], v[208:211], a[32:35], v[88:91]
    v_mfma_f32_16x16x32_bf16 v[92:95], v[200:203], a[96:99], v[92:95]
    v_mfma_f32_16x16x32_bf16 v[92:95], v[204:207], a[100:103], v[92:95]
    v_mfma_f32_16x16x32_bf16 v[92:95], v[208:211], a[104:107], v[92:95]
    buffer_load_dwordx4 v[180:183], v185, s[48:51], s23 offen offset:3072 sc1
    v_mfma_f32_16x16x32_bf16 v[96:99], v[200:203], a[168:171], v[96:99]
    v_mfma_f32_16x16x32_bf16 v[96:99], v[204:207], a[172:175], v[96:99]
    v_mfma_f32_16x16x32_bf16 v[96:99], v[208:211], a[176:179], v[96:99]
    v_mfma_f32_16x16x32_bf16 v[100:103], v[200:203], a[240:243], v[100:103]
    buffer_load_dwordx4 v[196:199], v186, s[48:51], s23 offen offset:0 sc1
    v_mfma_f32_16x16x32_bf16 v[100:103], v[204:207], a[244:247], v[100:103]
    v_mfma_f32_16x16x32_bf16 v[100:103], v[208:211], a[248:251], v[100:103]
    s_waitcnt vmcnt(34)
    v_mfma_f32_16x16x32_bf16 v[88:91], v[212:215], a[36:39], v[88:91]
    v_mfma_f32_16x16x32_bf16 v[88:91], v[136:139], a[40:43], v[88:91]
    buffer_load_dwordx4 v[200:203], v186, s[48:51], s23 offen offset:1024 sc1
    v_mfma_f32_16x16x32_bf16 v[88:91], v[140:143], a[44:47], v[88:91]
    v_mfma_f32_16x16x32_bf16 v[92:95], v[212:215], a[108:111], v[92:95]
    v_mfma_f32_16x16x32_bf16 v[92:95], v[136:139], a[112:115], v[92:95]
    v_mfma_f32_16x16x32_bf16 v[92:95], v[140:143], a[116:119], v[92:95]
    buffer_load_dwordx4 v[204:207], v186, s[48:51], s23 offen offset:2048 sc1
    v_mfma_f32_16x16x32_bf16 v[96:99], v[212:215], a[180:183], v[96:99]
    v_mfma_f32_16x16x32_bf16 v[96:99], v[136:139], a[184:187], v[96:99]
    v_mfma_f32_16x16x32_bf16 v[96:99], v[140:143], a[188:191], v[96:99]
    v_mfma_f32_16x16x32_bf16 v[100:103], v[212:215], a[252:255], v[100:103]
    buffer_load_dwordx4 v[208:211], v186, s[48:51], s23 offen offset:3072 sc1
    v_mfma_f32_16x16x32_bf16 v[100:103], v[136:139], v[220:223], v[100:103]
    v_mfma_f32_16x16x32_bf16 v[100:103], v[140:143], v[224:227], v[100:103]
    s_waitcnt vmcnt(34)
    v_mfma_f32_16x16x32_bf16 v[88:91], v[144:147], a[48:51], v[88:91]
    v_mfma_f32_16x16x32_bf16 v[88:91], v[160:163], a[52:55], v[88:91]
    buffer_load_dwordx4 v[212:215], v187, s[48:51], s23 offen offset:0 sc1
    v_mfma_f32_16x16x32_bf16 v[88:91], v[164:167], a[56:59], v[88:91]
    v_mfma_f32_16x16x32_bf16 v[92:95], v[144:147], a[120:123], v[92:95]
    v_mfma_f32_16x16x32_bf16 v[92:95], v[160:163], a[124:127], v[92:95]
    v_mfma_f32_16x16x32_bf16 v[92:95], v[164:167], a[128:131], v[92:95]
    buffer_load_dwordx4 v[136:139], v187, s[48:51], s23 offen offset:1024 sc1
    v_mfma_f32_16x16x32_bf16 v[96:99], v[144:147], a[192:195], v[96:99]
    v_mfma_f32_16x16x32_bf16 v[96:99], v[160:163], a[196:199], v[96:99]
    v_mfma_f32_16x16x32_bf16 v[96:99], v[164:167], a[200:203], v[96:99]
    v_mfma_f32_16x16x32_bf16 v[100:103], v[144:147], v[228:231], v[100:103]
    buffer_load_dwordx4 v[140:143], v187, s[48:51], s23 offen offset:2048 sc1
    v_mfma_f32_16x16x32_bf16 v[100:103], v[160:163], v[232:235], v[100:103]
    v_mfma_f32_16x16x32_bf16 v[100:103], v[164:167], v[236:239], v[100:103]
    s_waitcnt vmcnt(34)
    v_mfma_f32_16x16x32_bf16 v[88:91], v[168:171], a[60:63], v[88:91]
    v_mfma_f32_16x16x32_bf16 v[88:91], v[148:151], a[64:67], v[88:91]
    buffer_load_dwordx4 v[144:147], v187, s[48:51], s23 offen offset:3072 sc1
    v_mfma_f32_16x16x32_bf16 v[120:123], v[4:7], a[68:71], v[88:91]
    v_mfma_f32_16x16x32_bf16 v[92:95], v[168:171], a[132:135], v[92:95]
    v_mfma_f32_16x16x32_bf16 v[92:95], v[148:151], a[136:139], v[92:95]
    v_mfma_f32_16x16x32_bf16 v[124:127], v[4:7], a[140:143], v[92:95]
    buffer_load_dwordx4 v[160:163], v188, s[48:51], s23 offen offset:0 sc1
    v_mfma_f32_16x16x32_bf16 v[96:99], v[168:171], a[204:207], v[96:99]
    s_mov_b32 s74, 268435456
    v_mfma_f32_16x16x32_bf16 v[96:99], v[148:151], a[208:211], v[96:99]
    s_add_u32 s27, s27, 1024
    v_mfma_f32_16x16x32_bf16 v[128:131], v[4:7], a[212:215], v[96:99]
    s_add_u32 s25, s25, 1
    v_mfma_f32_16x16x32_bf16 v[100:103], v[168:171], v[240:243], v[100:103]
    buffer_load_dwordx4 v[164:167], v188, s[48:51], s23 offen offset:1024 sc1
    v_mfma_f32_16x16x32_bf16 v[100:103], v[148:151], v[244:247], v[100:103]
    s_add_u32 s23, s23, 18432
    v_mfma_f32_16x16x32_bf16 v[132:135], v[4:7], v[248:251], v[100:103]
L_ffn_dn_mid_36:
    s_waitcnt vmcnt(30)
    v_mfma_f32_16x16x32_bf16 v[88:91], v[16:19], a[0:3], 0
    v_mfma_f32_16x16x32_bf16 v[88:91], v[20:23], a[4:7], v[88:91]
    buffer_load_dwordx4 v[168:171], v184, s[48:51], s23 offen offset:0 sc1
    v_mfma_f32_16x16x32_bf16 v[88:91], v[24:27], a[8:11], v[88:91]
    v_mfma_f32_16x16x32_bf16 v[92:95], v[16:19], a[72:75], 0
    v_mfma_f32_16x16x32_bf16 v[92:95], v[20:23], a[76:79], v[92:95]
    v_mfma_f32_16x16x32_bf16 v[92:95], v[24:27], a[80:83], v[92:95]
    buffer_load_dwordx4 v[148:151], v184, s[48:51], s23 offen offset:1024 sc1
    v_mfma_f32_16x16x32_bf16 v[96:99], v[16:19], a[144:147], 0
    v_cvt_pk_bf16_f32 v152, v120, v121
    v_cvt_pk_bf16_f32 v153, v122, v123
    v_mfma_f32_16x16x32_bf16 v[96:99], v[20:23], a[148:151], v[96:99]
    v_cvt_pk_bf16_f32 v154, v124, v125
    v_cvt_pk_bf16_f32 v155, v126, v127
    v_mfma_f32_16x16x32_bf16 v[96:99], v[24:27], a[152:155], v[96:99]
    v_cvt_pk_bf16_f32 v156, v128, v129
    v_cvt_pk_bf16_f32 v157, v130, v131
    v_mfma_f32_16x16x32_bf16 v[100:103], v[16:19], a[216:219], 0
    buffer_load_dwordx4 v[4:7], v184, s[48:51], s23 offen offset:2048 sc1
    v_mfma_f32_16x16x32_bf16 v[100:103], v[20:23], a[220:223], v[100:103]
    v_cvt_pk_bf16_f32 v158, v132, v133
    v_cvt_pk_bf16_f32 v159, v134, v135
    v_mfma_f32_16x16x32_bf16 v[100:103], v[24:27], a[224:227], v[100:103]
    v_permlane16_swap_b32 v152, v154
    s_waitcnt vmcnt(30)
    v_mfma_f32_16x16x32_bf16 v[88:91], v[28:31], a[12:15], v[88:91]
    v_permlane16_swap_b32 v153, v155
    v_mfma_f32_16x16x32_bf16 v[88:91], v[32:35], a[16:19], v[88:91]
    buffer_load_dwordx4 v[16:19], v184, s[48:51], s23 offen offset:3072 sc1
    v_mfma_f32_16x16x32_bf16 v[88:91], v[36:39], a[20:23], v[88:91]
    v_permlane16_swap_b32 v156, v158
    v_mfma_f32_16x16x32_bf16 v[92:95], v[28:31], a[84:87], v[92:95]
    v_permlane16_swap_b32 v157, v159
    v_mfma_f32_16x16x32_bf16 v[92:95], v[32:35], a[88:91], v[92:95]
    buffer_store_dwordx4 v[152:155], v178, s[72:75], s27 offen sc1
    v_mfma_f32_16x16x32_bf16 v[92:95], v[36:39], a[92:95], v[92:95]
    buffer_load_dwordx4 v[20:23], v185, s[48:51], s23 offen offset:0 sc1
    v_mfma_f32_16x16x32_bf16 v[96:99], v[28:31], a[156:159], v[96:99]
    buffer_store_dwordx4 v[156:159], v179, s[72:75], s27 offen sc1
    v_mfma_f32_16x16x32_bf16 v[96:99], v[32:35], a[160:163], v[96:99]
    ds_write_b128 v216, v[152:155]
    v_mfma_f32_16x16x32_bf16 v[96:99], v[36:39], a[164:167], v[96:99]
    v_add_u32 v216, v216, v218
    v_mfma_f32_16x16x32_bf16 v[100:103], v[28:31], a[228:231], v[100:103]
    buffer_load_dwordx4 v[24:27], v185, s[48:51], s23 offen offset:1024 sc1
    v_mfma_f32_16x16x32_bf16 v[100:103], v[32:35], a[232:235], v[100:103]
    ds_write_b128 v217, v[156:159]
    v_mfma_f32_16x16x32_bf16 v[100:103], v[36:39], a[236:239], v[100:103]
    v_add_u32 v217, v217, v219
    s_waitcnt vmcnt(32)
    v_mfma_f32_16x16x32_bf16 v[88:91], v[40:43], a[24:27], v[88:91]
    v_mfma_f32_16x16x32_bf16 v[88:91], v[44:47], a[28:31], v[88:91]
    buffer_load_dwordx4 v[28:31], v185, s[48:51], s23 offen offset:2048 sc1
    v_mfma_f32_16x16x32_bf16 v[88:91], v[48:51], a[32:35], v[88:91]
    v_mfma_f32_16x16x32_bf16 v[92:95], v[40:43], a[96:99], v[92:95]
    v_mfma_f32_16x16x32_bf16 v[92:95], v[44:47], a[100:103], v[92:95]
    v_mfma_f32_16x16x32_bf16 v[92:95], v[48:51], a[104:107], v[92:95]
    buffer_load_dwordx4 v[32:35], v185, s[48:51], s23 offen offset:3072 sc1
    v_mfma_f32_16x16x32_bf16 v[96:99], v[40:43], a[168:171], v[96:99]
    v_mfma_f32_16x16x32_bf16 v[96:99], v[44:47], a[172:175], v[96:99]
    v_mfma_f32_16x16x32_bf16 v[96:99], v[48:51], a[176:179], v[96:99]
    v_mfma_f32_16x16x32_bf16 v[100:103], v[40:43], a[240:243], v[100:103]
    buffer_load_dwordx4 v[36:39], v186, s[48:51], s23 offen offset:0 sc1
    v_mfma_f32_16x16x32_bf16 v[100:103], v[44:47], a[244:247], v[100:103]
    v_mfma_f32_16x16x32_bf16 v[100:103], v[48:51], a[248:251], v[100:103]
    s_waitcnt vmcnt(32)
    s_cmp_lg_u32 s25, 6
    s_cbranch_scc1 L_early_37
    s_waitcnt vmcnt(24)
    s_barrier
    s_cmp_lg_u32 s3, 0
    s_cbranch_scc1 L_early_37
    v_lshlrev_b32 v15, 7, v0
    v_mov_b32 v1, s76
    s_mov_b64 exec, 0xff
    buffer_store_dword v1, v15, s[8:11], s29 offen sc1
    s_mov_b64 exec, -1
L_early_37:
    v_mfma_f32_16x16x32_bf16 v[88:91], v[52:55], a[36:39], v[88:91]
    v_mfma_f32_16x16x32_bf16 v[88:91], v[56:59], a[40:43], v[88:91]
    buffer_load_dwordx4 v[40:43], v186, s[48:51], s23 offen offset:1024 sc1
    v_mfma_f32_16x16x32_bf16 v[88:91], v[60:63], a[44:47], v[88:91]
    v_mfma_f32_16x16x32_bf16 v[92:95], v[52:55], a[108:111], v[92:95]
    v_mfma_f32_16x16x32_bf16 v[92:95], v[56:59], a[112:115], v[92:95]
    v_mfma_f32_16x16x32_bf16 v[92:95], v[60:63], a[116:119], v[92:95]
    buffer_load_dwordx4 v[44:47], v186, s[48:51], s23 offen offset:2048 sc1
    v_mfma_f32_16x16x32_bf16 v[96:99], v[52:55], a[180:183], v[96:99]
    v_mfma_f32_16x16x32_bf16 v[96:99], v[56:59], a[184:187], v[96:99]
    v_mfma_f32_16x16x32_bf16 v[96:99], v[60:63], a[188:191], v[96:99]
    v_mfma_f32_16x16x32_bf16 v[100:103], v[52:55], a[252:255], v[100:103]
    buffer_load_dwordx4 v[48:51], v186, s[48:51], s23 offen offset:3072 sc1
    v_mfma_f32_16x16x32_bf16 v[100:103], v[56:59], v[220:223], v[100:103]
    v_mfma_f32_16x16x32_bf16 v[100:103], v[60:63], v[224:227], v[100:103]
    s_waitcnt vmcnt(32)
    v_mfma_f32_16x16x32_bf16 v[88:91], v[64:67], a[48:51], v[88:91]
    v_mfma_f32_16x16x32_bf16 v[88:91], v[68:71], a[52:55], v[88:91]
    buffer_load_dwordx4 v[52:55], v187, s[48:51], s23 offen offset:0 sc1
    v_mfma_f32_16x16x32_bf16 v[88:91], v[72:75], a[56:59], v[88:91]
    v_mfma_f32_16x16x32_bf16 v[92:95], v[64:67], a[120:123], v[92:95]
    v_mfma_f32_16x16x32_bf16 v[92:95], v[68:71], a[124:127], v[92:95]
    v_mfma_f32_16x16x32_bf16 v[92:95], v[72:75], a[128:131], v[92:95]
    buffer_load_dwordx4 v[56:59], v187, s[48:51], s23 offen offset:1024 sc1
    v_mfma_f32_16x16x32_bf16 v[96:99], v[64:67], a[192:195], v[96:99]
    v_mfma_f32_16x16x32_bf16 v[96:99], v[68:71], a[196:199], v[96:99]
    v_mfma_f32_16x16x32_bf16 v[96:99], v[72:75], a[200:203], v[96:99]
    v_mfma_f32_16x16x32_bf16 v[100:103], v[64:67], v[228:231], v[100:103]
    buffer_load_dwordx4 v[60:63], v187, s[48:51], s23 offen offset:2048 sc1
    v_mfma_f32_16x16x32_bf16 v[100:103], v[68:71], v[232:235], v[100:103]
    v_mfma_f32_16x16x32_bf16 v[100:103], v[72:75], v[236:239], v[100:103]
    s_waitcnt vmcnt(32)
    v_mfma_f32_16x16x32_bf16 v[88:91], v[76:79], a[60:63], v[88:91]
    v_mfma_f32_16x16x32_bf16 v[88:91], v[80:83], a[64:67], v[88:91]
    buffer_load_dwordx4 v[64:67], v187, s[48:51], s23 offen offset:3072 sc1
    v_mfma_f32_16x16x32_bf16 v[120:123], v[84:87], a[68:71], v[88:91]
    v_mfma_f32_16x16x32_bf16 v[92:95], v[76:79], a[132:135], v[92:95]
    v_mfma_f32_16x16x32_bf16 v[92:95], v[80:83], a[136:139], v[92:95]
    v_mfma_f32_16x16x32_bf16 v[124:127], v[84:87], a[140:143], v[92:95]
    buffer_load_dwordx4 v[68:71], v188, s[48:51], s23 offen offset:0 sc1
    v_mfma_f32_16x16x32_bf16 v[96:99], v[76:79], a[204:207], v[96:99]
    s_mov_b32 s74, 268435456
    v_mfma_f32_16x16x32_bf16 v[96:99], v[80:83], a[208:211], v[96:99]
    s_add_u32 s27, s27, 1024
    v_mfma_f32_16x16x32_bf16 v[128:131], v[84:87], a[212:215], v[96:99]
    s_add_u32 s25, s25, 1
    v_mfma_f32_16x16x32_bf16 v[100:103], v[76:79], v[240:243], v[100:103]
    buffer_load_dwordx4 v[72:75], v188, s[48:51], s23 offen offset:1024 sc1
    v_mfma_f32_16x16x32_bf16 v[100:103], v[80:83], v[244:247], v[100:103]
    s_add_u32 s23, s23, 18432
    v_mfma_f32_16x16x32_bf16 v[132:135], v[84:87], v[248:251], v[100:103]
    s_cmp_lt_u32 s25, 7
    s_cbranch_scc1 L_ffn_dn_35
    s_waitcnt vmcnt(32)
    v_mfma_f32_16x16x32_bf16 v[88:91], v[104:107], a[0:3], 0
    v_mfma_f32_16x16x32_bf16 v[88:91], v[108:111], a[4:7], v[88:91]
    buffer_load_dwordx4 v[76:79], v184, s[48:51], s23 offen offset:0 sc1
    v_mfma_f32_16x16x32_bf16 v[88:91], v[112:115], a[8:11], v[88:91]
    v_mfma_f32_16x16x32_bf16 v[92:95], v[104:107], a[72:75], 0
    v_mfma_f32_16x16x32_bf16 v[92:95], v[108:111], a[76:79], v[92:95]
    v_mfma_f32_16x16x32_bf16 v[92:95], v[112:115], a[80:83], v[92:95]
    buffer_load_dwordx4 v[80:83], v184, s[48:51], s23 offen offset:1024 sc1
    v_mfma_f32_16x16x32_bf16 v[96:99], v[104:107], a[144:147], 0
    v_cvt_pk_bf16_f32 v152, v120, v121
    v_cvt_pk_bf16_f32 v153, v122, v123
    v_mfma_f32_16x16x32_bf16 v[96:99], v[108:111], a[148:151], v[96:99]
    v_cvt_pk_bf16_f32 v154, v124, v125
    v_cvt_pk_bf16_f32 v155, v126, v127
    v_mfma_f32_16x16x32_bf16 v[96:99], v[112:115], a[152:155], v[96:99]
    v_cvt_pk_bf16_f32 v156, v128, v129
    v_cvt_pk_bf16_f32 v157, v130, v131
    v_mfma_f32_16x16x32_bf16 v[100:103], v[104:107], a[216:219], 0
    buffer_load_dwordx4 v[84:87], v184, s[48:51], s23 offen offset:2048 sc1
    v_mfma_f32_16x16x32_bf16 v[100:103], v[108:111], a[220:223], v[100:103]
    v_cvt_pk_bf16_f32 v158, v132, v133
    v_cvt_pk_bf16_f32 v159, v134, v135
    v_mfma_f32_16x16x32_bf16 v[100:103], v[112:115], a[224:227], v[100:103]
    v_permlane16_swap_b32 v152, v154
    s_waitcnt vmcnt(32)
    v_mfma_f32_16x16x32_bf16 v[88:91], v[116:119], a[12:15], v[88:91]
    v_permlane16_swap_b32 v153, v155
    v_mfma_f32_16x16x32_bf16 v[88:91], v[180:183], a[16:19], v[88:91]
    v_permlane16_swap_b32 v156, v158
    v_mfma_f32_16x16x32_bf16 v[88:91], v[196:199], a[20:23], v[88:91]
    v_permlane16_swap_b32 v157, v159
    s_load_dwordx8 s[56:63], s[38:39], 0 glc
    v_mfma_f32_16x16x32_bf16 v[92:95], v[116:119], a[84:87], v[92:95]
    buffer_store_dwordx4 v[152:155], v178, s[72:75], s27 offen sc1
    s_mov_b32 s6, 0
    v_mfma_f32_16x16x32_bf16 v[92:95], v[180:183], a[88:91], v[92:95]
    buffer_store_dwordx4 v[156:159], v179, s[72:75], s27 offen sc1
    v_mfma_f32_16x16x32_bf16 v[92:95], v[196:199], a[92:95], v[92:95]
    ds_write_b128 v216, v[152:155]
    v_mfma_f32_16x16x32_bf16 v[96:99], v[116:119], a[156:159], v[96:99]
    v_add_u32 v216, v216, v218
    v_mfma_f32_16x16x32_bf16 v[96:99], v[180:183], a[160:163], v[96:99]
    ds_write_b128 v217, v[156:159]
    v_mfma_f32_16x16x32_bf16 v[96:99], v[196:199], a[164:167], v[96:99]
    v_add_u32 v217, v217, v219
    v_mfma_f32_16x16x32_bf16 v[100:103], v[116:119], a[228:231], v[100:103]
    v_mfma_f32_16x16x32_bf16 v[100:103], v[180:183], a[232:235], v[100:103]
    v_mfma_f32_16x16x32_bf16 v[100:103], v[196:199], a[236:239], v[100:103]
    s_waitcnt vmcnt(31)
L_epoll_38:
    s_waitcnt lgkmcnt(0)
    s_xor_b64 s[56:57], s[56:57], s[76:77]
    s_xor_b64 s[58:59], s[58:59], s[76:77]
    s_xor_b64 s[60:61], s[60:61], s[76:77]
    s_xor_b64 s[62:63], s[62:63], s[76:77]
    s_or_b64 s[56:57], s[56:57], s[58:59]
    s_or_b64 s[60:61], s[60:61], s[62:63]
    s_or_b64 s[56:57], s[56:57], s[60:61]
    s_cbranch_scc0 L_epolled_39
    s_load_dwordx8 s[56:63], s[38:39], 0 glc
    s_add_u32 s6, s6, 1
    s_cmp_lt_u32 s6, 1048576
    s_cbranch_scc1 L_epoll_38
    s_branch L_main_end
L_epolled_39:
    v_mfma_f32_16x16x32_bf16 v[88:91], v[200:203], a[24:27], v[88:91]
    v_mfma_f32_16x16x32_bf16 v[88:91], v[204:207], a[28:31], v[88:91]
    s_add_u32 s7, s40, 1
    s_and_b32 s7, s7, 7
    s_mul_i32 s7, s7, 9216
    s_add_u32 s19, s7, s20
    buffer_load_dwordx4 v[104:107], v172, s[8:11], s19 offen sc1
    v_mfma_f32_16x16x32_bf16 v[88:91], v[208:211], a[32:35], v[88:91]
    v_mfma_f32_16x16x32_bf16 v[92:95], v[200:203], a[96:99], v[92:95]
    v_mfma_f32_16x16x32_bf16 v[92:95], v[204:207], a[100:103], v[92:95]
    v_mfma_f32_16x16x32_bf16 v[92:95], v[208:211], a[104:107], v[92:95]
    buffer_load_dwordx4 v[108:111], v173, s[8:11], s19 offen sc1
    v_mfma_f32_16x16x32_bf16 v[96:99], v[200:203], a[168:171], v[96:99]
    v_mfma_f32_16x16x32_bf16 v[96:99], v[204:207], a[172:175], v[96:99]
    v_mfma_f32_16x16x32_bf16 v[96:99], v[208:211], a[176:179], v[96:99]
    v_mfma_f32_16x16x32_bf16 v[100:103], v[200:203], a[240:243], v[100:103]
    s_add_u32 s7, s40, 2
    s_and_b32 s7, s7, 7
    s_mul_i32 s7, s7, 9216
    s_add_u32 s19, s7, s20
    buffer_load_dwordx4 v[112:115], v172, s[8:11], s19 offen sc1
    v_mfma_f32_16x16x32_bf16 v[100:103], v[204:207], a[244:247], v[100:103]
    v_mfma_f32_16x16x32_bf16 v[100:103], v[208:211], a[248:251], v[100:103]
    s_waitcnt vmcnt(31)
    v_mfma_f32_16x16x32_bf16 v[88:91], v[212:215], a[36:39], v[88:91]
    v_mfma_f32_16x16x32_bf16 v[88:91], v[136:139], a[40:43], v[88:91]
    buffer_load_dwordx4 v[116:119], v173, s[8:11], s19 offen sc1
    v_mfma_f32_16x16x32_bf16 v[88:91], v[140:143], a[44:47], v[88:91]
    v_mfma_f32_16x16x32_bf16 v[92:95], v[212:215], a[108:111], v[92:95]
    v_mfma_f32_16x16x32_bf16 v[92:95], v[136:139], a[112:115], v[92:95]
    v_mfma_f32_16x16x32_bf16 v[92:95], v[140:143], a[116:119], v[92:95]
    s_add_u32 s7, s40, 3
    s_and_b32 s7, s7, 7
    s_mul_i32 s7, s7, 9216
    s_add_u32 s19, s7, s20
    buffer_load_dwordx4 v[180:183], v172, s[8:11], s19 offen sc1
    v_mfma_f32_16x16x32_bf16 v[96:99], v[212:215], a[180:183], v[96:99]
    v_mfma_f32_16x16x32_bf16 v[96:99], v[136:139], a[184:187], v[96:99]
    v_mfma_f32_16x16x32_bf16 v[96:99], v[140:143], a[188:191], v[96:99]
    v_mfma_f32_16x16x32_bf16 v[100:103], v[212:215], a[252:255], v[100:103]
    buffer_load_dwordx4 v[196:199], v173, s[8:11], s19 offen sc1
    v_mfma_f32_16x16x32_bf16 v[100:103], v[136:139], v[220:223], v[100:103]
    v_mfma_f32_16x16x32_bf16 v[100:103], v[140:143], v[224:227], v[100:103]
    s_waitcnt vmcnt(31)
    v_mfma_f32_16x16x32_bf16 v[88:91], v[144:147], a[48:51], v[88:91]
    v_mfma_f32_16x16x32_bf16 v[88:91], v[160:163], a[52:55], v[88:91]
    s_add_u32 s7, s40, 4
    s_and_b32 s7, s7, 7
    s_mul_i32 s7, s7, 9216
    s_add_u32 s19, s7, s20
    buffer_load_dwordx4 v[200:203], v172, s[8:11], s19 offen sc1
    v_mfma_f32_16x16x32_bf16 v[88:91], v[164:167], a[56:59], v[88:91]
    v_mfma_f32_16x16x32_bf16 v[92:95], v[144:147], a[120:123], v[92:95]
    v_mfma_f32_16x16x32_bf16 v[92:95], v[160:163], a[124:127], v[92:95]
    v_mfma_f32_16x16x32_bf16 v[92:95], v[164:167], a[128:131], v[92:95]
    buffer_load_dwordx4 v[204:207], v173, s[8:11], s19 offen sc1
    v_mfma_f32_16x16x32_bf16 v[96:99], v[144:147], a[192:195], v[96:99]
    v_mfma_f32_16x16x32_bf16 v[96:99], v[160:163], a[196:199], v[96:99]
    v_mfma_f32_16x16x32_bf16 v[96:99], v[164:167], a[200:203], v[96:99]
    v_mfma_f32_16x16x32_bf16 v[100:103], v[144:147], v[228:231], v[100:103]
    s_add_u32 s7, s40, 5
    s_and_b32 s7, s7, 7
    s_mul_i32 s7, s7, 9216
    s_add_u32 s19, s7, s20
    buffer_load_dwordx4 v[208:211], v172, s[8:11], s19 offen sc1
    v_mfma_f32_16x16x32_bf16 v[100:103], v[160:163], v[232:235], v[100:103]
    v_mfma_f32_16x16x32_bf16 v[100:103], v[164:167], v[236:239], v[100:103]
    s_waitcnt vmcnt(31)
    v_mfma_f32_16x16x32_bf16 v[88:91], v[168:171], a[60:63], v[88:91]
    v_mfma_f32_16x16x32_bf16 v[88:91], v[148:151], a[64:67], v[88:91]
    buffer_load_dwordx4 v[212:215], v173, s[8:11], s19 offen sc1
    v_mfma_f32_16x16x32_bf16 v[120:123], v[4:7], a[68:71], v[88:91]
    v_mfma_f32_16x16x32_bf16 v[92:95], v[168:171], a[132:135], v[92:95]
    v_mfma_f32_16x16x32_bf16 v[92:95], v[148:151], a[136:139], v[92:95]
    v_mfma_f32_16x16x32_bf16 v[124:127], v[4:7], a[140:143], v[92:95]
    s_add_u32 s7, s40, 6
    s_and_b32 s7, s7, 7
    s_mul_i32 s7, s7, 9216
    s_add_u32 s19, s7, s20
    buffer_load_dwordx4 v[136:139], v172, s[8:11], s19 offen sc1
    v_mfma_f32_16x16x32_bf16 v[96:99], v[168:171], a[204:207], v[96:99]
    s_mov_b32 s74, 268435456
    v_mfma_f32_16x16x32_bf16 v[96:99], v[148:151], a[208:211], v[96:99]
    s_add_u32 s27, s27, 1024
    v_mfma_f32_16x16x32_bf16 v[128:131], v[4:7], a[212:215], v[96:99]
    s_add_u32 s25, s25, 1
    v_mfma_f32_16x16x32_bf16 v[100:103], v[168:171], v[240:243], v[100:103]
    buffer_load_dwordx4 v[140:143], v173, s[8:11], s19 offen sc1
    v_mfma_f32_16x16x32_bf16 v[100:103], v[148:151], v[244:247], v[100:103]
    s_add_u32 s23, s23, 18432
    v_mfma_f32_16x16x32_bf16 v[132:135], v[4:7], v[248:251], v[100:103]
    s_waitcnt vmcnt(29)
    v_mfma_f32_16x16x32_bf16 v[88:91], v[16:19], a[0:3], 0
    v_mfma_f32_16x16x32_bf16 v[88:91], v[20:23], a[4:7], v[88:91]
    s_add_u32 s7, s40, 7
    s_and_b32 s7, s7, 7
    s_mul_i32 s7, s7, 9216
    s_add_u32 s19, s7, s20
    buffer_load_dwordx4 v[144:147], v172, s[8:11], s19 offen sc1
    v_mfma_f32_16x16x32_bf16 v[88:91], v[24:27], a[8:11], v[88:91]
    v_mfma_f32_16x16x32_bf16 v[92:95], v[16:19], a[72:75], 0
    v_mfma_f32_16x16x32_bf16 v[92:95], v[20:23], a[76:79], v[92:95]
    v_mfma_f32_16x16x32_bf16 v[92:95], v[24:27], a[80:83], v[92:95]
    buffer_load_dwordx4 v[160:163], v173, s[8:11], s19 offen sc1
    v_mfma_f32_16x16x32_bf16 v[96:99], v[16:19], a[144:147], 0
    v_cvt_pk_bf16_f32 v152, v120, v121
    v_cvt_pk_bf16_f32 v153, v122, v123
    v_mfma_f32_16x16x32_bf16 v[96:99], v[20:23], a[148:151], v[96:99]
    v_cvt_pk_bf16_f32 v154, v124, v125
    v_cvt_pk_bf16_f32 v155, v126, v127
    v_mfma_f32_16x16x32_bf16 v[96:99], v[24:27], a[152:155], v[96:99]
    v_cvt_pk_bf16_f32 v156, v128, v129
    v_cvt_pk_bf16_f32 v157, v130, v131
    v_mfma_f32_16x16x32_bf16 v[100:103], v[16:19], a[216:219], 0
    v_cvt_pk_bf16_f32 v158, v132, v133
    v_cvt_pk_bf16_f32 v159, v134, v135
    v_mfma_f32_16x16x32_bf16 v[100:103], v[20:23], a[220:223], v[100:103]
    v_permlane16_swap_b32 v152, v154
    v_mfma_f32_16x16x32_bf16 v[100:103], v[24:27], a[224:227], v[100:103]
    v_permlane16_swap_b32 v153, v155
    s_waitcnt vmcnt(28)
    v_mfma_f32_16x16x32_bf16 v[88:91], v[28:31], a[12:15], v[88:91]
    v_permlane16_swap_b32 v156, v158
    v_mfma_f32_16x16x32_bf16 v[88:91], v[32:35], a[16:19], v[88:91]
    v_permlane16_swap_b32 v157, v159
    v_mfma_f32_16x16x32_bf16 v[88:91], v[36:39], a[20:23], v[88:91]
    buffer_store_dwordx4 v[152:155], v178, s[72:75], s27 offen sc1
    v_mfma_f32_16x16x32_bf16 v[92:95], v[28:31], a[84:87], v[92:95]
    buffer_store_dwordx4 v[156:159], v179, s[72:75], s27 offen sc1
    v_mfma_f32_16x16x32_bf16 v[92:95], v[32:35], a[88:91], v[92:95]
    ds_write_b128 v216, v[152:155]
    v_mfma_f32_16x16x32_bf16 v[92:95], v[36:39], a[92:95], v[92:95]
    v_add_u32 v216, v216, v218
    v_mfma_f32_16x16x32_bf16 v[96:99], v[28:31], a[156:159], v[96:99]
    ds_write_b128 v217, v[156:159]
    v_mfma_f32_16x16x32_bf16 v[96:99], v[32:35], a[160:163], v[96:99]
    v_add_u32 v217, v217, v219
    v_mfma_f32_16x16x32_bf16 v[96:99], v[36:39], a[164:167], v[96:99]
    v_mfma_f32_16x16x32_bf16 v[100:103], v[28:31], a[228:231], v[100:103]
    v_mfma_f32_16x16x32_bf16 v[100:103], v[32:35], a[232:235], v[100:103]
    v_mfma_f32_16x16x32_bf16 v[100:103], v[36:39], a[236:239], v[100:103]
    s_waitcnt vmcnt(27)
    v_mfma_f32_16x16x32_bf16 v[88:91], v[40:43], a[24:27], v[88:91]
    v_mfma_f32_16x16x32_bf16 v[88:91], v[44:47], a[28:31], v[88:91]
    v_mfma_f32_16x16x32_bf16 v[88:91], v[48:51], a[32:35], v[88:91]
    v_mfma_f32_16x16x32_bf16 v[92:95], v[40:43], a[96:99], v[92:95]
    v_mfma_f32_16x16x32_bf16 v[92:95], v[44:47], a[100:103], v[92:95]
    v_mfma_f32_16x16x32_bf16 v[92:95], v[48:51], a[104:107], v[92:95]
    v_mfma_f32_16x16x32_bf16 v[96:99], v[40:43], a[168:171], v[96:99]
    v_mfma_f32_16x16x32_bf16 v[96:99], v[44:47], a[172:175], v[96:99]
    v_mfma_f32_16x16x32_bf16 v[96:99], v[48:51], a[176:179], v[96:99]
    v_mfma_f32_16x16x32_bf16 v[100:103], v[40:43], a[240:243], v[100:103]
    v_mfma_f32_16x16x32_bf16 v[100:103], v[44:47], a[244:247], v[100:103]
    v_mfma_f32_16x16x32_bf16 v[100:103], v[48:51], a[248:251], v[100:103]
    s_waitcnt vmcnt(24)
    v_mfma_f32_16x16x32_bf16 v[88:91], v[52:55], a[36:39], v[88:91]
    v_mfma_f32_16x16x32_bf16 v[88:91], v[56:59], a[40:43], v[88:91]
    v_mfma_f32_16x16x32_bf16 v[88:91], v[60:63], a[44:47], v[88:91]
    v_mfma_f32_16x16x32_bf16 v[92:95], v[52:55], a[108:111], v[92:95]
    v_mfma_f32_16x16x32_bf16 v[92:95], v[56:59], a[112:115], v[92:95]
    v_mfma_f32_16x16x32_bf16 v[92:95], v[60:63], a[116:119], v[92:95]
    v_mfma_f32_16x16x32_bf16 v[96:99], v[52:55], a[180:183], v[96:99]
    v_mfma_f32_16x16x32_bf16 v[96:99], v[56:59], a[184:187], v[96:99]
    v_mfma_f32_16x16x32_bf16 v[96:99], v[60:63], a[188:191], v[96:99]
    v_mfma_f32_16x16x32_bf16 v[100:103], v[52:55], a[252:255], v[100:103]
    v_mfma_f32_16x16x32_bf16 v[100:103], v[56:59], v[220:223], v[100:103]
    v_mfma_f32_16x16x32_bf16 v[100:103], v[60:63], v[224:227], v[100:103]
    s_waitcnt vmcnt(21)
    v_mfma_f32_16x16x32_bf16 v[88:91], v[64:67], a[48:51], v[88:91]
    v_mfma_f32_16x16x32_bf16 v[88:91], v[68:71], a[52:55], v[88:91]
    v_mfma_f32_16x16x32_bf16 v[88:91], v[72:75], a[56:59], v[88:91]
    v_mfma_f32_16x16x32_bf16 v[92:95], v[64:67], a[120:123], v[92:95]
    v_mfma_f32_16x16x32_bf16 v[92:95], v[68:71], a[124:127], v[92:95]
    v_mfma_f32_16x16x32_bf16 v[92:95], v[72:75], a[128:131], v[92:95]
    v_mfma_f32_16x16x32_bf16 v[96:99], v[64:67], a[192:195], v[96:99]
    v_mfma_f32_16x16x32_bf16 v[96:99], v[68:71], a[196:199], v[96:99]
    v_mfma_f32_16x16x32_bf16 v[96:99], v[72:75], a[200:203], v[96:99]
    v_mfma_f32_16x16x32_bf16 v[100:103], v[64:67], v[228:231], v[100:103]
    v_mfma_f32_16x16x32_bf16 v[100:103], v[68:71], v[232:235], v[100:103]
    v_mfma_f32_16x16x32_bf16 v[100:103], v[72:75], v[236:239], v[100:103]
    s_waitcnt vmcnt(18)
    v_mfma_f32_16x16x32_bf16 v[88:91], v[76:79], a[60:63], v[88:91]
    v_mfma_f32_16x16x32_bf16 v[88:91], v[80:83], a[64:67], v[88:91]
    v_mfma_f32_16x16x32_bf16 v[120:123], v[84:87], a[68:71], v[88:91]
    v_mfma_f32_16x16x32_bf16 v[92:95], v[76:79], a[132:135], v[92:95]
    v_mfma_f32_16x16x32_bf16 v[92:95], v[80:83], a[136:139], v[92:95]
    v_mfma_f32_16x16x32_bf16 v[124:127], v[84:87], a[140:143], v[92:95]
    v_mfma_f32_16x16x32_bf16 v[96:99], v[76:79], a[204:207], v[96:99]
    s_mov_b32 s74, 268435456
    v_mfma_f32_16x16x32_bf16 v[96:99], v[80:83], a[208:211], v[96:99]
    s_add_u32 s27, s27, 1024
    v_mfma_f32_16x16x32_bf16 v[128:131], v[84:87], a[212:215], v[96:99]
    s_add_u32 s25, s25, 1
    v_mfma_f32_16x16x32_bf16 v[100:103], v[76:79], v[240:243], v[100:103]
    v_mfma_f32_16x16x32_bf16 v[100:103], v[80:83], v[244:247], v[100:103]
    s_add_u32 s23, s23, 18432
    v_mfma_f32_16x16x32_bf16 v[132:135], v[84:87], v[248:251], v[100:103]
    s_nop 7
    v_cvt_pk_bf16_f32 v152, v120, v121
    v_cvt_pk_bf16_f32 v153, v122, v123
    v_cvt_pk_bf16_f32 v154, v124, v125
    v_cvt_pk_bf16_f32 v155, v126, v127
    v_cvt_pk_bf16_f32 v156, v128, v129
    v_cvt_pk_bf16_f32 v157, v130, v131
    v_cvt_pk_bf16_f32 v158, v132, v133
    v_cvt_pk_bf16_f32 v159, v134, v135
    s_nop 1
    v_permlane16_swap_b32 v152, v154
    v_permlane16_swap_b32 v153, v155
    v_permlane16_swap_b32 v156, v158
    v_permlane16_swap_b32 v157, v159
    buffer_store_dwordx4 v[152:155], v178, s[72:75], s27 offen sc1
    buffer_store_dwordx4 v[156:159], v179, s[72:75], s27 offen sc1
    ds_write_b128 v216, v[152:155]
    v_add_u32 v216, v216, v218
    ds_write_b128 v217, v[156:159]
    v_add_u32 v217, v217, v219
    s_waitcnt lgkmcnt(0)
    v_lshlrev_b32 v15, 7, v0
    s_lshl_b32 s6, s40, 2
    s_add_u32 s6, s6, s44
    s_add_u32 s6, s6, 65536
    v_mov_b32 v1, s76
    s_mov_b64 vcc, 0xff
    s_waitcnt vmcnt(0)
    s_barrier
    s_cmp_lg_u32 s3, 0
    s_cbranch_scc1 L_pub_40
    s_mov_b64 exec, vcc
    buffer_store_dword v1, v15, s[8:11], s6 offen sc1
L_pub_40:
    s_mov_b64 exec, -1
    s_add_u32 s19, s18, s43
    s_add_u32 s22, s19, 45875200
    s_lshl_b32 s23, s21, 5
    s_add_u32 s23, s23, s43
    s_add_u32 s23, s23, 48431104
    v_and_b32 v12, 7, v0
    v_lshlrev_b32 v12, 2, v12
    buffer_load_dword v10, v12, s[8:11], s23 offen sc1
    buffer_load_dwordx4 v[92:95], v172, s[8:11], s22 offen sc1
    buffer_load_dwordx4 v[96:99], v173, s[8:11], s22 offen sc1
    buffer_load_dwordx4 v[100:103], v174, s[8:11], s22 offen sc1
    v_min_u32 v13, 9216, v173
    ds_read_b128 v[148:151], v172 offset:4096
    ds_read_b128 v[152:155], v13 offset:4096
    ds_read_b128 v[156:159], v174 offset:4096
    s_lshl_b32 s28, s40, 2
    s_add_u32 s28, s28, s3
    s_mul_i32 s28, s28, 73728
    s_mul_i32 s7, s42, 1073741824
    v_add_u32 v3, s7, v253
    v_lshlrev_b32 v16, 16, v104
    v_and_b32 v17, s16, v104
    v_lshlrev_b32 v18, 16, v105
    v_and_b32 v19, s16, v105
    v_lshlrev_b32 v20, 16, v106
    v_and_b32 v21, s16, v106
    v_lshlrev_b32 v22, 16, v107
    v_and_b32 v23, s16, v107
    v_lshlrev_b32 v24, 16, v108
    v_and_b32 v25, s16, v108
    v_lshlrev_b32 v26, 16, v109
    v_and_b32 v27, s16, v109
    v_lshlrev_b32 v28, 16, v110
    v_and_b32 v29, s16, v110
    v_lshlrev_b32 v30, 16, v111
    v_and_b32 v31, s16, v111
    s_cmp_lg_u32 s42, 0
    s_cbranch_scc1 L_nopf_41
    buffer_load_dwordx4 a[0:3], v3, s[8:11], s28 offen offset:0 sc1
    buffer_load_dwordx4 a[4:7], v3, s[8:11], s28 offen offset:1024 sc1
    buffer_load_dwordx4 a[8:11], v3, s[8:11], s28 offen offset:2048 sc1
    buffer_load_dwordx4 a[12:15], v3, s[8:11], s28 offen offset:3072 sc1
    s_add_u32 s28, s28, 4096
    buffer_load_dwordx4 a[16:19], v3, s[8:11], s28 offen offset:0 sc1
    buffer_load_dwordx4 a[20:23], v3, s[8:11], s28 offen offset:1024 sc1
    buffer_load_dwordx4 a[24:27], v3, s[8:11], s28 offen offset:2048 sc1
    buffer_load_dwordx4 a[28:31], v3, s[8:11], s28 offen offset:3072 sc1
L_nopf_41:
    v_lshlrev_b32 v40, 16, v112
    v_and_b32 v41, s16, v112
    v_lshlrev_b32 v42, 16, v113
    v_and_b32 v43, s16, v113
    v_lshlrev_b32 v44, 16, v114
    v_and_b32 v45, s16, v114
    v_lshlrev_b32 v46, 16, v115
    v_and_b32 v47, s16, v115
    v_pk_add_f32 v[16:17], v[16:17], v[40:41]
    v_pk_add_f32 v[18:19], v[18:19], v[42:43]
    v_pk_add_f32 v[20:21], v[20:21], v[44:45]
    v_pk_add_f32 v[22:23], v[22:23], v[46:47]
    v_lshlrev_b32 v40, 16, v116
    v_and_b32 v41, s16, v116
    v_lshlrev_b32 v42, 16, v117
    v_and_b32 v43, s16, v117
    v_lshlrev_b32 v44, 16, v118
    v_and_b32 v45, s16, v118
    v_lshlrev_b32 v46, 16, v119
    v_and_b32 v47, s16, v119
    v_pk_add_f32 v[24:25], v[24:25], v[40:41]
    v_pk_add_f32 v[26:27], v[26:27], v[42:43]
    v_pk_add_f32 v[28:29], v[28:29], v[44:45]
    v_pk_add_f32 v[30:31], v[30:31], v[46:47]
    s_cmp_lg_u32 s42, 0
    s_cbranch_scc1 L_nopf_42
    s_add_u32 s28, s28, 4096
    buffer_load_dwordx4 a[32:35], v3, s[8:11], s28 offen offset:0 sc1
    buffer_load_dwordx4 a[36:39], v3, s[8:11], s28 offen offset:1024 sc1
    buffer_load_dwordx4 a[40:43], v3, s[8:11], s28 offen offset:2048 sc1
    buffer_load_dwordx4 a[44:47], v3, s[8:11], s28 offen offset:3072 sc1
    s_add_u32 s28, s28, 4096
    buffer_load_dwordx4 a[48:51], v3, s[8:11], s28 offen offset:0 sc1
    buffer_load_dwordx4 a[52:55], v3, s[8:11], s28 offen offset:1024 sc1
    buffer_load_dwordx4 a[56:59], v3, s[8:11], s28 offen offset:2048 sc1
    buffer_load_dwordx4 a[60:63], v3, s[8:11], s28 offen offset:3072 sc1
L_nopf_42:
    v_lshlrev_b32 v40, 16, v180
    v_and_b32 v41, s16, v180
    v_lshlrev_b32 v42, 16, v181
    v_and_b32 v43, s16, v181
    v_lshlrev_b32 v44, 16, v182
    v_and_b32 v45, s16, v182
    v_lshlrev_b32 v46, 16, v183
    v_and_b32 v47, s16, v183
    v_pk_add_f32 v[16:17], v[16:17], v[40:41]
    v_pk_add_f32 v[18:19], v[18:19], v[42:43]
    v_pk_add_f32 v[20:21], v[20:21], v[44:45]
    v_pk_add_f32 v[22:23], v[22:23], v[46:47]
    v_lshlrev_b32 v40, 16, v196
    v_and_b32 v41, s16, v196
    v_lshlrev_b32 v42, 16, v197
    v_and_b32 v43, s16, v197
    v_lshlrev_b32 v44, 16, v198
    v_and_b32 v45, s16, v198
    v_lshlrev_b32 v46, 16, v199
    v_and_b32 v47, s16, v199
    v_pk_add_f32 v[24:25], v[24:25], v[40:41]
    v_pk_add_f32 v[26:27], v[26:27], v[42:43]
    v_pk_add_f32 v[28:29], v[28:29], v[44:45]
    v_pk_add_f32 v[30:31], v[30:31], v[46:47]
    v_lshlrev_b32 v40, 16, v200
    v_and_b32 v41, s16, v200
    v_lshlrev_b32 v42, 16, v201
    v_and_b32 v43, s16, v201
    v_lshlrev_b32 v44, 16, v202
    v_and_b32 v45, s16, v202
    v_lshlrev_b32 v46, 16, v203
    v_and_b32 v47, s16, v203
    v_pk_add_f32 v[16:17], v[16:17], v[40:41]
    v_pk_add_f32 v[18:19], v[18:19], v[42:43]
    v_pk_add_f32 v[20:21], v[20:21], v[44:45]
    v_pk_add_f32 v[22:23], v[22:23], v[46:47]
    v_lshlrev_b32 v40, 16, v204
    v_and_b32 v41, s16, v204
    v_lshlrev_b32 v42, 16, v205
    v_and_b32 v43, s16, v205
    v_lshlrev_b32 v44, 16, v206
    v_and_b32 v45, s16, v206
    v_lshlrev_b32 v46, 16, v207
    v_and_b32 v47, s16, v207
    v_pk_add_f32 v[24:25], v[24:25], v[40:41]
    v_pk_add_f32 v[26:27], v[26:27], v[42:43]
    v_pk_add_f32 v[28:29], v[28:29], v[44:45]
    v_pk_add_f32 v[30:31], v[30:31], v[46:47]
    s_cmp_lg_u32 s3, 3
    s_cbranch_scc1 L_pollout_45
    s_lshl_b32 s7, s40, 7
    s_add_u32 s7, s7, s44
    s_add_u32 s7, s7, 65536
    s_add_u32 s52, s4, s7
    s_addc_u32 s53, s5, 0
    s_mov_b32 s6, 0
L_poll_43:
    s_load_dwordx8 s[56:63], s[52:53], 0 glc
    s_add_u32 s6, s6, 1
    s_waitcnt lgkmcnt(0)
    s_xor_b64 s[56:57], s[56:57], s[76:77]
    s_xor_b64 s[58:59], s[58:59], s[76:77]
    s_xor_b64 s[60:61], s[60:61], s[76:77]
    s_xor_b64 s[62:63], s[62:63], s[76:77]
    s_or_b64 s[56:57], s[56:57], s[58:59]
    s_or_b64 s[60:61], s[60:61], s[62:63]
    s_or_b64 s[56:57], s[56:57], s[60:61]
    s_cbranch_scc0 L_polled_44
    s_cmp_lt_u32 s6, 1048576
    s_cbranch_scc1 L_poll_43
    s_branch L_main_end
L_polled_44:
L_pollout_45:
    s_barrier
    s_add_u32 s7, s40, 1
    s_and_b32 s7, s7, 7
    s_mul_i32 s7, s7, 9216
    s_add_u32 s19, s7, s20
    buffer_load_dwordx4 v[60:63], v174, s[8:11], s19 offen sc1
    s_add_u32 s7, s40, 2
    s_and_b32 s7, s7, 7
    s_mul_i32 s7, s7, 9216
    s_add_u32 s19, s7, s20
    buffer_load_dwordx4 v[64:67], v174, s[8:11], s19 offen sc1
    s_add_u32 s7, s40, 3
    s_and_b32 s7, s7, 7
    s_mul_i32 s7, s7, 9216
    s_add_u32 s19, s7, s20
    buffer_load_dwordx4 v[68:71], v174, s[8:11], s19 offen sc1
    s_add_u32 s7, s40, 4
    s_and_b32 s7, s7, 7
    s_mul_i32 s7, s7, 9216
    s_add_u32 s19, s7, s20
    buffer_load_dwordx4 v[72:75], v174, s[8:11], s19 offen sc1
    s_add_u32 s7, s40, 5
    s_and_b32 s7, s7, 7
    s_mul_i32 s7, s7, 9216
    s_add_u32 s19, s7, s20
    buffer_load_dwordx4 v[76:79], v174, s[8:11], s19 offen sc1
    s_add_u32 s7, s40, 6
    s_and_b32 s7, s7, 7
    s_mul_i32 s7, s7, 9216
    s_add_u32 s19, s7, s20
    buffer_load_dwordx4 v[80:83], v174, s[8:11], s19 offen sc1
    s_add_u32 s7, s40, 7
    s_and_b32 s7, s7, 7
    s_mul_i32 s7, s7, 9216
    s_add_u32 s19, s7, s20
    buffer_load_dwordx4 v[84:87], v174, s[8:11], s19 offen sc1
    v_lshlrev_b32 v40, 16, v208
    v_and_b32 v41, s16, v208
    v_lshlrev_b32 v42, 16, v209
    v_and_b32 v43, s16, v209
    v_lshlrev_b32 v44, 16, v210
    v_and_b32 v45, s16, v210
    v_lshlrev_b32 v46, 16, v211
    v_and_b32 v47, s16, v211
    v_pk_add_f32 v[16:17], v[16:17], v[40:41]
    v_pk_add_f32 v[18:19], v[18:19], v[42:43]
    v_pk_add_f32 v[20:21], v[20:21], v[44:45]
    v_pk_add_f32 v[22:23], v[22:23], v[46:47]
    v_lshlrev_b32 v40, 16, v212
    v_and_b32 v41, s16, v212
    v_lshlrev_b32 v42, 16, v213
    v_and_b32 v43, s16, v213
    v_lshlrev_b32 v44, 16, v214
    v_and_b32 v45, s16, v214
    v_lshlrev_b32 v46, 16, v215
    v_and_b32 v47, s16, v215
    v_pk_add_f32 v[24:25], v[24:25], v[40:41]
    v_pk_add_f32 v[26:27], v[26:27], v[42:43]
    v_pk_add_f32 v[28:29], v[28:29], v[44:45]
    v_pk_add_f32 v[30:31], v[30:31], v[46:47]
    v_lshlrev_b32 v40, 16, v136
    v_and_b32 v41, s16, v136
    v_lshlrev_b32 v42, 16, v137
    v_and_b32 v43, s16, v137
    v_lshlrev_b32 v44, 16, v138
    v_and_b32 v45, s16, v138
    v_lshlrev_b32 v46, 16, v139
    v_and_b32 v47, s16, v139
    v_pk_add_f32 v[16:17], v[16:17], v[40:41]
    v_pk_add_f32 v[18:19], v[18:19], v[42:43]
    v_pk_add_f32 v[20:21], v[20:21], v[44:45]
    v_pk_add_f32 v[22:23], v[22:23], v[46:47]
    v_lshlrev_b32 v40, 16, v140
    v_and_b32 v41, s16, v140
    v_lshlrev_b32 v42, 16, v141
    v_and_b32 v43, s16, v141
    v_lshlrev_b32 v44, 16, v142
    v_and_b32 v45, s16, v142
    v_lshlrev_b32 v46, 16, v143
    v_and_b32 v47, s16, v143
    v_pk_add_f32 v[24:25], v[24:25], v[40:41]
    v_pk_add_f32 v[26:27], v[26:27], v[42:43]
    v_pk_add_f32 v[28:29], v[28:29], v[44:45]
    v_pk_add_f32 v[30:31], v[30:31], v[46:47]
    v_lshlrev_b32 v40, 16, v144
    v_and_b32 v41, s16, v144
    v_lshlrev_b32 v42, 16, v145
    v_and_b32 v43, s16, v145
    v_lshlrev_b32 v44, 16, v146
    v_and_b32 v45, s16, v146
    v_lshlrev_b32 v46, 16, v147
    v_and_b32 v47, s16, v147
    v_pk_add_f32 v[16:17], v[16:17], v[40:41]
    v_pk_add_f32 v[18:19], v[18:19], v[42:43]
    v_pk_add_f32 v[20:21], v[20:21], v[44:45]
    v_pk_add_f32 v[22:23], v[22:23], v[46:47]
    v_lshlrev_b32 v40, 16, v160
    v_and_b32 v41, s16, v160
    v_lshlrev_b32 v42, 16, v161
    v_and_b32 v43, s16, v161
    v_lshlrev_b32 v44, 16, v162
    v_and_b32 v45, s16, v162
    v_lshlrev_b32 v46, 16, v163
    v_and_b32 v47, s16, v163
    v_pk_add_f32 v[24:25], v[24:25], v[40:41]
    v_pk_add_f32 v[26:27], v[26:27], v[42:43]
    v_pk_add_f32 v[28:29], v[28:29], v[44:45]
    v_pk_add_f32 v[30:31], v[30:31], v[46:47]
    s_cmp_eq_u32 s3, 0
    s_cselect_b32 s7, 1.0, 0
    s_cselect_b32 s6, -1, 0
    s_waitcnt vmcnt(7) lgkmcnt(0)
    v_and_b32 v152, s6, v152
    v_and_b32 v153, s6, v153
    v_and_b32 v154, s6, v154
    v_and_b32 v155, s6, v155
    v_mul_f32 v11, s7, v10
    v_lshlrev_b32 v40, 16, v92
    v_and_b32 v41, s16, v92
    v_lshlrev_b32 v42, 16, v93
    v_and_b32 v43, s16, v93
    v_lshlrev_b32 v44, 16, v94
    v_and_b32 v45, s16, v94
    v_lshlrev_b32 v46, 16, v95
    v_and_b32 v47, s16, v95
    v_pk_add_f32 v[16:17], v[16:17], v[40:41]
    v_pk_add_f32 v[18:19], v[18:19], v[42:43]
    v_pk_add_f32 v[20:21], v[20:21], v[44:45]
    v_pk_add_f32 v[22:23], v[22:23], v[46:47]
    v_lshlrev_b32 v40, 16, v96
    v_and_b32 v41, s16, v96
    v_lshlrev_b32 v42, 16, v97
    v_and_b32 v43, s16, v97
    v_lshlrev_b32 v44, 16, v98
    v_and_b32 v45, s16, v98
    v_lshlrev_b32 v46, 16, v99
    v_and_b32 v47, s16, v99
    v_pk_add_f32 v[24:25], v[24:25], v[40:41]
    v_pk_add_f32 v[26:27], v[26:27], v[42:43]
    v_pk_add_f32 v[28:29], v[28:29], v[44:45]
    v_pk_add_f32 v[30:31], v[30:31], v[46:47]
    v_lshlrev_b32 v32, 16, v100
    v_and_b32 v33, s16, v100
    v_lshlrev_b32 v34, 16, v101
    v_and_b32 v35, s16, v101
    v_lshlrev_b32 v36, 16, v102
    v_and_b32 v37, s16, v102
    v_lshlrev_b32 v38, 16, v103
    v_and_b32 v39, s16, v103
    v_lshlrev_b32 v40, 16, v148
    v_and_b32 v41, s16, v148
    v_lshlrev_b32 v42, 16, v149
    v_and_b32 v43, s16, v149
    v_lshlrev_b32 v44, 16, v150
    v_and_b32 v45, s16, v150
    v_lshlrev_b32 v46, 16, v151
    v_and_b32 v47, s16, v151
    v_pk_add_f32 v[16:17], v[16:17], v[40:41]
    v_pk_add_f32 v[18:19], v[18:19], v[42:43]
    v_pk_add_f32 v[20:21], v[20:21], v[44:45]
    v_pk_add_f32 v[22:23], v[22:23], v[46:47]
    v_lshlrev_b32 v40, 16, v152
    v_and_b32 v41, s16, v152
    v_lshlrev_b32 v42, 16, v153
    v_and_b32 v43, s16, v153
    v_lshlrev_b32 v44, 16, v154
    v_and_b32 v45, s16, v154
    v_lshlrev_b32 v46, 16, v155
    v_and_b32 v47, s16, v155
    v_pk_add_f32 v[24:25], v[24:25], v[40:41]
    v_pk_add_f32 v[26:27], v[26:27], v[42:43]
    v_pk_add_f32 v[28:29], v[28:29], v[44:45]
    v_pk_add_f32 v[30:31], v[30:31], v[46:47]
    v_lshlrev_b32 v40, 16, v156
    v_and_b32 v41, s16, v156
    v_lshlrev_b32 v42, 16, v157
    v_and_b32 v43, s16, v157
    v_lshlrev_b32 v44, 16, v158
    v_and_b32 v45, s16, v158
    v_lshlrev_b32 v46, 16, v159
    v_and_b32 v47, s16, v159
    v_pk_add_f32 v[32:33], v[32:33], v[40:41]
    v_pk_add_f32 v[34:35], v[34:35], v[42:43]
    v_pk_add_f32 v[36:37], v[36:37], v[44:45]
    v_pk_add_f32 v[38:39], v[38:39], v[46:47]
    v_pk_add_f32 v[16:17], v[16:17], v[10:11] op_sel_hi:[1,0]
    v_pk_add_f32 v[18:19], v[18:19], v[10:11] op_sel_hi:[1,0]
    v_pk_add_f32 v[20:21], v[20:21], v[10:11] op_sel_hi:[1,0]
    v_pk_add_f32 v[22:23], v[22:23], v[10:11] op_sel_hi:[1,0]
    v_pk_add_f32 v[24:25], v[24:25], v[10:11] op_sel:[0,1] op_sel_hi:[1,1]
    v_pk_add_f32 v[26:27], v[26:27], v[10:11] op_sel:[0,1] op_sel_hi:[1,1]
    v_pk_add_f32 v[28:29], v[28:29], v[10:11] op_sel:[0,1] op_sel_hi:[1,1]
    v_pk_add_f32 v[30:31], v[30:31], v[10:11] op_sel:[0,1] op_sel_hi:[1,1]
    v_pk_add_f32 v[32:33], v[32:33], v[10:11] op_sel_hi:[1,0]
    v_pk_add_f32 v[34:35], v[34:35], v[10:11] op_sel_hi:[1,0]
    v_pk_add_f32 v[36:37], v[36:37], v[10:11] op_sel_hi:[1,0]
    v_pk_add_f32 v[38:39], v[38:39], v[10:11] op_sel_hi:[1,0]
    s_waitcnt vmcnt(6)
    s_add_u32 s28, s28, 4096
    buffer_load_dwordx4 a[64:67], v3, s[8:11], s28 offen offset:0 sc1
    v_lshlrev_b32 v40, 16, v60
    v_and_b32 v41, s16, v60
    v_lshlrev_b32 v42, 16, v61
    v_and_b32 v43, s16, v61
    v_lshlrev_b32 v44, 16, v62
    v_and_b32 v45, s16, v62
    v_lshlrev_b32 v46, 16, v63
    v_and_b32 v47, s16, v63
    v_pk_add_f32 v[32:33], v[32:33], v[40:41]
    v_pk_add_f32 v[34:35], v[34:35], v[42:43]
    v_pk_add_f32 v[36:37], v[36:37], v[44:45]
    v_pk_add_f32 v[38:39], v[38:39], v[46:47]
    s_waitcnt vmcnt(6)
    buffer_load_dwordx4 a[68:71], v3, s[8:11], s28 offen offset:1024 sc1
    v_lshlrev_b32 v40, 16, v64
    v_and_b32 v41, s16, v64
    v_lshlrev_b32 v42, 16, v65
    v_and_b32 v43, s16, v65
    v_lshlrev_b32 v44, 16, v66
    v_and_b32 v45, s16, v66
    v_lshlrev_b32 v46, 16, v67
    v_and_b32 v47, s16, v67
    v_pk_add_f32 v[32:33], v[32:33], v[40:41]
    v_pk_add_f32 v[34:35], v[34:35], v[42:43]
    v_pk_add_f32 v[36:37], v[36:37], v[44:45]
    v_pk_add_f32 v[38:39], v[38:39], v[46:47]
    s_waitcnt vmcnt(6)
    buffer_load_dwordx4 a[72:75], v3, s[8:11], s28 offen offset:2048 sc1
    v_lshlrev_b32 v40, 16, v68
    v_and_b32 v41, s16, v68
    v_lshlrev_b32 v42, 16, v69
    v_and_b32 v43, s16, v69
    v_lshlrev_b32 v44, 16, v70
    v_and_b32 v45, s16, v70
    v_lshlrev_b32 v46, 16, v71
    v_and_b32 v47, s16, v71
    v_pk_add_f32 v[32:33], v[32:33], v[40:41]
    v_pk_add_f32 v[34:35], v[34:35], v[42:43]
    v_pk_add_f32 v[36:37], v[36:37], v[44:45]
    v_pk_add_f32 v[38:39], v[38:39], v[46:47]
    s_waitcnt vmcnt(6)
    buffer_load_dwordx4 a[76:79], v3, s[8:11], s28 offen offset:3072 sc1
    v_lshlrev_b32 v40, 16, v72
    v_and_b32 v41, s16, v72
    v_lshlrev_b32 v42, 16, v73
    v_and_b32 v43, s16, v73
    v_lshlrev_b32 v44, 16, v74
    v_and_b32 v45, s16, v74
    v_lshlrev_b32 v46, 16, v75
    v_and_b32 v47, s16, v75
    v_pk_add_f32 v[32:33], v[32:33], v[40:41]
    v_pk_add_f32 v[34:35], v[34:35], v[42:43]
    v_pk_add_f32 v[36:37], v[36:37], v[44:45]
    v_pk_add_f32 v[38:39], v[38:39], v[46:47]
    s_waitcnt vmcnt(6)
    s_add_u32 s28, s28, 4096
    buffer_load_dwordx4 a[80:83], v3, s[8:11], s28 offen offset:0 sc1
    v_lshlrev_b32 v40, 16, v76
    v_and_b32 v41, s16, v76
    v_lshlrev_b32 v42, 16, v77
    v_and_b32 v43, s16, v77
    v_lshlrev_b32 v44, 16, v78
    v_and_b32 v45, s16, v78
    v_lshlrev_b32 v46, 16, v79
    v_and_b32 v47, s16, v79
    v_pk_add_f32 v[32:33], v[32:33], v[40:41]
    v_pk_add_f32 v[34:35], v[34:35], v[42:43]
    v_pk_add_f32 v[36:37], v[36:37], v[44:45]
    v_pk_add_f32 v[38:39], v[38:39], v[46:47]
    s_waitcnt vmcnt(6)
    buffer_load_dwordx4 a[84:87], v3, s[8:11], s28 offen offset:1024 sc1
    v_lshlrev_b32 v40, 16, v80
    v_and_b32 v41, s16, v80
    v_lshlrev_b32 v42, 16, v81
    v_and_b32 v43, s16, v81
    v_lshlrev_b32 v44, 16, v82
    v_and_b32 v45, s16, v82
    v_lshlrev_b32 v46, 16, v83
    v_and_b32 v47, s16, v83
    v_pk_add_f32 v[32:33], v[32:33], v[40:41]
    v_pk_add_f32 v[34:35], v[34:35], v[42:43]
    v_pk_add_f32 v[36:37], v[36:37], v[44:45]
    v_pk_add_f32 v[38:39], v[38:39], v[46:47]
    s_waitcnt vmcnt(6)
    buffer_load_dwordx4 a[88:91], v3, s[8:11], s28 offen offset:2048 sc1
    v_lshlrev_b32 v40, 16, v84
    v_and_b32 v41, s16, v84
    v_lshlrev_b32 v42, 16, v85
    v_and_b32 v43, s16, v85
    v_lshlrev_b32 v44, 16, v86
    v_and_b32 v45, s16, v86
    v_lshlrev_b32 v46, 16, v87
    v_and_b32 v47, s16, v87
    v_pk_add_f32 v[32:33], v[32:33], v[40:41]
    v_pk_add_f32 v[34:35], v[34:35], v[42:43]
    v_pk_add_f32 v[36:37], v[36:37], v[44:45]
    v_pk_add_f32 v[38:39], v[38:39], v[46:47]
    buffer_load_dwordx4 a[92:95], v3, s[8:11], s28 offen offset:3072 sc1
    v_cvt_pk_bf16_f32 v120, v16, v17
    v_cvt_pk_bf16_f32 v121, v18, v19
    v_cvt_pk_bf16_f32 v122, v20, v21
    v_cvt_pk_bf16_f32 v123, v22, v23
    v_cvt_pk_bf16_f32 v124, v24, v25
    v_cvt_pk_bf16_f32 v125, v26, v27
    v_cvt_pk_bf16_f32 v126, v28, v29
    v_cvt_pk_bf16_f32 v127, v30, v31
    v_cvt_pk_bf16_f32 v128, v32, v33
    v_cvt_pk_bf16_f32 v129, v34, v35
    v_cvt_pk_bf16_f32 v130, v36, v37
    v_cvt_pk_bf16_f32 v131, v38, v39
    s_cmp_lg_u32 s42, 0
    s_cbranch_scc1 L_main_last
    s_add_u32 s19, s18, 53215232
    s_add_u32 s20, s18, 48496640
    s_lshl_b32 s22, s21, 7
    s_add_u32 s22, s22, 57933824
    buffer_store_dwordx4 v[120:123], v172, s[8:11], s19 offen sc1
    buffer_store_dwordx4 v[124:127], v173, s[8:11], s19 offen sc1
    buffer_store_dwordx4 v[128:131], v174, s[8:11], s19 offen sc1
    s_mov_b32 s17, 0x3f803f80
    v_mov_b32 v8, 0
    v_mov_b32 v9, 0
    v_mov_b32 v10, 0
    v_mov_b32 v11, 0
    v_dot2c_f32_bf16 v8, s17, v120
    v_dot2c_f32_bf16 v9, v120, v120
    v_dot2c_f32_bf16 v10, s17, v121
    v_dot2c_f32_bf16 v11, v121, v121
    v_dot2c_f32_bf16 v8, s17, v122
    v_dot2c_f32_bf16 v9, v122, v122
    v_dot2c_f32_bf16 v10, s17, v123
    v_dot2c_f32_bf16 v11, v123, v123
    v_dot2c_f32_bf16 v8, s17, v124
    v_dot2c_f32_bf16 v9, v124, v124
    v_dot2c_f32_bf16 v10, s17, v125
    v_dot2c_f32_bf16 v11, v125, v125
    v_dot2c_f32_bf16 v8, s17, v126
    v_dot2c_f32_bf16 v9, v126, v126
    v_dot2c_f32_bf16 v10, s17, v127
    v_dot2c_f32_bf16 v11, v127, v127
    v_dot2c_f32_bf16 v8, s17, v128
    v_dot2c_f32_bf16 v9, v128, v128
    v_dot2c_f32_bf16 v10, s17, v129
    v_dot2c_f32_bf16 v11, v129, v129
    v_dot2c_f32_bf16 v8, s17, v130
    v_dot2c_f32_bf16 v9, v130, v130
    v_dot2c_f32_bf16 v10, s17, v131
    v_dot2c_f32_bf16 v11, v131, v131
    v_and_b32 v12, 7, v0
    v_lshlrev_b32 v12, 3, v12
    s_lshl_b32 s7, s3, 6
    v_add_u32 v13, s7, v12
    v_pk_add_f32 v[8:9], v[8:9], v[10:11]
    s_nop 1
    v_add_f32_dpp v8, v8, v8 row_ror:8 row_mask:0xf bank_mask:0xf
    v_add_f32_dpp v9, v9, v9 row_ror:8 row_mask:0xf bank_mask:0xf
    v_mov_b32 v10, v8
    v_mov_b32 v11, v9
    s_nop 1
    v_permlane32_swap_b32 v10, v8
    v_permlane32_swap_b32 v11, v9
    v_add_f32 v8, v8, v10
    v_add_f32 v9, v9, v11
    v_mov_b32 v10, v8
    v_mov_b32 v11, v9
    s_nop 1
    v_permlane16_swap_b32 v10, v8
    v_permlane16_swap_b32 v11, v9
    v_add_f32 v8, v8, v10
    v_add_f32 v9, v9, v11
    ds_write_b64 v13, v[8:9]
    s_waitcnt lgkmcnt(0)
    s_barrier
    ds_read_b64 v[40:41], v12 offset:0
    ds_read_b64 v[42:43], v12 offset:64
    ds_read_b64 v[44:45], v12 offset:128
    ds_read_b64 v[46:47], v12 offset:192
    s_waitcnt lgkmcnt(0)
    v_pk_add_f32 v[40:41], v[40:41], v[42:43]
    v_pk_add_f32 v[44:45], v[44:45], v[46:47]
    v_pk_add_f32 v[8:9], v[40:41], v[44:45]
    v_mul_f32 v8, 0x3ae38e39, v8
    v_mul_f32 v9, 0x3ae38e39, v9
    v_fma_f32 v9, -v8, v8, v9
    v_max_f32 v9, 0, v9
    v_add_f32 v9, 0x3727c5ac, v9
    v_rsq_f32 v10, v9
    s_nop 0
    v_mul_f32 v12, v8, v10
    v_mov_b32 v11, v10
    v_sub_f32 v12, 0, v12
    v_mov_b32 v13, v12
    s_cmp_eq_u32 s3, 0
    s_cselect_b32 s7, 32, 0
    v_lshlrev_b32 v14, 2, v0
    v_cmp_gt_u32 vcc, s7, v0
    v_mov_b32 v9, 1073741824
    s_nop 0
    v_cndmask_b32 v14, v9, v14, vcc
    buffer_store_dword v8, v14, s[8:11], s22 offen sc1
    v_lshlrev_b32 v40, 16, v120
    v_and_b32 v41, s16, v120
    v_lshlrev_b32 v42, 16, v121
    v_and_b32 v43, s16, v121
    v_lshlrev_b32 v44, 16, v122
    v_and_b32 v45, s16, v122
    v_lshlrev_b32 v46, 16, v123
    v_and_b32 v47, s16, v123
    v_pk_fma_f32 v[40:41], v[40:41], v[10:11], v[12:13]
    v_pk_fma_f32 v[42:43], v[42:43], v[10:11], v[12:13]
    v_pk_fma_f32 v[44:45], v[44:45], v[10:11], v[12:13]
    v_pk_fma_f32 v[46:47], v[46:47], v[10:11], v[12:13]
    v_cvt_pk_bf16_f32 v48, v40, v41
    v_cvt_pk_bf16_f32 v49, v42, v43
    v_cvt_pk_bf16_f32 v50, v44, v45
    v_cvt_pk_bf16_f32 v51, v46, v47
    v_lshlrev_b32 v40, 16, v124
    v_and_b32 v41, s16, v124
    v_lshlrev_b32 v42, 16, v125
    v_and_b32 v43, s16, v125
    v_lshlrev_b32 v44, 16, v126
    v_and_b32 v45, s16, v126
    v_lshlrev_b32 v46, 16, v127
    v_and_b32 v47, s16, v127
    v_pk_fma_f32 v[40:41], v[40:41], v[10:11], v[12:13]
    v_pk_fma_f32 v[42:43], v[42:43], v[10:11], v[12:13]
    v_pk_fma_f32 v[44:45], v[44:45], v[10:11], v[12:13]
    v_pk_fma_f32 v[46:47], v[46:47], v[10:11], v[12:13]
    v_cvt_pk_bf16_f32 v52, v40, v41
    v_cvt_pk_bf16_f32 v53, v42, v43
    v_cvt_pk_bf16_f32 v54, v44, v45
    v_cvt_pk_bf16_f32 v55, v46, v47
    v_lshlrev_b32 v40, 16, v128
    v_and_b32 v41, s16, v128
    v_lshlrev_b32 v42, 16, v129
    v_and_b32 v43, s16, v129
    v_lshlrev_b32 v44, 16, v130
    v_and_b32 v45, s16, v130
    v_lshlrev_b32 v46, 16, v131
    v_and_b32 v47, s16, v131
    v_pk_fma_f32 v[40:41], v[40:41], v[10:11], v[12:13]
    v_pk_fma_f32 v[42:43], v[42:43], v[10:11], v[12:13]
    v_pk_fma_f32 v[44:45], v[44:45], v[10:11], v[12:13]
    v_pk_fma_f32 v[46:47], v[46:47], v[10:11], v[12:13]
    v_cvt_pk_bf16_f32 v56, v40, v41
    v_cvt_pk_bf16_f32 v57, v42, v43
    v_cvt_pk_bf16_f32 v58, v44, v45
    v_cvt_pk_bf16_f32 v59, v46, v47
    buffer_store_dwordx4 v[48:51], v172, s[8:11], s20 offen sc1
    buffer_store_dwordx4 v[52:55], v173, s[8:11], s20 offen sc1
    buffer_store_dwordx4 v[56:59], v174, s[8:11], s20 offen sc1
    v_lshlrev_b32 v15, 7, v0
    s_lshl_b32 s6, s40, 2
    s_add_u32 s6, s6, s44
    s_add_u32 s6, s6, 98304
    v_mov_b32 v1, s76
    s_mov_b64 vcc, 0xff
    v_lshrrev_b32 v14, 3, v0
    v_lshl_add_u32 v15, v14, 3, v15
    s_cmp_ge_u32 s40, 6
    s_cselect_b32 s7, s41, 31
    s_cmp_lt_u32 s7, 31
    s_cmov_b64 vcc, 0xffff
    s_waitcnt vmcnt(0)
    s_barrier
    s_cmp_lg_u32 s3, 0
    s_cbranch_scc1 L_pub_46
    s_mov_b64 exec, vcc
    buffer_store_dword v1, v15, s[8:11], s6 offen sc1
L_pub_46:
    s_mov_b64 exec, -1
    s_add_u32 s28, s28, 4096
    buffer_load_dwordx4 a[96:99], v3, s[8:11], s28 offen offset:0 sc1
    buffer_load_dwordx4 a[100:103], v3, s[8:11], s28 offen offset:1024 sc1
    buffer_load_dwordx4 a[104:107], v3, s[8:11], s28 offen offset:2048 sc1
    buffer_load_dwordx4 a[108:111], v3, s[8:11], s28 offen offset:3072 sc1
    s_add_u32 s28, s28, 4096
    buffer_load_dwordx4 a[112:115], v3, s[8:11], s28 offen offset:0 sc1
    buffer_load_dwordx4 a[116:119], v3, s[8:11], s28 offen offset:1024 sc1
    buffer_load_dwordx4 a[120:123], v3, s[8:11], s28 offen offset:2048 sc1
    buffer_load_dwordx4 a[124:127], v3, s[8:11], s28 offen offset:3072 sc1
    s_add_u32 s28, s28, 4096
    buffer_load_dwordx4 a[128:131], v3, s[8:11], s28 offen offset:0 sc1
    buffer_load_dwordx4 a[132:135], v3, s[8:11], s28 offen offset:1024 sc1
    buffer_load_dwordx4 a[136:139], v3, s[8:11], s28 offen offset:2048 sc1
    buffer_load_dwordx4 a[140:143], v3, s[8:11], s28 offen offset:3072 sc1
    s_add_u32 s28, s28, 4096
    s_mov_b32 s42, 1
    s_mov_b32 s43, 9699328
    s_add_u32 s44, s44, 131072
    s_mov_b32 s74, 0
    s_branch L_main_layer
L_main_last:
    buffer_store_dwordx4 v[120:123], v175, s[12:15], s18 offen sc0 sc1
    buffer_store_dwordx4 v[124:127], v176, s[12:15], s18 offen sc0 sc1
    buffer_store_dwordx4 v[128:131], v177, s[12:15], s18 offen sc0 sc1
    s_or_b32 s7, s40, s41
    s_or_b32 s7, s7, s3
    s_cbranch_scc1 L_done_47
    v_mov_b32 v1, s76
    s_mov_b32 s7, 19660800
    s_mov_b64 exec, 1
    buffer_store_dword v1, off, s[8:11], s7 sc1
    s_mov_b64 exec, -1
L_done_47:
L_main_end:
    s_endpgm
L_main_code_end:
.section .rodata,"a"
.p2align 6
.amdhsa_kernel interleave_layers__sliding_local_dilated__glu_gated_geglu__prompt_kernel
.amdhsa_next_free_vgpr 512
.amdhsa_next_free_sgpr 102
.amdhsa_accum_offset 256
.amdhsa_group_segment_fixed_size 0
.amdhsa_kernarg_size 80
.amdhsa_user_sgpr_count 2
.amdhsa_user_sgpr_kernarg_segment_ptr 1
.amdhsa_system_sgpr_workgroup_id_x 1
.amdhsa_float_denorm_mode_32 3
.amdhsa_float_denorm_mode_16_64 3
.end_amdhsa_kernel
```

```asm
; @launch grid=(256,1,1) block=(256,1,1) lds=163840
.amdgcn_target "amdgcn-amd-amdhsa--gfx950"
.text
.globl interleave_layers__sliding_local_dilated__glu_gated_geglu__prompt_kernel
.p2align 8
.type interleave_layers__sliding_local_dilated__glu_gated_geglu__prompt_kernel,@function
interleave_layers__sliding_local_dilated__glu_gated_geglu__prompt_kernel:
    s_cmp_ge_u32 s2, 256
    s_cbranch_scc1 L_main_end
    s_load_dwordx2 s[4:5], s[0:1], 72
    s_load_dwordx4 s[16:19], s[0:1], 0
    s_load_dwordx2 s[22:23], s[0:1], 16
    s_load_dwordx8 s[24:31], s[0:1], 32
    s_getpc_b64 s[96:97]
L_main_pc:
    s_sub_u32 s96, s96, L_main_pc-interleave_layers__sliding_local_dilated__glu_gated_geglu__prompt_kernel
    s_subb_u32 s97, s97, 0
    s_and_b32 s97, s97, 0xffff
    s_mov_b32 s98, L_main_code_end-interleave_layers__sliding_local_dilated__glu_gated_geglu__prompt_kernel
    s_mov_b32 s99, 0x20000
    s_lshr_b32 s7, s2, 3
    s_lshl_b32 s7, s7, 11
    v_lshl_add_u32 v253, v0, 3, s7
    buffer_load_dwordx2 v[2:3], v253, s[96:99], 0 offen
    v_lshrrev_b32 v1, 6, v0
    v_and_b32 v0, 63, v0
    v_readfirstlane_b32 s3, v1
    s_waitcnt lgkmcnt(0)
    s_mov_b32 s8, s4
    s_and_b32 s9, s5, 0xffff
    s_mov_b32 s10, 268435456
    s_mov_b32 s11, 0x20000
    s_mov_b32 s7, 19660800
    s_load_dword s76, s[4:5], s7
    s_mov_b64 s[20:21], s[18:19]
    s_mov_b64 s[18:19], s[16:17]
    s_mov_b32 s48, s4
    s_and_b32 s49, s5, 0xffff
    s_mov_b32 s50, 268435456
    s_mov_b32 s51, 0x20000
    s_and_b32 s40, s2, 3
    s_lshl_b32 s40, s40, 1
    s_bfe_u32 s7, s2, 65539
    s_add_u32 s40, s40, s7
    s_bfe_u32 s41, s2, 65538
    s_lshl_b32 s41, s41, 4
    s_lshr_b32 s7, s2, 4
    s_add_u32 s41, s41, s7
    s_mov_b32 s42, 0
    s_mov_b32 s43, 0
    s_lshl_b32 s44, s41, 10
    s_add_u32 s44, s44, 19169280
    v_lshlrev_b32 v253, 4, v0
    s_mov_b32 s12, s18
    s_and_b32 s13, s19, 0xffff
    s_mov_b32 s14, 2359296
    s_mov_b32 s15, 0x20000
    s_mov_b32 s64, s20
    s_and_b32 s65, s21, 0xffff
    s_mov_b32 s66, 1990656
    s_mov_b32 s67, 0x20000
    s_mov_b32 s68, s22
    s_and_b32 s69, s23, 0xffff
    s_mov_b32 s70, 663552
    s_mov_b32 s71, 0x20000
    s_mov_b32 s16, 0xffff0000
    s_lshl_b32 s7, s3, 10
    v_add_u32 v172, s7, v253
    v_add_u32 v174, 5120, v172
    v_and_b32 v178, 7, v0
    v_mul_u32_u24 v178, 1152, v178
    v_lshrrev_b32 v179, 3, v0
    v_lshl_add_u32 v178, v179, 4, v178
    s_lshl_b32 s7, s3, 7
    v_add_u32 v175, s7, v178
    v_add_u32 v177, 640, v175
    s_cmp_eq_u32 s3, 0
    s_mov_b32 s17, 1073741824
    s_cmov_b32 s17, 4096
    v_add_u32 v173, s17, v172
    s_mov_b32 s17, 1073741824
    s_cmov_b32 s17, 512
    v_add_u32 v176, s17, v175
    s_lshl_b32 s21, s41, 3
    s_add_u32 s21, s21, s40
    s_mul_i32 s18, s21, 9216
    buffer_load_dwordx4 v[16:19], v175, s[12:15], s18 offen nt
    buffer_load_dwordx4 v[20:23], v176, s[12:15], s18 offen nt
    buffer_load_dwordx4 v[24:27], v177, s[12:15], s18 offen nt
    s_mov_b32 s12, s30
    s_and_b32 s13, s31, 0xffff
    s_mov_b32 s14, 2359296
    s_mov_b32 s15, 0x20000
    s_lshl_b32 s79, s3, 14
    s_add_u32 s79, s79, 98304
    s_sub_u32 s36, s21, 144
    s_cmp_ge_u32 s41, 18
    s_cbranch_scc1 L_prep_o_1
    s_mul_i32 s35, s41, 110592
    s_mul_i32 s7, s40, 144
    s_and_b32 s46, s7, 127
    s_sub_u32 s7, s7, s46
    s_add_u32 s35, s35, s7
    s_mul_i32 s7, s3, 13824
    s_add_u32 s35, s35, s7
    v_lshrrev_b32 v8, 4, v0
    v_mul_u32_u24 v8, 3456, v8
    v_and_b32 v9, 15, v0
    v_lshl_add_u32 v8, v9, 4, v8
    s_lshl_b32 s34, s3, 10
    s_add_u32 m0, s34, 8192
    s_add_u32 s7, s35, 0
    buffer_load_dwordx4 v8, s[64:67], s7 offen nt lds
    s_add_u32 m0, s34, 12288
    s_add_u32 s7, s35, 55296
    buffer_load_dwordx4 v8, s[64:67], s7 offen nt lds
    s_add_u32 m0, s34, 16384
    s_add_u32 s7, s35, 1152
    buffer_load_dwordx4 v8, s[64:67], s7 offen nt lds
    s_add_u32 m0, s34, 20480
    s_add_u32 s7, s35, 56448
    buffer_load_dwordx4 v8, s[64:67], s7 offen nt lds
    s_add_u32 m0, s34, 24576
    s_add_u32 s7, s35, 2304
    buffer_load_dwordx4 v8, s[64:67], s7 offen nt lds
    s_add_u32 m0, s34, 28672
    s_add_u32 s7, s35, 57600
    buffer_load_dwordx4 v8, s[64:67], s7 offen nt lds
    s_branch L_prep_go_3
L_prep_o_1:
    s_cmp_ge_u32 s36, 54
    s_cbranch_scc1 L_prep_m_2
    s_mul_i32 s33, s36, 349526
    s_lshr_b32 s33, s33, 20
    s_mul_i32 s34, s33, 3
    s_sub_u32 s34, s36, s34
    s_lshl_b32 s7, s33, 2
    s_add_u32 s7, s7, s3
    v_mov_b32 v8, s7
    v_lshrrev_b32 v9, 3, v0
    v_mul_u32_u24 v11, 7282, v8
    v_lshrrev_b32 v11, 16, v11
    v_mul_u32_u24 v12, 9, v11
    v_sub_u32 v12, v8, v12
    v_mul_u32_u24 v11, 72, v11
    v_cmp_eq_u32 vcc, 8, v12
    v_lshrrev_b32 v10, 1, v12
    v_mad_u32_u24 v10, v10, 18, v11
    v_and_b32 v12, 1, v12
    v_lshl_add_u32 v10, v12, 3, v10
    v_add_u32 v10, v10, v9
    v_lshrrev_b32 v12, 1, v9
    v_mad_u32_u24 v11, v12, 18, v11
    v_and_b32 v12, 1, v9
    v_add3_u32 v11, v11, v12, 16
    v_cndmask_b32 v10, v10, v11, vcc
    v_mul_u32_u24 v10, 1152, v10
    v_and_b32 v9, 7, v0
    v_lshl_add_u32 v10, v9, 4, v10
    s_mul_i32 s35, s34, 384
    s_lshl_b32 s6, s3, 10
    s_add_u32 m0, s6, 8192
    s_add_u32 s7, s35, 0
    buffer_load_dwordx4 v10, s[68:71], s7 offen nt lds
    s_add_u32 m0, s6, 12288
    s_add_u32 s7, s35, 128
    buffer_load_dwordx4 v10, s[68:71], s7 offen nt lds
    s_add_u32 m0, s6, 16384
    s_add_u32 s7, s35, 256
    buffer_load_dwordx4 v10, s[68:71], s7 offen nt lds
    s_branch L_prep_go_3
L_prep_m_2:
    s_sub_u32 s37, s36, 54
    s_lshl_b32 s7, s3, 6
    s_add_u32 s37, s37, s7
    s_cmp_ge_u32 s37, 36
    s_cbranch_scc1 L_prep_go_3
    s_lshl_b32 s7, s37, 1
    v_bfe_u32 v8, v0, 3, 1
    v_add_u32 v8, s7, v8
    v_and_b32 v9, 7, v0
    v_mul_u32_u24 v11, 7282, v8
    v_lshrrev_b32 v11, 16, v11
    v_mul_u32_u24 v12, 9, v11
    v_sub_u32 v12, v8, v12
    v_mul_u32_u24 v11, 72, v11
    v_cmp_eq_u32 vcc, 8, v12
    v_lshrrev_b32 v10, 1, v12
    v_mad_u32_u24 v10, v10, 18, v11
    v_and_b32 v12, 1, v12
    v_lshl_add_u32 v10, v12, 3, v10
    v_add_u32 v10, v10, v9
    v_lshrrev_b32 v12, 1, v9
    v_mad_u32_u24 v11, v12, 18, v11
    v_and_b32 v12, 1, v9
    v_add3_u32 v11, v11, v12, 16
    v_cndmask_b32 v10, v10, v11, vcc
    v_mul_u32_u24 v10, 1152, v10
    v_lshrrev_b32 v9, 4, v0
    v_lshl_add_u32 v10, v9, 4, v10
    buffer_load_dwordx4 v[64:67], v10, s[68:71], 0 offen offset:0
    buffer_load_dwordx4 v[68:71], v10, s[68:71], 0 offen offset:64
    buffer_load_dwordx4 v[72:75], v10, s[68:71], 0 offen offset:128
    buffer_load_dwordx4 v[76:79], v10, s[68:71], 0 offen offset:192
    buffer_load_dwordx4 v[80:83], v10, s[68:71], 0 offen offset:256
    buffer_load_dwordx4 v[84:87], v10, s[68:71], 0 offen offset:320
    buffer_load_dwordx4 v[88:91], v10, s[68:71], 0 offen offset:384
    buffer_load_dwordx4 v[92:95], v10, s[68:71], 0 offen offset:448
    buffer_load_dwordx4 v[96:99], v10, s[68:71], 0 offen offset:512
    buffer_load_dwordx4 v[100:103], v10, s[68:71], 0 offen offset:576
    buffer_load_dwordx4 v[104:107], v10, s[68:71], 0 offen offset:640
    buffer_load_dwordx4 v[108:111], v10, s[68:71], 0 offen offset:704
    buffer_load_dwordx4 v[112:115], v10, s[68:71], 0 offen offset:768
    buffer_load_dwordx4 v[116:119], v10, s[68:71], 0 offen offset:832
    buffer_load_dwordx4 v[120:123], v10, s[68:71], 0 offen offset:896
    buffer_load_dwordx4 v[124:127], v10, s[68:71], 0 offen offset:960
    buffer_load_dwordx4 v[128:131], v10, s[68:71], 0 offen offset:1024
    buffer_load_dwordx4 v[132:135], v10, s[68:71], 0 offen offset:1088
L_prep_go_3:
    s_lshl_b32 s7, s41, 2
    s_add_u32 s7, s7, s3
    s_mul_i32 s93, s7, 25576
    s_lshr_b32 s93, s93, 20
    s_min_u32 s93, s93, 2
    s_mul_i32 s6, s93, 41
    s_sub_u32 s7, s7, s6
    s_lshl_b32 s17, s7, 2
    s_cmp_eq_u32 s93, 1
    s_cselect_b32 s72, s26, s24
    s_cselect_b32 s73, s27, s25
    s_cmp_eq_u32 s93, 2
    s_cselect_b32 s72, s28, s72
    s_cselect_b32 s73, s29, s73
    s_mov_b32 s92, 73728
    s_cmov_b32 s92, 9216
    s_mov_b32 s47, 1152
    s_cmov_b32 s47, 663552
    s_and_b32 s73, s73, 0xffff
    s_mov_b32 s74, 5308416
    s_mov_b32 s75, 0x20000
    s_mul_i32 s47, s47, s40
    s_add_u32 s7, s17, 0
    s_min_u32 s7, s7, 161
    s_mul_i32 s84, s7, 116509
    s_lshr_b32 s84, s84, 20
    s_mul_i32 s88, s84, 9
    s_sub_u32 s88, s7, s88
    s_mul_i32 s7, s84, s92
    s_lshl_b32 s7, s7, 2
    s_add_u32 s7, s7, s47
    s_lshl_b32 s6, s88, 7
    s_add_u32 s80, s7, s6
    s_add_u32 s7, s17, 1
    s_min_u32 s7, s7, 161
    s_mul_i32 s85, s7, 116509
    s_lshr_b32 s85, s85, 20
    s_mul_i32 s89, s85, 9
    s_sub_u32 s89, s7, s89
    s_mul_i32 s7, s85, s92
    s_lshl_b32 s7, s7, 2
    s_add_u32 s7, s7, s47
    s_lshl_b32 s6, s89, 7
    s_add_u32 s81, s7, s6
    s_add_u32 s7, s17, 2
    s_min_u32 s7, s7, 161
    s_mul_i32 s86, s7, 116509
    s_lshr_b32 s86, s86, 20
    s_mul_i32 s90, s86, 9
    s_sub_u32 s90, s7, s90
    s_mul_i32 s7, s86, s92
    s_lshl_b32 s7, s7, 2
    s_add_u32 s7, s7, s47
    s_lshl_b32 s6, s90, 7
    s_add_u32 s82, s7, s6
    s_add_u32 s7, s17, 3
    s_min_u32 s7, s7, 161
    s_mul_i32 s87, s7, 116509
    s_lshr_b32 s87, s87, 20
    s_mul_i32 s91, s87, 9
    s_sub_u32 s91, s7, s91
    s_mul_i32 s7, s87, s92
    s_lshl_b32 s7, s7, 2
    s_add_u32 s7, s7, s47
    s_lshl_b32 s6, s91, 7
    s_add_u32 s83, s7, s6
    s_lshr_b32 s7, s92, 3
    v_lshrrev_b32 v224, 3, v0
    v_mul_lo_u32 v224, v224, s7
    v_and_b32 v8, 7, v0
    v_lshl_add_u32 v224, v8, 4, v224
    s_waitcnt lgkmcnt(0)
    s_mul_i32 s76, s76, 0x9e3779b1
    s_add_u32 s76, s76, 0x7f4a7c15
    s_mov_b32 s77, s76
    s_add_u32 m0, s79, 0
    s_mov_b32 s71, s80
    buffer_load_dwordx4 v224, s[72:75], s71 offen nt lds
    s_add_u32 m0, s79, 1024
    s_add_u32 s71, s71, s92
    buffer_load_dwordx4 v224, s[72:75], s71 offen nt lds
    s_add_u32 m0, s79, 2048
    s_add_u32 s71, s71, s92
    buffer_load_dwordx4 v224, s[72:75], s71 offen nt lds
    s_waitcnt vmcnt(3)
    s_barrier
    s_cmp_ge_u32 s41, 18
    s_cbranch_scc1 L_prep_o_4
    s_mul_i32 s7, s3, 36
    s_add_u32 s7, s7, s46
    v_lshrrev_b32 v8, 4, v0
    v_lshlrev_b32 v8, 11, v8
    v_add_u32 v8, s7, v8
    v_and_b32 v9, 15, v0
    v_cmp_gt_u32 s[22:23], 6, v9
    v_lshrrev_b32 v10, 1, v9
    v_min_u32 v10, 2, v10
    v_lshl_add_u32 v10, v10, 13, v8
    v_and_b32 v11, 1, v0
    v_lshl_add_u32 v10, v11, 1, v10
    v_lshl_add_u32 v8, v9, 1, v8
    ds_read_u16 v136, v8 offset:8192
    ds_read_u16 v137, v8 offset:8448
    ds_read_u16 v138, v8 offset:8704
    ds_read_u16 v139, v8 offset:8960
    ds_read_u16 v140, v8 offset:9216
    ds_read_u16 v141, v8 offset:9472
    ds_read_u16 v142, v8 offset:9728
    ds_read_u16 v143, v8 offset:9984
    s_lshl_b32 s33, s40, 2
    s_add_u32 s33, s33, s3
    s_mul_i32 s33, s33, 18
    s_add_u32 s33, s33, s41
    s_lshl_b32 s33, s33, 12
    ds_read_u16 v144, v8 offset:16384
    ds_read_u16 v145, v8 offset:16640
    ds_read_u16 v146, v8 offset:16896
    ds_read_u16 v147, v8 offset:17152
    ds_read_u16 v148, v8 offset:17408
    ds_read_u16 v149, v8 offset:17664
    ds_read_u16 v150, v8 offset:17920
    ds_read_u16 v151, v8 offset:18176
    s_waitcnt lgkmcnt(8)
    v_lshl_or_b32 v32, v137, 16, v136
    v_lshl_or_b32 v33, v139, 16, v138
    v_lshl_or_b32 v34, v141, 16, v140
    v_lshl_or_b32 v35, v143, 16, v142
    buffer_store_dwordx4 v[32:35], v253, s[8:11], s33 offen offset:0 sc1
    ds_read_u16 v152, v8 offset:24576
    ds_read_u16 v153, v8 offset:24832
    ds_read_u16 v154, v8 offset:25088
    ds_read_u16 v155, v8 offset:25344
    ds_read_u16 v156, v8 offset:25600
    ds_read_u16 v157, v8 offset:25856
    ds_read_u16 v158, v8 offset:26112
    ds_read_u16 v159, v8 offset:26368
    s_waitcnt lgkmcnt(8)
    v_lshl_or_b32 v36, v145, 16, v144
    v_lshl_or_b32 v37, v147, 16, v146
    v_lshl_or_b32 v38, v149, 16, v148
    v_lshl_or_b32 v39, v151, 16, v150
    buffer_store_dwordx4 v[36:39], v253, s[8:11], s33 offen offset:1024 sc1
    ds_read_u16 v160, v10 offset:8224
    ds_read_u16 v161, v10 offset:8480
    ds_read_u16 v162, v10 offset:8736
    ds_read_u16 v163, v10 offset:8992
    ds_read_u16 v164, v10 offset:9248
    ds_read_u16 v165, v10 offset:9504
    ds_read_u16 v166, v10 offset:9760
    ds_read_u16 v167, v10 offset:10016
    s_waitcnt lgkmcnt(8)
    v_lshl_or_b32 v40, v153, 16, v152
    v_lshl_or_b32 v41, v155, 16, v154
    v_lshl_or_b32 v42, v157, 16, v156
    v_lshl_or_b32 v43, v159, 16, v158
    buffer_store_dwordx4 v[40:43], v253, s[8:11], s33 offen offset:2048 sc1
    s_waitcnt lgkmcnt(0)
    v_lshl_or_b32 v44, v161, 16, v160
    v_cndmask_b32 v44, 0, v44, s[22:23]
    v_lshl_or_b32 v45, v163, 16, v162
    v_cndmask_b32 v45, 0, v45, s[22:23]
    v_lshl_or_b32 v46, v165, 16, v164
    v_cndmask_b32 v46, 0, v46, s[22:23]
    v_lshl_or_b32 v47, v167, 16, v166
    v_cndmask_b32 v47, 0, v47, s[22:23]
    buffer_store_dwordx4 v[44:47], v253, s[8:11], s33 offen offset:3072 sc1
    s_branch L_prep_done_6
L_prep_o_4:
    s_cmp_ge_u32 s36, 54
    s_cbranch_scc1 L_prep_m_5
    v_lshrrev_b32 v8, 4, v0
    v_lshlrev_b32 v8, 3, v8
    v_bfe_u32 v9, v0, 2, 2
    v_add_u32 v8, v8, v9
    v_mul_u32_u24 v8, 128, v8
    v_and_b32 v9, 3, v0
    v_lshl_add_u32 v8, v9, 3, v8
    s_lshl_b32 s7, s3, 5
    v_add_u32 v8, s7, v8
    ds_read_b64_tr_b16 v[32:33], v8 offset:8192
    ds_read_b64_tr_b16 v[34:35], v8 offset:8704
    ds_read_b64_tr_b16 v[36:37], v8 offset:12288
    ds_read_b64_tr_b16 v[38:39], v8 offset:12800
    ds_read_b64_tr_b16 v[40:41], v8 offset:16384
    ds_read_b64_tr_b16 v[42:43], v8 offset:16896
    s_mul_i32 s34, s34, 12
    s_add_u32 s34, s34, s3
    s_mul_i32 s34, s34, 18
    s_add_u32 s34, s34, s33
    s_lshl_b32 s34, s34, 10
    s_add_u32 s7, s34, 2359296
    s_waitcnt lgkmcnt(4)
    buffer_store_dwordx4 v[32:35], v253, s[8:11], s7 offen sc1
    s_add_u32 s7, s34, 2433024
    s_waitcnt lgkmcnt(2)
    buffer_store_dwordx4 v[36:39], v253, s[8:11], s7 offen sc1
    s_add_u32 s7, s34, 2506752
    s_waitcnt lgkmcnt(0)
    buffer_store_dwordx4 v[40:43], v253, s[8:11], s7 offen sc1
    s_branch L_prep_done_6
L_prep_m_5:
    s_cmp_ge_u32 s37, 36
    s_cbranch_scc1 L_prep_done_6
    v_mov_b32 v28, 0x3f803f80
    v_mov_b32 v29, 0x3f803f80
    v_mov_b32 v30, 0x3f803f80
    v_mov_b32 v31, 0x3f803f80
    v_and_b32 v9, 15, v0
    v_cmp_eq_u32 vcc, 0, v9
    v_cmp_eq_u32 s[22:23], 1, v9
    v_mfma_f32_16x16x32_bf16 v[32:35], v[64:67], v[28:31], 0
    v_mfma_f32_16x16x32_bf16 v[32:35], v[68:71], v[28:31], v[32:35]
    v_mfma_f32_16x16x32_bf16 v[32:35], v[72:75], v[28:31], v[32:35]
    v_mfma_f32_16x16x32_bf16 v[32:35], v[76:79], v[28:31], v[32:35]
    v_mfma_f32_16x16x32_bf16 v[32:35], v[80:83], v[28:31], v[32:35]
    v_mfma_f32_16x16x32_bf16 v[32:35], v[84:87], v[28:31], v[32:35]
    v_mfma_f32_16x16x32_bf16 v[32:35], v[88:91], v[28:31], v[32:35]
    v_mfma_f32_16x16x32_bf16 v[32:35], v[92:95], v[28:31], v[32:35]
    v_mfma_f32_16x16x32_bf16 v[32:35], v[96:99], v[28:31], v[32:35]
    v_mfma_f32_16x16x32_bf16 v[32:35], v[100:103], v[28:31], v[32:35]
    v_mfma_f32_16x16x32_bf16 v[32:35], v[104:107], v[28:31], v[32:35]
    v_mfma_f32_16x16x32_bf16 v[32:35], v[108:111], v[28:31], v[32:35]
    v_mfma_f32_16x16x32_bf16 v[32:35], v[112:115], v[28:31], v[32:35]
    v_mfma_f32_16x16x32_bf16 v[32:35], v[116:119], v[28:31], v[32:35]
    v_mfma_f32_16x16x32_bf16 v[32:35], v[120:123], v[28:31], v[32:35]
    v_mfma_f32_16x16x32_bf16 v[32:35], v[124:127], v[28:31], v[32:35]
    v_mfma_f32_16x16x32_bf16 v[32:35], v[128:131], v[28:31], v[32:35]
    v_mfma_f32_16x16x32_bf16 v[32:35], v[132:135], v[28:31], v[32:35]
    v_lshrrev_b32 v10, 5, v0
    v_lshlrev_b32 v10, 8, v10
    v_lshl_add_u32 v10, v9, 4, v10
    v_bfe_u32 v9, v0, 4, 1
    v_lshl_add_u32 v10, v9, 3, v10
    s_lshl_b32 s7, s37, 9
    s_add_u32 s7, s7, 3022848
    s_nop 0
    v_mul_f32 v32, 0x3ae38e39, v32
    v_mul_f32 v33, 0x3ae38e39, v33
    v_mul_f32 v34, 0x3ae38e39, v34
    v_mul_f32 v35, 0x3ae38e39, v35
    v_cvt_pk_bf16_f32 v36, v32, v33
    v_cvt_pk_bf16_f32 v37, v34, v35
    v_lshlrev_b32 v38, 16, v36
    v_and_b32 v39, s16, v36
    v_sub_f32 v38, v32, v38
    v_sub_f32 v39, v33, v39
    v_cvt_pk_bf16_f32 v28, v38, v39
    v_cndmask_b32 v28, 0, v28, s[22:23]
    v_cndmask_b32 v28, v28, v36, vcc
    v_lshlrev_b32 v38, 16, v37
    v_and_b32 v39, s16, v37
    v_sub_f32 v38, v34, v38
    v_sub_f32 v39, v35, v39
    v_cvt_pk_bf16_f32 v29, v38, v39
    v_cndmask_b32 v29, 0, v29, s[22:23]
    v_cndmask_b32 v29, v29, v37, vcc
    buffer_store_dwordx2 v[28:29], v10, s[8:11], s7 offen sc1
L_prep_done_6:
    s_add_u32 s19, s18, 43515904
    s_add_u32 s20, s18, 38797312
    s_lshl_b32 s22, s21, 7
    s_add_u32 s22, s22, 48234496
    buffer_store_dwordx4 v[16:19], v172, s[8:11], s19 offen sc1
    buffer_store_dwordx4 v[20:23], v173, s[8:11], s19 offen sc1
    buffer_store_dwordx4 v[24:27], v174, s[8:11], s19 offen sc1
    s_mov_b32 s17, 0x3f803f80
    v_mov_b32 v8, 0
    v_mov_b32 v9, 0
    v_mov_b32 v10, 0
    v_mov_b32 v11, 0
    v_dot2c_f32_bf16 v8, s17, v16
    v_dot2c_f32_bf16 v9, v16, v16
    v_dot2c_f32_bf16 v10, s17, v17
    v_dot2c_f32_bf16 v11, v17, v17
    v_dot2c_f32_bf16 v8, s17, v18
    v_dot2c_f32_bf16 v9, v18, v18
    v_dot2c_f32_bf16 v10, s17, v19
    v_dot2c_f32_bf16 v11, v19, v19
    v_dot2c_f32_bf16 v8, s17, v20
    v_dot2c_f32_bf16 v9, v20, v20
    v_dot2c_f32_bf16 v10, s17, v21
    v_dot2c_f32_bf16 v11, v21, v21
    v_dot2c_f32_bf16 v8, s17, v22
    v_dot2c_f32_bf16 v9, v22, v22
    v_dot2c_f32_bf16 v10, s17, v23
    v_dot2c_f32_bf16 v11, v23, v23
    v_dot2c_f32_bf16 v8, s17, v24
    v_dot2c_f32_bf16 v9, v24, v24
    v_dot2c_f32_bf16 v10, s17, v25
    v_dot2c_f32_bf16 v11, v25, v25
    v_dot2c_f32_bf16 v8, s17, v26
    v_dot2c_f32_bf16 v9, v26, v26
    v_dot2c_f32_bf16 v10, s17, v27
    v_dot2c_f32_bf16 v11, v27, v27
    v_and_b32 v12, 7, v0
    v_lshlrev_b32 v12, 3, v12
    s_lshl_b32 s7, s3, 6
    v_add_u32 v13, s7, v12
    v_pk_add_f32 v[8:9], v[8:9], v[10:11]
    s_nop 1
    v_add_f32_dpp v8, v8, v8 row_ror:8 row_mask:0xf bank_mask:0xf
    v_add_f32_dpp v9, v9, v9 row_ror:8 row_mask:0xf bank_mask:0xf
    v_mov_b32 v10, v8
    v_mov_b32 v11, v9
    s_nop 1
    v_permlane32_swap_b32 v10, v8
    v_permlane32_swap_b32 v11, v9
    v_add_f32 v8, v8, v10
    v_add_f32 v9, v9, v11
    v_mov_b32 v10, v8
    v_mov_b32 v11, v9
    s_nop 1
    v_permlane16_swap_b32 v10, v8
    v_permlane16_swap_b32 v11, v9
    v_add_f32 v8, v8, v10
    v_add_f32 v9, v9, v11
    ds_write_b64 v13, v[8:9]
    s_waitcnt lgkmcnt(0)
    s_barrier
    ds_read_b64 v[40:41], v12 offset:0
    ds_read_b64 v[42:43], v12 offset:64
    ds_read_b64 v[44:45], v12 offset:128
    ds_read_b64 v[46:47], v12 offset:192
    s_waitcnt lgkmcnt(0)
    v_pk_add_f32 v[40:41], v[40:41], v[42:43]
    v_pk_add_f32 v[44:45], v[44:45], v[46:47]
    v_pk_add_f32 v[8:9], v[40:41], v[44:45]
    v_mul_f32 v8, 0x3ae38e39, v8
    v_mul_f32 v9, 0x3ae38e39, v9
    v_fma_f32 v9, -v8, v8, v9
    v_max_f32 v9, 0, v9
    v_add_f32 v9, 0x3727c5ac, v9
    v_rsq_f32 v10, v9
    s_nop 0
    v_mul_f32 v12, v8, v10
    v_mov_b32 v11, v10
    v_sub_f32 v12, 0, v12
    v_mov_b32 v13, v12
    s_cmp_eq_u32 s3, 0
    s_cselect_b32 s7, 32, 0
    v_lshlrev_b32 v14, 2, v0
    v_cmp_gt_u32 vcc, s7, v0
    v_mov_b32 v9, 1073741824
    s_nop 0
    v_cndmask_b32 v14, v9, v14, vcc
    buffer_store_dword v8, v14, s[8:11], s22 offen sc1
    v_lshlrev_b32 v40, 16, v16
    v_and_b32 v41, s16, v16
    v_lshlrev_b32 v42, 16, v17
    v_and_b32 v43, s16, v17
    v_lshlrev_b32 v44, 16, v18
    v_and_b32 v45, s16, v18
    v_lshlrev_b32 v46, 16, v19
    v_and_b32 v47, s16, v19
    v_pk_fma_f32 v[40:41], v[40:41], v[10:11], v[12:13]
    v_pk_fma_f32 v[42:43], v[42:43], v[10:11], v[12:13]
    v_pk_fma_f32 v[44:45], v[44:45], v[10:11], v[12:13]
    v_pk_fma_f32 v[46:47], v[46:47], v[10:11], v[12:13]
    v_cvt_pk_bf16_f32 v48, v40, v41
    v_cvt_pk_bf16_f32 v49, v42, v43
    v_cvt_pk_bf16_f32 v50, v44, v45
    v_cvt_pk_bf16_f32 v51, v46, v47
    v_lshlrev_b32 v40, 16, v20
    v_and_b32 v41, s16, v20
    v_lshlrev_b32 v42, 16, v21
    v_and_b32 v43, s16, v21
    v_lshlrev_b32 v44, 16, v22
    v_and_b32 v45, s16, v22
    v_lshlrev_b32 v46, 16, v23
    v_and_b32 v47, s16, v23
    v_pk_fma_f32 v[40:41], v[40:41], v[10:11], v[12:13]
    v_pk_fma_f32 v[42:43], v[42:43], v[10:11], v[12:13]
    v_pk_fma_f32 v[44:45], v[44:45], v[10:11], v[12:13]
    v_pk_fma_f32 v[46:47], v[46:47], v[10:11], v[12:13]
    v_cvt_pk_bf16_f32 v52, v40, v41
    v_cvt_pk_bf16_f32 v53, v42, v43
    v_cvt_pk_bf16_f32 v54, v44, v45
    v_cvt_pk_bf16_f32 v55, v46, v47
    v_lshlrev_b32 v40, 16, v24
    v_and_b32 v41, s16, v24
    v_lshlrev_b32 v42, 16, v25
    v_and_b32 v43, s16, v25
    v_lshlrev_b32 v44, 16, v26
    v_and_b32 v45, s16, v26
    v_lshlrev_b32 v46, 16, v27
    v_and_b32 v47, s16, v27
    v_pk_fma_f32 v[40:41], v[40:41], v[10:11], v[12:13]
    v_pk_fma_f32 v[42:43], v[42:43], v[10:11], v[12:13]
    v_pk_fma_f32 v[44:45], v[44:45], v[10:11], v[12:13]
    v_pk_fma_f32 v[46:47], v[46:47], v[10:11], v[12:13]
    v_cvt_pk_bf16_f32 v56, v40, v41
    v_cvt_pk_bf16_f32 v57, v42, v43
    v_cvt_pk_bf16_f32 v58, v44, v45
    v_cvt_pk_bf16_f32 v59, v46, v47
    buffer_store_dwordx4 v[48:51], v172, s[8:11], s20 offen sc1
    buffer_store_dwordx4 v[52:55], v173, s[8:11], s20 offen sc1
    buffer_store_dwordx4 v[56:59], v174, s[8:11], s20 offen sc1
    v_lshlrev_b32 v15, 7, v0
    s_lshl_b32 s6, s40, 2
    s_add_u32 s6, s6, s44
    s_sub_u32 s6, s6, 32768
    v_mov_b32 v1, s76
    s_mov_b64 vcc, 0xff
    v_lshrrev_b32 v14, 3, v0
    v_lshl_add_u32 v15, v14, 3, v15
    s_cmp_ge_u32 s40, 6
    s_cselect_b32 s7, s41, 31
    s_cmp_lt_u32 s7, 31
    s_cmov_b64 vcc, 0xffff
    s_waitcnt vmcnt(0)
    s_barrier
    s_cmp_lg_u32 s3, 0
    s_cbranch_scc1 L_pub_7
    s_mov_b64 exec, vcc
    buffer_store_dword v1, v15, s[8:11], s6 offen sc1
    v_lshlrev_b32 v15, 10, v0
    s_lshl_b32 s6, s40, 7
    s_lshl_b32 s7, s41, 2
    s_add_u32 s6, s6, s7
    s_add_u32 s6, s6, 19431424
    s_mov_b64 exec, 0xffffffff
    v_lshlrev_b32 v15, 10, v0
    v_mov_b32 v1, s76
    buffer_store_dword v1, v15, s[8:11], s6 offen sc1
    s_cmp_lt_u32 s41, 18
    s_cbranch_scc1 L_pub_7
    s_lshl_b32 s6, s36, 2
    s_add_u32 s6, s6, 19496960
    s_mov_b64 exec, 1
    buffer_store_dword v1, off, s[8:11], s6 sc1
L_pub_7:
    s_mov_b64 exec, -1
    s_add_u32 m0, s79, 3072
    s_add_u32 s71, s71, s92
    buffer_load_dwordx4 v224, s[72:75], s71 offen nt lds
    s_add_u32 m0, s79, 4096
    s_mov_b32 s71, s81
    buffer_load_dwordx4 v224, s[72:75], s71 offen nt lds
    s_add_u32 m0, s79, 5120
    s_add_u32 s71, s71, s92
    buffer_load_dwordx4 v224, s[72:75], s71 offen nt lds
    s_add_u32 m0, s79, 6144
    s_add_u32 s71, s71, s92
    buffer_load_dwordx4 v224, s[72:75], s71 offen nt lds
    s_add_u32 m0, s79, 7168
    s_add_u32 s71, s71, s92
    buffer_load_dwordx4 v224, s[72:75], s71 offen nt lds
    s_add_u32 m0, s79, 8192
    s_mov_b32 s71, s82
    buffer_load_dwordx4 v224, s[72:75], s71 offen nt lds
    s_add_u32 m0, s79, 9216
    s_add_u32 s71, s71, s92
    buffer_load_dwordx4 v224, s[72:75], s71 offen nt lds
    s_add_u32 m0, s79, 10240
    s_add_u32 s71, s71, s92
    buffer_load_dwordx4 v224, s[72:75], s71 offen nt lds
    s_add_u32 m0, s79, 11264
    s_add_u32 s71, s71, s92
    buffer_load_dwordx4 v224, s[72:75], s71 offen nt lds
    s_add_u32 m0, s79, 12288
    s_mov_b32 s71, s83
    buffer_load_dwordx4 v224, s[72:75], s71 offen nt lds
    s_add_u32 m0, s79, 13312
    s_add_u32 s71, s71, s92
    buffer_load_dwordx4 v224, s[72:75], s71 offen nt lds
    s_add_u32 m0, s79, 14336
    s_add_u32 s71, s71, s92
    buffer_load_dwordx4 v224, s[72:75], s71 offen nt lds
    s_add_u32 m0, s79, 15360
    s_add_u32 s71, s71, s92
    buffer_load_dwordx4 v224, s[72:75], s71 offen nt lds
    s_cmp_lg_u32 s3, 0
    s_cbranch_scc1 L_wq_ready_8
    s_lshl_b32 s7, s41, 3
    s_add_u32 s7, s7, s40
    s_lshl_b32 s7, s7, 7
    s_add_u32 s7, s7, 19431424
    s_add_u32 s68, s4, s7
    s_addc_u32 s69, s5, 0
    s_mov_b32 s6, 0
    s_mov_b32 s7, 0
L_cpoll_9:
    s_load_dwordx16 s[52:67], s[68:69], s7 glc
    s_add_u32 s6, s6, 1
    s_waitcnt lgkmcnt(0)
    s_xor_b64 s[52:53], s[52:53], s[76:77]
    s_xor_b64 s[54:55], s[54:55], s[76:77]
    s_xor_b64 s[56:57], s[56:57], s[76:77]
    s_xor_b64 s[58:59], s[58:59], s[76:77]
    s_xor_b64 s[60:61], s[60:61], s[76:77]
    s_xor_b64 s[62:63], s[62:63], s[76:77]
    s_xor_b64 s[64:65], s[64:65], s[76:77]
    s_xor_b64 s[66:67], s[66:67], s[76:77]
    s_or_b64 s[52:53], s[52:53], s[60:61]
    s_or_b64 s[54:55], s[54:55], s[62:63]
    s_or_b64 s[56:57], s[56:57], s[64:65]
    s_or_b64 s[58:59], s[58:59], s[66:67]
    s_or_b64 s[52:53], s[52:53], s[56:57]
    s_or_b64 s[54:55], s[54:55], s[58:59]
    s_or_b64 s[52:53], s[52:53], s[54:55]
    s_cbranch_scc1 L_cpoll_10
    s_add_u32 s7, s7, 8
    s_cmp_eq_u32 s7, 16
    s_cbranch_scc1 L_cpolled_11
L_cpoll_10:
    s_cmp_lt_u32 s6, 1048576
    s_cbranch_scc1 L_cpoll_9
    s_branch L_main_end
L_cpolled_11:
L_wq_ready_8:
    s_barrier
    s_lshl_b32 s28, s40, 2
    s_add_u32 s28, s28, s3
    s_mul_i32 s28, s28, 73728
    buffer_load_dwordx4 a[0:3], v253, s[8:11], s28 offen offset:0 sc1
    buffer_load_dwordx4 a[4:7], v253, s[8:11], s28 offen offset:1024 sc1
    buffer_load_dwordx4 a[8:11], v253, s[8:11], s28 offen offset:2048 sc1
    buffer_load_dwordx4 a[12:15], v253, s[8:11], s28 offen offset:3072 sc1
    s_add_u32 s28, s28, 4096
    buffer_load_dwordx4 a[16:19], v253, s[8:11], s28 offen offset:0 sc1
    buffer_load_dwordx4 a[20:23], v253, s[8:11], s28 offen offset:1024 sc1
    buffer_load_dwordx4 a[24:27], v253, s[8:11], s28 offen offset:2048 sc1
    buffer_load_dwordx4 a[28:31], v253, s[8:11], s28 offen offset:3072 sc1
    s_add_u32 s28, s28, 4096
    buffer_load_dwordx4 a[32:35], v253, s[8:11], s28 offen offset:0 sc1
    buffer_load_dwordx4 a[36:39], v253, s[8:11], s28 offen offset:1024 sc1
    buffer_load_dwordx4 a[40:43], v253, s[8:11], s28 offen offset:2048 sc1
    buffer_load_dwordx4 a[44:47], v253, s[8:11], s28 offen offset:3072 sc1
    s_add_u32 s28, s28, 4096
    buffer_load_dwordx4 a[48:51], v253, s[8:11], s28 offen offset:0 sc1
    buffer_load_dwordx4 a[52:55], v253, s[8:11], s28 offen offset:1024 sc1
    buffer_load_dwordx4 a[56:59], v253, s[8:11], s28 offen offset:2048 sc1
    buffer_load_dwordx4 a[60:63], v253, s[8:11], s28 offen offset:3072 sc1
    s_add_u32 s28, s28, 4096
    buffer_load_dwordx4 a[64:67], v253, s[8:11], s28 offen offset:0 sc1
    buffer_load_dwordx4 a[68:71], v253, s[8:11], s28 offen offset:1024 sc1
    buffer_load_dwordx4 a[72:75], v253, s[8:11], s28 offen offset:2048 sc1
    buffer_load_dwordx4 a[76:79], v253, s[8:11], s28 offen offset:3072 sc1
    s_add_u32 s28, s28, 4096
    buffer_load_dwordx4 a[80:83], v253, s[8:11], s28 offen offset:0 sc1
    buffer_load_dwordx4 a[84:87], v253, s[8:11], s28 offen offset:1024 sc1
    buffer_load_dwordx4 a[88:91], v253, s[8:11], s28 offen offset:2048 sc1
    buffer_load_dwordx4 a[92:95], v253, s[8:11], s28 offen offset:3072 sc1
    s_add_u32 s28, s28, 4096
    buffer_load_dwordx4 a[96:99], v253, s[8:11], s28 offen offset:0 sc1
    buffer_load_dwordx4 a[100:103], v253, s[8:11], s28 offen offset:1024 sc1
    buffer_load_dwordx4 a[104:107], v253, s[8:11], s28 offen offset:2048 sc1
    buffer_load_dwordx4 a[108:111], v253, s[8:11], s28 offen offset:3072 sc1
    s_add_u32 s28, s28, 4096
    buffer_load_dwordx4 a[112:115], v253, s[8:11], s28 offen offset:0 sc1
    buffer_load_dwordx4 a[116:119], v253, s[8:11], s28 offen offset:1024 sc1
    buffer_load_dwordx4 a[120:123], v253, s[8:11], s28 offen offset:2048 sc1
    buffer_load_dwordx4 a[124:127], v253, s[8:11], s28 offen offset:3072 sc1
    s_add_u32 s28, s28, 4096
    buffer_load_dwordx4 a[128:131], v253, s[8:11], s28 offen offset:0 sc1
    buffer_load_dwordx4 a[132:135], v253, s[8:11], s28 offen offset:1024 sc1
    buffer_load_dwordx4 a[136:139], v253, s[8:11], s28 offen offset:2048 sc1
    buffer_load_dwordx4 a[140:143], v253, s[8:11], s28 offen offset:3072 sc1
    s_add_u32 s28, s28, 4096
L_main_layer:
    v_bfe_u32 v3, v0, 3, 1
    v_mul_u32_u24 v2, 9216, v3
    v_lshrrev_b32 v3, 4, v0
    v_lshl_add_u32 v2, v3, 7, v2
    v_and_b32 v3, 7, v0
    v_lshl_add_u32 v2, v3, 4, v2
    v_bfe_u32 v3, v0, 3, 2
    s_mov_b32 s7, 9216
    v_mul_lo_u32 v9, v3, s7
    v_lshrrev_b32 v3, 5, v0
    v_lshl_add_u32 v9, v3, 7, v9
    v_and_b32 v3, 7, v0
    v_lshl_add_u32 v9, v3, 4, v9
    s_mul_i32 s22, s41, 73728
    s_add_u32 s22, s22, s43
    s_add_u32 s23, s22, 38797312
    s_mul_i32 s7, s3, 18432
    s_add_u32 s24, s23, s7
    s_cmp_eq_u32 s41, 0
    s_cselect_b32 s7, 0, 18432
    s_sub_u32 s23, s23, s7
    s_lshl_b32 s25, s3, 10
    s_add_u32 s25, s25, 1024
    s_mul_i32 s26, s3, 5120
    s_lshl_b32 s7, s3, 9
    s_add_u32 s27, s23, s7
    s_and_b32 s7, s3, 1
    s_add_u32 s7, s7, 4
    s_mul_i32 s29, s7, 5120
    s_lshl_b32 s7, s7, 9
    s_add_u32 s23, s23, s7
    s_cmp_lg_u32 s3, 3
    s_cbranch_scc1 L_pollout_14
    s_lshl_b32 s7, s40, 7
    s_add_u32 s7, s7, s44
    s_sub_u32 s7, s7, 32768
    s_add_u32 s52, s4, s7
    s_addc_u32 s53, s5, 0
    s_cmp_eq_u32 s41, 0
    s_cselect_b32 s7, 0, 32
    s_mov_b32 s6, 0
L_poll_12:
    s_load_dwordx8 s[56:63], s[52:53], 0 glc
    s_load_dwordx2 s[54:55], s[52:53], s7 glc
    s_add_u32 s6, s6, 1
    s_waitcnt lgkmcnt(0)
    s_xor_b64 s[54:55], s[54:55], s[76:77]
    s_xor_b64 s[56:57], s[56:57], s[76:77]
    s_xor_b64 s[58:59], s[58:59], s[76:77]
    s_xor_b64 s[60:61], s[60:61], s[76:77]
    s_xor_b64 s[62:63], s[62:63], s[76:77]
    s_or_b64 s[56:57], s[56:57], s[58:59]
    s_or_b64 s[60:61], s[60:61], s[62:63]
    s_or_b64 s[56:57], s[56:57], s[54:55]
    s_or_b64 s[56:57], s[56:57], s[60:61]
    s_cbranch_scc0 L_polled_13
    s_cmp_lt_u32 s6, 1048576
    s_cbranch_scc1 L_poll_12
    s_branch L_main_end
L_polled_13:
L_pollout_14:
    s_barrier
    s_add_u32 m0, s25, 0
    s_nop 0
    buffer_load_dwordx4 v2, s[8:11], s24 offen offset:0 sc1 lds
    s_add_u32 m0, s25, 4608
    s_nop 0
    buffer_load_dwordx4 v2, s[8:11], s24 offen offset:512 sc1 lds
    s_add_u32 m0, s25, 9216
    s_nop 0
    buffer_load_dwordx4 v2, s[8:11], s24 offen offset:1024 sc1 lds
    s_add_u32 m0, s25, 13824
    s_nop 0
    buffer_load_dwordx4 v2, s[8:11], s24 offen offset:1536 sc1 lds
    s_add_u32 m0, s25, 18432
    s_nop 0
    buffer_load_dwordx4 v2, s[8:11], s24 offen offset:2048 sc1 lds
    s_add_u32 m0, s25, 23040
    s_nop 0
    buffer_load_dwordx4 v2, s[8:11], s24 offen offset:2560 sc1 lds
    s_add_u32 m0, s26, 0
    s_add_u32 s7, s27, 0
    buffer_load_dwordx4 v2, s[8:11], s7 offen sc1 lds
    s_add_u32 m0, s29, 0
    s_add_u32 s7, s23, 0
    buffer_load_dwordx4 v2, s[8:11], s7 offen sc1 lds
    v_mov_b32 v132, 0
    v_mov_b32 v133, 0
    v_mov_b32 v192, 0
    v_mov_b32 v193, 0
    v_mov_b32 v195, 0
    v_mov_b32 v135, 0
    v_mov_b32 v139, 0
    v_mov_b32 v143, 0
    v_mov_b32 v147, 0
    v_mov_b32 v151, 0
    v_mov_b32 v155, 0
    v_mov_b32 v159, 0
    v_mov_b32 v163, 0
    v_mov_b32 v167, 0
    v_mov_b32 v171, 0
    v_cmp_eq_u32 vcc, 16, v0
    v_mov_b32 v10, 0x3f80
    v_cmp_eq_u32 s[20:21], 17, v0
    v_cndmask_b32 v194, 0, v10, vcc
    v_and_b32 v11, 3, v0
    v_cndmask_b32 v194, v194, 1.0, s[20:21]
    v_cmp_eq_u32 vcc, 2, v11
    v_and_b32 v10, 15, v0
    v_lshrrev_b32 v11, 4, v0
    v_cndmask_b32 v196, 0, 1.0, vcc
    v_cndmask_b32 v197, 0, 1.0, vcc
    v_cndmask_b32 v198, 0, 1.0, vcc
    v_cndmask_b32 v199, 0, 1.0, vcc
    v_lshlrev_b32 v11, 2, v11
    v_sub_u32 v10, v11, v10
    v_mov_b32 v12, 0xf149f2ca
    s_cmp_eq_u32 s41, 0
    s_cselect_b64 s[38:39], 0, -1
    v_add_u32 v11, 0, v10
    v_and_b32 v13, 1, v11
    v_cmp_eq_u32 s[20:21], 0, v13
    v_cmp_lt_i32 vcc, 1, v11
    v_cmp_gt_i32 s[18:19], 1, v11
    s_and_b64 vcc, vcc, s[20:21]
    s_and_b64 s[18:19], s[18:19], s[20:21]
    s_and_b64 s[20:21], vcc, s[38:39]
    v_cndmask_b32 v200, v12, 0, vcc
    v_cndmask_b32 v204, v12, 0, s[18:19]
    v_cndmask_b32 v208, v12, 0, s[20:21]
    v_add_u32 v11, 1, v10
    v_and_b32 v13, 1, v11
    v_cmp_eq_u32 s[20:21], 0, v13
    v_cmp_lt_i32 vcc, 1, v11
    v_cmp_gt_i32 s[18:19], 1, v11
    s_and_b64 vcc, vcc, s[20:21]
    s_and_b64 s[18:19], s[18:19], s[20:21]
    s_and_b64 s[20:21], vcc, s[38:39]
    v_cndmask_b32 v201, v12, 0, vcc
    v_cndmask_b32 v205, v12, 0, s[18:19]
    v_cndmask_b32 v209, v12, 0, s[20:21]
    v_add_u32 v11, 2, v10
    v_and_b32 v13, 1, v11
    v_cmp_eq_u32 s[20:21], 0, v13
    v_cmp_lt_i32 vcc, 1, v11
    v_cmp_gt_i32 s[18:19], 1, v11
    s_and_b64 vcc, vcc, s[20:21]
    s_and_b64 s[18:19], s[18:19], s[20:21]
    s_and_b64 s[20:21], vcc, s[38:39]
    v_cndmask_b32 v202, v12, 0, vcc
    v_cndmask_b32 v206, v12, 0, s[18:19]
    v_cndmask_b32 v210, v12, 0, s[20:21]
    v_add_u32 v11, 3, v10
    v_and_b32 v13, 1, v11
    v_cmp_eq_u32 s[20:21], 0, v13
    v_cmp_lt_i32 vcc, 1, v11
    v_cmp_gt_i32 s[18:19], 1, v11
    s_and_b64 vcc, vcc, s[20:21]
    s_and_b64 s[18:19], s[18:19], s[20:21]
    s_and_b64 s[20:21], vcc, s[38:39]
    v_cndmask_b32 v203, v12, 0, vcc
    v_cndmask_b32 v207, v12, 0, s[18:19]
    v_cndmask_b32 v211, v12, 0, s[20:21]
    s_lshl_b32 s45, s41, 1
    s_lshr_b32 s7, s40, 2
    s_add_u32 s45, s45, s7
    s_mul_i32 s30, s45, 36864
    s_add_u32 s30, s30, s43
    s_and_b32 s31, s40, 3
    s_mul_i32 s31, s31, 9
    s_add_u32 s31, s31, s3
    s_mul_i32 s32, s31, 18432
    s_add_u32 s32, s32, 2359296
    s_add_u32 s33, s32, 73728
    s_add_u32 s34, s32, 147456
    s_mov_b32 s39, 19496960
    v_min_u32 v228, 44, v0
    v_lshlrev_b32 v228, 3, v228
    s_cmp_eq_u32 s3, 1
    s_cmov_b32 s34, 3022848
    s_cmp_lt_u32 s3, 2
    s_cselect_b32 s35, 0, 1073741824
    v_add_u32 v5, s35, v253
    s_cmp_eq_u32 s3, 0
    s_cselect_b32 s35, 0, 1073741824
    v_add_u32 v7, s35, v9
    s_lshl_b32 s7, s31, 8
    s_add_u32 s36, s30, s7
    s_add_u32 s37, s36, 43515904
    s_add_u32 s46, s36, 45875200
    s_lshl_b32 s36, s45, 7
    s_add_u32 s36, s36, s43
    s_add_u32 s36, s36, 48431104
    s_lshl_b32 s47, s45, 9
    s_add_u32 s47, s47, s43
    s_add_u32 s47, s47, 48234496
    v_bfe_u32 v10, v0, 3, 2
    v_and_b32 v8, 7, v0
    v_lshlrev_b32 v8, 2, v8
    v_lshl_add_u32 v8, v10, 7, v8
    v_add_u32 v6, 46080, v253
    s_waitcnt vmcnt(0)
    s_barrier
    ds_read_b128 v[16:19], v253 offset:0
    ds_read_b128 v[20:23], v253 offset:1024
    ds_read_b128 v[24:27], v253 offset:2048
    ds_read_b128 v[28:31], v253 offset:3072
    ds_read_b128 v[32:35], v253 offset:4096
    s_waitcnt lgkmcnt(0)
    v_mfma_f32_16x16x32_bf16 v[56:59], a[0:3], v[20:23], 0
    ds_read_b128 v[36:39], v253 offset:5120
    v_mfma_f32_16x16x32_bf16 v[60:63], a[0:3], v[24:27], 0
    ds_read_b128 v[40:43], v253 offset:6144
    v_mfma_f32_16x16x32_bf16 v[64:67], a[0:3], v[28:31], 0
    ds_read_b128 v[44:47], v253 offset:7168
    v_mfma_f32_16x16x32_bf16 v[68:71], a[0:3], v[32:35], 0
    ds_read_b128 v[48:51], v253 offset:8192
    v_mfma_f32_16x16x32_bf16 v[72:75], a[4:7], v[16:19], 0
    ds_read_b128 v[52:55], v253 offset:9216
    v_mfma_f32_16x16x32_bf16 v[76:79], a[4:7], v[20:23], 0
    s_add_u32 m0, s25, 27648
    s_nop 0
    buffer_load_dwordx4 v2, s[8:11], s24 offen offset:3072 sc1 lds
    v_mfma_f32_16x16x32_bf16 v[80:83], a[4:7], v[24:27], 0
    v_mfma_f32_16x16x32_bf16 v[84:87], a[4:7], v[28:31], 0
    s_add_u32 m0, s25, 32256
    s_nop 0
    buffer_load_dwordx4 v2, s[8:11], s24 offen offset:3584 sc1 lds
    v_mfma_f32_16x16x32_bf16 v[88:91], a[4:7], v[32:35], 0
    v_mfma_f32_16x16x32_bf16 v[92:95], v[16:19], a[8:11], 0
    buffer_load_dwordx4 a[144:147], v253, s[8:11], s28 offen offset:0 sc1
    v_mfma_f32_16x16x32_bf16 v[96:99], v[20:23], a[8:11], 0
    v_mfma_f32_16x16x32_bf16 v[100:103], v[24:27], a[8:11], 0
    buffer_load_dwordx4 a[148:151], v253, s[8:11], s28 offen offset:1024 sc1
    v_mfma_f32_16x16x32_bf16 v[104:107], v[28:31], a[8:11], 0
    v_mfma_f32_16x16x32_bf16 v[108:111], v[32:35], a[8:11], 0
    buffer_load_dwordx4 a[152:155], v253, s[8:11], s28 offen offset:2048 sc1
    v_mfma_f32_16x16x32_bf16 v[112:115], a[12:15], v[16:19], 0
    v_mfma_f32_16x16x32_bf16 v[116:119], a[12:15], v[20:23], 0
    v_mfma_f32_16x16x32_bf16 v[120:123], a[12:15], v[24:27], 0
    v_mfma_f32_16x16x32_bf16 v[124:127], a[12:15], v[28:31], 0
    v_mfma_f32_16x16x32_bf16 v[128:131], a[12:15], v[32:35], 0
    s_waitcnt lgkmcnt(0)
    v_mfma_f32_16x16x32_bf16 v[56:59], a[16:19], v[40:43], v[56:59]
    ds_read_b128 v[16:19], v253 offset:10240
    v_mfma_f32_16x16x32_bf16 v[60:63], a[16:19], v[44:47], v[60:63]
    ds_read_b128 v[20:23], v253 offset:11264
    v_mfma_f32_16x16x32_bf16 v[64:67], a[16:19], v[48:51], v[64:67]
    ds_read_b128 v[24:27], v253 offset:12288
    v_mfma_f32_16x16x32_bf16 v[68:71], a[16:19], v[52:55], v[68:71]
    ds_read_b128 v[28:31], v253 offset:13312
    v_mfma_f32_16x16x32_bf16 v[72:75], a[20:23], v[36:39], v[72:75]
    ds_read_b128 v[32:35], v253 offset:14336
    v_mfma_f32_16x16x32_bf16 v[76:79], a[20:23], v[40:43], v[76:79]
    s_add_u32 m0, s25, 40960
    s_add_u32 s24, s24, 4096
    buffer_load_dwordx4 v2, s[8:11], s24 offen offset:0 sc1 lds
    v_mfma_f32_16x16x32_bf16 v[80:83], a[20:23], v[44:47], v[80:83]
    v_mfma_f32_16x16x32_bf16 v[84:87], a[20:23], v[48:51], v[84:87]
    s_add_u32 m0, s25, 45568
    s_nop 0
    buffer_load_dwordx4 v2, s[8:11], s24 offen offset:512 sc1 lds
    v_mfma_f32_16x16x32_bf16 v[88:91], a[20:23], v[52:55], v[88:91]
    v_mfma_f32_16x16x32_bf16 v[92:95], v[36:39], a[24:27], v[92:95]
    buffer_load_dwordx4 a[156:159], v253, s[8:11], s28 offen offset:3072 sc1
    s_add_u32 s28, s28, 4096
    v_mfma_f32_16x16x32_bf16 v[96:99], v[40:43], a[24:27], v[96:99]
    v_mfma_f32_16x16x32_bf16 v[100:103], v[44:47], a[24:27], v[100:103]
    buffer_load_dwordx4 a[0:3], v253, s[8:11], s28 offen offset:0 sc1
    v_mfma_f32_16x16x32_bf16 v[104:107], v[48:51], a[24:27], v[104:107]
    v_mfma_f32_16x16x32_bf16 v[108:111], v[52:55], a[24:27], v[108:111]
    buffer_load_dwordx4 a[4:7], v253, s[8:11], s28 offen offset:1024 sc1
    v_mfma_f32_16x16x32_bf16 v[112:115], a[28:31], v[36:39], v[112:115]
    v_mfma_f32_16x16x32_bf16 v[116:119], a[28:31], v[40:43], v[116:119]
    v_mfma_f32_16x16x32_bf16 v[120:123], a[28:31], v[44:47], v[120:123]
    v_mfma_f32_16x16x32_bf16 v[124:127], a[28:31], v[48:51], v[124:127]
    v_mfma_f32_16x16x32_bf16 v[128:131], a[28:31], v[52:55], v[128:131]
    s_waitcnt lgkmcnt(0)
    v_mfma_f32_16x16x32_bf16 v[56:59], a[32:35], v[20:23], v[56:59]
    ds_read_b128 v[36:39], v253 offset:15360
    v_mfma_f32_16x16x32_bf16 v[60:63], a[32:35], v[24:27], v[60:63]
    ds_read_b128 v[40:43], v253 offset:16384
    v_mfma_f32_16x16x32_bf16 v[64:67], a[32:35], v[28:31], v[64:67]
    ds_read_b128 v[44:47], v253 offset:17408
    v_mfma_f32_16x16x32_bf16 v[68:71], a[32:35], v[32:35], v[68:71]
    ds_read_b128 v[48:51], v253 offset:18432
    v_mfma_f32_16x16x32_bf16 v[72:75], a[36:39], v[16:19], v[72:75]
    ds_read_b128 v[52:55], v253 offset:19456
    v_mfma_f32_16x16x32_bf16 v[76:79], a[36:39], v[20:23], v[76:79]
    s_add_u32 m0, s25, 50176
    s_nop 0
    buffer_load_dwordx4 v2, s[8:11], s24 offen offset:1024 sc1 lds
    v_mfma_f32_16x16x32_bf16 v[80:83], a[36:39], v[24:27], v[80:83]
    v_mfma_f32_16x16x32_bf16 v[84:87], a[36:39], v[28:31], v[84:87]
    s_add_u32 m0, s25, 54784
    s_nop 0
    buffer_load_dwordx4 v2, s[8:11], s24 offen offset:1536 sc1 lds
    v_mfma_f32_16x16x32_bf16 v[88:91], a[36:39], v[32:35], v[88:91]
    v_mfma_f32_16x16x32_bf16 v[92:95], v[16:19], a[40:43], v[92:95]
    buffer_load_dwordx4 a[8:11], v253, s[8:11], s28 offen offset:2048 sc1
    v_mfma_f32_16x16x32_bf16 v[96:99], v[20:23], a[40:43], v[96:99]
    v_mfma_f32_16x16x32_bf16 v[100:103], v[24:27], a[40:43], v[100:103]
    buffer_load_dwordx4 a[12:15], v253, s[8:11], s28 offen offset:3072 sc1
    s_add_u32 s28, s28, 4096
    v_mfma_f32_16x16x32_bf16 v[104:107], v[28:31], a[40:43], v[104:107]
    v_mfma_f32_16x16x32_bf16 v[108:111], v[32:35], a[40:43], v[108:111]
    buffer_load_dwordx4 a[16:19], v253, s[8:11], s28 offen offset:0 sc1
    v_mfma_f32_16x16x32_bf16 v[112:115], a[44:47], v[16:19], v[112:115]
    v_mfma_f32_16x16x32_bf16 v[116:119], a[44:47], v[20:23], v[116:119]
    v_mfma_f32_16x16x32_bf16 v[120:123], a[44:47], v[24:27], v[120:123]
    v_mfma_f32_16x16x32_bf16 v[124:127], a[44:47], v[28:31], v[124:127]
    v_mfma_f32_16x16x32_bf16 v[128:131], a[44:47], v[32:35], v[128:131]
    s_waitcnt lgkmcnt(0)
    v_mfma_f32_16x16x32_bf16 v[56:59], a[48:51], v[40:43], v[56:59]
    ds_read_b128 v[16:19], v253 offset:20480
    v_mfma_f32_16x16x32_bf16 v[60:63], a[48:51], v[44:47], v[60:63]
    ds_read_b128 v[20:23], v253 offset:21504
    v_mfma_f32_16x16x32_bf16 v[64:67], a[48:51], v[48:51], v[64:67]
    ds_read_b128 v[24:27], v253 offset:22528
    v_mfma_f32_16x16x32_bf16 v[68:71], a[48:51], v[52:55], v[68:71]
    ds_read_b128 v[28:31], v253 offset:23552
    v_mfma_f32_16x16x32_bf16 v[72:75], a[52:55], v[36:39], v[72:75]
    ds_read_b128 v[32:35], v253 offset:24576
    v_mfma_f32_16x16x32_bf16 v[76:79], a[52:55], v[40:43], v[76:79]
    s_add_u32 m0, s26, 30720
    s_add_u32 s7, s27, 3072
    buffer_load_dwordx4 v2, s[8:11], s7 offen sc1 lds
    v_mfma_f32_16x16x32_bf16 v[80:83], a[52:55], v[44:47], v[80:83]
    v_mfma_f32_16x16x32_bf16 v[84:87], a[52:55], v[48:51], v[84:87]
    s_add_u32 m0, s29, 30720
    s_add_u32 s7, s23, 3072
    buffer_load_dwordx4 v2, s[8:11], s7 offen sc1 lds
    v_mfma_f32_16x16x32_bf16 v[88:91], a[52:55], v[52:55], v[88:91]
    v_mfma_f32_16x16x32_bf16 v[92:95], v[36:39], a[56:59], v[92:95]
    buffer_load_dwordx4 a[20:23], v253, s[8:11], s28 offen offset:1024 sc1
    v_mfma_f32_16x16x32_bf16 v[96:99], v[40:43], a[56:59], v[96:99]
    v_mfma_f32_16x16x32_bf16 v[100:103], v[44:47], a[56:59], v[100:103]
    buffer_load_dwordx4 a[24:27], v253, s[8:11], s28 offen offset:2048 sc1
    v_mfma_f32_16x16x32_bf16 v[104:107], v[48:51], a[56:59], v[104:107]
    v_mfma_f32_16x16x32_bf16 v[108:111], v[52:55], a[56:59], v[108:111]
    buffer_load_dwordx4 a[28:31], v253, s[8:11], s28 offen offset:3072 sc1
    s_add_u32 s28, s28, 4096
    v_mfma_f32_16x16x32_bf16 v[112:115], a[60:63], v[36:39], v[112:115]
    v_mfma_f32_16x16x32_bf16 v[116:119], a[60:63], v[40:43], v[116:119]
    v_mfma_f32_16x16x32_bf16 v[120:123], a[60:63], v[44:47], v[120:123]
    v_mfma_f32_16x16x32_bf16 v[124:127], a[60:63], v[48:51], v[124:127]
    v_mfma_f32_16x16x32_bf16 v[128:131], a[60:63], v[52:55], v[128:131]
    s_waitcnt lgkmcnt(0)
    v_mfma_f32_16x16x32_bf16 v[56:59], a[64:67], v[20:23], v[56:59]
    ds_read_b128 v[36:39], v253 offset:25600
    v_mfma_f32_16x16x32_bf16 v[60:63], a[64:67], v[24:27], v[60:63]
    ds_read_b128 v[40:43], v253 offset:26624
    v_mfma_f32_16x16x32_bf16 v[64:67], a[64:67], v[28:31], v[64:67]
    ds_read_b128 v[44:47], v253 offset:27648
    v_mfma_f32_16x16x32_bf16 v[68:71], a[64:67], v[32:35], v[68:71]
    ds_read_b128 v[48:51], v253 offset:28672
    v_mfma_f32_16x16x32_bf16 v[72:75], a[68:71], v[16:19], v[72:75]
    ds_read_b128 v[52:55], v253 offset:29696
    v_mfma_f32_16x16x32_bf16 v[76:79], a[68:71], v[20:23], v[76:79]
    buffer_load_dwordx4 a[32:35], v253, s[8:11], s28 offen offset:0 sc1
    v_mfma_f32_16x16x32_bf16 v[80:83], a[68:71], v[24:27], v[80:83]
    v_mfma_f32_16x16x32_bf16 v[84:87], a[68:71], v[28:31], v[84:87]
    buffer_load_dwordx4 a[36:39], v253, s[8:11], s28 offen offset:1024 sc1
    v_mfma_f32_16x16x32_bf16 v[88:91], a[68:71], v[32:35], v[88:91]
    v_mfma_f32_16x16x32_bf16 v[92:95], v[16:19], a[72:75], v[92:95]
    buffer_load_dwordx4 a[40:43], v253, s[8:11], s28 offen offset:2048 sc1
    v_mfma_f32_16x16x32_bf16 v[96:99], v[20:23], a[72:75], v[96:99]
    v_mfma_f32_16x16x32_bf16 v[100:103], v[24:27], a[72:75], v[100:103]
    buffer_load_dwordx2 v[226:227], v228, s[8:11], s39 offen sc1
    v_mfma_f32_16x16x32_bf16 v[104:107], v[28:31], a[72:75], v[104:107]
    v_mfma_f32_16x16x32_bf16 v[108:111], v[32:35], a[72:75], v[108:111]
    v_mfma_f32_16x16x32_bf16 v[112:115], a[76:79], v[16:19], v[112:115]
    v_mfma_f32_16x16x32_bf16 v[116:119], a[76:79], v[20:23], v[116:119]
    v_mfma_f32_16x16x32_bf16 v[120:123], a[76:79], v[24:27], v[120:123]
    v_mfma_f32_16x16x32_bf16 v[124:127], a[76:79], v[28:31], v[124:127]
    v_mfma_f32_16x16x32_bf16 v[128:131], a[76:79], v[32:35], v[128:131]
    s_waitcnt vmcnt(7) lgkmcnt(0)
    s_barrier
    v_mfma_f32_16x16x32_bf16 v[56:59], a[80:83], v[40:43], v[56:59]
    ds_read_b128 v[16:19], v253 offset:30720
    v_mfma_f32_16x16x32_bf16 v[60:63], a[80:83], v[44:47], v[60:63]
    ds_read_b128 v[20:23], v253 offset:31744
    v_mfma_f32_16x16x32_bf16 v[64:67], a[80:83], v[48:51], v[64:67]
    ds_read_b128 v[24:27], v253 offset:32768
    v_mfma_f32_16x16x32_bf16 v[68:71], a[80:83], v[52:55], v[68:71]
    ds_read_b128 v[28:31], v253 offset:33792
    v_mfma_f32_16x16x32_bf16 v[72:75], a[84:87], v[36:39], v[72:75]
    ds_read_b128 v[32:35], v253 offset:34816
    v_mfma_f32_16x16x32_bf16 v[76:79], a[84:87], v[40:43], v[76:79]
    s_add_u32 m0, s25, 59392
    s_nop 0
    buffer_load_dwordx4 v2, s[8:11], s24 offen offset:2048 sc1 lds
    v_mfma_f32_16x16x32_bf16 v[80:83], a[84:87], v[44:47], v[80:83]
    v_mfma_f32_16x16x32_bf16 v[84:87], a[84:87], v[48:51], v[84:87]
    s_add_u32 m0, s25, 64000
    s_nop 0
    buffer_load_dwordx4 v2, s[8:11], s24 offen offset:2560 sc1 lds
    v_mfma_f32_16x16x32_bf16 v[88:91], a[84:87], v[52:55], v[88:91]
    v_mfma_f32_16x16x32_bf16 v[92:95], v[36:39], a[88:91], v[92:95]
    buffer_load_dwordx4 a[44:47], v253, s[8:11], s28 offen offset:3072 sc1
    s_add_u32 s28, s28, 4096
    v_mfma_f32_16x16x32_bf16 v[96:99], v[40:43], a[88:91], v[96:99]
    v_mfma_f32_16x16x32_bf16 v[100:103], v[44:47], a[88:91], v[100:103]
    buffer_load_dwordx4 a[48:51], v253, s[8:11], s28 offen offset:0 sc1
    v_mfma_f32_16x16x32_bf16 v[104:107], v[48:51], a[88:91], v[104:107]
    v_mfma_f32_16x16x32_bf16 v[108:111], v[52:55], a[88:91], v[108:111]
    buffer_load_dwordx4 a[52:55], v253, s[8:11], s28 offen offset:1024 sc1
    v_mfma_f32_16x16x32_bf16 v[112:115], a[92:95], v[36:39], v[112:115]
    v_mfma_f32_16x16x32_bf16 v[116:119], a[92:95], v[40:43], v[116:119]
    v_mfma_f32_16x16x32_bf16 v[120:123], a[92:95], v[44:47], v[120:123]
    v_mfma_f32_16x16x32_bf16 v[124:127], a[92:95], v[48:51], v[124:127]
    v_mfma_f32_16x16x32_bf16 v[128:131], a[92:95], v[52:55], v[128:131]
    s_waitcnt lgkmcnt(0)
    v_mfma_f32_16x16x32_bf16 v[56:59], a[96:99], v[20:23], v[56:59]
    ds_read_b128 v[36:39], v253 offset:35840
    v_mfma_f32_16x16x32_bf16 v[60:63], a[96:99], v[24:27], v[60:63]
    ds_read_b128 v[40:43], v253 offset:36864
    v_mfma_f32_16x16x32_bf16 v[64:67], a[96:99], v[28:31], v[64:67]
    ds_read_b128 v[44:47], v253 offset:37888
    v_mfma_f32_16x16x32_bf16 v[68:71], a[96:99], v[32:35], v[68:71]
    ds_read_b128 v[48:51], v253 offset:38912
    v_mfma_f32_16x16x32_bf16 v[72:75], a[100:103], v[16:19], v[72:75]
    ds_read_b128 v[52:55], v253 offset:39936
    v_mfma_f32_16x16x32_bf16 v[76:79], a[100:103], v[20:23], v[76:79]
    s_add_u32 m0, s25, 68608
    s_nop 0
    buffer_load_dwordx4 v2, s[8:11], s24 offen offset:3072 sc1 lds
    v_mfma_f32_16x16x32_bf16 v[80:83], a[100:103], v[24:27], v[80:83]
    v_mfma_f32_16x16x32_bf16 v[84:87], a[100:103], v[28:31], v[84:87]
    s_add_u32 m0, s25, 73216
    s_nop 0
    buffer_load_dwordx4 v2, s[8:11], s24 offen offset:3584 sc1 lds
    v_mfma_f32_16x16x32_bf16 v[88:91], a[100:103], v[32:35], v[88:91]
    v_mfma_f32_16x16x32_bf16 v[92:95], v[16:19], a[104:107], v[92:95]
    buffer_load_dwordx4 a[56:59], v253, s[8:11], s28 offen offset:2048 sc1
    v_mfma_f32_16x16x32_bf16 v[96:99], v[20:23], a[104:107], v[96:99]
    v_mfma_f32_16x16x32_bf16 v[100:103], v[24:27], a[104:107], v[100:103]
    buffer_load_dwordx4 a[60:63], v253, s[8:11], s28 offen offset:3072 sc1
    s_add_u32 s28, s28, 4096
    v_mfma_f32_16x16x32_bf16 v[104:107], v[28:31], a[104:107], v[104:107]
    v_mfma_f32_16x16x32_bf16 v[108:111], v[32:35], a[104:107], v[108:111]
    buffer_load_dwordx4 a[64:67], v253, s[8:11], s28 offen offset:0 sc1
    v_mfma_f32_16x16x32_bf16 v[112:115], a[108:111], v[16:19], v[112:115]
    v_mfma_f32_16x16x32_bf16 v[116:119], a[108:111], v[20:23], v[116:119]
    v_mfma_f32_16x16x32_bf16 v[120:123], a[108:111], v[24:27], v[120:123]
    v_mfma_f32_16x16x32_bf16 v[124:127], a[108:111], v[28:31], v[124:127]
    v_mfma_f32_16x16x32_bf16 v[128:131], a[108:111], v[32:35], v[128:131]
    s_waitcnt lgkmcnt(0)
    v_mfma_f32_16x16x32_bf16 v[56:59], a[112:115], v[40:43], v[56:59]
    ds_read_b128 v[16:19], v253 offset:40960
    v_mfma_f32_16x16x32_bf16 v[60:63], a[112:115], v[44:47], v[60:63]
    ds_read_b128 v[20:23], v253 offset:41984
    v_mfma_f32_16x16x32_bf16 v[64:67], a[112:115], v[48:51], v[64:67]
    ds_read_b128 v[24:27], v253 offset:43008
    v_mfma_f32_16x16x32_bf16 v[68:71], a[112:115], v[52:55], v[68:71]
    ds_read_b128 v[28:31], v253 offset:44032
    v_mfma_f32_16x16x32_bf16 v[72:75], a[116:119], v[36:39], v[72:75]
    ds_read_b128 v[32:35], v253 offset:45056
    v_mfma_f32_16x16x32_bf16 v[76:79], a[116:119], v[40:43], v[76:79]
    s_add_u32 m0, s25, 81920
    s_add_u32 s24, s24, 4096
    buffer_load_dwordx4 v2, s[8:11], s24 offen offset:0 sc1 lds
    v_mfma_f32_16x16x32_bf16 v[80:83], a[116:119], v[44:47], v[80:83]
    v_mfma_f32_16x16x32_bf16 v[84:87], a[116:119], v[48:51], v[84:87]
    s_add_u32 m0, s25, 86528
    s_nop 0
    buffer_load_dwordx4 v2, s[8:11], s24 offen offset:512 sc1 lds
    v_mfma_f32_16x16x32_bf16 v[88:91], a[116:119], v[52:55], v[88:91]
    v_mfma_f32_16x16x32_bf16 v[92:95], v[36:39], a[120:123], v[92:95]
    buffer_load_dwordx4 a[68:71], v253, s[8:11], s28 offen offset:1024 sc1
    v_mfma_f32_16x16x32_bf16 v[96:99], v[40:43], a[120:123], v[96:99]
    v_mfma_f32_16x16x32_bf16 v[100:103], v[44:47], a[120:123], v[100:103]
    buffer_load_dwordx4 a[72:75], v253, s[8:11], s28 offen offset:2048 sc1
    v_mfma_f32_16x16x32_bf16 v[104:107], v[48:51], a[120:123], v[104:107]
    v_mfma_f32_16x16x32_bf16 v[108:111], v[52:55], a[120:123], v[108:111]
    buffer_load_dwordx4 a[76:79], v253, s[8:11], s28 offen offset:3072 sc1
    s_add_u32 s28, s28, 4096
    v_mfma_f32_16x16x32_bf16 v[112:115], a[124:127], v[36:39], v[112:115]
    v_mfma_f32_16x16x32_bf16 v[116:119], a[124:127], v[40:43], v[116:119]
    v_mfma_f32_16x16x32_bf16 v[120:123], a[124:127], v[44:47], v[120:123]
    v_mfma_f32_16x16x32_bf16 v[124:127], a[124:127], v[48:51], v[124:127]
    v_mfma_f32_16x16x32_bf16 v[128:131], a[124:127], v[52:55], v[128:131]
    s_waitcnt lgkmcnt(0)
    v_mfma_f32_16x16x32_bf16 v[56:59], a[128:131], v[20:23], v[56:59]
    ds_read_b128 v[36:39], v6 offset:0
    v_mfma_f32_16x16x32_bf16 v[60:63], a[128:131], v[24:27], v[60:63]
    ds_read_b128 v[40:43], v6 offset:1024
    v_mfma_f32_16x16x32_bf16 v[64:67], a[128:131], v[28:31], v[64:67]
    ds_read_b128 v[44:47], v6 offset:2048
    v_mfma_f32_16x16x32_bf16 v[68:71], a[128:131], v[32:35], v[68:71]
    ds_read_b128 v[48:51], v6 offset:3072
    v_mfma_f32_16x16x32_bf16 v[72:75], a[132:135], v[16:19], v[72:75]
    ds_read_b128 v[52:55], v6 offset:4096
    v_mfma_f32_16x16x32_bf16 v[76:79], a[132:135], v[20:23], v[76:79]
    s_add_u32 m0, s26, 61440
    s_add_u32 s7, s27, 6144
    buffer_load_dwordx4 v2, s[8:11], s7 offen sc1 lds
    v_mfma_f32_16x16x32_bf16 v[80:83], a[132:135], v[24:27], v[80:83]
    v_mfma_f32_16x16x32_bf16 v[84:87], a[132:135], v[28:31], v[84:87]
    s_add_u32 m0, s29, 61440
    s_add_u32 s7, s23, 6144
    buffer_load_dwordx4 v2, s[8:11], s7 offen sc1 lds
    v_mfma_f32_16x16x32_bf16 v[88:91], a[132:135], v[32:35], v[88:91]
    v_mfma_f32_16x16x32_bf16 v[92:95], v[16:19], a[136:139], v[92:95]
    buffer_load_dwordx4 a[80:83], v253, s[8:11], s28 offen offset:0 sc1
    v_mfma_f32_16x16x32_bf16 v[96:99], v[20:23], a[136:139], v[96:99]
    v_mfma_f32_16x16x32_bf16 v[100:103], v[24:27], a[136:139], v[100:103]
    buffer_load_dwordx4 a[84:87], v253, s[8:11], s28 offen offset:1024 sc1
    v_mfma_f32_16x16x32_bf16 v[104:107], v[28:31], a[136:139], v[104:107]
    v_mfma_f32_16x16x32_bf16 v[108:111], v[32:35], a[136:139], v[108:111]
    buffer_load_dwordx4 a[88:91], v253, s[8:11], s28 offen offset:2048 sc1
    v_mfma_f32_16x16x32_bf16 v[112:115], a[140:143], v[16:19], v[112:115]
    v_mfma_f32_16x16x32_bf16 v[116:119], a[140:143], v[20:23], v[116:119]
    v_mfma_f32_16x16x32_bf16 v[120:123], a[140:143], v[24:27], v[120:123]
    v_mfma_f32_16x16x32_bf16 v[124:127], a[140:143], v[28:31], v[124:127]
    v_mfma_f32_16x16x32_bf16 v[128:131], a[140:143], v[32:35], v[128:131]
    s_waitcnt vmcnt(20) lgkmcnt(0)
    s_mov_b32 s6, 0
L_wo_poll_15:
    v_cmp_eq_u32 vcc, s76, v226
    v_cmp_eq_u32 s[20:21], s76, v227
    s_and_b64 vcc, vcc, s[20:21]
    s_cmp_eq_u64 vcc, exec
    s_cbranch_scc1 L_wo_ready_16
    buffer_load_dwordx2 v[226:227], v228, s[8:11], s39 offen sc1
    s_add_u32 s6, s6, 1
    s_cmp_lt_u32 s6, 1048576
    s_waitcnt vmcnt(0)
    s_cbranch_scc1 L_wo_poll_15
    s_branch L_main_end
L_wo_ready_16:
    v_mfma_f32_16x16x32_bf16 v[56:59], a[144:147], v[40:43], v[56:59]
    ds_read_b128 v[16:19], v6 offset:5120
    v_mfma_f32_16x16x32_bf16 v[60:63], a[144:147], v[44:47], v[60:63]
    ds_read_b128 v[20:23], v6 offset:6144
    v_mfma_f32_16x16x32_bf16 v[64:67], a[144:147], v[48:51], v[64:67]
    ds_read_b128 v[24:27], v6 offset:7168
    v_mfma_f32_16x16x32_bf16 v[68:71], a[144:147], v[52:55], v[68:71]
    ds_read_b128 v[28:31], v6 offset:8192
    v_mfma_f32_16x16x32_bf16 v[72:75], a[148:151], v[36:39], v[72:75]
    ds_read_b128 v[32:35], v6 offset:9216
    v_mfma_f32_16x16x32_bf16 v[76:79], a[148:151], v[40:43], v[76:79]
    buffer_load_dwordx4 a[92:95], v253, s[8:11], s28 offen offset:3072 sc1
    s_add_u32 s28, s28, 4096
    v_mfma_f32_16x16x32_bf16 v[80:83], a[148:151], v[44:47], v[80:83]
    v_mfma_f32_16x16x32_bf16 v[84:87], a[148:151], v[48:51], v[84:87]
    buffer_load_dwordx4 a[96:99], v253, s[8:11], s28 offen offset:0 sc1
    v_mfma_f32_16x16x32_bf16 v[88:91], a[148:151], v[52:55], v[88:91]
    v_mfma_f32_16x16x32_bf16 v[92:95], v[36:39], a[152:155], v[92:95]
    buffer_load_dwordx4 a[100:103], v253, s[8:11], s28 offen offset:1024 sc1
    v_mfma_f32_16x16x32_bf16 v[96:99], v[40:43], a[152:155], v[96:99]
    v_mfma_f32_16x16x32_bf16 v[100:103], v[44:47], a[152:155], v[100:103]
    buffer_load_dwordx4 a[160:163], v253, s[8:11], s32 offen offset:0 sc1
    v_mfma_f32_16x16x32_bf16 v[104:107], v[48:51], a[152:155], v[104:107]
    v_mfma_f32_16x16x32_bf16 v[108:111], v[52:55], a[152:155], v[108:111]
    v_mfma_f32_16x16x32_bf16 v[112:115], a[156:159], v[36:39], v[112:115]
    v_mfma_f32_16x16x32_bf16 v[116:119], a[156:159], v[40:43], v[116:119]
    v_mfma_f32_16x16x32_bf16 v[120:123], a[156:159], v[44:47], v[120:123]
    v_mfma_f32_16x16x32_bf16 v[124:127], a[156:159], v[48:51], v[124:127]
    v_mfma_f32_16x16x32_bf16 v[128:131], a[156:159], v[52:55], v[128:131]
    s_waitcnt vmcnt(34) lgkmcnt(0)
    v_mfma_f32_16x16x32_bf16 v[56:59], a[0:3], v[20:23], v[56:59]
    ds_read_b128 v[36:39], v6 offset:10240
    v_mfma_f32_16x16x32_bf16 v[60:63], a[0:3], v[24:27], v[60:63]
    ds_read_b128 v[40:43], v6 offset:11264
    v_mfma_f32_16x16x32_bf16 v[64:67], a[0:3], v[28:31], v[64:67]
    ds_read_b128 v[44:47], v6 offset:12288
    v_mfma_f32_16x16x32_bf16 v[68:71], a[0:3], v[32:35], v[68:71]
    ds_read_b128 v[48:51], v6 offset:13312
    v_mfma_f32_16x16x32_bf16 v[72:75], a[4:7], v[16:19], v[72:75]
    ds_read_b128 v[52:55], v6 offset:14336
    v_mfma_f32_16x16x32_bf16 v[76:79], a[4:7], v[20:23], v[76:79]
    buffer_load_dwordx4 a[104:107], v253, s[8:11], s28 offen offset:2048 sc1
    v_mfma_f32_16x16x32_bf16 v[80:83], a[4:7], v[24:27], v[80:83]
    v_mfma_f32_16x16x32_bf16 v[84:87], a[4:7], v[28:31], v[84:87]
    buffer_load_dwordx4 a[108:111], v253, s[8:11], s28 offen offset:3072 sc1
    s_add_u32 s28, s28, 4096
    v_mfma_f32_16x16x32_bf16 v[88:91], a[4:7], v[32:35], v[88:91]
    v_mfma_f32_16x16x32_bf16 v[92:95], v[16:19], a[8:11], v[92:95]
    buffer_load_dwordx4 a[112:115], v253, s[8:11], s28 offen offset:0 sc1
    v_mfma_f32_16x16x32_bf16 v[96:99], v[20:23], a[8:11], v[96:99]
    v_mfma_f32_16x16x32_bf16 v[100:103], v[24:27], a[8:11], v[100:103]
    buffer_load_dwordx4 a[164:167], v253, s[8:11], s33 offen offset:0 sc1
    v_mfma_f32_16x16x32_bf16 v[104:107], v[28:31], a[8:11], v[104:107]
    v_mfma_f32_16x16x32_bf16 v[108:111], v[32:35], a[8:11], v[108:111]
    v_mfma_f32_16x16x32_bf16 v[112:115], a[12:15], v[16:19], v[112:115]
    v_mfma_f32_16x16x32_bf16 v[116:119], a[12:15], v[20:23], v[116:119]
    v_mfma_f32_16x16x32_bf16 v[120:123], a[12:15], v[24:27], v[120:123]
    v_mfma_f32_16x16x32_bf16 v[124:127], a[12:15], v[28:31], v[124:127]
    v_mfma_f32_16x16x32_bf16 v[128:131], a[12:15], v[32:35], v[128:131]
    s_waitcnt vmcnt(11) lgkmcnt(0)
    s_barrier
    v_mfma_f32_16x16x32_bf16 v[56:59], a[16:19], v[40:43], v[56:59]
    ds_read_b128 v[16:19], v6 offset:15360
    v_mfma_f32_16x16x32_bf16 v[60:63], a[16:19], v[44:47], v[60:63]
    ds_read_b128 v[20:23], v6 offset:16384
    v_mfma_f32_16x16x32_bf16 v[64:67], a[16:19], v[48:51], v[64:67]
    ds_read_b128 v[24:27], v6 offset:17408
    v_mfma_f32_16x16x32_bf16 v[68:71], a[16:19], v[52:55], v[68:71]
    ds_read_b128 v[28:31], v6 offset:18432
    v_mfma_f32_16x16x32_bf16 v[72:75], a[20:23], v[36:39], v[72:75]
    ds_read_b128 v[32:35], v6 offset:19456
    v_mfma_f32_16x16x32_bf16 v[76:79], a[20:23], v[40:43], v[76:79]
    buffer_load_dwordx4 a[116:119], v253, s[8:11], s28 offen offset:1024 sc1
    v_mfma_f32_16x16x32_bf16 v[80:83], a[20:23], v[44:47], v[80:83]
    v_mfma_f32_16x16x32_bf16 v[84:87], a[20:23], v[48:51], v[84:87]
    buffer_load_dwordx4 a[120:123], v253, s[8:11], s28 offen offset:2048 sc1
    v_mfma_f32_16x16x32_bf16 v[88:91], a[20:23], v[52:55], v[88:91]
    v_mfma_f32_16x16x32_bf16 v[92:95], v[36:39], a[24:27], v[92:95]
    buffer_load_dwordx4 a[124:127], v253, s[8:11], s28 offen offset:3072 sc1
    s_add_u32 s28, s28, 4096
    v_mfma_f32_16x16x32_bf16 v[96:99], v[40:43], a[24:27], v[96:99]
    v_mfma_f32_16x16x32_bf16 v[100:103], v[44:47], a[24:27], v[100:103]
    buffer_load_dwordx4 a[168:171], v5, s[8:11], s34 offen offset:0 sc1
    v_mfma_f32_16x16x32_bf16 v[104:107], v[48:51], a[24:27], v[104:107]
    v_mfma_f32_16x16x32_bf16 v[108:111], v[52:55], a[24:27], v[108:111]
    v_mfma_f32_16x16x32_bf16 v[112:115], a[28:31], v[36:39], v[112:115]
    v_mfma_f32_16x16x32_bf16 v[116:119], a[28:31], v[40:43], v[116:119]
    v_mfma_f32_16x16x32_bf16 v[120:123], a[28:31], v[44:47], v[120:123]
    v_mfma_f32_16x16x32_bf16 v[124:127], a[28:31], v[48:51], v[124:127]
    v_mfma_f32_16x16x32_bf16 v[128:131], a[28:31], v[52:55], v[128:131]
    s_waitcnt vmcnt(29) lgkmcnt(0)
    v_mfma_f32_16x16x32_bf16 v[56:59], a[32:35], v[20:23], v[56:59]
    ds_read_b128 v[36:39], v6 offset:20480
    v_mfma_f32_16x16x32_bf16 v[60:63], a[32:35], v[24:27], v[60:63]
    ds_read_b128 v[40:43], v6 offset:21504
    v_mfma_f32_16x16x32_bf16 v[64:67], a[32:35], v[28:31], v[64:67]
    ds_read_b128 v[44:47], v6 offset:22528
    v_mfma_f32_16x16x32_bf16 v[68:71], a[32:35], v[32:35], v[68:71]
    ds_read_b128 v[48:51], v6 offset:23552
    v_mfma_f32_16x16x32_bf16 v[72:75], a[36:39], v[16:19], v[72:75]
    ds_read_b128 v[52:55], v6 offset:24576
    v_mfma_f32_16x16x32_bf16 v[76:79], a[36:39], v[20:23], v[76:79]
    buffer_load_dwordx4 a[172:175], v253, s[8:11], s32 offen offset:1024 sc1
    v_mfma_f32_16x16x32_bf16 v[80:83], a[36:39], v[24:27], v[80:83]
    v_mfma_f32_16x16x32_bf16 v[84:87], a[36:39], v[28:31], v[84:87]
    buffer_load_dwordx4 a[176:179], v253, s[8:11], s33 offen offset:1024 sc1
    v_mfma_f32_16x16x32_bf16 v[88:91], a[36:39], v[32:35], v[88:91]
    v_mfma_f32_16x16x32_bf16 v[92:95], v[16:19], a[40:43], v[92:95]
    buffer_load_dwordx4 a[180:183], v5, s[8:11], s34 offen offset:1024 sc1
    v_mfma_f32_16x16x32_bf16 v[96:99], v[20:23], a[40:43], v[96:99]
    v_mfma_f32_16x16x32_bf16 v[100:103], v[24:27], a[40:43], v[100:103]
    buffer_load_dwordx4 a[184:187], v253, s[8:11], s32 offen offset:2048 sc1
    v_mfma_f32_16x16x32_bf16 v[104:107], v[28:31], a[40:43], v[104:107]
    v_mfma_f32_16x16x32_bf16 v[108:111], v[32:35], a[40:43], v[108:111]
    v_mfma_f32_16x16x32_bf16 v[112:115], a[44:47], v[16:19], v[112:115]
    v_mfma_f32_16x16x32_bf16 v[116:119], a[44:47], v[20:23], v[116:119]
    v_mfma_f32_16x16x32_bf16 v[120:123], a[44:47], v[24:27], v[120:123]
    v_mfma_f32_16x16x32_bf16 v[124:127], a[44:47], v[28:31], v[124:127]
    v_mfma_f32_16x16x32_bf16 v[128:131], a[44:47], v[32:35], v[128:131]
    s_waitcnt vmcnt(27) lgkmcnt(0)
    v_mfma_f32_16x16x32_bf16 v[56:59], a[48:51], v[40:43], v[56:59]
    ds_read_b128 v[16:19], v6 offset:25600
    v_mfma_f32_16x16x32_bf16 v[60:63], a[48:51], v[44:47], v[60:63]
    ds_read_b128 v[20:23], v6 offset:26624
    v_mfma_f32_16x16x32_bf16 v[64:67], a[48:51], v[48:51], v[64:67]
    ds_read_b128 v[24:27], v6 offset:27648
    v_mfma_f32_16x16x32_bf16 v[68:71], a[48:51], v[52:55], v[68:71]
    ds_read_b128 v[28:31], v6 offset:28672
    v_mfma_f32_16x16x32_bf16 v[72:75], a[52:55], v[36:39], v[72:75]
    ds_read_b128 v[32:35], v6 offset:29696
    v_mfma_f32_16x16x32_bf16 v[76:79], a[52:55], v[40:43], v[76:79]
    buffer_load_dwordx4 a[188:191], v253, s[8:11], s33 offen offset:2048 sc1
    v_mfma_f32_16x16x32_bf16 v[80:83], a[52:55], v[44:47], v[80:83]
    v_mfma_f32_16x16x32_bf16 v[84:87], a[52:55], v[48:51], v[84:87]
    buffer_load_dwordx4 a[192:195], v5, s[8:11], s34 offen offset:2048 sc1
    v_mfma_f32_16x16x32_bf16 v[88:91], a[52:55], v[52:55], v[88:91]
    v_mfma_f32_16x16x32_bf16 v[92:95], v[36:39], a[56:59], v[92:95]
    buffer_load_dwordx4 a[196:199], v253, s[8:11], s32 offen offset:3072 sc1
    s_add_u32 s32, s32, 4096
    v_mfma_f32_16x16x32_bf16 v[96:99], v[40:43], a[56:59], v[96:99]
    v_mfma_f32_16x16x32_bf16 v[100:103], v[44:47], a[56:59], v[100:103]
    buffer_load_dwordx4 a[200:203], v253, s[8:11], s33 offen offset:3072 sc1
    s_add_u32 s33, s33, 4096
    v_mfma_f32_16x16x32_bf16 v[104:107], v[48:51], a[56:59], v[104:107]
    v_mfma_f32_16x16x32_bf16 v[108:111], v[52:55], a[56:59], v[108:111]
    v_mfma_f32_16x16x32_bf16 v[112:115], a[60:63], v[36:39], v[112:115]
    v_mfma_f32_16x16x32_bf16 v[116:119], a[60:63], v[40:43], v[116:119]
    v_mfma_f32_16x16x32_bf16 v[120:123], a[60:63], v[44:47], v[120:123]
    v_mfma_f32_16x16x32_bf16 v[124:127], a[60:63], v[48:51], v[124:127]
    v_mfma_f32_16x16x32_bf16 v[128:131], a[60:63], v[52:55], v[128:131]
    s_waitcnt vmcnt(25) lgkmcnt(0)
    v_mfma_f32_16x16x32_bf16 v[56:59], a[64:67], v[20:23], v[56:59]
    ds_read_b128 v[36:39], v6 offset:30720
    v_mfma_f32_16x16x32_bf16 v[60:63], a[64:67], v[24:27], v[60:63]
    ds_read_b128 v[40:43], v6 offset:31744
    v_mfma_f32_16x16x32_bf16 v[64:67], a[64:67], v[28:31], v[64:67]
    ds_read_b128 v[44:47], v6 offset:32768
    v_mfma_f32_16x16x32_bf16 v[68:71], a[64:67], v[32:35], v[68:71]
    ds_read_b128 v[48:51], v6 offset:33792
    v_mfma_f32_16x16x32_bf16 v[72:75], a[68:71], v[16:19], v[72:75]
    ds_read_b128 v[52:55], v6 offset:34816
    v_mfma_f32_16x16x32_bf16 v[76:79], a[68:71], v[20:23], v[76:79]
    buffer_load_dwordx4 a[204:207], v5, s[8:11], s34 offen offset:3072 sc1
    s_add_u32 s34, s34, 4096
    v_mfma_f32_16x16x32_bf16 v[80:83], a[68:71], v[24:27], v[80:83]
    v_mfma_f32_16x16x32_bf16 v[84:87], a[68:71], v[28:31], v[84:87]
    buffer_load_dwordx4 a[208:211], v253, s[8:11], s32 offen offset:0 sc1
    v_mfma_f32_16x16x32_bf16 v[88:91], a[68:71], v[32:35], v[88:91]
    v_mfma_f32_16x16x32_bf16 v[92:95], v[16:19], a[72:75], v[92:95]
    buffer_load_dwordx4 a[212:215], v253, s[8:11], s33 offen offset:0 sc1
    v_mfma_f32_16x16x32_bf16 v[96:99], v[20:23], a[72:75], v[96:99]
    v_mfma_f32_16x16x32_bf16 v[100:103], v[24:27], a[72:75], v[100:103]
    buffer_load_dwordx4 a[216:219], v5, s[8:11], s34 offen offset:0 sc1
    v_mfma_f32_16x16x32_bf16 v[104:107], v[28:31], a[72:75], v[104:107]
    v_mfma_f32_16x16x32_bf16 v[108:111], v[32:35], a[72:75], v[108:111]
    v_mfma_f32_16x16x32_bf16 v[112:115], a[76:79], v[16:19], v[112:115]
    v_mfma_f32_16x16x32_bf16 v[116:119], a[76:79], v[20:23], v[116:119]
    v_mfma_f32_16x16x32_bf16 v[120:123], a[76:79], v[24:27], v[120:123]
    v_mfma_f32_16x16x32_bf16 v[124:127], a[76:79], v[28:31], v[124:127]
    v_mfma_f32_16x16x32_bf16 v[128:131], a[76:79], v[32:35], v[128:131]
    s_waitcnt vmcnt(23) lgkmcnt(0)
    v_mfma_f32_16x16x32_bf16 v[56:59], a[80:83], v[40:43], v[56:59]
    ds_read_b128 v[16:19], v6 offset:35840
    v_mfma_f32_16x16x32_bf16 v[60:63], a[80:83], v[44:47], v[60:63]
    ds_read_b128 v[20:23], v6 offset:36864
    v_mfma_f32_16x16x32_bf16 v[64:67], a[80:83], v[48:51], v[64:67]
    ds_read_b128 v[24:27], v6 offset:37888
    v_mfma_f32_16x16x32_bf16 v[68:71], a[80:83], v[52:55], v[68:71]
    ds_read_b128 v[28:31], v6 offset:38912
    v_mfma_f32_16x16x32_bf16 v[72:75], a[84:87], v[36:39], v[72:75]
    ds_read_b128 v[32:35], v6 offset:39936
    v_mfma_f32_16x16x32_bf16 v[76:79], a[84:87], v[40:43], v[76:79]
    buffer_load_dwordx4 a[220:223], v253, s[8:11], s32 offen offset:1024 sc1
    v_mfma_f32_16x16x32_bf16 v[80:83], a[84:87], v[44:47], v[80:83]
    v_mfma_f32_16x16x32_bf16 v[84:87], a[84:87], v[48:51], v[84:87]
    buffer_load_dwordx4 a[224:227], v253, s[8:11], s33 offen offset:1024 sc1
    v_mfma_f32_16x16x32_bf16 v[88:91], a[84:87], v[52:55], v[88:91]
    v_mfma_f32_16x16x32_bf16 v[92:95], v[36:39], a[88:91], v[92:95]
    buffer_load_dwordx4 a[228:231], v5, s[8:11], s34 offen offset:1024 sc1
    v_mfma_f32_16x16x32_bf16 v[96:99], v[40:43], a[88:91], v[96:99]
    v_mfma_f32_16x16x32_bf16 v[100:103], v[44:47], a[88:91], v[100:103]
    buffer_load_dwordx4 a[232:235], v253, s[8:11], s32 offen offset:2048 sc1
    v_mfma_f32_16x16x32_bf16 v[104:107], v[48:51], a[88:91], v[104:107]
    v_mfma_f32_16x16x32_bf16 v[108:111], v[52:55], a[88:91], v[108:111]
    v_mfma_f32_16x16x32_bf16 v[112:115], a[92:95], v[36:39], v[112:115]
    v_mfma_f32_16x16x32_bf16 v[116:119], a[92:95], v[40:43], v[116:119]
    v_mfma_f32_16x16x32_bf16 v[120:123], a[92:95], v[44:47], v[120:123]
    v_mfma_f32_16x16x32_bf16 v[124:127], a[92:95], v[48:51], v[124:127]
    v_mfma_f32_16x16x32_bf16 v[128:131], a[92:95], v[52:55], v[128:131]
    s_waitcnt vmcnt(22) lgkmcnt(0)
    v_mfma_f32_16x16x32_bf16 v[56:59], a[96:99], v[20:23], v[56:59]
    ds_read_b128 v[36:39], v6 offset:40960
    v_mfma_f32_16x16x32_bf16 v[60:63], a[96:99], v[24:27], v[60:63]
    ds_read_b128 v[40:43], v6 offset:41984
    v_mfma_f32_16x16x32_bf16 v[64:67], a[96:99], v[28:31], v[64:67]
    ds_read_b128 v[44:47], v6 offset:43008
    v_mfma_f32_16x16x32_bf16 v[68:71], a[96:99], v[32:35], v[68:71]
    ds_read_b128 v[48:51], v6 offset:44032
    v_mfma_f32_16x16x32_bf16 v[72:75], a[100:103], v[16:19], v[72:75]
    ds_read_b128 v[52:55], v6 offset:45056
    v_mfma_f32_16x16x32_bf16 v[76:79], a[100:103], v[20:23], v[76:79]
    buffer_load_dwordx4 a[236:239], v253, s[8:11], s33 offen offset:2048 sc1
    v_mfma_f32_16x16x32_bf16 v[80:83], a[100:103], v[24:27], v[80:83]
    v_mfma_f32_16x16x32_bf16 v[84:87], a[100:103], v[28:31], v[84:87]
    buffer_load_dwordx4 a[240:243], v5, s[8:11], s34 offen offset:2048 sc1
    v_mfma_f32_16x16x32_bf16 v[88:91], a[100:103], v[32:35], v[88:91]
    v_mfma_f32_16x16x32_bf16 v[92:95], v[16:19], a[104:107], v[92:95]
    buffer_load_dwordx4 a[244:247], v253, s[8:11], s32 offen offset:3072 sc1
    s_add_u32 s32, s32, 4096
    v_mfma_f32_16x16x32_bf16 v[96:99], v[20:23], a[104:107], v[96:99]
    v_mfma_f32_16x16x32_bf16 v[100:103], v[24:27], a[104:107], v[100:103]
    buffer_load_dwordx4 a[248:251], v253, s[8:11], s33 offen offset:3072 sc1
    s_add_u32 s33, s33, 4096
    v_mfma_f32_16x16x32_bf16 v[104:107], v[28:31], a[104:107], v[104:107]
    v_mfma_f32_16x16x32_bf16 v[108:111], v[32:35], a[104:107], v[108:111]
    v_mfma_f32_16x16x32_bf16 v[112:115], a[108:111], v[16:19], v[112:115]
    v_mfma_f32_16x16x32_bf16 v[116:119], a[108:111], v[20:23], v[116:119]
    v_mfma_f32_16x16x32_bf16 v[120:123], a[108:111], v[24:27], v[120:123]
    v_mfma_f32_16x16x32_bf16 v[124:127], a[108:111], v[28:31], v[124:127]
    v_mfma_f32_16x16x32_bf16 v[128:131], a[108:111], v[32:35], v[128:131]
    s_waitcnt vmcnt(21) lgkmcnt(0)
    v_mfma_f32_16x16x32_bf16 v[56:59], a[112:115], v[40:43], v[56:59]
    v_mfma_f32_16x16x32_bf16 v[60:63], a[112:115], v[44:47], v[60:63]
    v_mfma_f32_16x16x32_bf16 v[64:67], a[112:115], v[48:51], v[64:67]
    v_mfma_f32_16x16x32_bf16 v[68:71], a[112:115], v[52:55], v[68:71]
    v_mfma_f32_16x16x32_bf16 v[72:75], a[116:119], v[36:39], v[72:75]
    v_mfma_f32_16x16x32_bf16 v[76:79], a[116:119], v[40:43], v[76:79]
    buffer_load_dwordx4 a[252:255], v5, s[8:11], s34 offen offset:3072 sc1
    s_add_u32 s34, s34, 4096
    v_mfma_f32_16x16x32_bf16 v[80:83], a[116:119], v[44:47], v[80:83]
    v_mfma_f32_16x16x32_bf16 v[84:87], a[116:119], v[48:51], v[84:87]
    buffer_load_dwordx4 a[128:131], v253, s[8:11], s32 offen offset:0 sc1
    v_mfma_f32_16x16x32_bf16 v[88:91], a[116:119], v[52:55], v[88:91]
    v_mfma_f32_16x16x32_bf16 v[92:95], v[36:39], a[120:123], v[92:95]
    buffer_load_dwordx4 a[132:135], v253, s[8:11], s33 offen offset:0 sc1
    v_mfma_f32_16x16x32_bf16 v[96:99], v[40:43], a[120:123], v[96:99]
    v_mfma_f32_16x16x32_bf16 v[100:103], v[44:47], a[120:123], v[100:103]
    buffer_load_dwordx4 a[136:139], v5, s[8:11], s34 offen offset:0 sc1
    v_mfma_f32_16x16x32_bf16 v[104:107], v[48:51], a[120:123], v[104:107]
    v_mfma_f32_16x16x32_bf16 v[108:111], v[52:55], a[120:123], v[108:111]
    v_mfma_f32_16x16x32_bf16 v[112:115], a[124:127], v[36:39], v[112:115]
    v_mfma_f32_16x16x32_bf16 v[116:119], a[124:127], v[40:43], v[116:119]
    v_mfma_f32_16x16x32_bf16 v[120:123], a[124:127], v[44:47], v[120:123]
    v_mfma_f32_16x16x32_bf16 v[124:127], a[124:127], v[48:51], v[124:127]
    v_mfma_f32_16x16x32_bf16 v[128:131], a[124:127], v[52:55], v[128:131]
    v_cvt_pk_bf16_f32 v136, v56, v57
    v_cvt_pk_bf16_f32 v137, v58, v59
    v_cvt_pk_bf16_f32 v140, v60, v61
    v_cvt_pk_bf16_f32 v141, v62, v63
    v_cvt_pk_bf16_f32 v144, v64, v65
    v_cvt_pk_bf16_f32 v145, v66, v67
    v_cvt_pk_bf16_f32 v148, v68, v69
    v_cvt_pk_bf16_f32 v149, v70, v71
    v_cvt_pk_bf16_f32 v152, v72, v73
    buffer_load_dwordx4 a[140:143], v253, s[8:11], s32 offen offset:1024 sc1
    v_cvt_pk_bf16_f32 v153, v74, v75
    v_cvt_pk_bf16_f32 v156, v76, v77
    v_cvt_pk_bf16_f32 v157, v78, v79
    v_cvt_pk_bf16_f32 v160, v80, v81
    v_cvt_pk_bf16_f32 v161, v82, v83
    v_cvt_pk_bf16_f32 v164, v84, v85
    v_cvt_pk_bf16_f32 v165, v86, v87
    v_cvt_pk_bf16_f32 v168, v88, v89
    v_cvt_pk_bf16_f32 v169, v90, v91
    buffer_load_dwordx4 a[144:147], v253, s[8:11], s33 offen offset:1024 sc1
    v_cvt_pk_bf16_f32 v134, v112, v113
    v_cvt_pk_bf16_f32 v154, v114, v115
    v_cvt_pk_bf16_f32 v138, v116, v117
    v_cvt_pk_bf16_f32 v158, v118, v119
    v_cvt_pk_bf16_f32 v142, v120, v121
    v_cvt_pk_bf16_f32 v162, v122, v123
    v_cvt_pk_bf16_f32 v146, v124, v125
    v_cvt_pk_bf16_f32 v166, v126, v127
    v_cvt_pk_bf16_f32 v150, v128, v129
    buffer_load_dwordx4 a[148:151], v5, s[8:11], s34 offen offset:1024 sc1
    v_cvt_pk_bf16_f32 v170, v130, v131
    v_cvt_pk_bf16_f32 v172, v92, v93
    v_cvt_pk_bf16_f32 v173, v94, v95
    v_cvt_pk_bf16_f32 v174, v96, v97
    v_cvt_pk_bf16_f32 v175, v98, v99
    v_cvt_pk_bf16_f32 v176, v100, v101
    v_cvt_pk_bf16_f32 v177, v102, v103
    v_cvt_pk_bf16_f32 v178, v104, v105
    v_cvt_pk_bf16_f32 v179, v106, v107
    buffer_load_dwordx4 a[152:155], v253, s[8:11], s32 offen offset:2048 sc1
    v_cvt_pk_bf16_f32 v180, v108, v109
    v_cvt_pk_bf16_f32 v181, v110, v111
    v_mfma_f32_16x16x32_bf16 v[16:19], v[152:155], v[136:139], v[208:211]
    v_mfma_f32_16x16x32_bf16 v[20:23], v[156:159], v[136:139], v[204:207]
    v_mfma_f32_16x16x32_bf16 v[24:27], v[156:159], v[140:143], v[200:203]
    v_mfma_f32_16x16x32_bf16 v[28:31], v[160:163], v[140:143], v[204:207]
    v_mfma_f32_16x16x32_bf16 v[32:35], v[160:163], v[144:147], v[200:203]
    v_mfma_f32_16x16x32_bf16 v[36:39], v[164:167], v[144:147], v[204:207]
    v_mfma_f32_16x16x32_bf16 v[40:43], v[164:167], v[148:151], v[200:203]
    buffer_load_dwordx4 a[156:159], v253, s[8:11], s33 offen offset:2048 sc1
    v_mfma_f32_16x16x32_bf16 v[44:47], v[168:171], v[148:151], v[204:207]
    v_mfma_f32_16x16x32_bf16 v[56:59], v[132:135], v[192:195], v[196:199]
    v_mfma_f32_16x16x32_bf16 v[60:63], v[136:139], v[192:195], v[196:199]
    v_mfma_f32_16x16x32_bf16 v[64:67], v[140:143], v[192:195], v[196:199]
    v_mfma_f32_16x16x32_bf16 v[68:71], v[144:147], v[192:195], v[196:199]
    v_mfma_f32_16x16x32_bf16 v[72:75], v[148:151], v[192:195], v[196:199]
    v_max3_f32 v92, v16, v17, v18
    v_max3_f32 v96, v19, v20, v21
    v_max3_f32 v93, v24, v25, v26
    buffer_load_dwordx4 a[0:3], v5, s[8:11], s34 offen offset:2048 sc1
    v_max3_f32 v97, v27, v28, v29
    v_max3_f32 v94, v32, v33, v34
    v_max3_f32 v98, v35, v36, v37
    v_max3_f32 v95, v40, v41, v42
    v_max3_f32 v99, v43, v44, v45
    v_max3_f32 v92, v92, v22, v23
    v_max3_f32 v93, v93, v30, v31
    v_max3_f32 v94, v94, v38, v39
    v_max3_f32 v95, v95, v46, v47
    buffer_load_dwordx4 a[4:7], v253, s[8:11], s32 offen offset:3072 sc1
    s_add_u32 s32, s32, 4096
    v_max_f32 v92, v92, v96
    v_max_f32 v93, v93, v97
    v_max_f32 v94, v94, v98
    v_max_f32 v95, v95, v99
    s_mov_b32 s18, 0x3eae1a93
    v_cvt_pk_bf16_f32 v182, v56, v57
    v_permlane32_swap_b32 v92, v93
    v_permlane32_swap_b32 v94, v95
    v_max_f32 v92, v92, v93
    buffer_load_dwordx4 a[8:11], v253, s[8:11], s33 offen offset:3072 sc1
    s_add_u32 s33, s33, 4096
    v_max_f32 v94, v94, v95
    v_cvt_pk_bf16_f32 v183, v58, v59
    v_cvt_pk_bf16_f32 v184, v60, v61
    v_permlane16_swap_b32 v92, v94
    v_max_f32 v92, v92, v94
    v_mul_f32 v92, 0xbeae1a93, v92
    v_mov_b32 v94, v92
    v_cvt_pk_bf16_f32 v185, v62, v63
    v_cvt_pk_bf16_f32 v186, v64, v65
    buffer_load_dwordx4 a[12:15], v5, s[8:11], s34 offen offset:3072 sc1
    s_add_u32 s34, s34, 4096
    v_permlane16_swap_b32 v92, v94
    v_mov_b32 v93, v92
    v_mov_b32 v95, v94
    v_cvt_pk_bf16_f32 v187, v66, v67
    v_cvt_pk_bf16_f32 v188, v68, v69
    v_permlane32_swap_b32 v92, v93
    v_permlane32_swap_b32 v94, v95
    v_cvt_pk_bf16_f32 v189, v70, v71
    v_cvt_pk_bf16_f32 v190, v72, v73
    buffer_load_dwordx4 a[16:19], v253, s[8:11], s32 offen offset:0 sc1
    v_cvt_pk_bf16_f32 v191, v74, v75
    v_fma_f32 v16, v16, s18, v92
    v_fma_f32 v17, v17, s18, v92
    v_fma_f32 v18, v18, s18, v92
    v_fma_f32 v19, v19, s18, v92
    v_fma_f32 v20, v20, s18, v92
    v_fma_f32 v21, v21, s18, v92
    v_fma_f32 v22, v22, s18, v92
    v_fma_f32 v23, v23, s18, v92
    buffer_load_dwordx4 a[20:23], v253, s[8:11], s33 offen offset:0 sc1
    v_exp_f32 v16, v16
    v_exp_f32 v17, v17
    v_exp_f32 v18, v18
    v_exp_f32 v19, v19
    v_exp_f32 v20, v20
    v_exp_f32 v21, v21
    v_exp_f32 v22, v22
    v_exp_f32 v23, v23
    s_nop 0
    buffer_load_dwordx4 a[24:27], v5, s[8:11], s34 offen offset:0 sc1
    v_cvt_pk_bf16_f32 v76, v16, v17
    v_cvt_pk_bf16_f32 v77, v18, v19
    v_cvt_pk_bf16_f32 v78, v20, v21
    v_cvt_pk_bf16_f32 v79, v22, v23
    v_fma_f32 v24, v24, s18, v93
    v_fma_f32 v25, v25, s18, v93
    v_fma_f32 v26, v26, s18, v93
    v_fma_f32 v27, v27, s18, v93
    v_fma_f32 v28, v28, s18, v93
    buffer_load_dwordx4 a[28:31], v253, s[8:11], s32 offen offset:1024 sc1
    v_fma_f32 v29, v29, s18, v93
    v_fma_f32 v30, v30, s18, v93
    v_fma_f32 v31, v31, s18, v93
    v_exp_f32 v24, v24
    v_exp_f32 v25, v25
    v_exp_f32 v26, v26
    v_exp_f32 v27, v27
    v_exp_f32 v28, v28
    v_exp_f32 v29, v29
    buffer_load_dwordx4 a[32:35], v253, s[8:11], s33 offen offset:1024 sc1
    v_exp_f32 v30, v30
    v_exp_f32 v31, v31
    v_mfma_f32_16x16x32_bf16 v[100:103], v[172:175], v[76:79], 0
    v_mfma_f32_16x16x32_bf16 v[116:119], v[182:185], v[76:79], 0
    v_cvt_pk_bf16_f32 v80, v24, v25
    v_cvt_pk_bf16_f32 v81, v26, v27
    v_cvt_pk_bf16_f32 v82, v28, v29
    v_cvt_pk_bf16_f32 v83, v30, v31
    v_fma_f32 v32, v32, s18, v94
    buffer_load_dwordx4 a[36:39], v5, s[8:11], s34 offen offset:1024 sc1
    v_fma_f32 v33, v33, s18, v94
    v_fma_f32 v34, v34, s18, v94
    v_fma_f32 v35, v35, s18, v94
    v_fma_f32 v36, v36, s18, v94
    v_fma_f32 v37, v37, s18, v94
    v_fma_f32 v38, v38, s18, v94
    v_fma_f32 v39, v39, s18, v94
    v_exp_f32 v32, v32
    v_exp_f32 v33, v33
    buffer_load_dwordx4 a[40:43], v253, s[8:11], s32 offen offset:2048 sc1
    v_exp_f32 v34, v34
    v_exp_f32 v35, v35
    v_exp_f32 v36, v36
    v_exp_f32 v37, v37
    v_exp_f32 v38, v38
    v_exp_f32 v39, v39
    v_mfma_f32_16x16x32_bf16 v[104:107], v[174:177], v[80:83], 0
    v_mfma_f32_16x16x32_bf16 v[120:123], v[184:187], v[80:83], 0
    v_cvt_pk_bf16_f32 v84, v32, v33
    buffer_load_dwordx4 a[44:47], v253, s[8:11], s33 offen offset:2048 sc1
    v_cvt_pk_bf16_f32 v85, v34, v35
    v_cvt_pk_bf16_f32 v86, v36, v37
    v_cvt_pk_bf16_f32 v87, v38, v39
    v_fma_f32 v40, v40, s18, v95
    v_fma_f32 v41, v41, s18, v95
    v_fma_f32 v42, v42, s18, v95
    v_fma_f32 v43, v43, s18, v95
    v_fma_f32 v44, v44, s18, v95
    v_fma_f32 v45, v45, s18, v95
    buffer_load_dwordx4 a[48:51], v5, s[8:11], s34 offen offset:2048 sc1
    v_fma_f32 v46, v46, s18, v95
    v_fma_f32 v47, v47, s18, v95
    v_exp_f32 v40, v40
    v_exp_f32 v41, v41
    v_exp_f32 v42, v42
    v_exp_f32 v43, v43
    v_exp_f32 v44, v44
    v_exp_f32 v45, v45
    v_exp_f32 v46, v46
    buffer_load_dwordx4 a[52:55], v253, s[8:11], s32 offen offset:3072 sc1
    s_add_u32 s32, s32, 4096
    v_exp_f32 v47, v47
    v_mfma_f32_16x16x32_bf16 v[108:111], v[176:179], v[84:87], 0
    v_mfma_f32_16x16x32_bf16 v[124:127], v[186:189], v[84:87], 0
    v_cvt_pk_bf16_f32 v88, v40, v41
    v_cvt_pk_bf16_f32 v89, v42, v43
    v_cvt_pk_bf16_f32 v90, v44, v45
    v_cvt_pk_bf16_f32 v91, v46, v47
    v_rcp_f32 v96, v118
    v_rcp_f32 v97, v122
    buffer_load_dwordx4 v[240:243], v9, s[8:11], s37 offen offset:0 sc1
    v_mfma_f32_16x16x32_bf16 v[112:115], v[178:181], v[88:91], 0
    v_mfma_f32_16x16x32_bf16 v[128:131], v[188:191], v[88:91], 0
    v_pk_mul_f32 v[100:101], v[96:97], v[100:101] op_sel:[0,0] op_sel_hi:[0,1]
    v_pk_mul_f32 v[102:103], v[96:97], v[102:103] op_sel:[0,0] op_sel_hi:[0,1]
    v_pk_mul_f32 v[116:117], v[96:97], v[116:117] op_sel:[0,0] op_sel_hi:[0,1]
    v_cvt_pk_bf16_f32 v212, v100, v101
    v_cvt_pk_bf16_f32 v213, v102, v103
    v_cvt_pk_bf16_f32 v220, v116, v117
    v_rcp_f32 v98, v126
    buffer_load_dwordx4 v[244:247], v9, s[8:11], s37 offen offset:1024 sc1
    v_pk_mul_f32 v[104:105], v[96:97], v[104:105] op_sel:[1,0] op_sel_hi:[1,1]
    v_pk_mul_f32 v[106:107], v[96:97], v[106:107] op_sel:[1,0] op_sel_hi:[1,1]
    v_pk_mul_f32 v[120:121], v[96:97], v[120:121] op_sel:[1,0] op_sel_hi:[1,1]
    v_cvt_pk_bf16_f32 v214, v104, v105
    v_cvt_pk_bf16_f32 v215, v106, v107
    v_cvt_pk_bf16_f32 v221, v120, v121
    v_rcp_f32 v99, v130
    v_permlane16_swap_b32 v212, v214
    v_permlane16_swap_b32 v213, v215
    buffer_load_dwordx4 v[248:251], v7, s[8:11], s37 offen offset:2048 sc1
    v_pk_mul_f32 v[108:109], v[98:99], v[108:109] op_sel:[0,0] op_sel_hi:[0,1]
    v_pk_mul_f32 v[110:111], v[98:99], v[110:111] op_sel:[0,0] op_sel_hi:[0,1]
    v_pk_mul_f32 v[124:125], v[98:99], v[124:125] op_sel:[0,0] op_sel_hi:[0,1]
    v_cvt_pk_bf16_f32 v216, v108, v109
    v_cvt_pk_bf16_f32 v217, v110, v111
    v_cvt_pk_bf16_f32 v222, v124, v125
    v_pk_mul_f32 v[112:113], v[98:99], v[112:113] op_sel:[1,0] op_sel_hi:[1,1]
    v_pk_mul_f32 v[114:115], v[98:99], v[114:115] op_sel:[1,0] op_sel_hi:[1,1]
    v_pk_mul_f32 v[128:129], v[98:99], v[128:129] op_sel:[1,0] op_sel_hi:[1,1]
    buffer_load_dword v252, v8, s[8:11], s47 offen sc1
    v_cvt_pk_bf16_f32 v218, v112, v113
    v_cvt_pk_bf16_f32 v219, v114, v115
    v_cvt_pk_bf16_f32 v223, v128, v129
    s_lshl_b32 s7, s3, 2
    s_add_u32 s7, s7, 94208
    v_permlane16_swap_b32 v220, v221
    v_permlane16_swap_b32 v222, v223
    v_add_u32 v11, s7, v253
    v_lshrrev_b32 v10, 3, v0
    v_permlane32_swap_b32 v220, v222
    v_mul_u32_u24 v10, 9216, v10
    ds_write_b32 v11, v220
    v_permlane16_swap_b32 v216, v218
    v_permlane16_swap_b32 v217, v219
    s_mul_i32 s7, s40, 1152
    s_add_u32 s22, s22, s7
    s_add_u32 s22, s22, 41156608
    s_lshl_b32 s7, s3, 8
    s_add_u32 s23, s22, s7
    s_add_u32 s24, s23, 36864
    buffer_store_dwordx4 v[212:215], v9, s[8:11], s23 offen sc1
    buffer_store_dwordx4 v[216:219], v9, s[8:11], s24 offen sc1
    v_and_b32 v11, 7, v0
    v_lshl_add_u32 v10, v11, 4, v10
    s_cmp_eq_u32 s3, 3
    s_cselect_b32 s7, 0, 1073741824
    v_add_u32 v10, s7, v10
    v_add_u32 v11, 94208, v253
    s_waitcnt lgkmcnt(0)
    s_barrier
    ds_read_b128 v[220:223], v11
    s_waitcnt lgkmcnt(0)
    buffer_store_dwordx4 v[220:223], v10, s[8:11], s22 offen offset:1024 sc1
    v_lshlrev_b32 v15, 7, v0
    s_lshl_b32 s6, s40, 2
    s_add_u32 s6, s6, s44
    v_mov_b32 v1, s76
    s_mov_b64 vcc, 0xff
    s_waitcnt vmcnt(0)
    s_barrier
    s_cmp_lg_u32 s3, 0
    s_cbranch_scc1 L_pub_17
    s_mov_b64 exec, vcc
    buffer_store_dword v1, v15, s[8:11], s6 offen sc1
L_pub_17:
    s_mov_b64 exec, -1
    buffer_load_dwordx4 a[56:59], v253, s[8:11], s33 offen offset:3072 sc1
    s_add_u32 s33, s33, 4096
    buffer_load_dwordx4 a[60:63], v5, s[8:11], s34 offen offset:3072 sc1
    s_add_u32 s34, s34, 4096
    buffer_load_dwordx4 a[64:67], v253, s[8:11], s32 offen offset:0 sc1
    buffer_load_dwordx4 a[68:71], v253, s[8:11], s33 offen offset:0 sc1
    buffer_load_dwordx4 a[72:75], v5, s[8:11], s34 offen offset:0 sc1
    buffer_load_dwordx4 a[76:79], v253, s[8:11], s32 offen offset:1024 sc1
    buffer_load_dwordx4 a[80:83], v253, s[8:11], s33 offen offset:1024 sc1
    buffer_load_dwordx4 a[84:87], v5, s[8:11], s34 offen offset:1024 sc1
    s_cmp_lg_u32 s42, 0
    s_cbranch_scc1 L_swz_18
    s_cmp_eq_u32 s93, 2
    s_cselect_b32 s6, 2, 3
    s_mov_b32 s7, 512
    s_cmov_b32 s7, 2048
    v_lshrrev_b32 v14, 4, v0
    v_lshlrev_b32 v14, s6, v14
    v_bfe_u32 v15, v0, 2, 2
    v_add_u32 v14, v14, v15
    v_mul_u32_u24 v14, 128, v14
    v_and_b32 v15, 3, v0
    v_lshl_add_u32 v14, v15, 3, v14
    v_add_u32 v14, s79, v14
    v_add_u32 v15, s7, v14
    ds_read_b64_tr_b16 v[76:77], v14 offset:0
    ds_read_b64_tr_b16 v[78:79], v15 offset:0
    ds_read_b64_tr_b16 v[80:81], v14 offset:32
    ds_read_b64_tr_b16 v[82:83], v15 offset:32
    ds_read_b64_tr_b16 v[84:85], v14 offset:64
    ds_read_b64_tr_b16 v[86:87], v15 offset:64
    ds_read_b64_tr_b16 v[88:89], v14 offset:96
    ds_read_b64_tr_b16 v[90:91], v15 offset:96
    ds_read_b64_tr_b16 v[92:93], v14 offset:4096
    ds_read_b64_tr_b16 v[94:95], v15 offset:4096
    ds_read_b64_tr_b16 v[96:97], v14 offset:4128
    ds_read_b64_tr_b16 v[98:99], v15 offset:4128
    ds_read_b64_tr_b16 v[176:177], v14 offset:4160
    ds_read_b64_tr_b16 v[178:179], v15 offset:4160
    ds_read_b64_tr_b16 v[180:181], v14 offset:4192
    ds_read_b64_tr_b16 v[182:183], v15 offset:4192
    ds_read_b64_tr_b16 v[196:197], v14 offset:8192
    ds_read_b64_tr_b16 v[198:199], v15 offset:8192
    ds_read_b64_tr_b16 v[200:201], v14 offset:8224
    ds_read_b64_tr_b16 v[202:203], v15 offset:8224
    ds_read_b64_tr_b16 v[204:205], v14 offset:8256
    ds_read_b64_tr_b16 v[206:207], v15 offset:8256
    ds_read_b64_tr_b16 v[208:209], v14 offset:8288
    ds_read_b64_tr_b16 v[210:211], v15 offset:8288
    ds_read_b64_tr_b16 v[212:213], v14 offset:12288
    ds_read_b64_tr_b16 v[214:215], v15 offset:12288
    ds_read_b64_tr_b16 v[216:217], v14 offset:12320
    ds_read_b64_tr_b16 v[218:219], v15 offset:12320
    ds_read_b64_tr_b16 v[220:221], v14 offset:12352
    ds_read_b64_tr_b16 v[222:223], v15 offset:12352
    ds_read_b64_tr_b16 v[228:229], v14 offset:12384
    ds_read_b64_tr_b16 v[230:231], v15 offset:12384
    s_mul_i32 s68, s40, 1990656
    s_add_u32 s68, s68, 3145728
    s_cmp_eq_u32 s93, 2
    s_cbranch_scc1 L_swz_down_19
    s_mul_i32 s6, s84, 349526
    s_lshr_b32 s6, s6, 20
    s_mul_i32 s7, s6, 3
    s_sub_u32 s7, s84, s7
    s_mul_i32 s6, s6, 6
    s_add_u32 s7, s7, s6
    s_mul_i32 s6, s88, 36
    s_add_u32 s7, s7, s6
    s_mul_i32 s6, s93, 3
    s_add_u32 s7, s7, s6
    s_lshl_b32 s7, s7, 10
    s_add_u32 s7, s7, s68
    s_add_u32 s80, s7, 0
    s_add_u32 s81, s7, 497664
    s_add_u32 s82, s7, 995328
    s_add_u32 s83, s7, 1492992
    s_mul_i32 s6, s85, 349526
    s_lshr_b32 s6, s6, 20
    s_mul_i32 s7, s6, 3
    s_sub_u32 s7, s85, s7
    s_mul_i32 s6, s6, 6
    s_add_u32 s7, s7, s6
    s_mul_i32 s6, s89, 36
    s_add_u32 s7, s7, s6
    s_mul_i32 s6, s93, 3
    s_add_u32 s7, s7, s6
    s_lshl_b32 s7, s7, 10
    s_add_u32 s7, s7, s68
    s_add_u32 s64, s7, 0
    s_add_u32 s65, s7, 497664
    s_add_u32 s18, s7, 995328
    s_add_u32 s19, s7, 1492992
    s_mul_i32 s6, s86, 349526
    s_lshr_b32 s6, s6, 20
    s_mul_i32 s7, s6, 3
    s_sub_u32 s7, s86, s7
    s_mul_i32 s6, s6, 6
    s_add_u32 s7, s7, s6
    s_mul_i32 s6, s90, 36
    s_add_u32 s7, s7, s6
    s_mul_i32 s6, s93, 3
    s_add_u32 s7, s7, s6
    s_lshl_b32 s7, s7, 10
    s_add_u32 s7, s7, s68
    s_add_u32 s20, s7, 0
    s_add_u32 s21, s7, 497664
    s_add_u32 s22, s7, 995328
    s_add_u32 s25, s7, 1492992
    s_mul_i32 s6, s87, 349526
    s_lshr_b32 s6, s6, 20
    s_mul_i32 s7, s6, 3
    s_sub_u32 s7, s87, s7
    s_mul_i32 s6, s6, 6
    s_add_u32 s7, s7, s6
    s_mul_i32 s6, s91, 36
    s_add_u32 s7, s7, s6
    s_mul_i32 s6, s93, 3
    s_add_u32 s7, s7, s6
    s_lshl_b32 s7, s7, 10
    s_add_u32 s7, s7, s68
    s_add_u32 s26, s7, 0
    s_add_u32 s27, s7, 497664
    s_add_u32 s28, s7, 995328
    s_add_u32 s29, s7, 1492992
    s_branch L_swz_dest_20
L_swz_down_19:
    s_mul_i32 s7, s88, 18
    s_add_u32 s7, s7, s84
    s_add_u32 s7, s7, 324
    s_lshl_b32 s7, s7, 10
    s_add_u32 s7, s7, s68
    s_add_u32 s80, s7, 0
    s_add_u32 s81, s7, 497664
    s_add_u32 s82, s7, 995328
    s_add_u32 s83, s7, 1492992
    s_mul_i32 s7, s89, 18
    s_add_u32 s7, s7, s85
    s_add_u32 s7, s7, 324
    s_lshl_b32 s7, s7, 10
    s_add_u32 s7, s7, s68
    s_add_u32 s64, s7, 0
    s_add_u32 s65, s7, 497664
    s_add_u32 s18, s7, 995328
    s_add_u32 s19, s7, 1492992
    s_mul_i32 s7, s90, 18
    s_add_u32 s7, s7, s86
    s_add_u32 s7, s7, 324
    s_lshl_b32 s7, s7, 10
    s_add_u32 s7, s7, s68
    s_add_u32 s20, s7, 0
    s_add_u32 s21, s7, 497664
    s_add_u32 s22, s7, 995328
    s_add_u32 s25, s7, 1492992
    s_mul_i32 s7, s91, 18
    s_add_u32 s7, s7, s87
    s_add_u32 s7, s7, 324
    s_lshl_b32 s7, s7, 10
    s_add_u32 s7, s7, s68
    s_add_u32 s26, s7, 0
    s_add_u32 s27, s7, 497664
    s_add_u32 s28, s7, 995328
    s_add_u32 s29, s7, 1492992
L_swz_dest_20:
    s_mov_b32 s72, s8
    s_mov_b32 s73, s9
    s_mov_b32 s74, 268435456
    s_waitcnt lgkmcnt(0)
    buffer_store_dwordx4 v[76:79], v253, s[72:75], s80 offen sc1
    buffer_store_dwordx4 v[80:83], v253, s[72:75], s81 offen sc1
    buffer_store_dwordx4 v[84:87], v253, s[72:75], s82 offen sc1
    buffer_store_dwordx4 v[88:91], v253, s[72:75], s83 offen sc1
    buffer_store_dwordx4 v[92:95], v253, s[72:75], s64 offen sc1
    buffer_store_dwordx4 v[96:99], v253, s[72:75], s65 offen sc1
    buffer_store_dwordx4 v[176:179], v253, s[72:75], s18 offen sc1
    buffer_store_dwordx4 v[180:183], v253, s[72:75], s19 offen sc1
    buffer_store_dwordx4 v[196:199], v253, s[72:75], s20 offen sc1
    buffer_store_dwordx4 v[200:203], v253, s[72:75], s21 offen sc1
    buffer_store_dwordx4 v[204:207], v253, s[72:75], s22 offen sc1
    buffer_store_dwordx4 v[208:211], v253, s[72:75], s25 offen sc1
    buffer_store_dwordx4 v[212:215], v253, s[72:75], s26 offen sc1
    buffer_store_dwordx4 v[216:219], v253, s[72:75], s27 offen sc1
    buffer_store_dwordx4 v[220:223], v253, s[72:75], s28 offen sc1
    buffer_store_dwordx4 v[228:231], v253, s[72:75], s29 offen sc1
    s_lshr_b32 s7, s2, 3
    s_lshl_b32 s7, s7, 2
    s_add_u32 s7, s7, s3
    s_lshl_b32 s7, s7, 9
    v_lshrrev_b32 v1, 1, v253
    v_add_u32 v1, s7, v1
    buffer_load_dwordx2 v[14:15], v1, s[96:99], 0 offen
L_swz_18:
    s_and_b32 s7, s3, 1
    s_mul_i32 s7, s7, 18432
    s_add_u32 s24, s30, s7
    s_lshr_b32 s7, s3, 1
    s_lshl_b32 s7, s7, 9
    s_add_u32 s24, s24, s7
    s_add_u32 s24, s24, 41156608
    s_mov_b32 s16, 0xffff0000
    v_lshlrev_b32 v124, 16, v240
    v_and_b32 v125, s16, v240
    v_lshlrev_b32 v126, 16, v241
    v_and_b32 v127, s16, v241
    v_lshlrev_b32 v128, 16, v242
    v_and_b32 v129, s16, v242
    v_lshlrev_b32 v130, 16, v243
    v_and_b32 v131, s16, v243
    v_lshlrev_b32 v132, 16, v244
    v_and_b32 v133, s16, v244
    v_lshlrev_b32 v134, 16, v245
    v_and_b32 v135, s16, v245
    v_lshlrev_b32 v136, 16, v246
    v_and_b32 v137, s16, v246
    v_lshlrev_b32 v138, 16, v247
    v_and_b32 v139, s16, v247
    v_lshlrev_b32 v140, 16, v248
    v_and_b32 v141, s16, v248
    v_lshlrev_b32 v142, 16, v249
    v_and_b32 v143, s16, v249
    v_lshlrev_b32 v144, 16, v250
    v_and_b32 v145, s16, v250
    v_lshlrev_b32 v146, 16, v251
    v_and_b32 v147, s16, v251
    s_cmp_eq_u32 s3, 1
    s_cselect_b32 s7, 16, 0
    v_lshlrev_b32 v12, 2, v0
    v_cmp_gt_u32 vcc, s7, v0
    v_add_u32 v10, 40960, v12
    v_add_u32 v11, 41472, v12
    v_cndmask_b32 v10, v11, v10, vcc
    v_and_b32 v11, 0x7c, v12
    v_cmp_gt_u32 vcc, 32, v0
    v_mov_b32 v13, 1073741824
    s_and_b32 s7, s40, 3
    s_lshl_b32 s45, s45, 2
    v_cndmask_b32 v8, v13, v12, vcc
    s_add_u32 s6, s7, s3
    s_cmp_eq_u32 s6, 0
    s_cselect_b32 s6, 0, 1073741824
    v_add_u32 v6, s6, v8
    s_add_u32 s45, s45, s7
    s_lshl_b32 s45, s45, 2
    s_add_u32 s45, s45, s3
    s_lshl_b32 s45, s45, 7
    s_add_u32 s45, s45, s43
    s_add_u32 s45, s45, 48300032
    s_cmp_eq_u32 s3, 0
    s_cselect_b32 s35, 1.0, 0
    s_lshl_b32 s7, s40, 2
    s_add_u32 s7, s7, s3
    s_mul_i32 s23, s7, 497664
    s_add_u32 s23, s23, 3145728
    s_add_u32 s50, s23, 497664
    s_mul_i32 s50, s50, s42
    v_mov_b32 v184, v253
    v_add_u32 v185, 4096, v253
    v_add_u32 v186, 8192, v253
    v_add_u32 v187, 12288, v253
    v_add_u32 v188, 16384, v253
    v_add_u32 v189, 20480, v253
    v_add_u32 v190, 24576, v253
    v_add_u32 v191, 28672, v253
    v_add_u32 v192, 32768, v253
    s_cmp_lg_u32 s3, 3
    s_cbranch_scc1 L_pollout_23
    s_lshl_b32 s7, s40, 7
    s_add_u32 s7, s7, s44
    s_add_u32 s52, s4, s7
    s_addc_u32 s53, s5, 0
    s_mov_b32 s6, 0
L_poll_21:
    s_load_dwordx8 s[56:63], s[52:53], 0 glc
    s_add_u32 s6, s6, 1
    s_waitcnt lgkmcnt(0)
    s_xor_b64 s[56:57], s[56:57], s[76:77]
    s_xor_b64 s[58:59], s[58:59], s[76:77]
    s_xor_b64 s[60:61], s[60:61], s[76:77]
    s_xor_b64 s[62:63], s[62:63], s[76:77]
    s_or_b64 s[56:57], s[56:57], s[58:59]
    s_or_b64 s[60:61], s[60:61], s[62:63]
    s_or_b64 s[56:57], s[56:57], s[60:61]
    s_cbranch_scc0 L_polled_22
    s_cmp_lt_u32 s6, 1048576
    s_cbranch_scc1 L_poll_21
    s_branch L_main_end
L_polled_22:
L_pollout_23:
    s_barrier
    s_lshl_b32 m0, s3, 10
    s_nop 0
    buffer_load_dwordx4 v2, s[8:11], s24 offen sc1 lds
    s_add_u32 m0, m0, 4096
    s_add_u32 s24, s24, 1024
    buffer_load_dwordx4 v2, s[8:11], s24 offen sc1 lds
    s_add_u32 m0, m0, 4096
    s_add_u32 s24, s24, 1024
    buffer_load_dwordx4 v2, s[8:11], s24 offen sc1 lds
    s_add_u32 m0, m0, 4096
    s_add_u32 s24, s24, 1024
    buffer_load_dwordx4 v2, s[8:11], s24 offen sc1 lds
    s_add_u32 m0, m0, 4096
    s_add_u32 s24, s24, 1024
    buffer_load_dwordx4 v2, s[8:11], s24 offen sc1 lds
    s_add_u32 m0, m0, 4096
    s_add_u32 s24, s24, 1024
    buffer_load_dwordx4 v2, s[8:11], s24 offen sc1 lds
    s_add_u32 m0, m0, 4096
    s_add_u32 s24, s24, 1024
    buffer_load_dwordx4 v2, s[8:11], s24 offen sc1 lds
    s_add_u32 m0, m0, 4096
    s_add_u32 s24, s24, 1024
    buffer_load_dwordx4 v2, s[8:11], s24 offen sc1 lds
    s_add_u32 m0, m0, 4096
    s_add_u32 s24, s24, 1024
    buffer_load_dwordx4 v2, s[8:11], s24 offen sc1 lds
    s_waitcnt vmcnt(4)
    s_barrier
    ds_read_b128 v[160:163], v253 offset:0
    ds_read_b128 v[164:167], v253 offset:1024
    s_waitcnt lgkmcnt(0)
    v_mfma_f32_16x16x32_bf16 v[100:103], a[160:163], v[160:163], 0
    ds_read_b128 v[168:171], v253 offset:2048
    v_mfma_f32_16x16x32_bf16 v[104:107], a[160:163], v[164:167], 0
    ds_read_b128 v[172:175], v253 offset:3072
    v_mfma_f32_16x16x32_bf16 v[108:111], a[164:167], v[160:163], 0
    v_mfma_f32_16x16x32_bf16 v[112:115], a[164:167], v[164:167], 0
    buffer_load_dwordx4 v[16:19], v184, s[48:51], s23 offen offset:0 sc1
    v_mfma_f32_16x16x32_bf16 v[116:119], a[168:171], v[160:163], 0
    v_mfma_f32_16x16x32_bf16 v[120:123], a[168:171], v[164:167], 0
    s_waitcnt lgkmcnt(0)
    v_mfma_f32_16x16x32_bf16 v[100:103], a[172:175], v[168:171], v[100:103]
    ds_read_b128 v[160:163], v253 offset:4096
    v_mfma_f32_16x16x32_bf16 v[104:107], a[172:175], v[172:175], v[104:107]
    ds_read_b128 v[164:167], v253 offset:5120
    v_mfma_f32_16x16x32_bf16 v[108:111], a[176:179], v[168:171], v[108:111]
    v_mfma_f32_16x16x32_bf16 v[112:115], a[176:179], v[172:175], v[112:115]
    buffer_load_dwordx4 v[20:23], v184, s[48:51], s23 offen offset:1024 sc1
    v_mfma_f32_16x16x32_bf16 v[116:119], a[180:183], v[168:171], v[116:119]
    v_mfma_f32_16x16x32_bf16 v[120:123], a[180:183], v[172:175], v[120:123]
    s_waitcnt lgkmcnt(0)
    v_mfma_f32_16x16x32_bf16 v[100:103], a[184:187], v[160:163], v[100:103]
    ds_read_b128 v[168:171], v253 offset:6144
    v_mfma_f32_16x16x32_bf16 v[104:107], a[184:187], v[164:167], v[104:107]
    ds_read_b128 v[172:175], v253 offset:7168
    v_mfma_f32_16x16x32_bf16 v[108:111], a[188:191], v[160:163], v[108:111]
    v_mfma_f32_16x16x32_bf16 v[112:115], a[188:191], v[164:167], v[112:115]
    buffer_load_dwordx4 v[24:27], v184, s[48:51], s23 offen offset:2048 sc1
    v_mfma_f32_16x16x32_bf16 v[116:119], a[192:195], v[160:163], v[116:119]
    v_mfma_f32_16x16x32_bf16 v[120:123], a[192:195], v[164:167], v[120:123]
    s_waitcnt lgkmcnt(0)
    v_mfma_f32_16x16x32_bf16 v[100:103], a[196:199], v[168:171], v[100:103]
    ds_read_b128 v[160:163], v253 offset:8192
    v_mfma_f32_16x16x32_bf16 v[104:107], a[196:199], v[172:175], v[104:107]
    ds_read_b128 v[164:167], v253 offset:9216
    v_mfma_f32_16x16x32_bf16 v[108:111], a[200:203], v[168:171], v[108:111]
    v_mfma_f32_16x16x32_bf16 v[112:115], a[200:203], v[172:175], v[112:115]
    buffer_load_dwordx4 v[28:31], v184, s[48:51], s23 offen offset:3072 sc1
    v_mfma_f32_16x16x32_bf16 v[116:119], a[204:207], v[168:171], v[116:119]
    v_mfma_f32_16x16x32_bf16 v[120:123], a[204:207], v[172:175], v[120:123]
    s_waitcnt lgkmcnt(0)
    v_mfma_f32_16x16x32_bf16 v[100:103], a[208:211], v[160:163], v[100:103]
    ds_read_b128 v[168:171], v253 offset:10240
    v_mfma_f32_16x16x32_bf16 v[104:107], a[208:211], v[164:167], v[104:107]
    ds_read_b128 v[172:175], v253 offset:11264
    v_mfma_f32_16x16x32_bf16 v[108:111], a[212:215], v[160:163], v[108:111]
    v_mfma_f32_16x16x32_bf16 v[112:115], a[212:215], v[164:167], v[112:115]
    buffer_load_dwordx4 v[32:35], v185, s[48:51], s23 offen offset:0 sc1
    v_mfma_f32_16x16x32_bf16 v[116:119], a[216:219], v[160:163], v[116:119]
    v_mfma_f32_16x16x32_bf16 v[120:123], a[216:219], v[164:167], v[120:123]
    s_waitcnt lgkmcnt(0)
    v_mfma_f32_16x16x32_bf16 v[100:103], a[220:223], v[168:171], v[100:103]
    ds_read_b128 v[160:163], v253 offset:12288
    v_mfma_f32_16x16x32_bf16 v[104:107], a[220:223], v[172:175], v[104:107]
    ds_read_b128 v[164:167], v253 offset:13312
    v_mfma_f32_16x16x32_bf16 v[108:111], a[224:227], v[168:171], v[108:111]
    v_mfma_f32_16x16x32_bf16 v[112:115], a[224:227], v[172:175], v[112:115]
    buffer_load_dwordx4 v[36:39], v185, s[48:51], s23 offen offset:1024 sc1
    v_mfma_f32_16x16x32_bf16 v[116:119], a[228:231], v[168:171], v[116:119]
    v_mfma_f32_16x16x32_bf16 v[120:123], a[228:231], v[172:175], v[120:123]
    s_waitcnt lgkmcnt(0)
    v_mfma_f32_16x16x32_bf16 v[100:103], a[232:235], v[160:163], v[100:103]
    ds_read_b128 v[168:171], v253 offset:14336
    v_mfma_f32_16x16x32_bf16 v[104:107], a[232:235], v[164:167], v[104:107]
    ds_read_b128 v[172:175], v253 offset:15360
    v_mfma_f32_16x16x32_bf16 v[108:111], a[236:239], v[160:163], v[108:111]
    v_mfma_f32_16x16x32_bf16 v[112:115], a[236:239], v[164:167], v[112:115]
    buffer_load_dwordx4 v[40:43], v185, s[48:51], s23 offen offset:2048 sc1
    v_mfma_f32_16x16x32_bf16 v[116:119], a[240:243], v[160:163], v[116:119]
    v_mfma_f32_16x16x32_bf16 v[120:123], a[240:243], v[164:167], v[120:123]
    s_waitcnt lgkmcnt(0)
    v_mfma_f32_16x16x32_bf16 v[100:103], a[244:247], v[168:171], v[100:103]
    ds_read_b128 v[160:163], v253 offset:16384
    v_mfma_f32_16x16x32_bf16 v[104:107], a[244:247], v[172:175], v[104:107]
    ds_read_b128 v[164:167], v253 offset:17408
    v_mfma_f32_16x16x32_bf16 v[108:111], a[248:251], v[168:171], v[108:111]
    v_mfma_f32_16x16x32_bf16 v[112:115], a[248:251], v[172:175], v[112:115]
    buffer_load_dwordx4 v[44:47], v185, s[48:51], s23 offen offset:3072 sc1
    v_mfma_f32_16x16x32_bf16 v[116:119], a[252:255], v[168:171], v[116:119]
    v_mfma_f32_16x16x32_bf16 v[120:123], a[252:255], v[172:175], v[120:123]
    s_waitcnt lgkmcnt(0)
    v_mfma_f32_16x16x32_bf16 v[100:103], a[128:131], v[160:163], v[100:103]
    ds_read_b128 v[168:171], v253 offset:18432
    v_mfma_f32_16x16x32_bf16 v[104:107], a[128:131], v[164:167], v[104:107]
    ds_read_b128 v[172:175], v253 offset:19456
    v_mfma_f32_16x16x32_bf16 v[108:111], a[132:135], v[160:163], v[108:111]
    v_mfma_f32_16x16x32_bf16 v[112:115], a[132:135], v[164:167], v[112:115]
    buffer_load_dwordx4 v[48:51], v186, s[48:51], s23 offen offset:0 sc1
    v_mfma_f32_16x16x32_bf16 v[116:119], a[136:139], v[160:163], v[116:119]
    v_mfma_f32_16x16x32_bf16 v[120:123], a[136:139], v[164:167], v[120:123]
    s_waitcnt vmcnt(9) lgkmcnt(0)
    s_barrier
    s_xor_b32 s7, s3, 0
    s_or_b32 s7, s7, s42
    s_cbranch_scc1 L_swz_24
    v_lshlrev_b32 v15, 10, v0
    s_lshl_b32 s6, s40, 7
    s_lshl_b32 s7, s41, 2
    s_add_u32 s6, s6, s7
    s_add_u32 s6, s6, 19464192
    s_mov_b64 exec, 0xffffffff
    v_lshlrev_b32 v15, 10, v0
    v_mov_b32 v1, s76
    buffer_store_dword v1, v15, s[8:11], s6 offen sc1
    s_mov_b64 exec, -1
L_swz_24:
    v_mfma_f32_16x16x32_bf16 v[100:103], a[140:143], v[168:171], v[100:103]
    ds_read_b128 v[160:163], v253 offset:20480
    v_mfma_f32_16x16x32_bf16 v[104:107], a[140:143], v[172:175], v[104:107]
    ds_read_b128 v[164:167], v253 offset:21504
    v_mfma_f32_16x16x32_bf16 v[108:111], a[144:147], v[168:171], v[108:111]
    v_mfma_f32_16x16x32_bf16 v[112:115], a[144:147], v[172:175], v[112:115]
    buffer_load_dwordx4 v[52:55], v186, s[48:51], s23 offen offset:1024 sc1
    v_mfma_f32_16x16x32_bf16 v[116:119], a[148:151], v[168:171], v[116:119]
    v_mfma_f32_16x16x32_bf16 v[120:123], a[148:151], v[172:175], v[120:123]
    s_waitcnt lgkmcnt(0)
    v_mfma_f32_16x16x32_bf16 v[100:103], a[152:155], v[160:163], v[100:103]
    ds_read_b128 v[168:171], v253 offset:22528
    v_mfma_f32_16x16x32_bf16 v[104:107], a[152:155], v[164:167], v[104:107]
    ds_read_b128 v[172:175], v253 offset:23552
    v_mfma_f32_16x16x32_bf16 v[108:111], a[156:159], v[160:163], v[108:111]
    v_mfma_f32_16x16x32_bf16 v[112:115], a[156:159], v[164:167], v[112:115]
    buffer_load_dwordx4 v[56:59], v186, s[48:51], s23 offen offset:2048 sc1
    v_mfma_f32_16x16x32_bf16 v[116:119], a[0:3], v[160:163], v[116:119]
    v_mfma_f32_16x16x32_bf16 v[120:123], a[0:3], v[164:167], v[120:123]
    s_waitcnt lgkmcnt(0)
    v_mfma_f32_16x16x32_bf16 v[100:103], a[4:7], v[168:171], v[100:103]
    ds_read_b128 v[160:163], v253 offset:24576
    v_mfma_f32_16x16x32_bf16 v[104:107], a[4:7], v[172:175], v[104:107]
    ds_read_b128 v[164:167], v253 offset:25600
    v_mfma_f32_16x16x32_bf16 v[108:111], a[8:11], v[168:171], v[108:111]
    v_mfma_f32_16x16x32_bf16 v[112:115], a[8:11], v[172:175], v[112:115]
    buffer_load_dwordx4 v[60:63], v186, s[48:51], s23 offen offset:3072 sc1
    v_mfma_f32_16x16x32_bf16 v[116:119], a[12:15], v[168:171], v[116:119]
    v_mfma_f32_16x16x32_bf16 v[120:123], a[12:15], v[172:175], v[120:123]
    s_waitcnt lgkmcnt(0)
    v_mfma_f32_16x16x32_bf16 v[100:103], a[16:19], v[160:163], v[100:103]
    ds_read_b128 v[168:171], v253 offset:26624
    v_mfma_f32_16x16x32_bf16 v[104:107], a[16:19], v[164:167], v[104:107]
    ds_read_b128 v[172:175], v253 offset:27648
    v_mfma_f32_16x16x32_bf16 v[108:111], a[20:23], v[160:163], v[108:111]
    v_mfma_f32_16x16x32_bf16 v[112:115], a[20:23], v[164:167], v[112:115]
    buffer_load_dwordx4 v[64:67], v187, s[48:51], s23 offen offset:0 sc1
    v_mfma_f32_16x16x32_bf16 v[116:119], a[24:27], v[160:163], v[116:119]
    v_mfma_f32_16x16x32_bf16 v[120:123], a[24:27], v[164:167], v[120:123]
    s_waitcnt lgkmcnt(0)
    v_mfma_f32_16x16x32_bf16 v[100:103], a[28:31], v[168:171], v[100:103]
    ds_read_b128 v[160:163], v253 offset:28672
    v_mfma_f32_16x16x32_bf16 v[104:107], a[28:31], v[172:175], v[104:107]
    ds_read_b128 v[164:167], v253 offset:29696
    v_mfma_f32_16x16x32_bf16 v[108:111], a[32:35], v[168:171], v[108:111]
    v_mfma_f32_16x16x32_bf16 v[112:115], a[32:35], v[172:175], v[112:115]
    buffer_load_dwordx4 v[68:71], v187, s[48:51], s23 offen offset:1024 sc1
    v_mfma_f32_16x16x32_bf16 v[116:119], a[36:39], v[168:171], v[116:119]
    v_mfma_f32_16x16x32_bf16 v[120:123], a[36:39], v[172:175], v[120:123]
    s_waitcnt lgkmcnt(0)
    v_mfma_f32_16x16x32_bf16 v[100:103], a[40:43], v[160:163], v[100:103]
    ds_read_b128 v[168:171], v253 offset:30720
    v_mfma_f32_16x16x32_bf16 v[104:107], a[40:43], v[164:167], v[104:107]
    ds_read_b128 v[172:175], v253 offset:31744
    v_mfma_f32_16x16x32_bf16 v[108:111], a[44:47], v[160:163], v[108:111]
    v_mfma_f32_16x16x32_bf16 v[112:115], a[44:47], v[164:167], v[112:115]
    buffer_load_dwordx4 v[72:75], v187, s[48:51], s23 offen offset:2048 sc1
    v_mfma_f32_16x16x32_bf16 v[116:119], a[48:51], v[160:163], v[116:119]
    v_mfma_f32_16x16x32_bf16 v[120:123], a[48:51], v[164:167], v[120:123]
    s_waitcnt lgkmcnt(0)
    v_mfma_f32_16x16x32_bf16 v[100:103], a[52:55], v[168:171], v[100:103]
    ds_read_b128 v[160:163], v253 offset:32768
    v_mfma_f32_16x16x32_bf16 v[104:107], a[52:55], v[172:175], v[104:107]
    ds_read_b128 v[164:167], v253 offset:33792
    v_mfma_f32_16x16x32_bf16 v[108:111], a[56:59], v[168:171], v[108:111]
    v_mfma_f32_16x16x32_bf16 v[112:115], a[56:59], v[172:175], v[112:115]
    v_mfma_f32_16x16x32_bf16 v[116:119], a[60:63], v[168:171], v[116:119]
    v_mfma_f32_16x16x32_bf16 v[120:123], a[60:63], v[172:175], v[120:123]
    s_waitcnt lgkmcnt(0)
    v_mfma_f32_16x16x32_bf16 v[100:103], a[64:67], v[160:163], v[100:103]
    ds_read_b128 v[168:171], v253 offset:34816
    v_mfma_f32_16x16x32_bf16 v[104:107], a[64:67], v[164:167], v[104:107]
    ds_read_b128 v[172:175], v253 offset:35840
    v_mfma_f32_16x16x32_bf16 v[108:111], a[68:71], v[160:163], v[108:111]
    v_mfma_f32_16x16x32_bf16 v[112:115], a[68:71], v[164:167], v[112:115]
    v_mfma_f32_16x16x32_bf16 v[116:119], a[72:75], v[160:163], v[116:119]
    v_mfma_f32_16x16x32_bf16 v[120:123], a[72:75], v[164:167], v[120:123]
    s_waitcnt lgkmcnt(0)
    v_mfma_f32_16x16x32_bf16 v[100:103], a[76:79], v[168:171], v[100:103]
    v_mfma_f32_16x16x32_bf16 v[104:107], a[76:79], v[172:175], v[104:107]
    v_mfma_f32_16x16x32_bf16 v[108:111], a[80:83], v[168:171], v[108:111]
    v_mfma_f32_16x16x32_bf16 v[112:115], a[80:83], v[172:175], v[112:115]
    v_mfma_f32_16x16x32_bf16 v[116:119], a[84:87], v[168:171], v[116:119]
    v_mfma_f32_16x16x32_bf16 v[120:123], a[84:87], v[172:175], v[120:123]
    s_nop 3
    v_permlane16_swap_b32 v100, v104
    v_permlane16_swap_b32 v101, v105
    v_permlane16_swap_b32 v102, v106
    v_permlane16_swap_b32 v103, v107
    v_add_f32 v12, v116, v117
    v_add_f32 v13, v120, v121
    ds_write_b32 v10, v12
    ds_write_b32 v10, v13 offset:64
    v_permlane16_swap_b32 v108, v112
    v_permlane16_swap_b32 v109, v113
    v_permlane16_swap_b32 v110, v114
    v_permlane16_swap_b32 v111, v115
    v_permlane16_swap_b32 v116, v120
    v_permlane16_swap_b32 v117, v121
    v_permlane16_swap_b32 v118, v122
    v_permlane16_swap_b32 v119, v123
    s_waitcnt lgkmcnt(0)
    s_barrier
    ds_read_b32 v12, v11 offset:40960
    v_pk_add_f32 v[124:125], v[124:125], v[100:101]
    v_pk_add_f32 v[126:127], v[126:127], v[102:103]
    v_pk_add_f32 v[128:129], v[128:129], v[104:105]
    v_pk_add_f32 v[130:131], v[130:131], v[106:107]
    v_pk_add_f32 v[132:133], v[132:133], v[108:109]
    v_pk_add_f32 v[134:135], v[134:135], v[110:111]
    v_pk_add_f32 v[136:137], v[136:137], v[112:113]
    v_pk_add_f32 v[138:139], v[138:139], v[114:115]
    v_pk_add_f32 v[140:141], v[140:141], v[116:117]
    v_pk_add_f32 v[142:143], v[142:143], v[118:119]
    v_pk_add_f32 v[144:145], v[144:145], v[120:121]
    v_pk_add_f32 v[146:147], v[146:147], v[122:123]
    v_mov_b32 v14, 0
    v_mov_b32 v15, 0
    s_waitcnt lgkmcnt(0)
    v_add_f32 v12, v12, v252
    v_pk_add_f32 v[100:101], v[124:125], v[12:13] op_sel_hi:[1,0] neg_lo:[0,1] neg_hi:[0,1]
    v_pk_add_f32 v[102:103], v[126:127], v[12:13] op_sel_hi:[1,0] neg_lo:[0,1] neg_hi:[0,1]
    v_pk_add_f32 v[104:105], v[128:129], v[12:13] op_sel_hi:[1,0] neg_lo:[0,1] neg_hi:[0,1]
    v_pk_add_f32 v[106:107], v[130:131], v[12:13] op_sel_hi:[1,0] neg_lo:[0,1] neg_hi:[0,1]
    v_cvt_pk_bf16_f32 v148, v100, v101
    v_cvt_pk_bf16_f32 v149, v102, v103
    v_cvt_pk_bf16_f32 v150, v104, v105
    v_cvt_pk_bf16_f32 v151, v106, v107
    buffer_store_dwordx4 v[148:151], v9, s[8:11], s46 offen offset:0 sc1
    v_pk_add_f32 v[108:109], v[132:133], v[12:13] op_sel_hi:[1,0] neg_lo:[0,1] neg_hi:[0,1]
    v_pk_add_f32 v[110:111], v[134:135], v[12:13] op_sel_hi:[1,0] neg_lo:[0,1] neg_hi:[0,1]
    v_pk_add_f32 v[112:113], v[136:137], v[12:13] op_sel_hi:[1,0] neg_lo:[0,1] neg_hi:[0,1]
    v_pk_add_f32 v[114:115], v[138:139], v[12:13] op_sel_hi:[1,0] neg_lo:[0,1] neg_hi:[0,1]
    v_cvt_pk_bf16_f32 v152, v108, v109
    v_cvt_pk_bf16_f32 v153, v110, v111
    v_cvt_pk_bf16_f32 v154, v112, v113
    v_cvt_pk_bf16_f32 v155, v114, v115
    buffer_store_dwordx4 v[152:155], v9, s[8:11], s46 offen offset:1024 sc1
    v_pk_add_f32 v[116:117], v[140:141], v[12:13] op_sel_hi:[1,0] neg_lo:[0,1] neg_hi:[0,1]
    v_pk_add_f32 v[118:119], v[142:143], v[12:13] op_sel_hi:[1,0] neg_lo:[0,1] neg_hi:[0,1]
    v_pk_add_f32 v[120:121], v[144:145], v[12:13] op_sel_hi:[1,0] neg_lo:[0,1] neg_hi:[0,1]
    v_pk_add_f32 v[122:123], v[146:147], v[12:13] op_sel_hi:[1,0] neg_lo:[0,1] neg_hi:[0,1]
    v_cvt_pk_bf16_f32 v156, v116, v117
    v_cvt_pk_bf16_f32 v157, v118, v119
    v_cvt_pk_bf16_f32 v158, v120, v121
    v_cvt_pk_bf16_f32 v159, v122, v123
    buffer_store_dwordx4 v[156:159], v7, s[8:11], s46 offen offset:2048 sc1
    v_dot2c_f32_bf16 v14, v148, v148
    v_dot2c_f32_bf16 v14, v149, v149
    v_dot2c_f32_bf16 v14, v150, v150
    v_dot2c_f32_bf16 v14, v151, v151
    v_dot2c_f32_bf16 v14, v152, v152
    v_dot2c_f32_bf16 v14, v153, v153
    v_dot2c_f32_bf16 v14, v154, v154
    v_dot2c_f32_bf16 v14, v155, v155
    v_dot2c_f32_bf16 v15, v156, v156
    v_dot2c_f32_bf16 v15, v157, v157
    v_dot2c_f32_bf16 v15, v158, v158
    v_dot2c_f32_bf16 v15, v159, v159
    buffer_store_dword v12, v6, s[8:11], s36 offen sc1
    s_nop 1
    v_fma_f32 v14, v15, s35, v14
    v_mov_b32 v15, v14
    s_nop 1
    v_permlane32_swap_b32 v14, v15
    v_add_f32 v14, v14, v15
    buffer_store_dword v14, v8, s[8:11], s45 offen sc1
    v_lshlrev_b32 v15, 7, v0
    s_lshl_b32 s6, s40, 2
    s_add_u32 s6, s6, s44
    s_add_u32 s6, s6, 32768
    v_mov_b32 v1, s76
    s_mov_b64 vcc, 0xff
    s_waitcnt vmcnt(0)
    s_barrier
    s_cmp_lg_u32 s3, 0
    s_cbranch_scc1 L_pub_25
    s_mov_b64 exec, vcc
    buffer_store_dword v1, v15, s[8:11], s6 offen sc1
L_pub_25:
    s_mov_b64 exec, -1
    s_lshl_b32 s7, s41, 2
    s_add_u32 s7, s7, s3
    s_mul_i32 s22, s7, 18432
    s_add_u32 s22, s22, s43
    s_add_u32 s22, s22, 45875200
    s_mul_i32 s24, s3, 18432
    s_lshl_b32 s25, s41, 12
    s_add_u32 s25, s25, s43
    s_add_u32 s25, s25, 48300032
    v_lshrrev_b32 v3, 5, v0
    v_and_b32 v10, 31, v0
    v_lshlrev_b32 v10, 2, v10
    v_lshl_add_u32 v3, v3, 11, v10
    v_add_u32 v11, 36864, v184
    s_mov_b32 s16, 0xffff0000
    s_lshl_b32 s7, s3, 10
    v_add_u32 v172, s7, v253
    v_add_u32 v174, 5120, v172
    v_and_b32 v178, 7, v0
    v_mul_u32_u24 v178, 1152, v178
    v_lshrrev_b32 v179, 3, v0
    v_lshl_add_u32 v178, v179, 4, v178
    s_lshl_b32 s7, s3, 7
    v_add_u32 v175, s7, v178
    v_add_u32 v177, 640, v175
    s_cmp_eq_u32 s3, 0
    s_mov_b32 s17, 1073741824
    s_cmov_b32 s17, 4096
    v_add_u32 v173, s17, v172
    s_mov_b32 s17, 1073741824
    s_cmov_b32 s17, 512
    v_add_u32 v176, s17, v175
    s_lshl_b32 s21, s41, 3
    s_add_u32 s21, s21, s40
    s_mul_i32 s18, s21, 9216
    s_mul_i32 s20, s21, 73728
    s_add_u32 s20, s20, 19922944
    v_bfe_u32 v1, v0, 3, 2
    s_mov_b32 s7, 73728
    v_mul_lo_u32 v178, v1, s7
    v_lshrrev_b32 v1, 5, v0
    v_lshl_add_u32 v178, v1, 7, v178
    v_and_b32 v1, 7, v0
    v_lshl_add_u32 v178, v1, 4, v178
    v_add_u32 v179, 294912, v178
    v_lshrrev_b32 v1, 5, v0
    v_and_b32 v15, 7, v0
    v_lshlrev_b32 v15, 4, v15
    v_lshl_add_u32 v15, v1, 7, v15
    s_lshl_b32 s7, s3, 8
    s_add_u32 s7, s7, 3072
    v_add_u32 v15, s7, v15
    v_bfe_u32 v1, v0, 3, 2
    v_mov_b32 v182, 1073741824
    v_add_u32 v183, 14336, v253
    s_sub_u32 s7, s40, 0
    v_cmp_eq_u32 vcc, s7, v1
    s_nop 1
    v_cndmask_b32 v178, v178, v182, vcc
    v_cndmask_b32 v216, v183, v15, vcc
    v_cndmask_b32 v218, 0, 1, vcc
    v_lshlrev_b32 v218, 10, v218
    s_sub_u32 s7, s40, 4
    v_cmp_eq_u32 vcc, s7, v1
    s_nop 1
    v_cndmask_b32 v179, v179, v182, vcc
    v_cndmask_b32 v217, v183, v15, vcc
    v_cndmask_b32 v219, 0, 1, vcc
    v_lshlrev_b32 v219, 10, v219
    s_mul_i32 s26, s41, 589824
    s_mul_i32 s7, s40, 9216
    s_add_u32 s26, s26, s7
    s_lshl_b32 s7, s3, 8
    s_add_u32 s27, s26, s7
    s_add_u32 s27, s27, 19921920
    s_mov_b32 s74, 0
    s_mul_i32 s7, s42, 98304
    s_sub_u32 s29, s44, s7
    s_add_u32 s29, s29, 360448
    s_lshl_b32 s7, s40, 7
    s_add_u32 s7, s7, s29
    s_add_u32 s38, s4, s7
    s_addc_u32 s39, s5, 0
    s_lshl_b32 s7, s40, 2
    s_add_u32 s29, s29, s7
    s_add_u32 s50, s23, 497664
    s_cmp_lg_u32 s42, 0
    s_cbranch_scc1 L_ring_26
    s_cmp_lg_u32 s3, 0
    s_cbranch_scc1 L_ring_27
    s_lshl_b32 s7, s41, 3
    s_add_u32 s7, s7, s40
    s_lshl_b32 s7, s7, 7
    s_add_u32 s7, s7, 19464192
    s_add_u32 s68, s4, s7
    s_addc_u32 s69, s5, 0
    s_mov_b32 s6, 0
    s_mov_b32 s7, 0
L_cpoll_28:
    s_load_dwordx16 s[52:67], s[68:69], s7 glc
    s_add_u32 s6, s6, 1
    s_waitcnt lgkmcnt(0)
    s_xor_b64 s[52:53], s[52:53], s[76:77]
    s_xor_b64 s[54:55], s[54:55], s[76:77]
    s_xor_b64 s[56:57], s[56:57], s[76:77]
    s_xor_b64 s[58:59], s[58:59], s[76:77]
    s_xor_b64 s[60:61], s[60:61], s[76:77]
    s_xor_b64 s[62:63], s[62:63], s[76:77]
    s_xor_b64 s[64:65], s[64:65], s[76:77]
    s_xor_b64 s[66:67], s[66:67], s[76:77]
    s_or_b64 s[52:53], s[52:53], s[60:61]
    s_or_b64 s[54:55], s[54:55], s[62:63]
    s_or_b64 s[56:57], s[56:57], s[64:65]
    s_or_b64 s[58:59], s[58:59], s[66:67]
    s_or_b64 s[52:53], s[52:53], s[56:57]
    s_or_b64 s[54:55], s[54:55], s[58:59]
    s_or_b64 s[52:53], s[52:53], s[54:55]
    s_cbranch_scc1 L_cpoll_29
    s_add_u32 s7, s7, 64
    s_cmp_eq_u32 s7, 128
    s_cbranch_scc1 L_cpolled_30
L_cpoll_29:
    s_cmp_lt_u32 s6, 1048576
    s_cbranch_scc1 L_cpoll_28
    s_branch L_main_end
L_cpolled_30:
L_ring_27:
    s_barrier
    buffer_load_dwordx4 v[16:19], v184, s[48:51], s23 offen offset:0 sc1
    buffer_load_dwordx4 v[20:23], v184, s[48:51], s23 offen offset:1024 sc1
    buffer_load_dwordx4 v[24:27], v184, s[48:51], s23 offen offset:2048 sc1
    buffer_load_dwordx4 v[28:31], v184, s[48:51], s23 offen offset:3072 sc1
    buffer_load_dwordx4 v[32:35], v185, s[48:51], s23 offen offset:0 sc1
    buffer_load_dwordx4 v[36:39], v185, s[48:51], s23 offen offset:1024 sc1
    buffer_load_dwordx4 v[40:43], v185, s[48:51], s23 offen offset:2048 sc1
    buffer_load_dwordx4 v[44:47], v185, s[48:51], s23 offen offset:3072 sc1
    buffer_load_dwordx4 v[48:51], v186, s[48:51], s23 offen offset:0 sc1
    buffer_load_dwordx4 v[52:55], v186, s[48:51], s23 offen offset:1024 sc1
    buffer_load_dwordx4 v[56:59], v186, s[48:51], s23 offen offset:2048 sc1
    buffer_load_dwordx4 v[60:63], v186, s[48:51], s23 offen offset:3072 sc1
    buffer_load_dwordx4 v[64:67], v187, s[48:51], s23 offen offset:0 sc1
    buffer_load_dwordx4 v[68:71], v187, s[48:51], s23 offen offset:1024 sc1
    buffer_load_dwordx4 v[72:75], v187, s[48:51], s23 offen offset:2048 sc1
L_ring_26:
    s_cmp_lg_u32 s3, 3
    s_cbranch_scc1 L_pollout_33
    s_lshl_b32 s7, s40, 7
    s_add_u32 s7, s7, s44
    s_add_u32 s7, s7, 32768
    s_add_u32 s52, s4, s7
    s_addc_u32 s53, s5, 0
    s_mov_b32 s6, 0
L_poll_31:
    s_load_dwordx8 s[56:63], s[52:53], 0 glc
    s_add_u32 s6, s6, 1
    s_waitcnt lgkmcnt(0)
    s_xor_b64 s[56:57], s[56:57], s[76:77]
    s_xor_b64 s[58:59], s[58:59], s[76:77]
    s_xor_b64 s[60:61], s[60:61], s[76:77]
    s_xor_b64 s[62:63], s[62:63], s[76:77]
    s_or_b64 s[56:57], s[56:57], s[58:59]
    s_or_b64 s[60:61], s[60:61], s[62:63]
    s_or_b64 s[56:57], s[56:57], s[60:61]
    s_cbranch_scc0 L_polled_32
    s_cmp_lt_u32 s6, 1048576
    s_cbranch_scc1 L_poll_31
    s_branch L_main_end
L_polled_32:
L_pollout_33:
    s_barrier
    s_add_u32 m0, s24, 0
    s_nop 0
    buffer_load_dwordx4 v2, s[8:11], s22 offen offset:0 sc1 lds
    s_add_u32 m0, s24, 512
    s_nop 0
    buffer_load_dwordx4 v2, s[8:11], s22 offen offset:512 sc1 lds
    s_add_u32 m0, s24, 1024
    s_nop 0
    buffer_load_dwordx4 v2, s[8:11], s22 offen offset:1024 sc1 lds
    s_add_u32 m0, s24, 1536
    s_nop 0
    buffer_load_dwordx4 v2, s[8:11], s22 offen offset:1536 sc1 lds
    s_add_u32 m0, s24, 2048
    s_nop 0
    buffer_load_dwordx4 v2, s[8:11], s22 offen offset:2048 sc1 lds
    s_add_u32 m0, s24, 2560
    s_nop 0
    buffer_load_dwordx4 v2, s[8:11], s22 offen offset:2560 sc1 lds
    s_add_u32 m0, s24, 3072
    s_nop 0
    buffer_load_dwordx4 v2, s[8:11], s22 offen offset:3072 sc1 lds
    s_add_u32 m0, s24, 3584
    s_nop 0
    buffer_load_dwordx4 v2, s[8:11], s22 offen offset:3584 sc1 lds
    s_add_u32 m0, s24, 8192
    s_add_u32 s22, s22, 4096
    buffer_load_dwordx4 v2, s[8:11], s22 offen offset:0 sc1 lds
    s_add_u32 m0, s24, 8704
    s_nop 0
    buffer_load_dwordx4 v2, s[8:11], s22 offen offset:512 sc1 lds
    s_add_u32 m0, s24, 9216
    s_nop 0
    buffer_load_dwordx4 v2, s[8:11], s22 offen offset:1024 sc1 lds
    s_add_u32 m0, s24, 9728
    s_nop 0
    buffer_load_dwordx4 v2, s[8:11], s22 offen offset:1536 sc1 lds
    s_add_u32 s23, s23, 15360
    s_lshr_b32 s7, s3, 1
    s_lshl_b32 s7, s7, 10
    s_and_b32 s6, s3, 1
    s_lshl_b32 s6, s6, 3
    s_add_u32 s28, s7, s6
    s_add_u32 s28, s28, 73728
    s_waitcnt vmcnt(6)
    s_barrier
    ds_read_b128 a[0:3], v184 offset:0
    ds_read_b128 a[72:75], v184 offset:18432
    ds_read_b128 a[144:147], v11 offset:0
    ds_read_b128 a[216:219], v11 offset:18432
    ds_read_b128 a[4:7], v184 offset:1024
    ds_read_b128 a[76:79], v184 offset:19456
    ds_read_b128 a[148:151], v11 offset:1024
    ds_read_b128 a[220:223], v11 offset:19456
    ds_read_b128 a[8:11], v184 offset:2048
    ds_read_b128 a[80:83], v184 offset:20480
    ds_read_b128 a[152:155], v11 offset:2048
    ds_read_b128 a[224:227], v11 offset:20480
    s_waitcnt vmcnt(24) lgkmcnt(0)
    v_mfma_f32_16x16x32_bf16 v[88:91], v[16:19], a[0:3], 0
    ds_read_b128 a[12:15], v184 offset:3072
    v_mfma_f32_16x16x32_bf16 v[88:91], v[20:23], a[4:7], v[88:91]
    buffer_load_dwordx4 v[76:79], v184, s[48:51], s23 offen offset:0 sc1
    v_mfma_f32_16x16x32_bf16 v[88:91], v[24:27], a[8:11], v[88:91]
    ds_read_b128 a[84:87], v184 offset:21504
    v_mfma_f32_16x16x32_bf16 v[92:95], v[16:19], a[72:75], 0
    s_add_u32 m0, s24, 10240
    s_nop 0
    buffer_load_dwordx4 v2, s[8:11], s22 offen offset:2048 sc1 lds
    v_mfma_f32_16x16x32_bf16 v[92:95], v[20:23], a[76:79], v[92:95]
    ds_read_b128 a[156:159], v11 offset:3072
    ds_read_b128 a[228:231], v11 offset:21504
    v_mfma_f32_16x16x32_bf16 v[92:95], v[24:27], a[80:83], v[92:95]
    buffer_load_dwordx4 v[80:83], v184, s[48:51], s23 offen offset:1024 sc1
    v_mfma_f32_16x16x32_bf16 v[96:99], v[16:19], a[144:147], 0
    ds_read_b128 a[16:19], v184 offset:4096
    v_mfma_f32_16x16x32_bf16 v[96:99], v[20:23], a[148:151], v[96:99]
    s_add_u32 m0, s24, 10752
    s_nop 0
    buffer_load_dwordx4 v2, s[8:11], s22 offen offset:2560 sc1 lds
    v_mfma_f32_16x16x32_bf16 v[96:99], v[24:27], a[152:155], v[96:99]
    ds_read_b128 a[88:91], v184 offset:22528
    v_mfma_f32_16x16x32_bf16 v[100:103], v[16:19], a[216:219], 0
    buffer_load_dwordx4 v[84:87], v184, s[48:51], s23 offen offset:2048 sc1
    v_mfma_f32_16x16x32_bf16 v[100:103], v[20:23], a[220:223], v[100:103]
    ds_read_b128 a[160:163], v11 offset:4096
    ds_read_b128 a[232:235], v11 offset:22528
    v_mfma_f32_16x16x32_bf16 v[100:103], v[24:27], a[224:227], v[100:103]
    s_add_u32 m0, s24, 11264
    s_nop 0
    buffer_load_dwordx4 v2, s[8:11], s22 offen offset:3072 sc1 lds
    s_waitcnt vmcnt(27) lgkmcnt(8)
    v_mfma_f32_16x16x32_bf16 v[104:107], v[28:31], a[0:3], 0
    ds_read_b128 a[20:23], v184 offset:5120
    v_mfma_f32_16x16x32_bf16 v[104:107], v[32:35], a[4:7], v[104:107]
    buffer_load_dwordx4 v[16:19], v184, s[48:51], s23 offen offset:3072 sc1
    v_mfma_f32_16x16x32_bf16 v[104:107], v[36:39], a[8:11], v[104:107]
    ds_read_b128 a[92:95], v184 offset:23552
    v_mfma_f32_16x16x32_bf16 v[108:111], v[28:31], a[72:75], 0
    s_add_u32 m0, s24, 11776
    s_nop 0
    buffer_load_dwordx4 v2, s[8:11], s22 offen offset:3584 sc1 lds
    v_mfma_f32_16x16x32_bf16 v[108:111], v[32:35], a[76:79], v[108:111]
    ds_read_b128 a[164:167], v11 offset:5120
    ds_read_b128 a[236:239], v11 offset:23552
    v_mfma_f32_16x16x32_bf16 v[108:111], v[36:39], a[80:83], v[108:111]
    buffer_load_dwordx4 v[20:23], v185, s[48:51], s23 offen offset:0 sc1
    v_mfma_f32_16x16x32_bf16 v[112:115], v[28:31], a[144:147], 0
    v_mfma_f32_16x16x32_bf16 v[112:115], v[32:35], a[148:151], v[112:115]
    s_add_u32 m0, s24, 16384
    s_add_u32 s22, s22, 4096
    buffer_load_dwordx4 v2, s[8:11], s22 offen offset:0 sc1 lds
    v_mfma_f32_16x16x32_bf16 v[112:115], v[36:39], a[152:155], v[112:115]
    v_mfma_f32_16x16x32_bf16 v[116:119], v[28:31], a[216:219], 0
    buffer_load_dwordx4 v[24:27], v185, s[48:51], s23 offen offset:1024 sc1
    v_mfma_f32_16x16x32_bf16 v[116:119], v[32:35], a[220:223], v[116:119]
    v_mfma_f32_16x16x32_bf16 v[116:119], v[36:39], a[224:227], v[116:119]
    s_add_u32 m0, s24, 16896
    s_nop 0
    buffer_load_dwordx4 v2, s[8:11], s22 offen offset:512 sc1 lds
    s_waitcnt vmcnt(12) lgkmcnt(0)
    s_barrier
    v_mfma_f32_16x16x32_bf16 v[88:91], v[40:43], a[12:15], v[88:91]
    ds_read_b128 a[24:27], v184 offset:6144
    v_mfma_f32_16x16x32_bf16 v[88:91], v[44:47], a[16:19], v[88:91]
    buffer_load_dwordx4 v[28:31], v185, s[48:51], s23 offen offset:2048 sc1
    v_mfma_f32_16x16x32_bf16 v[88:91], v[48:51], a[20:23], v[88:91]
    ds_read_b128 a[96:99], v184 offset:24576
    v_mfma_f32_16x16x32_bf16 v[92:95], v[40:43], a[84:87], v[92:95]
    buffer_load_dword v136, v3, s[8:11], s25 offen offset:0 sc1
    v_mfma_f32_16x16x32_bf16 v[92:95], v[44:47], a[88:91], v[92:95]
    ds_read_b128 a[168:171], v11 offset:6144
    ds_read_b128 a[240:243], v11 offset:24576
    v_mfma_f32_16x16x32_bf16 v[92:95], v[48:51], a[92:95], v[92:95]
    buffer_load_dwordx4 v[32:35], v185, s[48:51], s23 offen offset:3072 sc1
    v_mfma_f32_16x16x32_bf16 v[96:99], v[40:43], a[156:159], v[96:99]
    buffer_load_dword v137, v3, s[8:11], s25 offen offset:128 sc1
    v_mfma_f32_16x16x32_bf16 v[96:99], v[44:47], a[160:163], v[96:99]
    buffer_load_dword v138, v3, s[8:11], s25 offen offset:256 sc1
    v_mfma_f32_16x16x32_bf16 v[96:99], v[48:51], a[164:167], v[96:99]
    ds_read_b128 a[28:31], v184 offset:7168
    ds_read_b128 a[100:103], v184 offset:25600
    v_mfma_f32_16x16x32_bf16 v[100:103], v[40:43], a[228:231], v[100:103]
    buffer_load_dwordx4 v[36:39], v186, s[48:51], s23 offen offset:0 sc1
    v_mfma_f32_16x16x32_bf16 v[100:103], v[44:47], a[232:235], v[100:103]
    buffer_load_dword v139, v3, s[8:11], s25 offen offset:384 sc1
    v_mfma_f32_16x16x32_bf16 v[100:103], v[48:51], a[236:239], v[100:103]
    buffer_load_dword v140, v3, s[8:11], s25 offen offset:512 sc1
    s_waitcnt vmcnt(35) lgkmcnt(6)
    v_mfma_f32_16x16x32_bf16 v[104:107], v[52:55], a[12:15], v[104:107]
    ds_read_b128 a[172:175], v11 offset:7168
    ds_read_b128 a[244:247], v11 offset:25600
    v_mfma_f32_16x16x32_bf16 v[104:107], v[56:59], a[16:19], v[104:107]
    buffer_load_dwordx4 v[40:43], v186, s[48:51], s23 offen offset:1024 sc1
    v_mfma_f32_16x16x32_bf16 v[104:107], v[60:63], a[20:23], v[104:107]
    ds_read_b128 a[32:35], v184 offset:8192
    ds_read_b128 a[104:107], v184 offset:26624
    v_mfma_f32_16x16x32_bf16 v[108:111], v[52:55], a[84:87], v[108:111]
    buffer_load_dword v141, v3, s[8:11], s25 offen offset:640 sc1
    v_mfma_f32_16x16x32_bf16 v[108:111], v[56:59], a[88:91], v[108:111]
    ds_read_b128 a[176:179], v11 offset:8192
    ds_read_b128 a[248:251], v11 offset:26624
    v_mfma_f32_16x16x32_bf16 v[108:111], v[60:63], a[92:95], v[108:111]
    buffer_load_dwordx4 v[44:47], v186, s[48:51], s23 offen offset:2048 sc1
    v_mfma_f32_16x16x32_bf16 v[112:115], v[52:55], a[156:159], v[112:115]
    buffer_load_dword v142, v3, s[8:11], s25 offen offset:768 sc1
    v_mfma_f32_16x16x32_bf16 v[112:115], v[56:59], a[160:163], v[112:115]
    buffer_load_dword v143, v3, s[8:11], s25 offen offset:896 sc1
    v_mfma_f32_16x16x32_bf16 v[112:115], v[60:63], a[164:167], v[112:115]
    v_mfma_f32_16x16x32_bf16 v[116:119], v[52:55], a[228:231], v[116:119]
    buffer_load_dwordx4 v[48:51], v186, s[48:51], s23 offen offset:3072 sc1
    v_mfma_f32_16x16x32_bf16 v[116:119], v[56:59], a[232:235], v[116:119]
    buffer_load_dword v144, v3, s[8:11], s25 offen offset:1024 sc1
    v_mfma_f32_16x16x32_bf16 v[116:119], v[60:63], a[236:239], v[116:119]
    buffer_load_dword v145, v3, s[8:11], s25 offen offset:1152 sc1
    s_waitcnt vmcnt(40) lgkmcnt(0)
    v_mfma_f32_16x16x32_bf16 v[88:91], v[64:67], a[24:27], v[88:91]
    ds_read_b128 a[36:39], v184 offset:9216
    v_mfma_f32_16x16x32_bf16 v[88:91], v[68:71], a[28:31], v[88:91]
    buffer_load_dwordx4 v[52:55], v187, s[48:51], s23 offen offset:0 sc1
    v_mfma_f32_16x16x32_bf16 v[88:91], v[72:75], a[32:35], v[88:91]
    ds_read_b128 a[108:111], v184 offset:27648
    v_mfma_f32_16x16x32_bf16 v[92:95], v[64:67], a[96:99], v[92:95]
    buffer_load_dword v146, v3, s[8:11], s25 offen offset:1280 sc1
    v_mfma_f32_16x16x32_bf16 v[92:95], v[68:71], a[100:103], v[92:95]
    ds_read_b128 a[180:183], v11 offset:9216
    ds_read_b128 a[252:255], v11 offset:27648
    v_mfma_f32_16x16x32_bf16 v[92:95], v[72:75], a[104:107], v[92:95]
    buffer_load_dwordx4 v[56:59], v187, s[48:51], s23 offen offset:1024 sc1
    v_mfma_f32_16x16x32_bf16 v[96:99], v[64:67], a[168:171], v[96:99]
    buffer_load_dword v147, v3, s[8:11], s25 offen offset:1408 sc1
    v_mfma_f32_16x16x32_bf16 v[96:99], v[68:71], a[172:175], v[96:99]
    buffer_load_dword v148, v3, s[8:11], s25 offen offset:1536 sc1
    v_mfma_f32_16x16x32_bf16 v[96:99], v[72:75], a[176:179], v[96:99]
    ds_read_b128 a[40:43], v184 offset:10240
    ds_read_b128 a[112:115], v184 offset:28672
    v_mfma_f32_16x16x32_bf16 v[100:103], v[64:67], a[240:243], v[100:103]
    buffer_load_dwordx4 v[60:63], v187, s[48:51], s23 offen offset:2048 sc1
    v_mfma_f32_16x16x32_bf16 v[100:103], v[68:71], a[244:247], v[100:103]
    buffer_load_dword v149, v3, s[8:11], s25 offen offset:1664 sc1
    v_mfma_f32_16x16x32_bf16 v[100:103], v[72:75], a[248:251], v[100:103]
    buffer_load_dword v150, v3, s[8:11], s25 offen offset:1792 sc1
    s_waitcnt vmcnt(31) lgkmcnt(6)
    v_mfma_f32_16x16x32_bf16 v[104:107], v[76:79], a[24:27], v[104:107]
    ds_read_b128 a[184:187], v11 offset:10240
    ds_read_b128 v[220:223], v11 offset:28672
    v_mfma_f32_16x16x32_bf16 v[104:107], v[80:83], a[28:31], v[104:107]
    buffer_load_dwordx4 v[64:67], v187, s[48:51], s23 offen offset:3072 sc1
    v_mfma_f32_16x16x32_bf16 v[104:107], v[84:87], a[32:35], v[104:107]
    ds_read_b128 a[44:47], v184 offset:11264
    ds_read_b128 a[116:119], v184 offset:29696
    v_mfma_f32_16x16x32_bf16 v[108:111], v[76:79], a[96:99], v[108:111]
    buffer_load_dword v151, v3, s[8:11], s25 offen offset:1920 sc1
    v_mfma_f32_16x16x32_bf16 v[108:111], v[80:83], a[100:103], v[108:111]
    ds_read_b128 a[188:191], v11 offset:11264
    ds_read_b128 v[224:227], v11 offset:29696
    v_mfma_f32_16x16x32_bf16 v[108:111], v[84:87], a[104:107], v[108:111]
    buffer_load_dwordx4 v[68:71], v188, s[48:51], s23 offen offset:0 sc1
    v_mfma_f32_16x16x32_bf16 v[112:115], v[76:79], a[168:171], v[112:115]
    v_mfma_f32_16x16x32_bf16 v[112:115], v[80:83], a[172:175], v[112:115]
    v_mfma_f32_16x16x32_bf16 v[112:115], v[84:87], a[176:179], v[112:115]
    v_mfma_f32_16x16x32_bf16 v[116:119], v[76:79], a[240:243], v[116:119]
    buffer_load_dwordx4 v[72:75], v188, s[48:51], s23 offen offset:1024 sc1
    v_mfma_f32_16x16x32_bf16 v[116:119], v[80:83], a[244:247], v[116:119]
    v_mfma_f32_16x16x32_bf16 v[116:119], v[84:87], a[248:251], v[116:119]
    s_waitcnt vmcnt(28) lgkmcnt(0)
    s_barrier
    v_mfma_f32_16x16x32_bf16 v[88:91], v[16:19], a[36:39], v[88:91]
    ds_read_b128 a[48:51], v184 offset:12288
    v_mfma_f32_16x16x32_bf16 v[88:91], v[20:23], a[40:43], v[88:91]
    buffer_load_dwordx4 v[76:79], v188, s[48:51], s23 offen offset:2048 sc1
    v_mfma_f32_16x16x32_bf16 v[88:91], v[24:27], a[44:47], v[88:91]
    ds_read_b128 a[120:123], v184 offset:30720
    v_mfma_f32_16x16x32_bf16 v[92:95], v[16:19], a[108:111], v[92:95]
    ds_read_b128 a[192:195], v11 offset:12288
    v_mfma_f32_16x16x32_bf16 v[92:95], v[20:23], a[112:115], v[92:95]
    ds_read_b128 v[228:231], v11 offset:30720
    v_mfma_f32_16x16x32_bf16 v[92:95], v[24:27], a[116:119], v[92:95]
    buffer_load_dwordx4 v[80:83], v188, s[48:51], s23 offen offset:3072 sc1
    v_mfma_f32_16x16x32_bf16 v[96:99], v[16:19], a[180:183], v[96:99]
    ds_read_b128 a[52:55], v184 offset:13312
    v_mfma_f32_16x16x32_bf16 v[96:99], v[20:23], a[184:187], v[96:99]
    ds_read_b128 a[124:127], v184 offset:31744
    v_mfma_f32_16x16x32_bf16 v[96:99], v[24:27], a[188:191], v[96:99]
    v_mfma_f32_16x16x32_bf16 v[100:103], v[16:19], a[252:255], v[100:103]
    buffer_load_dwordx4 v[84:87], v189, s[48:51], s23 offen offset:0 sc1
    v_mfma_f32_16x16x32_bf16 v[100:103], v[20:23], v[220:223], v[100:103]
    ds_read_b128 a[196:199], v11 offset:13312
    ds_read_b128 v[232:235], v11 offset:31744
    v_mfma_f32_16x16x32_bf16 v[100:103], v[24:27], v[224:227], v[100:103]
    s_waitcnt vmcnt(25) lgkmcnt(8)
    v_mfma_f32_16x16x32_bf16 v[104:107], v[28:31], a[36:39], v[104:107]
    ds_read_b128 a[56:59], v184 offset:14336
    v_mfma_f32_16x16x32_bf16 v[104:107], v[32:35], a[40:43], v[104:107]
    buffer_load_dwordx4 v[16:19], v189, s[48:51], s23 offen offset:1024 sc1
    v_mfma_f32_16x16x32_bf16 v[104:107], v[36:39], a[44:47], v[104:107]
    ds_read_b128 a[128:131], v184 offset:32768
    v_mfma_f32_16x16x32_bf16 v[108:111], v[28:31], a[108:111], v[108:111]
    ds_read_b128 a[200:203], v11 offset:14336
    v_mfma_f32_16x16x32_bf16 v[108:111], v[32:35], a[112:115], v[108:111]
    ds_read_b128 v[236:239], v11 offset:32768
    v_mfma_f32_16x16x32_bf16 v[108:111], v[36:39], a[116:119], v[108:111]
    buffer_load_dwordx4 v[20:23], v189, s[48:51], s23 offen offset:2048 sc1
    v_mfma_f32_16x16x32_bf16 v[112:115], v[28:31], a[180:183], v[112:115]
    v_mfma_f32_16x16x32_bf16 v[112:115], v[32:35], a[184:187], v[112:115]
    v_mfma_f32_16x16x32_bf16 v[112:115], v[36:39], a[188:191], v[112:115]
    v_mfma_f32_16x16x32_bf16 v[116:119], v[28:31], a[252:255], v[116:119]
    buffer_load_dwordx4 v[24:27], v189, s[48:51], s23 offen offset:3072 sc1
    v_mfma_f32_16x16x32_bf16 v[116:119], v[32:35], v[220:223], v[116:119]
    v_mfma_f32_16x16x32_bf16 v[116:119], v[36:39], v[224:227], v[116:119]
    s_waitcnt vmcnt(8) lgkmcnt(0)
    v_mfma_f32_16x16x32_bf16 v[88:91], v[40:43], a[48:51], v[88:91]
    ds_read_b128 a[60:63], v184 offset:15360
    v_add_f32 v136, v136, v144
    v_mfma_f32_16x16x32_bf16 v[88:91], v[44:47], a[52:55], v[88:91]
    buffer_load_dwordx4 v[28:31], v190, s[48:51], s23 offen offset:0 sc1
    v_mfma_f32_16x16x32_bf16 v[88:91], v[48:51], a[56:59], v[88:91]
    ds_read_b128 a[132:135], v184 offset:33792
    v_add_f32 v137, v137, v145
    v_mfma_f32_16x16x32_bf16 v[92:95], v[40:43], a[120:123], v[92:95]
    ds_read_b128 a[204:207], v11 offset:15360
    v_add_f32 v138, v138, v146
    v_mfma_f32_16x16x32_bf16 v[92:95], v[44:47], a[124:127], v[92:95]
    ds_read_b128 v[240:243], v11 offset:33792
    v_add_f32 v139, v139, v147
    v_mfma_f32_16x16x32_bf16 v[92:95], v[48:51], a[128:131], v[92:95]
    buffer_load_dwordx4 v[32:35], v190, s[48:51], s23 offen offset:1024 sc1
    v_mfma_f32_16x16x32_bf16 v[96:99], v[40:43], a[192:195], v[96:99]
    ds_read_b128 a[64:67], v184 offset:16384
    v_add_f32 v140, v140, v148
    v_mfma_f32_16x16x32_bf16 v[96:99], v[44:47], a[196:199], v[96:99]
    ds_read_b128 a[136:139], v184 offset:34816
    v_add_f32 v141, v141, v149
    v_mfma_f32_16x16x32_bf16 v[96:99], v[48:51], a[200:203], v[96:99]
    v_add_f32 v142, v142, v150
    v_add_f32 v143, v143, v151
    v_mfma_f32_16x16x32_bf16 v[100:103], v[40:43], v[228:231], v[100:103]
    buffer_load_dwordx4 v[36:39], v190, s[48:51], s23 offen offset:2048 sc1
    v_mfma_f32_16x16x32_bf16 v[100:103], v[44:47], v[232:235], v[100:103]
    ds_read_b128 a[208:211], v11 offset:16384
    ds_read_b128 v[244:247], v11 offset:34816
    v_mfma_f32_16x16x32_bf16 v[100:103], v[48:51], v[236:239], v[100:103]
    v_add_f32 v136, v136, v140
    v_add_f32 v137, v137, v141
    s_waitcnt vmcnt(15) lgkmcnt(8)
    v_mfma_f32_16x16x32_bf16 v[104:107], v[52:55], a[48:51], v[104:107]
    ds_read_b128 a[68:71], v184 offset:17408
    v_add_f32 v138, v138, v142
    v_mfma_f32_16x16x32_bf16 v[104:107], v[56:59], a[52:55], v[104:107]
    buffer_load_dwordx4 v[40:43], v190, s[48:51], s23 offen offset:3072 sc1
    v_mfma_f32_16x16x32_bf16 v[104:107], v[60:63], a[56:59], v[104:107]
    ds_read_b128 a[140:143], v184 offset:35840
    v_add_f32 v139, v139, v143
    v_mfma_f32_16x16x32_bf16 v[108:111], v[52:55], a[120:123], v[108:111]
    ds_read_b128 a[212:215], v11 offset:17408
    v_add_f32 v136, v136, v138
    v_mfma_f32_16x16x32_bf16 v[108:111], v[56:59], a[124:127], v[108:111]
    ds_read_b128 v[248:251], v11 offset:35840
    v_add_f32 v137, v137, v139
    v_mfma_f32_16x16x32_bf16 v[108:111], v[60:63], a[128:131], v[108:111]
    buffer_load_dwordx4 v[44:47], v191, s[48:51], s23 offen offset:0 sc1
    v_mfma_f32_16x16x32_bf16 v[112:115], v[52:55], a[192:195], v[112:115]
    v_add_f32 v136, v136, v137
    v_mov_b32 v137, 0x3727c5ac
    v_mfma_f32_16x16x32_bf16 v[112:115], v[56:59], a[196:199], v[112:115]
    v_fmac_f32 v137, 0x3ae38e39, v136
    v_mov_b32 v193, v137
    v_mfma_f32_16x16x32_bf16 v[112:115], v[60:63], a[200:203], v[112:115]
    s_nop 0
    v_permlane16_swap_b32 v193, v137
    v_mfma_f32_16x16x32_bf16 v[116:119], v[52:55], v[228:231], v[116:119]
    buffer_load_dwordx4 v[48:51], v191, s[48:51], s23 offen offset:1024 sc1
    v_mfma_f32_16x16x32_bf16 v[116:119], v[56:59], v[232:235], v[116:119]
    v_mov_b32 v195, v193
    v_mov_b32 v194, v137
    v_mfma_f32_16x16x32_bf16 v[116:119], v[60:63], v[236:239], v[116:119]
    v_mov_b32 v252, v137
    s_waitcnt vmcnt(12) lgkmcnt(0)
    v_mfma_f32_16x16x32_bf16 v[88:91], v[64:67], a[60:63], v[88:91]
    s_nop 0
    v_permlane32_swap_b32 v193, v195
    v_mfma_f32_16x16x32_bf16 v[88:91], v[68:71], a[64:67], v[88:91]
    buffer_load_dwordx4 v[52:55], v191, s[48:51], s23 offen offset:2048 sc1
    v_mfma_f32_16x16x32_bf16 v[120:123], v[72:75], a[68:71], v[88:91]
    v_permlane32_swap_b32 v194, v252
    v_mfma_f32_16x16x32_bf16 v[92:95], v[64:67], a[132:135], v[92:95]
    v_rsq_f32 v4, v193
    v_mfma_f32_16x16x32_bf16 v[92:95], v[68:71], a[136:139], v[92:95]
    v_rsq_f32 v5, v194
    v_mfma_f32_16x16x32_bf16 v[124:127], v[72:75], a[140:143], v[92:95]
    buffer_load_dwordx4 v[56:59], v191, s[48:51], s23 offen offset:3072 sc1
    v_mfma_f32_16x16x32_bf16 v[96:99], v[64:67], a[204:207], v[96:99]
    v_rsq_f32 v6, v195
    v_mfma_f32_16x16x32_bf16 v[96:99], v[68:71], a[208:211], v[96:99]
    v_rsq_f32 v7, v252
    v_mfma_f32_16x16x32_bf16 v[128:131], v[72:75], a[212:215], v[96:99]
    v_mul_f32 v8, v4, v4
    v_mul_f32 v9, v5, v5
    v_mfma_f32_16x16x32_bf16 v[100:103], v[64:67], v[240:243], v[100:103]
    buffer_load_dwordx4 v[60:63], v192, s[48:51], s23 offen offset:0 sc1
    v_mfma_f32_16x16x32_bf16 v[100:103], v[68:71], v[244:247], v[100:103]
    v_mul_f32 v13, v6, v6
    v_mul_f32 v14, v7, v7
    v_mfma_f32_16x16x32_bf16 v[132:135], v[72:75], v[248:251], v[100:103]
    v_mul_f32 v4, 0xc0135761, v4
    v_mul_f32 v5, 0xc0135761, v5
    s_waitcnt vmcnt(12) lgkmcnt(0)
    v_mfma_f32_16x16x32_bf16 v[104:107], v[76:79], a[60:63], v[104:107]
    v_mul_f32 v6, 0xc0135761, v6
    v_mul_f32 v7, 0xc0135761, v7
    v_mfma_f32_16x16x32_bf16 v[104:107], v[80:83], a[64:67], v[104:107]
    buffer_load_dwordx4 v[64:67], v192, s[48:51], s23 offen offset:1024 sc1
    v_mfma_f32_16x16x32_bf16 v[136:139], v[84:87], a[68:71], v[104:107]
    v_mul_f32 v8, 0x3d372713, v8
    v_mul_f32 v9, 0x3d372713, v9
    v_mfma_f32_16x16x32_bf16 v[108:111], v[76:79], a[132:135], v[108:111]
    v_mul_f32 v13, 0x3d372713, v13
    v_mul_f32 v14, 0x3d372713, v14
    v_mfma_f32_16x16x32_bf16 v[108:111], v[80:83], a[136:139], v[108:111]
    v_mul_f32 v8, v8, v4
    v_mul_f32 v9, v9, v5
    v_mfma_f32_16x16x32_bf16 v[140:143], v[84:87], a[140:143], v[108:111]
    buffer_load_dwordx4 v[68:71], v192, s[48:51], s23 offen offset:2048 sc1
    v_mfma_f32_16x16x32_bf16 v[112:115], v[76:79], a[204:207], v[112:115]
    v_mul_f32 v13, v13, v6
    v_mul_f32 v14, v14, v7
    v_mfma_f32_16x16x32_bf16 v[112:115], v[80:83], a[208:211], v[112:115]
    s_mov_b32 s25, 0
    v_mfma_f32_16x16x32_bf16 v[144:147], v[84:87], a[212:215], v[112:115]
    s_mov_b32 s7, s28
    v_mfma_f32_16x16x32_bf16 v[116:119], v[76:79], v[240:243], v[116:119]
    buffer_load_dwordx4 v[72:75], v192, s[48:51], s23 offen offset:3072 sc1
    v_mfma_f32_16x16x32_bf16 v[116:119], v[80:83], v[244:247], v[116:119]
    s_add_u32 s23, s23, 36864
    v_mfma_f32_16x16x32_bf16 v[148:151], v[84:87], v[248:251], v[116:119]
    v_add_u32 v12, s7, v184
    s_add_u32 s25, s25, 1
L_ffn_gu_34:
    s_waitcnt vmcnt(12)
    v_mfma_f32_16x16x32_bf16 v[88:91], v[16:19], a[0:3], 0
    v_mfma_f32_16x16x32_bf16 v[88:91], v[20:23], a[4:7], v[88:91]
    buffer_load_dwordx4 v[76:79], v184, s[48:51], s23 offen offset:0 sc1
    v_mfma_f32_16x16x32_bf16 v[88:91], v[24:27], a[8:11], v[88:91]
    v_mul_f32 v152, v120, v120
    v_mul_f32 v153, v121, v121
    v_mfma_f32_16x16x32_bf16 v[92:95], v[16:19], a[72:75], 0
    v_mul_f32 v154, v122, v122
    v_mul_f32 v155, v123, v123
    v_mfma_f32_16x16x32_bf16 v[92:95], v[20:23], a[76:79], v[92:95]
    v_fma_f32 v152, v152, v8, v4
    v_fma_f32 v153, v153, v8, v4
    v_mfma_f32_16x16x32_bf16 v[92:95], v[24:27], a[80:83], v[92:95]
    buffer_load_dwordx4 v[80:83], v184, s[48:51], s23 offen offset:1024 sc1
    v_mfma_f32_16x16x32_bf16 v[96:99], v[16:19], a[144:147], 0
    v_fma_f32 v154, v154, v8, v4
    v_fma_f32 v155, v155, v8, v4
    v_mfma_f32_16x16x32_bf16 v[96:99], v[20:23], a[148:151], v[96:99]
    v_mul_f32 v152, v120, v152
    v_mul_f32 v153, v121, v153
    v_mfma_f32_16x16x32_bf16 v[96:99], v[24:27], a[152:155], v[96:99]
    v_mul_f32 v154, v122, v154
    v_mul_f32 v155, v123, v155
    v_mfma_f32_16x16x32_bf16 v[100:103], v[16:19], a[216:219], 0
    buffer_load_dwordx4 v[84:87], v184, s[48:51], s23 offen offset:2048 sc1
    v_mfma_f32_16x16x32_bf16 v[100:103], v[20:23], a[220:223], v[100:103]
    v_exp_f32 v152, v152
    v_mfma_f32_16x16x32_bf16 v[100:103], v[24:27], a[224:227], v[100:103]
    v_exp_f32 v153, v153
    s_waitcnt vmcnt(12)
    v_mfma_f32_16x16x32_bf16 v[104:107], v[28:31], a[0:3], 0
    v_exp_f32 v154, v154
    v_mfma_f32_16x16x32_bf16 v[104:107], v[32:35], a[4:7], v[104:107]
    buffer_load_dwordx4 v[16:19], v184, s[48:51], s23 offen offset:3072 sc1
    v_mfma_f32_16x16x32_bf16 v[104:107], v[36:39], a[8:11], v[104:107]
    v_exp_f32 v155, v155
    v_mfma_f32_16x16x32_bf16 v[108:111], v[28:31], a[72:75], 0
    v_mul_f32 v156, v120, v136
    v_mul_f32 v157, v121, v137
    v_mfma_f32_16x16x32_bf16 v[108:111], v[32:35], a[76:79], v[108:111]
    v_mul_f32 v158, v122, v138
    v_mul_f32 v159, v123, v139
    v_mfma_f32_16x16x32_bf16 v[108:111], v[36:39], a[80:83], v[108:111]
    buffer_load_dwordx4 v[20:23], v185, s[48:51], s23 offen offset:0 sc1
    v_mfma_f32_16x16x32_bf16 v[112:115], v[28:31], a[144:147], 0
    v_fma_f32 v152, v152, v193, v193
    v_fma_f32 v153, v153, v193, v193
    v_mfma_f32_16x16x32_bf16 v[112:115], v[32:35], a[148:151], v[112:115]
    v_fma_f32 v154, v154, v193, v193
    v_fma_f32 v155, v155, v193, v193
    v_mfma_f32_16x16x32_bf16 v[112:115], v[36:39], a[152:155], v[112:115]
    v_rcp_f32 v152, v152
    v_mfma_f32_16x16x32_bf16 v[116:119], v[28:31], a[216:219], 0
    buffer_load_dwordx4 v[24:27], v185, s[48:51], s23 offen offset:1024 sc1
    v_mfma_f32_16x16x32_bf16 v[116:119], v[32:35], a[220:223], v[116:119]
    v_rcp_f32 v153, v153
    v_mfma_f32_16x16x32_bf16 v[116:119], v[36:39], a[224:227], v[116:119]
    v_rcp_f32 v154, v154
    s_waitcnt vmcnt(12)
    v_mfma_f32_16x16x32_bf16 v[88:91], v[40:43], a[12:15], v[88:91]
    v_rcp_f32 v155, v155
    v_mfma_f32_16x16x32_bf16 v[88:91], v[44:47], a[16:19], v[88:91]
    buffer_load_dwordx4 v[28:31], v185, s[48:51], s23 offen offset:2048 sc1
    v_mfma_f32_16x16x32_bf16 v[88:91], v[48:51], a[20:23], v[88:91]
    v_mul_f32 v156, v156, v152
    v_mul_f32 v157, v157, v153
    v_mfma_f32_16x16x32_bf16 v[92:95], v[40:43], a[84:87], v[92:95]
    v_mul_f32 v158, v158, v154
    v_mul_f32 v159, v159, v155
    v_mfma_f32_16x16x32_bf16 v[92:95], v[44:47], a[88:91], v[92:95]
    v_cvt_pk_bf16_f32 v160, v156, v157
    v_cvt_pk_bf16_f32 v161, v158, v159
    v_mfma_f32_16x16x32_bf16 v[92:95], v[48:51], a[92:95], v[92:95]
    buffer_load_dwordx4 v[32:35], v185, s[48:51], s23 offen offset:3072 sc1
    v_mfma_f32_16x16x32_bf16 v[96:99], v[40:43], a[156:159], v[96:99]
    ds_write_b64 v12, v[160:161] offset:0
    v_mfma_f32_16x16x32_bf16 v[96:99], v[44:47], a[160:163], v[96:99]
    v_mul_f32 v162, v124, v124
    v_mul_f32 v163, v125, v125
    v_mfma_f32_16x16x32_bf16 v[96:99], v[48:51], a[164:167], v[96:99]
    v_mul_f32 v164, v126, v126
    v_mul_f32 v165, v127, v127
    v_mfma_f32_16x16x32_bf16 v[100:103], v[40:43], a[228:231], v[100:103]
    buffer_load_dwordx4 v[36:39], v186, s[48:51], s23 offen offset:0 sc1
    v_mfma_f32_16x16x32_bf16 v[100:103], v[44:47], a[232:235], v[100:103]
    v_fma_f32 v162, v162, v9, v5
    v_fma_f32 v163, v163, v9, v5
    v_mfma_f32_16x16x32_bf16 v[100:103], v[48:51], a[236:239], v[100:103]
    v_fma_f32 v164, v164, v9, v5
    v_fma_f32 v165, v165, v9, v5
    s_waitcnt vmcnt(12)
    v_mfma_f32_16x16x32_bf16 v[104:107], v[52:55], a[12:15], v[104:107]
    v_mul_f32 v162, v124, v162
    v_mul_f32 v163, v125, v163
    v_mfma_f32_16x16x32_bf16 v[104:107], v[56:59], a[16:19], v[104:107]
    buffer_load_dwordx4 v[40:43], v186, s[48:51], s23 offen offset:1024 sc1
    v_mfma_f32_16x16x32_bf16 v[104:107], v[60:63], a[20:23], v[104:107]
    v_mul_f32 v164, v126, v164
    v_mul_f32 v165, v127, v165
    v_mfma_f32_16x16x32_bf16 v[108:111], v[52:55], a[84:87], v[108:111]
    v_exp_f32 v162, v162
    v_mfma_f32_16x16x32_bf16 v[108:111], v[56:59], a[88:91], v[108:111]
    v_exp_f32 v163, v163
    v_mfma_f32_16x16x32_bf16 v[108:111], v[60:63], a[92:95], v[108:111]
    buffer_load_dwordx4 v[44:47], v186, s[48:51], s23 offen offset:2048 sc1
    v_mfma_f32_16x16x32_bf16 v[112:115], v[52:55], a[156:159], v[112:115]
    v_exp_f32 v164, v164
    v_mfma_f32_16x16x32_bf16 v[112:115], v[56:59], a[160:163], v[112:115]
    v_exp_f32 v165, v165
    v_mfma_f32_16x16x32_bf16 v[112:115], v[60:63], a[164:167], v[112:115]
    v_mul_f32 v166, v124, v140
    v_mul_f32 v167, v125, v141
    v_mfma_f32_16x16x32_bf16 v[116:119], v[52:55], a[228:231], v[116:119]
    buffer_load_dwordx4 v[48:51], v186, s[48:51], s23 offen offset:3072 sc1
    v_mfma_f32_16x16x32_bf16 v[116:119], v[56:59], a[232:235], v[116:119]
    v_mul_f32 v168, v126, v142
    v_mul_f32 v169, v127, v143
    v_mfma_f32_16x16x32_bf16 v[116:119], v[60:63], a[236:239], v[116:119]
    v_fma_f32 v162, v162, v194, v194
    v_fma_f32 v163, v163, v194, v194
    s_waitcnt vmcnt(12)
    v_mfma_f32_16x16x32_bf16 v[88:91], v[64:67], a[24:27], v[88:91]
    v_fma_f32 v164, v164, v194, v194
    v_fma_f32 v165, v165, v194, v194
    v_mfma_f32_16x16x32_bf16 v[88:91], v[68:71], a[28:31], v[88:91]
    buffer_load_dwordx4 v[52:55], v187, s[48:51], s23 offen offset:0 sc1
    v_mfma_f32_16x16x32_bf16 v[88:91], v[72:75], a[32:35], v[88:91]
    v_rcp_f32 v162, v162
    v_mfma_f32_16x16x32_bf16 v[92:95], v[64:67], a[96:99], v[92:95]
    v_rcp_f32 v163, v163
    v_mfma_f32_16x16x32_bf16 v[92:95], v[68:71], a[100:103], v[92:95]
    v_rcp_f32 v164, v164
    v_mfma_f32_16x16x32_bf16 v[92:95], v[72:75], a[104:107], v[92:95]
    buffer_load_dwordx4 v[56:59], v187, s[48:51], s23 offen offset:1024 sc1
    v_mfma_f32_16x16x32_bf16 v[96:99], v[64:67], a[168:171], v[96:99]
    v_rcp_f32 v165, v165
    v_mfma_f32_16x16x32_bf16 v[96:99], v[68:71], a[172:175], v[96:99]
    v_mul_f32 v166, v166, v162
    v_mul_f32 v167, v167, v163
    v_mfma_f32_16x16x32_bf16 v[96:99], v[72:75], a[176:179], v[96:99]
    v_mul_f32 v168, v168, v164
    v_mul_f32 v169, v169, v165
    v_mfma_f32_16x16x32_bf16 v[100:103], v[64:67], a[240:243], v[100:103]
    buffer_load_dwordx4 v[60:63], v187, s[48:51], s23 offen offset:2048 sc1
    v_mfma_f32_16x16x32_bf16 v[100:103], v[68:71], a[244:247], v[100:103]
    v_cvt_pk_bf16_f32 v170, v166, v167
    v_cvt_pk_bf16_f32 v171, v168, v169
    v_mfma_f32_16x16x32_bf16 v[100:103], v[72:75], a[248:251], v[100:103]
    ds_write_b64 v12, v[170:171] offset:18432
    s_waitcnt vmcnt(12)
    v_mfma_f32_16x16x32_bf16 v[104:107], v[76:79], a[24:27], v[104:107]
    v_mul_f32 v152, v128, v128
    v_mul_f32 v153, v129, v129
    v_mfma_f32_16x16x32_bf16 v[104:107], v[80:83], a[28:31], v[104:107]
    buffer_load_dwordx4 v[64:67], v187, s[48:51], s23 offen offset:3072 sc1
    v_mfma_f32_16x16x32_bf16 v[104:107], v[84:87], a[32:35], v[104:107]
    v_mul_f32 v154, v130, v130
    v_mul_f32 v155, v131, v131
    v_mfma_f32_16x16x32_bf16 v[108:111], v[76:79], a[96:99], v[108:111]
    v_fma_f32 v152, v152, v13, v6
    v_fma_f32 v153, v153, v13, v6
    v_mfma_f32_16x16x32_bf16 v[108:111], v[80:83], a[100:103], v[108:111]
    v_fma_f32 v154, v154, v13, v6
    v_fma_f32 v155, v155, v13, v6
    v_mfma_f32_16x16x32_bf16 v[108:111], v[84:87], a[104:107], v[108:111]
    buffer_load_dwordx4 v[68:71], v188, s[48:51], s23 offen offset:0 sc1
    v_mfma_f32_16x16x32_bf16 v[112:115], v[76:79], a[168:171], v[112:115]
    v_mul_f32 v152, v128, v152
    v_mul_f32 v153, v129, v153
    v_mfma_f32_16x16x32_bf16 v[112:115], v[80:83], a[172:175], v[112:115]
    v_mul_f32 v154, v130, v154
    v_mul_f32 v155, v131, v155
    v_mfma_f32_16x16x32_bf16 v[112:115], v[84:87], a[176:179], v[112:115]
    v_exp_f32 v152, v152
    v_mfma_f32_16x16x32_bf16 v[116:119], v[76:79], a[240:243], v[116:119]
    buffer_load_dwordx4 v[72:75], v188, s[48:51], s23 offen offset:1024 sc1
    v_mfma_f32_16x16x32_bf16 v[116:119], v[80:83], a[244:247], v[116:119]
    v_exp_f32 v153, v153
    v_mfma_f32_16x16x32_bf16 v[116:119], v[84:87], a[248:251], v[116:119]
    v_exp_f32 v154, v154
    s_waitcnt vmcnt(12)
    v_mfma_f32_16x16x32_bf16 v[88:91], v[16:19], a[36:39], v[88:91]
    v_exp_f32 v155, v155
    v_mfma_f32_16x16x32_bf16 v[88:91], v[20:23], a[40:43], v[88:91]
    buffer_load_dwordx4 v[76:79], v188, s[48:51], s23 offen offset:2048 sc1
    v_mfma_f32_16x16x32_bf16 v[88:91], v[24:27], a[44:47], v[88:91]
    v_mul_f32 v156, v128, v144
    v_mul_f32 v157, v129, v145
    v_mfma_f32_16x16x32_bf16 v[92:95], v[16:19], a[108:111], v[92:95]
    v_mul_f32 v158, v130, v146
    v_mul_f32 v159, v131, v147
    v_mfma_f32_16x16x32_bf16 v[92:95], v[20:23], a[112:115], v[92:95]
    v_fma_f32 v152, v152, v195, v195
    v_fma_f32 v153, v153, v195, v195
    v_mfma_f32_16x16x32_bf16 v[92:95], v[24:27], a[116:119], v[92:95]
    buffer_load_dwordx4 v[80:83], v188, s[48:51], s23 offen offset:3072 sc1
    v_mfma_f32_16x16x32_bf16 v[96:99], v[16:19], a[180:183], v[96:99]
    v_fma_f32 v154, v154, v195, v195
    v_fma_f32 v155, v155, v195, v195
    v_mfma_f32_16x16x32_bf16 v[96:99], v[20:23], a[184:187], v[96:99]
    v_rcp_f32 v152, v152
    v_mfma_f32_16x16x32_bf16 v[96:99], v[24:27], a[188:191], v[96:99]
    v_rcp_f32 v153, v153
    v_mfma_f32_16x16x32_bf16 v[100:103], v[16:19], a[252:255], v[100:103]
    buffer_load_dwordx4 v[84:87], v189, s[48:51], s23 offen offset:0 sc1
    v_mfma_f32_16x16x32_bf16 v[100:103], v[20:23], v[220:223], v[100:103]
    v_rcp_f32 v154, v154
    v_mfma_f32_16x16x32_bf16 v[100:103], v[24:27], v[224:227], v[100:103]
    v_rcp_f32 v155, v155
    s_waitcnt vmcnt(12)
    v_mfma_f32_16x16x32_bf16 v[104:107], v[28:31], a[36:39], v[104:107]
    v_mul_f32 v156, v156, v152
    v_mul_f32 v157, v157, v153
    v_mfma_f32_16x16x32_bf16 v[104:107], v[32:35], a[40:43], v[104:107]
    buffer_load_dwordx4 v[16:19], v189, s[48:51], s23 offen offset:1024 sc1
    v_mfma_f32_16x16x32_bf16 v[104:107], v[36:39], a[44:47], v[104:107]
    v_mul_f32 v158, v158, v154
    v_mul_f32 v159, v159, v155
    v_mfma_f32_16x16x32_bf16 v[108:111], v[28:31], a[108:111], v[108:111]
    v_cvt_pk_bf16_f32 v160, v156, v157
    v_cvt_pk_bf16_f32 v161, v158, v159
    v_mfma_f32_16x16x32_bf16 v[108:111], v[32:35], a[112:115], v[108:111]
    ds_write_b64 v12, v[160:161] offset:36864
    v_mfma_f32_16x16x32_bf16 v[108:111], v[36:39], a[116:119], v[108:111]
    buffer_load_dwordx4 v[20:23], v189, s[48:51], s23 offen offset:2048 sc1
    v_mfma_f32_16x16x32_bf16 v[112:115], v[28:31], a[180:183], v[112:115]
    v_mul_f32 v162, v132, v132
    v_mul_f32 v163, v133, v133
    v_mfma_f32_16x16x32_bf16 v[112:115], v[32:35], a[184:187], v[112:115]
    v_mul_f32 v164, v134, v134
    v_mul_f32 v165, v135, v135
    v_mfma_f32_16x16x32_bf16 v[112:115], v[36:39], a[188:191], v[112:115]
    v_fma_f32 v162, v162, v14, v7
    v_fma_f32 v163, v163, v14, v7
    v_mfma_f32_16x16x32_bf16 v[116:119], v[28:31], a[252:255], v[116:119]
    buffer_load_dwordx4 v[24:27], v189, s[48:51], s23 offen offset:3072 sc1
    v_mfma_f32_16x16x32_bf16 v[116:119], v[32:35], v[220:223], v[116:119]
    v_fma_f32 v164, v164, v14, v7
    v_fma_f32 v165, v165, v14, v7
    v_mfma_f32_16x16x32_bf16 v[116:119], v[36:39], v[224:227], v[116:119]
    v_mul_f32 v162, v132, v162
    v_mul_f32 v163, v133, v163
    s_waitcnt vmcnt(12)
    v_mfma_f32_16x16x32_bf16 v[88:91], v[40:43], a[48:51], v[88:91]
    v_mul_f32 v164, v134, v164
    v_mul_f32 v165, v135, v165
    v_mfma_f32_16x16x32_bf16 v[88:91], v[44:47], a[52:55], v[88:91]
    buffer_load_dwordx4 v[28:31], v190, s[48:51], s23 offen offset:0 sc1
    v_mfma_f32_16x16x32_bf16 v[88:91], v[48:51], a[56:59], v[88:91]
    v_exp_f32 v162, v162
    v_mfma_f32_16x16x32_bf16 v[92:95], v[40:43], a[120:123], v[92:95]
    v_exp_f32 v163, v163
    v_mfma_f32_16x16x32_bf16 v[92:95], v[44:47], a[124:127], v[92:95]
    v_exp_f32 v164, v164
    v_mfma_f32_16x16x32_bf16 v[92:95], v[48:51], a[128:131], v[92:95]
    buffer_load_dwordx4 v[32:35], v190, s[48:51], s23 offen offset:1024 sc1
    v_mfma_f32_16x16x32_bf16 v[96:99], v[40:43], a[192:195], v[96:99]
    v_exp_f32 v165, v165
    v_mfma_f32_16x16x32_bf16 v[96:99], v[44:47], a[196:199], v[96:99]
    v_mul_f32 v166, v132, v148
    v_mul_f32 v167, v133, v149
    v_mfma_f32_16x16x32_bf16 v[96:99], v[48:51], a[200:203], v[96:99]
    v_mul_f32 v168, v134, v150
    v_mul_f32 v169, v135, v151
    v_mfma_f32_16x16x32_bf16 v[100:103], v[40:43], v[228:231], v[100:103]
    buffer_load_dwordx4 v[36:39], v190, s[48:51], s23 offen offset:2048 sc1
    v_mfma_f32_16x16x32_bf16 v[100:103], v[44:47], v[232:235], v[100:103]
    v_fma_f32 v162, v162, v252, v252
    v_fma_f32 v163, v163, v252, v252
    v_mfma_f32_16x16x32_bf16 v[100:103], v[48:51], v[236:239], v[100:103]
    v_fma_f32 v164, v164, v252, v252
    v_fma_f32 v165, v165, v252, v252
    s_waitcnt vmcnt(12)
    v_mfma_f32_16x16x32_bf16 v[104:107], v[52:55], a[48:51], v[104:107]
    v_rcp_f32 v162, v162
    v_mfma_f32_16x16x32_bf16 v[104:107], v[56:59], a[52:55], v[104:107]
    buffer_load_dwordx4 v[40:43], v190, s[48:51], s23 offen offset:3072 sc1
    v_mfma_f32_16x16x32_bf16 v[104:107], v[60:63], a[56:59], v[104:107]
    v_rcp_f32 v163, v163
    v_mfma_f32_16x16x32_bf16 v[108:111], v[52:55], a[120:123], v[108:111]
    v_rcp_f32 v164, v164
    v_mfma_f32_16x16x32_bf16 v[108:111], v[56:59], a[124:127], v[108:111]
    v_rcp_f32 v165, v165
    v_mfma_f32_16x16x32_bf16 v[108:111], v[60:63], a[128:131], v[108:111]
    buffer_load_dwordx4 v[44:47], v191, s[48:51], s23 offen offset:0 sc1
    v_mfma_f32_16x16x32_bf16 v[112:115], v[52:55], a[192:195], v[112:115]
    v_mul_f32 v166, v166, v162
    v_mul_f32 v167, v167, v163
    v_mfma_f32_16x16x32_bf16 v[112:115], v[56:59], a[196:199], v[112:115]
    v_mul_f32 v168, v168, v164
    v_mul_f32 v169, v169, v165
    v_mfma_f32_16x16x32_bf16 v[112:115], v[60:63], a[200:203], v[112:115]
    v_cvt_pk_bf16_f32 v170, v166, v167
    v_cvt_pk_bf16_f32 v171, v168, v169
    v_mfma_f32_16x16x32_bf16 v[116:119], v[52:55], v[228:231], v[116:119]
    buffer_load_dwordx4 v[48:51], v191, s[48:51], s23 offen offset:1024 sc1
    v_mfma_f32_16x16x32_bf16 v[116:119], v[56:59], v[232:235], v[116:119]
    ds_write_b64 v12, v[170:171] offset:55296
    v_mfma_f32_16x16x32_bf16 v[116:119], v[60:63], v[236:239], v[116:119]
    s_waitcnt vmcnt(12)
    v_mfma_f32_16x16x32_bf16 v[88:91], v[64:67], a[60:63], v[88:91]
    v_mfma_f32_16x16x32_bf16 v[88:91], v[68:71], a[64:67], v[88:91]
    buffer_load_dwordx4 v[52:55], v191, s[48:51], s23 offen offset:2048 sc1
    v_mfma_f32_16x16x32_bf16 v[120:123], v[72:75], a[68:71], v[88:91]
    v_mfma_f32_16x16x32_bf16 v[92:95], v[64:67], a[132:135], v[92:95]
    v_mfma_f32_16x16x32_bf16 v[92:95], v[68:71], a[136:139], v[92:95]
    v_mfma_f32_16x16x32_bf16 v[124:127], v[72:75], a[140:143], v[92:95]
    buffer_load_dwordx4 v[56:59], v191, s[48:51], s23 offen offset:3072 sc1
    v_mfma_f32_16x16x32_bf16 v[96:99], v[64:67], a[204:207], v[96:99]
    v_mfma_f32_16x16x32_bf16 v[96:99], v[68:71], a[208:211], v[96:99]
    v_mfma_f32_16x16x32_bf16 v[128:131], v[72:75], a[212:215], v[96:99]
    v_mfma_f32_16x16x32_bf16 v[100:103], v[64:67], v[240:243], v[100:103]
    buffer_load_dwordx4 v[60:63], v192, s[48:51], s23 offen offset:0 sc1
    v_mfma_f32_16x16x32_bf16 v[100:103], v[68:71], v[244:247], v[100:103]
    v_mfma_f32_16x16x32_bf16 v[132:135], v[72:75], v[248:251], v[100:103]
    s_waitcnt vmcnt(12)
    v_mfma_f32_16x16x32_bf16 v[104:107], v[76:79], a[60:63], v[104:107]
    v_mfma_f32_16x16x32_bf16 v[104:107], v[80:83], a[64:67], v[104:107]
    buffer_load_dwordx4 v[64:67], v192, s[48:51], s23 offen offset:1024 sc1
    v_mfma_f32_16x16x32_bf16 v[136:139], v[84:87], a[68:71], v[104:107]
    v_mfma_f32_16x16x32_bf16 v[108:111], v[76:79], a[132:135], v[108:111]
    v_mfma_f32_16x16x32_bf16 v[108:111], v[80:83], a[136:139], v[108:111]
    v_mfma_f32_16x16x32_bf16 v[140:143], v[84:87], a[140:143], v[108:111]
    buffer_load_dwordx4 v[68:71], v192, s[48:51], s23 offen offset:2048 sc1
    v_mfma_f32_16x16x32_bf16 v[112:115], v[76:79], a[204:207], v[112:115]
    v_mfma_f32_16x16x32_bf16 v[112:115], v[80:83], a[208:211], v[112:115]
    s_lshl_b32 s7, s25, 11
    v_mfma_f32_16x16x32_bf16 v[144:147], v[84:87], a[212:215], v[112:115]
    s_add_u32 s7, s7, s28
    v_mfma_f32_16x16x32_bf16 v[116:119], v[76:79], v[240:243], v[116:119]
    buffer_load_dwordx4 v[72:75], v192, s[48:51], s23 offen offset:3072 sc1
    v_mfma_f32_16x16x32_bf16 v[116:119], v[80:83], v[244:247], v[116:119]
    s_add_u32 s23, s23, 36864
    v_mfma_f32_16x16x32_bf16 v[148:151], v[84:87], v[248:251], v[116:119]
    v_add_u32 v12, s7, v184
    s_add_u32 s25, s25, 1
    s_cmp_lt_u32 s25, 8
    s_cbranch_scc1 L_ffn_gu_34
    v_add_u32 v10, 73728, v184
    v_add_u32 v11, 110592, v184
    s_lshr_b32 s7, s2, 3
    s_lshl_b32 s7, s7, 2
    s_add_u32 s7, s7, s3
    s_lshl_b32 s7, s7, 9
    v_lshrrev_b32 v1, 1, v253
    v_add_u32 v1, s7, v1
    buffer_load_dwordx2 v[2:3], v1, s[96:99], 0 offen
    s_waitcnt lgkmcnt(0)
    s_barrier
    s_waitcnt vmcnt(12)
    v_mfma_f32_16x16x32_bf16 v[88:91], v[16:19], a[0:3], 0
    v_mfma_f32_16x16x32_bf16 v[88:91], v[20:23], a[4:7], v[88:91]
    buffer_load_dwordx4 v[76:79], v184, s[48:51], s23 offen offset:0 sc1
    v_mfma_f32_16x16x32_bf16 v[88:91], v[24:27], a[8:11], v[88:91]
    v_mul_f32 v152, v120, v120
    v_mul_f32 v153, v121, v121
    v_mfma_f32_16x16x32_bf16 v[92:95], v[16:19], a[72:75], 0
    v_mul_f32 v154, v122, v122
    v_mul_f32 v155, v123, v123
    v_mfma_f32_16x16x32_bf16 v[92:95], v[20:23], a[76:79], v[92:95]
    v_fma_f32 v152, v152, v8, v4
    v_fma_f32 v153, v153, v8, v4
    v_mfma_f32_16x16x32_bf16 v[92:95], v[24:27], a[80:83], v[92:95]
    buffer_load_dwordx4 v[80:83], v184, s[48:51], s23 offen offset:1024 sc1
    v_mfma_f32_16x16x32_bf16 v[96:99], v[16:19], a[144:147], 0
    v_fma_f32 v154, v154, v8, v4
    v_fma_f32 v155, v155, v8, v4
    v_mfma_f32_16x16x32_bf16 v[96:99], v[20:23], a[148:151], v[96:99]
    v_mul_f32 v152, v120, v152
    v_mul_f32 v153, v121, v153
    v_mfma_f32_16x16x32_bf16 v[96:99], v[24:27], a[152:155], v[96:99]
    v_mul_f32 v154, v122, v154
    v_mul_f32 v155, v123, v155
    v_mfma_f32_16x16x32_bf16 v[100:103], v[16:19], a[216:219], 0
    buffer_load_dwordx4 v[84:87], v184, s[48:51], s23 offen offset:2048 sc1
    v_mfma_f32_16x16x32_bf16 v[100:103], v[20:23], a[220:223], v[100:103]
    v_exp_f32 v152, v152
    v_mfma_f32_16x16x32_bf16 v[100:103], v[24:27], a[224:227], v[100:103]
    v_exp_f32 v153, v153
    s_waitcnt vmcnt(12)
    v_mfma_f32_16x16x32_bf16 v[104:107], v[28:31], a[0:3], 0
    v_exp_f32 v154, v154
    ds_read_b128 a[0:3], v10 offset:0
    v_mfma_f32_16x16x32_bf16 v[104:107], v[32:35], a[4:7], v[104:107]
    buffer_load_dwordx4 v[16:19], v184, s[48:51], s23 offen offset:3072 sc1
    v_mfma_f32_16x16x32_bf16 v[104:107], v[36:39], a[8:11], v[104:107]
    v_exp_f32 v155, v155
    v_mfma_f32_16x16x32_bf16 v[108:111], v[28:31], a[72:75], 0
    v_mul_f32 v156, v120, v136
    v_mul_f32 v157, v121, v137
    ds_read_b128 a[72:75], v10 offset:18432
    v_mfma_f32_16x16x32_bf16 v[108:111], v[32:35], a[76:79], v[108:111]
    v_mul_f32 v158, v122, v138
    v_mul_f32 v159, v123, v139
    v_mfma_f32_16x16x32_bf16 v[108:111], v[36:39], a[80:83], v[108:111]
    buffer_load_dwordx4 v[20:23], v185, s[48:51], s23 offen offset:0 sc1
    v_mfma_f32_16x16x32_bf16 v[112:115], v[28:31], a[144:147], 0
    v_fma_f32 v152, v152, v193, v193
    v_fma_f32 v153, v153, v193, v193
    ds_read_b128 a[144:147], v11 offset:0
    v_mfma_f32_16x16x32_bf16 v[112:115], v[32:35], a[148:151], v[112:115]
    v_fma_f32 v154, v154, v193, v193
    v_fma_f32 v155, v155, v193, v193
    v_mfma_f32_16x16x32_bf16 v[112:115], v[36:39], a[152:155], v[112:115]
    v_rcp_f32 v152, v152
    v_mfma_f32_16x16x32_bf16 v[116:119], v[28:31], a[216:219], 0
    buffer_load_dwordx4 v[24:27], v185, s[48:51], s23 offen offset:1024 sc1
    v_mfma_f32_16x16x32_bf16 v[116:119], v[32:35], a[220:223], v[116:119]
    v_rcp_f32 v153, v153
    ds_read_b128 a[216:219], v11 offset:18432
    v_mfma_f32_16x16x32_bf16 v[116:119], v[36:39], a[224:227], v[116:119]
    v_rcp_f32 v154, v154
    ds_read_b128 a[4:7], v10 offset:1024
    s_waitcnt vmcnt(12)
    v_mfma_f32_16x16x32_bf16 v[88:91], v[40:43], a[12:15], v[88:91]
    v_rcp_f32 v155, v155
    ds_read_b128 a[76:79], v10 offset:19456
    v_mfma_f32_16x16x32_bf16 v[88:91], v[44:47], a[16:19], v[88:91]
    buffer_load_dwordx4 v[28:31], v185, s[48:51], s23 offen offset:2048 sc1
    v_mfma_f32_16x16x32_bf16 v[88:91], v[48:51], a[20:23], v[88:91]
    v_mul_f32 v156, v156, v152
    v_mul_f32 v157, v157, v153
    ds_read_b128 a[148:151], v11 offset:1024
    v_mfma_f32_16x16x32_bf16 v[92:95], v[40:43], a[84:87], v[92:95]
    v_mul_f32 v158, v158, v154
    v_mul_f32 v159, v159, v155
    ds_read_b128 a[220:223], v11 offset:19456
    v_mfma_f32_16x16x32_bf16 v[92:95], v[44:47], a[88:91], v[92:95]
    v_cvt_pk_bf16_f32 v160, v156, v157
    v_cvt_pk_bf16_f32 v161, v158, v159
    ds_read_b128 a[8:11], v10 offset:2048
    v_mfma_f32_16x16x32_bf16 v[92:95], v[48:51], a[92:95], v[92:95]
    buffer_load_dwordx4 v[32:35], v185, s[48:51], s23 offen offset:3072 sc1
    v_mfma_f32_16x16x32_bf16 v[96:99], v[40:43], a[156:159], v[96:99]
    ds_write_b64 v12, v[160:161] offset:0
    v_mfma_f32_16x16x32_bf16 v[96:99], v[44:47], a[160:163], v[96:99]
    v_mul_f32 v162, v124, v124
    v_mul_f32 v163, v125, v125
    ds_read_b128 a[80:83], v10 offset:20480
    v_mfma_f32_16x16x32_bf16 v[96:99], v[48:51], a[164:167], v[96:99]
    v_mul_f32 v164, v126, v126
    v_mul_f32 v165, v127, v127
    ds_read_b128 a[152:155], v11 offset:2048
    v_mfma_f32_16x16x32_bf16 v[100:103], v[40:43], a[228:231], v[100:103]
    buffer_load_dwordx4 v[36:39], v186, s[48:51], s23 offen offset:0 sc1
    v_mfma_f32_16x16x32_bf16 v[100:103], v[44:47], a[232:235], v[100:103]
    v_fma_f32 v162, v162, v9, v5
    v_fma_f32 v163, v163, v9, v5
    ds_read_b128 a[224:227], v11 offset:20480
    v_mfma_f32_16x16x32_bf16 v[100:103], v[48:51], a[236:239], v[100:103]
    v_fma_f32 v164, v164, v9, v5
    v_fma_f32 v165, v165, v9, v5
    s_waitcnt vmcnt(12)
    v_mfma_f32_16x16x32_bf16 v[104:107], v[52:55], a[12:15], v[104:107]
    v_mul_f32 v162, v124, v162
    v_mul_f32 v163, v125, v163
    ds_read_b128 a[12:15], v10 offset:3072
    v_mfma_f32_16x16x32_bf16 v[104:107], v[56:59], a[16:19], v[104:107]
    buffer_load_dwordx4 v[40:43], v186, s[48:51], s23 offen offset:1024 sc1
    v_mfma_f32_16x16x32_bf16 v[104:107], v[60:63], a[20:23], v[104:107]
    v_mul_f32 v164, v126, v164
    v_mul_f32 v165, v127, v165
    v_mfma_f32_16x16x32_bf16 v[108:111], v[52:55], a[84:87], v[108:111]
    v_exp_f32 v162, v162
    ds_read_b128 a[84:87], v10 offset:21504
    v_mfma_f32_16x16x32_bf16 v[108:111], v[56:59], a[88:91], v[108:111]
    v_exp_f32 v163, v163
    v_mfma_f32_16x16x32_bf16 v[108:111], v[60:63], a[92:95], v[108:111]
    buffer_load_dwordx4 v[44:47], v186, s[48:51], s23 offen offset:2048 sc1
    v_mfma_f32_16x16x32_bf16 v[112:115], v[52:55], a[156:159], v[112:115]
    v_exp_f32 v164, v164
    ds_read_b128 a[156:159], v11 offset:3072
    v_mfma_f32_16x16x32_bf16 v[112:115], v[56:59], a[160:163], v[112:115]
    v_exp_f32 v165, v165
    v_mfma_f32_16x16x32_bf16 v[112:115], v[60:63], a[164:167], v[112:115]
    v_mul_f32 v166, v124, v140
    v_mul_f32 v167, v125, v141
    v_mfma_f32_16x16x32_bf16 v[116:119], v[52:55], a[228:231], v[116:119]
    buffer_load_dwordx4 v[48:51], v186, s[48:51], s23 offen offset:3072 sc1
    v_mfma_f32_16x16x32_bf16 v[116:119], v[56:59], a[232:235], v[116:119]
    v_mul_f32 v168, v126, v142
    v_mul_f32 v169, v127, v143
    ds_read_b128 a[228:231], v11 offset:21504
    v_mfma_f32_16x16x32_bf16 v[116:119], v[60:63], a[236:239], v[116:119]
    v_fma_f32 v162, v162, v194, v194
    v_fma_f32 v163, v163, v194, v194
    ds_read_b128 a[16:19], v10 offset:4096
    s_waitcnt vmcnt(12)
    v_mfma_f32_16x16x32_bf16 v[88:91], v[64:67], a[24:27], v[88:91]
    v_fma_f32 v164, v164, v194, v194
    v_fma_f32 v165, v165, v194, v194
    ds_read_b128 a[88:91], v10 offset:22528
    v_mfma_f32_16x16x32_bf16 v[88:91], v[68:71], a[28:31], v[88:91]
    buffer_load_dwordx4 v[52:55], v187, s[48:51], s23 offen offset:0 sc1
    v_mfma_f32_16x16x32_bf16 v[88:91], v[72:75], a[32:35], v[88:91]
    v_rcp_f32 v162, v162
    ds_read_b128 a[160:163], v11 offset:4096
    v_mfma_f32_16x16x32_bf16 v[92:95], v[64:67], a[96:99], v[92:95]
    v_rcp_f32 v163, v163
    ds_read_b128 a[232:235], v11 offset:22528
    v_mfma_f32_16x16x32_bf16 v[92:95], v[68:71], a[100:103], v[92:95]
    v_rcp_f32 v164, v164
    ds_read_b128 a[20:23], v10 offset:5120
    v_mfma_f32_16x16x32_bf16 v[92:95], v[72:75], a[104:107], v[92:95]
    buffer_load_dwordx4 v[56:59], v187, s[48:51], s23 offen offset:1024 sc1
    v_mfma_f32_16x16x32_bf16 v[96:99], v[64:67], a[168:171], v[96:99]
    v_rcp_f32 v165, v165
    ds_read_b128 a[92:95], v10 offset:23552
    v_mfma_f32_16x16x32_bf16 v[96:99], v[68:71], a[172:175], v[96:99]
    v_mul_f32 v166, v166, v162
    v_mul_f32 v167, v167, v163
    ds_read_b128 a[164:167], v11 offset:5120
    v_mfma_f32_16x16x32_bf16 v[96:99], v[72:75], a[176:179], v[96:99]
    v_mul_f32 v168, v168, v164
    v_mul_f32 v169, v169, v165
    ds_read_b128 a[236:239], v11 offset:23552
    v_mfma_f32_16x16x32_bf16 v[100:103], v[64:67], a[240:243], v[100:103]
    buffer_load_dwordx4 v[60:63], v187, s[48:51], s23 offen offset:2048 sc1
    v_mfma_f32_16x16x32_bf16 v[100:103], v[68:71], a[244:247], v[100:103]
    v_cvt_pk_bf16_f32 v170, v166, v167
    v_cvt_pk_bf16_f32 v171, v168, v169
    v_mfma_f32_16x16x32_bf16 v[100:103], v[72:75], a[248:251], v[100:103]
    ds_write_b64 v12, v[170:171] offset:18432
    s_waitcnt vmcnt(12)
    v_mfma_f32_16x16x32_bf16 v[104:107], v[76:79], a[24:27], v[104:107]
    v_mul_f32 v152, v128, v128
    v_mul_f32 v153, v129, v129
    ds_read_b128 a[24:27], v10 offset:6144
    v_mfma_f32_16x16x32_bf16 v[104:107], v[80:83], a[28:31], v[104:107]
    buffer_load_dwordx4 v[64:67], v187, s[48:51], s23 offen offset:3072 sc1
    v_mfma_f32_16x16x32_bf16 v[104:107], v[84:87], a[32:35], v[104:107]
    v_mul_f32 v154, v130, v130
    v_mul_f32 v155, v131, v131
    v_mfma_f32_16x16x32_bf16 v[108:111], v[76:79], a[96:99], v[108:111]
    v_fma_f32 v152, v152, v13, v6
    v_fma_f32 v153, v153, v13, v6
    ds_read_b128 a[96:99], v10 offset:24576
    v_mfma_f32_16x16x32_bf16 v[108:111], v[80:83], a[100:103], v[108:111]
    v_fma_f32 v154, v154, v13, v6
    v_fma_f32 v155, v155, v13, v6
    v_mfma_f32_16x16x32_bf16 v[108:111], v[84:87], a[104:107], v[108:111]
    buffer_load_dwordx4 v[68:71], v188, s[48:51], s23 offen offset:0 sc1
    v_mfma_f32_16x16x32_bf16 v[112:115], v[76:79], a[168:171], v[112:115]
    v_mul_f32 v152, v128, v152
    v_mul_f32 v153, v129, v153
    ds_read_b128 a[168:171], v11 offset:6144
    v_mfma_f32_16x16x32_bf16 v[112:115], v[80:83], a[172:175], v[112:115]
    v_mul_f32 v154, v130, v154
    v_mul_f32 v155, v131, v155
    v_mfma_f32_16x16x32_bf16 v[112:115], v[84:87], a[176:179], v[112:115]
    v_exp_f32 v152, v152
    v_mfma_f32_16x16x32_bf16 v[116:119], v[76:79], a[240:243], v[116:119]
    buffer_load_dwordx4 v[72:75], v188, s[48:51], s23 offen offset:1024 sc1
    v_mfma_f32_16x16x32_bf16 v[116:119], v[80:83], a[244:247], v[116:119]
    v_exp_f32 v153, v153
    ds_read_b128 a[240:243], v11 offset:24576
    v_mfma_f32_16x16x32_bf16 v[116:119], v[84:87], a[248:251], v[116:119]
    v_exp_f32 v154, v154
    ds_read_b128 a[28:31], v10 offset:7168
    s_waitcnt vmcnt(12)
    v_mfma_f32_16x16x32_bf16 v[88:91], v[16:19], a[36:39], v[88:91]
    v_exp_f32 v155, v155
    ds_read_b128 a[100:103], v10 offset:25600
    v_mfma_f32_16x16x32_bf16 v[88:91], v[20:23], a[40:43], v[88:91]
    buffer_load_dwordx4 v[76:79], v188, s[48:51], s23 offen offset:2048 sc1
    v_mfma_f32_16x16x32_bf16 v[88:91], v[24:27], a[44:47], v[88:91]
    v_mul_f32 v156, v128, v144
    v_mul_f32 v157, v129, v145
    ds_read_b128 a[172:175], v11 offset:7168
    v_mfma_f32_16x16x32_bf16 v[92:95], v[16:19], a[108:111], v[92:95]
    v_mul_f32 v158, v130, v146
    v_mul_f32 v159, v131, v147
    ds_read_b128 a[244:247], v11 offset:25600
    v_mfma_f32_16x16x32_bf16 v[92:95], v[20:23], a[112:115], v[92:95]
    v_fma_f32 v152, v152, v195, v195
    v_fma_f32 v153, v153, v195, v195
    ds_read_b128 a[32:35], v10 offset:8192
    v_mfma_f32_16x16x32_bf16 v[92:95], v[24:27], a[116:119], v[92:95]
    buffer_load_dwordx4 v[80:83], v188, s[48:51], s23 offen offset:3072 sc1
    v_mfma_f32_16x16x32_bf16 v[96:99], v[16:19], a[180:183], v[96:99]
    v_fma_f32 v154, v154, v195, v195
    v_fma_f32 v155, v155, v195, v195
    ds_read_b128 a[104:107], v10 offset:26624
    v_mfma_f32_16x16x32_bf16 v[96:99], v[20:23], a[184:187], v[96:99]
    v_rcp_f32 v152, v152
    ds_read_b128 a[176:179], v11 offset:8192
    v_mfma_f32_16x16x32_bf16 v[96:99], v[24:27], a[188:191], v[96:99]
    v_rcp_f32 v153, v153
    ds_read_b128 a[248:251], v11 offset:26624
    v_mfma_f32_16x16x32_bf16 v[100:103], v[16:19], a[252:255], v[100:103]
    buffer_load_dwordx4 v[84:87], v189, s[48:51], s23 offen offset:0 sc1
    v_mfma_f32_16x16x32_bf16 v[100:103], v[20:23], v[220:223], v[100:103]
    v_rcp_f32 v154, v154
    v_mfma_f32_16x16x32_bf16 v[100:103], v[24:27], v[224:227], v[100:103]
    v_rcp_f32 v155, v155
    s_waitcnt vmcnt(12)
    v_mfma_f32_16x16x32_bf16 v[104:107], v[28:31], a[36:39], v[104:107]
    v_mul_f32 v156, v156, v152
    v_mul_f32 v157, v157, v153
    ds_read_b128 a[36:39], v10 offset:9216
    v_mfma_f32_16x16x32_bf16 v[104:107], v[32:35], a[40:43], v[104:107]
    buffer_load_dwordx4 v[16:19], v189, s[48:51], s23 offen offset:1024 sc1
    v_mfma_f32_16x16x32_bf16 v[104:107], v[36:39], a[44:47], v[104:107]
    v_mul_f32 v158, v158, v154
    v_mul_f32 v159, v159, v155
    v_mfma_f32_16x16x32_bf16 v[108:111], v[28:31], a[108:111], v[108:111]
    v_cvt_pk_bf16_f32 v160, v156, v157
    v_cvt_pk_bf16_f32 v161, v158, v159
    ds_read_b128 a[108:111], v10 offset:27648
    v_mfma_f32_16x16x32_bf16 v[108:111], v[32:35], a[112:115], v[108:111]
    ds_write_b64 v12, v[160:161] offset:36864
    v_mfma_f32_16x16x32_bf16 v[108:111], v[36:39], a[116:119], v[108:111]
    buffer_load_dwordx4 v[20:23], v189, s[48:51], s23 offen offset:2048 sc1
    v_mfma_f32_16x16x32_bf16 v[112:115], v[28:31], a[180:183], v[112:115]
    v_mul_f32 v162, v132, v132
    v_mul_f32 v163, v133, v133
    ds_read_b128 a[180:183], v11 offset:9216
    v_mfma_f32_16x16x32_bf16 v[112:115], v[32:35], a[184:187], v[112:115]
    v_mul_f32 v164, v134, v134
    v_mul_f32 v165, v135, v135
    v_mfma_f32_16x16x32_bf16 v[112:115], v[36:39], a[188:191], v[112:115]
    v_fma_f32 v162, v162, v14, v7
    v_fma_f32 v163, v163, v14, v7
    v_mfma_f32_16x16x32_bf16 v[116:119], v[28:31], a[252:255], v[116:119]
    buffer_load_dwordx4 v[24:27], v189, s[48:51], s23 offen offset:3072 sc1
    v_mfma_f32_16x16x32_bf16 v[116:119], v[32:35], v[220:223], v[116:119]
    v_fma_f32 v164, v164, v14, v7
    v_fma_f32 v165, v165, v14, v7
    ds_read_b128 a[252:255], v11 offset:27648
    v_mfma_f32_16x16x32_bf16 v[116:119], v[36:39], v[224:227], v[116:119]
    v_mul_f32 v162, v132, v162
    v_mul_f32 v163, v133, v163
    ds_read_b128 a[40:43], v10 offset:10240
    s_waitcnt vmcnt(12)
    v_mfma_f32_16x16x32_bf16 v[88:91], v[40:43], a[48:51], v[88:91]
    v_mul_f32 v164, v134, v164
    v_mul_f32 v165, v135, v165
    ds_read_b128 a[112:115], v10 offset:28672
    v_mfma_f32_16x16x32_bf16 v[88:91], v[44:47], a[52:55], v[88:91]
    buffer_load_dwordx4 v[28:31], v190, s[48:51], s23 offen offset:0 sc1
    v_mfma_f32_16x16x32_bf16 v[88:91], v[48:51], a[56:59], v[88:91]
    v_exp_f32 v162, v162
    ds_read_b128 a[184:187], v11 offset:10240
    v_mfma_f32_16x16x32_bf16 v[92:95], v[40:43], a[120:123], v[92:95]
    v_exp_f32 v163, v163
    ds_read_b128 v[220:223], v11 offset:28672
    v_mfma_f32_16x16x32_bf16 v[92:95], v[44:47], a[124:127], v[92:95]
    v_exp_f32 v164, v164
    ds_read_b128 a[44:47], v10 offset:11264
    v_mfma_f32_16x16x32_bf16 v[92:95], v[48:51], a[128:131], v[92:95]
    buffer_load_dwordx4 v[32:35], v190, s[48:51], s23 offen offset:1024 sc1
    v_mfma_f32_16x16x32_bf16 v[96:99], v[40:43], a[192:195], v[96:99]
    v_exp_f32 v165, v165
    ds_read_b128 a[116:119], v10 offset:29696
    v_mfma_f32_16x16x32_bf16 v[96:99], v[44:47], a[196:199], v[96:99]
    v_mul_f32 v166, v132, v148
    v_mul_f32 v167, v133, v149
    ds_read_b128 a[188:191], v11 offset:11264
    v_mfma_f32_16x16x32_bf16 v[96:99], v[48:51], a[200:203], v[96:99]
    v_mul_f32 v168, v134, v150
    v_mul_f32 v169, v135, v151
    ds_read_b128 v[224:227], v11 offset:29696
    v_mfma_f32_16x16x32_bf16 v[100:103], v[40:43], v[228:231], v[100:103]
    buffer_load_dwordx4 v[36:39], v190, s[48:51], s23 offen offset:2048 sc1
    v_mfma_f32_16x16x32_bf16 v[100:103], v[44:47], v[232:235], v[100:103]
    v_fma_f32 v162, v162, v252, v252
    v_fma_f32 v163, v163, v252, v252
    v_mfma_f32_16x16x32_bf16 v[100:103], v[48:51], v[236:239], v[100:103]
    v_fma_f32 v164, v164, v252, v252
    v_fma_f32 v165, v165, v252, v252
    s_waitcnt vmcnt(12)
    v_mfma_f32_16x16x32_bf16 v[104:107], v[52:55], a[48:51], v[104:107]
    v_rcp_f32 v162, v162
    ds_read_b128 a[48:51], v10 offset:12288
    v_mfma_f32_16x16x32_bf16 v[104:107], v[56:59], a[52:55], v[104:107]
    buffer_load_dwordx4 v[40:43], v190, s[48:51], s23 offen offset:3072 sc1
    v_mfma_f32_16x16x32_bf16 v[104:107], v[60:63], a[56:59], v[104:107]
    v_rcp_f32 v163, v163
    v_mfma_f32_16x16x32_bf16 v[108:111], v[52:55], a[120:123], v[108:111]
    v_rcp_f32 v164, v164
    ds_read_b128 a[120:123], v10 offset:30720
    v_mfma_f32_16x16x32_bf16 v[108:111], v[56:59], a[124:127], v[108:111]
    v_rcp_f32 v165, v165
    v_mfma_f32_16x16x32_bf16 v[108:111], v[60:63], a[128:131], v[108:111]
    buffer_load_dwordx4 v[44:47], v191, s[48:51], s23 offen offset:0 sc1
    v_mfma_f32_16x16x32_bf16 v[112:115], v[52:55], a[192:195], v[112:115]
    v_mul_f32 v166, v166, v162
    v_mul_f32 v167, v167, v163
    ds_read_b128 a[192:195], v11 offset:12288
    v_mfma_f32_16x16x32_bf16 v[112:115], v[56:59], a[196:199], v[112:115]
    v_mul_f32 v168, v168, v164
    v_mul_f32 v169, v169, v165
    v_mfma_f32_16x16x32_bf16 v[112:115], v[60:63], a[200:203], v[112:115]
    v_cvt_pk_bf16_f32 v170, v166, v167
    v_cvt_pk_bf16_f32 v171, v168, v169
    v_mfma_f32_16x16x32_bf16 v[116:119], v[52:55], v[228:231], v[116:119]
    buffer_load_dwordx4 v[48:51], v191, s[48:51], s23 offen offset:1024 sc1
    v_mfma_f32_16x16x32_bf16 v[116:119], v[56:59], v[232:235], v[116:119]
    ds_write_b64 v12, v[170:171] offset:55296
    v_mfma_f32_16x16x32_bf16 v[116:119], v[60:63], v[236:239], v[116:119]
    ds_read_b128 v[228:231], v11 offset:30720
    s_waitcnt vmcnt(12)
    v_mfma_f32_16x16x32_bf16 v[88:91], v[64:67], a[60:63], v[88:91]
    ds_read_b128 a[52:55], v10 offset:13312
    v_mfma_f32_16x16x32_bf16 v[88:91], v[68:71], a[64:67], v[88:91]
    buffer_load_dwordx4 v[52:55], v191, s[48:51], s23 offen offset:2048 sc1
    v_mfma_f32_16x16x32_bf16 v[120:123], v[72:75], a[68:71], v[88:91]
    ds_read_b128 a[124:127], v10 offset:31744
    v_mfma_f32_16x16x32_bf16 v[92:95], v[64:67], a[132:135], v[92:95]
    ds_read_b128 a[196:199], v11 offset:13312
    v_mfma_f32_16x16x32_bf16 v[92:95], v[68:71], a[136:139], v[92:95]
    ds_read_b128 v[232:235], v11 offset:31744
    v_mfma_f32_16x16x32_bf16 v[124:127], v[72:75], a[140:143], v[92:95]
    buffer_load_dwordx4 v[56:59], v191, s[48:51], s23 offen offset:3072 sc1
    v_mfma_f32_16x16x32_bf16 v[96:99], v[64:67], a[204:207], v[96:99]
    v_mfma_f32_16x16x32_bf16 v[96:99], v[68:71], a[208:211], v[96:99]
    v_mfma_f32_16x16x32_bf16 v[128:131], v[72:75], a[212:215], v[96:99]
    v_mfma_f32_16x16x32_bf16 v[100:103], v[64:67], v[240:243], v[100:103]
    buffer_load_dwordx4 v[60:63], v192, s[48:51], s23 offen offset:0 sc1
    v_mfma_f32_16x16x32_bf16 v[100:103], v[68:71], v[244:247], v[100:103]
    v_mfma_f32_16x16x32_bf16 v[132:135], v[72:75], v[248:251], v[100:103]
    s_waitcnt vmcnt(12)
    v_mfma_f32_16x16x32_bf16 v[104:107], v[76:79], a[60:63], v[104:107]
    v_mfma_f32_16x16x32_bf16 v[104:107], v[80:83], a[64:67], v[104:107]
    buffer_load_dwordx4 v[64:67], v192, s[48:51], s23 offen offset:1024 sc1
    v_mfma_f32_16x16x32_bf16 v[136:139], v[84:87], a[68:71], v[104:107]
    v_mfma_f32_16x16x32_bf16 v[108:111], v[76:79], a[132:135], v[108:111]
    v_mfma_f32_16x16x32_bf16 v[108:111], v[80:83], a[136:139], v[108:111]
    v_mfma_f32_16x16x32_bf16 v[140:143], v[84:87], a[140:143], v[108:111]
    buffer_load_dwordx4 v[68:71], v192, s[48:51], s23 offen offset:2048 sc1
    v_mfma_f32_16x16x32_bf16 v[112:115], v[76:79], a[204:207], v[112:115]
    v_mfma_f32_16x16x32_bf16 v[112:115], v[80:83], a[208:211], v[112:115]
    s_lshl_b32 s7, s25, 11
    v_mfma_f32_16x16x32_bf16 v[144:147], v[84:87], a[212:215], v[112:115]
    s_add_u32 s7, s7, s28
    v_mfma_f32_16x16x32_bf16 v[116:119], v[76:79], v[240:243], v[116:119]
    buffer_load_dwordx4 v[72:75], v192, s[48:51], s23 offen offset:3072 sc1
    v_mfma_f32_16x16x32_bf16 v[116:119], v[80:83], v[244:247], v[116:119]
    s_add_u32 s23, s23, 36864
    v_mfma_f32_16x16x32_bf16 v[148:151], v[84:87], v[248:251], v[116:119]
    v_add_u32 v12, s7, v184
    s_add_u32 s25, s25, 1
    s_waitcnt lgkmcnt(0)
    s_barrier
    v_pk_mul_f32 v[152:153], v[120:121], v[120:121]
    ds_read_b128 a[56:59], v10 offset:14336
    v_pk_mul_f32 v[154:155], v[122:123], v[122:123]
    ds_read_b128 a[128:131], v10 offset:32768
    v_pk_fma_f32 v[152:153], v[152:153], v[8:9], v[4:5] op_sel:[0,0,0] op_sel_hi:[1,0,0]
    ds_read_b128 a[200:203], v11 offset:14336
    v_pk_fma_f32 v[154:155], v[154:155], v[8:9], v[4:5] op_sel:[0,0,0] op_sel_hi:[1,0,0]
    v_pk_mul_f32 v[152:153], v[120:121], v[152:153]
    ds_read_b128 v[236:239], v11 offset:32768
    v_pk_mul_f32 v[154:155], v[122:123], v[154:155]
    ds_read_b128 a[60:63], v10 offset:15360
    buffer_load_dwordx4 v[76:79], v184, s[48:51], s23 offen offset:0 sc1
    v_exp_f32 v152, v152
    ds_read_b128 a[132:135], v10 offset:33792
    v_exp_f32 v153, v153
    v_exp_f32 v154, v154
    ds_read_b128 a[204:207], v11 offset:15360
    v_exp_f32 v155, v155
    ds_read_b128 v[240:243], v11 offset:33792
    v_pk_mul_f32 v[156:157], v[120:121], v[136:137]
    v_pk_mul_f32 v[158:159], v[122:123], v[138:139]
    buffer_load_dwordx4 v[80:83], v184, s[48:51], s23 offen offset:1024 sc1
    v_pk_fma_f32 v[152:153], v[152:153], v[192:193], v[192:193] op_sel:[0,1,1] op_sel_hi:[1,1,1]
    v_pk_fma_f32 v[154:155], v[154:155], v[192:193], v[192:193] op_sel:[0,1,1] op_sel_hi:[1,1,1]
    v_rcp_f32 v152, v152
    v_rcp_f32 v153, v153
    v_rcp_f32 v154, v154
    v_rcp_f32 v155, v155
    buffer_load_dwordx4 v[84:87], v184, s[48:51], s23 offen offset:2048 sc1
    s_nop 0
    v_pk_mul_f32 v[156:157], v[156:157], v[152:153]
    v_pk_mul_f32 v[158:159], v[158:159], v[154:155]
    v_cvt_pk_bf16_f32 v160, v156, v157
    v_cvt_pk_bf16_f32 v161, v158, v159
    ds_write_b64 v12, v[160:161] offset:0
    buffer_load_dwordx4 v[104:107], v184, s[48:51], s23 offen offset:3072 sc1
    v_pk_mul_f32 v[162:163], v[124:125], v[124:125]
    v_pk_mul_f32 v[164:165], v[126:127], v[126:127]
    v_pk_fma_f32 v[162:163], v[162:163], v[8:9], v[4:5] op_sel:[0,1,1] op_sel_hi:[1,1,1]
    v_pk_fma_f32 v[164:165], v[164:165], v[8:9], v[4:5] op_sel:[0,1,1] op_sel_hi:[1,1,1]
    v_pk_mul_f32 v[162:163], v[124:125], v[162:163]
    v_pk_mul_f32 v[164:165], v[126:127], v[164:165]
    buffer_load_dwordx4 v[108:111], v185, s[48:51], s23 offen offset:0 sc1
    v_exp_f32 v162, v162
    v_exp_f32 v163, v163
    v_exp_f32 v164, v164
    v_exp_f32 v165, v165
    v_pk_mul_f32 v[166:167], v[124:125], v[140:141]
    v_pk_mul_f32 v[168:169], v[126:127], v[142:143]
    buffer_load_dwordx4 v[112:115], v185, s[48:51], s23 offen offset:1024 sc1
    v_pk_fma_f32 v[162:163], v[162:163], v[194:195], v[194:195] op_sel:[0,0,0] op_sel_hi:[1,0,0]
    v_pk_fma_f32 v[164:165], v[164:165], v[194:195], v[194:195] op_sel:[0,0,0] op_sel_hi:[1,0,0]
    v_rcp_f32 v162, v162
    v_rcp_f32 v163, v163
    v_rcp_f32 v164, v164
    v_rcp_f32 v165, v165
    buffer_load_dwordx4 v[116:119], v185, s[48:51], s23 offen offset:2048 sc1
    s_nop 0
    v_pk_mul_f32 v[166:167], v[166:167], v[162:163]
    v_pk_mul_f32 v[168:169], v[168:169], v[164:165]
    v_cvt_pk_bf16_f32 v170, v166, v167
    v_cvt_pk_bf16_f32 v171, v168, v169
    ds_write_b64 v12, v[170:171] offset:18432
    buffer_load_dwordx4 v[180:183], v185, s[48:51], s23 offen offset:3072 sc1
    v_pk_mul_f32 v[152:153], v[128:129], v[128:129]
    v_pk_mul_f32 v[154:155], v[130:131], v[130:131]
    v_pk_fma_f32 v[152:153], v[152:153], v[12:13], v[6:7] op_sel:[0,1,0] op_sel_hi:[1,1,0]
    v_pk_fma_f32 v[154:155], v[154:155], v[12:13], v[6:7] op_sel:[0,1,0] op_sel_hi:[1,1,0]
    v_pk_mul_f32 v[152:153], v[128:129], v[152:153]
    v_pk_mul_f32 v[154:155], v[130:131], v[154:155]
    buffer_load_dwordx4 v[196:199], v186, s[48:51], s23 offen offset:0 sc1
    v_exp_f32 v152, v152
    v_exp_f32 v153, v153
    v_exp_f32 v154, v154
    v_exp_f32 v155, v155
    v_pk_mul_f32 v[156:157], v[128:129], v[144:145]
    v_pk_mul_f32 v[158:159], v[130:131], v[146:147]
    buffer_load_dwordx4 v[200:203], v186, s[48:51], s23 offen offset:1024 sc1
    v_pk_fma_f32 v[152:153], v[152:153], v[194:195], v[194:195] op_sel:[0,1,1] op_sel_hi:[1,1,1]
    v_pk_fma_f32 v[154:155], v[154:155], v[194:195], v[194:195] op_sel:[0,1,1] op_sel_hi:[1,1,1]
    v_rcp_f32 v152, v152
    v_rcp_f32 v153, v153
    v_rcp_f32 v154, v154
    v_rcp_f32 v155, v155
    buffer_load_dwordx4 v[204:207], v186, s[48:51], s23 offen offset:2048 sc1
    s_nop 0
    v_pk_mul_f32 v[156:157], v[156:157], v[152:153]
    v_pk_mul_f32 v[158:159], v[158:159], v[154:155]
    v_cvt_pk_bf16_f32 v160, v156, v157
    v_cvt_pk_bf16_f32 v161, v158, v159
    ds_write_b64 v12, v[160:161] offset:36864
    buffer_load_dwordx4 v[208:211], v186, s[48:51], s23 offen offset:3072 sc1
    v_pk_mul_f32 v[162:163], v[132:133], v[132:133]
    v_pk_mul_f32 v[164:165], v[134:135], v[134:135]
    v_pk_fma_f32 v[162:163], v[162:163], v[14:15], v[6:7] op_sel:[0,0,1] op_sel_hi:[1,0,1]
    v_pk_fma_f32 v[164:165], v[164:165], v[14:15], v[6:7] op_sel:[0,0,1] op_sel_hi:[1,0,1]
    v_pk_mul_f32 v[162:163], v[132:133], v[162:163]
    v_pk_mul_f32 v[164:165], v[134:135], v[164:165]
    buffer_load_dwordx4 v[212:215], v187, s[48:51], s23 offen offset:0 sc1
    v_exp_f32 v162, v162
    v_exp_f32 v163, v163
    v_exp_f32 v164, v164
    v_exp_f32 v165, v165
    v_pk_mul_f32 v[166:167], v[132:133], v[148:149]
    v_pk_mul_f32 v[168:169], v[134:135], v[150:151]
    v_pk_fma_f32 v[162:163], v[162:163], v[252:253], v[252:253] op_sel:[0,0,0] op_sel_hi:[1,0,0]
    v_pk_fma_f32 v[164:165], v[164:165], v[252:253], v[252:253] op_sel:[0,0,0] op_sel_hi:[1,0,0]
    v_rcp_f32 v162, v162
    v_rcp_f32 v163, v163
    v_rcp_f32 v164, v164
    v_rcp_f32 v165, v165
    s_nop 0
    v_pk_mul_f32 v[166:167], v[166:167], v[162:163]
    v_pk_mul_f32 v[168:169], v[168:169], v[164:165]
    v_cvt_pk_bf16_f32 v170, v166, v167
    v_cvt_pk_bf16_f32 v171, v168, v169
    ds_write_b64 v12, v[170:171] offset:55296
    buffer_load_dwordx4 v[136:139], v187, s[48:51], s23 offen offset:1024 sc1
    buffer_load_dwordx4 v[140:143], v187, s[48:51], s23 offen offset:2048 sc1
    buffer_load_dwordx4 v[144:147], v187, s[48:51], s23 offen offset:3072 sc1
    buffer_load_dwordx4 v[160:163], v188, s[48:51], s23 offen offset:0 sc1
    buffer_load_dwordx4 v[164:167], v188, s[48:51], s23 offen offset:1024 sc1
    s_add_u32 s23, s23, 18432
    s_waitcnt lgkmcnt(0)
    s_barrier
    ds_read_b128 a[64:67], v10 offset:16384
    ds_read_b128 a[136:139], v10 offset:34816
    ds_read_b128 a[208:211], v11 offset:16384
    ds_read_b128 v[244:247], v11 offset:34816
    ds_read_b128 a[68:71], v10 offset:17408
    ds_read_b128 a[140:143], v10 offset:35840
    ds_read_b128 a[212:215], v11 offset:17408
    ds_read_b128 v[248:251], v11 offset:35840
    s_mov_b32 s25, 0
    s_waitcnt lgkmcnt(0)
    s_branch L_ffn_dn_mid_36
L_ffn_dn_35:
    s_waitcnt vmcnt(32)
    v_mfma_f32_16x16x32_bf16 v[88:91], v[104:107], a[0:3], 0
    v_mfma_f32_16x16x32_bf16 v[88:91], v[108:111], a[4:7], v[88:91]
    buffer_load_dwordx4 v[76:79], v184, s[48:51], s23 offen offset:0 sc1
    v_mfma_f32_16x16x32_bf16 v[88:91], v[112:115], a[8:11], v[88:91]
    v_mfma_f32_16x16x32_bf16 v[92:95], v[104:107], a[72:75], 0
    v_mfma_f32_16x16x32_bf16 v[92:95], v[108:111], a[76:79], v[92:95]
    v_mfma_f32_16x16x32_bf16 v[92:95], v[112:115], a[80:83], v[92:95]
    buffer_load_dwordx4 v[80:83], v184, s[48:51], s23 offen offset:1024 sc1
    v_mfma_f32_16x16x32_bf16 v[96:99], v[104:107], a[144:147], 0
    v_cvt_pk_bf16_f32 v152, v120, v121
    v_cvt_pk_bf16_f32 v153, v122, v123
    v_mfma_f32_16x16x32_bf16 v[96:99], v[108:111], a[148:151], v[96:99]
    v_cvt_pk_bf16_f32 v154, v124, v125
    v_cvt_pk_bf16_f32 v155, v126, v127
    v_mfma_f32_16x16x32_bf16 v[96:99], v[112:115], a[152:155], v[96:99]
    v_cvt_pk_bf16_f32 v156, v128, v129
    v_cvt_pk_bf16_f32 v157, v130, v131
    v_mfma_f32_16x16x32_bf16 v[100:103], v[104:107], a[216:219], 0
    buffer_load_dwordx4 v[84:87], v184, s[48:51], s23 offen offset:2048 sc1
    v_mfma_f32_16x16x32_bf16 v[100:103], v[108:111], a[220:223], v[100:103]
    v_cvt_pk_bf16_f32 v158, v132, v133
    v_cvt_pk_bf16_f32 v159, v134, v135
    v_mfma_f32_16x16x32_bf16 v[100:103], v[112:115], a[224:227], v[100:103]
    v_permlane16_swap_b32 v152, v154
    s_waitcnt vmcnt(32)
    v_mfma_f32_16x16x32_bf16 v[88:91], v[116:119], a[12:15], v[88:91]
    v_permlane16_swap_b32 v153, v155
    v_mfma_f32_16x16x32_bf16 v[88:91], v[180:183], a[16:19], v[88:91]
    buffer_load_dwordx4 v[104:107], v184, s[48:51], s23 offen offset:3072 sc1
    v_mfma_f32_16x16x32_bf16 v[88:91], v[196:199], a[20:23], v[88:91]
    v_permlane16_swap_b32 v156, v158
    v_mfma_f32_16x16x32_bf16 v[92:95], v[116:119], a[84:87], v[92:95]
    v_permlane16_swap_b32 v157, v159
    v_mfma_f32_16x16x32_bf16 v[92:95], v[180:183], a[88:91], v[92:95]
    buffer_store_dwordx4 v[152:155], v178, s[72:75], s27 offen sc1
    v_mfma_f32_16x16x32_bf16 v[92:95], v[196:199], a[92:95], v[92:95]
    buffer_load_dwordx4 v[108:111], v185, s[48:51], s23 offen offset:0 sc1
    v_mfma_f32_16x16x32_bf16 v[96:99], v[116:119], a[156:159], v[96:99]
    buffer_store_dwordx4 v[156:159], v179, s[72:75], s27 offen sc1
    v_mfma_f32_16x16x32_bf16 v[96:99], v[180:183], a[160:163], v[96:99]
    ds_write_b128 v216, v[152:155]
    v_mfma_f32_16x16x32_bf16 v[96:99], v[196:199], a[164:167], v[96:99]
    v_add_u32 v216, v216, v218
    v_mfma_f32_16x16x32_bf16 v[100:103], v[116:119], a[228:231], v[100:103]
    buffer_load_dwordx4 v[112:115], v185, s[48:51], s23 offen offset:1024 sc1
    v_mfma_f32_16x16x32_bf16 v[100:103], v[180:183], a[232:235], v[100:103]
    ds_write_b128 v217, v[156:159]
    v_mfma_f32_16x16x32_bf16 v[100:103], v[196:199], a[236:239], v[100:103]
    v_add_u32 v217, v217, v219
    s_waitcnt vmcnt(34)
    v_mfma_f32_16x16x32_bf16 v[88:91], v[200:203], a[24:27], v[88:91]
    v_mfma_f32_16x16x32_bf16 v[88:91], v[204:207], a[28:31], v[88:91]
    buffer_load_dwordx4 v[116:119], v185, s[48:51], s23 offen offset:2048 sc1
    v_mfma_f32_16x16x32_bf16 v[88:91], v[208:211], a[32:35], v[88:91]
    v_mfma_f32_16x16x32_bf16 v[92:95], v[200:203], a[96:99], v[92:95]
    v_mfma_f32_16x16x32_bf16 v[92:95], v[204:207], a[100:103], v[92:95]
    v_mfma_f32_16x16x32_bf16 v[92:95], v[208:211], a[104:107], v[92:95]
    buffer_load_dwordx4 v[180:183], v185, s[48:51], s23 offen offset:3072 sc1
    v_mfma_f32_16x16x32_bf16 v[96:99], v[200:203], a[168:171], v[96:99]
    v_mfma_f32_16x16x32_bf16 v[96:99], v[204:207], a[172:175], v[96:99]
    v_mfma_f32_16x16x32_bf16 v[96:99], v[208:211], a[176:179], v[96:99]
    v_mfma_f32_16x16x32_bf16 v[100:103], v[200:203], a[240:243], v[100:103]
    buffer_load_dwordx4 v[196:199], v186, s[48:51], s23 offen offset:0 sc1
    v_mfma_f32_16x16x32_bf16 v[100:103], v[204:207], a[244:247], v[100:103]
    v_mfma_f32_16x16x32_bf16 v[100:103], v[208:211], a[248:251], v[100:103]
    s_waitcnt vmcnt(34)
    v_mfma_f32_16x16x32_bf16 v[88:91], v[212:215], a[36:39], v[88:91]
    v_mfma_f32_16x16x32_bf16 v[88:91], v[136:139], a[40:43], v[88:91]
    buffer_load_dwordx4 v[200:203], v186, s[48:51], s23 offen offset:1024 sc1
    v_mfma_f32_16x16x32_bf16 v[88:91], v[140:143], a[44:47], v[88:91]
    v_mfma_f32_16x16x32_bf16 v[92:95], v[212:215], a[108:111], v[92:95]
    v_mfma_f32_16x16x32_bf16 v[92:95], v[136:139], a[112:115], v[92:95]
    v_mfma_f32_16x16x32_bf16 v[92:95], v[140:143], a[116:119], v[92:95]
    buffer_load_dwordx4 v[204:207], v186, s[48:51], s23 offen offset:2048 sc1
    v_mfma_f32_16x16x32_bf16 v[96:99], v[212:215], a[180:183], v[96:99]
    v_mfma_f32_16x16x32_bf16 v[96:99], v[136:139], a[184:187], v[96:99]
    v_mfma_f32_16x16x32_bf16 v[96:99], v[140:143], a[188:191], v[96:99]
    v_mfma_f32_16x16x32_bf16 v[100:103], v[212:215], a[252:255], v[100:103]
    buffer_load_dwordx4 v[208:211], v186, s[48:51], s23 offen offset:3072 sc1
    v_mfma_f32_16x16x32_bf16 v[100:103], v[136:139], v[220:223], v[100:103]
    v_mfma_f32_16x16x32_bf16 v[100:103], v[140:143], v[224:227], v[100:103]
    s_waitcnt vmcnt(34)
    v_mfma_f32_16x16x32_bf16 v[88:91], v[144:147], a[48:51], v[88:91]
    v_mfma_f32_16x16x32_bf16 v[88:91], v[160:163], a[52:55], v[88:91]
    buffer_load_dwordx4 v[212:215], v187, s[48:51], s23 offen offset:0 sc1
    v_mfma_f32_16x16x32_bf16 v[88:91], v[164:167], a[56:59], v[88:91]
    v_mfma_f32_16x16x32_bf16 v[92:95], v[144:147], a[120:123], v[92:95]
    v_mfma_f32_16x16x32_bf16 v[92:95], v[160:163], a[124:127], v[92:95]
    v_mfma_f32_16x16x32_bf16 v[92:95], v[164:167], a[128:131], v[92:95]
    buffer_load_dwordx4 v[136:139], v187, s[48:51], s23 offen offset:1024 sc1
    v_mfma_f32_16x16x32_bf16 v[96:99], v[144:147], a[192:195], v[96:99]
    v_mfma_f32_16x16x32_bf16 v[96:99], v[160:163], a[196:199], v[96:99]
    v_mfma_f32_16x16x32_bf16 v[96:99], v[164:167], a[200:203], v[96:99]
    v_mfma_f32_16x16x32_bf16 v[100:103], v[144:147], v[228:231], v[100:103]
    buffer_load_dwordx4 v[140:143], v187, s[48:51], s23 offen offset:2048 sc1
    v_mfma_f32_16x16x32_bf16 v[100:103], v[160:163], v[232:235], v[100:103]
    v_mfma_f32_16x16x32_bf16 v[100:103], v[164:167], v[236:239], v[100:103]
    s_waitcnt vmcnt(34)
    v_mfma_f32_16x16x32_bf16 v[88:91], v[168:171], a[60:63], v[88:91]
    v_mfma_f32_16x16x32_bf16 v[88:91], v[148:151], a[64:67], v[88:91]
    buffer_load_dwordx4 v[144:147], v187, s[48:51], s23 offen offset:3072 sc1
    v_mfma_f32_16x16x32_bf16 v[120:123], v[4:7], a[68:71], v[88:91]
    v_mfma_f32_16x16x32_bf16 v[92:95], v[168:171], a[132:135], v[92:95]
    v_mfma_f32_16x16x32_bf16 v[92:95], v[148:151], a[136:139], v[92:95]
    v_mfma_f32_16x16x32_bf16 v[124:127], v[4:7], a[140:143], v[92:95]
    buffer_load_dwordx4 v[160:163], v188, s[48:51], s23 offen offset:0 sc1
    v_mfma_f32_16x16x32_bf16 v[96:99], v[168:171], a[204:207], v[96:99]
    s_mov_b32 s74, 268435456
    v_mfma_f32_16x16x32_bf16 v[96:99], v[148:151], a[208:211], v[96:99]
    s_add_u32 s27, s27, 1024
    v_mfma_f32_16x16x32_bf16 v[128:131], v[4:7], a[212:215], v[96:99]
    s_add_u32 s25, s25, 1
    v_mfma_f32_16x16x32_bf16 v[100:103], v[168:171], v[240:243], v[100:103]
    buffer_load_dwordx4 v[164:167], v188, s[48:51], s23 offen offset:1024 sc1
    v_mfma_f32_16x16x32_bf16 v[100:103], v[148:151], v[244:247], v[100:103]
    s_add_u32 s23, s23, 18432
    v_mfma_f32_16x16x32_bf16 v[132:135], v[4:7], v[248:251], v[100:103]
L_ffn_dn_mid_36:
    s_waitcnt vmcnt(30)
    v_mfma_f32_16x16x32_bf16 v[88:91], v[16:19], a[0:3], 0
    v_mfma_f32_16x16x32_bf16 v[88:91], v[20:23], a[4:7], v[88:91]
    buffer_load_dwordx4 v[168:171], v184, s[48:51], s23 offen offset:0 sc1
    v_mfma_f32_16x16x32_bf16 v[88:91], v[24:27], a[8:11], v[88:91]
    v_mfma_f32_16x16x32_bf16 v[92:95], v[16:19], a[72:75], 0
    v_mfma_f32_16x16x32_bf16 v[92:95], v[20:23], a[76:79], v[92:95]
    v_mfma_f32_16x16x32_bf16 v[92:95], v[24:27], a[80:83], v[92:95]
    buffer_load_dwordx4 v[148:151], v184, s[48:51], s23 offen offset:1024 sc1
    v_mfma_f32_16x16x32_bf16 v[96:99], v[16:19], a[144:147], 0
    v_cvt_pk_bf16_f32 v152, v120, v121
    v_cvt_pk_bf16_f32 v153, v122, v123
    v_mfma_f32_16x16x32_bf16 v[96:99], v[20:23], a[148:151], v[96:99]
    v_cvt_pk_bf16_f32 v154, v124, v125
    v_cvt_pk_bf16_f32 v155, v126, v127
    v_mfma_f32_16x16x32_bf16 v[96:99], v[24:27], a[152:155], v[96:99]
    v_cvt_pk_bf16_f32 v156, v128, v129
    v_cvt_pk_bf16_f32 v157, v130, v131
    v_mfma_f32_16x16x32_bf16 v[100:103], v[16:19], a[216:219], 0
    buffer_load_dwordx4 v[4:7], v184, s[48:51], s23 offen offset:2048 sc1
    v_mfma_f32_16x16x32_bf16 v[100:103], v[20:23], a[220:223], v[100:103]
    v_cvt_pk_bf16_f32 v158, v132, v133
    v_cvt_pk_bf16_f32 v159, v134, v135
    v_mfma_f32_16x16x32_bf16 v[100:103], v[24:27], a[224:227], v[100:103]
    v_permlane16_swap_b32 v152, v154
    s_waitcnt vmcnt(30)
    v_mfma_f32_16x16x32_bf16 v[88:91], v[28:31], a[12:15], v[88:91]
    v_permlane16_swap_b32 v153, v155
    v_mfma_f32_16x16x32_bf16 v[88:91], v[32:35], a[16:19], v[88:91]
    buffer_load_dwordx4 v[16:19], v184, s[48:51], s23 offen offset:3072 sc1
    v_mfma_f32_16x16x32_bf16 v[88:91], v[36:39], a[20:23], v[88:91]
    v_permlane16_swap_b32 v156, v158
    v_mfma_f32_16x16x32_bf16 v[92:95], v[28:31], a[84:87], v[92:95]
    v_permlane16_swap_b32 v157, v159
    v_mfma_f32_16x16x32_bf16 v[92:95], v[32:35], a[88:91], v[92:95]
    buffer_store_dwordx4 v[152:155], v178, s[72:75], s27 offen sc1
    v_mfma_f32_16x16x32_bf16 v[92:95], v[36:39], a[92:95], v[92:95]
    buffer_load_dwordx4 v[20:23], v185, s[48:51], s23 offen offset:0 sc1
    v_mfma_f32_16x16x32_bf16 v[96:99], v[28:31], a[156:159], v[96:99]
    buffer_store_dwordx4 v[156:159], v179, s[72:75], s27 offen sc1
    v_mfma_f32_16x16x32_bf16 v[96:99], v[32:35], a[160:163], v[96:99]
    ds_write_b128 v216, v[152:155]
    v_mfma_f32_16x16x32_bf16 v[96:99], v[36:39], a[164:167], v[96:99]
    v_add_u32 v216, v216, v218
    v_mfma_f32_16x16x32_bf16 v[100:103], v[28:31], a[228:231], v[100:103]
    buffer_load_dwordx4 v[24:27], v185, s[48:51], s23 offen offset:1024 sc1
    v_mfma_f32_16x16x32_bf16 v[100:103], v[32:35], a[232:235], v[100:103]
    ds_write_b128 v217, v[156:159]
    v_mfma_f32_16x16x32_bf16 v[100:103], v[36:39], a[236:239], v[100:103]
    v_add_u32 v217, v217, v219
    s_waitcnt vmcnt(32)
    v_mfma_f32_16x16x32_bf16 v[88:91], v[40:43], a[24:27], v[88:91]
    v_mfma_f32_16x16x32_bf16 v[88:91], v[44:47], a[28:31], v[88:91]
    buffer_load_dwordx4 v[28:31], v185, s[48:51], s23 offen offset:2048 sc1
    v_mfma_f32_16x16x32_bf16 v[88:91], v[48:51], a[32:35], v[88:91]
    v_mfma_f32_16x16x32_bf16 v[92:95], v[40:43], a[96:99], v[92:95]
    v_mfma_f32_16x16x32_bf16 v[92:95], v[44:47], a[100:103], v[92:95]
    v_mfma_f32_16x16x32_bf16 v[92:95], v[48:51], a[104:107], v[92:95]
    buffer_load_dwordx4 v[32:35], v185, s[48:51], s23 offen offset:3072 sc1
    v_mfma_f32_16x16x32_bf16 v[96:99], v[40:43], a[168:171], v[96:99]
    v_mfma_f32_16x16x32_bf16 v[96:99], v[44:47], a[172:175], v[96:99]
    v_mfma_f32_16x16x32_bf16 v[96:99], v[48:51], a[176:179], v[96:99]
    v_mfma_f32_16x16x32_bf16 v[100:103], v[40:43], a[240:243], v[100:103]
    buffer_load_dwordx4 v[36:39], v186, s[48:51], s23 offen offset:0 sc1
    v_mfma_f32_16x16x32_bf16 v[100:103], v[44:47], a[244:247], v[100:103]
    v_mfma_f32_16x16x32_bf16 v[100:103], v[48:51], a[248:251], v[100:103]
    s_waitcnt vmcnt(32)
    s_cmp_lg_u32 s25, 6
    s_cbranch_scc1 L_early_37
    s_waitcnt vmcnt(24)
    s_barrier
    s_cmp_lg_u32 s3, 0
    s_cbranch_scc1 L_early_37
    v_lshlrev_b32 v15, 7, v0
    v_mov_b32 v1, s76
    s_mov_b64 exec, 0xff
    buffer_store_dword v1, v15, s[8:11], s29 offen sc1
    s_mov_b64 exec, -1
L_early_37:
    v_mfma_f32_16x16x32_bf16 v[88:91], v[52:55], a[36:39], v[88:91]
    v_mfma_f32_16x16x32_bf16 v[88:91], v[56:59], a[40:43], v[88:91]
    buffer_load_dwordx4 v[40:43], v186, s[48:51], s23 offen offset:1024 sc1
    v_mfma_f32_16x16x32_bf16 v[88:91], v[60:63], a[44:47], v[88:91]
    v_mfma_f32_16x16x32_bf16 v[92:95], v[52:55], a[108:111], v[92:95]
    v_mfma_f32_16x16x32_bf16 v[92:95], v[56:59], a[112:115], v[92:95]
    v_mfma_f32_16x16x32_bf16 v[92:95], v[60:63], a[116:119], v[92:95]
    buffer_load_dwordx4 v[44:47], v186, s[48:51], s23 offen offset:2048 sc1
    v_mfma_f32_16x16x32_bf16 v[96:99], v[52:55], a[180:183], v[96:99]
    v_mfma_f32_16x16x32_bf16 v[96:99], v[56:59], a[184:187], v[96:99]
    v_mfma_f32_16x16x32_bf16 v[96:99], v[60:63], a[188:191], v[96:99]
    v_mfma_f32_16x16x32_bf16 v[100:103], v[52:55], a[252:255], v[100:103]
    buffer_load_dwordx4 v[48:51], v186, s[48:51], s23 offen offset:3072 sc1
    v_mfma_f32_16x16x32_bf16 v[100:103], v[56:59], v[220:223], v[100:103]
    v_mfma_f32_16x16x32_bf16 v[100:103], v[60:63], v[224:227], v[100:103]
    s_waitcnt vmcnt(32)
    v_mfma_f32_16x16x32_bf16 v[88:91], v[64:67], a[48:51], v[88:91]
    v_mfma_f32_16x16x32_bf16 v[88:91], v[68:71], a[52:55], v[88:91]
    buffer_load_dwordx4 v[52:55], v187, s[48:51], s23 offen offset:0 sc1
    v_mfma_f32_16x16x32_bf16 v[88:91], v[72:75], a[56:59], v[88:91]
    v_mfma_f32_16x16x32_bf16 v[92:95], v[64:67], a[120:123], v[92:95]
    v_mfma_f32_16x16x32_bf16 v[92:95], v[68:71], a[124:127], v[92:95]
    v_mfma_f32_16x16x32_bf16 v[92:95], v[72:75], a[128:131], v[92:95]
    buffer_load_dwordx4 v[56:59], v187, s[48:51], s23 offen offset:1024 sc1
    v_mfma_f32_16x16x32_bf16 v[96:99], v[64:67], a[192:195], v[96:99]
    v_mfma_f32_16x16x32_bf16 v[96:99], v[68:71], a[196:199], v[96:99]
    v_mfma_f32_16x16x32_bf16 v[96:99], v[72:75], a[200:203], v[96:99]
    v_mfma_f32_16x16x32_bf16 v[100:103], v[64:67], v[228:231], v[100:103]
    buffer_load_dwordx4 v[60:63], v187, s[48:51], s23 offen offset:2048 sc1
    v_mfma_f32_16x16x32_bf16 v[100:103], v[68:71], v[232:235], v[100:103]
    v_mfma_f32_16x16x32_bf16 v[100:103], v[72:75], v[236:239], v[100:103]
    s_waitcnt vmcnt(32)
    v_mfma_f32_16x16x32_bf16 v[88:91], v[76:79], a[60:63], v[88:91]
    v_mfma_f32_16x16x32_bf16 v[88:91], v[80:83], a[64:67], v[88:91]
    buffer_load_dwordx4 v[64:67], v187, s[48:51], s23 offen offset:3072 sc1
    v_mfma_f32_16x16x32_bf16 v[120:123], v[84:87], a[68:71], v[88:91]
    v_mfma_f32_16x16x32_bf16 v[92:95], v[76:79], a[132:135], v[92:95]
    v_mfma_f32_16x16x32_bf16 v[92:95], v[80:83], a[136:139], v[92:95]
    v_mfma_f32_16x16x32_bf16 v[124:127], v[84:87], a[140:143], v[92:95]
    buffer_load_dwordx4 v[68:71], v188, s[48:51], s23 offen offset:0 sc1
    v_mfma_f32_16x16x32_bf16 v[96:99], v[76:79], a[204:207], v[96:99]
    s_mov_b32 s74, 268435456
    v_mfma_f32_16x16x32_bf16 v[96:99], v[80:83], a[208:211], v[96:99]
    s_add_u32 s27, s27, 1024
    v_mfma_f32_16x16x32_bf16 v[128:131], v[84:87], a[212:215], v[96:99]
    s_add_u32 s25, s25, 1
    v_mfma_f32_16x16x32_bf16 v[100:103], v[76:79], v[240:243], v[100:103]
    buffer_load_dwordx4 v[72:75], v188, s[48:51], s23 offen offset:1024 sc1
    v_mfma_f32_16x16x32_bf16 v[100:103], v[80:83], v[244:247], v[100:103]
    s_add_u32 s23, s23, 18432
    v_mfma_f32_16x16x32_bf16 v[132:135], v[84:87], v[248:251], v[100:103]
    s_cmp_lt_u32 s25, 7
    s_cbranch_scc1 L_ffn_dn_35
    s_waitcnt vmcnt(32)
    v_mfma_f32_16x16x32_bf16 v[88:91], v[104:107], a[0:3], 0
    v_mfma_f32_16x16x32_bf16 v[88:91], v[108:111], a[4:7], v[88:91]
    buffer_load_dwordx4 v[76:79], v184, s[48:51], s23 offen offset:0 sc1
    v_mfma_f32_16x16x32_bf16 v[88:91], v[112:115], a[8:11], v[88:91]
    v_mfma_f32_16x16x32_bf16 v[92:95], v[104:107], a[72:75], 0
    v_mfma_f32_16x16x32_bf16 v[92:95], v[108:111], a[76:79], v[92:95]
    v_mfma_f32_16x16x32_bf16 v[92:95], v[112:115], a[80:83], v[92:95]
    buffer_load_dwordx4 v[80:83], v184, s[48:51], s23 offen offset:1024 sc1
    v_mfma_f32_16x16x32_bf16 v[96:99], v[104:107], a[144:147], 0
    v_cvt_pk_bf16_f32 v152, v120, v121
    v_cvt_pk_bf16_f32 v153, v122, v123
    v_mfma_f32_16x16x32_bf16 v[96:99], v[108:111], a[148:151], v[96:99]
    v_cvt_pk_bf16_f32 v154, v124, v125
    v_cvt_pk_bf16_f32 v155, v126, v127
    v_mfma_f32_16x16x32_bf16 v[96:99], v[112:115], a[152:155], v[96:99]
    v_cvt_pk_bf16_f32 v156, v128, v129
    v_cvt_pk_bf16_f32 v157, v130, v131
    v_mfma_f32_16x16x32_bf16 v[100:103], v[104:107], a[216:219], 0
    buffer_load_dwordx4 v[84:87], v184, s[48:51], s23 offen offset:2048 sc1
    v_mfma_f32_16x16x32_bf16 v[100:103], v[108:111], a[220:223], v[100:103]
    v_cvt_pk_bf16_f32 v158, v132, v133
    v_cvt_pk_bf16_f32 v159, v134, v135
    v_mfma_f32_16x16x32_bf16 v[100:103], v[112:115], a[224:227], v[100:103]
    v_permlane16_swap_b32 v152, v154
    s_waitcnt vmcnt(32)
    v_mfma_f32_16x16x32_bf16 v[88:91], v[116:119], a[12:15], v[88:91]
    v_permlane16_swap_b32 v153, v155
    v_mfma_f32_16x16x32_bf16 v[88:91], v[180:183], a[16:19], v[88:91]
    v_permlane16_swap_b32 v156, v158
    v_mfma_f32_16x16x32_bf16 v[88:91], v[196:199], a[20:23], v[88:91]
    v_permlane16_swap_b32 v157, v159
    s_load_dwordx8 s[56:63], s[38:39], 0 glc
    v_mfma_f32_16x16x32_bf16 v[92:95], v[116:119], a[84:87], v[92:95]
    buffer_store_dwordx4 v[152:155], v178, s[72:75], s27 offen sc1
    s_mov_b32 s6, 0
    v_mfma_f32_16x16x32_bf16 v[92:95], v[180:183], a[88:91], v[92:95]
    buffer_store_dwordx4 v[156:159], v179, s[72:75], s27 offen sc1
    v_mfma_f32_16x16x32_bf16 v[92:95], v[196:199], a[92:95], v[92:95]
    ds_write_b128 v216, v[152:155]
    v_mfma_f32_16x16x32_bf16 v[96:99], v[116:119], a[156:159], v[96:99]
    v_add_u32 v216, v216, v218
    v_mfma_f32_16x16x32_bf16 v[96:99], v[180:183], a[160:163], v[96:99]
    ds_write_b128 v217, v[156:159]
    v_mfma_f32_16x16x32_bf16 v[96:99], v[196:199], a[164:167], v[96:99]
    v_add_u32 v217, v217, v219
    v_mfma_f32_16x16x32_bf16 v[100:103], v[116:119], a[228:231], v[100:103]
    v_mfma_f32_16x16x32_bf16 v[100:103], v[180:183], a[232:235], v[100:103]
    v_mfma_f32_16x16x32_bf16 v[100:103], v[196:199], a[236:239], v[100:103]
    s_waitcnt vmcnt(31)
L_epoll_38:
    s_waitcnt lgkmcnt(0)
    s_xor_b64 s[56:57], s[56:57], s[76:77]
    s_xor_b64 s[58:59], s[58:59], s[76:77]
    s_xor_b64 s[60:61], s[60:61], s[76:77]
    s_xor_b64 s[62:63], s[62:63], s[76:77]
    s_or_b64 s[56:57], s[56:57], s[58:59]
    s_or_b64 s[60:61], s[60:61], s[62:63]
    s_or_b64 s[56:57], s[56:57], s[60:61]
    s_cbranch_scc0 L_epolled_39
    s_load_dwordx8 s[56:63], s[38:39], 0 glc
    s_add_u32 s6, s6, 1
    s_cmp_lt_u32 s6, 1048576
    s_cbranch_scc1 L_epoll_38
    s_branch L_main_end
L_epolled_39:
    v_mfma_f32_16x16x32_bf16 v[88:91], v[200:203], a[24:27], v[88:91]
    v_mfma_f32_16x16x32_bf16 v[88:91], v[204:207], a[28:31], v[88:91]
    s_add_u32 s7, s40, 1
    s_and_b32 s7, s7, 7
    s_mul_i32 s7, s7, 9216
    s_add_u32 s19, s7, s20
    buffer_load_dwordx4 v[104:107], v172, s[8:11], s19 offen sc1
    v_mfma_f32_16x16x32_bf16 v[88:91], v[208:211], a[32:35], v[88:91]
    v_mfma_f32_16x16x32_bf16 v[92:95], v[200:203], a[96:99], v[92:95]
    v_mfma_f32_16x16x32_bf16 v[92:95], v[204:207], a[100:103], v[92:95]
    v_mfma_f32_16x16x32_bf16 v[92:95], v[208:211], a[104:107], v[92:95]
    buffer_load_dwordx4 v[108:111], v173, s[8:11], s19 offen sc1
    v_mfma_f32_16x16x32_bf16 v[96:99], v[200:203], a[168:171], v[96:99]
    v_mfma_f32_16x16x32_bf16 v[96:99], v[204:207], a[172:175], v[96:99]
    v_mfma_f32_16x16x32_bf16 v[96:99], v[208:211], a[176:179], v[96:99]
    v_mfma_f32_16x16x32_bf16 v[100:103], v[200:203], a[240:243], v[100:103]
    s_add_u32 s7, s40, 2
    s_and_b32 s7, s7, 7
    s_mul_i32 s7, s7, 9216
    s_add_u32 s19, s7, s20
    buffer_load_dwordx4 v[112:115], v172, s[8:11], s19 offen sc1
    v_mfma_f32_16x16x32_bf16 v[100:103], v[204:207], a[244:247], v[100:103]
    v_mfma_f32_16x16x32_bf16 v[100:103], v[208:211], a[248:251], v[100:103]
    s_waitcnt vmcnt(31)
    v_mfma_f32_16x16x32_bf16 v[88:91], v[212:215], a[36:39], v[88:91]
    v_mfma_f32_16x16x32_bf16 v[88:91], v[136:139], a[40:43], v[88:91]
    buffer_load_dwordx4 v[116:119], v173, s[8:11], s19 offen sc1
    v_mfma_f32_16x16x32_bf16 v[88:91], v[140:143], a[44:47], v[88:91]
    v_mfma_f32_16x16x32_bf16 v[92:95], v[212:215], a[108:111], v[92:95]
    v_mfma_f32_16x16x32_bf16 v[92:95], v[136:139], a[112:115], v[92:95]
    v_mfma_f32_16x16x32_bf16 v[92:95], v[140:143], a[116:119], v[92:95]
    s_add_u32 s7, s40, 3
    s_and_b32 s7, s7, 7
    s_mul_i32 s7, s7, 9216
    s_add_u32 s19, s7, s20
    buffer_load_dwordx4 v[180:183], v172, s[8:11], s19 offen sc1
    v_mfma_f32_16x16x32_bf16 v[96:99], v[212:215], a[180:183], v[96:99]
    v_mfma_f32_16x16x32_bf16 v[96:99], v[136:139], a[184:187], v[96:99]
    v_mfma_f32_16x16x32_bf16 v[96:99], v[140:143], a[188:191], v[96:99]
    v_mfma_f32_16x16x32_bf16 v[100:103], v[212:215], a[252:255], v[100:103]
    buffer_load_dwordx4 v[196:199], v173, s[8:11], s19 offen sc1
    v_mfma_f32_16x16x32_bf16 v[100:103], v[136:139], v[220:223], v[100:103]
    v_mfma_f32_16x16x32_bf16 v[100:103], v[140:143], v[224:227], v[100:103]
    s_waitcnt vmcnt(31)
    v_mfma_f32_16x16x32_bf16 v[88:91], v[144:147], a[48:51], v[88:91]
    v_mfma_f32_16x16x32_bf16 v[88:91], v[160:163], a[52:55], v[88:91]
    s_add_u32 s7, s40, 4
    s_and_b32 s7, s7, 7
    s_mul_i32 s7, s7, 9216
    s_add_u32 s19, s7, s20
    buffer_load_dwordx4 v[200:203], v172, s[8:11], s19 offen sc1
    v_mfma_f32_16x16x32_bf16 v[88:91], v[164:167], a[56:59], v[88:91]
    v_mfma_f32_16x16x32_bf16 v[92:95], v[144:147], a[120:123], v[92:95]
    v_mfma_f32_16x16x32_bf16 v[92:95], v[160:163], a[124:127], v[92:95]
    v_mfma_f32_16x16x32_bf16 v[92:95], v[164:167], a[128:131], v[92:95]
    buffer_load_dwordx4 v[204:207], v173, s[8:11], s19 offen sc1
    v_mfma_f32_16x16x32_bf16 v[96:99], v[144:147], a[192:195], v[96:99]
    v_mfma_f32_16x16x32_bf16 v[96:99], v[160:163], a[196:199], v[96:99]
    v_mfma_f32_16x16x32_bf16 v[96:99], v[164:167], a[200:203], v[96:99]
    v_mfma_f32_16x16x32_bf16 v[100:103], v[144:147], v[228:231], v[100:103]
    s_add_u32 s7, s40, 5
    s_and_b32 s7, s7, 7
    s_mul_i32 s7, s7, 9216
    s_add_u32 s19, s7, s20
    buffer_load_dwordx4 v[208:211], v172, s[8:11], s19 offen sc1
    v_mfma_f32_16x16x32_bf16 v[100:103], v[160:163], v[232:235], v[100:103]
    v_mfma_f32_16x16x32_bf16 v[100:103], v[164:167], v[236:239], v[100:103]
    s_waitcnt vmcnt(31)
    v_mfma_f32_16x16x32_bf16 v[88:91], v[168:171], a[60:63], v[88:91]
    v_mfma_f32_16x16x32_bf16 v[88:91], v[148:151], a[64:67], v[88:91]
    buffer_load_dwordx4 v[212:215], v173, s[8:11], s19 offen sc1
    v_mfma_f32_16x16x32_bf16 v[120:123], v[4:7], a[68:71], v[88:91]
    v_mfma_f32_16x16x32_bf16 v[92:95], v[168:171], a[132:135], v[92:95]
    v_mfma_f32_16x16x32_bf16 v[92:95], v[148:151], a[136:139], v[92:95]
    v_mfma_f32_16x16x32_bf16 v[124:127], v[4:7], a[140:143], v[92:95]
    s_add_u32 s7, s40, 6
    s_and_b32 s7, s7, 7
    s_mul_i32 s7, s7, 9216
    s_add_u32 s19, s7, s20
    buffer_load_dwordx4 v[136:139], v172, s[8:11], s19 offen sc1
    v_mfma_f32_16x16x32_bf16 v[96:99], v[168:171], a[204:207], v[96:99]
    s_mov_b32 s74, 268435456
    v_mfma_f32_16x16x32_bf16 v[96:99], v[148:151], a[208:211], v[96:99]
    s_add_u32 s27, s27, 1024
    v_mfma_f32_16x16x32_bf16 v[128:131], v[4:7], a[212:215], v[96:99]
    s_add_u32 s25, s25, 1
    v_mfma_f32_16x16x32_bf16 v[100:103], v[168:171], v[240:243], v[100:103]
    buffer_load_dwordx4 v[140:143], v173, s[8:11], s19 offen sc1
    v_mfma_f32_16x16x32_bf16 v[100:103], v[148:151], v[244:247], v[100:103]
    s_add_u32 s23, s23, 18432
    v_mfma_f32_16x16x32_bf16 v[132:135], v[4:7], v[248:251], v[100:103]
    s_waitcnt vmcnt(29)
    v_mfma_f32_16x16x32_bf16 v[88:91], v[16:19], a[0:3], 0
    v_mfma_f32_16x16x32_bf16 v[88:91], v[20:23], a[4:7], v[88:91]
    s_add_u32 s7, s40, 7
    s_and_b32 s7, s7, 7
    s_mul_i32 s7, s7, 9216
    s_add_u32 s19, s7, s20
    buffer_load_dwordx4 v[144:147], v172, s[8:11], s19 offen sc1
    v_mfma_f32_16x16x32_bf16 v[88:91], v[24:27], a[8:11], v[88:91]
    v_mfma_f32_16x16x32_bf16 v[92:95], v[16:19], a[72:75], 0
    v_mfma_f32_16x16x32_bf16 v[92:95], v[20:23], a[76:79], v[92:95]
    v_mfma_f32_16x16x32_bf16 v[92:95], v[24:27], a[80:83], v[92:95]
    buffer_load_dwordx4 v[160:163], v173, s[8:11], s19 offen sc1
    v_mfma_f32_16x16x32_bf16 v[96:99], v[16:19], a[144:147], 0
    v_cvt_pk_bf16_f32 v152, v120, v121
    v_cvt_pk_bf16_f32 v153, v122, v123
    v_mfma_f32_16x16x32_bf16 v[96:99], v[20:23], a[148:151], v[96:99]
    v_cvt_pk_bf16_f32 v154, v124, v125
    v_cvt_pk_bf16_f32 v155, v126, v127
    v_mfma_f32_16x16x32_bf16 v[96:99], v[24:27], a[152:155], v[96:99]
    v_cvt_pk_bf16_f32 v156, v128, v129
    v_cvt_pk_bf16_f32 v157, v130, v131
    v_mfma_f32_16x16x32_bf16 v[100:103], v[16:19], a[216:219], 0
    v_cvt_pk_bf16_f32 v158, v132, v133
    v_cvt_pk_bf16_f32 v159, v134, v135
    v_mfma_f32_16x16x32_bf16 v[100:103], v[20:23], a[220:223], v[100:103]
    v_permlane16_swap_b32 v152, v154
    v_mfma_f32_16x16x32_bf16 v[100:103], v[24:27], a[224:227], v[100:103]
    v_permlane16_swap_b32 v153, v155
    s_waitcnt vmcnt(28)
    v_mfma_f32_16x16x32_bf16 v[88:91], v[28:31], a[12:15], v[88:91]
    v_permlane16_swap_b32 v156, v158
    v_mfma_f32_16x16x32_bf16 v[88:91], v[32:35], a[16:19], v[88:91]
    v_permlane16_swap_b32 v157, v159
    v_mfma_f32_16x16x32_bf16 v[88:91], v[36:39], a[20:23], v[88:91]
    buffer_store_dwordx4 v[152:155], v178, s[72:75], s27 offen sc1
    v_mfma_f32_16x16x32_bf16 v[92:95], v[28:31], a[84:87], v[92:95]
    buffer_store_dwordx4 v[156:159], v179, s[72:75], s27 offen sc1
    v_mfma_f32_16x16x32_bf16 v[92:95], v[32:35], a[88:91], v[92:95]
    ds_write_b128 v216, v[152:155]
    v_mfma_f32_16x16x32_bf16 v[92:95], v[36:39], a[92:95], v[92:95]
    v_add_u32 v216, v216, v218
    v_mfma_f32_16x16x32_bf16 v[96:99], v[28:31], a[156:159], v[96:99]
    ds_write_b128 v217, v[156:159]
    v_mfma_f32_16x16x32_bf16 v[96:99], v[32:35], a[160:163], v[96:99]
    v_add_u32 v217, v217, v219
    v_mfma_f32_16x16x32_bf16 v[96:99], v[36:39], a[164:167], v[96:99]
    v_mfma_f32_16x16x32_bf16 v[100:103], v[28:31], a[228:231], v[100:103]
    v_mfma_f32_16x16x32_bf16 v[100:103], v[32:35], a[232:235], v[100:103]
    v_mfma_f32_16x16x32_bf16 v[100:103], v[36:39], a[236:239], v[100:103]
    s_waitcnt vmcnt(27)
    v_mfma_f32_16x16x32_bf16 v[88:91], v[40:43], a[24:27], v[88:91]
    v_mfma_f32_16x16x32_bf16 v[88:91], v[44:47], a[28:31], v[88:91]
    v_mfma_f32_16x16x32_bf16 v[88:91], v[48:51], a[32:35], v[88:91]
    v_mfma_f32_16x16x32_bf16 v[92:95], v[40:43], a[96:99], v[92:95]
    v_mfma_f32_16x16x32_bf16 v[92:95], v[44:47], a[100:103], v[92:95]
    v_mfma_f32_16x16x32_bf16 v[92:95], v[48:51], a[104:107], v[92:95]
    v_mfma_f32_16x16x32_bf16 v[96:99], v[40:43], a[168:171], v[96:99]
    v_mfma_f32_16x16x32_bf16 v[96:99], v[44:47], a[172:175], v[96:99]
    v_mfma_f32_16x16x32_bf16 v[96:99], v[48:51], a[176:179], v[96:99]
    v_mfma_f32_16x16x32_bf16 v[100:103], v[40:43], a[240:243], v[100:103]
    v_mfma_f32_16x16x32_bf16 v[100:103], v[44:47], a[244:247], v[100:103]
    v_mfma_f32_16x16x32_bf16 v[100:103], v[48:51], a[248:251], v[100:103]
    s_waitcnt vmcnt(24)
    v_mfma_f32_16x16x32_bf16 v[88:91], v[52:55], a[36:39], v[88:91]
    v_mfma_f32_16x16x32_bf16 v[88:91], v[56:59], a[40:43], v[88:91]
    v_mfma_f32_16x16x32_bf16 v[88:91], v[60:63], a[44:47], v[88:91]
    v_mfma_f32_16x16x32_bf16 v[92:95], v[52:55], a[108:111], v[92:95]
    v_mfma_f32_16x16x32_bf16 v[92:95], v[56:59], a[112:115], v[92:95]
    v_mfma_f32_16x16x32_bf16 v[92:95], v[60:63], a[116:119], v[92:95]
    v_mfma_f32_16x16x32_bf16 v[96:99], v[52:55], a[180:183], v[96:99]
    v_mfma_f32_16x16x32_bf16 v[96:99], v[56:59], a[184:187], v[96:99]
    v_mfma_f32_16x16x32_bf16 v[96:99], v[60:63], a[188:191], v[96:99]
    v_mfma_f32_16x16x32_bf16 v[100:103], v[52:55], a[252:255], v[100:103]
    v_mfma_f32_16x16x32_bf16 v[100:103], v[56:59], v[220:223], v[100:103]
    v_mfma_f32_16x16x32_bf16 v[100:103], v[60:63], v[224:227], v[100:103]
    s_waitcnt vmcnt(21)
    v_mfma_f32_16x16x32_bf16 v[88:91], v[64:67], a[48:51], v[88:91]
    v_mfma_f32_16x16x32_bf16 v[88:91], v[68:71], a[52:55], v[88:91]
    v_mfma_f32_16x16x32_bf16 v[88:91], v[72:75], a[56:59], v[88:91]
    v_mfma_f32_16x16x32_bf16 v[92:95], v[64:67], a[120:123], v[92:95]
    v_mfma_f32_16x16x32_bf16 v[92:95], v[68:71], a[124:127], v[92:95]
    v_mfma_f32_16x16x32_bf16 v[92:95], v[72:75], a[128:131], v[92:95]
    v_mfma_f32_16x16x32_bf16 v[96:99], v[64:67], a[192:195], v[96:99]
    v_mfma_f32_16x16x32_bf16 v[96:99], v[68:71], a[196:199], v[96:99]
    v_mfma_f32_16x16x32_bf16 v[96:99], v[72:75], a[200:203], v[96:99]
    v_mfma_f32_16x16x32_bf16 v[100:103], v[64:67], v[228:231], v[100:103]
    v_mfma_f32_16x16x32_bf16 v[100:103], v[68:71], v[232:235], v[100:103]
    v_mfma_f32_16x16x32_bf16 v[100:103], v[72:75], v[236:239], v[100:103]
    s_waitcnt vmcnt(18)
    v_mfma_f32_16x16x32_bf16 v[88:91], v[76:79], a[60:63], v[88:91]
    v_mfma_f32_16x16x32_bf16 v[88:91], v[80:83], a[64:67], v[88:91]
    v_mfma_f32_16x16x32_bf16 v[120:123], v[84:87], a[68:71], v[88:91]
    v_mfma_f32_16x16x32_bf16 v[92:95], v[76:79], a[132:135], v[92:95]
    v_mfma_f32_16x16x32_bf16 v[92:95], v[80:83], a[136:139], v[92:95]
    v_mfma_f32_16x16x32_bf16 v[124:127], v[84:87], a[140:143], v[92:95]
    v_mfma_f32_16x16x32_bf16 v[96:99], v[76:79], a[204:207], v[96:99]
    s_mov_b32 s74, 268435456
    v_mfma_f32_16x16x32_bf16 v[96:99], v[80:83], a[208:211], v[96:99]
    s_add_u32 s27, s27, 1024
    v_mfma_f32_16x16x32_bf16 v[128:131], v[84:87], a[212:215], v[96:99]
    s_add_u32 s25, s25, 1
    v_mfma_f32_16x16x32_bf16 v[100:103], v[76:79], v[240:243], v[100:103]
    v_mfma_f32_16x16x32_bf16 v[100:103], v[80:83], v[244:247], v[100:103]
    s_add_u32 s23, s23, 18432
    v_mfma_f32_16x16x32_bf16 v[132:135], v[84:87], v[248:251], v[100:103]
    s_nop 7
    v_cvt_pk_bf16_f32 v152, v120, v121
    v_cvt_pk_bf16_f32 v153, v122, v123
    v_cvt_pk_bf16_f32 v154, v124, v125
    v_cvt_pk_bf16_f32 v155, v126, v127
    v_cvt_pk_bf16_f32 v156, v128, v129
    v_cvt_pk_bf16_f32 v157, v130, v131
    v_cvt_pk_bf16_f32 v158, v132, v133
    v_cvt_pk_bf16_f32 v159, v134, v135
    s_nop 1
    v_permlane16_swap_b32 v152, v154
    v_permlane16_swap_b32 v153, v155
    v_permlane16_swap_b32 v156, v158
    v_permlane16_swap_b32 v157, v159
    buffer_store_dwordx4 v[152:155], v178, s[72:75], s27 offen sc1
    buffer_store_dwordx4 v[156:159], v179, s[72:75], s27 offen sc1
    ds_write_b128 v216, v[152:155]
    v_add_u32 v216, v216, v218
    ds_write_b128 v217, v[156:159]
    v_add_u32 v217, v217, v219
    s_waitcnt lgkmcnt(0)
    v_lshlrev_b32 v15, 7, v0
    s_lshl_b32 s6, s40, 2
    s_add_u32 s6, s6, s44
    s_add_u32 s6, s6, 65536
    v_mov_b32 v1, s76
    s_mov_b64 vcc, 0xff
    s_waitcnt vmcnt(0)
    s_barrier
    s_cmp_lg_u32 s3, 0
    s_cbranch_scc1 L_pub_40
    s_mov_b64 exec, vcc
    buffer_store_dword v1, v15, s[8:11], s6 offen sc1
L_pub_40:
    s_mov_b64 exec, -1
    s_add_u32 s19, s18, s43
    s_add_u32 s22, s19, 45875200
    s_lshl_b32 s23, s21, 5
    s_add_u32 s23, s23, s43
    s_add_u32 s23, s23, 48431104
    v_and_b32 v12, 7, v0
    v_lshlrev_b32 v12, 2, v12
    buffer_load_dword v10, v12, s[8:11], s23 offen sc1
    buffer_load_dwordx4 v[92:95], v172, s[8:11], s22 offen sc1
    buffer_load_dwordx4 v[96:99], v173, s[8:11], s22 offen sc1
    buffer_load_dwordx4 v[100:103], v174, s[8:11], s22 offen sc1
    v_min_u32 v13, 9216, v173
    ds_read_b128 v[148:151], v172 offset:4096
    ds_read_b128 v[152:155], v13 offset:4096
    ds_read_b128 v[156:159], v174 offset:4096
    s_lshl_b32 s28, s40, 2
    s_add_u32 s28, s28, s3
    s_mul_i32 s28, s28, 73728
    s_mul_i32 s7, s42, 1073741824
    v_add_u32 v3, s7, v253
    v_lshlrev_b32 v16, 16, v104
    v_and_b32 v17, s16, v104
    v_lshlrev_b32 v18, 16, v105
    v_and_b32 v19, s16, v105
    v_lshlrev_b32 v20, 16, v106
    v_and_b32 v21, s16, v106
    v_lshlrev_b32 v22, 16, v107
    v_and_b32 v23, s16, v107
    v_lshlrev_b32 v24, 16, v108
    v_and_b32 v25, s16, v108
    v_lshlrev_b32 v26, 16, v109
    v_and_b32 v27, s16, v109
    v_lshlrev_b32 v28, 16, v110
    v_and_b32 v29, s16, v110
    v_lshlrev_b32 v30, 16, v111
    v_and_b32 v31, s16, v111
    s_cmp_lg_u32 s42, 0
    s_cbranch_scc1 L_nopf_41
    buffer_load_dwordx4 a[0:3], v3, s[8:11], s28 offen offset:0 sc1
    buffer_load_dwordx4 a[4:7], v3, s[8:11], s28 offen offset:1024 sc1
    buffer_load_dwordx4 a[8:11], v3, s[8:11], s28 offen offset:2048 sc1
    buffer_load_dwordx4 a[12:15], v3, s[8:11], s28 offen offset:3072 sc1
    s_add_u32 s28, s28, 4096
    buffer_load_dwordx4 a[16:19], v3, s[8:11], s28 offen offset:0 sc1
    buffer_load_dwordx4 a[20:23], v3, s[8:11], s28 offen offset:1024 sc1
    buffer_load_dwordx4 a[24:27], v3, s[8:11], s28 offen offset:2048 sc1
    buffer_load_dwordx4 a[28:31], v3, s[8:11], s28 offen offset:3072 sc1
L_nopf_41:
    v_lshlrev_b32 v40, 16, v112
    v_and_b32 v41, s16, v112
    v_lshlrev_b32 v42, 16, v113
    v_and_b32 v43, s16, v113
    v_lshlrev_b32 v44, 16, v114
    v_and_b32 v45, s16, v114
    v_lshlrev_b32 v46, 16, v115
    v_and_b32 v47, s16, v115
    v_pk_add_f32 v[16:17], v[16:17], v[40:41]
    v_pk_add_f32 v[18:19], v[18:19], v[42:43]
    v_pk_add_f32 v[20:21], v[20:21], v[44:45]
    v_pk_add_f32 v[22:23], v[22:23], v[46:47]
    v_lshlrev_b32 v40, 16, v116
    v_and_b32 v41, s16, v116
    v_lshlrev_b32 v42, 16, v117
    v_and_b32 v43, s16, v117
    v_lshlrev_b32 v44, 16, v118
    v_and_b32 v45, s16, v118
    v_lshlrev_b32 v46, 16, v119
    v_and_b32 v47, s16, v119
    v_pk_add_f32 v[24:25], v[24:25], v[40:41]
    v_pk_add_f32 v[26:27], v[26:27], v[42:43]
    v_pk_add_f32 v[28:29], v[28:29], v[44:45]
    v_pk_add_f32 v[30:31], v[30:31], v[46:47]
    s_cmp_lg_u32 s42, 0
    s_cbranch_scc1 L_nopf_42
    s_add_u32 s28, s28, 4096
    buffer_load_dwordx4 a[32:35], v3, s[8:11], s28 offen offset:0 sc1
    buffer_load_dwordx4 a[36:39], v3, s[8:11], s28 offen offset:1024 sc1
    buffer_load_dwordx4 a[40:43], v3, s[8:11], s28 offen offset:2048 sc1
    buffer_load_dwordx4 a[44:47], v3, s[8:11], s28 offen offset:3072 sc1
    s_add_u32 s28, s28, 4096
    buffer_load_dwordx4 a[48:51], v3, s[8:11], s28 offen offset:0 sc1
    buffer_load_dwordx4 a[52:55], v3, s[8:11], s28 offen offset:1024 sc1
    buffer_load_dwordx4 a[56:59], v3, s[8:11], s28 offen offset:2048 sc1
    buffer_load_dwordx4 a[60:63], v3, s[8:11], s28 offen offset:3072 sc1
L_nopf_42:
    v_lshlrev_b32 v40, 16, v180
    v_and_b32 v41, s16, v180
    v_lshlrev_b32 v42, 16, v181
    v_and_b32 v43, s16, v181
    v_lshlrev_b32 v44, 16, v182
    v_and_b32 v45, s16, v182
    v_lshlrev_b32 v46, 16, v183
    v_and_b32 v47, s16, v183
    v_pk_add_f32 v[16:17], v[16:17], v[40:41]
    v_pk_add_f32 v[18:19], v[18:19], v[42:43]
    v_pk_add_f32 v[20:21], v[20:21], v[44:45]
    v_pk_add_f32 v[22:23], v[22:23], v[46:47]
    v_lshlrev_b32 v40, 16, v196
    v_and_b32 v41, s16, v196
    v_lshlrev_b32 v42, 16, v197
    v_and_b32 v43, s16, v197
    v_lshlrev_b32 v44, 16, v198
    v_and_b32 v45, s16, v198
    v_lshlrev_b32 v46, 16, v199
    v_and_b32 v47, s16, v199
    v_pk_add_f32 v[24:25], v[24:25], v[40:41]
    v_pk_add_f32 v[26:27], v[26:27], v[42:43]
    v_pk_add_f32 v[28:29], v[28:29], v[44:45]
    v_pk_add_f32 v[30:31], v[30:31], v[46:47]
    v_lshlrev_b32 v40, 16, v200
    v_and_b32 v41, s16, v200
    v_lshlrev_b32 v42, 16, v201
    v_and_b32 v43, s16, v201
    v_lshlrev_b32 v44, 16, v202
    v_and_b32 v45, s16, v202
    v_lshlrev_b32 v46, 16, v203
    v_and_b32 v47, s16, v203
    v_pk_add_f32 v[16:17], v[16:17], v[40:41]
    v_pk_add_f32 v[18:19], v[18:19], v[42:43]
    v_pk_add_f32 v[20:21], v[20:21], v[44:45]
    v_pk_add_f32 v[22:23], v[22:23], v[46:47]
    v_lshlrev_b32 v40, 16, v204
    v_and_b32 v41, s16, v204
    v_lshlrev_b32 v42, 16, v205
    v_and_b32 v43, s16, v205
    v_lshlrev_b32 v44, 16, v206
    v_and_b32 v45, s16, v206
    v_lshlrev_b32 v46, 16, v207
    v_and_b32 v47, s16, v207
    v_pk_add_f32 v[24:25], v[24:25], v[40:41]
    v_pk_add_f32 v[26:27], v[26:27], v[42:43]
    v_pk_add_f32 v[28:29], v[28:29], v[44:45]
    v_pk_add_f32 v[30:31], v[30:31], v[46:47]
    s_cmp_lg_u32 s3, 3
    s_cbranch_scc1 L_pollout_45
    s_lshl_b32 s7, s40, 7
    s_add_u32 s7, s7, s44
    s_add_u32 s7, s7, 65536
    s_add_u32 s52, s4, s7
    s_addc_u32 s53, s5, 0
    s_mov_b32 s6, 0
L_poll_43:
    s_load_dwordx8 s[56:63], s[52:53], 0 glc
    s_add_u32 s6, s6, 1
    s_waitcnt lgkmcnt(0)
    s_xor_b64 s[56:57], s[56:57], s[76:77]
    s_xor_b64 s[58:59], s[58:59], s[76:77]
    s_xor_b64 s[60:61], s[60:61], s[76:77]
    s_xor_b64 s[62:63], s[62:63], s[76:77]
    s_or_b64 s[56:57], s[56:57], s[58:59]
    s_or_b64 s[60:61], s[60:61], s[62:63]
    s_or_b64 s[56:57], s[56:57], s[60:61]
    s_cbranch_scc0 L_polled_44
    s_cmp_lt_u32 s6, 1048576
    s_cbranch_scc1 L_poll_43
    s_branch L_main_end
L_polled_44:
L_pollout_45:
    s_barrier
    s_add_u32 s7, s40, 1
    s_and_b32 s7, s7, 7
    s_mul_i32 s7, s7, 9216
    s_add_u32 s19, s7, s20
    buffer_load_dwordx4 v[60:63], v174, s[8:11], s19 offen sc1
    s_add_u32 s7, s40, 2
    s_and_b32 s7, s7, 7
    s_mul_i32 s7, s7, 9216
    s_add_u32 s19, s7, s20
    buffer_load_dwordx4 v[64:67], v174, s[8:11], s19 offen sc1
    s_add_u32 s7, s40, 3
    s_and_b32 s7, s7, 7
    s_mul_i32 s7, s7, 9216
    s_add_u32 s19, s7, s20
    buffer_load_dwordx4 v[68:71], v174, s[8:11], s19 offen sc1
    s_add_u32 s7, s40, 4
    s_and_b32 s7, s7, 7
    s_mul_i32 s7, s7, 9216
    s_add_u32 s19, s7, s20
    buffer_load_dwordx4 v[72:75], v174, s[8:11], s19 offen sc1
    s_add_u32 s7, s40, 5
    s_and_b32 s7, s7, 7
    s_mul_i32 s7, s7, 9216
    s_add_u32 s19, s7, s20
    buffer_load_dwordx4 v[76:79], v174, s[8:11], s19 offen sc1
    s_add_u32 s7, s40, 6
    s_and_b32 s7, s7, 7
    s_mul_i32 s7, s7, 9216
    s_add_u32 s19, s7, s20
    buffer_load_dwordx4 v[80:83], v174, s[8:11], s19 offen sc1
    s_add_u32 s7, s40, 7
    s_and_b32 s7, s7, 7
    s_mul_i32 s7, s7, 9216
    s_add_u32 s19, s7, s20
    buffer_load_dwordx4 v[84:87], v174, s[8:11], s19 offen sc1
    v_lshlrev_b32 v40, 16, v208
    v_and_b32 v41, s16, v208
    v_lshlrev_b32 v42, 16, v209
    v_and_b32 v43, s16, v209
    v_lshlrev_b32 v44, 16, v210
    v_and_b32 v45, s16, v210
    v_lshlrev_b32 v46, 16, v211
    v_and_b32 v47, s16, v211
    v_pk_add_f32 v[16:17], v[16:17], v[40:41]
    v_pk_add_f32 v[18:19], v[18:19], v[42:43]
    v_pk_add_f32 v[20:21], v[20:21], v[44:45]
    v_pk_add_f32 v[22:23], v[22:23], v[46:47]
    v_lshlrev_b32 v40, 16, v212
    v_and_b32 v41, s16, v212
    v_lshlrev_b32 v42, 16, v213
    v_and_b32 v43, s16, v213
    v_lshlrev_b32 v44, 16, v214
    v_and_b32 v45, s16, v214
    v_lshlrev_b32 v46, 16, v215
    v_and_b32 v47, s16, v215
    v_pk_add_f32 v[24:25], v[24:25], v[40:41]
    v_pk_add_f32 v[26:27], v[26:27], v[42:43]
    v_pk_add_f32 v[28:29], v[28:29], v[44:45]
    v_pk_add_f32 v[30:31], v[30:31], v[46:47]
    v_lshlrev_b32 v40, 16, v136
    v_and_b32 v41, s16, v136
    v_lshlrev_b32 v42, 16, v137
    v_and_b32 v43, s16, v137
    v_lshlrev_b32 v44, 16, v138
    v_and_b32 v45, s16, v138
    v_lshlrev_b32 v46, 16, v139
    v_and_b32 v47, s16, v139
    v_pk_add_f32 v[16:17], v[16:17], v[40:41]
    v_pk_add_f32 v[18:19], v[18:19], v[42:43]
    v_pk_add_f32 v[20:21], v[20:21], v[44:45]
    v_pk_add_f32 v[22:23], v[22:23], v[46:47]
    v_lshlrev_b32 v40, 16, v140
    v_and_b32 v41, s16, v140
    v_lshlrev_b32 v42, 16, v141
    v_and_b32 v43, s16, v141
    v_lshlrev_b32 v44, 16, v142
    v_and_b32 v45, s16, v142
    v_lshlrev_b32 v46, 16, v143
    v_and_b32 v47, s16, v143
    v_pk_add_f32 v[24:25], v[24:25], v[40:41]
    v_pk_add_f32 v[26:27], v[26:27], v[42:43]
    v_pk_add_f32 v[28:29], v[28:29], v[44:45]
    v_pk_add_f32 v[30:31], v[30:31], v[46:47]
    v_lshlrev_b32 v40, 16, v144
    v_and_b32 v41, s16, v144
    v_lshlrev_b32 v42, 16, v145
    v_and_b32 v43, s16, v145
    v_lshlrev_b32 v44, 16, v146
    v_and_b32 v45, s16, v146
    v_lshlrev_b32 v46, 16, v147
    v_and_b32 v47, s16, v147
    v_pk_add_f32 v[16:17], v[16:17], v[40:41]
    v_pk_add_f32 v[18:19], v[18:19], v[42:43]
    v_pk_add_f32 v[20:21], v[20:21], v[44:45]
    v_pk_add_f32 v[22:23], v[22:23], v[46:47]
    v_lshlrev_b32 v40, 16, v160
    v_and_b32 v41, s16, v160
    v_lshlrev_b32 v42, 16, v161
    v_and_b32 v43, s16, v161
    v_lshlrev_b32 v44, 16, v162
    v_and_b32 v45, s16, v162
    v_lshlrev_b32 v46, 16, v163
    v_and_b32 v47, s16, v163
    v_pk_add_f32 v[24:25], v[24:25], v[40:41]
    v_pk_add_f32 v[26:27], v[26:27], v[42:43]
    v_pk_add_f32 v[28:29], v[28:29], v[44:45]
    v_pk_add_f32 v[30:31], v[30:31], v[46:47]
    s_cmp_eq_u32 s3, 0
    s_cselect_b32 s7, 1.0, 0
    s_cselect_b32 s6, -1, 0
    s_waitcnt vmcnt(7) lgkmcnt(0)
    v_and_b32 v152, s6, v152
    v_and_b32 v153, s6, v153
    v_and_b32 v154, s6, v154
    v_and_b32 v155, s6, v155
    v_mul_f32 v11, s7, v10
    v_lshlrev_b32 v40, 16, v92
    v_and_b32 v41, s16, v92
    v_lshlrev_b32 v42, 16, v93
    v_and_b32 v43, s16, v93
    v_lshlrev_b32 v44, 16, v94
    v_and_b32 v45, s16, v94
    v_lshlrev_b32 v46, 16, v95
    v_and_b32 v47, s16, v95
    v_pk_add_f32 v[16:17], v[16:17], v[40:41]
    v_pk_add_f32 v[18:19], v[18:19], v[42:43]
    v_pk_add_f32 v[20:21], v[20:21], v[44:45]
    v_pk_add_f32 v[22:23], v[22:23], v[46:47]
    v_lshlrev_b32 v40, 16, v96
    v_and_b32 v41, s16, v96
    v_lshlrev_b32 v42, 16, v97
    v_and_b32 v43, s16, v97
    v_lshlrev_b32 v44, 16, v98
    v_and_b32 v45, s16, v98
    v_lshlrev_b32 v46, 16, v99
    v_and_b32 v47, s16, v99
    v_pk_add_f32 v[24:25], v[24:25], v[40:41]
    v_pk_add_f32 v[26:27], v[26:27], v[42:43]
    v_pk_add_f32 v[28:29], v[28:29], v[44:45]
    v_pk_add_f32 v[30:31], v[30:31], v[46:47]
    v_lshlrev_b32 v32, 16, v100
    v_and_b32 v33, s16, v100
    v_lshlrev_b32 v34, 16, v101
    v_and_b32 v35, s16, v101
    v_lshlrev_b32 v36, 16, v102
    v_and_b32 v37, s16, v102
    v_lshlrev_b32 v38, 16, v103
    v_and_b32 v39, s16, v103
    v_lshlrev_b32 v40, 16, v148
    v_and_b32 v41, s16, v148
    v_lshlrev_b32 v42, 16, v149
    v_and_b32 v43, s16, v149
    v_lshlrev_b32 v44, 16, v150
    v_and_b32 v45, s16, v150
    v_lshlrev_b32 v46, 16, v151
    v_and_b32 v47, s16, v151
    v_pk_add_f32 v[16:17], v[16:17], v[40:41]
    v_pk_add_f32 v[18:19], v[18:19], v[42:43]
    v_pk_add_f32 v[20:21], v[20:21], v[44:45]
    v_pk_add_f32 v[22:23], v[22:23], v[46:47]
    v_lshlrev_b32 v40, 16, v152
    v_and_b32 v41, s16, v152
    v_lshlrev_b32 v42, 16, v153
    v_and_b32 v43, s16, v153
    v_lshlrev_b32 v44, 16, v154
    v_and_b32 v45, s16, v154
    v_lshlrev_b32 v46, 16, v155
    v_and_b32 v47, s16, v155
    v_pk_add_f32 v[24:25], v[24:25], v[40:41]
    v_pk_add_f32 v[26:27], v[26:27], v[42:43]
    v_pk_add_f32 v[28:29], v[28:29], v[44:45]
    v_pk_add_f32 v[30:31], v[30:31], v[46:47]
    v_lshlrev_b32 v40, 16, v156
    v_and_b32 v41, s16, v156
    v_lshlrev_b32 v42, 16, v157
    v_and_b32 v43, s16, v157
    v_lshlrev_b32 v44, 16, v158
    v_and_b32 v45, s16, v158
    v_lshlrev_b32 v46, 16, v159
    v_and_b32 v47, s16, v159
    v_pk_add_f32 v[32:33], v[32:33], v[40:41]
    v_pk_add_f32 v[34:35], v[34:35], v[42:43]
    v_pk_add_f32 v[36:37], v[36:37], v[44:45]
    v_pk_add_f32 v[38:39], v[38:39], v[46:47]
    v_pk_add_f32 v[16:17], v[16:17], v[10:11] op_sel_hi:[1,0]
    v_pk_add_f32 v[18:19], v[18:19], v[10:11] op_sel_hi:[1,0]
    v_pk_add_f32 v[20:21], v[20:21], v[10:11] op_sel_hi:[1,0]
    v_pk_add_f32 v[22:23], v[22:23], v[10:11] op_sel_hi:[1,0]
    v_pk_add_f32 v[24:25], v[24:25], v[10:11] op_sel:[0,1] op_sel_hi:[1,1]
    v_pk_add_f32 v[26:27], v[26:27], v[10:11] op_sel:[0,1] op_sel_hi:[1,1]
    v_pk_add_f32 v[28:29], v[28:29], v[10:11] op_sel:[0,1] op_sel_hi:[1,1]
    v_pk_add_f32 v[30:31], v[30:31], v[10:11] op_sel:[0,1] op_sel_hi:[1,1]
    v_pk_add_f32 v[32:33], v[32:33], v[10:11] op_sel_hi:[1,0]
    v_pk_add_f32 v[34:35], v[34:35], v[10:11] op_sel_hi:[1,0]
    v_pk_add_f32 v[36:37], v[36:37], v[10:11] op_sel_hi:[1,0]
    v_pk_add_f32 v[38:39], v[38:39], v[10:11] op_sel_hi:[1,0]
    s_waitcnt vmcnt(6)
    s_add_u32 s28, s28, 4096
    buffer_load_dwordx4 a[64:67], v3, s[8:11], s28 offen offset:0 sc1
    v_lshlrev_b32 v40, 16, v60
    v_and_b32 v41, s16, v60
    v_lshlrev_b32 v42, 16, v61
    v_and_b32 v43, s16, v61
    v_lshlrev_b32 v44, 16, v62
    v_and_b32 v45, s16, v62
    v_lshlrev_b32 v46, 16, v63
    v_and_b32 v47, s16, v63
    v_pk_add_f32 v[32:33], v[32:33], v[40:41]
    v_pk_add_f32 v[34:35], v[34:35], v[42:43]
    v_pk_add_f32 v[36:37], v[36:37], v[44:45]
    v_pk_add_f32 v[38:39], v[38:39], v[46:47]
    s_waitcnt vmcnt(6)
    buffer_load_dwordx4 a[68:71], v3, s[8:11], s28 offen offset:1024 sc1
    v_lshlrev_b32 v40, 16, v64
    v_and_b32 v41, s16, v64
    v_lshlrev_b32 v42, 16, v65
    v_and_b32 v43, s16, v65
    v_lshlrev_b32 v44, 16, v66
    v_and_b32 v45, s16, v66
    v_lshlrev_b32 v46, 16, v67
    v_and_b32 v47, s16, v67
    v_pk_add_f32 v[32:33], v[32:33], v[40:41]
    v_pk_add_f32 v[34:35], v[34:35], v[42:43]
    v_pk_add_f32 v[36:37], v[36:37], v[44:45]
    v_pk_add_f32 v[38:39], v[38:39], v[46:47]
    s_waitcnt vmcnt(6)
    buffer_load_dwordx4 a[72:75], v3, s[8:11], s28 offen offset:2048 sc1
    v_lshlrev_b32 v40, 16, v68
    v_and_b32 v41, s16, v68
    v_lshlrev_b32 v42, 16, v69
    v_and_b32 v43, s16, v69
    v_lshlrev_b32 v44, 16, v70
    v_and_b32 v45, s16, v70
    v_lshlrev_b32 v46, 16, v71
    v_and_b32 v47, s16, v71
    v_pk_add_f32 v[32:33], v[32:33], v[40:41]
    v_pk_add_f32 v[34:35], v[34:35], v[42:43]
    v_pk_add_f32 v[36:37], v[36:37], v[44:45]
    v_pk_add_f32 v[38:39], v[38:39], v[46:47]
    s_waitcnt vmcnt(6)
    buffer_load_dwordx4 a[76:79], v3, s[8:11], s28 offen offset:3072 sc1
    v_lshlrev_b32 v40, 16, v72
    v_and_b32 v41, s16, v72
    v_lshlrev_b32 v42, 16, v73
    v_and_b32 v43, s16, v73
    v_lshlrev_b32 v44, 16, v74
    v_and_b32 v45, s16, v74
    v_lshlrev_b32 v46, 16, v75
    v_and_b32 v47, s16, v75
    v_pk_add_f32 v[32:33], v[32:33], v[40:41]
    v_pk_add_f32 v[34:35], v[34:35], v[42:43]
    v_pk_add_f32 v[36:37], v[36:37], v[44:45]
    v_pk_add_f32 v[38:39], v[38:39], v[46:47]
    s_waitcnt vmcnt(6)
    s_add_u32 s28, s28, 4096
    buffer_load_dwordx4 a[80:83], v3, s[8:11], s28 offen offset:0 sc1
    v_lshlrev_b32 v40, 16, v76
    v_and_b32 v41, s16, v76
    v_lshlrev_b32 v42, 16, v77
    v_and_b32 v43, s16, v77
    v_lshlrev_b32 v44, 16, v78
    v_and_b32 v45, s16, v78
    v_lshlrev_b32 v46, 16, v79
    v_and_b32 v47, s16, v79
    v_pk_add_f32 v[32:33], v[32:33], v[40:41]
    v_pk_add_f32 v[34:35], v[34:35], v[42:43]
    v_pk_add_f32 v[36:37], v[36:37], v[44:45]
    v_pk_add_f32 v[38:39], v[38:39], v[46:47]
    s_waitcnt vmcnt(6)
    buffer_load_dwordx4 a[84:87], v3, s[8:11], s28 offen offset:1024 sc1
    v_lshlrev_b32 v40, 16, v80
    v_and_b32 v41, s16, v80
    v_lshlrev_b32 v42, 16, v81
    v_and_b32 v43, s16, v81
    v_lshlrev_b32 v44, 16, v82
    v_and_b32 v45, s16, v82
    v_lshlrev_b32 v46, 16, v83
    v_and_b32 v47, s16, v83
    v_pk_add_f32 v[32:33], v[32:33], v[40:41]
    v_pk_add_f32 v[34:35], v[34:35], v[42:43]
    v_pk_add_f32 v[36:37], v[36:37], v[44:45]
    v_pk_add_f32 v[38:39], v[38:39], v[46:47]
    s_waitcnt vmcnt(6)
    buffer_load_dwordx4 a[88:91], v3, s[8:11], s28 offen offset:2048 sc1
    v_lshlrev_b32 v40, 16, v84
    v_and_b32 v41, s16, v84
    v_lshlrev_b32 v42, 16, v85
    v_and_b32 v43, s16, v85
    v_lshlrev_b32 v44, 16, v86
    v_and_b32 v45, s16, v86
    v_lshlrev_b32 v46, 16, v87
    v_and_b32 v47, s16, v87
    v_pk_add_f32 v[32:33], v[32:33], v[40:41]
    v_pk_add_f32 v[34:35], v[34:35], v[42:43]
    v_pk_add_f32 v[36:37], v[36:37], v[44:45]
    v_pk_add_f32 v[38:39], v[38:39], v[46:47]
    buffer_load_dwordx4 a[92:95], v3, s[8:11], s28 offen offset:3072 sc1
    v_cvt_pk_bf16_f32 v120, v16, v17
    v_cvt_pk_bf16_f32 v121, v18, v19
    v_cvt_pk_bf16_f32 v122, v20, v21
    v_cvt_pk_bf16_f32 v123, v22, v23
    v_cvt_pk_bf16_f32 v124, v24, v25
    v_cvt_pk_bf16_f32 v125, v26, v27
    v_cvt_pk_bf16_f32 v126, v28, v29
    v_cvt_pk_bf16_f32 v127, v30, v31
    v_cvt_pk_bf16_f32 v128, v32, v33
    v_cvt_pk_bf16_f32 v129, v34, v35
    v_cvt_pk_bf16_f32 v130, v36, v37
    v_cvt_pk_bf16_f32 v131, v38, v39
    s_cmp_lg_u32 s42, 0
    s_cbranch_scc1 L_main_last
    s_add_u32 s19, s18, 43515904
    s_add_u32 s20, s18, 38797312
    s_lshl_b32 s22, s21, 7
    s_add_u32 s22, s22, 48234496
    buffer_store_dwordx4 v[120:123], v172, s[8:11], s19 offen sc1
    buffer_store_dwordx4 v[124:127], v173, s[8:11], s19 offen sc1
    buffer_store_dwordx4 v[128:131], v174, s[8:11], s19 offen sc1
    s_mov_b32 s17, 0x3f803f80
    v_mov_b32 v8, 0
    v_mov_b32 v9, 0
    v_mov_b32 v10, 0
    v_mov_b32 v11, 0
    v_dot2c_f32_bf16 v8, s17, v120
    v_dot2c_f32_bf16 v9, v120, v120
    v_dot2c_f32_bf16 v10, s17, v121
    v_dot2c_f32_bf16 v11, v121, v121
    v_dot2c_f32_bf16 v8, s17, v122
    v_dot2c_f32_bf16 v9, v122, v122
    v_dot2c_f32_bf16 v10, s17, v123
    v_dot2c_f32_bf16 v11, v123, v123
    v_dot2c_f32_bf16 v8, s17, v124
    v_dot2c_f32_bf16 v9, v124, v124
    v_dot2c_f32_bf16 v10, s17, v125
    v_dot2c_f32_bf16 v11, v125, v125
    v_dot2c_f32_bf16 v8, s17, v126
    v_dot2c_f32_bf16 v9, v126, v126
    v_dot2c_f32_bf16 v10, s17, v127
    v_dot2c_f32_bf16 v11, v127, v127
    v_dot2c_f32_bf16 v8, s17, v128
    v_dot2c_f32_bf16 v9, v128, v128
    v_dot2c_f32_bf16 v10, s17, v129
    v_dot2c_f32_bf16 v11, v129, v129
    v_dot2c_f32_bf16 v8, s17, v130
    v_dot2c_f32_bf16 v9, v130, v130
    v_dot2c_f32_bf16 v10, s17, v131
    v_dot2c_f32_bf16 v11, v131, v131
    v_and_b32 v12, 7, v0
    v_lshlrev_b32 v12, 3, v12
    s_lshl_b32 s7, s3, 6
    v_add_u32 v13, s7, v12
    v_pk_add_f32 v[8:9], v[8:9], v[10:11]
    s_nop 1
    v_add_f32_dpp v8, v8, v8 row_ror:8 row_mask:0xf bank_mask:0xf
    v_add_f32_dpp v9, v9, v9 row_ror:8 row_mask:0xf bank_mask:0xf
    v_mov_b32 v10, v8
    v_mov_b32 v11, v9
    s_nop 1
    v_permlane32_swap_b32 v10, v8
    v_permlane32_swap_b32 v11, v9
    v_add_f32 v8, v8, v10
    v_add_f32 v9, v9, v11
    v_mov_b32 v10, v8
    v_mov_b32 v11, v9
    s_nop 1
    v_permlane16_swap_b32 v10, v8
    v_permlane16_swap_b32 v11, v9
    v_add_f32 v8, v8, v10
    v_add_f32 v9, v9, v11
    ds_write_b64 v13, v[8:9]
    s_waitcnt lgkmcnt(0)
    s_barrier
    ds_read_b64 v[40:41], v12 offset:0
    ds_read_b64 v[42:43], v12 offset:64
    ds_read_b64 v[44:45], v12 offset:128
    ds_read_b64 v[46:47], v12 offset:192
    s_waitcnt lgkmcnt(0)
    v_pk_add_f32 v[40:41], v[40:41], v[42:43]
    v_pk_add_f32 v[44:45], v[44:45], v[46:47]
    v_pk_add_f32 v[8:9], v[40:41], v[44:45]
    v_mul_f32 v8, 0x3ae38e39, v8
    v_mul_f32 v9, 0x3ae38e39, v9
    v_fma_f32 v9, -v8, v8, v9
    v_max_f32 v9, 0, v9
    v_add_f32 v9, 0x3727c5ac, v9
    v_rsq_f32 v10, v9
    s_nop 0
    v_mul_f32 v12, v8, v10
    v_mov_b32 v11, v10
    v_sub_f32 v12, 0, v12
    v_mov_b32 v13, v12
    s_cmp_eq_u32 s3, 0
    s_cselect_b32 s7, 32, 0
    v_lshlrev_b32 v14, 2, v0
    v_cmp_gt_u32 vcc, s7, v0
    v_mov_b32 v9, 1073741824
    s_nop 0
    v_cndmask_b32 v14, v9, v14, vcc
    buffer_store_dword v8, v14, s[8:11], s22 offen sc1
    v_lshlrev_b32 v40, 16, v120
    v_and_b32 v41, s16, v120
    v_lshlrev_b32 v42, 16, v121
    v_and_b32 v43, s16, v121
    v_lshlrev_b32 v44, 16, v122
    v_and_b32 v45, s16, v122
    v_lshlrev_b32 v46, 16, v123
    v_and_b32 v47, s16, v123
    v_pk_fma_f32 v[40:41], v[40:41], v[10:11], v[12:13]
    v_pk_fma_f32 v[42:43], v[42:43], v[10:11], v[12:13]
    v_pk_fma_f32 v[44:45], v[44:45], v[10:11], v[12:13]
    v_pk_fma_f32 v[46:47], v[46:47], v[10:11], v[12:13]
    v_cvt_pk_bf16_f32 v48, v40, v41
    v_cvt_pk_bf16_f32 v49, v42, v43
    v_cvt_pk_bf16_f32 v50, v44, v45
    v_cvt_pk_bf16_f32 v51, v46, v47
    v_lshlrev_b32 v40, 16, v124
    v_and_b32 v41, s16, v124
    v_lshlrev_b32 v42, 16, v125
    v_and_b32 v43, s16, v125
    v_lshlrev_b32 v44, 16, v126
    v_and_b32 v45, s16, v126
    v_lshlrev_b32 v46, 16, v127
    v_and_b32 v47, s16, v127
    v_pk_fma_f32 v[40:41], v[40:41], v[10:11], v[12:13]
    v_pk_fma_f32 v[42:43], v[42:43], v[10:11], v[12:13]
    v_pk_fma_f32 v[44:45], v[44:45], v[10:11], v[12:13]
    v_pk_fma_f32 v[46:47], v[46:47], v[10:11], v[12:13]
    v_cvt_pk_bf16_f32 v52, v40, v41
    v_cvt_pk_bf16_f32 v53, v42, v43
    v_cvt_pk_bf16_f32 v54, v44, v45
    v_cvt_pk_bf16_f32 v55, v46, v47
    v_lshlrev_b32 v40, 16, v128
    v_and_b32 v41, s16, v128
    v_lshlrev_b32 v42, 16, v129
    v_and_b32 v43, s16, v129
    v_lshlrev_b32 v44, 16, v130
    v_and_b32 v45, s16, v130
    v_lshlrev_b32 v46, 16, v131
    v_and_b32 v47, s16, v131
    v_pk_fma_f32 v[40:41], v[40:41], v[10:11], v[12:13]
    v_pk_fma_f32 v[42:43], v[42:43], v[10:11], v[12:13]
    v_pk_fma_f32 v[44:45], v[44:45], v[10:11], v[12:13]
    v_pk_fma_f32 v[46:47], v[46:47], v[10:11], v[12:13]
    v_cvt_pk_bf16_f32 v56, v40, v41
    v_cvt_pk_bf16_f32 v57, v42, v43
    v_cvt_pk_bf16_f32 v58, v44, v45
    v_cvt_pk_bf16_f32 v59, v46, v47
    buffer_store_dwordx4 v[48:51], v172, s[8:11], s20 offen sc1
    buffer_store_dwordx4 v[52:55], v173, s[8:11], s20 offen sc1
    buffer_store_dwordx4 v[56:59], v174, s[8:11], s20 offen sc1
    v_lshlrev_b32 v15, 7, v0
    s_lshl_b32 s6, s40, 2
    s_add_u32 s6, s6, s44
    s_add_u32 s6, s6, 98304
    v_mov_b32 v1, s76
    s_mov_b64 vcc, 0xff
    v_lshrrev_b32 v14, 3, v0
    v_lshl_add_u32 v15, v14, 3, v15
    s_cmp_ge_u32 s40, 6
    s_cselect_b32 s7, s41, 31
    s_cmp_lt_u32 s7, 31
    s_cmov_b64 vcc, 0xffff
    s_waitcnt vmcnt(0)
    s_barrier
    s_cmp_lg_u32 s3, 0
    s_cbranch_scc1 L_pub_46
    s_mov_b64 exec, vcc
    buffer_store_dword v1, v15, s[8:11], s6 offen sc1
L_pub_46:
    s_mov_b64 exec, -1
    s_add_u32 s28, s28, 4096
    buffer_load_dwordx4 a[96:99], v3, s[8:11], s28 offen offset:0 sc1
    buffer_load_dwordx4 a[100:103], v3, s[8:11], s28 offen offset:1024 sc1
    buffer_load_dwordx4 a[104:107], v3, s[8:11], s28 offen offset:2048 sc1
    buffer_load_dwordx4 a[108:111], v3, s[8:11], s28 offen offset:3072 sc1
    s_add_u32 s28, s28, 4096
    buffer_load_dwordx4 a[112:115], v3, s[8:11], s28 offen offset:0 sc1
    buffer_load_dwordx4 a[116:119], v3, s[8:11], s28 offen offset:1024 sc1
    buffer_load_dwordx4 a[120:123], v3, s[8:11], s28 offen offset:2048 sc1
    buffer_load_dwordx4 a[124:127], v3, s[8:11], s28 offen offset:3072 sc1
    s_add_u32 s28, s28, 4096
    buffer_load_dwordx4 a[128:131], v3, s[8:11], s28 offen offset:0 sc1
    buffer_load_dwordx4 a[132:135], v3, s[8:11], s28 offen offset:1024 sc1
    buffer_load_dwordx4 a[136:139], v3, s[8:11], s28 offen offset:2048 sc1
    buffer_load_dwordx4 a[140:143], v3, s[8:11], s28 offen offset:3072 sc1
    s_add_u32 s28, s28, 4096
    s_mov_b32 s42, 1
    s_mov_b32 s43, 0
    s_add_u32 s44, s44, 131072
    s_mov_b32 s74, 0
    s_branch L_main_layer
L_main_last:
    buffer_store_dwordx4 v[120:123], v175, s[12:15], s18 offen sc0 sc1
    buffer_store_dwordx4 v[124:127], v176, s[12:15], s18 offen sc0 sc1
    buffer_store_dwordx4 v[128:131], v177, s[12:15], s18 offen sc0 sc1
    s_or_b32 s7, s40, s41
    s_or_b32 s7, s7, s3
    s_cbranch_scc1 L_done_47
    v_mov_b32 v1, s76
    s_mov_b32 s7, 19660800
    s_mov_b64 exec, 1
    buffer_store_dword v1, off, s[8:11], s7 sc1
    s_mov_b64 exec, -1
L_done_47:
L_main_end:
    s_endpgm
L_main_code_end:
.section .rodata,"a"
.p2align 6
.amdhsa_kernel interleave_layers__sliding_local_dilated__glu_gated_geglu__prompt_kernel
.amdhsa_next_free_vgpr 512
.amdhsa_next_free_sgpr 102
.amdhsa_accum_offset 256
.amdhsa_group_segment_fixed_size 0
.amdhsa_kernarg_size 80
.amdhsa_user_sgpr_count 2
.amdhsa_user_sgpr_kernarg_segment_ptr 1
.amdhsa_system_sgpr_workgroup_id_x 1
.amdhsa_float_denorm_mode_32 3
.amdhsa_float_denorm_mode_16_64 3
.end_amdhsa_kernel
```

```asm
; @launch grid=(256,1,1) block=(256,1,1) lds=163840
.amdgcn_target "amdgcn-amd-amdhsa--gfx950"
.text
.globl interleave_layers__sliding_local_dilated__glu_gated_geglu__prompt_kernel
.p2align 8
.type interleave_layers__sliding_local_dilated__glu_gated_geglu__prompt_kernel,@function
interleave_layers__sliding_local_dilated__glu_gated_geglu__prompt_kernel:
    s_cmp_ge_u32 s2, 256
    s_cbranch_scc1 L_main_end
    s_load_dwordx2 s[4:5], s[0:1], 72
    s_load_dwordx4 s[16:19], s[0:1], 0
    s_load_dwordx2 s[22:23], s[0:1], 16
    s_load_dwordx8 s[24:31], s[0:1], 32
    s_getpc_b64 s[96:97]
L_main_pc:
    s_sub_u32 s96, s96, L_main_pc-interleave_layers__sliding_local_dilated__glu_gated_geglu__prompt_kernel
    s_subb_u32 s97, s97, 0
    s_and_b32 s97, s97, 0xffff
    s_mov_b32 s98, L_main_code_end-interleave_layers__sliding_local_dilated__glu_gated_geglu__prompt_kernel
    s_mov_b32 s99, 0x20000
    s_lshr_b32 s7, s2, 3
    s_lshl_b32 s7, s7, 11
    v_lshl_add_u32 v253, v0, 3, s7
    buffer_load_dwordx2 v[2:3], v253, s[96:99], 0 offen
    v_lshrrev_b32 v1, 6, v0
    v_and_b32 v0, 63, v0
    v_readfirstlane_b32 s3, v1
    s_waitcnt lgkmcnt(0)
    s_mov_b32 s8, s4
    s_and_b32 s9, s5, 0xffff
    s_mov_b32 s10, 268435456
    s_mov_b32 s11, 0x20000
    s_mov_b32 s7, 19660800
    s_load_dword s76, s[4:5], s7
    s_mov_b64 s[20:21], s[18:19]
    s_mov_b64 s[18:19], s[16:17]
    s_mov_b32 s48, s4
    s_and_b32 s49, s5, 0xffff
    s_mov_b32 s50, 268435456
    s_mov_b32 s51, 0x20000
    s_and_b32 s40, s2, 3
    s_lshl_b32 s40, s40, 1
    s_bfe_u32 s7, s2, 65539
    s_add_u32 s40, s40, s7
    s_bfe_u32 s41, s2, 65538
    s_lshl_b32 s41, s41, 4
    s_lshr_b32 s7, s2, 4
    s_add_u32 s41, s41, s7
    s_mov_b32 s42, 0
    s_mov_b32 s43, 0
    s_lshl_b32 s44, s41, 10
    s_add_u32 s44, s44, 19169280
    v_lshlrev_b32 v253, 4, v0
    s_mov_b32 s12, s18
    s_and_b32 s13, s19, 0xffff
    s_mov_b32 s14, 2359296
    s_mov_b32 s15, 0x20000
    s_mov_b32 s64, s20
    s_and_b32 s65, s21, 0xffff
    s_mov_b32 s66, 1990656
    s_mov_b32 s67, 0x20000
    s_mov_b32 s68, s22
    s_and_b32 s69, s23, 0xffff
    s_mov_b32 s70, 663552
    s_mov_b32 s71, 0x20000
    s_mov_b32 s16, 0xffff0000
    s_lshl_b32 s7, s3, 10
    v_add_u32 v172, s7, v253
    v_add_u32 v174, 5120, v172
    v_and_b32 v178, 7, v0
    v_mul_u32_u24 v178, 1152, v178
    v_lshrrev_b32 v179, 3, v0
    v_lshl_add_u32 v178, v179, 4, v178
    s_lshl_b32 s7, s3, 7
    v_add_u32 v175, s7, v178
    v_add_u32 v177, 640, v175
    s_cmp_eq_u32 s3, 0
    s_mov_b32 s17, 1073741824
    s_cmov_b32 s17, 4096
    v_add_u32 v173, s17, v172
    s_mov_b32 s17, 1073741824
    s_cmov_b32 s17, 512
    v_add_u32 v176, s17, v175
    s_lshl_b32 s21, s41, 3
    s_add_u32 s21, s21, s40
    s_mul_i32 s18, s21, 9216
    buffer_load_dwordx4 v[16:19], v175, s[12:15], s18 offen nt
    buffer_load_dwordx4 v[20:23], v176, s[12:15], s18 offen nt
    buffer_load_dwordx4 v[24:27], v177, s[12:15], s18 offen nt
    s_mov_b32 s12, s30
    s_and_b32 s13, s31, 0xffff
    s_mov_b32 s14, 2359296
    s_mov_b32 s15, 0x20000
    s_lshl_b32 s79, s3, 14
    s_add_u32 s79, s79, 98304
    s_sub_u32 s36, s21, 144
    s_cmp_ge_u32 s41, 18
    s_cbranch_scc1 L_prep_o_1
    s_mul_i32 s35, s41, 110592
    s_mul_i32 s7, s40, 144
    s_and_b32 s46, s7, 127
    s_sub_u32 s7, s7, s46
    s_add_u32 s35, s35, s7
    s_mul_i32 s7, s3, 13824
    s_add_u32 s35, s35, s7
    v_lshrrev_b32 v8, 4, v0
    v_mul_u32_u24 v8, 3456, v8
    v_and_b32 v9, 15, v0
    v_lshl_add_u32 v8, v9, 4, v8
    s_lshl_b32 s34, s3, 10
    s_add_u32 m0, s34, 8192
    s_add_u32 s7, s35, 0
    buffer_load_dwordx4 v8, s[64:67], s7 offen nt lds
    s_add_u32 m0, s34, 12288
    s_add_u32 s7, s35, 55296
    buffer_load_dwordx4 v8, s[64:67], s7 offen nt lds
    s_add_u32 m0, s34, 16384
    s_add_u32 s7, s35, 1152
    buffer_load_dwordx4 v8, s[64:67], s7 offen nt lds
    s_add_u32 m0, s34, 20480
    s_add_u32 s7, s35, 56448
    buffer_load_dwordx4 v8, s[64:67], s7 offen nt lds
    s_add_u32 m0, s34, 24576
    s_add_u32 s7, s35, 2304
    buffer_load_dwordx4 v8, s[64:67], s7 offen nt lds
    s_add_u32 m0, s34, 28672
    s_add_u32 s7, s35, 57600
    buffer_load_dwordx4 v8, s[64:67], s7 offen nt lds
    s_branch L_prep_go_3
L_prep_o_1:
    s_cmp_ge_u32 s36, 54
    s_cbranch_scc1 L_prep_m_2
    s_mul_i32 s33, s36, 349526
    s_lshr_b32 s33, s33, 20
    s_mul_i32 s34, s33, 3
    s_sub_u32 s34, s36, s34
    s_lshl_b32 s7, s33, 2
    s_add_u32 s7, s7, s3
    v_mov_b32 v8, s7
    v_lshrrev_b32 v9, 3, v0
    v_mul_u32_u24 v11, 7282, v8
    v_lshrrev_b32 v11, 16, v11
    v_mul_u32_u24 v12, 9, v11
    v_sub_u32 v12, v8, v12
    v_mul_u32_u24 v11, 72, v11
    v_cmp_eq_u32 vcc, 8, v12
    v_lshrrev_b32 v10, 1, v12
    v_mad_u32_u24 v10, v10, 18, v11
    v_and_b32 v12, 1, v12
    v_lshl_add_u32 v10, v12, 3, v10
    v_add_u32 v10, v10, v9
    v_lshrrev_b32 v12, 1, v9
    v_mad_u32_u24 v11, v12, 18, v11
    v_and_b32 v12, 1, v9
    v_add3_u32 v11, v11, v12, 16
    v_cndmask_b32 v10, v10, v11, vcc
    v_mul_u32_u24 v10, 1152, v10
    v_and_b32 v9, 7, v0
    v_lshl_add_u32 v10, v9, 4, v10
    s_mul_i32 s35, s34, 384
    s_lshl_b32 s6, s3, 10
    s_add_u32 m0, s6, 8192
    s_add_u32 s7, s35, 0
    buffer_load_dwordx4 v10, s[68:71], s7 offen nt lds
    s_add_u32 m0, s6, 12288
    s_add_u32 s7, s35, 128
    buffer_load_dwordx4 v10, s[68:71], s7 offen nt lds
    s_add_u32 m0, s6, 16384
    s_add_u32 s7, s35, 256
    buffer_load_dwordx4 v10, s[68:71], s7 offen nt lds
    s_branch L_prep_go_3
L_prep_m_2:
    s_sub_u32 s37, s36, 54
    s_lshl_b32 s7, s3, 6
    s_add_u32 s37, s37, s7
    s_cmp_ge_u32 s37, 36
    s_cbranch_scc1 L_prep_go_3
    s_lshl_b32 s7, s37, 1
    v_bfe_u32 v8, v0, 3, 1
    v_add_u32 v8, s7, v8
    v_and_b32 v9, 7, v0
    v_mul_u32_u24 v11, 7282, v8
    v_lshrrev_b32 v11, 16, v11
    v_mul_u32_u24 v12, 9, v11
    v_sub_u32 v12, v8, v12
    v_mul_u32_u24 v11, 72, v11
    v_cmp_eq_u32 vcc, 8, v12
    v_lshrrev_b32 v10, 1, v12
    v_mad_u32_u24 v10, v10, 18, v11
    v_and_b32 v12, 1, v12
    v_lshl_add_u32 v10, v12, 3, v10
    v_add_u32 v10, v10, v9
    v_lshrrev_b32 v12, 1, v9
    v_mad_u32_u24 v11, v12, 18, v11
    v_and_b32 v12, 1, v9
    v_add3_u32 v11, v11, v12, 16
    v_cndmask_b32 v10, v10, v11, vcc
    v_mul_u32_u24 v10, 1152, v10
    v_lshrrev_b32 v9, 4, v0
    v_lshl_add_u32 v10, v9, 4, v10
    buffer_load_dwordx4 v[64:67], v10, s[68:71], 0 offen offset:0
    buffer_load_dwordx4 v[68:71], v10, s[68:71], 0 offen offset:64
    buffer_load_dwordx4 v[72:75], v10, s[68:71], 0 offen offset:128
    buffer_load_dwordx4 v[76:79], v10, s[68:71], 0 offen offset:192
    buffer_load_dwordx4 v[80:83], v10, s[68:71], 0 offen offset:256
    buffer_load_dwordx4 v[84:87], v10, s[68:71], 0 offen offset:320
    buffer_load_dwordx4 v[88:91], v10, s[68:71], 0 offen offset:384
    buffer_load_dwordx4 v[92:95], v10, s[68:71], 0 offen offset:448
    buffer_load_dwordx4 v[96:99], v10, s[68:71], 0 offen offset:512
    buffer_load_dwordx4 v[100:103], v10, s[68:71], 0 offen offset:576
    buffer_load_dwordx4 v[104:107], v10, s[68:71], 0 offen offset:640
    buffer_load_dwordx4 v[108:111], v10, s[68:71], 0 offen offset:704
    buffer_load_dwordx4 v[112:115], v10, s[68:71], 0 offen offset:768
    buffer_load_dwordx4 v[116:119], v10, s[68:71], 0 offen offset:832
    buffer_load_dwordx4 v[120:123], v10, s[68:71], 0 offen offset:896
    buffer_load_dwordx4 v[124:127], v10, s[68:71], 0 offen offset:960
    buffer_load_dwordx4 v[128:131], v10, s[68:71], 0 offen offset:1024
    buffer_load_dwordx4 v[132:135], v10, s[68:71], 0 offen offset:1088
L_prep_go_3:
    s_lshl_b32 s7, s41, 2
    s_add_u32 s7, s7, s3
    s_mul_i32 s93, s7, 25576
    s_lshr_b32 s93, s93, 20
    s_min_u32 s93, s93, 2
    s_mul_i32 s6, s93, 41
    s_sub_u32 s7, s7, s6
    s_lshl_b32 s17, s7, 2
    s_cmp_eq_u32 s93, 1
    s_cselect_b32 s72, s26, s24
    s_cselect_b32 s73, s27, s25
    s_cmp_eq_u32 s93, 2
    s_cselect_b32 s72, s28, s72
    s_cselect_b32 s73, s29, s73
    s_mov_b32 s92, 73728
    s_cmov_b32 s92, 9216
    s_mov_b32 s47, 1152
    s_cmov_b32 s47, 663552
    s_and_b32 s73, s73, 0xffff
    s_mov_b32 s74, 5308416
    s_mov_b32 s75, 0x20000
    s_mul_i32 s47, s47, s40
    s_add_u32 s7, s17, 0
    s_min_u32 s7, s7, 161
    s_mul_i32 s84, s7, 116509
    s_lshr_b32 s84, s84, 20
    s_mul_i32 s88, s84, 9
    s_sub_u32 s88, s7, s88
    s_mul_i32 s7, s84, s92
    s_lshl_b32 s7, s7, 2
    s_add_u32 s7, s7, s47
    s_lshl_b32 s6, s88, 7
    s_add_u32 s80, s7, s6
    s_add_u32 s7, s17, 1
    s_min_u32 s7, s7, 161
    s_mul_i32 s85, s7, 116509
    s_lshr_b32 s85, s85, 20
    s_mul_i32 s89, s85, 9
    s_sub_u32 s89, s7, s89
    s_mul_i32 s7, s85, s92
    s_lshl_b32 s7, s7, 2
    s_add_u32 s7, s7, s47
    s_lshl_b32 s6, s89, 7
    s_add_u32 s81, s7, s6
    s_add_u32 s7, s17, 2
    s_min_u32 s7, s7, 161
    s_mul_i32 s86, s7, 116509
    s_lshr_b32 s86, s86, 20
    s_mul_i32 s90, s86, 9
    s_sub_u32 s90, s7, s90
    s_mul_i32 s7, s86, s92
    s_lshl_b32 s7, s7, 2
    s_add_u32 s7, s7, s47
    s_lshl_b32 s6, s90, 7
    s_add_u32 s82, s7, s6
    s_add_u32 s7, s17, 3
    s_min_u32 s7, s7, 161
    s_mul_i32 s87, s7, 116509
    s_lshr_b32 s87, s87, 20
    s_mul_i32 s91, s87, 9
    s_sub_u32 s91, s7, s91
    s_mul_i32 s7, s87, s92
    s_lshl_b32 s7, s7, 2
    s_add_u32 s7, s7, s47
    s_lshl_b32 s6, s91, 7
    s_add_u32 s83, s7, s6
    s_lshr_b32 s7, s92, 3
    v_lshrrev_b32 v224, 3, v0
    v_mul_lo_u32 v224, v224, s7
    v_and_b32 v8, 7, v0
    v_lshl_add_u32 v224, v8, 4, v224
    s_waitcnt lgkmcnt(0)
    s_mul_i32 s76, s76, 0x9e3779b1
    s_add_u32 s76, s76, 0x7f4a7c15
    s_mov_b32 s77, s76
    s_add_u32 m0, s79, 0
    s_mov_b32 s71, s80
    buffer_load_dwordx4 v224, s[72:75], s71 offen nt lds
    s_add_u32 m0, s79, 1024
    s_add_u32 s71, s71, s92
    buffer_load_dwordx4 v224, s[72:75], s71 offen nt lds
    s_add_u32 m0, s79, 2048
    s_add_u32 s71, s71, s92
    buffer_load_dwordx4 v224, s[72:75], s71 offen nt lds
    s_waitcnt vmcnt(3)
    s_barrier
    s_cmp_ge_u32 s41, 18
    s_cbranch_scc1 L_prep_o_4
    s_mul_i32 s7, s3, 36
    s_add_u32 s7, s7, s46
    v_lshrrev_b32 v8, 4, v0
    v_lshlrev_b32 v8, 11, v8
    v_add_u32 v8, s7, v8
    v_and_b32 v9, 15, v0
    v_cmp_gt_u32 s[22:23], 6, v9
    v_lshrrev_b32 v10, 1, v9
    v_min_u32 v10, 2, v10
    v_lshl_add_u32 v10, v10, 13, v8
    v_and_b32 v11, 1, v0
    v_lshl_add_u32 v10, v11, 1, v10
    v_lshl_add_u32 v8, v9, 1, v8
    ds_read_u16 v136, v8 offset:8192
    ds_read_u16 v137, v8 offset:8448
    ds_read_u16 v138, v8 offset:8704
    ds_read_u16 v139, v8 offset:8960
    ds_read_u16 v140, v8 offset:9216
    ds_read_u16 v141, v8 offset:9472
    ds_read_u16 v142, v8 offset:9728
    ds_read_u16 v143, v8 offset:9984
    s_lshl_b32 s33, s40, 2
    s_add_u32 s33, s33, s3
    s_mul_i32 s33, s33, 18
    s_add_u32 s33, s33, s41
    s_lshl_b32 s33, s33, 12
    ds_read_u16 v144, v8 offset:16384
    ds_read_u16 v145, v8 offset:16640
    ds_read_u16 v146, v8 offset:16896
    ds_read_u16 v147, v8 offset:17152
    ds_read_u16 v148, v8 offset:17408
    ds_read_u16 v149, v8 offset:17664
    ds_read_u16 v150, v8 offset:17920
    ds_read_u16 v151, v8 offset:18176
    s_waitcnt lgkmcnt(8)
    v_lshl_or_b32 v32, v137, 16, v136
    v_lshl_or_b32 v33, v139, 16, v138
    v_lshl_or_b32 v34, v141, 16, v140
    v_lshl_or_b32 v35, v143, 16, v142
    buffer_store_dwordx4 v[32:35], v253, s[8:11], s33 offen offset:0 sc1
    ds_read_u16 v152, v8 offset:24576
    ds_read_u16 v153, v8 offset:24832
    ds_read_u16 v154, v8 offset:25088
    ds_read_u16 v155, v8 offset:25344
    ds_read_u16 v156, v8 offset:25600
    ds_read_u16 v157, v8 offset:25856
    ds_read_u16 v158, v8 offset:26112
    ds_read_u16 v159, v8 offset:26368
    s_waitcnt lgkmcnt(8)
    v_lshl_or_b32 v36, v145, 16, v144
    v_lshl_or_b32 v37, v147, 16, v146
    v_lshl_or_b32 v38, v149, 16, v148
    v_lshl_or_b32 v39, v151, 16, v150
    buffer_store_dwordx4 v[36:39], v253, s[8:11], s33 offen offset:1024 sc1
    ds_read_u16 v160, v10 offset:8224
    ds_read_u16 v161, v10 offset:8480
    ds_read_u16 v162, v10 offset:8736
    ds_read_u16 v163, v10 offset:8992
    ds_read_u16 v164, v10 offset:9248
    ds_read_u16 v165, v10 offset:9504
    ds_read_u16 v166, v10 offset:9760
    ds_read_u16 v167, v10 offset:10016
    s_waitcnt lgkmcnt(8)
    v_lshl_or_b32 v40, v153, 16, v152
    v_lshl_or_b32 v41, v155, 16, v154
    v_lshl_or_b32 v42, v157, 16, v156
    v_lshl_or_b32 v43, v159, 16, v158
    buffer_store_dwordx4 v[40:43], v253, s[8:11], s33 offen offset:2048 sc1
    s_waitcnt lgkmcnt(0)
    v_lshl_or_b32 v44, v161, 16, v160
    v_cndmask_b32 v44, 0, v44, s[22:23]
    v_lshl_or_b32 v45, v163, 16, v162
    v_cndmask_b32 v45, 0, v45, s[22:23]
    v_lshl_or_b32 v46, v165, 16, v164
    v_cndmask_b32 v46, 0, v46, s[22:23]
    v_lshl_or_b32 v47, v167, 16, v166
    v_cndmask_b32 v47, 0, v47, s[22:23]
    buffer_store_dwordx4 v[44:47], v253, s[8:11], s33 offen offset:3072 sc1
    s_branch L_prep_done_6
L_prep_o_4:
    s_cmp_ge_u32 s36, 54
    s_cbranch_scc1 L_prep_m_5
    v_lshrrev_b32 v8, 4, v0
    v_lshlrev_b32 v8, 3, v8
    v_bfe_u32 v9, v0, 2, 2
    v_add_u32 v8, v8, v9
    v_mul_u32_u24 v8, 128, v8
    v_and_b32 v9, 3, v0
    v_lshl_add_u32 v8, v9, 3, v8
    s_lshl_b32 s7, s3, 5
    v_add_u32 v8, s7, v8
    ds_read_b64_tr_b16 v[32:33], v8 offset:8192
    ds_read_b64_tr_b16 v[34:35], v8 offset:8704
    ds_read_b64_tr_b16 v[36:37], v8 offset:12288
    ds_read_b64_tr_b16 v[38:39], v8 offset:12800
    ds_read_b64_tr_b16 v[40:41], v8 offset:16384
    ds_read_b64_tr_b16 v[42:43], v8 offset:16896
    s_mul_i32 s34, s34, 12
    s_add_u32 s34, s34, s3
    s_mul_i32 s34, s34, 18
    s_add_u32 s34, s34, s33
    s_lshl_b32 s34, s34, 10
    s_add_u32 s7, s34, 2359296
    s_waitcnt lgkmcnt(4)
    buffer_store_dwordx4 v[32:35], v253, s[8:11], s7 offen sc1
    s_add_u32 s7, s34, 2433024
    s_waitcnt lgkmcnt(2)
    buffer_store_dwordx4 v[36:39], v253, s[8:11], s7 offen sc1
    s_add_u32 s7, s34, 2506752
    s_waitcnt lgkmcnt(0)
    buffer_store_dwordx4 v[40:43], v253, s[8:11], s7 offen sc1
    s_branch L_prep_done_6
L_prep_m_5:
    s_cmp_ge_u32 s37, 36
    s_cbranch_scc1 L_prep_done_6
    v_mov_b32 v28, 0x3f803f80
    v_mov_b32 v29, 0x3f803f80
    v_mov_b32 v30, 0x3f803f80
    v_mov_b32 v31, 0x3f803f80
    v_and_b32 v9, 15, v0
    v_cmp_eq_u32 vcc, 0, v9
    v_cmp_eq_u32 s[22:23], 1, v9
    v_mfma_f32_16x16x32_bf16 v[32:35], v[64:67], v[28:31], 0
    v_mfma_f32_16x16x32_bf16 v[32:35], v[68:71], v[28:31], v[32:35]
    v_mfma_f32_16x16x32_bf16 v[32:35], v[72:75], v[28:31], v[32:35]
    v_mfma_f32_16x16x32_bf16 v[32:35], v[76:79], v[28:31], v[32:35]
    v_mfma_f32_16x16x32_bf16 v[32:35], v[80:83], v[28:31], v[32:35]
    v_mfma_f32_16x16x32_bf16 v[32:35], v[84:87], v[28:31], v[32:35]
    v_mfma_f32_16x16x32_bf16 v[32:35], v[88:91], v[28:31], v[32:35]
    v_mfma_f32_16x16x32_bf16 v[32:35], v[92:95], v[28:31], v[32:35]
    v_mfma_f32_16x16x32_bf16 v[32:35], v[96:99], v[28:31], v[32:35]
    v_mfma_f32_16x16x32_bf16 v[32:35], v[100:103], v[28:31], v[32:35]
    v_mfma_f32_16x16x32_bf16 v[32:35], v[104:107], v[28:31], v[32:35]
    v_mfma_f32_16x16x32_bf16 v[32:35], v[108:111], v[28:31], v[32:35]
    v_mfma_f32_16x16x32_bf16 v[32:35], v[112:115], v[28:31], v[32:35]
    v_mfma_f32_16x16x32_bf16 v[32:35], v[116:119], v[28:31], v[32:35]
    v_mfma_f32_16x16x32_bf16 v[32:35], v[120:123], v[28:31], v[32:35]
    v_mfma_f32_16x16x32_bf16 v[32:35], v[124:127], v[28:31], v[32:35]
    v_mfma_f32_16x16x32_bf16 v[32:35], v[128:131], v[28:31], v[32:35]
    v_mfma_f32_16x16x32_bf16 v[32:35], v[132:135], v[28:31], v[32:35]
    v_lshrrev_b32 v10, 5, v0
    v_lshlrev_b32 v10, 8, v10
    v_lshl_add_u32 v10, v9, 4, v10
    v_bfe_u32 v9, v0, 4, 1
    v_lshl_add_u32 v10, v9, 3, v10
    s_lshl_b32 s7, s37, 9
    s_add_u32 s7, s7, 3022848
    s_nop 0
    v_mul_f32 v32, 0x3ae38e39, v32
    v_mul_f32 v33, 0x3ae38e39, v33
    v_mul_f32 v34, 0x3ae38e39, v34
    v_mul_f32 v35, 0x3ae38e39, v35
    v_cvt_pk_bf16_f32 v36, v32, v33
    v_cvt_pk_bf16_f32 v37, v34, v35
    v_lshlrev_b32 v38, 16, v36
    v_and_b32 v39, s16, v36
    v_sub_f32 v38, v32, v38
    v_sub_f32 v39, v33, v39
    v_cvt_pk_bf16_f32 v28, v38, v39
    v_cndmask_b32 v28, 0, v28, s[22:23]
    v_cndmask_b32 v28, v28, v36, vcc
    v_lshlrev_b32 v38, 16, v37
    v_and_b32 v39, s16, v37
    v_sub_f32 v38, v34, v38
    v_sub_f32 v39, v35, v39
    v_cvt_pk_bf16_f32 v29, v38, v39
    v_cndmask_b32 v29, 0, v29, s[22:23]
    v_cndmask_b32 v29, v29, v37, vcc
    buffer_store_dwordx2 v[28:29], v10, s[8:11], s7 offen sc1
L_prep_done_6:
    s_add_u32 s19, s18, 43515904
    s_add_u32 s20, s18, 38797312
    s_lshl_b32 s22, s21, 7
    s_add_u32 s22, s22, 48234496
    buffer_store_dwordx4 v[16:19], v172, s[8:11], s19 offen sc1
    buffer_store_dwordx4 v[20:23], v173, s[8:11], s19 offen sc1
    buffer_store_dwordx4 v[24:27], v174, s[8:11], s19 offen sc1
    s_mov_b32 s17, 0x3f803f80
    v_mov_b32 v8, 0
    v_mov_b32 v9, 0
    v_mov_b32 v10, 0
    v_mov_b32 v11, 0
    v_dot2c_f32_bf16 v8, s17, v16
    v_dot2c_f32_bf16 v9, v16, v16
    v_dot2c_f32_bf16 v10, s17, v17
    v_dot2c_f32_bf16 v11, v17, v17
    v_dot2c_f32_bf16 v8, s17, v18
    v_dot2c_f32_bf16 v9, v18, v18
    v_dot2c_f32_bf16 v10, s17, v19
    v_dot2c_f32_bf16 v11, v19, v19
    v_dot2c_f32_bf16 v8, s17, v20
    v_dot2c_f32_bf16 v9, v20, v20
    v_dot2c_f32_bf16 v10, s17, v21
    v_dot2c_f32_bf16 v11, v21, v21
    v_dot2c_f32_bf16 v8, s17, v22
    v_dot2c_f32_bf16 v9, v22, v22
    v_dot2c_f32_bf16 v10, s17, v23
    v_dot2c_f32_bf16 v11, v23, v23
    v_dot2c_f32_bf16 v8, s17, v24
    v_dot2c_f32_bf16 v9, v24, v24
    v_dot2c_f32_bf16 v10, s17, v25
    v_dot2c_f32_bf16 v11, v25, v25
    v_dot2c_f32_bf16 v8, s17, v26
    v_dot2c_f32_bf16 v9, v26, v26
    v_dot2c_f32_bf16 v10, s17, v27
    v_dot2c_f32_bf16 v11, v27, v27
    v_and_b32 v12, 7, v0
    v_lshlrev_b32 v12, 3, v12
    s_lshl_b32 s7, s3, 6
    v_add_u32 v13, s7, v12
    v_pk_add_f32 v[8:9], v[8:9], v[10:11]
    s_nop 1
    v_add_f32_dpp v8, v8, v8 row_ror:8 row_mask:0xf bank_mask:0xf
    v_add_f32_dpp v9, v9, v9 row_ror:8 row_mask:0xf bank_mask:0xf
    v_mov_b32 v10, v8
    v_mov_b32 v11, v9
    s_nop 1
    v_permlane32_swap_b32 v10, v8
    v_permlane32_swap_b32 v11, v9
    v_add_f32 v8, v8, v10
    v_add_f32 v9, v9, v11
    v_mov_b32 v10, v8
    v_mov_b32 v11, v9
    s_nop 1
    v_permlane16_swap_b32 v10, v8
    v_permlane16_swap_b32 v11, v9
    v_add_f32 v8, v8, v10
    v_add_f32 v9, v9, v11
    ds_write_b64 v13, v[8:9]
    s_waitcnt lgkmcnt(0)
    s_barrier
    ds_read_b64 v[40:41], v12 offset:0
    ds_read_b64 v[42:43], v12 offset:64
    ds_read_b64 v[44:45], v12 offset:128
    ds_read_b64 v[46:47], v12 offset:192
    s_waitcnt lgkmcnt(0)
    v_pk_add_f32 v[40:41], v[40:41], v[42:43]
    v_pk_add_f32 v[44:45], v[44:45], v[46:47]
    v_pk_add_f32 v[8:9], v[40:41], v[44:45]
    v_mul_f32 v8, 0x3ae38e39, v8
    v_mul_f32 v9, 0x3ae38e39, v9
    v_fma_f32 v9, -v8, v8, v9
    v_max_f32 v9, 0, v9
    v_add_f32 v9, 0x3727c5ac, v9
    v_rsq_f32 v10, v9
    s_nop 0
    v_mul_f32 v12, v8, v10
    v_mov_b32 v11, v10
    v_sub_f32 v12, 0, v12
    v_mov_b32 v13, v12
    s_cmp_eq_u32 s3, 0
    s_cselect_b32 s7, 32, 0
    v_lshlrev_b32 v14, 2, v0
    v_cmp_gt_u32 vcc, s7, v0
    v_mov_b32 v9, 1073741824
    s_nop 0
    v_cndmask_b32 v14, v9, v14, vcc
    buffer_store_dword v8, v14, s[8:11], s22 offen sc1
    v_lshlrev_b32 v40, 16, v16
    v_and_b32 v41, s16, v16
    v_lshlrev_b32 v42, 16, v17
    v_and_b32 v43, s16, v17
    v_lshlrev_b32 v44, 16, v18
    v_and_b32 v45, s16, v18
    v_lshlrev_b32 v46, 16, v19
    v_and_b32 v47, s16, v19
    v_pk_fma_f32 v[40:41], v[40:41], v[10:11], v[12:13]
    v_pk_fma_f32 v[42:43], v[42:43], v[10:11], v[12:13]
    v_pk_fma_f32 v[44:45], v[44:45], v[10:11], v[12:13]
    v_pk_fma_f32 v[46:47], v[46:47], v[10:11], v[12:13]
    v_cvt_pk_bf16_f32 v48, v40, v41
    v_cvt_pk_bf16_f32 v49, v42, v43
    v_cvt_pk_bf16_f32 v50, v44, v45
    v_cvt_pk_bf16_f32 v51, v46, v47
    v_lshlrev_b32 v40, 16, v20
    v_and_b32 v41, s16, v20
    v_lshlrev_b32 v42, 16, v21
    v_and_b32 v43, s16, v21
    v_lshlrev_b32 v44, 16, v22
    v_and_b32 v45, s16, v22
    v_lshlrev_b32 v46, 16, v23
    v_and_b32 v47, s16, v23
    v_pk_fma_f32 v[40:41], v[40:41], v[10:11], v[12:13]
    v_pk_fma_f32 v[42:43], v[42:43], v[10:11], v[12:13]
    v_pk_fma_f32 v[44:45], v[44:45], v[10:11], v[12:13]
    v_pk_fma_f32 v[46:47], v[46:47], v[10:11], v[12:13]
    v_cvt_pk_bf16_f32 v52, v40, v41
    v_cvt_pk_bf16_f32 v53, v42, v43
    v_cvt_pk_bf16_f32 v54, v44, v45
    v_cvt_pk_bf16_f32 v55, v46, v47
    v_lshlrev_b32 v40, 16, v24
    v_and_b32 v41, s16, v24
    v_lshlrev_b32 v42, 16, v25
    v_and_b32 v43, s16, v25
    v_lshlrev_b32 v44, 16, v26
    v_and_b32 v45, s16, v26
    v_lshlrev_b32 v46, 16, v27
    v_and_b32 v47, s16, v27
    v_pk_fma_f32 v[40:41], v[40:41], v[10:11], v[12:13]
    v_pk_fma_f32 v[42:43], v[42:43], v[10:11], v[12:13]
    v_pk_fma_f32 v[44:45], v[44:45], v[10:11], v[12:13]
    v_pk_fma_f32 v[46:47], v[46:47], v[10:11], v[12:13]
    v_cvt_pk_bf16_f32 v56, v40, v41
    v_cvt_pk_bf16_f32 v57, v42, v43
    v_cvt_pk_bf16_f32 v58, v44, v45
    v_cvt_pk_bf16_f32 v59, v46, v47
    buffer_store_dwordx4 v[48:51], v172, s[8:11], s20 offen sc1
    buffer_store_dwordx4 v[52:55], v173, s[8:11], s20 offen sc1
    buffer_store_dwordx4 v[56:59], v174, s[8:11], s20 offen sc1
    v_lshlrev_b32 v15, 7, v0
    s_lshl_b32 s6, s40, 2
    s_add_u32 s6, s6, s44
    s_sub_u32 s6, s6, 32768
    v_mov_b32 v1, s76
    s_mov_b64 vcc, 0xff
    v_lshrrev_b32 v14, 3, v0
    v_lshl_add_u32 v15, v14, 3, v15
    s_cmp_ge_u32 s40, 6
    s_cselect_b32 s7, s41, 31
    s_cmp_lt_u32 s7, 31
    s_cmov_b64 vcc, 0xffff
    s_waitcnt vmcnt(0)
    s_barrier
    s_cmp_lg_u32 s3, 0
    s_cbranch_scc1 L_pub_7
    s_mov_b64 exec, vcc
    buffer_store_dword v1, v15, s[8:11], s6 offen sc1
    v_lshlrev_b32 v15, 10, v0
    s_lshl_b32 s6, s40, 7
    s_lshl_b32 s7, s41, 2
    s_add_u32 s6, s6, s7
    s_add_u32 s6, s6, 19431424
    s_mov_b64 exec, 0xffffffff
    v_lshlrev_b32 v15, 10, v0
    v_mov_b32 v1, s76
    buffer_store_dword v1, v15, s[8:11], s6 offen sc1
    s_cmp_lt_u32 s41, 18
    s_cbranch_scc1 L_pub_7
    s_lshl_b32 s6, s36, 2
    s_add_u32 s6, s6, 19496960
    s_mov_b64 exec, 1
    buffer_store_dword v1, off, s[8:11], s6 sc1
L_pub_7:
    s_mov_b64 exec, -1
    s_add_u32 m0, s79, 3072
    s_add_u32 s71, s71, s92
    buffer_load_dwordx4 v224, s[72:75], s71 offen nt lds
    s_add_u32 m0, s79, 4096
    s_mov_b32 s71, s81
    buffer_load_dwordx4 v224, s[72:75], s71 offen nt lds
    s_add_u32 m0, s79, 5120
    s_add_u32 s71, s71, s92
    buffer_load_dwordx4 v224, s[72:75], s71 offen nt lds
    s_add_u32 m0, s79, 6144
    s_add_u32 s71, s71, s92
    buffer_load_dwordx4 v224, s[72:75], s71 offen nt lds
    s_add_u32 m0, s79, 7168
    s_add_u32 s71, s71, s92
    buffer_load_dwordx4 v224, s[72:75], s71 offen nt lds
    s_add_u32 m0, s79, 8192
    s_mov_b32 s71, s82
    buffer_load_dwordx4 v224, s[72:75], s71 offen nt lds
    s_add_u32 m0, s79, 9216
    s_add_u32 s71, s71, s92
    buffer_load_dwordx4 v224, s[72:75], s71 offen nt lds
    s_add_u32 m0, s79, 10240
    s_add_u32 s71, s71, s92
    buffer_load_dwordx4 v224, s[72:75], s71 offen nt lds
    s_add_u32 m0, s79, 11264
    s_add_u32 s71, s71, s92
    buffer_load_dwordx4 v224, s[72:75], s71 offen nt lds
    s_add_u32 m0, s79, 12288
    s_mov_b32 s71, s83
    buffer_load_dwordx4 v224, s[72:75], s71 offen nt lds
    s_add_u32 m0, s79, 13312
    s_add_u32 s71, s71, s92
    buffer_load_dwordx4 v224, s[72:75], s71 offen nt lds
    s_add_u32 m0, s79, 14336
    s_add_u32 s71, s71, s92
    buffer_load_dwordx4 v224, s[72:75], s71 offen nt lds
    s_add_u32 m0, s79, 15360
    s_add_u32 s71, s71, s92
    buffer_load_dwordx4 v224, s[72:75], s71 offen nt lds
    s_cmp_lg_u32 s3, 0
    s_cbranch_scc1 L_wq_ready_8
    s_lshl_b32 s7, s41, 3
    s_add_u32 s7, s7, s40
    s_lshl_b32 s7, s7, 7
    s_add_u32 s7, s7, 19431424
    s_add_u32 s68, s4, s7
    s_addc_u32 s69, s5, 0
    s_mov_b32 s6, 0
    s_mov_b32 s7, 0
L_cpoll_9:
    s_load_dwordx16 s[52:67], s[68:69], s7 glc
    s_add_u32 s6, s6, 1
    s_waitcnt lgkmcnt(0)
    s_xor_b64 s[52:53], s[52:53], s[76:77]
    s_xor_b64 s[54:55], s[54:55], s[76:77]
    s_xor_b64 s[56:57], s[56:57], s[76:77]
    s_xor_b64 s[58:59], s[58:59], s[76:77]
    s_xor_b64 s[60:61], s[60:61], s[76:77]
    s_xor_b64 s[62:63], s[62:63], s[76:77]
    s_xor_b64 s[64:65], s[64:65], s[76:77]
    s_xor_b64 s[66:67], s[66:67], s[76:77]
    s_or_b64 s[52:53], s[52:53], s[60:61]
    s_or_b64 s[54:55], s[54:55], s[62:63]
    s_or_b64 s[56:57], s[56:57], s[64:65]
    s_or_b64 s[58:59], s[58:59], s[66:67]
    s_or_b64 s[52:53], s[52:53], s[56:57]
    s_or_b64 s[54:55], s[54:55], s[58:59]
    s_or_b64 s[52:53], s[52:53], s[54:55]
    s_cbranch_scc1 L_cpoll_10
    s_add_u32 s7, s7, 8
    s_cmp_eq_u32 s7, 16
    s_cbranch_scc1 L_cpolled_11
L_cpoll_10:
    s_cmp_lt_u32 s6, 1048576
    s_cbranch_scc1 L_cpoll_9
    s_branch L_main_end
L_cpolled_11:
L_wq_ready_8:
    s_barrier
    s_lshl_b32 s28, s40, 2
    s_add_u32 s28, s28, s3
    s_mul_i32 s28, s28, 73728
    buffer_load_dwordx4 a[0:3], v253, s[8:11], s28 offen offset:0 sc1
    buffer_load_dwordx4 a[4:7], v253, s[8:11], s28 offen offset:1024 sc1
    buffer_load_dwordx4 a[8:11], v253, s[8:11], s28 offen offset:2048 sc1
    buffer_load_dwordx4 a[12:15], v253, s[8:11], s28 offen offset:3072 sc1
    s_add_u32 s28, s28, 4096
    buffer_load_dwordx4 a[16:19], v253, s[8:11], s28 offen offset:0 sc1
    buffer_load_dwordx4 a[20:23], v253, s[8:11], s28 offen offset:1024 sc1
    buffer_load_dwordx4 a[24:27], v253, s[8:11], s28 offen offset:2048 sc1
    buffer_load_dwordx4 a[28:31], v253, s[8:11], s28 offen offset:3072 sc1
    s_add_u32 s28, s28, 4096
    buffer_load_dwordx4 a[32:35], v253, s[8:11], s28 offen offset:0 sc1
    buffer_load_dwordx4 a[36:39], v253, s[8:11], s28 offen offset:1024 sc1
    buffer_load_dwordx4 a[40:43], v253, s[8:11], s28 offen offset:2048 sc1
    buffer_load_dwordx4 a[44:47], v253, s[8:11], s28 offen offset:3072 sc1
    s_add_u32 s28, s28, 4096
    buffer_load_dwordx4 a[48:51], v253, s[8:11], s28 offen offset:0 sc1
    buffer_load_dwordx4 a[52:55], v253, s[8:11], s28 offen offset:1024 sc1
    buffer_load_dwordx4 a[56:59], v253, s[8:11], s28 offen offset:2048 sc1
    buffer_load_dwordx4 a[60:63], v253, s[8:11], s28 offen offset:3072 sc1
    s_add_u32 s28, s28, 4096
    buffer_load_dwordx4 a[64:67], v253, s[8:11], s28 offen offset:0 sc1
    buffer_load_dwordx4 a[68:71], v253, s[8:11], s28 offen offset:1024 sc1
    buffer_load_dwordx4 a[72:75], v253, s[8:11], s28 offen offset:2048 sc1
    buffer_load_dwordx4 a[76:79], v253, s[8:11], s28 offen offset:3072 sc1
    s_add_u32 s28, s28, 4096
    buffer_load_dwordx4 a[80:83], v253, s[8:11], s28 offen offset:0 sc1
    buffer_load_dwordx4 a[84:87], v253, s[8:11], s28 offen offset:1024 sc1
    buffer_load_dwordx4 a[88:91], v253, s[8:11], s28 offen offset:2048 sc1
    buffer_load_dwordx4 a[92:95], v253, s[8:11], s28 offen offset:3072 sc1
    s_add_u32 s28, s28, 4096
    buffer_load_dwordx4 a[96:99], v253, s[8:11], s28 offen offset:0 sc1
    buffer_load_dwordx4 a[100:103], v253, s[8:11], s28 offen offset:1024 sc1
    buffer_load_dwordx4 a[104:107], v253, s[8:11], s28 offen offset:2048 sc1
    buffer_load_dwordx4 a[108:111], v253, s[8:11], s28 offen offset:3072 sc1
    s_add_u32 s28, s28, 4096
    buffer_load_dwordx4 a[112:115], v253, s[8:11], s28 offen offset:0 sc1
    buffer_load_dwordx4 a[116:119], v253, s[8:11], s28 offen offset:1024 sc1
    buffer_load_dwordx4 a[120:123], v253, s[8:11], s28 offen offset:2048 sc1
    buffer_load_dwordx4 a[124:127], v253, s[8:11], s28 offen offset:3072 sc1
    s_add_u32 s28, s28, 4096
    buffer_load_dwordx4 a[128:131], v253, s[8:11], s28 offen offset:0 sc1
    buffer_load_dwordx4 a[132:135], v253, s[8:11], s28 offen offset:1024 sc1
    buffer_load_dwordx4 a[136:139], v253, s[8:11], s28 offen offset:2048 sc1
    buffer_load_dwordx4 a[140:143], v253, s[8:11], s28 offen offset:3072 sc1
    s_add_u32 s28, s28, 4096
L_main_layer:
    v_bfe_u32 v3, v0, 3, 1
    v_mul_u32_u24 v2, 9216, v3
    v_lshrrev_b32 v3, 4, v0
    v_lshl_add_u32 v2, v3, 7, v2
    v_and_b32 v3, 7, v0
    v_lshl_add_u32 v2, v3, 4, v2
    v_bfe_u32 v3, v0, 3, 2
    s_mov_b32 s7, 9216
    v_mul_lo_u32 v9, v3, s7
    v_lshrrev_b32 v3, 5, v0
    v_lshl_add_u32 v9, v3, 7, v9
    v_and_b32 v3, 7, v0
    v_lshl_add_u32 v9, v3, 4, v9
    s_mul_i32 s22, s41, 73728
    s_add_u32 s22, s22, s43
    s_add_u32 s23, s22, 38797312
    s_mul_i32 s7, s3, 18432
    s_add_u32 s24, s23, s7
    s_cmp_eq_u32 s41, 0
    s_cselect_b32 s7, 0, 18432
    s_sub_u32 s23, s23, s7
    s_lshl_b32 s25, s3, 10
    s_add_u32 s25, s25, 1024
    s_mul_i32 s26, s3, 5120
    s_lshl_b32 s7, s3, 9
    s_add_u32 s27, s23, s7
    s_and_b32 s7, s3, 1
    s_add_u32 s7, s7, 4
    s_mul_i32 s29, s7, 5120
    s_lshl_b32 s7, s7, 9
    s_add_u32 s23, s23, s7
    s_cmp_lg_u32 s3, 3
    s_cbranch_scc1 L_pollout_14
    s_lshl_b32 s7, s40, 7
    s_add_u32 s7, s7, s44
    s_sub_u32 s7, s7, 32768
    s_add_u32 s52, s4, s7
    s_addc_u32 s53, s5, 0
    s_cmp_eq_u32 s41, 0
    s_cselect_b32 s7, 0, 32
    s_mov_b32 s6, 0
L_poll_12:
    s_load_dwordx8 s[56:63], s[52:53], 0 glc
    s_load_dwordx2 s[54:55], s[52:53], s7 glc
    s_add_u32 s6, s6, 1
    s_waitcnt lgkmcnt(0)
    s_xor_b64 s[54:55], s[54:55], s[76:77]
    s_xor_b64 s[56:57], s[56:57], s[76:77]
    s_xor_b64 s[58:59], s[58:59], s[76:77]
    s_xor_b64 s[60:61], s[60:61], s[76:77]
    s_xor_b64 s[62:63], s[62:63], s[76:77]
    s_or_b64 s[56:57], s[56:57], s[58:59]
    s_or_b64 s[60:61], s[60:61], s[62:63]
    s_or_b64 s[56:57], s[56:57], s[54:55]
    s_or_b64 s[56:57], s[56:57], s[60:61]
    s_cbranch_scc0 L_polled_13
    s_cmp_lt_u32 s6, 1048576
    s_cbranch_scc1 L_poll_12
    s_branch L_main_end
L_polled_13:
L_pollout_14:
    s_barrier
    s_add_u32 m0, s25, 0
    s_nop 0
    buffer_load_dwordx4 v2, s[8:11], s24 offen offset:0 sc1 lds
    s_add_u32 m0, s25, 4608
    s_nop 0
    buffer_load_dwordx4 v2, s[8:11], s24 offen offset:512 sc1 lds
    s_add_u32 m0, s25, 9216
    s_nop 0
    buffer_load_dwordx4 v2, s[8:11], s24 offen offset:1024 sc1 lds
    s_add_u32 m0, s25, 13824
    s_nop 0
    buffer_load_dwordx4 v2, s[8:11], s24 offen offset:1536 sc1 lds
    s_add_u32 m0, s25, 18432
    s_nop 0
    buffer_load_dwordx4 v2, s[8:11], s24 offen offset:2048 sc1 lds
    s_add_u32 m0, s25, 23040
    s_nop 0
    buffer_load_dwordx4 v2, s[8:11], s24 offen offset:2560 sc1 lds
    s_add_u32 m0, s26, 0
    s_add_u32 s7, s27, 0
    buffer_load_dwordx4 v2, s[8:11], s7 offen sc1 lds
    s_add_u32 m0, s29, 0
    s_add_u32 s7, s23, 0
    buffer_load_dwordx4 v2, s[8:11], s7 offen sc1 lds
    v_mov_b32 v132, 0
    v_mov_b32 v133, 0
    v_mov_b32 v192, 0
    v_mov_b32 v193, 0
    v_mov_b32 v195, 0
    v_mov_b32 v135, 0
    v_mov_b32 v139, 0
    v_mov_b32 v143, 0
    v_mov_b32 v147, 0
    v_mov_b32 v151, 0
    v_mov_b32 v155, 0
    v_mov_b32 v159, 0
    v_mov_b32 v163, 0
    v_mov_b32 v167, 0
    v_mov_b32 v171, 0
    v_cmp_eq_u32 vcc, 16, v0
    v_mov_b32 v10, 0x3f80
    v_cmp_eq_u32 s[20:21], 17, v0
    v_cndmask_b32 v194, 0, v10, vcc
    v_and_b32 v11, 3, v0
    v_cndmask_b32 v194, v194, 1.0, s[20:21]
    v_cmp_eq_u32 vcc, 2, v11
    v_and_b32 v10, 15, v0
    v_lshrrev_b32 v11, 4, v0
    v_cndmask_b32 v196, 0, 1.0, vcc
    v_cndmask_b32 v197, 0, 1.0, vcc
    v_cndmask_b32 v198, 0, 1.0, vcc
    v_cndmask_b32 v199, 0, 1.0, vcc
    v_lshlrev_b32 v11, 2, v11
    v_sub_u32 v10, v11, v10
    v_mov_b32 v12, 0xf149f2ca
    s_cmp_eq_u32 s41, 0
    s_cselect_b64 s[38:39], 0, -1
    v_add_u32 v11, 0, v10
    v_and_b32 v13, 1, v11
    v_cmp_eq_u32 s[20:21], 0, v13
    v_cmp_lt_i32 vcc, 1, v11
    v_cmp_gt_i32 s[18:19], 1, v11
    s_and_b64 vcc, vcc, s[20:21]
    s_and_b64 s[18:19], s[18:19], s[20:21]
    s_and_b64 s[20:21], vcc, s[38:39]
    v_cndmask_b32 v200, v12, 0, vcc
    v_cndmask_b32 v204, v12, 0, s[18:19]
    v_cndmask_b32 v208, v12, 0, s[20:21]
    v_add_u32 v11, 1, v10
    v_and_b32 v13, 1, v11
    v_cmp_eq_u32 s[20:21], 0, v13
    v_cmp_lt_i32 vcc, 1, v11
    v_cmp_gt_i32 s[18:19], 1, v11
    s_and_b64 vcc, vcc, s[20:21]
    s_and_b64 s[18:19], s[18:19], s[20:21]
    s_and_b64 s[20:21], vcc, s[38:39]
    v_cndmask_b32 v201, v12, 0, vcc
    v_cndmask_b32 v205, v12, 0, s[18:19]
    v_cndmask_b32 v209, v12, 0, s[20:21]
    v_add_u32 v11, 2, v10
    v_and_b32 v13, 1, v11
    v_cmp_eq_u32 s[20:21], 0, v13
    v_cmp_lt_i32 vcc, 1, v11
    v_cmp_gt_i32 s[18:19], 1, v11
    s_and_b64 vcc, vcc, s[20:21]
    s_and_b64 s[18:19], s[18:19], s[20:21]
    s_and_b64 s[20:21], vcc, s[38:39]
    v_cndmask_b32 v202, v12, 0, vcc
    v_cndmask_b32 v206, v12, 0, s[18:19]
    v_cndmask_b32 v210, v12, 0, s[20:21]
    v_add_u32 v11, 3, v10
    v_and_b32 v13, 1, v11
    v_cmp_eq_u32 s[20:21], 0, v13
    v_cmp_lt_i32 vcc, 1, v11
    v_cmp_gt_i32 s[18:19], 1, v11
    s_and_b64 vcc, vcc, s[20:21]
    s_and_b64 s[18:19], s[18:19], s[20:21]
    s_and_b64 s[20:21], vcc, s[38:39]
    v_cndmask_b32 v203, v12, 0, vcc
    v_cndmask_b32 v207, v12, 0, s[18:19]
    v_cndmask_b32 v211, v12, 0, s[20:21]
    s_lshl_b32 s45, s41, 1
    s_lshr_b32 s7, s40, 2
    s_add_u32 s45, s45, s7
    s_mul_i32 s30, s45, 36864
    s_add_u32 s30, s30, s43
    s_and_b32 s31, s40, 3
    s_mul_i32 s31, s31, 9
    s_add_u32 s31, s31, s3
    s_mul_i32 s32, s31, 18432
    s_add_u32 s32, s32, 2359296
    s_add_u32 s33, s32, 73728
    s_add_u32 s34, s32, 147456
    s_mov_b32 s39, 19496960
    v_min_u32 v228, 44, v0
    v_lshlrev_b32 v228, 3, v228
    s_cmp_eq_u32 s3, 1
    s_cmov_b32 s34, 3022848
    s_cmp_lt_u32 s3, 2
    s_cselect_b32 s35, 0, 1073741824
    v_add_u32 v5, s35, v253
    s_cmp_eq_u32 s3, 0
    s_cselect_b32 s35, 0, 1073741824
    v_add_u32 v7, s35, v9
    s_lshl_b32 s7, s31, 8
    s_add_u32 s36, s30, s7
    s_add_u32 s37, s36, 43515904
    s_add_u32 s46, s36, 45875200
    s_lshl_b32 s36, s45, 7
    s_add_u32 s36, s36, s43
    s_add_u32 s36, s36, 48431104
    s_lshl_b32 s47, s45, 9
    s_add_u32 s47, s47, s43
    s_add_u32 s47, s47, 48234496
    v_bfe_u32 v10, v0, 3, 2
    v_and_b32 v8, 7, v0
    v_lshlrev_b32 v8, 2, v8
    v_lshl_add_u32 v8, v10, 7, v8
    v_add_u32 v6, 46080, v253
    s_waitcnt vmcnt(0)
    s_barrier
    ds_read_b128 v[16:19], v253 offset:0
    ds_read_b128 v[20:23], v253 offset:1024
    ds_read_b128 v[24:27], v253 offset:2048
    ds_read_b128 v[28:31], v253 offset:3072
    ds_read_b128 v[32:35], v253 offset:4096
    s_waitcnt lgkmcnt(0)
    v_mfma_f32_16x16x32_bf16 v[56:59], a[0:3], v[20:23], 0
    ds_read_b128 v[36:39], v253 offset:5120
    v_mfma_f32_16x16x32_bf16 v[60:63], a[0:3], v[24:27], 0
    ds_read_b128 v[40:43], v253 offset:6144
    v_mfma_f32_16x16x32_bf16 v[64:67], a[0:3], v[28:31], 0
    ds_read_b128 v[44:47], v253 offset:7168
    v_mfma_f32_16x16x32_bf16 v[68:71], a[0:3], v[32:35], 0
    ds_read_b128 v[48:51], v253 offset:8192
    v_mfma_f32_16x16x32_bf16 v[72:75], a[4:7], v[16:19], 0
    ds_read_b128 v[52:55], v253 offset:9216
    v_mfma_f32_16x16x32_bf16 v[76:79], a[4:7], v[20:23], 0
    s_add_u32 m0, s25, 27648
    s_nop 0
    buffer_load_dwordx4 v2, s[8:11], s24 offen offset:3072 sc1 lds
    v_mfma_f32_16x16x32_bf16 v[80:83], a[4:7], v[24:27], 0
    v_mfma_f32_16x16x32_bf16 v[84:87], a[4:7], v[28:31], 0
    s_add_u32 m0, s25, 32256
    s_nop 0
    buffer_load_dwordx4 v2, s[8:11], s24 offen offset:3584 sc1 lds
    v_mfma_f32_16x16x32_bf16 v[88:91], a[4:7], v[32:35], 0
    v_mfma_f32_16x16x32_bf16 v[92:95], v[16:19], a[8:11], 0
    buffer_load_dwordx4 a[144:147], v253, s[8:11], s28 offen offset:0 sc1
    v_mfma_f32_16x16x32_bf16 v[96:99], v[20:23], a[8:11], 0
    v_mfma_f32_16x16x32_bf16 v[100:103], v[24:27], a[8:11], 0
    buffer_load_dwordx4 a[148:151], v253, s[8:11], s28 offen offset:1024 sc1
    v_mfma_f32_16x16x32_bf16 v[104:107], v[28:31], a[8:11], 0
    v_mfma_f32_16x16x32_bf16 v[108:111], v[32:35], a[8:11], 0
    buffer_load_dwordx4 a[152:155], v253, s[8:11], s28 offen offset:2048 sc1
    v_mfma_f32_16x16x32_bf16 v[112:115], a[12:15], v[16:19], 0
    v_mfma_f32_16x16x32_bf16 v[116:119], a[12:15], v[20:23], 0
    v_mfma_f32_16x16x32_bf16 v[120:123], a[12:15], v[24:27], 0
    v_mfma_f32_16x16x32_bf16 v[124:127], a[12:15], v[28:31], 0
    v_mfma_f32_16x16x32_bf16 v[128:131], a[12:15], v[32:35], 0
    s_waitcnt lgkmcnt(0)
    v_mfma_f32_16x16x32_bf16 v[56:59], a[16:19], v[40:43], v[56:59]
    ds_read_b128 v[16:19], v253 offset:10240
    v_mfma_f32_16x16x32_bf16 v[60:63], a[16:19], v[44:47], v[60:63]
    ds_read_b128 v[20:23], v253 offset:11264
    v_mfma_f32_16x16x32_bf16 v[64:67], a[16:19], v[48:51], v[64:67]
    ds_read_b128 v[24:27], v253 offset:12288
    v_mfma_f32_16x16x32_bf16 v[68:71], a[16:19], v[52:55], v[68:71]
    ds_read_b128 v[28:31], v253 offset:13312
    v_mfma_f32_16x16x32_bf16 v[72:75], a[20:23], v[36:39], v[72:75]
    ds_read_b128 v[32:35], v253 offset:14336
    v_mfma_f32_16x16x32_bf16 v[76:79], a[20:23], v[40:43], v[76:79]
    s_add_u32 m0, s25, 40960
    s_add_u32 s24, s24, 4096
    buffer_load_dwordx4 v2, s[8:11], s24 offen offset:0 sc1 lds
    v_mfma_f32_16x16x32_bf16 v[80:83], a[20:23], v[44:47], v[80:83]
    v_mfma_f32_16x16x32_bf16 v[84:87], a[20:23], v[48:51], v[84:87]
    s_add_u32 m0, s25, 45568
    s_nop 0
    buffer_load_dwordx4 v2, s[8:11], s24 offen offset:512 sc1 lds
    v_mfma_f32_16x16x32_bf16 v[88:91], a[20:23], v[52:55], v[88:91]
    v_mfma_f32_16x16x32_bf16 v[92:95], v[36:39], a[24:27], v[92:95]
    buffer_load_dwordx4 a[156:159], v253, s[8:11], s28 offen offset:3072 sc1
    s_add_u32 s28, s28, 4096
    v_mfma_f32_16x16x32_bf16 v[96:99], v[40:43], a[24:27], v[96:99]
    v_mfma_f32_16x16x32_bf16 v[100:103], v[44:47], a[24:27], v[100:103]
    buffer_load_dwordx4 a[0:3], v253, s[8:11], s28 offen offset:0 sc1
    v_mfma_f32_16x16x32_bf16 v[104:107], v[48:51], a[24:27], v[104:107]
    v_mfma_f32_16x16x32_bf16 v[108:111], v[52:55], a[24:27], v[108:111]
    buffer_load_dwordx4 a[4:7], v253, s[8:11], s28 offen offset:1024 sc1
    v_mfma_f32_16x16x32_bf16 v[112:115], a[28:31], v[36:39], v[112:115]
    v_mfma_f32_16x16x32_bf16 v[116:119], a[28:31], v[40:43], v[116:119]
    v_mfma_f32_16x16x32_bf16 v[120:123], a[28:31], v[44:47], v[120:123]
    v_mfma_f32_16x16x32_bf16 v[124:127], a[28:31], v[48:51], v[124:127]
    v_mfma_f32_16x16x32_bf16 v[128:131], a[28:31], v[52:55], v[128:131]
    s_waitcnt lgkmcnt(0)
    v_mfma_f32_16x16x32_bf16 v[56:59], a[32:35], v[20:23], v[56:59]
    ds_read_b128 v[36:39], v253 offset:15360
    v_mfma_f32_16x16x32_bf16 v[60:63], a[32:35], v[24:27], v[60:63]
    ds_read_b128 v[40:43], v253 offset:16384
    v_mfma_f32_16x16x32_bf16 v[64:67], a[32:35], v[28:31], v[64:67]
    ds_read_b128 v[44:47], v253 offset:17408
    v_mfma_f32_16x16x32_bf16 v[68:71], a[32:35], v[32:35], v[68:71]
    ds_read_b128 v[48:51], v253 offset:18432
    v_mfma_f32_16x16x32_bf16 v[72:75], a[36:39], v[16:19], v[72:75]
    ds_read_b128 v[52:55], v253 offset:19456
    v_mfma_f32_16x16x32_bf16 v[76:79], a[36:39], v[20:23], v[76:79]
    s_add_u32 m0, s25, 50176
    s_nop 0
    buffer_load_dwordx4 v2, s[8:11], s24 offen offset:1024 sc1 lds
    v_mfma_f32_16x16x32_bf16 v[80:83], a[36:39], v[24:27], v[80:83]
    v_mfma_f32_16x16x32_bf16 v[84:87], a[36:39], v[28:31], v[84:87]
    s_add_u32 m0, s25, 54784
    s_nop 0
    buffer_load_dwordx4 v2, s[8:11], s24 offen offset:1536 sc1 lds
    v_mfma_f32_16x16x32_bf16 v[88:91], a[36:39], v[32:35], v[88:91]
    v_mfma_f32_16x16x32_bf16 v[92:95], v[16:19], a[40:43], v[92:95]
    buffer_load_dwordx4 a[8:11], v253, s[8:11], s28 offen offset:2048 sc1
    v_mfma_f32_16x16x32_bf16 v[96:99], v[20:23], a[40:43], v[96:99]
    v_mfma_f32_16x16x32_bf16 v[100:103], v[24:27], a[40:43], v[100:103]
    buffer_load_dwordx4 a[12:15], v253, s[8:11], s28 offen offset:3072 sc1
    s_add_u32 s28, s28, 4096
    v_mfma_f32_16x16x32_bf16 v[104:107], v[28:31], a[40:43], v[104:107]
    v_mfma_f32_16x16x32_bf16 v[108:111], v[32:35], a[40:43], v[108:111]
    buffer_load_dwordx4 a[16:19], v253, s[8:11], s28 offen offset:0 sc1
    v_mfma_f32_16x16x32_bf16 v[112:115], a[44:47], v[16:19], v[112:115]
    v_mfma_f32_16x16x32_bf16 v[116:119], a[44:47], v[20:23], v[116:119]
    v_mfma_f32_16x16x32_bf16 v[120:123], a[44:47], v[24:27], v[120:123]
    v_mfma_f32_16x16x32_bf16 v[124:127], a[44:47], v[28:31], v[124:127]
    v_mfma_f32_16x16x32_bf16 v[128:131], a[44:47], v[32:35], v[128:131]
    s_waitcnt lgkmcnt(0)
    v_mfma_f32_16x16x32_bf16 v[56:59], a[48:51], v[40:43], v[56:59]
    ds_read_b128 v[16:19], v253 offset:20480
    v_mfma_f32_16x16x32_bf16 v[60:63], a[48:51], v[44:47], v[60:63]
    ds_read_b128 v[20:23], v253 offset:21504
    v_mfma_f32_16x16x32_bf16 v[64:67], a[48:51], v[48:51], v[64:67]
    ds_read_b128 v[24:27], v253 offset:22528
    v_mfma_f32_16x16x32_bf16 v[68:71], a[48:51], v[52:55], v[68:71]
    ds_read_b128 v[28:31], v253 offset:23552
    v_mfma_f32_16x16x32_bf16 v[72:75], a[52:55], v[36:39], v[72:75]
    ds_read_b128 v[32:35], v253 offset:24576
    v_mfma_f32_16x16x32_bf16 v[76:79], a[52:55], v[40:43], v[76:79]
    s_add_u32 m0, s26, 30720
    s_add_u32 s7, s27, 3072
    buffer_load_dwordx4 v2, s[8:11], s7 offen sc1 lds
    v_mfma_f32_16x16x32_bf16 v[80:83], a[52:55], v[44:47], v[80:83]
    v_mfma_f32_16x16x32_bf16 v[84:87], a[52:55], v[48:51], v[84:87]
    s_add_u32 m0, s29, 30720
    s_add_u32 s7, s23, 3072
    buffer_load_dwordx4 v2, s[8:11], s7 offen sc1 lds
    v_mfma_f32_16x16x32_bf16 v[88:91], a[52:55], v[52:55], v[88:91]
    v_mfma_f32_16x16x32_bf16 v[92:95], v[36:39], a[56:59], v[92:95]
    buffer_load_dwordx4 a[20:23], v253, s[8:11], s28 offen offset:1024 sc1
    v_mfma_f32_16x16x32_bf16 v[96:99], v[40:43], a[56:59], v[96:99]
    v_mfma_f32_16x16x32_bf16 v[100:103], v[44:47], a[56:59], v[100:103]
    buffer_load_dwordx4 a[24:27], v253, s[8:11], s28 offen offset:2048 sc1
    v_mfma_f32_16x16x32_bf16 v[104:107], v[48:51], a[56:59], v[104:107]
    v_mfma_f32_16x16x32_bf16 v[108:111], v[52:55], a[56:59], v[108:111]
    buffer_load_dwordx4 a[28:31], v253, s[8:11], s28 offen offset:3072 sc1
    s_add_u32 s28, s28, 4096
    v_mfma_f32_16x16x32_bf16 v[112:115], a[60:63], v[36:39], v[112:115]
    v_mfma_f32_16x16x32_bf16 v[116:119], a[60:63], v[40:43], v[116:119]
    v_mfma_f32_16x16x32_bf16 v[120:123], a[60:63], v[44:47], v[120:123]
    v_mfma_f32_16x16x32_bf16 v[124:127], a[60:63], v[48:51], v[124:127]
    v_mfma_f32_16x16x32_bf16 v[128:131], a[60:63], v[52:55], v[128:131]
    s_waitcnt lgkmcnt(0)
    v_mfma_f32_16x16x32_bf16 v[56:59], a[64:67], v[20:23], v[56:59]
    ds_read_b128 v[36:39], v253 offset:25600
    v_mfma_f32_16x16x32_bf16 v[60:63], a[64:67], v[24:27], v[60:63]
    ds_read_b128 v[40:43], v253 offset:26624
    v_mfma_f32_16x16x32_bf16 v[64:67], a[64:67], v[28:31], v[64:67]
    ds_read_b128 v[44:47], v253 offset:27648
    v_mfma_f32_16x16x32_bf16 v[68:71], a[64:67], v[32:35], v[68:71]
    ds_read_b128 v[48:51], v253 offset:28672
    v_mfma_f32_16x16x32_bf16 v[72:75], a[68:71], v[16:19], v[72:75]
    ds_read_b128 v[52:55], v253 offset:29696
    v_mfma_f32_16x16x32_bf16 v[76:79], a[68:71], v[20:23], v[76:79]
    buffer_load_dwordx4 a[32:35], v253, s[8:11], s28 offen offset:0 sc1
    v_mfma_f32_16x16x32_bf16 v[80:83], a[68:71], v[24:27], v[80:83]
    v_mfma_f32_16x16x32_bf16 v[84:87], a[68:71], v[28:31], v[84:87]
    buffer_load_dwordx4 a[36:39], v253, s[8:11], s28 offen offset:1024 sc1
    v_mfma_f32_16x16x32_bf16 v[88:91], a[68:71], v[32:35], v[88:91]
    v_mfma_f32_16x16x32_bf16 v[92:95], v[16:19], a[72:75], v[92:95]
    buffer_load_dwordx4 a[40:43], v253, s[8:11], s28 offen offset:2048 sc1
    v_mfma_f32_16x16x32_bf16 v[96:99], v[20:23], a[72:75], v[96:99]
    v_mfma_f32_16x16x32_bf16 v[100:103], v[24:27], a[72:75], v[100:103]
    buffer_load_dwordx2 v[226:227], v228, s[8:11], s39 offen sc1
    v_mfma_f32_16x16x32_bf16 v[104:107], v[28:31], a[72:75], v[104:107]
    v_mfma_f32_16x16x32_bf16 v[108:111], v[32:35], a[72:75], v[108:111]
    v_mfma_f32_16x16x32_bf16 v[112:115], a[76:79], v[16:19], v[112:115]
    v_mfma_f32_16x16x32_bf16 v[116:119], a[76:79], v[20:23], v[116:119]
    v_mfma_f32_16x16x32_bf16 v[120:123], a[76:79], v[24:27], v[120:123]
    v_mfma_f32_16x16x32_bf16 v[124:127], a[76:79], v[28:31], v[124:127]
    v_mfma_f32_16x16x32_bf16 v[128:131], a[76:79], v[32:35], v[128:131]
    s_waitcnt vmcnt(7) lgkmcnt(0)
    s_barrier
    v_mfma_f32_16x16x32_bf16 v[56:59], a[80:83], v[40:43], v[56:59]
    ds_read_b128 v[16:19], v253 offset:30720
    v_mfma_f32_16x16x32_bf16 v[60:63], a[80:83], v[44:47], v[60:63]
    ds_read_b128 v[20:23], v253 offset:31744
    v_mfma_f32_16x16x32_bf16 v[64:67], a[80:83], v[48:51], v[64:67]
    ds_read_b128 v[24:27], v253 offset:32768
    v_mfma_f32_16x16x32_bf16 v[68:71], a[80:83], v[52:55], v[68:71]
    ds_read_b128 v[28:31], v253 offset:33792
    v_mfma_f32_16x16x32_bf16 v[72:75], a[84:87], v[36:39], v[72:75]
    ds_read_b128 v[32:35], v253 offset:34816
    v_mfma_f32_16x16x32_bf16 v[76:79], a[84:87], v[40:43], v[76:79]
    s_add_u32 m0, s25, 59392
    s_nop 0
    buffer_load_dwordx4 v2, s[8:11], s24 offen offset:2048 sc1 lds
    v_mfma_f32_16x16x32_bf16 v[80:83], a[84:87], v[44:47], v[80:83]
    v_mfma_f32_16x16x32_bf16 v[84:87], a[84:87], v[48:51], v[84:87]
    s_add_u32 m0, s25, 64000
    s_nop 0
    buffer_load_dwordx4 v2, s[8:11], s24 offen offset:2560 sc1 lds
    v_mfma_f32_16x16x32_bf16 v[88:91], a[84:87], v[52:55], v[88:91]
    v_mfma_f32_16x16x32_bf16 v[92:95], v[36:39], a[88:91], v[92:95]
    buffer_load_dwordx4 a[44:47], v253, s[8:11], s28 offen offset:3072 sc1
    s_add_u32 s28, s28, 4096
    v_mfma_f32_16x16x32_bf16 v[96:99], v[40:43], a[88:91], v[96:99]
    v_mfma_f32_16x16x32_bf16 v[100:103], v[44:47], a[88:91], v[100:103]
    buffer_load_dwordx4 a[48:51], v253, s[8:11], s28 offen offset:0 sc1
    v_mfma_f32_16x16x32_bf16 v[104:107], v[48:51], a[88:91], v[104:107]
    v_mfma_f32_16x16x32_bf16 v[108:111], v[52:55], a[88:91], v[108:111]
    buffer_load_dwordx4 a[52:55], v253, s[8:11], s28 offen offset:1024 sc1
    v_mfma_f32_16x16x32_bf16 v[112:115], a[92:95], v[36:39], v[112:115]
    v_mfma_f32_16x16x32_bf16 v[116:119], a[92:95], v[40:43], v[116:119]
    v_mfma_f32_16x16x32_bf16 v[120:123], a[92:95], v[44:47], v[120:123]
    v_mfma_f32_16x16x32_bf16 v[124:127], a[92:95], v[48:51], v[124:127]
    v_mfma_f32_16x16x32_bf16 v[128:131], a[92:95], v[52:55], v[128:131]
    s_waitcnt lgkmcnt(0)
    v_mfma_f32_16x16x32_bf16 v[56:59], a[96:99], v[20:23], v[56:59]
    ds_read_b128 v[36:39], v253 offset:35840
    v_mfma_f32_16x16x32_bf16 v[60:63], a[96:99], v[24:27], v[60:63]
    ds_read_b128 v[40:43], v253 offset:36864
    v_mfma_f32_16x16x32_bf16 v[64:67], a[96:99], v[28:31], v[64:67]
    ds_read_b128 v[44:47], v253 offset:37888
    v_mfma_f32_16x16x32_bf16 v[68:71], a[96:99], v[32:35], v[68:71]
    ds_read_b128 v[48:51], v253 offset:38912
    v_mfma_f32_16x16x32_bf16 v[72:75], a[100:103], v[16:19], v[72:75]
    ds_read_b128 v[52:55], v253 offset:39936
    v_mfma_f32_16x16x32_bf16 v[76:79], a[100:103], v[20:23], v[76:79]
    s_add_u32 m0, s25, 68608
    s_nop 0
    buffer_load_dwordx4 v2, s[8:11], s24 offen offset:3072 sc1 lds
    v_mfma_f32_16x16x32_bf16 v[80:83], a[100:103], v[24:27], v[80:83]
    v_mfma_f32_16x16x32_bf16 v[84:87], a[100:103], v[28:31], v[84:87]
    s_add_u32 m0, s25, 73216
    s_nop 0
    buffer_load_dwordx4 v2, s[8:11], s24 offen offset:3584 sc1 lds
    v_mfma_f32_16x16x32_bf16 v[88:91], a[100:103], v[32:35], v[88:91]
    v_mfma_f32_16x16x32_bf16 v[92:95], v[16:19], a[104:107], v[92:95]
    buffer_load_dwordx4 a[56:59], v253, s[8:11], s28 offen offset:2048 sc1
    v_mfma_f32_16x16x32_bf16 v[96:99], v[20:23], a[104:107], v[96:99]
    v_mfma_f32_16x16x32_bf16 v[100:103], v[24:27], a[104:107], v[100:103]
    buffer_load_dwordx4 a[60:63], v253, s[8:11], s28 offen offset:3072 sc1
    s_add_u32 s28, s28, 4096
    v_mfma_f32_16x16x32_bf16 v[104:107], v[28:31], a[104:107], v[104:107]
    v_mfma_f32_16x16x32_bf16 v[108:111], v[32:35], a[104:107], v[108:111]
    buffer_load_dwordx4 a[64:67], v253, s[8:11], s28 offen offset:0 sc1
    v_mfma_f32_16x16x32_bf16 v[112:115], a[108:111], v[16:19], v[112:115]
    v_mfma_f32_16x16x32_bf16 v[116:119], a[108:111], v[20:23], v[116:119]
    v_mfma_f32_16x16x32_bf16 v[120:123], a[108:111], v[24:27], v[120:123]
    v_mfma_f32_16x16x32_bf16 v[124:127], a[108:111], v[28:31], v[124:127]
    v_mfma_f32_16x16x32_bf16 v[128:131], a[108:111], v[32:35], v[128:131]
    s_waitcnt lgkmcnt(0)
    v_mfma_f32_16x16x32_bf16 v[56:59], a[112:115], v[40:43], v[56:59]
    ds_read_b128 v[16:19], v253 offset:40960
    v_mfma_f32_16x16x32_bf16 v[60:63], a[112:115], v[44:47], v[60:63]
    ds_read_b128 v[20:23], v253 offset:41984
    v_mfma_f32_16x16x32_bf16 v[64:67], a[112:115], v[48:51], v[64:67]
    ds_read_b128 v[24:27], v253 offset:43008
    v_mfma_f32_16x16x32_bf16 v[68:71], a[112:115], v[52:55], v[68:71]
    ds_read_b128 v[28:31], v253 offset:44032
    v_mfma_f32_16x16x32_bf16 v[72:75], a[116:119], v[36:39], v[72:75]
    ds_read_b128 v[32:35], v253 offset:45056
    v_mfma_f32_16x16x32_bf16 v[76:79], a[116:119], v[40:43], v[76:79]
    s_add_u32 m0, s25, 81920
    s_add_u32 s24, s24, 4096
    buffer_load_dwordx4 v2, s[8:11], s24 offen offset:0 sc1 lds
    v_mfma_f32_16x16x32_bf16 v[80:83], a[116:119], v[44:47], v[80:83]
    v_mfma_f32_16x16x32_bf16 v[84:87], a[116:119], v[48:51], v[84:87]
    s_add_u32 m0, s25, 86528
    s_nop 0
    buffer_load_dwordx4 v2, s[8:11], s24 offen offset:512 sc1 lds
    v_mfma_f32_16x16x32_bf16 v[88:91], a[116:119], v[52:55], v[88:91]
    v_mfma_f32_16x16x32_bf16 v[92:95], v[36:39], a[120:123], v[92:95]
    buffer_load_dwordx4 a[68:71], v253, s[8:11], s28 offen offset:1024 sc1
    v_mfma_f32_16x16x32_bf16 v[96:99], v[40:43], a[120:123], v[96:99]
    v_mfma_f32_16x16x32_bf16 v[100:103], v[44:47], a[120:123], v[100:103]
    buffer_load_dwordx4 a[72:75], v253, s[8:11], s28 offen offset:2048 sc1
    v_mfma_f32_16x16x32_bf16 v[104:107], v[48:51], a[120:123], v[104:107]
    v_mfma_f32_16x16x32_bf16 v[108:111], v[52:55], a[120:123], v[108:111]
    buffer_load_dwordx4 a[76:79], v253, s[8:11], s28 offen offset:3072 sc1
    s_add_u32 s28, s28, 4096
    v_mfma_f32_16x16x32_bf16 v[112:115], a[124:127], v[36:39], v[112:115]
    v_mfma_f32_16x16x32_bf16 v[116:119], a[124:127], v[40:43], v[116:119]
    v_mfma_f32_16x16x32_bf16 v[120:123], a[124:127], v[44:47], v[120:123]
    v_mfma_f32_16x16x32_bf16 v[124:127], a[124:127], v[48:51], v[124:127]
    v_mfma_f32_16x16x32_bf16 v[128:131], a[124:127], v[52:55], v[128:131]
    s_waitcnt lgkmcnt(0)
    v_mfma_f32_16x16x32_bf16 v[56:59], a[128:131], v[20:23], v[56:59]
    ds_read_b128 v[36:39], v6 offset:0
    v_mfma_f32_16x16x32_bf16 v[60:63], a[128:131], v[24:27], v[60:63]
    ds_read_b128 v[40:43], v6 offset:1024
    v_mfma_f32_16x16x32_bf16 v[64:67], a[128:131], v[28:31], v[64:67]
    ds_read_b128 v[44:47], v6 offset:2048
    v_mfma_f32_16x16x32_bf16 v[68:71], a[128:131], v[32:35], v[68:71]
    ds_read_b128 v[48:51], v6 offset:3072
    v_mfma_f32_16x16x32_bf16 v[72:75], a[132:135], v[16:19], v[72:75]
    ds_read_b128 v[52:55], v6 offset:4096
    v_mfma_f32_16x16x32_bf16 v[76:79], a[132:135], v[20:23], v[76:79]
    s_add_u32 m0, s26, 61440
    s_add_u32 s7, s27, 6144
    buffer_load_dwordx4 v2, s[8:11], s7 offen sc1 lds
    v_mfma_f32_16x16x32_bf16 v[80:83], a[132:135], v[24:27], v[80:83]
    v_mfma_f32_16x16x32_bf16 v[84:87], a[132:135], v[28:31], v[84:87]
    s_add_u32 m0, s29, 61440
    s_add_u32 s7, s23, 6144
    buffer_load_dwordx4 v2, s[8:11], s7 offen sc1 lds
    v_mfma_f32_16x16x32_bf16 v[88:91], a[132:135], v[32:35], v[88:91]
    v_mfma_f32_16x16x32_bf16 v[92:95], v[16:19], a[136:139], v[92:95]
    buffer_load_dwordx4 a[80:83], v253, s[8:11], s28 offen offset:0 sc1
    v_mfma_f32_16x16x32_bf16 v[96:99], v[20:23], a[136:139], v[96:99]
    v_mfma_f32_16x16x32_bf16 v[100:103], v[24:27], a[136:139], v[100:103]
    buffer_load_dwordx4 a[84:87], v253, s[8:11], s28 offen offset:1024 sc1
    v_mfma_f32_16x16x32_bf16 v[104:107], v[28:31], a[136:139], v[104:107]
    v_mfma_f32_16x16x32_bf16 v[108:111], v[32:35], a[136:139], v[108:111]
    buffer_load_dwordx4 a[88:91], v253, s[8:11], s28 offen offset:2048 sc1
    v_mfma_f32_16x16x32_bf16 v[112:115], a[140:143], v[16:19], v[112:115]
    v_mfma_f32_16x16x32_bf16 v[116:119], a[140:143], v[20:23], v[116:119]
    v_mfma_f32_16x16x32_bf16 v[120:123], a[140:143], v[24:27], v[120:123]
    v_mfma_f32_16x16x32_bf16 v[124:127], a[140:143], v[28:31], v[124:127]
    v_mfma_f32_16x16x32_bf16 v[128:131], a[140:143], v[32:35], v[128:131]
    s_waitcnt vmcnt(20) lgkmcnt(0)
    s_mov_b32 s6, 0
L_wo_poll_15:
    v_cmp_eq_u32 vcc, s76, v226
    v_cmp_eq_u32 s[20:21], s76, v227
    s_and_b64 vcc, vcc, s[20:21]
    s_cmp_eq_u64 vcc, exec
    s_cbranch_scc1 L_wo_ready_16
    buffer_load_dwordx2 v[226:227], v228, s[8:11], s39 offen sc1
    s_add_u32 s6, s6, 1
    s_cmp_lt_u32 s6, 1048576
    s_waitcnt vmcnt(0)
    s_cbranch_scc1 L_wo_poll_15
    s_branch L_main_end
L_wo_ready_16:
    v_mfma_f32_16x16x32_bf16 v[56:59], a[144:147], v[40:43], v[56:59]
    ds_read_b128 v[16:19], v6 offset:5120
    v_mfma_f32_16x16x32_bf16 v[60:63], a[144:147], v[44:47], v[60:63]
    ds_read_b128 v[20:23], v6 offset:6144
    v_mfma_f32_16x16x32_bf16 v[64:67], a[144:147], v[48:51], v[64:67]
    ds_read_b128 v[24:27], v6 offset:7168
    v_mfma_f32_16x16x32_bf16 v[68:71], a[144:147], v[52:55], v[68:71]
    ds_read_b128 v[28:31], v6 offset:8192
    v_mfma_f32_16x16x32_bf16 v[72:75], a[148:151], v[36:39], v[72:75]
    ds_read_b128 v[32:35], v6 offset:9216
    v_mfma_f32_16x16x32_bf16 v[76:79], a[148:151], v[40:43], v[76:79]
    buffer_load_dwordx4 a[92:95], v253, s[8:11], s28 offen offset:3072 sc1
    s_add_u32 s28, s28, 4096
    v_mfma_f32_16x16x32_bf16 v[80:83], a[148:151], v[44:47], v[80:83]
    v_mfma_f32_16x16x32_bf16 v[84:87], a[148:151], v[48:51], v[84:87]
    buffer_load_dwordx4 a[96:99], v253, s[8:11], s28 offen offset:0 sc1
    v_mfma_f32_16x16x32_bf16 v[88:91], a[148:151], v[52:55], v[88:91]
    v_mfma_f32_16x16x32_bf16 v[92:95], v[36:39], a[152:155], v[92:95]
    buffer_load_dwordx4 a[100:103], v253, s[8:11], s28 offen offset:1024 sc1
    v_mfma_f32_16x16x32_bf16 v[96:99], v[40:43], a[152:155], v[96:99]
    v_mfma_f32_16x16x32_bf16 v[100:103], v[44:47], a[152:155], v[100:103]
    buffer_load_dwordx4 a[160:163], v253, s[8:11], s32 offen offset:0 sc1
    v_mfma_f32_16x16x32_bf16 v[104:107], v[48:51], a[152:155], v[104:107]
    v_mfma_f32_16x16x32_bf16 v[108:111], v[52:55], a[152:155], v[108:111]
    v_mfma_f32_16x16x32_bf16 v[112:115], a[156:159], v[36:39], v[112:115]
    v_mfma_f32_16x16x32_bf16 v[116:119], a[156:159], v[40:43], v[116:119]
    v_mfma_f32_16x16x32_bf16 v[120:123], a[156:159], v[44:47], v[120:123]
    v_mfma_f32_16x16x32_bf16 v[124:127], a[156:159], v[48:51], v[124:127]
    v_mfma_f32_16x16x32_bf16 v[128:131], a[156:159], v[52:55], v[128:131]
    s_waitcnt vmcnt(34) lgkmcnt(0)
    v_mfma_f32_16x16x32_bf16 v[56:59], a[0:3], v[20:23], v[56:59]
    ds_read_b128 v[36:39], v6 offset:10240
    v_mfma_f32_16x16x32_bf16 v[60:63], a[0:3], v[24:27], v[60:63]
    ds_read_b128 v[40:43], v6 offset:11264
    v_mfma_f32_16x16x32_bf16 v[64:67], a[0:3], v[28:31], v[64:67]
    ds_read_b128 v[44:47], v6 offset:12288
    v_mfma_f32_16x16x32_bf16 v[68:71], a[0:3], v[32:35], v[68:71]
    ds_read_b128 v[48:51], v6 offset:13312
    v_mfma_f32_16x16x32_bf16 v[72:75], a[4:7], v[16:19], v[72:75]
    ds_read_b128 v[52:55], v6 offset:14336
    v_mfma_f32_16x16x32_bf16 v[76:79], a[4:7], v[20:23], v[76:79]
    buffer_load_dwordx4 a[104:107], v253, s[8:11], s28 offen offset:2048 sc1
    v_mfma_f32_16x16x32_bf16 v[80:83], a[4:7], v[24:27], v[80:83]
    v_mfma_f32_16x16x32_bf16 v[84:87], a[4:7], v[28:31], v[84:87]
    buffer_load_dwordx4 a[108:111], v253, s[8:11], s28 offen offset:3072 sc1
    s_add_u32 s28, s28, 4096
    v_mfma_f32_16x16x32_bf16 v[88:91], a[4:7], v[32:35], v[88:91]
    v_mfma_f32_16x16x32_bf16 v[92:95], v[16:19], a[8:11], v[92:95]
    buffer_load_dwordx4 a[112:115], v253, s[8:11], s28 offen offset:0 sc1
    v_mfma_f32_16x16x32_bf16 v[96:99], v[20:23], a[8:11], v[96:99]
    v_mfma_f32_16x16x32_bf16 v[100:103], v[24:27], a[8:11], v[100:103]
    buffer_load_dwordx4 a[164:167], v253, s[8:11], s33 offen offset:0 sc1
    v_mfma_f32_16x16x32_bf16 v[104:107], v[28:31], a[8:11], v[104:107]
    v_mfma_f32_16x16x32_bf16 v[108:111], v[32:35], a[8:11], v[108:111]
    v_mfma_f32_16x16x32_bf16 v[112:115], a[12:15], v[16:19], v[112:115]
    v_mfma_f32_16x16x32_bf16 v[116:119], a[12:15], v[20:23], v[116:119]
    v_mfma_f32_16x16x32_bf16 v[120:123], a[12:15], v[24:27], v[120:123]
    v_mfma_f32_16x16x32_bf16 v[124:127], a[12:15], v[28:31], v[124:127]
    v_mfma_f32_16x16x32_bf16 v[128:131], a[12:15], v[32:35], v[128:131]
    s_waitcnt vmcnt(11) lgkmcnt(0)
    s_barrier
    v_mfma_f32_16x16x32_bf16 v[56:59], a[16:19], v[40:43], v[56:59]
    ds_read_b128 v[16:19], v6 offset:15360
    v_mfma_f32_16x16x32_bf16 v[60:63], a[16:19], v[44:47], v[60:63]
    ds_read_b128 v[20:23], v6 offset:16384
    v_mfma_f32_16x16x32_bf16 v[64:67], a[16:19], v[48:51], v[64:67]
    ds_read_b128 v[24:27], v6 offset:17408
    v_mfma_f32_16x16x32_bf16 v[68:71], a[16:19], v[52:55], v[68:71]
    ds_read_b128 v[28:31], v6 offset:18432
    v_mfma_f32_16x16x32_bf16 v[72:75], a[20:23], v[36:39], v[72:75]
    ds_read_b128 v[32:35], v6 offset:19456
    v_mfma_f32_16x16x32_bf16 v[76:79], a[20:23], v[40:43], v[76:79]
    buffer_load_dwordx4 a[116:119], v253, s[8:11], s28 offen offset:1024 sc1
    v_mfma_f32_16x16x32_bf16 v[80:83], a[20:23], v[44:47], v[80:83]
    v_mfma_f32_16x16x32_bf16 v[84:87], a[20:23], v[48:51], v[84:87]
    buffer_load_dwordx4 a[120:123], v253, s[8:11], s28 offen offset:2048 sc1
    v_mfma_f32_16x16x32_bf16 v[88:91], a[20:23], v[52:55], v[88:91]
    v_mfma_f32_16x16x32_bf16 v[92:95], v[36:39], a[24:27], v[92:95]
    buffer_load_dwordx4 a[124:127], v253, s[8:11], s28 offen offset:3072 sc1
    s_add_u32 s28, s28, 4096
    v_mfma_f32_16x16x32_bf16 v[96:99], v[40:43], a[24:27], v[96:99]
    v_mfma_f32_16x16x32_bf16 v[100:103], v[44:47], a[24:27], v[100:103]
    buffer_load_dwordx4 a[168:171], v5, s[8:11], s34 offen offset:0 sc1
    v_mfma_f32_16x16x32_bf16 v[104:107], v[48:51], a[24:27], v[104:107]
    v_mfma_f32_16x16x32_bf16 v[108:111], v[52:55], a[24:27], v[108:111]
    v_mfma_f32_16x16x32_bf16 v[112:115], a[28:31], v[36:39], v[112:115]
    v_mfma_f32_16x16x32_bf16 v[116:119], a[28:31], v[40:43], v[116:119]
    v_mfma_f32_16x16x32_bf16 v[120:123], a[28:31], v[44:47], v[120:123]
    v_mfma_f32_16x16x32_bf16 v[124:127], a[28:31], v[48:51], v[124:127]
    v_mfma_f32_16x16x32_bf16 v[128:131], a[28:31], v[52:55], v[128:131]
    s_waitcnt vmcnt(29) lgkmcnt(0)
    v_mfma_f32_16x16x32_bf16 v[56:59], a[32:35], v[20:23], v[56:59]
    ds_read_b128 v[36:39], v6 offset:20480
    v_mfma_f32_16x16x32_bf16 v[60:63], a[32:35], v[24:27], v[60:63]
    ds_read_b128 v[40:43], v6 offset:21504
    v_mfma_f32_16x16x32_bf16 v[64:67], a[32:35], v[28:31], v[64:67]
    ds_read_b128 v[44:47], v6 offset:22528
    v_mfma_f32_16x16x32_bf16 v[68:71], a[32:35], v[32:35], v[68:71]
    ds_read_b128 v[48:51], v6 offset:23552
    v_mfma_f32_16x16x32_bf16 v[72:75], a[36:39], v[16:19], v[72:75]
    ds_read_b128 v[52:55], v6 offset:24576
    v_mfma_f32_16x16x32_bf16 v[76:79], a[36:39], v[20:23], v[76:79]
    buffer_load_dwordx4 a[172:175], v253, s[8:11], s32 offen offset:1024 sc1
    v_mfma_f32_16x16x32_bf16 v[80:83], a[36:39], v[24:27], v[80:83]
    v_mfma_f32_16x16x32_bf16 v[84:87], a[36:39], v[28:31], v[84:87]
    buffer_load_dwordx4 a[176:179], v253, s[8:11], s33 offen offset:1024 sc1
    v_mfma_f32_16x16x32_bf16 v[88:91], a[36:39], v[32:35], v[88:91]
    v_mfma_f32_16x16x32_bf16 v[92:95], v[16:19], a[40:43], v[92:95]
    buffer_load_dwordx4 a[180:183], v5, s[8:11], s34 offen offset:1024 sc1
    v_mfma_f32_16x16x32_bf16 v[96:99], v[20:23], a[40:43], v[96:99]
    v_mfma_f32_16x16x32_bf16 v[100:103], v[24:27], a[40:43], v[100:103]
    buffer_load_dwordx4 a[184:187], v253, s[8:11], s32 offen offset:2048 sc1
    v_mfma_f32_16x16x32_bf16 v[104:107], v[28:31], a[40:43], v[104:107]
    v_mfma_f32_16x16x32_bf16 v[108:111], v[32:35], a[40:43], v[108:111]
    v_mfma_f32_16x16x32_bf16 v[112:115], a[44:47], v[16:19], v[112:115]
    v_mfma_f32_16x16x32_bf16 v[116:119], a[44:47], v[20:23], v[116:119]
    v_mfma_f32_16x16x32_bf16 v[120:123], a[44:47], v[24:27], v[120:123]
    v_mfma_f32_16x16x32_bf16 v[124:127], a[44:47], v[28:31], v[124:127]
    v_mfma_f32_16x16x32_bf16 v[128:131], a[44:47], v[32:35], v[128:131]
    s_waitcnt vmcnt(27) lgkmcnt(0)
    v_mfma_f32_16x16x32_bf16 v[56:59], a[48:51], v[40:43], v[56:59]
    ds_read_b128 v[16:19], v6 offset:25600
    v_mfma_f32_16x16x32_bf16 v[60:63], a[48:51], v[44:47], v[60:63]
    ds_read_b128 v[20:23], v6 offset:26624
    v_mfma_f32_16x16x32_bf16 v[64:67], a[48:51], v[48:51], v[64:67]
    ds_read_b128 v[24:27], v6 offset:27648
    v_mfma_f32_16x16x32_bf16 v[68:71], a[48:51], v[52:55], v[68:71]
    ds_read_b128 v[28:31], v6 offset:28672
    v_mfma_f32_16x16x32_bf16 v[72:75], a[52:55], v[36:39], v[72:75]
    ds_read_b128 v[32:35], v6 offset:29696
    v_mfma_f32_16x16x32_bf16 v[76:79], a[52:55], v[40:43], v[76:79]
    buffer_load_dwordx4 a[188:191], v253, s[8:11], s33 offen offset:2048 sc1
    v_mfma_f32_16x16x32_bf16 v[80:83], a[52:55], v[44:47], v[80:83]
    v_mfma_f32_16x16x32_bf16 v[84:87], a[52:55], v[48:51], v[84:87]
    buffer_load_dwordx4 a[192:195], v5, s[8:11], s34 offen offset:2048 sc1
    v_mfma_f32_16x16x32_bf16 v[88:91], a[52:55], v[52:55], v[88:91]
    v_mfma_f32_16x16x32_bf16 v[92:95], v[36:39], a[56:59], v[92:95]
    buffer_load_dwordx4 a[196:199], v253, s[8:11], s32 offen offset:3072 sc1
    s_add_u32 s32, s32, 4096
    v_mfma_f32_16x16x32_bf16 v[96:99], v[40:43], a[56:59], v[96:99]
    v_mfma_f32_16x16x32_bf16 v[100:103], v[44:47], a[56:59], v[100:103]
    buffer_load_dwordx4 a[200:203], v253, s[8:11], s33 offen offset:3072 sc1
    s_add_u32 s33, s33, 4096
    v_mfma_f32_16x16x32_bf16 v[104:107], v[48:51], a[56:59], v[104:107]
    v_mfma_f32_16x16x32_bf16 v[108:111], v[52:55], a[56:59], v[108:111]
    v_mfma_f32_16x16x32_bf16 v[112:115], a[60:63], v[36:39], v[112:115]
    v_mfma_f32_16x16x32_bf16 v[116:119], a[60:63], v[40:43], v[116:119]
    v_mfma_f32_16x16x32_bf16 v[120:123], a[60:63], v[44:47], v[120:123]
    v_mfma_f32_16x16x32_bf16 v[124:127], a[60:63], v[48:51], v[124:127]
    v_mfma_f32_16x16x32_bf16 v[128:131], a[60:63], v[52:55], v[128:131]
    s_waitcnt vmcnt(25) lgkmcnt(0)
    v_mfma_f32_16x16x32_bf16 v[56:59], a[64:67], v[20:23], v[56:59]
    ds_read_b128 v[36:39], v6 offset:30720
    v_mfma_f32_16x16x32_bf16 v[60:63], a[64:67], v[24:27], v[60:63]
    ds_read_b128 v[40:43], v6 offset:31744
    v_mfma_f32_16x16x32_bf16 v[64:67], a[64:67], v[28:31], v[64:67]
    ds_read_b128 v[44:47], v6 offset:32768
    v_mfma_f32_16x16x32_bf16 v[68:71], a[64:67], v[32:35], v[68:71]
    ds_read_b128 v[48:51], v6 offset:33792
    v_mfma_f32_16x16x32_bf16 v[72:75], a[68:71], v[16:19], v[72:75]
    ds_read_b128 v[52:55], v6 offset:34816
    v_mfma_f32_16x16x32_bf16 v[76:79], a[68:71], v[20:23], v[76:79]
    buffer_load_dwordx4 a[204:207], v5, s[8:11], s34 offen offset:3072 sc1
    s_add_u32 s34, s34, 4096
    v_mfma_f32_16x16x32_bf16 v[80:83], a[68:71], v[24:27], v[80:83]
    v_mfma_f32_16x16x32_bf16 v[84:87], a[68:71], v[28:31], v[84:87]
    buffer_load_dwordx4 a[208:211], v253, s[8:11], s32 offen offset:0 sc1
    v_mfma_f32_16x16x32_bf16 v[88:91], a[68:71], v[32:35], v[88:91]
    v_mfma_f32_16x16x32_bf16 v[92:95], v[16:19], a[72:75], v[92:95]
    buffer_load_dwordx4 a[212:215], v253, s[8:11], s33 offen offset:0 sc1
    v_mfma_f32_16x16x32_bf16 v[96:99], v[20:23], a[72:75], v[96:99]
    v_mfma_f32_16x16x32_bf16 v[100:103], v[24:27], a[72:75], v[100:103]
    buffer_load_dwordx4 a[216:219], v5, s[8:11], s34 offen offset:0 sc1
    v_mfma_f32_16x16x32_bf16 v[104:107], v[28:31], a[72:75], v[104:107]
    v_mfma_f32_16x16x32_bf16 v[108:111], v[32:35], a[72:75], v[108:111]
    v_mfma_f32_16x16x32_bf16 v[112:115], a[76:79], v[16:19], v[112:115]
    v_mfma_f32_16x16x32_bf16 v[116:119], a[76:79], v[20:23], v[116:119]
    v_mfma_f32_16x16x32_bf16 v[120:123], a[76:79], v[24:27], v[120:123]
    v_mfma_f32_16x16x32_bf16 v[124:127], a[76:79], v[28:31], v[124:127]
    v_mfma_f32_16x16x32_bf16 v[128:131], a[76:79], v[32:35], v[128:131]
    s_waitcnt vmcnt(23) lgkmcnt(0)
    v_mfma_f32_16x16x32_bf16 v[56:59], a[80:83], v[40:43], v[56:59]
    ds_read_b128 v[16:19], v6 offset:35840
    v_mfma_f32_16x16x32_bf16 v[60:63], a[80:83], v[44:47], v[60:63]
    ds_read_b128 v[20:23], v6 offset:36864
    v_mfma_f32_16x16x32_bf16 v[64:67], a[80:83], v[48:51], v[64:67]
    ds_read_b128 v[24:27], v6 offset:37888
    v_mfma_f32_16x16x32_bf16 v[68:71], a[80:83], v[52:55], v[68:71]
    ds_read_b128 v[28:31], v6 offset:38912
    v_mfma_f32_16x16x32_bf16 v[72:75], a[84:87], v[36:39], v[72:75]
    ds_read_b128 v[32:35], v6 offset:39936
    v_mfma_f32_16x16x32_bf16 v[76:79], a[84:87], v[40:43], v[76:79]
    buffer_load_dwordx4 a[220:223], v253, s[8:11], s32 offen offset:1024 sc1
    v_mfma_f32_16x16x32_bf16 v[80:83], a[84:87], v[44:47], v[80:83]
    v_mfma_f32_16x16x32_bf16 v[84:87], a[84:87], v[48:51], v[84:87]
    buffer_load_dwordx4 a[224:227], v253, s[8:11], s33 offen offset:1024 sc1
    v_mfma_f32_16x16x32_bf16 v[88:91], a[84:87], v[52:55], v[88:91]
    v_mfma_f32_16x16x32_bf16 v[92:95], v[36:39], a[88:91], v[92:95]
    buffer_load_dwordx4 a[228:231], v5, s[8:11], s34 offen offset:1024 sc1
    v_mfma_f32_16x16x32_bf16 v[96:99], v[40:43], a[88:91], v[96:99]
    v_mfma_f32_16x16x32_bf16 v[100:103], v[44:47], a[88:91], v[100:103]
    buffer_load_dwordx4 a[232:235], v253, s[8:11], s32 offen offset:2048 sc1
    v_mfma_f32_16x16x32_bf16 v[104:107], v[48:51], a[88:91], v[104:107]
    v_mfma_f32_16x16x32_bf16 v[108:111], v[52:55], a[88:91], v[108:111]
    v_mfma_f32_16x16x32_bf16 v[112:115], a[92:95], v[36:39], v[112:115]
    v_mfma_f32_16x16x32_bf16 v[116:119], a[92:95], v[40:43], v[116:119]
    v_mfma_f32_16x16x32_bf16 v[120:123], a[92:95], v[44:47], v[120:123]
    v_mfma_f32_16x16x32_bf16 v[124:127], a[92:95], v[48:51], v[124:127]
    v_mfma_f32_16x16x32_bf16 v[128:131], a[92:95], v[52:55], v[128:131]
    s_waitcnt vmcnt(22) lgkmcnt(0)
    v_mfma_f32_16x16x32_bf16 v[56:59], a[96:99], v[20:23], v[56:59]
    ds_read_b128 v[36:39], v6 offset:40960
    v_mfma_f32_16x16x32_bf16 v[60:63], a[96:99], v[24:27], v[60:63]
    ds_read_b128 v[40:43], v6 offset:41984
    v_mfma_f32_16x16x32_bf16 v[64:67], a[96:99], v[28:31], v[64:67]
    ds_read_b128 v[44:47], v6 offset:43008
    v_mfma_f32_16x16x32_bf16 v[68:71], a[96:99], v[32:35], v[68:71]
    ds_read_b128 v[48:51], v6 offset:44032
    v_mfma_f32_16x16x32_bf16 v[72:75], a[100:103], v[16:19], v[72:75]
    ds_read_b128 v[52:55], v6 offset:45056
    v_mfma_f32_16x16x32_bf16 v[76:79], a[100:103], v[20:23], v[76:79]
    buffer_load_dwordx4 a[236:239], v253, s[8:11], s33 offen offset:2048 sc1
    v_mfma_f32_16x16x32_bf16 v[80:83], a[100:103], v[24:27], v[80:83]
    v_mfma_f32_16x16x32_bf16 v[84:87], a[100:103], v[28:31], v[84:87]
    buffer_load_dwordx4 a[240:243], v5, s[8:11], s34 offen offset:2048 sc1
    v_mfma_f32_16x16x32_bf16 v[88:91], a[100:103], v[32:35], v[88:91]
    v_mfma_f32_16x16x32_bf16 v[92:95], v[16:19], a[104:107], v[92:95]
    buffer_load_dwordx4 a[244:247], v253, s[8:11], s32 offen offset:3072 sc1
    s_add_u32 s32, s32, 4096
    v_mfma_f32_16x16x32_bf16 v[96:99], v[20:23], a[104:107], v[96:99]
    v_mfma_f32_16x16x32_bf16 v[100:103], v[24:27], a[104:107], v[100:103]
    buffer_load_dwordx4 a[248:251], v253, s[8:11], s33 offen offset:3072 sc1
    s_add_u32 s33, s33, 4096
    v_mfma_f32_16x16x32_bf16 v[104:107], v[28:31], a[104:107], v[104:107]
    v_mfma_f32_16x16x32_bf16 v[108:111], v[32:35], a[104:107], v[108:111]
    v_mfma_f32_16x16x32_bf16 v[112:115], a[108:111], v[16:19], v[112:115]
    v_mfma_f32_16x16x32_bf16 v[116:119], a[108:111], v[20:23], v[116:119]
    v_mfma_f32_16x16x32_bf16 v[120:123], a[108:111], v[24:27], v[120:123]
    v_mfma_f32_16x16x32_bf16 v[124:127], a[108:111], v[28:31], v[124:127]
    v_mfma_f32_16x16x32_bf16 v[128:131], a[108:111], v[32:35], v[128:131]
    s_waitcnt vmcnt(21) lgkmcnt(0)
    v_mfma_f32_16x16x32_bf16 v[56:59], a[112:115], v[40:43], v[56:59]
    v_mfma_f32_16x16x32_bf16 v[60:63], a[112:115], v[44:47], v[60:63]
    v_mfma_f32_16x16x32_bf16 v[64:67], a[112:115], v[48:51], v[64:67]
    v_mfma_f32_16x16x32_bf16 v[68:71], a[112:115], v[52:55], v[68:71]
    v_mfma_f32_16x16x32_bf16 v[72:75], a[116:119], v[36:39], v[72:75]
    v_mfma_f32_16x16x32_bf16 v[76:79], a[116:119], v[40:43], v[76:79]
    buffer_load_dwordx4 a[252:255], v5, s[8:11], s34 offen offset:3072 sc1
    s_add_u32 s34, s34, 4096
    v_mfma_f32_16x16x32_bf16 v[80:83], a[116:119], v[44:47], v[80:83]
    v_mfma_f32_16x16x32_bf16 v[84:87], a[116:119], v[48:51], v[84:87]
    buffer_load_dwordx4 a[128:131], v253, s[8:11], s32 offen offset:0 sc1
    v_mfma_f32_16x16x32_bf16 v[88:91], a[116:119], v[52:55], v[88:91]
    v_mfma_f32_16x16x32_bf16 v[92:95], v[36:39], a[120:123], v[92:95]
    buffer_load_dwordx4 a[132:135], v253, s[8:11], s33 offen offset:0 sc1
    v_mfma_f32_16x16x32_bf16 v[96:99], v[40:43], a[120:123], v[96:99]
    v_mfma_f32_16x16x32_bf16 v[100:103], v[44:47], a[120:123], v[100:103]
    buffer_load_dwordx4 a[136:139], v5, s[8:11], s34 offen offset:0 sc1
    v_mfma_f32_16x16x32_bf16 v[104:107], v[48:51], a[120:123], v[104:107]
    v_mfma_f32_16x16x32_bf16 v[108:111], v[52:55], a[120:123], v[108:111]
    v_mfma_f32_16x16x32_bf16 v[112:115], a[124:127], v[36:39], v[112:115]
    v_mfma_f32_16x16x32_bf16 v[116:119], a[124:127], v[40:43], v[116:119]
    v_mfma_f32_16x16x32_bf16 v[120:123], a[124:127], v[44:47], v[120:123]
    v_mfma_f32_16x16x32_bf16 v[124:127], a[124:127], v[48:51], v[124:127]
    v_mfma_f32_16x16x32_bf16 v[128:131], a[124:127], v[52:55], v[128:131]
    v_cvt_pk_bf16_f32 v136, v56, v57
    v_cvt_pk_bf16_f32 v137, v58, v59
    v_cvt_pk_bf16_f32 v140, v60, v61
    v_cvt_pk_bf16_f32 v141, v62, v63
    v_cvt_pk_bf16_f32 v144, v64, v65
    v_cvt_pk_bf16_f32 v145, v66, v67
    v_cvt_pk_bf16_f32 v148, v68, v69
    v_cvt_pk_bf16_f32 v149, v70, v71
    v_cvt_pk_bf16_f32 v152, v72, v73
    buffer_load_dwordx4 a[140:143], v253, s[8:11], s32 offen offset:1024 sc1
    v_cvt_pk_bf16_f32 v153, v74, v75
    v_cvt_pk_bf16_f32 v156, v76, v77
    v_cvt_pk_bf16_f32 v157, v78, v79
    v_cvt_pk_bf16_f32 v160, v80, v81
    v_cvt_pk_bf16_f32 v161, v82, v83
    v_cvt_pk_bf16_f32 v164, v84, v85
    v_cvt_pk_bf16_f32 v165, v86, v87
    v_cvt_pk_bf16_f32 v168, v88, v89
    v_cvt_pk_bf16_f32 v169, v90, v91
    buffer_load_dwordx4 a[144:147], v253, s[8:11], s33 offen offset:1024 sc1
    v_cvt_pk_bf16_f32 v134, v112, v113
    v_cvt_pk_bf16_f32 v154, v114, v115
    v_cvt_pk_bf16_f32 v138, v116, v117
    v_cvt_pk_bf16_f32 v158, v118, v119
    v_cvt_pk_bf16_f32 v142, v120, v121
    v_cvt_pk_bf16_f32 v162, v122, v123
    v_cvt_pk_bf16_f32 v146, v124, v125
    v_cvt_pk_bf16_f32 v166, v126, v127
    v_cvt_pk_bf16_f32 v150, v128, v129
    buffer_load_dwordx4 a[148:151], v5, s[8:11], s34 offen offset:1024 sc1
    v_cvt_pk_bf16_f32 v170, v130, v131
    v_cvt_pk_bf16_f32 v172, v92, v93
    v_cvt_pk_bf16_f32 v173, v94, v95
    v_cvt_pk_bf16_f32 v174, v96, v97
    v_cvt_pk_bf16_f32 v175, v98, v99
    v_cvt_pk_bf16_f32 v176, v100, v101
    v_cvt_pk_bf16_f32 v177, v102, v103
    v_cvt_pk_bf16_f32 v178, v104, v105
    v_cvt_pk_bf16_f32 v179, v106, v107
    buffer_load_dwordx4 a[152:155], v253, s[8:11], s32 offen offset:2048 sc1
    v_cvt_pk_bf16_f32 v180, v108, v109
    v_cvt_pk_bf16_f32 v181, v110, v111
    v_mfma_f32_16x16x32_bf16 v[16:19], v[152:155], v[136:139], v[208:211]
    v_mfma_f32_16x16x32_bf16 v[20:23], v[156:159], v[136:139], v[204:207]
    v_mfma_f32_16x16x32_bf16 v[24:27], v[156:159], v[140:143], v[200:203]
    v_mfma_f32_16x16x32_bf16 v[28:31], v[160:163], v[140:143], v[204:207]
    v_mfma_f32_16x16x32_bf16 v[32:35], v[160:163], v[144:147], v[200:203]
    v_mfma_f32_16x16x32_bf16 v[36:39], v[164:167], v[144:147], v[204:207]
    v_mfma_f32_16x16x32_bf16 v[40:43], v[164:167], v[148:151], v[200:203]
    buffer_load_dwordx4 a[156:159], v253, s[8:11], s33 offen offset:2048 sc1
    v_mfma_f32_16x16x32_bf16 v[44:47], v[168:171], v[148:151], v[204:207]
    v_mfma_f32_16x16x32_bf16 v[56:59], v[132:135], v[192:195], v[196:199]
    v_mfma_f32_16x16x32_bf16 v[60:63], v[136:139], v[192:195], v[196:199]
    v_mfma_f32_16x16x32_bf16 v[64:67], v[140:143], v[192:195], v[196:199]
    v_mfma_f32_16x16x32_bf16 v[68:71], v[144:147], v[192:195], v[196:199]
    v_mfma_f32_16x16x32_bf16 v[72:75], v[148:151], v[192:195], v[196:199]
    v_max3_f32 v92, v16, v17, v18
    v_max3_f32 v96, v19, v20, v21
    v_max3_f32 v93, v24, v25, v26
    buffer_load_dwordx4 a[0:3], v5, s[8:11], s34 offen offset:2048 sc1
    v_max3_f32 v97, v27, v28, v29
    v_max3_f32 v94, v32, v33, v34
    v_max3_f32 v98, v35, v36, v37
    v_max3_f32 v95, v40, v41, v42
    v_max3_f32 v99, v43, v44, v45
    v_max3_f32 v92, v92, v22, v23
    v_max3_f32 v93, v93, v30, v31
    v_max3_f32 v94, v94, v38, v39
    v_max3_f32 v95, v95, v46, v47
    buffer_load_dwordx4 a[4:7], v253, s[8:11], s32 offen offset:3072 sc1
    s_add_u32 s32, s32, 4096
    v_max_f32 v92, v92, v96
    v_max_f32 v93, v93, v97
    v_max_f32 v94, v94, v98
    v_max_f32 v95, v95, v99
    s_mov_b32 s18, 0x3eae1a93
    v_cvt_pk_bf16_f32 v182, v56, v57
    v_permlane32_swap_b32 v92, v93
    v_permlane32_swap_b32 v94, v95
    v_max_f32 v92, v92, v93
    buffer_load_dwordx4 a[8:11], v253, s[8:11], s33 offen offset:3072 sc1
    s_add_u32 s33, s33, 4096
    v_max_f32 v94, v94, v95
    v_cvt_pk_bf16_f32 v183, v58, v59
    v_cvt_pk_bf16_f32 v184, v60, v61
    v_permlane16_swap_b32 v92, v94
    v_max_f32 v92, v92, v94
    v_mul_f32 v92, 0xbeae1a93, v92
    v_mov_b32 v94, v92
    v_cvt_pk_bf16_f32 v185, v62, v63
    v_cvt_pk_bf16_f32 v186, v64, v65
    buffer_load_dwordx4 a[12:15], v5, s[8:11], s34 offen offset:3072 sc1
    s_add_u32 s34, s34, 4096
    v_permlane16_swap_b32 v92, v94
    v_mov_b32 v93, v92
    v_mov_b32 v95, v94
    v_cvt_pk_bf16_f32 v187, v66, v67
    v_cvt_pk_bf16_f32 v188, v68, v69
    v_permlane32_swap_b32 v92, v93
    v_permlane32_swap_b32 v94, v95
    v_cvt_pk_bf16_f32 v189, v70, v71
    v_cvt_pk_bf16_f32 v190, v72, v73
    buffer_load_dwordx4 a[16:19], v253, s[8:11], s32 offen offset:0 sc1
    v_cvt_pk_bf16_f32 v191, v74, v75
    v_fma_f32 v16, v16, s18, v92
    v_fma_f32 v17, v17, s18, v92
    v_fma_f32 v18, v18, s18, v92
    v_fma_f32 v19, v19, s18, v92
    v_fma_f32 v20, v20, s18, v92
    v_fma_f32 v21, v21, s18, v92
    v_fma_f32 v22, v22, s18, v92
    v_fma_f32 v23, v23, s18, v92
    buffer_load_dwordx4 a[20:23], v253, s[8:11], s33 offen offset:0 sc1
    v_exp_f32 v16, v16
    v_exp_f32 v17, v17
    v_exp_f32 v18, v18
    v_exp_f32 v19, v19
    v_exp_f32 v20, v20
    v_exp_f32 v21, v21
    v_exp_f32 v22, v22
    v_exp_f32 v23, v23
    s_nop 0
    buffer_load_dwordx4 a[24:27], v5, s[8:11], s34 offen offset:0 sc1
    v_cvt_pk_bf16_f32 v76, v16, v17
    v_cvt_pk_bf16_f32 v77, v18, v19
    v_cvt_pk_bf16_f32 v78, v20, v21
    v_cvt_pk_bf16_f32 v79, v22, v23
    v_fma_f32 v24, v24, s18, v93
    v_fma_f32 v25, v25, s18, v93
    v_fma_f32 v26, v26, s18, v93
    v_fma_f32 v27, v27, s18, v93
    v_fma_f32 v28, v28, s18, v93
    buffer_load_dwordx4 a[28:31], v253, s[8:11], s32 offen offset:1024 sc1
    v_fma_f32 v29, v29, s18, v93
    v_fma_f32 v30, v30, s18, v93
    v_fma_f32 v31, v31, s18, v93
    v_exp_f32 v24, v24
    v_exp_f32 v25, v25
    v_exp_f32 v26, v26
    v_exp_f32 v27, v27
    v_exp_f32 v28, v28
    v_exp_f32 v29, v29
    buffer_load_dwordx4 a[32:35], v253, s[8:11], s33 offen offset:1024 sc1
    v_exp_f32 v30, v30
    v_exp_f32 v31, v31
    v_mfma_f32_16x16x32_bf16 v[100:103], v[172:175], v[76:79], 0
    v_mfma_f32_16x16x32_bf16 v[116:119], v[182:185], v[76:79], 0
    v_cvt_pk_bf16_f32 v80, v24, v25
    v_cvt_pk_bf16_f32 v81, v26, v27
    v_cvt_pk_bf16_f32 v82, v28, v29
    v_cvt_pk_bf16_f32 v83, v30, v31
    v_fma_f32 v32, v32, s18, v94
    buffer_load_dwordx4 a[36:39], v5, s[8:11], s34 offen offset:1024 sc1
    v_fma_f32 v33, v33, s18, v94
    v_fma_f32 v34, v34, s18, v94
    v_fma_f32 v35, v35, s18, v94
    v_fma_f32 v36, v36, s18, v94
    v_fma_f32 v37, v37, s18, v94
    v_fma_f32 v38, v38, s18, v94
    v_fma_f32 v39, v39, s18, v94
    v_exp_f32 v32, v32
    v_exp_f32 v33, v33
    buffer_load_dwordx4 a[40:43], v253, s[8:11], s32 offen offset:2048 sc1
    v_exp_f32 v34, v34
    v_exp_f32 v35, v35
    v_exp_f32 v36, v36
    v_exp_f32 v37, v37
    v_exp_f32 v38, v38
    v_exp_f32 v39, v39
    v_mfma_f32_16x16x32_bf16 v[104:107], v[174:177], v[80:83], 0
    v_mfma_f32_16x16x32_bf16 v[120:123], v[184:187], v[80:83], 0
    v_cvt_pk_bf16_f32 v84, v32, v33
    buffer_load_dwordx4 a[44:47], v253, s[8:11], s33 offen offset:2048 sc1
    v_cvt_pk_bf16_f32 v85, v34, v35
    v_cvt_pk_bf16_f32 v86, v36, v37
    v_cvt_pk_bf16_f32 v87, v38, v39
    v_fma_f32 v40, v40, s18, v95
    v_fma_f32 v41, v41, s18, v95
    v_fma_f32 v42, v42, s18, v95
    v_fma_f32 v43, v43, s18, v95
    v_fma_f32 v44, v44, s18, v95
    v_fma_f32 v45, v45, s18, v95
    buffer_load_dwordx4 a[48:51], v5, s[8:11], s34 offen offset:2048 sc1
    v_fma_f32 v46, v46, s18, v95
    v_fma_f32 v47, v47, s18, v95
    v_exp_f32 v40, v40
    v_exp_f32 v41, v41
    v_exp_f32 v42, v42
    v_exp_f32 v43, v43
    v_exp_f32 v44, v44
    v_exp_f32 v45, v45
    v_exp_f32 v46, v46
    buffer_load_dwordx4 a[52:55], v253, s[8:11], s32 offen offset:3072 sc1
    s_add_u32 s32, s32, 4096
    v_exp_f32 v47, v47
    v_mfma_f32_16x16x32_bf16 v[108:111], v[176:179], v[84:87], 0
    v_mfma_f32_16x16x32_bf16 v[124:127], v[186:189], v[84:87], 0
    v_cvt_pk_bf16_f32 v88, v40, v41
    v_cvt_pk_bf16_f32 v89, v42, v43
    v_cvt_pk_bf16_f32 v90, v44, v45
    v_cvt_pk_bf16_f32 v91, v46, v47
    v_rcp_f32 v96, v118
    v_rcp_f32 v97, v122
    buffer_load_dwordx4 v[240:243], v9, s[8:11], s37 offen offset:0 sc1
    v_mfma_f32_16x16x32_bf16 v[112:115], v[178:181], v[88:91], 0
    v_mfma_f32_16x16x32_bf16 v[128:131], v[188:191], v[88:91], 0
    v_pk_mul_f32 v[100:101], v[96:97], v[100:101] op_sel:[0,0] op_sel_hi:[0,1]
    v_pk_mul_f32 v[102:103], v[96:97], v[102:103] op_sel:[0,0] op_sel_hi:[0,1]
    v_pk_mul_f32 v[116:117], v[96:97], v[116:117] op_sel:[0,0] op_sel_hi:[0,1]
    v_cvt_pk_bf16_f32 v212, v100, v101
    v_cvt_pk_bf16_f32 v213, v102, v103
    v_cvt_pk_bf16_f32 v220, v116, v117
    v_rcp_f32 v98, v126
    buffer_load_dwordx4 v[244:247], v9, s[8:11], s37 offen offset:1024 sc1
    v_pk_mul_f32 v[104:105], v[96:97], v[104:105] op_sel:[1,0] op_sel_hi:[1,1]
    v_pk_mul_f32 v[106:107], v[96:97], v[106:107] op_sel:[1,0] op_sel_hi:[1,1]
    v_pk_mul_f32 v[120:121], v[96:97], v[120:121] op_sel:[1,0] op_sel_hi:[1,1]
    v_cvt_pk_bf16_f32 v214, v104, v105
    v_cvt_pk_bf16_f32 v215, v106, v107
    v_cvt_pk_bf16_f32 v221, v120, v121
    v_rcp_f32 v99, v130
    v_permlane16_swap_b32 v212, v214
    v_permlane16_swap_b32 v213, v215
    buffer_load_dwordx4 v[248:251], v7, s[8:11], s37 offen offset:2048 sc1
    v_pk_mul_f32 v[108:109], v[98:99], v[108:109] op_sel:[0,0] op_sel_hi:[0,1]
    v_pk_mul_f32 v[110:111], v[98:99], v[110:111] op_sel:[0,0] op_sel_hi:[0,1]
    v_pk_mul_f32 v[124:125], v[98:99], v[124:125] op_sel:[0,0] op_sel_hi:[0,1]
    v_cvt_pk_bf16_f32 v216, v108, v109
    v_cvt_pk_bf16_f32 v217, v110, v111
    v_cvt_pk_bf16_f32 v222, v124, v125
    v_pk_mul_f32 v[112:113], v[98:99], v[112:113] op_sel:[1,0] op_sel_hi:[1,1]
    v_pk_mul_f32 v[114:115], v[98:99], v[114:115] op_sel:[1,0] op_sel_hi:[1,1]
    v_pk_mul_f32 v[128:129], v[98:99], v[128:129] op_sel:[1,0] op_sel_hi:[1,1]
    buffer_load_dword v252, v8, s[8:11], s47 offen sc1
    v_cvt_pk_bf16_f32 v218, v112, v113
    v_cvt_pk_bf16_f32 v219, v114, v115
    v_cvt_pk_bf16_f32 v223, v128, v129
    s_lshl_b32 s7, s3, 2
    s_add_u32 s7, s7, 94208
    v_permlane16_swap_b32 v220, v221
    v_permlane16_swap_b32 v222, v223
    v_add_u32 v11, s7, v253
    v_lshrrev_b32 v10, 3, v0
    v_permlane32_swap_b32 v220, v222
    v_mul_u32_u24 v10, 9216, v10
    ds_write_b32 v11, v220
    v_permlane16_swap_b32 v216, v218
    v_permlane16_swap_b32 v217, v219
    s_mul_i32 s7, s40, 1152
    s_add_u32 s22, s22, s7
    s_add_u32 s22, s22, 41156608
    s_lshl_b32 s7, s3, 8
    s_add_u32 s23, s22, s7
    s_add_u32 s24, s23, 36864
    buffer_store_dwordx4 v[212:215], v9, s[8:11], s23 offen sc1
    buffer_store_dwordx4 v[216:219], v9, s[8:11], s24 offen sc1
    v_and_b32 v11, 7, v0
    v_lshl_add_u32 v10, v11, 4, v10
    s_cmp_eq_u32 s3, 3
    s_cselect_b32 s7, 0, 1073741824
    v_add_u32 v10, s7, v10
    v_add_u32 v11, 94208, v253
    s_waitcnt lgkmcnt(0)
    s_barrier
    ds_read_b128 v[220:223], v11
    s_waitcnt lgkmcnt(0)
    buffer_store_dwordx4 v[220:223], v10, s[8:11], s22 offen offset:1024 sc1
    v_lshlrev_b32 v15, 7, v0
    s_lshl_b32 s6, s40, 2
    s_add_u32 s6, s6, s44
    v_mov_b32 v1, s76
    s_mov_b64 vcc, 0xff
    s_waitcnt vmcnt(0)
    s_barrier
    s_cmp_lg_u32 s3, 0
    s_cbranch_scc1 L_pub_17
    s_mov_b64 exec, vcc
    buffer_store_dword v1, v15, s[8:11], s6 offen sc1
L_pub_17:
    s_mov_b64 exec, -1
    buffer_load_dwordx4 a[56:59], v253, s[8:11], s33 offen offset:3072 sc1
    s_add_u32 s33, s33, 4096
    buffer_load_dwordx4 a[60:63], v5, s[8:11], s34 offen offset:3072 sc1
    s_add_u32 s34, s34, 4096
    buffer_load_dwordx4 a[64:67], v253, s[8:11], s32 offen offset:0 sc1
    buffer_load_dwordx4 a[68:71], v253, s[8:11], s33 offen offset:0 sc1
    buffer_load_dwordx4 a[72:75], v5, s[8:11], s34 offen offset:0 sc1
    buffer_load_dwordx4 a[76:79], v253, s[8:11], s32 offen offset:1024 sc1
    buffer_load_dwordx4 a[80:83], v253, s[8:11], s33 offen offset:1024 sc1
    buffer_load_dwordx4 a[84:87], v5, s[8:11], s34 offen offset:1024 sc1
    s_cmp_lg_u32 s42, 0
    s_cbranch_scc1 L_swz_18
    s_cmp_eq_u32 s93, 2
    s_cselect_b32 s6, 2, 3
    s_mov_b32 s7, 512
    s_cmov_b32 s7, 2048
    v_lshrrev_b32 v14, 4, v0
    v_lshlrev_b32 v14, s6, v14
    v_bfe_u32 v15, v0, 2, 2
    v_add_u32 v14, v14, v15
    v_mul_u32_u24 v14, 128, v14
    v_and_b32 v15, 3, v0
    v_lshl_add_u32 v14, v15, 3, v14
    v_add_u32 v14, s79, v14
    v_add_u32 v15, s7, v14
    ds_read_b64_tr_b16 v[76:77], v14 offset:0
    ds_read_b64_tr_b16 v[78:79], v15 offset:0
    ds_read_b64_tr_b16 v[80:81], v14 offset:32
    ds_read_b64_tr_b16 v[82:83], v15 offset:32
    ds_read_b64_tr_b16 v[84:85], v14 offset:64
    ds_read_b64_tr_b16 v[86:87], v15 offset:64
    ds_read_b64_tr_b16 v[88:89], v14 offset:96
    ds_read_b64_tr_b16 v[90:91], v15 offset:96
    ds_read_b64_tr_b16 v[92:93], v14 offset:4096
    ds_read_b64_tr_b16 v[94:95], v15 offset:4096
    ds_read_b64_tr_b16 v[96:97], v14 offset:4128
    ds_read_b64_tr_b16 v[98:99], v15 offset:4128
    ds_read_b64_tr_b16 v[176:177], v14 offset:4160
    ds_read_b64_tr_b16 v[178:179], v15 offset:4160
    ds_read_b64_tr_b16 v[180:181], v14 offset:4192
    ds_read_b64_tr_b16 v[182:183], v15 offset:4192
    ds_read_b64_tr_b16 v[196:197], v14 offset:8192
    ds_read_b64_tr_b16 v[198:199], v15 offset:8192
    ds_read_b64_tr_b16 v[200:201], v14 offset:8224
    ds_read_b64_tr_b16 v[202:203], v15 offset:8224
    ds_read_b64_tr_b16 v[204:205], v14 offset:8256
    ds_read_b64_tr_b16 v[206:207], v15 offset:8256
    ds_read_b64_tr_b16 v[208:209], v14 offset:8288
    ds_read_b64_tr_b16 v[210:211], v15 offset:8288
    ds_read_b64_tr_b16 v[212:213], v14 offset:12288
    ds_read_b64_tr_b16 v[214:215], v15 offset:12288
    ds_read_b64_tr_b16 v[216:217], v14 offset:12320
    ds_read_b64_tr_b16 v[218:219], v15 offset:12320
    ds_read_b64_tr_b16 v[220:221], v14 offset:12352
    ds_read_b64_tr_b16 v[222:223], v15 offset:12352
    ds_read_b64_tr_b16 v[228:229], v14 offset:12384
    ds_read_b64_tr_b16 v[230:231], v15 offset:12384
    s_mul_i32 s68, s40, 1990656
    s_add_u32 s68, s68, 3145728
    s_cmp_eq_u32 s93, 2
    s_cbranch_scc1 L_swz_down_19
    s_mul_i32 s6, s84, 349526
    s_lshr_b32 s6, s6, 20
    s_mul_i32 s7, s6, 3
    s_sub_u32 s7, s84, s7
    s_mul_i32 s6, s6, 6
    s_add_u32 s7, s7, s6
    s_mul_i32 s6, s88, 36
    s_add_u32 s7, s7, s6
    s_mul_i32 s6, s93, 3
    s_add_u32 s7, s7, s6
    s_lshl_b32 s7, s7, 10
    s_add_u32 s7, s7, s68
    s_add_u32 s80, s7, 0
    s_add_u32 s81, s7, 497664
    s_add_u32 s82, s7, 995328
    s_add_u32 s83, s7, 1492992
    s_mul_i32 s6, s85, 349526
    s_lshr_b32 s6, s6, 20
    s_mul_i32 s7, s6, 3
    s_sub_u32 s7, s85, s7
    s_mul_i32 s6, s6, 6
    s_add_u32 s7, s7, s6
    s_mul_i32 s6, s89, 36
    s_add_u32 s7, s7, s6
    s_mul_i32 s6, s93, 3
    s_add_u32 s7, s7, s6
    s_lshl_b32 s7, s7, 10
    s_add_u32 s7, s7, s68
    s_add_u32 s64, s7, 0
    s_add_u32 s65, s7, 497664
    s_add_u32 s18, s7, 995328
    s_add_u32 s19, s7, 1492992
    s_mul_i32 s6, s86, 349526
    s_lshr_b32 s6, s6, 20
    s_mul_i32 s7, s6, 3
    s_sub_u32 s7, s86, s7
    s_mul_i32 s6, s6, 6
    s_add_u32 s7, s7, s6
    s_mul_i32 s6, s90, 36
    s_add_u32 s7, s7, s6
    s_mul_i32 s6, s93, 3
    s_add_u32 s7, s7, s6
    s_lshl_b32 s7, s7, 10
    s_add_u32 s7, s7, s68
    s_add_u32 s20, s7, 0
    s_add_u32 s21, s7, 497664
    s_add_u32 s22, s7, 995328
    s_add_u32 s25, s7, 1492992
    s_mul_i32 s6, s87, 349526
    s_lshr_b32 s6, s6, 20
    s_mul_i32 s7, s6, 3
    s_sub_u32 s7, s87, s7
    s_mul_i32 s6, s6, 6
    s_add_u32 s7, s7, s6
    s_mul_i32 s6, s91, 36
    s_add_u32 s7, s7, s6
    s_mul_i32 s6, s93, 3
    s_add_u32 s7, s7, s6
    s_lshl_b32 s7, s7, 10
    s_add_u32 s7, s7, s68
    s_add_u32 s26, s7, 0
    s_add_u32 s27, s7, 497664
    s_add_u32 s28, s7, 995328
    s_add_u32 s29, s7, 1492992
    s_branch L_swz_dest_20
L_swz_down_19:
    s_mul_i32 s7, s88, 18
    s_add_u32 s7, s7, s84
    s_add_u32 s7, s7, 324
    s_lshl_b32 s7, s7, 10
    s_add_u32 s7, s7, s68
    s_add_u32 s80, s7, 0
    s_add_u32 s81, s7, 497664
    s_add_u32 s82, s7, 995328
    s_add_u32 s83, s7, 1492992
    s_mul_i32 s7, s89, 18
    s_add_u32 s7, s7, s85
    s_add_u32 s7, s7, 324
    s_lshl_b32 s7, s7, 10
    s_add_u32 s7, s7, s68
    s_add_u32 s64, s7, 0
    s_add_u32 s65, s7, 497664
    s_add_u32 s18, s7, 995328
    s_add_u32 s19, s7, 1492992
    s_mul_i32 s7, s90, 18
    s_add_u32 s7, s7, s86
    s_add_u32 s7, s7, 324
    s_lshl_b32 s7, s7, 10
    s_add_u32 s7, s7, s68
    s_add_u32 s20, s7, 0
    s_add_u32 s21, s7, 497664
    s_add_u32 s22, s7, 995328
    s_add_u32 s25, s7, 1492992
    s_mul_i32 s7, s91, 18
    s_add_u32 s7, s7, s87
    s_add_u32 s7, s7, 324
    s_lshl_b32 s7, s7, 10
    s_add_u32 s7, s7, s68
    s_add_u32 s26, s7, 0
    s_add_u32 s27, s7, 497664
    s_add_u32 s28, s7, 995328
    s_add_u32 s29, s7, 1492992
L_swz_dest_20:
    s_mov_b32 s72, s8
    s_mov_b32 s73, s9
    s_mov_b32 s74, 268435456
    s_waitcnt lgkmcnt(0)
    buffer_store_dwordx4 v[76:79], v253, s[72:75], s80 offen sc1
    buffer_store_dwordx4 v[80:83], v253, s[72:75], s81 offen sc1
    buffer_store_dwordx4 v[84:87], v253, s[72:75], s82 offen sc1
    buffer_store_dwordx4 v[88:91], v253, s[72:75], s83 offen sc1
    buffer_store_dwordx4 v[92:95], v253, s[72:75], s64 offen sc1
    buffer_store_dwordx4 v[96:99], v253, s[72:75], s65 offen sc1
    buffer_store_dwordx4 v[176:179], v253, s[72:75], s18 offen sc1
    buffer_store_dwordx4 v[180:183], v253, s[72:75], s19 offen sc1
    buffer_store_dwordx4 v[196:199], v253, s[72:75], s20 offen sc1
    buffer_store_dwordx4 v[200:203], v253, s[72:75], s21 offen sc1
    buffer_store_dwordx4 v[204:207], v253, s[72:75], s22 offen sc1
    buffer_store_dwordx4 v[208:211], v253, s[72:75], s25 offen sc1
    buffer_store_dwordx4 v[212:215], v253, s[72:75], s26 offen sc1
    buffer_store_dwordx4 v[216:219], v253, s[72:75], s27 offen sc1
    buffer_store_dwordx4 v[220:223], v253, s[72:75], s28 offen sc1
    buffer_store_dwordx4 v[228:231], v253, s[72:75], s29 offen sc1
    s_lshr_b32 s7, s2, 3
    s_lshl_b32 s7, s7, 2
    s_add_u32 s7, s7, s3
    s_lshl_b32 s7, s7, 9
    v_lshrrev_b32 v1, 1, v253
    v_add_u32 v1, s7, v1
    buffer_load_dwordx2 v[14:15], v1, s[96:99], 0 offen
L_swz_18:
    s_and_b32 s7, s3, 1
    s_mul_i32 s7, s7, 18432
    s_add_u32 s24, s30, s7
    s_lshr_b32 s7, s3, 1
    s_lshl_b32 s7, s7, 9
    s_add_u32 s24, s24, s7
    s_add_u32 s24, s24, 41156608
    s_mov_b32 s16, 0xffff0000
    v_lshlrev_b32 v124, 16, v240
    v_and_b32 v125, s16, v240
    v_lshlrev_b32 v126, 16, v241
    v_and_b32 v127, s16, v241
    v_lshlrev_b32 v128, 16, v242
    v_and_b32 v129, s16, v242
    v_lshlrev_b32 v130, 16, v243
    v_and_b32 v131, s16, v243
    v_lshlrev_b32 v132, 16, v244
    v_and_b32 v133, s16, v244
    v_lshlrev_b32 v134, 16, v245
    v_and_b32 v135, s16, v245
    v_lshlrev_b32 v136, 16, v246
    v_and_b32 v137, s16, v246
    v_lshlrev_b32 v138, 16, v247
    v_and_b32 v139, s16, v247
    v_lshlrev_b32 v140, 16, v248
    v_and_b32 v141, s16, v248
    v_lshlrev_b32 v142, 16, v249
    v_and_b32 v143, s16, v249
    v_lshlrev_b32 v144, 16, v250
    v_and_b32 v145, s16, v250
    v_lshlrev_b32 v146, 16, v251
    v_and_b32 v147, s16, v251
    s_cmp_eq_u32 s3, 1
    s_cselect_b32 s7, 16, 0
    v_lshlrev_b32 v12, 2, v0
    v_cmp_gt_u32 vcc, s7, v0
    v_add_u32 v10, 40960, v12
    v_add_u32 v11, 41472, v12
    v_cndmask_b32 v10, v11, v10, vcc
    v_and_b32 v11, 0x7c, v12
    v_cmp_gt_u32 vcc, 32, v0
    v_mov_b32 v13, 1073741824
    s_and_b32 s7, s40, 3
    s_lshl_b32 s45, s45, 2
    v_cndmask_b32 v8, v13, v12, vcc
    s_add_u32 s6, s7, s3
    s_cmp_eq_u32 s6, 0
    s_cselect_b32 s6, 0, 1073741824
    v_add_u32 v6, s6, v8
    s_add_u32 s45, s45, s7
    s_lshl_b32 s45, s45, 2
    s_add_u32 s45, s45, s3
    s_lshl_b32 s45, s45, 7
    s_add_u32 s45, s45, s43
    s_add_u32 s45, s45, 48300032
    s_cmp_eq_u32 s3, 0
    s_cselect_b32 s35, 1.0, 0
    s_lshl_b32 s7, s40, 2
    s_add_u32 s7, s7, s3
    s_mul_i32 s23, s7, 497664
    s_add_u32 s23, s23, 3145728
    s_add_u32 s50, s23, 497664
    s_mul_i32 s50, s50, s42
    v_mov_b32 v184, v253
    v_add_u32 v185, 4096, v253
    v_add_u32 v186, 8192, v253
    v_add_u32 v187, 12288, v253
    v_add_u32 v188, 16384, v253
    v_add_u32 v189, 20480, v253
    v_add_u32 v190, 24576, v253
    v_add_u32 v191, 28672, v253
    v_add_u32 v192, 32768, v253
    s_cmp_lg_u32 s3, 3
    s_cbranch_scc1 L_pollout_23
    s_lshl_b32 s7, s40, 7
    s_add_u32 s7, s7, s44
    s_add_u32 s52, s4, s7
    s_addc_u32 s53, s5, 0
    s_mov_b32 s6, 0
L_poll_21:
    s_load_dwordx8 s[56:63], s[52:53], 0 glc
    s_add_u32 s6, s6, 1
    s_waitcnt lgkmcnt(0)
    s_xor_b64 s[56:57], s[56:57], s[76:77]
    s_xor_b64 s[58:59], s[58:59], s[76:77]
    s_xor_b64 s[60:61], s[60:61], s[76:77]
    s_xor_b64 s[62:63], s[62:63], s[76:77]
    s_or_b64 s[56:57], s[56:57], s[58:59]
    s_or_b64 s[60:61], s[60:61], s[62:63]
    s_or_b64 s[56:57], s[56:57], s[60:61]
    s_cbranch_scc0 L_polled_22
    s_cmp_lt_u32 s6, 1048576
    s_cbranch_scc1 L_poll_21
    s_branch L_main_end
L_polled_22:
L_pollout_23:
    s_barrier
    s_lshl_b32 m0, s3, 10
    s_nop 0
    buffer_load_dwordx4 v2, s[8:11], s24 offen sc1 lds
    s_add_u32 m0, m0, 4096
    s_add_u32 s24, s24, 1024
    buffer_load_dwordx4 v2, s[8:11], s24 offen sc1 lds
    s_add_u32 m0, m0, 4096
    s_add_u32 s24, s24, 1024
    buffer_load_dwordx4 v2, s[8:11], s24 offen sc1 lds
    s_add_u32 m0, m0, 4096
    s_add_u32 s24, s24, 1024
    buffer_load_dwordx4 v2, s[8:11], s24 offen sc1 lds
    s_add_u32 m0, m0, 4096
    s_add_u32 s24, s24, 1024
    buffer_load_dwordx4 v2, s[8:11], s24 offen sc1 lds
    s_add_u32 m0, m0, 4096
    s_add_u32 s24, s24, 1024
    buffer_load_dwordx4 v2, s[8:11], s24 offen sc1 lds
    s_add_u32 m0, m0, 4096
    s_add_u32 s24, s24, 1024
    buffer_load_dwordx4 v2, s[8:11], s24 offen sc1 lds
    s_add_u32 m0, m0, 4096
    s_add_u32 s24, s24, 1024
    buffer_load_dwordx4 v2, s[8:11], s24 offen sc1 lds
    s_add_u32 m0, m0, 4096
    s_add_u32 s24, s24, 1024
    buffer_load_dwordx4 v2, s[8:11], s24 offen sc1 lds
    s_waitcnt vmcnt(4)
    s_barrier
    ds_read_b128 v[160:163], v253 offset:0
    ds_read_b128 v[164:167], v253 offset:1024
    s_waitcnt lgkmcnt(0)
    v_mfma_f32_16x16x32_bf16 v[100:103], a[160:163], v[160:163], 0
    ds_read_b128 v[168:171], v253 offset:2048
    v_mfma_f32_16x16x32_bf16 v[104:107], a[160:163], v[164:167], 0
    ds_read_b128 v[172:175], v253 offset:3072
    v_mfma_f32_16x16x32_bf16 v[108:111], a[164:167], v[160:163], 0
    v_mfma_f32_16x16x32_bf16 v[112:115], a[164:167], v[164:167], 0
    buffer_load_dwordx4 v[16:19], v184, s[48:51], s23 offen offset:0 sc1
    v_mfma_f32_16x16x32_bf16 v[116:119], a[168:171], v[160:163], 0
    v_mfma_f32_16x16x32_bf16 v[120:123], a[168:171], v[164:167], 0
    s_waitcnt lgkmcnt(0)
    v_mfma_f32_16x16x32_bf16 v[100:103], a[172:175], v[168:171], v[100:103]
    ds_read_b128 v[160:163], v253 offset:4096
    v_mfma_f32_16x16x32_bf16 v[104:107], a[172:175], v[172:175], v[104:107]
    ds_read_b128 v[164:167], v253 offset:5120
    v_mfma_f32_16x16x32_bf16 v[108:111], a[176:179], v[168:171], v[108:111]
    v_mfma_f32_16x16x32_bf16 v[112:115], a[176:179], v[172:175], v[112:115]
    buffer_load_dwordx4 v[20:23], v184, s[48:51], s23 offen offset:1024 sc1
    v_mfma_f32_16x16x32_bf16 v[116:119], a[180:183], v[168:171], v[116:119]
    v_mfma_f32_16x16x32_bf16 v[120:123], a[180:183], v[172:175], v[120:123]
    s_waitcnt lgkmcnt(0)
    v_mfma_f32_16x16x32_bf16 v[100:103], a[184:187], v[160:163], v[100:103]
    ds_read_b128 v[168:171], v253 offset:6144
    v_mfma_f32_16x16x32_bf16 v[104:107], a[184:187], v[164:167], v[104:107]
    ds_read_b128 v[172:175], v253 offset:7168
    v_mfma_f32_16x16x32_bf16 v[108:111], a[188:191], v[160:163], v[108:111]
    v_mfma_f32_16x16x32_bf16 v[112:115], a[188:191], v[164:167], v[112:115]
    buffer_load_dwordx4 v[24:27], v184, s[48:51], s23 offen offset:2048 sc1
    v_mfma_f32_16x16x32_bf16 v[116:119], a[192:195], v[160:163], v[116:119]
    v_mfma_f32_16x16x32_bf16 v[120:123], a[192:195], v[164:167], v[120:123]
    s_waitcnt lgkmcnt(0)
    v_mfma_f32_16x16x32_bf16 v[100:103], a[196:199], v[168:171], v[100:103]
    ds_read_b128 v[160:163], v253 offset:8192
    v_mfma_f32_16x16x32_bf16 v[104:107], a[196:199], v[172:175], v[104:107]
    ds_read_b128 v[164:167], v253 offset:9216
    v_mfma_f32_16x16x32_bf16 v[108:111], a[200:203], v[168:171], v[108:111]
    v_mfma_f32_16x16x32_bf16 v[112:115], a[200:203], v[172:175], v[112:115]
    buffer_load_dwordx4 v[28:31], v184, s[48:51], s23 offen offset:3072 sc1
    v_mfma_f32_16x16x32_bf16 v[116:119], a[204:207], v[168:171], v[116:119]
    v_mfma_f32_16x16x32_bf16 v[120:123], a[204:207], v[172:175], v[120:123]
    s_waitcnt lgkmcnt(0)
    v_mfma_f32_16x16x32_bf16 v[100:103], a[208:211], v[160:163], v[100:103]
    ds_read_b128 v[168:171], v253 offset:10240
    v_mfma_f32_16x16x32_bf16 v[104:107], a[208:211], v[164:167], v[104:107]
    ds_read_b128 v[172:175], v253 offset:11264
    v_mfma_f32_16x16x32_bf16 v[108:111], a[212:215], v[160:163], v[108:111]
    v_mfma_f32_16x16x32_bf16 v[112:115], a[212:215], v[164:167], v[112:115]
    buffer_load_dwordx4 v[32:35], v185, s[48:51], s23 offen offset:0 sc1
    v_mfma_f32_16x16x32_bf16 v[116:119], a[216:219], v[160:163], v[116:119]
    v_mfma_f32_16x16x32_bf16 v[120:123], a[216:219], v[164:167], v[120:123]
    s_waitcnt lgkmcnt(0)
    v_mfma_f32_16x16x32_bf16 v[100:103], a[220:223], v[168:171], v[100:103]
    ds_read_b128 v[160:163], v253 offset:12288
    v_mfma_f32_16x16x32_bf16 v[104:107], a[220:223], v[172:175], v[104:107]
    ds_read_b128 v[164:167], v253 offset:13312
    v_mfma_f32_16x16x32_bf16 v[108:111], a[224:227], v[168:171], v[108:111]
    v_mfma_f32_16x16x32_bf16 v[112:115], a[224:227], v[172:175], v[112:115]
    buffer_load_dwordx4 v[36:39], v185, s[48:51], s23 offen offset:1024 sc1
    v_mfma_f32_16x16x32_bf16 v[116:119], a[228:231], v[168:171], v[116:119]
    v_mfma_f32_16x16x32_bf16 v[120:123], a[228:231], v[172:175], v[120:123]
    s_waitcnt lgkmcnt(0)
    v_mfma_f32_16x16x32_bf16 v[100:103], a[232:235], v[160:163], v[100:103]
    ds_read_b128 v[168:171], v253 offset:14336
    v_mfma_f32_16x16x32_bf16 v[104:107], a[232:235], v[164:167], v[104:107]
    ds_read_b128 v[172:175], v253 offset:15360
    v_mfma_f32_16x16x32_bf16 v[108:111], a[236:239], v[160:163], v[108:111]
    v_mfma_f32_16x16x32_bf16 v[112:115], a[236:239], v[164:167], v[112:115]
    buffer_load_dwordx4 v[40:43], v185, s[48:51], s23 offen offset:2048 sc1
    v_mfma_f32_16x16x32_bf16 v[116:119], a[240:243], v[160:163], v[116:119]
    v_mfma_f32_16x16x32_bf16 v[120:123], a[240:243], v[164:167], v[120:123]
    s_waitcnt lgkmcnt(0)
    v_mfma_f32_16x16x32_bf16 v[100:103], a[244:247], v[168:171], v[100:103]
    ds_read_b128 v[160:163], v253 offset:16384
    v_mfma_f32_16x16x32_bf16 v[104:107], a[244:247], v[172:175], v[104:107]
    ds_read_b128 v[164:167], v253 offset:17408
    v_mfma_f32_16x16x32_bf16 v[108:111], a[248:251], v[168:171], v[108:111]
    v_mfma_f32_16x16x32_bf16 v[112:115], a[248:251], v[172:175], v[112:115]
    buffer_load_dwordx4 v[44:47], v185, s[48:51], s23 offen offset:3072 sc1
    v_mfma_f32_16x16x32_bf16 v[116:119], a[252:255], v[168:171], v[116:119]
    v_mfma_f32_16x16x32_bf16 v[120:123], a[252:255], v[172:175], v[120:123]
    s_waitcnt lgkmcnt(0)
    v_mfma_f32_16x16x32_bf16 v[100:103], a[128:131], v[160:163], v[100:103]
    ds_read_b128 v[168:171], v253 offset:18432
    v_mfma_f32_16x16x32_bf16 v[104:107], a[128:131], v[164:167], v[104:107]
    ds_read_b128 v[172:175], v253 offset:19456
    v_mfma_f32_16x16x32_bf16 v[108:111], a[132:135], v[160:163], v[108:111]
    v_mfma_f32_16x16x32_bf16 v[112:115], a[132:135], v[164:167], v[112:115]
    buffer_load_dwordx4 v[48:51], v186, s[48:51], s23 offen offset:0 sc1
    v_mfma_f32_16x16x32_bf16 v[116:119], a[136:139], v[160:163], v[116:119]
    v_mfma_f32_16x16x32_bf16 v[120:123], a[136:139], v[164:167], v[120:123]
    s_waitcnt vmcnt(9) lgkmcnt(0)
    s_barrier
    s_xor_b32 s7, s3, 0
    s_or_b32 s7, s7, s42
    s_cbranch_scc1 L_swz_24
    v_lshlrev_b32 v15, 10, v0
    s_lshl_b32 s6, s40, 7
    s_lshl_b32 s7, s41, 2
    s_add_u32 s6, s6, s7
    s_add_u32 s6, s6, 19464192
    s_mov_b64 exec, 0xffffffff
    v_lshlrev_b32 v15, 10, v0
    v_mov_b32 v1, s76
    buffer_store_dword v1, v15, s[8:11], s6 offen sc1
    s_mov_b64 exec, -1
L_swz_24:
    v_mfma_f32_16x16x32_bf16 v[100:103], a[140:143], v[168:171], v[100:103]
    ds_read_b128 v[160:163], v253 offset:20480
    v_mfma_f32_16x16x32_bf16 v[104:107], a[140:143], v[172:175], v[104:107]
    ds_read_b128 v[164:167], v253 offset:21504
    v_mfma_f32_16x16x32_bf16 v[108:111], a[144:147], v[168:171], v[108:111]
    v_mfma_f32_16x16x32_bf16 v[112:115], a[144:147], v[172:175], v[112:115]
    buffer_load_dwordx4 v[52:55], v186, s[48:51], s23 offen offset:1024 sc1
    v_mfma_f32_16x16x32_bf16 v[116:119], a[148:151], v[168:171], v[116:119]
    v_mfma_f32_16x16x32_bf16 v[120:123], a[148:151], v[172:175], v[120:123]
    s_waitcnt lgkmcnt(0)
    v_mfma_f32_16x16x32_bf16 v[100:103], a[152:155], v[160:163], v[100:103]
    ds_read_b128 v[168:171], v253 offset:22528
    v_mfma_f32_16x16x32_bf16 v[104:107], a[152:155], v[164:167], v[104:107]
    ds_read_b128 v[172:175], v253 offset:23552
    v_mfma_f32_16x16x32_bf16 v[108:111], a[156:159], v[160:163], v[108:111]
    v_mfma_f32_16x16x32_bf16 v[112:115], a[156:159], v[164:167], v[112:115]
    buffer_load_dwordx4 v[56:59], v186, s[48:51], s23 offen offset:2048 sc1
    v_mfma_f32_16x16x32_bf16 v[116:119], a[0:3], v[160:163], v[116:119]
    v_mfma_f32_16x16x32_bf16 v[120:123], a[0:3], v[164:167], v[120:123]
    s_waitcnt lgkmcnt(0)
    v_mfma_f32_16x16x32_bf16 v[100:103], a[4:7], v[168:171], v[100:103]
    ds_read_b128 v[160:163], v253 offset:24576
    v_mfma_f32_16x16x32_bf16 v[104:107], a[4:7], v[172:175], v[104:107]
    ds_read_b128 v[164:167], v253 offset:25600
    v_mfma_f32_16x16x32_bf16 v[108:111], a[8:11], v[168:171], v[108:111]
    v_mfma_f32_16x16x32_bf16 v[112:115], a[8:11], v[172:175], v[112:115]
    buffer_load_dwordx4 v[60:63], v186, s[48:51], s23 offen offset:3072 sc1
    v_mfma_f32_16x16x32_bf16 v[116:119], a[12:15], v[168:171], v[116:119]
    v_mfma_f32_16x16x32_bf16 v[120:123], a[12:15], v[172:175], v[120:123]
    s_waitcnt lgkmcnt(0)
    v_mfma_f32_16x16x32_bf16 v[100:103], a[16:19], v[160:163], v[100:103]
    ds_read_b128 v[168:171], v253 offset:26624
    v_mfma_f32_16x16x32_bf16 v[104:107], a[16:19], v[164:167], v[104:107]
    ds_read_b128 v[172:175], v253 offset:27648
    v_mfma_f32_16x16x32_bf16 v[108:111], a[20:23], v[160:163], v[108:111]
    v_mfma_f32_16x16x32_bf16 v[112:115], a[20:23], v[164:167], v[112:115]
    buffer_load_dwordx4 v[64:67], v187, s[48:51], s23 offen offset:0 sc1
    v_mfma_f32_16x16x32_bf16 v[116:119], a[24:27], v[160:163], v[116:119]
    v_mfma_f32_16x16x32_bf16 v[120:123], a[24:27], v[164:167], v[120:123]
    s_waitcnt lgkmcnt(0)
    v_mfma_f32_16x16x32_bf16 v[100:103], a[28:31], v[168:171], v[100:103]
    ds_read_b128 v[160:163], v253 offset:28672
    v_mfma_f32_16x16x32_bf16 v[104:107], a[28:31], v[172:175], v[104:107]
    ds_read_b128 v[164:167], v253 offset:29696
    v_mfma_f32_16x16x32_bf16 v[108:111], a[32:35], v[168:171], v[108:111]
    v_mfma_f32_16x16x32_bf16 v[112:115], a[32:35], v[172:175], v[112:115]
    buffer_load_dwordx4 v[68:71], v187, s[48:51], s23 offen offset:1024 sc1
    v_mfma_f32_16x16x32_bf16 v[116:119], a[36:39], v[168:171], v[116:119]
    v_mfma_f32_16x16x32_bf16 v[120:123], a[36:39], v[172:175], v[120:123]
    s_waitcnt lgkmcnt(0)
    v_mfma_f32_16x16x32_bf16 v[100:103], a[40:43], v[160:163], v[100:103]
    ds_read_b128 v[168:171], v253 offset:30720
    v_mfma_f32_16x16x32_bf16 v[104:107], a[40:43], v[164:167], v[104:107]
    ds_read_b128 v[172:175], v253 offset:31744
    v_mfma_f32_16x16x32_bf16 v[108:111], a[44:47], v[160:163], v[108:111]
    v_mfma_f32_16x16x32_bf16 v[112:115], a[44:47], v[164:167], v[112:115]
    buffer_load_dwordx4 v[72:75], v187, s[48:51], s23 offen offset:2048 sc1
    v_mfma_f32_16x16x32_bf16 v[116:119], a[48:51], v[160:163], v[116:119]
    v_mfma_f32_16x16x32_bf16 v[120:123], a[48:51], v[164:167], v[120:123]
    s_waitcnt lgkmcnt(0)
    v_mfma_f32_16x16x32_bf16 v[100:103], a[52:55], v[168:171], v[100:103]
    ds_read_b128 v[160:163], v253 offset:32768
    v_mfma_f32_16x16x32_bf16 v[104:107], a[52:55], v[172:175], v[104:107]
    ds_read_b128 v[164:167], v253 offset:33792
    v_mfma_f32_16x16x32_bf16 v[108:111], a[56:59], v[168:171], v[108:111]
    v_mfma_f32_16x16x32_bf16 v[112:115], a[56:59], v[172:175], v[112:115]
    v_mfma_f32_16x16x32_bf16 v[116:119], a[60:63], v[168:171], v[116:119]
    v_mfma_f32_16x16x32_bf16 v[120:123], a[60:63], v[172:175], v[120:123]
    s_waitcnt lgkmcnt(0)
    v_mfma_f32_16x16x32_bf16 v[100:103], a[64:67], v[160:163], v[100:103]
    ds_read_b128 v[168:171], v253 offset:34816
    v_mfma_f32_16x16x32_bf16 v[104:107], a[64:67], v[164:167], v[104:107]
    ds_read_b128 v[172:175], v253 offset:35840
    v_mfma_f32_16x16x32_bf16 v[108:111], a[68:71], v[160:163], v[108:111]
    v_mfma_f32_16x16x32_bf16 v[112:115], a[68:71], v[164:167], v[112:115]
    v_mfma_f32_16x16x32_bf16 v[116:119], a[72:75], v[160:163], v[116:119]
    v_mfma_f32_16x16x32_bf16 v[120:123], a[72:75], v[164:167], v[120:123]
    s_waitcnt lgkmcnt(0)
    v_mfma_f32_16x16x32_bf16 v[100:103], a[76:79], v[168:171], v[100:103]
    v_mfma_f32_16x16x32_bf16 v[104:107], a[76:79], v[172:175], v[104:107]
    v_mfma_f32_16x16x32_bf16 v[108:111], a[80:83], v[168:171], v[108:111]
    v_mfma_f32_16x16x32_bf16 v[112:115], a[80:83], v[172:175], v[112:115]
    v_mfma_f32_16x16x32_bf16 v[116:119], a[84:87], v[168:171], v[116:119]
    v_mfma_f32_16x16x32_bf16 v[120:123], a[84:87], v[172:175], v[120:123]
    s_nop 3
    v_permlane16_swap_b32 v100, v104
    v_permlane16_swap_b32 v101, v105
    v_permlane16_swap_b32 v102, v106
    v_permlane16_swap_b32 v103, v107
    v_add_f32 v12, v116, v117
    v_add_f32 v13, v120, v121
    ds_write_b32 v10, v12
    ds_write_b32 v10, v13 offset:64
    v_permlane16_swap_b32 v108, v112
    v_permlane16_swap_b32 v109, v113
    v_permlane16_swap_b32 v110, v114
    v_permlane16_swap_b32 v111, v115
    v_permlane16_swap_b32 v116, v120
    v_permlane16_swap_b32 v117, v121
    v_permlane16_swap_b32 v118, v122
    v_permlane16_swap_b32 v119, v123
    s_waitcnt lgkmcnt(0)
    s_barrier
    ds_read_b32 v12, v11 offset:40960
    v_pk_add_f32 v[124:125], v[124:125], v[100:101]
    v_pk_add_f32 v[126:127], v[126:127], v[102:103]
    v_pk_add_f32 v[128:129], v[128:129], v[104:105]
    v_pk_add_f32 v[130:131], v[130:131], v[106:107]
    v_pk_add_f32 v[132:133], v[132:133], v[108:109]
    v_pk_add_f32 v[134:135], v[134:135], v[110:111]
    v_pk_add_f32 v[136:137], v[136:137], v[112:113]
    v_pk_add_f32 v[138:139], v[138:139], v[114:115]
    v_pk_add_f32 v[140:141], v[140:141], v[116:117]
    v_pk_add_f32 v[142:143], v[142:143], v[118:119]
    v_pk_add_f32 v[144:145], v[144:145], v[120:121]
    v_pk_add_f32 v[146:147], v[146:147], v[122:123]
    v_mov_b32 v14, 0
    v_mov_b32 v15, 0
    s_waitcnt lgkmcnt(0)
    v_add_f32 v12, v12, v252
    v_pk_add_f32 v[100:101], v[124:125], v[12:13] op_sel_hi:[1,0] neg_lo:[0,1] neg_hi:[0,1]
    v_pk_add_f32 v[102:103], v[126:127], v[12:13] op_sel_hi:[1,0] neg_lo:[0,1] neg_hi:[0,1]
    v_pk_add_f32 v[104:105], v[128:129], v[12:13] op_sel_hi:[1,0] neg_lo:[0,1] neg_hi:[0,1]
    v_pk_add_f32 v[106:107], v[130:131], v[12:13] op_sel_hi:[1,0] neg_lo:[0,1] neg_hi:[0,1]
    v_cvt_pk_bf16_f32 v148, v100, v101
    v_cvt_pk_bf16_f32 v149, v102, v103
    v_cvt_pk_bf16_f32 v150, v104, v105
    v_cvt_pk_bf16_f32 v151, v106, v107
    buffer_store_dwordx4 v[148:151], v9, s[8:11], s46 offen offset:0 sc1
    v_pk_add_f32 v[108:109], v[132:133], v[12:13] op_sel_hi:[1,0] neg_lo:[0,1] neg_hi:[0,1]
    v_pk_add_f32 v[110:111], v[134:135], v[12:13] op_sel_hi:[1,0] neg_lo:[0,1] neg_hi:[0,1]
    v_pk_add_f32 v[112:113], v[136:137], v[12:13] op_sel_hi:[1,0] neg_lo:[0,1] neg_hi:[0,1]
    v_pk_add_f32 v[114:115], v[138:139], v[12:13] op_sel_hi:[1,0] neg_lo:[0,1] neg_hi:[0,1]
    v_cvt_pk_bf16_f32 v152, v108, v109
    v_cvt_pk_bf16_f32 v153, v110, v111
    v_cvt_pk_bf16_f32 v154, v112, v113
    v_cvt_pk_bf16_f32 v155, v114, v115
    buffer_store_dwordx4 v[152:155], v9, s[8:11], s46 offen offset:1024 sc1
    v_pk_add_f32 v[116:117], v[140:141], v[12:13] op_sel_hi:[1,0] neg_lo:[0,1] neg_hi:[0,1]
    v_pk_add_f32 v[118:119], v[142:143], v[12:13] op_sel_hi:[1,0] neg_lo:[0,1] neg_hi:[0,1]
    v_pk_add_f32 v[120:121], v[144:145], v[12:13] op_sel_hi:[1,0] neg_lo:[0,1] neg_hi:[0,1]
    v_pk_add_f32 v[122:123], v[146:147], v[12:13] op_sel_hi:[1,0] neg_lo:[0,1] neg_hi:[0,1]
    v_cvt_pk_bf16_f32 v156, v116, v117
    v_cvt_pk_bf16_f32 v157, v118, v119
    v_cvt_pk_bf16_f32 v158, v120, v121
    v_cvt_pk_bf16_f32 v159, v122, v123
    buffer_store_dwordx4 v[156:159], v7, s[8:11], s46 offen offset:2048 sc1
    v_dot2c_f32_bf16 v14, v148, v148
    v_dot2c_f32_bf16 v14, v149, v149
    v_dot2c_f32_bf16 v14, v150, v150
    v_dot2c_f32_bf16 v14, v151, v151
    v_dot2c_f32_bf16 v14, v152, v152
    v_dot2c_f32_bf16 v14, v153, v153
    v_dot2c_f32_bf16 v14, v154, v154
    v_dot2c_f32_bf16 v14, v155, v155
    v_dot2c_f32_bf16 v15, v156, v156
    v_dot2c_f32_bf16 v15, v157, v157
    v_dot2c_f32_bf16 v15, v158, v158
    v_dot2c_f32_bf16 v15, v159, v159
    buffer_store_dword v12, v6, s[8:11], s36 offen sc1
    s_nop 1
    v_fma_f32 v14, v15, s35, v14
    v_mov_b32 v15, v14
    s_nop 1
    v_permlane32_swap_b32 v14, v15
    v_add_f32 v14, v14, v15
    buffer_store_dword v14, v8, s[8:11], s45 offen sc1
    v_lshlrev_b32 v15, 7, v0
    s_lshl_b32 s6, s40, 2
    s_add_u32 s6, s6, s44
    s_add_u32 s6, s6, 32768
    v_mov_b32 v1, s76
    s_mov_b64 vcc, 0xff
    s_waitcnt vmcnt(0)
    s_barrier
    s_cmp_lg_u32 s3, 0
    s_cbranch_scc1 L_pub_25
    s_mov_b64 exec, vcc
    buffer_store_dword v1, v15, s[8:11], s6 offen sc1
L_pub_25:
    s_mov_b64 exec, -1
    s_lshl_b32 s7, s41, 2
    s_add_u32 s7, s7, s3
    s_mul_i32 s22, s7, 18432
    s_add_u32 s22, s22, s43
    s_add_u32 s22, s22, 45875200
    s_mul_i32 s24, s3, 18432
    s_lshl_b32 s25, s41, 12
    s_add_u32 s25, s25, s43
    s_add_u32 s25, s25, 48300032
    v_lshrrev_b32 v3, 5, v0
    v_and_b32 v10, 31, v0
    v_lshlrev_b32 v10, 2, v10
    v_lshl_add_u32 v3, v3, 11, v10
    v_add_u32 v11, 36864, v184
    s_mov_b32 s16, 0xffff0000
    s_lshl_b32 s7, s3, 10
    v_add_u32 v172, s7, v253
    v_add_u32 v174, 5120, v172
    v_and_b32 v178, 7, v0
    v_mul_u32_u24 v178, 1152, v178
    v_lshrrev_b32 v179, 3, v0
    v_lshl_add_u32 v178, v179, 4, v178
    s_lshl_b32 s7, s3, 7
    v_add_u32 v175, s7, v178
    v_add_u32 v177, 640, v175
    s_cmp_eq_u32 s3, 0
    s_mov_b32 s17, 1073741824
    s_cmov_b32 s17, 4096
    v_add_u32 v173, s17, v172
    s_mov_b32 s17, 1073741824
    s_cmov_b32 s17, 512
    v_add_u32 v176, s17, v175
    s_lshl_b32 s21, s41, 3
    s_add_u32 s21, s21, s40
    s_mul_i32 s18, s21, 9216
    s_mul_i32 s20, s21, 73728
    s_add_u32 s20, s20, 19922944
    v_bfe_u32 v1, v0, 3, 2
    s_mov_b32 s7, 73728
    v_mul_lo_u32 v178, v1, s7
    v_lshrrev_b32 v1, 5, v0
    v_lshl_add_u32 v178, v1, 7, v178
    v_and_b32 v1, 7, v0
    v_lshl_add_u32 v178, v1, 4, v178
    v_add_u32 v179, 294912, v178
    v_lshrrev_b32 v1, 5, v0
    v_and_b32 v15, 7, v0
    v_lshlrev_b32 v15, 4, v15
    v_lshl_add_u32 v15, v1, 7, v15
    s_lshl_b32 s7, s3, 8
    s_add_u32 s7, s7, 3072
    v_add_u32 v15, s7, v15
    v_bfe_u32 v1, v0, 3, 2
    v_mov_b32 v182, 1073741824
    v_add_u32 v183, 14336, v253
    s_sub_u32 s7, s40, 0
    v_cmp_eq_u32 vcc, s7, v1
    s_nop 1
    v_cndmask_b32 v178, v178, v182, vcc
    v_cndmask_b32 v216, v183, v15, vcc
    v_cndmask_b32 v218, 0, 1, vcc
    v_lshlrev_b32 v218, 10, v218
    s_sub_u32 s7, s40, 4
    v_cmp_eq_u32 vcc, s7, v1
    s_nop 1
    v_cndmask_b32 v179, v179, v182, vcc
    v_cndmask_b32 v217, v183, v15, vcc
    v_cndmask_b32 v219, 0, 1, vcc
    v_lshlrev_b32 v219, 10, v219
    s_mul_i32 s26, s41, 589824
    s_mul_i32 s7, s40, 9216
    s_add_u32 s26, s26, s7
    s_lshl_b32 s7, s3, 8
    s_add_u32 s27, s26, s7
    s_add_u32 s27, s27, 19921920
    s_mov_b32 s74, 0
    s_mul_i32 s7, s42, 98304
    s_sub_u32 s29, s44, s7
    s_add_u32 s29, s29, 360448
    s_lshl_b32 s7, s40, 7
    s_add_u32 s7, s7, s29
    s_add_u32 s38, s4, s7
    s_addc_u32 s39, s5, 0
    s_lshl_b32 s7, s40, 2
    s_add_u32 s29, s29, s7
    s_add_u32 s50, s23, 497664
    s_cmp_lg_u32 s42, 0
    s_cbranch_scc1 L_ring_26
    s_cmp_lg_u32 s3, 0
    s_cbranch_scc1 L_ring_27
    s_lshl_b32 s7, s41, 3
    s_add_u32 s7, s7, s40
    s_lshl_b32 s7, s7, 7
    s_add_u32 s7, s7, 19464192
    s_add_u32 s68, s4, s7
    s_addc_u32 s69, s5, 0
    s_mov_b32 s6, 0
    s_mov_b32 s7, 0
L_cpoll_28:
    s_load_dwordx16 s[52:67], s[68:69], s7 glc
    s_add_u32 s6, s6, 1
    s_waitcnt lgkmcnt(0)
    s_xor_b64 s[52:53], s[52:53], s[76:77]
    s_xor_b64 s[54:55], s[54:55], s[76:77]
    s_xor_b64 s[56:57], s[56:57], s[76:77]
    s_xor_b64 s[58:59], s[58:59], s[76:77]
    s_xor_b64 s[60:61], s[60:61], s[76:77]
    s_xor_b64 s[62:63], s[62:63], s[76:77]
    s_xor_b64 s[64:65], s[64:65], s[76:77]
    s_xor_b64 s[66:67], s[66:67], s[76:77]
    s_or_b64 s[52:53], s[52:53], s[60:61]
    s_or_b64 s[54:55], s[54:55], s[62:63]
    s_or_b64 s[56:57], s[56:57], s[64:65]
    s_or_b64 s[58:59], s[58:59], s[66:67]
    s_or_b64 s[52:53], s[52:53], s[56:57]
    s_or_b64 s[54:55], s[54:55], s[58:59]
    s_or_b64 s[52:53], s[52:53], s[54:55]
    s_cbranch_scc1 L_cpoll_29
    s_add_u32 s7, s7, 64
    s_cmp_eq_u32 s7, 128
    s_cbranch_scc1 L_cpolled_30
L_cpoll_29:
    s_cmp_lt_u32 s6, 1048576
    s_cbranch_scc1 L_cpoll_28
    s_branch L_main_end
L_cpolled_30:
L_ring_27:
    s_barrier
    buffer_load_dwordx4 v[16:19], v184, s[48:51], s23 offen offset:0 sc1
    buffer_load_dwordx4 v[20:23], v184, s[48:51], s23 offen offset:1024 sc1
    buffer_load_dwordx4 v[24:27], v184, s[48:51], s23 offen offset:2048 sc1
    buffer_load_dwordx4 v[28:31], v184, s[48:51], s23 offen offset:3072 sc1
    buffer_load_dwordx4 v[32:35], v185, s[48:51], s23 offen offset:0 sc1
    buffer_load_dwordx4 v[36:39], v185, s[48:51], s23 offen offset:1024 sc1
    buffer_load_dwordx4 v[40:43], v185, s[48:51], s23 offen offset:2048 sc1
    buffer_load_dwordx4 v[44:47], v185, s[48:51], s23 offen offset:3072 sc1
    buffer_load_dwordx4 v[48:51], v186, s[48:51], s23 offen offset:0 sc1
    buffer_load_dwordx4 v[52:55], v186, s[48:51], s23 offen offset:1024 sc1
    buffer_load_dwordx4 v[56:59], v186, s[48:51], s23 offen offset:2048 sc1
    buffer_load_dwordx4 v[60:63], v186, s[48:51], s23 offen offset:3072 sc1
    buffer_load_dwordx4 v[64:67], v187, s[48:51], s23 offen offset:0 sc1
    buffer_load_dwordx4 v[68:71], v187, s[48:51], s23 offen offset:1024 sc1
    buffer_load_dwordx4 v[72:75], v187, s[48:51], s23 offen offset:2048 sc1
L_ring_26:
    s_cmp_lg_u32 s3, 3
    s_cbranch_scc1 L_pollout_33
    s_lshl_b32 s7, s40, 7
    s_add_u32 s7, s7, s44
    s_add_u32 s7, s7, 32768
    s_add_u32 s52, s4, s7
    s_addc_u32 s53, s5, 0
    s_mov_b32 s6, 0
L_poll_31:
    s_load_dwordx8 s[56:63], s[52:53], 0 glc
    s_add_u32 s6, s6, 1
    s_waitcnt lgkmcnt(0)
    s_xor_b64 s[56:57], s[56:57], s[76:77]
    s_xor_b64 s[58:59], s[58:59], s[76:77]
    s_xor_b64 s[60:61], s[60:61], s[76:77]
    s_xor_b64 s[62:63], s[62:63], s[76:77]
    s_or_b64 s[56:57], s[56:57], s[58:59]
    s_or_b64 s[60:61], s[60:61], s[62:63]
    s_or_b64 s[56:57], s[56:57], s[60:61]
    s_cbranch_scc0 L_polled_32
    s_cmp_lt_u32 s6, 1048576
    s_cbranch_scc1 L_poll_31
    s_branch L_main_end
L_polled_32:
L_pollout_33:
    s_barrier
    s_add_u32 m0, s24, 0
    s_nop 0
    buffer_load_dwordx4 v2, s[8:11], s22 offen offset:0 sc1 lds
    s_add_u32 m0, s24, 512
    s_nop 0
    buffer_load_dwordx4 v2, s[8:11], s22 offen offset:512 sc1 lds
    s_add_u32 m0, s24, 1024
    s_nop 0
    buffer_load_dwordx4 v2, s[8:11], s22 offen offset:1024 sc1 lds
    s_add_u32 m0, s24, 1536
    s_nop 0
    buffer_load_dwordx4 v2, s[8:11], s22 offen offset:1536 sc1 lds
    s_add_u32 m0, s24, 2048
    s_nop 0
    buffer_load_dwordx4 v2, s[8:11], s22 offen offset:2048 sc1 lds
    s_add_u32 m0, s24, 2560
    s_nop 0
    buffer_load_dwordx4 v2, s[8:11], s22 offen offset:2560 sc1 lds
    s_add_u32 m0, s24, 3072
    s_nop 0
    buffer_load_dwordx4 v2, s[8:11], s22 offen offset:3072 sc1 lds
    s_add_u32 m0, s24, 3584
    s_nop 0
    buffer_load_dwordx4 v2, s[8:11], s22 offen offset:3584 sc1 lds
    s_add_u32 m0, s24, 8192
    s_add_u32 s22, s22, 4096
    buffer_load_dwordx4 v2, s[8:11], s22 offen offset:0 sc1 lds
    s_add_u32 m0, s24, 8704
    s_nop 0
    buffer_load_dwordx4 v2, s[8:11], s22 offen offset:512 sc1 lds
    s_add_u32 m0, s24, 9216
    s_nop 0
    buffer_load_dwordx4 v2, s[8:11], s22 offen offset:1024 sc1 lds
    s_add_u32 m0, s24, 9728
    s_nop 0
    buffer_load_dwordx4 v2, s[8:11], s22 offen offset:1536 sc1 lds
    s_add_u32 s23, s23, 15360
    s_lshr_b32 s7, s3, 1
    s_lshl_b32 s7, s7, 10
    s_and_b32 s6, s3, 1
    s_lshl_b32 s6, s6, 3
    s_add_u32 s28, s7, s6
    s_add_u32 s28, s28, 73728
    s_waitcnt vmcnt(6)
    s_barrier
    ds_read_b128 a[0:3], v184 offset:0
    ds_read_b128 a[72:75], v184 offset:18432
    ds_read_b128 a[144:147], v11 offset:0
    ds_read_b128 a[216:219], v11 offset:18432
    ds_read_b128 a[4:7], v184 offset:1024
    ds_read_b128 a[76:79], v184 offset:19456
    ds_read_b128 a[148:151], v11 offset:1024
    ds_read_b128 a[220:223], v11 offset:19456
    ds_read_b128 a[8:11], v184 offset:2048
    ds_read_b128 a[80:83], v184 offset:20480
    ds_read_b128 a[152:155], v11 offset:2048
    ds_read_b128 a[224:227], v11 offset:20480
    s_waitcnt vmcnt(24) lgkmcnt(0)
    v_mfma_f32_16x16x32_bf16 v[88:91], v[16:19], a[0:3], 0
    ds_read_b128 a[12:15], v184 offset:3072
    v_mfma_f32_16x16x32_bf16 v[88:91], v[20:23], a[4:7], v[88:91]
    buffer_load_dwordx4 v[76:79], v184, s[48:51], s23 offen offset:0 sc1
    v_mfma_f32_16x16x32_bf16 v[88:91], v[24:27], a[8:11], v[88:91]
    ds_read_b128 a[84:87], v184 offset:21504
    v_mfma_f32_16x16x32_bf16 v[92:95], v[16:19], a[72:75], 0
    s_add_u32 m0, s24, 10240
    s_nop 0
    buffer_load_dwordx4 v2, s[8:11], s22 offen offset:2048 sc1 lds
    v_mfma_f32_16x16x32_bf16 v[92:95], v[20:23], a[76:79], v[92:95]
    ds_read_b128 a[156:159], v11 offset:3072
    ds_read_b128 a[228:231], v11 offset:21504
    v_mfma_f32_16x16x32_bf16 v[92:95], v[24:27], a[80:83], v[92:95]
    buffer_load_dwordx4 v[80:83], v184, s[48:51], s23 offen offset:1024 sc1
    v_mfma_f32_16x16x32_bf16 v[96:99], v[16:19], a[144:147], 0
    ds_read_b128 a[16:19], v184 offset:4096
    v_mfma_f32_16x16x32_bf16 v[96:99], v[20:23], a[148:151], v[96:99]
    s_add_u32 m0, s24, 10752
    s_nop 0
    buffer_load_dwordx4 v2, s[8:11], s22 offen offset:2560 sc1 lds
    v_mfma_f32_16x16x32_bf16 v[96:99], v[24:27], a[152:155], v[96:99]
    ds_read_b128 a[88:91], v184 offset:22528
    v_mfma_f32_16x16x32_bf16 v[100:103], v[16:19], a[216:219], 0
    buffer_load_dwordx4 v[84:87], v184, s[48:51], s23 offen offset:2048 sc1
    v_mfma_f32_16x16x32_bf16 v[100:103], v[20:23], a[220:223], v[100:103]
    ds_read_b128 a[160:163], v11 offset:4096
    ds_read_b128 a[232:235], v11 offset:22528
    v_mfma_f32_16x16x32_bf16 v[100:103], v[24:27], a[224:227], v[100:103]
    s_add_u32 m0, s24, 11264
    s_nop 0
    buffer_load_dwordx4 v2, s[8:11], s22 offen offset:3072 sc1 lds
    s_waitcnt vmcnt(27) lgkmcnt(8)
    v_mfma_f32_16x16x32_bf16 v[104:107], v[28:31], a[0:3], 0
    ds_read_b128 a[20:23], v184 offset:5120
    v_mfma_f32_16x16x32_bf16 v[104:107], v[32:35], a[4:7], v[104:107]
    buffer_load_dwordx4 v[16:19], v184, s[48:51], s23 offen offset:3072 sc1
    v_mfma_f32_16x16x32_bf16 v[104:107], v[36:39], a[8:11], v[104:107]
    ds_read_b128 a[92:95], v184 offset:23552
    v_mfma_f32_16x16x32_bf16 v[108:111], v[28:31], a[72:75], 0
    s_add_u32 m0, s24, 11776
    s_nop 0
    buffer_load_dwordx4 v2, s[8:11], s22 offen offset:3584 sc1 lds
    v_mfma_f32_16x16x32_bf16 v[108:111], v[32:35], a[76:79], v[108:111]
    ds_read_b128 a[164:167], v11 offset:5120
    ds_read_b128 a[236:239], v11 offset:23552
    v_mfma_f32_16x16x32_bf16 v[108:111], v[36:39], a[80:83], v[108:111]
    buffer_load_dwordx4 v[20:23], v185, s[48:51], s23 offen offset:0 sc1
    v_mfma_f32_16x16x32_bf16 v[112:115], v[28:31], a[144:147], 0
    v_mfma_f32_16x16x32_bf16 v[112:115], v[32:35], a[148:151], v[112:115]
    s_add_u32 m0, s24, 16384
    s_add_u32 s22, s22, 4096
    buffer_load_dwordx4 v2, s[8:11], s22 offen offset:0 sc1 lds
    v_mfma_f32_16x16x32_bf16 v[112:115], v[36:39], a[152:155], v[112:115]
    v_mfma_f32_16x16x32_bf16 v[116:119], v[28:31], a[216:219], 0
    buffer_load_dwordx4 v[24:27], v185, s[48:51], s23 offen offset:1024 sc1
    v_mfma_f32_16x16x32_bf16 v[116:119], v[32:35], a[220:223], v[116:119]
    v_mfma_f32_16x16x32_bf16 v[116:119], v[36:39], a[224:227], v[116:119]
    s_add_u32 m0, s24, 16896
    s_nop 0
    buffer_load_dwordx4 v2, s[8:11], s22 offen offset:512 sc1 lds
    s_waitcnt vmcnt(12) lgkmcnt(0)
    s_barrier
    v_mfma_f32_16x16x32_bf16 v[88:91], v[40:43], a[12:15], v[88:91]
    ds_read_b128 a[24:27], v184 offset:6144
    v_mfma_f32_16x16x32_bf16 v[88:91], v[44:47], a[16:19], v[88:91]
    buffer_load_dwordx4 v[28:31], v185, s[48:51], s23 offen offset:2048 sc1
    v_mfma_f32_16x16x32_bf16 v[88:91], v[48:51], a[20:23], v[88:91]
    ds_read_b128 a[96:99], v184 offset:24576
    v_mfma_f32_16x16x32_bf16 v[92:95], v[40:43], a[84:87], v[92:95]
    buffer_load_dword v136, v3, s[8:11], s25 offen offset:0 sc1
    v_mfma_f32_16x16x32_bf16 v[92:95], v[44:47], a[88:91], v[92:95]
    ds_read_b128 a[168:171], v11 offset:6144
    ds_read_b128 a[240:243], v11 offset:24576
    v_mfma_f32_16x16x32_bf16 v[92:95], v[48:51], a[92:95], v[92:95]
    buffer_load_dwordx4 v[32:35], v185, s[48:51], s23 offen offset:3072 sc1
    v_mfma_f32_16x16x32_bf16 v[96:99], v[40:43], a[156:159], v[96:99]
    buffer_load_dword v137, v3, s[8:11], s25 offen offset:128 sc1
    v_mfma_f32_16x16x32_bf16 v[96:99], v[44:47], a[160:163], v[96:99]
    buffer_load_dword v138, v3, s[8:11], s25 offen offset:256 sc1
    v_mfma_f32_16x16x32_bf16 v[96:99], v[48:51], a[164:167], v[96:99]
    ds_read_b128 a[28:31], v184 offset:7168
    ds_read_b128 a[100:103], v184 offset:25600
    v_mfma_f32_16x16x32_bf16 v[100:103], v[40:43], a[228:231], v[100:103]
    buffer_load_dwordx4 v[36:39], v186, s[48:51], s23 offen offset:0 sc1
    v_mfma_f32_16x16x32_bf16 v[100:103], v[44:47], a[232:235], v[100:103]
    buffer_load_dword v139, v3, s[8:11], s25 offen offset:384 sc1
    v_mfma_f32_16x16x32_bf16 v[100:103], v[48:51], a[236:239], v[100:103]
    buffer_load_dword v140, v3, s[8:11], s25 offen offset:512 sc1
    s_waitcnt vmcnt(35) lgkmcnt(6)
    v_mfma_f32_16x16x32_bf16 v[104:107], v[52:55], a[12:15], v[104:107]
    ds_read_b128 a[172:175], v11 offset:7168
    ds_read_b128 a[244:247], v11 offset:25600
    v_mfma_f32_16x16x32_bf16 v[104:107], v[56:59], a[16:19], v[104:107]
    buffer_load_dwordx4 v[40:43], v186, s[48:51], s23 offen offset:1024 sc1
    v_mfma_f32_16x16x32_bf16 v[104:107], v[60:63], a[20:23], v[104:107]
    ds_read_b128 a[32:35], v184 offset:8192
    ds_read_b128 a[104:107], v184 offset:26624
    v_mfma_f32_16x16x32_bf16 v[108:111], v[52:55], a[84:87], v[108:111]
    buffer_load_dword v141, v3, s[8:11], s25 offen offset:640 sc1
    v_mfma_f32_16x16x32_bf16 v[108:111], v[56:59], a[88:91], v[108:111]
    ds_read_b128 a[176:179], v11 offset:8192
    ds_read_b128 a[248:251], v11 offset:26624
    v_mfma_f32_16x16x32_bf16 v[108:111], v[60:63], a[92:95], v[108:111]
    buffer_load_dwordx4 v[44:47], v186, s[48:51], s23 offen offset:2048 sc1
    v_mfma_f32_16x16x32_bf16 v[112:115], v[52:55], a[156:159], v[112:115]
    buffer_load_dword v142, v3, s[8:11], s25 offen offset:768 sc1
    v_mfma_f32_16x16x32_bf16 v[112:115], v[56:59], a[160:163], v[112:115]
    buffer_load_dword v143, v3, s[8:11], s25 offen offset:896 sc1
    v_mfma_f32_16x16x32_bf16 v[112:115], v[60:63], a[164:167], v[112:115]
    v_mfma_f32_16x16x32_bf16 v[116:119], v[52:55], a[228:231], v[116:119]
    buffer_load_dwordx4 v[48:51], v186, s[48:51], s23 offen offset:3072 sc1
    v_mfma_f32_16x16x32_bf16 v[116:119], v[56:59], a[232:235], v[116:119]
    buffer_load_dword v144, v3, s[8:11], s25 offen offset:1024 sc1
    v_mfma_f32_16x16x32_bf16 v[116:119], v[60:63], a[236:239], v[116:119]
    buffer_load_dword v145, v3, s[8:11], s25 offen offset:1152 sc1
    s_waitcnt vmcnt(40) lgkmcnt(0)
    v_mfma_f32_16x16x32_bf16 v[88:91], v[64:67], a[24:27], v[88:91]
    ds_read_b128 a[36:39], v184 offset:9216
    v_mfma_f32_16x16x32_bf16 v[88:91], v[68:71], a[28:31], v[88:91]
    buffer_load_dwordx4 v[52:55], v187, s[48:51], s23 offen offset:0 sc1
    v_mfma_f32_16x16x32_bf16 v[88:91], v[72:75], a[32:35], v[88:91]
    ds_read_b128 a[108:111], v184 offset:27648
    v_mfma_f32_16x16x32_bf16 v[92:95], v[64:67], a[96:99], v[92:95]
    buffer_load_dword v146, v3, s[8:11], s25 offen offset:1280 sc1
    v_mfma_f32_16x16x32_bf16 v[92:95], v[68:71], a[100:103], v[92:95]
    ds_read_b128 a[180:183], v11 offset:9216
    ds_read_b128 a[252:255], v11 offset:27648
    v_mfma_f32_16x16x32_bf16 v[92:95], v[72:75], a[104:107], v[92:95]
    buffer_load_dwordx4 v[56:59], v187, s[48:51], s23 offen offset:1024 sc1
    v_mfma_f32_16x16x32_bf16 v[96:99], v[64:67], a[168:171], v[96:99]
    buffer_load_dword v147, v3, s[8:11], s25 offen offset:1408 sc1
    v_mfma_f32_16x16x32_bf16 v[96:99], v[68:71], a[172:175], v[96:99]
    buffer_load_dword v148, v3, s[8:11], s25 offen offset:1536 sc1
    v_mfma_f32_16x16x32_bf16 v[96:99], v[72:75], a[176:179], v[96:99]
    ds_read_b128 a[40:43], v184 offset:10240
    ds_read_b128 a[112:115], v184 offset:28672
    v_mfma_f32_16x16x32_bf16 v[100:103], v[64:67], a[240:243], v[100:103]
    buffer_load_dwordx4 v[60:63], v187, s[48:51], s23 offen offset:2048 sc1
    v_mfma_f32_16x16x32_bf16 v[100:103], v[68:71], a[244:247], v[100:103]
    buffer_load_dword v149, v3, s[8:11], s25 offen offset:1664 sc1
    v_mfma_f32_16x16x32_bf16 v[100:103], v[72:75], a[248:251], v[100:103]
    buffer_load_dword v150, v3, s[8:11], s25 offen offset:1792 sc1
    s_waitcnt vmcnt(31) lgkmcnt(6)
    v_mfma_f32_16x16x32_bf16 v[104:107], v[76:79], a[24:27], v[104:107]
    ds_read_b128 a[184:187], v11 offset:10240
    ds_read_b128 v[220:223], v11 offset:28672
    v_mfma_f32_16x16x32_bf16 v[104:107], v[80:83], a[28:31], v[104:107]
    buffer_load_dwordx4 v[64:67], v187, s[48:51], s23 offen offset:3072 sc1
    v_mfma_f32_16x16x32_bf16 v[104:107], v[84:87], a[32:35], v[104:107]
    ds_read_b128 a[44:47], v184 offset:11264
    ds_read_b128 a[116:119], v184 offset:29696
    v_mfma_f32_16x16x32_bf16 v[108:111], v[76:79], a[96:99], v[108:111]
    buffer_load_dword v151, v3, s[8:11], s25 offen offset:1920 sc1
    v_mfma_f32_16x16x32_bf16 v[108:111], v[80:83], a[100:103], v[108:111]
    ds_read_b128 a[188:191], v11 offset:11264
    ds_read_b128 v[224:227], v11 offset:29696
    v_mfma_f32_16x16x32_bf16 v[108:111], v[84:87], a[104:107], v[108:111]
    buffer_load_dwordx4 v[68:71], v188, s[48:51], s23 offen offset:0 sc1
    v_mfma_f32_16x16x32_bf16 v[112:115], v[76:79], a[168:171], v[112:115]
    v_mfma_f32_16x16x32_bf16 v[112:115], v[80:83], a[172:175], v[112:115]
    v_mfma_f32_16x16x32_bf16 v[112:115], v[84:87], a[176:179], v[112:115]
    v_mfma_f32_16x16x32_bf16 v[116:119], v[76:79], a[240:243], v[116:119]
    buffer_load_dwordx4 v[72:75], v188, s[48:51], s23 offen offset:1024 sc1
    v_mfma_f32_16x16x32_bf16 v[116:119], v[80:83], a[244:247], v[116:119]
    v_mfma_f32_16x16x32_bf16 v[116:119], v[84:87], a[248:251], v[116:119]
    s_waitcnt vmcnt(28) lgkmcnt(0)
    s_barrier
    v_mfma_f32_16x16x32_bf16 v[88:91], v[16:19], a[36:39], v[88:91]
    ds_read_b128 a[48:51], v184 offset:12288
    v_mfma_f32_16x16x32_bf16 v[88:91], v[20:23], a[40:43], v[88:91]
    buffer_load_dwordx4 v[76:79], v188, s[48:51], s23 offen offset:2048 sc1
    v_mfma_f32_16x16x32_bf16 v[88:91], v[24:27], a[44:47], v[88:91]
    ds_read_b128 a[120:123], v184 offset:30720
    v_mfma_f32_16x16x32_bf16 v[92:95], v[16:19], a[108:111], v[92:95]
    ds_read_b128 a[192:195], v11 offset:12288
    v_mfma_f32_16x16x32_bf16 v[92:95], v[20:23], a[112:115], v[92:95]
    ds_read_b128 v[228:231], v11 offset:30720
    v_mfma_f32_16x16x32_bf16 v[92:95], v[24:27], a[116:119], v[92:95]
    buffer_load_dwordx4 v[80:83], v188, s[48:51], s23 offen offset:3072 sc1
    v_mfma_f32_16x16x32_bf16 v[96:99], v[16:19], a[180:183], v[96:99]
    ds_read_b128 a[52:55], v184 offset:13312
    v_mfma_f32_16x16x32_bf16 v[96:99], v[20:23], a[184:187], v[96:99]
    ds_read_b128 a[124:127], v184 offset:31744
    v_mfma_f32_16x16x32_bf16 v[96:99], v[24:27], a[188:191], v[96:99]
    v_mfma_f32_16x16x32_bf16 v[100:103], v[16:19], a[252:255], v[100:103]
    buffer_load_dwordx4 v[84:87], v189, s[48:51], s23 offen offset:0 sc1
    v_mfma_f32_16x16x32_bf16 v[100:103], v[20:23], v[220:223], v[100:103]
    ds_read_b128 a[196:199], v11 offset:13312
    ds_read_b128 v[232:235], v11 offset:31744
    v_mfma_f32_16x16x32_bf16 v[100:103], v[24:27], v[224:227], v[100:103]
    s_waitcnt vmcnt(25) lgkmcnt(8)
    v_mfma_f32_16x16x32_bf16 v[104:107], v[28:31], a[36:39], v[104:107]
    ds_read_b128 a[56:59], v184 offset:14336
    v_mfma_f32_16x16x32_bf16 v[104:107], v[32:35], a[40:43], v[104:107]
    buffer_load_dwordx4 v[16:19], v189, s[48:51], s23 offen offset:1024 sc1
    v_mfma_f32_16x16x32_bf16 v[104:107], v[36:39], a[44:47], v[104:107]
    ds_read_b128 a[128:131], v184 offset:32768
    v_mfma_f32_16x16x32_bf16 v[108:111], v[28:31], a[108:111], v[108:111]
    ds_read_b128 a[200:203], v11 offset:14336
    v_mfma_f32_16x16x32_bf16 v[108:111], v[32:35], a[112:115], v[108:111]
    ds_read_b128 v[236:239], v11 offset:32768
    v_mfma_f32_16x16x32_bf16 v[108:111], v[36:39], a[116:119], v[108:111]
    buffer_load_dwordx4 v[20:23], v189, s[48:51], s23 offen offset:2048 sc1
    v_mfma_f32_16x16x32_bf16 v[112:115], v[28:31], a[180:183], v[112:115]
    v_mfma_f32_16x16x32_bf16 v[112:115], v[32:35], a[184:187], v[112:115]
    v_mfma_f32_16x16x32_bf16 v[112:115], v[36:39], a[188:191], v[112:115]
    v_mfma_f32_16x16x32_bf16 v[116:119], v[28:31], a[252:255], v[116:119]
    buffer_load_dwordx4 v[24:27], v189, s[48:51], s23 offen offset:3072 sc1
    v_mfma_f32_16x16x32_bf16 v[116:119], v[32:35], v[220:223], v[116:119]
    v_mfma_f32_16x16x32_bf16 v[116:119], v[36:39], v[224:227], v[116:119]
    s_waitcnt vmcnt(8) lgkmcnt(0)
    v_mfma_f32_16x16x32_bf16 v[88:91], v[40:43], a[48:51], v[88:91]
    ds_read_b128 a[60:63], v184 offset:15360
    v_add_f32 v136, v136, v144
    v_mfma_f32_16x16x32_bf16 v[88:91], v[44:47], a[52:55], v[88:91]
    buffer_load_dwordx4 v[28:31], v190, s[48:51], s23 offen offset:0 sc1
    v_mfma_f32_16x16x32_bf16 v[88:91], v[48:51], a[56:59], v[88:91]
    ds_read_b128 a[132:135], v184 offset:33792
    v_add_f32 v137, v137, v145
    v_mfma_f32_16x16x32_bf16 v[92:95], v[40:43], a[120:123], v[92:95]
    ds_read_b128 a[204:207], v11 offset:15360
    v_add_f32 v138, v138, v146
    v_mfma_f32_16x16x32_bf16 v[92:95], v[44:47], a[124:127], v[92:95]
    ds_read_b128 v[240:243], v11 offset:33792
    v_add_f32 v139, v139, v147
    v_mfma_f32_16x16x32_bf16 v[92:95], v[48:51], a[128:131], v[92:95]
    buffer_load_dwordx4 v[32:35], v190, s[48:51], s23 offen offset:1024 sc1
    v_mfma_f32_16x16x32_bf16 v[96:99], v[40:43], a[192:195], v[96:99]
    ds_read_b128 a[64:67], v184 offset:16384
    v_add_f32 v140, v140, v148
    v_mfma_f32_16x16x32_bf16 v[96:99], v[44:47], a[196:199], v[96:99]
    ds_read_b128 a[136:139], v184 offset:34816
    v_add_f32 v141, v141, v149
    v_mfma_f32_16x16x32_bf16 v[96:99], v[48:51], a[200:203], v[96:99]
    v_add_f32 v142, v142, v150
    v_add_f32 v143, v143, v151
    v_mfma_f32_16x16x32_bf16 v[100:103], v[40:43], v[228:231], v[100:103]
    buffer_load_dwordx4 v[36:39], v190, s[48:51], s23 offen offset:2048 sc1
    v_mfma_f32_16x16x32_bf16 v[100:103], v[44:47], v[232:235], v[100:103]
    ds_read_b128 a[208:211], v11 offset:16384
    ds_read_b128 v[244:247], v11 offset:34816
    v_mfma_f32_16x16x32_bf16 v[100:103], v[48:51], v[236:239], v[100:103]
    v_add_f32 v136, v136, v140
    v_add_f32 v137, v137, v141
    s_waitcnt vmcnt(15) lgkmcnt(8)
    v_mfma_f32_16x16x32_bf16 v[104:107], v[52:55], a[48:51], v[104:107]
    ds_read_b128 a[68:71], v184 offset:17408
    v_add_f32 v138, v138, v142
    v_mfma_f32_16x16x32_bf16 v[104:107], v[56:59], a[52:55], v[104:107]
    buffer_load_dwordx4 v[40:43], v190, s[48:51], s23 offen offset:3072 sc1
    v_mfma_f32_16x16x32_bf16 v[104:107], v[60:63], a[56:59], v[104:107]
    ds_read_b128 a[140:143], v184 offset:35840
    v_add_f32 v139, v139, v143
    v_mfma_f32_16x16x32_bf16 v[108:111], v[52:55], a[120:123], v[108:111]
    ds_read_b128 a[212:215], v11 offset:17408
    v_add_f32 v136, v136, v138
    v_mfma_f32_16x16x32_bf16 v[108:111], v[56:59], a[124:127], v[108:111]
    ds_read_b128 v[248:251], v11 offset:35840
    v_add_f32 v137, v137, v139
    v_mfma_f32_16x16x32_bf16 v[108:111], v[60:63], a[128:131], v[108:111]
    buffer_load_dwordx4 v[44:47], v191, s[48:51], s23 offen offset:0 sc1
    v_mfma_f32_16x16x32_bf16 v[112:115], v[52:55], a[192:195], v[112:115]
    v_add_f32 v136, v136, v137
    v_mov_b32 v137, 0x3727c5ac
    v_mfma_f32_16x16x32_bf16 v[112:115], v[56:59], a[196:199], v[112:115]
    v_fmac_f32 v137, 0x3ae38e39, v136
    v_mov_b32 v193, v137
    v_mfma_f32_16x16x32_bf16 v[112:115], v[60:63], a[200:203], v[112:115]
    s_nop 0
    v_permlane16_swap_b32 v193, v137
    v_mfma_f32_16x16x32_bf16 v[116:119], v[52:55], v[228:231], v[116:119]
    buffer_load_dwordx4 v[48:51], v191, s[48:51], s23 offen offset:1024 sc1
    v_mfma_f32_16x16x32_bf16 v[116:119], v[56:59], v[232:235], v[116:119]
    v_mov_b32 v195, v193
    v_mov_b32 v194, v137
    v_mfma_f32_16x16x32_bf16 v[116:119], v[60:63], v[236:239], v[116:119]
    v_mov_b32 v252, v137
    s_waitcnt vmcnt(12) lgkmcnt(0)
    v_mfma_f32_16x16x32_bf16 v[88:91], v[64:67], a[60:63], v[88:91]
    s_nop 0
    v_permlane32_swap_b32 v193, v195
    v_mfma_f32_16x16x32_bf16 v[88:91], v[68:71], a[64:67], v[88:91]
    buffer_load_dwordx4 v[52:55], v191, s[48:51], s23 offen offset:2048 sc1
    v_mfma_f32_16x16x32_bf16 v[120:123], v[72:75], a[68:71], v[88:91]
    v_permlane32_swap_b32 v194, v252
    v_mfma_f32_16x16x32_bf16 v[92:95], v[64:67], a[132:135], v[92:95]
    v_rsq_f32 v4, v193
    v_mfma_f32_16x16x32_bf16 v[92:95], v[68:71], a[136:139], v[92:95]
    v_rsq_f32 v5, v194
    v_mfma_f32_16x16x32_bf16 v[124:127], v[72:75], a[140:143], v[92:95]
    buffer_load_dwordx4 v[56:59], v191, s[48:51], s23 offen offset:3072 sc1
    v_mfma_f32_16x16x32_bf16 v[96:99], v[64:67], a[204:207], v[96:99]
    v_rsq_f32 v6, v195
    v_mfma_f32_16x16x32_bf16 v[96:99], v[68:71], a[208:211], v[96:99]
    v_rsq_f32 v7, v252
    v_mfma_f32_16x16x32_bf16 v[128:131], v[72:75], a[212:215], v[96:99]
    v_mul_f32 v8, v4, v4
    v_mul_f32 v9, v5, v5
    v_mfma_f32_16x16x32_bf16 v[100:103], v[64:67], v[240:243], v[100:103]
    buffer_load_dwordx4 v[60:63], v192, s[48:51], s23 offen offset:0 sc1
    v_mfma_f32_16x16x32_bf16 v[100:103], v[68:71], v[244:247], v[100:103]
    v_mul_f32 v13, v6, v6
    v_mul_f32 v14, v7, v7
    v_mfma_f32_16x16x32_bf16 v[132:135], v[72:75], v[248:251], v[100:103]
    v_mul_f32 v4, 0xc0135761, v4
    v_mul_f32 v5, 0xc0135761, v5
    s_waitcnt vmcnt(12) lgkmcnt(0)
    v_mfma_f32_16x16x32_bf16 v[104:107], v[76:79], a[60:63], v[104:107]
    v_mul_f32 v6, 0xc0135761, v6
    v_mul_f32 v7, 0xc0135761, v7
    v_mfma_f32_16x16x32_bf16 v[104:107], v[80:83], a[64:67], v[104:107]
    buffer_load_dwordx4 v[64:67], v192, s[48:51], s23 offen offset:1024 sc1
    v_mfma_f32_16x16x32_bf16 v[136:139], v[84:87], a[68:71], v[104:107]
    v_mul_f32 v8, 0x3d372713, v8
    v_mul_f32 v9, 0x3d372713, v9
    v_mfma_f32_16x16x32_bf16 v[108:111], v[76:79], a[132:135], v[108:111]
    v_mul_f32 v13, 0x3d372713, v13
    v_mul_f32 v14, 0x3d372713, v14
    v_mfma_f32_16x16x32_bf16 v[108:111], v[80:83], a[136:139], v[108:111]
    v_mul_f32 v8, v8, v4
    v_mul_f32 v9, v9, v5
    v_mfma_f32_16x16x32_bf16 v[140:143], v[84:87], a[140:143], v[108:111]
    buffer_load_dwordx4 v[68:71], v192, s[48:51], s23 offen offset:2048 sc1
    v_mfma_f32_16x16x32_bf16 v[112:115], v[76:79], a[204:207], v[112:115]
    v_mul_f32 v13, v13, v6
    v_mul_f32 v14, v14, v7
    v_mfma_f32_16x16x32_bf16 v[112:115], v[80:83], a[208:211], v[112:115]
    s_mov_b32 s25, 0
    v_mfma_f32_16x16x32_bf16 v[144:147], v[84:87], a[212:215], v[112:115]
    s_mov_b32 s7, s28
    v_mfma_f32_16x16x32_bf16 v[116:119], v[76:79], v[240:243], v[116:119]
    buffer_load_dwordx4 v[72:75], v192, s[48:51], s23 offen offset:3072 sc1
    v_mfma_f32_16x16x32_bf16 v[116:119], v[80:83], v[244:247], v[116:119]
    s_add_u32 s23, s23, 36864
    v_mfma_f32_16x16x32_bf16 v[148:151], v[84:87], v[248:251], v[116:119]
    v_add_u32 v12, s7, v184
    s_add_u32 s25, s25, 1
L_ffn_gu_34:
    s_waitcnt vmcnt(12)
    v_mfma_f32_16x16x32_bf16 v[88:91], v[16:19], a[0:3], 0
    v_mfma_f32_16x16x32_bf16 v[88:91], v[20:23], a[4:7], v[88:91]
    buffer_load_dwordx4 v[76:79], v184, s[48:51], s23 offen offset:0 sc1
    v_mfma_f32_16x16x32_bf16 v[88:91], v[24:27], a[8:11], v[88:91]
    v_mul_f32 v152, v120, v120
    v_mul_f32 v153, v121, v121
    v_mfma_f32_16x16x32_bf16 v[92:95], v[16:19], a[72:75], 0
    v_mul_f32 v154, v122, v122
    v_mul_f32 v155, v123, v123
    v_mfma_f32_16x16x32_bf16 v[92:95], v[20:23], a[76:79], v[92:95]
    v_fma_f32 v152, v152, v8, v4
    v_fma_f32 v153, v153, v8, v4
    v_mfma_f32_16x16x32_bf16 v[92:95], v[24:27], a[80:83], v[92:95]
    buffer_load_dwordx4 v[80:83], v184, s[48:51], s23 offen offset:1024 sc1
    v_mfma_f32_16x16x32_bf16 v[96:99], v[16:19], a[144:147], 0
    v_fma_f32 v154, v154, v8, v4
    v_fma_f32 v155, v155, v8, v4
    v_mfma_f32_16x16x32_bf16 v[96:99], v[20:23], a[148:151], v[96:99]
    v_mul_f32 v152, v120, v152
    v_mul_f32 v153, v121, v153
    v_mfma_f32_16x16x32_bf16 v[96:99], v[24:27], a[152:155], v[96:99]
    v_mul_f32 v154, v122, v154
    v_mul_f32 v155, v123, v155
    v_mfma_f32_16x16x32_bf16 v[100:103], v[16:19], a[216:219], 0
    buffer_load_dwordx4 v[84:87], v184, s[48:51], s23 offen offset:2048 sc1
    v_mfma_f32_16x16x32_bf16 v[100:103], v[20:23], a[220:223], v[100:103]
    v_exp_f32 v152, v152
    v_mfma_f32_16x16x32_bf16 v[100:103], v[24:27], a[224:227], v[100:103]
    v_exp_f32 v153, v153
    s_waitcnt vmcnt(12)
    v_mfma_f32_16x16x32_bf16 v[104:107], v[28:31], a[0:3], 0
    v_exp_f32 v154, v154
    v_mfma_f32_16x16x32_bf16 v[104:107], v[32:35], a[4:7], v[104:107]
    buffer_load_dwordx4 v[16:19], v184, s[48:51], s23 offen offset:3072 sc1
    v_mfma_f32_16x16x32_bf16 v[104:107], v[36:39], a[8:11], v[104:107]
    v_exp_f32 v155, v155
    v_mfma_f32_16x16x32_bf16 v[108:111], v[28:31], a[72:75], 0
    v_mul_f32 v156, v120, v136
    v_mul_f32 v157, v121, v137
    v_mfma_f32_16x16x32_bf16 v[108:111], v[32:35], a[76:79], v[108:111]
    v_mul_f32 v158, v122, v138
    v_mul_f32 v159, v123, v139
    v_mfma_f32_16x16x32_bf16 v[108:111], v[36:39], a[80:83], v[108:111]
    buffer_load_dwordx4 v[20:23], v185, s[48:51], s23 offen offset:0 sc1
    v_mfma_f32_16x16x32_bf16 v[112:115], v[28:31], a[144:147], 0
    v_fma_f32 v152, v152, v193, v193
    v_fma_f32 v153, v153, v193, v193
    v_mfma_f32_16x16x32_bf16 v[112:115], v[32:35], a[148:151], v[112:115]
    v_fma_f32 v154, v154, v193, v193
    v_fma_f32 v155, v155, v193, v193
    v_mfma_f32_16x16x32_bf16 v[112:115], v[36:39], a[152:155], v[112:115]
    v_rcp_f32 v152, v152
    v_mfma_f32_16x16x32_bf16 v[116:119], v[28:31], a[216:219], 0
    buffer_load_dwordx4 v[24:27], v185, s[48:51], s23 offen offset:1024 sc1
    v_mfma_f32_16x16x32_bf16 v[116:119], v[32:35], a[220:223], v[116:119]
    v_rcp_f32 v153, v153
    v_mfma_f32_16x16x32_bf16 v[116:119], v[36:39], a[224:227], v[116:119]
    v_rcp_f32 v154, v154
    s_waitcnt vmcnt(12)
    v_mfma_f32_16x16x32_bf16 v[88:91], v[40:43], a[12:15], v[88:91]
    v_rcp_f32 v155, v155
    v_mfma_f32_16x16x32_bf16 v[88:91], v[44:47], a[16:19], v[88:91]
    buffer_load_dwordx4 v[28:31], v185, s[48:51], s23 offen offset:2048 sc1
    v_mfma_f32_16x16x32_bf16 v[88:91], v[48:51], a[20:23], v[88:91]
    v_mul_f32 v156, v156, v152
    v_mul_f32 v157, v157, v153
    v_mfma_f32_16x16x32_bf16 v[92:95], v[40:43], a[84:87], v[92:95]
    v_mul_f32 v158, v158, v154
    v_mul_f32 v159, v159, v155
    v_mfma_f32_16x16x32_bf16 v[92:95], v[44:47], a[88:91], v[92:95]
    v_cvt_pk_bf16_f32 v160, v156, v157
    v_cvt_pk_bf16_f32 v161, v158, v159
    v_mfma_f32_16x16x32_bf16 v[92:95], v[48:51], a[92:95], v[92:95]
    buffer_load_dwordx4 v[32:35], v185, s[48:51], s23 offen offset:3072 sc1
    v_mfma_f32_16x16x32_bf16 v[96:99], v[40:43], a[156:159], v[96:99]
    ds_write_b64 v12, v[160:161] offset:0
    v_mfma_f32_16x16x32_bf16 v[96:99], v[44:47], a[160:163], v[96:99]
    v_mul_f32 v162, v124, v124
    v_mul_f32 v163, v125, v125
    v_mfma_f32_16x16x32_bf16 v[96:99], v[48:51], a[164:167], v[96:99]
    v_mul_f32 v164, v126, v126
    v_mul_f32 v165, v127, v127
    v_mfma_f32_16x16x32_bf16 v[100:103], v[40:43], a[228:231], v[100:103]
    buffer_load_dwordx4 v[36:39], v186, s[48:51], s23 offen offset:0 sc1
    v_mfma_f32_16x16x32_bf16 v[100:103], v[44:47], a[232:235], v[100:103]
    v_fma_f32 v162, v162, v9, v5
    v_fma_f32 v163, v163, v9, v5
    v_mfma_f32_16x16x32_bf16 v[100:103], v[48:51], a[236:239], v[100:103]
    v_fma_f32 v164, v164, v9, v5
    v_fma_f32 v165, v165, v9, v5
    s_waitcnt vmcnt(12)
    v_mfma_f32_16x16x32_bf16 v[104:107], v[52:55], a[12:15], v[104:107]
    v_mul_f32 v162, v124, v162
    v_mul_f32 v163, v125, v163
    v_mfma_f32_16x16x32_bf16 v[104:107], v[56:59], a[16:19], v[104:107]
    buffer_load_dwordx4 v[40:43], v186, s[48:51], s23 offen offset:1024 sc1
    v_mfma_f32_16x16x32_bf16 v[104:107], v[60:63], a[20:23], v[104:107]
    v_mul_f32 v164, v126, v164
    v_mul_f32 v165, v127, v165
    v_mfma_f32_16x16x32_bf16 v[108:111], v[52:55], a[84:87], v[108:111]
    v_exp_f32 v162, v162
    v_mfma_f32_16x16x32_bf16 v[108:111], v[56:59], a[88:91], v[108:111]
    v_exp_f32 v163, v163
    v_mfma_f32_16x16x32_bf16 v[108:111], v[60:63], a[92:95], v[108:111]
    buffer_load_dwordx4 v[44:47], v186, s[48:51], s23 offen offset:2048 sc1
    v_mfma_f32_16x16x32_bf16 v[112:115], v[52:55], a[156:159], v[112:115]
    v_exp_f32 v164, v164
    v_mfma_f32_16x16x32_bf16 v[112:115], v[56:59], a[160:163], v[112:115]
    v_exp_f32 v165, v165
    v_mfma_f32_16x16x32_bf16 v[112:115], v[60:63], a[164:167], v[112:115]
    v_mul_f32 v166, v124, v140
    v_mul_f32 v167, v125, v141
    v_mfma_f32_16x16x32_bf16 v[116:119], v[52:55], a[228:231], v[116:119]
    buffer_load_dwordx4 v[48:51], v186, s[48:51], s23 offen offset:3072 sc1
    v_mfma_f32_16x16x32_bf16 v[116:119], v[56:59], a[232:235], v[116:119]
    v_mul_f32 v168, v126, v142
    v_mul_f32 v169, v127, v143
    v_mfma_f32_16x16x32_bf16 v[116:119], v[60:63], a[236:239], v[116:119]
    v_fma_f32 v162, v162, v194, v194
    v_fma_f32 v163, v163, v194, v194
    s_waitcnt vmcnt(12)
    v_mfma_f32_16x16x32_bf16 v[88:91], v[64:67], a[24:27], v[88:91]
    v_fma_f32 v164, v164, v194, v194
    v_fma_f32 v165, v165, v194, v194
    v_mfma_f32_16x16x32_bf16 v[88:91], v[68:71], a[28:31], v[88:91]
    buffer_load_dwordx4 v[52:55], v187, s[48:51], s23 offen offset:0 sc1
    v_mfma_f32_16x16x32_bf16 v[88:91], v[72:75], a[32:35], v[88:91]
    v_rcp_f32 v162, v162
    v_mfma_f32_16x16x32_bf16 v[92:95], v[64:67], a[96:99], v[92:95]
    v_rcp_f32 v163, v163
    v_mfma_f32_16x16x32_bf16 v[92:95], v[68:71], a[100:103], v[92:95]
    v_rcp_f32 v164, v164
    v_mfma_f32_16x16x32_bf16 v[92:95], v[72:75], a[104:107], v[92:95]
    buffer_load_dwordx4 v[56:59], v187, s[48:51], s23 offen offset:1024 sc1
    v_mfma_f32_16x16x32_bf16 v[96:99], v[64:67], a[168:171], v[96:99]
    v_rcp_f32 v165, v165
    v_mfma_f32_16x16x32_bf16 v[96:99], v[68:71], a[172:175], v[96:99]
    v_mul_f32 v166, v166, v162
    v_mul_f32 v167, v167, v163
    v_mfma_f32_16x16x32_bf16 v[96:99], v[72:75], a[176:179], v[96:99]
    v_mul_f32 v168, v168, v164
    v_mul_f32 v169, v169, v165
    v_mfma_f32_16x16x32_bf16 v[100:103], v[64:67], a[240:243], v[100:103]
    buffer_load_dwordx4 v[60:63], v187, s[48:51], s23 offen offset:2048 sc1
    v_mfma_f32_16x16x32_bf16 v[100:103], v[68:71], a[244:247], v[100:103]
    v_cvt_pk_bf16_f32 v170, v166, v167
    v_cvt_pk_bf16_f32 v171, v168, v169
    v_mfma_f32_16x16x32_bf16 v[100:103], v[72:75], a[248:251], v[100:103]
    ds_write_b64 v12, v[170:171] offset:18432
    s_waitcnt vmcnt(12)
    v_mfma_f32_16x16x32_bf16 v[104:107], v[76:79], a[24:27], v[104:107]
    v_mul_f32 v152, v128, v128
    v_mul_f32 v153, v129, v129
    v_mfma_f32_16x16x32_bf16 v[104:107], v[80:83], a[28:31], v[104:107]
    buffer_load_dwordx4 v[64:67], v187, s[48:51], s23 offen offset:3072 sc1
    v_mfma_f32_16x16x32_bf16 v[104:107], v[84:87], a[32:35], v[104:107]
    v_mul_f32 v154, v130, v130
    v_mul_f32 v155, v131, v131
    v_mfma_f32_16x16x32_bf16 v[108:111], v[76:79], a[96:99], v[108:111]
    v_fma_f32 v152, v152, v13, v6
    v_fma_f32 v153, v153, v13, v6
    v_mfma_f32_16x16x32_bf16 v[108:111], v[80:83], a[100:103], v[108:111]
    v_fma_f32 v154, v154, v13, v6
    v_fma_f32 v155, v155, v13, v6
    v_mfma_f32_16x16x32_bf16 v[108:111], v[84:87], a[104:107], v[108:111]
    buffer_load_dwordx4 v[68:71], v188, s[48:51], s23 offen offset:0 sc1
    v_mfma_f32_16x16x32_bf16 v[112:115], v[76:79], a[168:171], v[112:115]
    v_mul_f32 v152, v128, v152
    v_mul_f32 v153, v129, v153
    v_mfma_f32_16x16x32_bf16 v[112:115], v[80:83], a[172:175], v[112:115]
    v_mul_f32 v154, v130, v154
    v_mul_f32 v155, v131, v155
    v_mfma_f32_16x16x32_bf16 v[112:115], v[84:87], a[176:179], v[112:115]
    v_exp_f32 v152, v152
    v_mfma_f32_16x16x32_bf16 v[116:119], v[76:79], a[240:243], v[116:119]
    buffer_load_dwordx4 v[72:75], v188, s[48:51], s23 offen offset:1024 sc1
    v_mfma_f32_16x16x32_bf16 v[116:119], v[80:83], a[244:247], v[116:119]
    v_exp_f32 v153, v153
    v_mfma_f32_16x16x32_bf16 v[116:119], v[84:87], a[248:251], v[116:119]
    v_exp_f32 v154, v154
    s_waitcnt vmcnt(12)
    v_mfma_f32_16x16x32_bf16 v[88:91], v[16:19], a[36:39], v[88:91]
    v_exp_f32 v155, v155
    v_mfma_f32_16x16x32_bf16 v[88:91], v[20:23], a[40:43], v[88:91]
    buffer_load_dwordx4 v[76:79], v188, s[48:51], s23 offen offset:2048 sc1
    v_mfma_f32_16x16x32_bf16 v[88:91], v[24:27], a[44:47], v[88:91]
    v_mul_f32 v156, v128, v144
    v_mul_f32 v157, v129, v145
    v_mfma_f32_16x16x32_bf16 v[92:95], v[16:19], a[108:111], v[92:95]
    v_mul_f32 v158, v130, v146
    v_mul_f32 v159, v131, v147
    v_mfma_f32_16x16x32_bf16 v[92:95], v[20:23], a[112:115], v[92:95]
    v_fma_f32 v152, v152, v195, v195
    v_fma_f32 v153, v153, v195, v195
    v_mfma_f32_16x16x32_bf16 v[92:95], v[24:27], a[116:119], v[92:95]
    buffer_load_dwordx4 v[80:83], v188, s[48:51], s23 offen offset:3072 sc1
    v_mfma_f32_16x16x32_bf16 v[96:99], v[16:19], a[180:183], v[96:99]
    v_fma_f32 v154, v154, v195, v195
    v_fma_f32 v155, v155, v195, v195
    v_mfma_f32_16x16x32_bf16 v[96:99], v[20:23], a[184:187], v[96:99]
    v_rcp_f32 v152, v152
    v_mfma_f32_16x16x32_bf16 v[96:99], v[24:27], a[188:191], v[96:99]
    v_rcp_f32 v153, v153
    v_mfma_f32_16x16x32_bf16 v[100:103], v[16:19], a[252:255], v[100:103]
    buffer_load_dwordx4 v[84:87], v189, s[48:51], s23 offen offset:0 sc1
    v_mfma_f32_16x16x32_bf16 v[100:103], v[20:23], v[220:223], v[100:103]
    v_rcp_f32 v154, v154
    v_mfma_f32_16x16x32_bf16 v[100:103], v[24:27], v[224:227], v[100:103]
    v_rcp_f32 v155, v155
    s_waitcnt vmcnt(12)
    v_mfma_f32_16x16x32_bf16 v[104:107], v[28:31], a[36:39], v[104:107]
    v_mul_f32 v156, v156, v152
    v_mul_f32 v157, v157, v153
    v_mfma_f32_16x16x32_bf16 v[104:107], v[32:35], a[40:43], v[104:107]
    buffer_load_dwordx4 v[16:19], v189, s[48:51], s23 offen offset:1024 sc1
    v_mfma_f32_16x16x32_bf16 v[104:107], v[36:39], a[44:47], v[104:107]
    v_mul_f32 v158, v158, v154
    v_mul_f32 v159, v159, v155
    v_mfma_f32_16x16x32_bf16 v[108:111], v[28:31], a[108:111], v[108:111]
    v_cvt_pk_bf16_f32 v160, v156, v157
    v_cvt_pk_bf16_f32 v161, v158, v159
    v_mfma_f32_16x16x32_bf16 v[108:111], v[32:35], a[112:115], v[108:111]
    ds_write_b64 v12, v[160:161] offset:36864
    v_mfma_f32_16x16x32_bf16 v[108:111], v[36:39], a[116:119], v[108:111]
    buffer_load_dwordx4 v[20:23], v189, s[48:51], s23 offen offset:2048 sc1
    v_mfma_f32_16x16x32_bf16 v[112:115], v[28:31], a[180:183], v[112:115]
    v_mul_f32 v162, v132, v132
    v_mul_f32 v163, v133, v133
    v_mfma_f32_16x16x32_bf16 v[112:115], v[32:35], a[184:187], v[112:115]
    v_mul_f32 v164, v134, v134
    v_mul_f32 v165, v135, v135
    v_mfma_f32_16x16x32_bf16 v[112:115], v[36:39], a[188:191], v[112:115]
    v_fma_f32 v162, v162, v14, v7
    v_fma_f32 v163, v163, v14, v7
    v_mfma_f32_16x16x32_bf16 v[116:119], v[28:31], a[252:255], v[116:119]
    buffer_load_dwordx4 v[24:27], v189, s[48:51], s23 offen offset:3072 sc1
    v_mfma_f32_16x16x32_bf16 v[116:119], v[32:35], v[220:223], v[116:119]
    v_fma_f32 v164, v164, v14, v7
    v_fma_f32 v165, v165, v14, v7
    v_mfma_f32_16x16x32_bf16 v[116:119], v[36:39], v[224:227], v[116:119]
    v_mul_f32 v162, v132, v162
    v_mul_f32 v163, v133, v163
    s_waitcnt vmcnt(12)
    v_mfma_f32_16x16x32_bf16 v[88:91], v[40:43], a[48:51], v[88:91]
    v_mul_f32 v164, v134, v164
    v_mul_f32 v165, v135, v165
    v_mfma_f32_16x16x32_bf16 v[88:91], v[44:47], a[52:55], v[88:91]
    buffer_load_dwordx4 v[28:31], v190, s[48:51], s23 offen offset:0 sc1
    v_mfma_f32_16x16x32_bf16 v[88:91], v[48:51], a[56:59], v[88:91]
    v_exp_f32 v162, v162
    v_mfma_f32_16x16x32_bf16 v[92:95], v[40:43], a[120:123], v[92:95]
    v_exp_f32 v163, v163
    v_mfma_f32_16x16x32_bf16 v[92:95], v[44:47], a[124:127], v[92:95]
    v_exp_f32 v164, v164
    v_mfma_f32_16x16x32_bf16 v[92:95], v[48:51], a[128:131], v[92:95]
    buffer_load_dwordx4 v[32:35], v190, s[48:51], s23 offen offset:1024 sc1
    v_mfma_f32_16x16x32_bf16 v[96:99], v[40:43], a[192:195], v[96:99]
    v_exp_f32 v165, v165
    v_mfma_f32_16x16x32_bf16 v[96:99], v[44:47], a[196:199], v[96:99]
    v_mul_f32 v166, v132, v148
    v_mul_f32 v167, v133, v149
    v_mfma_f32_16x16x32_bf16 v[96:99], v[48:51], a[200:203], v[96:99]
    v_mul_f32 v168, v134, v150
    v_mul_f32 v169, v135, v151
    v_mfma_f32_16x16x32_bf16 v[100:103], v[40:43], v[228:231], v[100:103]
    buffer_load_dwordx4 v[36:39], v190, s[48:51], s23 offen offset:2048 sc1
    v_mfma_f32_16x16x32_bf16 v[100:103], v[44:47], v[232:235], v[100:103]
    v_fma_f32 v162, v162, v252, v252
    v_fma_f32 v163, v163, v252, v252
    v_mfma_f32_16x16x32_bf16 v[100:103], v[48:51], v[236:239], v[100:103]
    v_fma_f32 v164, v164, v252, v252
    v_fma_f32 v165, v165, v252, v252
    s_waitcnt vmcnt(12)
    v_mfma_f32_16x16x32_bf16 v[104:107], v[52:55], a[48:51], v[104:107]
    v_rcp_f32 v162, v162
    v_mfma_f32_16x16x32_bf16 v[104:107], v[56:59], a[52:55], v[104:107]
    buffer_load_dwordx4 v[40:43], v190, s[48:51], s23 offen offset:3072 sc1
    v_mfma_f32_16x16x32_bf16 v[104:107], v[60:63], a[56:59], v[104:107]
    v_rcp_f32 v163, v163
    v_mfma_f32_16x16x32_bf16 v[108:111], v[52:55], a[120:123], v[108:111]
    v_rcp_f32 v164, v164
    v_mfma_f32_16x16x32_bf16 v[108:111], v[56:59], a[124:127], v[108:111]
    v_rcp_f32 v165, v165
    v_mfma_f32_16x16x32_bf16 v[108:111], v[60:63], a[128:131], v[108:111]
    buffer_load_dwordx4 v[44:47], v191, s[48:51], s23 offen offset:0 sc1
    v_mfma_f32_16x16x32_bf16 v[112:115], v[52:55], a[192:195], v[112:115]
    v_mul_f32 v166, v166, v162
    v_mul_f32 v167, v167, v163
    v_mfma_f32_16x16x32_bf16 v[112:115], v[56:59], a[196:199], v[112:115]
    v_mul_f32 v168, v168, v164
    v_mul_f32 v169, v169, v165
    v_mfma_f32_16x16x32_bf16 v[112:115], v[60:63], a[200:203], v[112:115]
    v_cvt_pk_bf16_f32 v170, v166, v167
    v_cvt_pk_bf16_f32 v171, v168, v169
    v_mfma_f32_16x16x32_bf16 v[116:119], v[52:55], v[228:231], v[116:119]
    buffer_load_dwordx4 v[48:51], v191, s[48:51], s23 offen offset:1024 sc1
    v_mfma_f32_16x16x32_bf16 v[116:119], v[56:59], v[232:235], v[116:119]
    ds_write_b64 v12, v[170:171] offset:55296
    v_mfma_f32_16x16x32_bf16 v[116:119], v[60:63], v[236:239], v[116:119]
    s_waitcnt vmcnt(12)
    v_mfma_f32_16x16x32_bf16 v[88:91], v[64:67], a[60:63], v[88:91]
    v_mfma_f32_16x16x32_bf16 v[88:91], v[68:71], a[64:67], v[88:91]
    buffer_load_dwordx4 v[52:55], v191, s[48:51], s23 offen offset:2048 sc1
    v_mfma_f32_16x16x32_bf16 v[120:123], v[72:75], a[68:71], v[88:91]
    v_mfma_f32_16x16x32_bf16 v[92:95], v[64:67], a[132:135], v[92:95]
    v_mfma_f32_16x16x32_bf16 v[92:95], v[68:71], a[136:139], v[92:95]
    v_mfma_f32_16x16x32_bf16 v[124:127], v[72:75], a[140:143], v[92:95]
    buffer_load_dwordx4 v[56:59], v191, s[48:51], s23 offen offset:3072 sc1
    v_mfma_f32_16x16x32_bf16 v[96:99], v[64:67], a[204:207], v[96:99]
    v_mfma_f32_16x16x32_bf16 v[96:99], v[68:71], a[208:211], v[96:99]
    v_mfma_f32_16x16x32_bf16 v[128:131], v[72:75], a[212:215], v[96:99]
    v_mfma_f32_16x16x32_bf16 v[100:103], v[64:67], v[240:243], v[100:103]
    buffer_load_dwordx4 v[60:63], v192, s[48:51], s23 offen offset:0 sc1
    v_mfma_f32_16x16x32_bf16 v[100:103], v[68:71], v[244:247], v[100:103]
    v_mfma_f32_16x16x32_bf16 v[132:135], v[72:75], v[248:251], v[100:103]
    s_waitcnt vmcnt(12)
    v_mfma_f32_16x16x32_bf16 v[104:107], v[76:79], a[60:63], v[104:107]
    v_mfma_f32_16x16x32_bf16 v[104:107], v[80:83], a[64:67], v[104:107]
    buffer_load_dwordx4 v[64:67], v192, s[48:51], s23 offen offset:1024 sc1
    v_mfma_f32_16x16x32_bf16 v[136:139], v[84:87], a[68:71], v[104:107]
    v_mfma_f32_16x16x32_bf16 v[108:111], v[76:79], a[132:135], v[108:111]
    v_mfma_f32_16x16x32_bf16 v[108:111], v[80:83], a[136:139], v[108:111]
    v_mfma_f32_16x16x32_bf16 v[140:143], v[84:87], a[140:143], v[108:111]
    buffer_load_dwordx4 v[68:71], v192, s[48:51], s23 offen offset:2048 sc1
    v_mfma_f32_16x16x32_bf16 v[112:115], v[76:79], a[204:207], v[112:115]
    v_mfma_f32_16x16x32_bf16 v[112:115], v[80:83], a[208:211], v[112:115]
    s_lshl_b32 s7, s25, 11
    v_mfma_f32_16x16x32_bf16 v[144:147], v[84:87], a[212:215], v[112:115]
    s_add_u32 s7, s7, s28
    v_mfma_f32_16x16x32_bf16 v[116:119], v[76:79], v[240:243], v[116:119]
    buffer_load_dwordx4 v[72:75], v192, s[48:51], s23 offen offset:3072 sc1
    v_mfma_f32_16x16x32_bf16 v[116:119], v[80:83], v[244:247], v[116:119]
    s_add_u32 s23, s23, 36864
    v_mfma_f32_16x16x32_bf16 v[148:151], v[84:87], v[248:251], v[116:119]
    v_add_u32 v12, s7, v184
    s_add_u32 s25, s25, 1
    s_cmp_lt_u32 s25, 8
    s_cbranch_scc1 L_ffn_gu_34
    v_add_u32 v10, 73728, v184
    v_add_u32 v11, 110592, v184
    s_lshr_b32 s7, s2, 3
    s_lshl_b32 s7, s7, 2
    s_add_u32 s7, s7, s3
    s_lshl_b32 s7, s7, 9
    v_lshrrev_b32 v1, 1, v253
    v_add_u32 v1, s7, v1
    buffer_load_dwordx2 v[2:3], v1, s[96:99], 0 offen
    s_waitcnt lgkmcnt(0)
    s_barrier
    s_waitcnt vmcnt(12)
    v_mfma_f32_16x16x32_bf16 v[88:91], v[16:19], a[0:3], 0
    v_mfma_f32_16x16x32_bf16 v[88:91], v[20:23], a[4:7], v[88:91]
    buffer_load_dwordx4 v[76:79], v184, s[48:51], s23 offen offset:0 sc1
    v_mfma_f32_16x16x32_bf16 v[88:91], v[24:27], a[8:11], v[88:91]
    v_mul_f32 v152, v120, v120
    v_mul_f32 v153, v121, v121
    v_mfma_f32_16x16x32_bf16 v[92:95], v[16:19], a[72:75], 0
    v_mul_f32 v154, v122, v122
    v_mul_f32 v155, v123, v123
    v_mfma_f32_16x16x32_bf16 v[92:95], v[20:23], a[76:79], v[92:95]
    v_fma_f32 v152, v152, v8, v4
    v_fma_f32 v153, v153, v8, v4
    v_mfma_f32_16x16x32_bf16 v[92:95], v[24:27], a[80:83], v[92:95]
    buffer_load_dwordx4 v[80:83], v184, s[48:51], s23 offen offset:1024 sc1
    v_mfma_f32_16x16x32_bf16 v[96:99], v[16:19], a[144:147], 0
    v_fma_f32 v154, v154, v8, v4
    v_fma_f32 v155, v155, v8, v4
    v_mfma_f32_16x16x32_bf16 v[96:99], v[20:23], a[148:151], v[96:99]
    v_mul_f32 v152, v120, v152
    v_mul_f32 v153, v121, v153
    v_mfma_f32_16x16x32_bf16 v[96:99], v[24:27], a[152:155], v[96:99]
    v_mul_f32 v154, v122, v154
    v_mul_f32 v155, v123, v155
    v_mfma_f32_16x16x32_bf16 v[100:103], v[16:19], a[216:219], 0
    buffer_load_dwordx4 v[84:87], v184, s[48:51], s23 offen offset:2048 sc1
    v_mfma_f32_16x16x32_bf16 v[100:103], v[20:23], a[220:223], v[100:103]
    v_exp_f32 v152, v152
    v_mfma_f32_16x16x32_bf16 v[100:103], v[24:27], a[224:227], v[100:103]
    v_exp_f32 v153, v153
    s_waitcnt vmcnt(12)
    v_mfma_f32_16x16x32_bf16 v[104:107], v[28:31], a[0:3], 0
    v_exp_f32 v154, v154
    ds_read_b128 a[0:3], v10 offset:0
    v_mfma_f32_16x16x32_bf16 v[104:107], v[32:35], a[4:7], v[104:107]
    buffer_load_dwordx4 v[16:19], v184, s[48:51], s23 offen offset:3072 sc1
    v_mfma_f32_16x16x32_bf16 v[104:107], v[36:39], a[8:11], v[104:107]
    v_exp_f32 v155, v155
    v_mfma_f32_16x16x32_bf16 v[108:111], v[28:31], a[72:75], 0
    v_mul_f32 v156, v120, v136
    v_mul_f32 v157, v121, v137
    ds_read_b128 a[72:75], v10 offset:18432
    v_mfma_f32_16x16x32_bf16 v[108:111], v[32:35], a[76:79], v[108:111]
    v_mul_f32 v158, v122, v138
    v_mul_f32 v159, v123, v139
    v_mfma_f32_16x16x32_bf16 v[108:111], v[36:39], a[80:83], v[108:111]
    buffer_load_dwordx4 v[20:23], v185, s[48:51], s23 offen offset:0 sc1
    v_mfma_f32_16x16x32_bf16 v[112:115], v[28:31], a[144:147], 0
    v_fma_f32 v152, v152, v193, v193
    v_fma_f32 v153, v153, v193, v193
    ds_read_b128 a[144:147], v11 offset:0
    v_mfma_f32_16x16x32_bf16 v[112:115], v[32:35], a[148:151], v[112:115]
    v_fma_f32 v154, v154, v193, v193
    v_fma_f32 v155, v155, v193, v193
    v_mfma_f32_16x16x32_bf16 v[112:115], v[36:39], a[152:155], v[112:115]
    v_rcp_f32 v152, v152
    v_mfma_f32_16x16x32_bf16 v[116:119], v[28:31], a[216:219], 0
    buffer_load_dwordx4 v[24:27], v185, s[48:51], s23 offen offset:1024 sc1
    v_mfma_f32_16x16x32_bf16 v[116:119], v[32:35], a[220:223], v[116:119]
    v_rcp_f32 v153, v153
    ds_read_b128 a[216:219], v11 offset:18432
    v_mfma_f32_16x16x32_bf16 v[116:119], v[36:39], a[224:227], v[116:119]
    v_rcp_f32 v154, v154
    ds_read_b128 a[4:7], v10 offset:1024
    s_waitcnt vmcnt(12)
    v_mfma_f32_16x16x32_bf16 v[88:91], v[40:43], a[12:15], v[88:91]
    v_rcp_f32 v155, v155
    ds_read_b128 a[76:79], v10 offset:19456
    v_mfma_f32_16x16x32_bf16 v[88:91], v[44:47], a[16:19], v[88:91]
    buffer_load_dwordx4 v[28:31], v185, s[48:51], s23 offen offset:2048 sc1
    v_mfma_f32_16x16x32_bf16 v[88:91], v[48:51], a[20:23], v[88:91]
    v_mul_f32 v156, v156, v152
    v_mul_f32 v157, v157, v153
    ds_read_b128 a[148:151], v11 offset:1024
    v_mfma_f32_16x16x32_bf16 v[92:95], v[40:43], a[84:87], v[92:95]
    v_mul_f32 v158, v158, v154
    v_mul_f32 v159, v159, v155
    ds_read_b128 a[220:223], v11 offset:19456
    v_mfma_f32_16x16x32_bf16 v[92:95], v[44:47], a[88:91], v[92:95]
    v_cvt_pk_bf16_f32 v160, v156, v157
    v_cvt_pk_bf16_f32 v161, v158, v159
    ds_read_b128 a[8:11], v10 offset:2048
    v_mfma_f32_16x16x32_bf16 v[92:95], v[48:51], a[92:95], v[92:95]
    buffer_load_dwordx4 v[32:35], v185, s[48:51], s23 offen offset:3072 sc1
    v_mfma_f32_16x16x32_bf16 v[96:99], v[40:43], a[156:159], v[96:99]
    ds_write_b64 v12, v[160:161] offset:0
    v_mfma_f32_16x16x32_bf16 v[96:99], v[44:47], a[160:163], v[96:99]
    v_mul_f32 v162, v124, v124
    v_mul_f32 v163, v125, v125
    ds_read_b128 a[80:83], v10 offset:20480
    v_mfma_f32_16x16x32_bf16 v[96:99], v[48:51], a[164:167], v[96:99]
    v_mul_f32 v164, v126, v126
    v_mul_f32 v165, v127, v127
    ds_read_b128 a[152:155], v11 offset:2048
    v_mfma_f32_16x16x32_bf16 v[100:103], v[40:43], a[228:231], v[100:103]
    buffer_load_dwordx4 v[36:39], v186, s[48:51], s23 offen offset:0 sc1
    v_mfma_f32_16x16x32_bf16 v[100:103], v[44:47], a[232:235], v[100:103]
    v_fma_f32 v162, v162, v9, v5
    v_fma_f32 v163, v163, v9, v5
    ds_read_b128 a[224:227], v11 offset:20480
    v_mfma_f32_16x16x32_bf16 v[100:103], v[48:51], a[236:239], v[100:103]
    v_fma_f32 v164, v164, v9, v5
    v_fma_f32 v165, v165, v9, v5
    s_waitcnt vmcnt(12)
    v_mfma_f32_16x16x32_bf16 v[104:107], v[52:55], a[12:15], v[104:107]
    v_mul_f32 v162, v124, v162
    v_mul_f32 v163, v125, v163
    ds_read_b128 a[12:15], v10 offset:3072
    v_mfma_f32_16x16x32_bf16 v[104:107], v[56:59], a[16:19], v[104:107]
    buffer_load_dwordx4 v[40:43], v186, s[48:51], s23 offen offset:1024 sc1
    v_mfma_f32_16x16x32_bf16 v[104:107], v[60:63], a[20:23], v[104:107]
    v_mul_f32 v164, v126, v164
    v_mul_f32 v165, v127, v165
    v_mfma_f32_16x16x32_bf16 v[108:111], v[52:55], a[84:87], v[108:111]
    v_exp_f32 v162, v162
    ds_read_b128 a[84:87], v10 offset:21504
    v_mfma_f32_16x16x32_bf16 v[108:111], v[56:59], a[88:91], v[108:111]
    v_exp_f32 v163, v163
    v_mfma_f32_16x16x32_bf16 v[108:111], v[60:63], a[92:95], v[108:111]
    buffer_load_dwordx4 v[44:47], v186, s[48:51], s23 offen offset:2048 sc1
    v_mfma_f32_16x16x32_bf16 v[112:115], v[52:55], a[156:159], v[112:115]
    v_exp_f32 v164, v164
    ds_read_b128 a[156:159], v11 offset:3072
    v_mfma_f32_16x16x32_bf16 v[112:115], v[56:59], a[160:163], v[112:115]
    v_exp_f32 v165, v165
    v_mfma_f32_16x16x32_bf16 v[112:115], v[60:63], a[164:167], v[112:115]
    v_mul_f32 v166, v124, v140
    v_mul_f32 v167, v125, v141
    v_mfma_f32_16x16x32_bf16 v[116:119], v[52:55], a[228:231], v[116:119]
    buffer_load_dwordx4 v[48:51], v186, s[48:51], s23 offen offset:3072 sc1
    v_mfma_f32_16x16x32_bf16 v[116:119], v[56:59], a[232:235], v[116:119]
    v_mul_f32 v168, v126, v142
    v_mul_f32 v169, v127, v143
    ds_read_b128 a[228:231], v11 offset:21504
    v_mfma_f32_16x16x32_bf16 v[116:119], v[60:63], a[236:239], v[116:119]
    v_fma_f32 v162, v162, v194, v194
    v_fma_f32 v163, v163, v194, v194
    ds_read_b128 a[16:19], v10 offset:4096
    s_waitcnt vmcnt(12)
    v_mfma_f32_16x16x32_bf16 v[88:91], v[64:67], a[24:27], v[88:91]
    v_fma_f32 v164, v164, v194, v194
    v_fma_f32 v165, v165, v194, v194
    ds_read_b128 a[88:91], v10 offset:22528
    v_mfma_f32_16x16x32_bf16 v[88:91], v[68:71], a[28:31], v[88:91]
    buffer_load_dwordx4 v[52:55], v187, s[48:51], s23 offen offset:0 sc1
    v_mfma_f32_16x16x32_bf16 v[88:91], v[72:75], a[32:35], v[88:91]
    v_rcp_f32 v162, v162
    ds_read_b128 a[160:163], v11 offset:4096
    v_mfma_f32_16x16x32_bf16 v[92:95], v[64:67], a[96:99], v[92:95]
    v_rcp_f32 v163, v163
    ds_read_b128 a[232:235], v11 offset:22528
    v_mfma_f32_16x16x32_bf16 v[92:95], v[68:71], a[100:103], v[92:95]
    v_rcp_f32 v164, v164
    ds_read_b128 a[20:23], v10 offset:5120
    v_mfma_f32_16x16x32_bf16 v[92:95], v[72:75], a[104:107], v[92:95]
    buffer_load_dwordx4 v[56:59], v187, s[48:51], s23 offen offset:1024 sc1
    v_mfma_f32_16x16x32_bf16 v[96:99], v[64:67], a[168:171], v[96:99]
    v_rcp_f32 v165, v165
    ds_read_b128 a[92:95], v10 offset:23552
    v_mfma_f32_16x16x32_bf16 v[96:99], v[68:71], a[172:175], v[96:99]
    v_mul_f32 v166, v166, v162
    v_mul_f32 v167, v167, v163
    ds_read_b128 a[164:167], v11 offset:5120
    v_mfma_f32_16x16x32_bf16 v[96:99], v[72:75], a[176:179], v[96:99]
    v_mul_f32 v168, v168, v164
    v_mul_f32 v169, v169, v165
    ds_read_b128 a[236:239], v11 offset:23552
    v_mfma_f32_16x16x32_bf16 v[100:103], v[64:67], a[240:243], v[100:103]
    buffer_load_dwordx4 v[60:63], v187, s[48:51], s23 offen offset:2048 sc1
    v_mfma_f32_16x16x32_bf16 v[100:103], v[68:71], a[244:247], v[100:103]
    v_cvt_pk_bf16_f32 v170, v166, v167
    v_cvt_pk_bf16_f32 v171, v168, v169
    v_mfma_f32_16x16x32_bf16 v[100:103], v[72:75], a[248:251], v[100:103]
    ds_write_b64 v12, v[170:171] offset:18432
    s_waitcnt vmcnt(12)
    v_mfma_f32_16x16x32_bf16 v[104:107], v[76:79], a[24:27], v[104:107]
    v_mul_f32 v152, v128, v128
    v_mul_f32 v153, v129, v129
    ds_read_b128 a[24:27], v10 offset:6144
    v_mfma_f32_16x16x32_bf16 v[104:107], v[80:83], a[28:31], v[104:107]
    buffer_load_dwordx4 v[64:67], v187, s[48:51], s23 offen offset:3072 sc1
    v_mfma_f32_16x16x32_bf16 v[104:107], v[84:87], a[32:35], v[104:107]
    v_mul_f32 v154, v130, v130
    v_mul_f32 v155, v131, v131
    v_mfma_f32_16x16x32_bf16 v[108:111], v[76:79], a[96:99], v[108:111]
    v_fma_f32 v152, v152, v13, v6
    v_fma_f32 v153, v153, v13, v6
    ds_read_b128 a[96:99], v10 offset:24576
    v_mfma_f32_16x16x32_bf16 v[108:111], v[80:83], a[100:103], v[108:111]
    v_fma_f32 v154, v154, v13, v6
    v_fma_f32 v155, v155, v13, v6
    v_mfma_f32_16x16x32_bf16 v[108:111], v[84:87], a[104:107], v[108:111]
    buffer_load_dwordx4 v[68:71], v188, s[48:51], s23 offen offset:0 sc1
    v_mfma_f32_16x16x32_bf16 v[112:115], v[76:79], a[168:171], v[112:115]
    v_mul_f32 v152, v128, v152
    v_mul_f32 v153, v129, v153
    ds_read_b128 a[168:171], v11 offset:6144
    v_mfma_f32_16x16x32_bf16 v[112:115], v[80:83], a[172:175], v[112:115]
    v_mul_f32 v154, v130, v154
    v_mul_f32 v155, v131, v155
    v_mfma_f32_16x16x32_bf16 v[112:115], v[84:87], a[176:179], v[112:115]
    v_exp_f32 v152, v152
    v_mfma_f32_16x16x32_bf16 v[116:119], v[76:79], a[240:243], v[116:119]
    buffer_load_dwordx4 v[72:75], v188, s[48:51], s23 offen offset:1024 sc1
    v_mfma_f32_16x16x32_bf16 v[116:119], v[80:83], a[244:247], v[116:119]
    v_exp_f32 v153, v153
    ds_read_b128 a[240:243], v11 offset:24576
    v_mfma_f32_16x16x32_bf16 v[116:119], v[84:87], a[248:251], v[116:119]
    v_exp_f32 v154, v154
    ds_read_b128 a[28:31], v10 offset:7168
    s_waitcnt vmcnt(12)
    v_mfma_f32_16x16x32_bf16 v[88:91], v[16:19], a[36:39], v[88:91]
    v_exp_f32 v155, v155
    ds_read_b128 a[100:103], v10 offset:25600
    v_mfma_f32_16x16x32_bf16 v[88:91], v[20:23], a[40:43], v[88:91]
    buffer_load_dwordx4 v[76:79], v188, s[48:51], s23 offen offset:2048 sc1
    v_mfma_f32_16x16x32_bf16 v[88:91], v[24:27], a[44:47], v[88:91]
    v_mul_f32 v156, v128, v144
    v_mul_f32 v157, v129, v145
    ds_read_b128 a[172:175], v11 offset:7168
    v_mfma_f32_16x16x32_bf16 v[92:95], v[16:19], a[108:111], v[92:95]
    v_mul_f32 v158, v130, v146
    v_mul_f32 v159, v131, v147
    ds_read_b128 a[244:247], v11 offset:25600
    v_mfma_f32_16x16x32_bf16 v[92:95], v[20:23], a[112:115], v[92:95]
    v_fma_f32 v152, v152, v195, v195
    v_fma_f32 v153, v153, v195, v195
    ds_read_b128 a[32:35], v10 offset:8192
    v_mfma_f32_16x16x32_bf16 v[92:95], v[24:27], a[116:119], v[92:95]
    buffer_load_dwordx4 v[80:83], v188, s[48:51], s23 offen offset:3072 sc1
    v_mfma_f32_16x16x32_bf16 v[96:99], v[16:19], a[180:183], v[96:99]
    v_fma_f32 v154, v154, v195, v195
    v_fma_f32 v155, v155, v195, v195
    ds_read_b128 a[104:107], v10 offset:26624
    v_mfma_f32_16x16x32_bf16 v[96:99], v[20:23], a[184:187], v[96:99]
    v_rcp_f32 v152, v152
    ds_read_b128 a[176:179], v11 offset:8192
    v_mfma_f32_16x16x32_bf16 v[96:99], v[24:27], a[188:191], v[96:99]
    v_rcp_f32 v153, v153
    ds_read_b128 a[248:251], v11 offset:26624
    v_mfma_f32_16x16x32_bf16 v[100:103], v[16:19], a[252:255], v[100:103]
    buffer_load_dwordx4 v[84:87], v189, s[48:51], s23 offen offset:0 sc1
    v_mfma_f32_16x16x32_bf16 v[100:103], v[20:23], v[220:223], v[100:103]
    v_rcp_f32 v154, v154
    v_mfma_f32_16x16x32_bf16 v[100:103], v[24:27], v[224:227], v[100:103]
    v_rcp_f32 v155, v155
    s_waitcnt vmcnt(12)
    v_mfma_f32_16x16x32_bf16 v[104:107], v[28:31], a[36:39], v[104:107]
    v_mul_f32 v156, v156, v152
    v_mul_f32 v157, v157, v153
    ds_read_b128 a[36:39], v10 offset:9216
    v_mfma_f32_16x16x32_bf16 v[104:107], v[32:35], a[40:43], v[104:107]
    buffer_load_dwordx4 v[16:19], v189, s[48:51], s23 offen offset:1024 sc1
    v_mfma_f32_16x16x32_bf16 v[104:107], v[36:39], a[44:47], v[104:107]
    v_mul_f32 v158, v158, v154
    v_mul_f32 v159, v159, v155
    v_mfma_f32_16x16x32_bf16 v[108:111], v[28:31], a[108:111], v[108:111]
    v_cvt_pk_bf16_f32 v160, v156, v157
    v_cvt_pk_bf16_f32 v161, v158, v159
    ds_read_b128 a[108:111], v10 offset:27648
    v_mfma_f32_16x16x32_bf16 v[108:111], v[32:35], a[112:115], v[108:111]
    ds_write_b64 v12, v[160:161] offset:36864
    v_mfma_f32_16x16x32_bf16 v[108:111], v[36:39], a[116:119], v[108:111]
    buffer_load_dwordx4 v[20:23], v189, s[48:51], s23 offen offset:2048 sc1
    v_mfma_f32_16x16x32_bf16 v[112:115], v[28:31], a[180:183], v[112:115]
    v_mul_f32 v162, v132, v132
    v_mul_f32 v163, v133, v133
    ds_read_b128 a[180:183], v11 offset:9216
    v_mfma_f32_16x16x32_bf16 v[112:115], v[32:35], a[184:187], v[112:115]
    v_mul_f32 v164, v134, v134
    v_mul_f32 v165, v135, v135
    v_mfma_f32_16x16x32_bf16 v[112:115], v[36:39], a[188:191], v[112:115]
    v_fma_f32 v162, v162, v14, v7
    v_fma_f32 v163, v163, v14, v7
    v_mfma_f32_16x16x32_bf16 v[116:119], v[28:31], a[252:255], v[116:119]
    buffer_load_dwordx4 v[24:27], v189, s[48:51], s23 offen offset:3072 sc1
    v_mfma_f32_16x16x32_bf16 v[116:119], v[32:35], v[220:223], v[116:119]
    v_fma_f32 v164, v164, v14, v7
    v_fma_f32 v165, v165, v14, v7
    ds_read_b128 a[252:255], v11 offset:27648
    v_mfma_f32_16x16x32_bf16 v[116:119], v[36:39], v[224:227], v[116:119]
    v_mul_f32 v162, v132, v162
    v_mul_f32 v163, v133, v163
    ds_read_b128 a[40:43], v10 offset:10240
    s_waitcnt vmcnt(12)
    v_mfma_f32_16x16x32_bf16 v[88:91], v[40:43], a[48:51], v[88:91]
    v_mul_f32 v164, v134, v164
    v_mul_f32 v165, v135, v165
    ds_read_b128 a[112:115], v10 offset:28672
    v_mfma_f32_16x16x32_bf16 v[88:91], v[44:47], a[52:55], v[88:91]
    buffer_load_dwordx4 v[28:31], v190, s[48:51], s23 offen offset:0 sc1
    v_mfma_f32_16x16x32_bf16 v[88:91], v[48:51], a[56:59], v[88:91]
    v_exp_f32 v162, v162
    ds_read_b128 a[184:187], v11 offset:10240
    v_mfma_f32_16x16x32_bf16 v[92:95], v[40:43], a[120:123], v[92:95]
    v_exp_f32 v163, v163
    ds_read_b128 v[220:223], v11 offset:28672
    v_mfma_f32_16x16x32_bf16 v[92:95], v[44:47], a[124:127], v[92:95]
    v_exp_f32 v164, v164
    ds_read_b128 a[44:47], v10 offset:11264
    v_mfma_f32_16x16x32_bf16 v[92:95], v[48:51], a[128:131], v[92:95]
    buffer_load_dwordx4 v[32:35], v190, s[48:51], s23 offen offset:1024 sc1
    v_mfma_f32_16x16x32_bf16 v[96:99], v[40:43], a[192:195], v[96:99]
    v_exp_f32 v165, v165
    ds_read_b128 a[116:119], v10 offset:29696
    v_mfma_f32_16x16x32_bf16 v[96:99], v[44:47], a[196:199], v[96:99]
    v_mul_f32 v166, v132, v148
    v_mul_f32 v167, v133, v149
    ds_read_b128 a[188:191], v11 offset:11264
    v_mfma_f32_16x16x32_bf16 v[96:99], v[48:51], a[200:203], v[96:99]
    v_mul_f32 v168, v134, v150
    v_mul_f32 v169, v135, v151
    ds_read_b128 v[224:227], v11 offset:29696
    v_mfma_f32_16x16x32_bf16 v[100:103], v[40:43], v[228:231], v[100:103]
    buffer_load_dwordx4 v[36:39], v190, s[48:51], s23 offen offset:2048 sc1
    v_mfma_f32_16x16x32_bf16 v[100:103], v[44:47], v[232:235], v[100:103]
    v_fma_f32 v162, v162, v252, v252
    v_fma_f32 v163, v163, v252, v252
    v_mfma_f32_16x16x32_bf16 v[100:103], v[48:51], v[236:239], v[100:103]
    v_fma_f32 v164, v164, v252, v252
    v_fma_f32 v165, v165, v252, v252
    s_waitcnt vmcnt(12)
    v_mfma_f32_16x16x32_bf16 v[104:107], v[52:55], a[48:51], v[104:107]
    v_rcp_f32 v162, v162
    ds_read_b128 a[48:51], v10 offset:12288
    v_mfma_f32_16x16x32_bf16 v[104:107], v[56:59], a[52:55], v[104:107]
    buffer_load_dwordx4 v[40:43], v190, s[48:51], s23 offen offset:3072 sc1
    v_mfma_f32_16x16x32_bf16 v[104:107], v[60:63], a[56:59], v[104:107]
    v_rcp_f32 v163, v163
    v_mfma_f32_16x16x32_bf16 v[108:111], v[52:55], a[120:123], v[108:111]
    v_rcp_f32 v164, v164
    ds_read_b128 a[120:123], v10 offset:30720
    v_mfma_f32_16x16x32_bf16 v[108:111], v[56:59], a[124:127], v[108:111]
    v_rcp_f32 v165, v165
    v_mfma_f32_16x16x32_bf16 v[108:111], v[60:63], a[128:131], v[108:111]
    buffer_load_dwordx4 v[44:47], v191, s[48:51], s23 offen offset:0 sc1
    v_mfma_f32_16x16x32_bf16 v[112:115], v[52:55], a[192:195], v[112:115]
    v_mul_f32 v166, v166, v162
    v_mul_f32 v167, v167, v163
    ds_read_b128 a[192:195], v11 offset:12288
    v_mfma_f32_16x16x32_bf16 v[112:115], v[56:59], a[196:199], v[112:115]
    v_mul_f32 v168, v168, v164
    v_mul_f32 v169, v169, v165
    v_mfma_f32_16x16x32_bf16 v[112:115], v[60:63], a[200:203], v[112:115]
    v_cvt_pk_bf16_f32 v170, v166, v167
    v_cvt_pk_bf16_f32 v171, v168, v169
    v_mfma_f32_16x16x32_bf16 v[116:119], v[52:55], v[228:231], v[116:119]
    buffer_load_dwordx4 v[48:51], v191, s[48:51], s23 offen offset:1024 sc1
    v_mfma_f32_16x16x32_bf16 v[116:119], v[56:59], v[232:235], v[116:119]
    ds_write_b64 v12, v[170:171] offset:55296
    v_mfma_f32_16x16x32_bf16 v[116:119], v[60:63], v[236:239], v[116:119]
    ds_read_b128 v[228:231], v11 offset:30720
    s_waitcnt vmcnt(12)
    v_mfma_f32_16x16x32_bf16 v[88:91], v[64:67], a[60:63], v[88:91]
    ds_read_b128 a[52:55], v10 offset:13312
    v_mfma_f32_16x16x32_bf16 v[88:91], v[68:71], a[64:67], v[88:91]
    buffer_load_dwordx4 v[52:55], v191, s[48:51], s23 offen offset:2048 sc1
    v_mfma_f32_16x16x32_bf16 v[120:123], v[72:75], a[68:71], v[88:91]
    ds_read_b128 a[124:127], v10 offset:31744
    v_mfma_f32_16x16x32_bf16 v[92:95], v[64:67], a[132:135], v[92:95]
    ds_read_b128 a[196:199], v11 offset:13312
    v_mfma_f32_16x16x32_bf16 v[92:95], v[68:71], a[136:139], v[92:95]
    ds_read_b128 v[232:235], v11 offset:31744
    v_mfma_f32_16x16x32_bf16 v[124:127], v[72:75], a[140:143], v[92:95]
    buffer_load_dwordx4 v[56:59], v191, s[48:51], s23 offen offset:3072 sc1
    v_mfma_f32_16x16x32_bf16 v[96:99], v[64:67], a[204:207], v[96:99]
    v_mfma_f32_16x16x32_bf16 v[96:99], v[68:71], a[208:211], v[96:99]
    v_mfma_f32_16x16x32_bf16 v[128:131], v[72:75], a[212:215], v[96:99]
    v_mfma_f32_16x16x32_bf16 v[100:103], v[64:67], v[240:243], v[100:103]
    buffer_load_dwordx4 v[60:63], v192, s[48:51], s23 offen offset:0 sc1
    v_mfma_f32_16x16x32_bf16 v[100:103], v[68:71], v[244:247], v[100:103]
    v_mfma_f32_16x16x32_bf16 v[132:135], v[72:75], v[248:251], v[100:103]
    s_waitcnt vmcnt(12)
    v_mfma_f32_16x16x32_bf16 v[104:107], v[76:79], a[60:63], v[104:107]
    v_mfma_f32_16x16x32_bf16 v[104:107], v[80:83], a[64:67], v[104:107]
    buffer_load_dwordx4 v[64:67], v192, s[48:51], s23 offen offset:1024 sc1
    v_mfma_f32_16x16x32_bf16 v[136:139], v[84:87], a[68:71], v[104:107]
    v_mfma_f32_16x16x32_bf16 v[108:111], v[76:79], a[132:135], v[108:111]
    v_mfma_f32_16x16x32_bf16 v[108:111], v[80:83], a[136:139], v[108:111]
    v_mfma_f32_16x16x32_bf16 v[140:143], v[84:87], a[140:143], v[108:111]
    buffer_load_dwordx4 v[68:71], v192, s[48:51], s23 offen offset:2048 sc1
    v_mfma_f32_16x16x32_bf16 v[112:115], v[76:79], a[204:207], v[112:115]
    v_mfma_f32_16x16x32_bf16 v[112:115], v[80:83], a[208:211], v[112:115]
    s_lshl_b32 s7, s25, 11
    v_mfma_f32_16x16x32_bf16 v[144:147], v[84:87], a[212:215], v[112:115]
    s_add_u32 s7, s7, s28
    v_mfma_f32_16x16x32_bf16 v[116:119], v[76:79], v[240:243], v[116:119]
    buffer_load_dwordx4 v[72:75], v192, s[48:51], s23 offen offset:3072 sc1
    v_mfma_f32_16x16x32_bf16 v[116:119], v[80:83], v[244:247], v[116:119]
    s_add_u32 s23, s23, 36864
    v_mfma_f32_16x16x32_bf16 v[148:151], v[84:87], v[248:251], v[116:119]
    v_add_u32 v12, s7, v184
    s_add_u32 s25, s25, 1
    s_waitcnt lgkmcnt(0)
    s_barrier
    v_pk_mul_f32 v[152:153], v[120:121], v[120:121]
    ds_read_b128 a[56:59], v10 offset:14336
    v_pk_mul_f32 v[154:155], v[122:123], v[122:123]
    ds_read_b128 a[128:131], v10 offset:32768
    v_pk_fma_f32 v[152:153], v[152:153], v[8:9], v[4:5] op_sel:[0,0,0] op_sel_hi:[1,0,0]
    ds_read_b128 a[200:203], v11 offset:14336
    v_pk_fma_f32 v[154:155], v[154:155], v[8:9], v[4:5] op_sel:[0,0,0] op_sel_hi:[1,0,0]
    v_pk_mul_f32 v[152:153], v[120:121], v[152:153]
    ds_read_b128 v[236:239], v11 offset:32768
    v_pk_mul_f32 v[154:155], v[122:123], v[154:155]
    ds_read_b128 a[60:63], v10 offset:15360
    buffer_load_dwordx4 v[76:79], v184, s[48:51], s23 offen offset:0 sc1
    v_exp_f32 v152, v152
    ds_read_b128 a[132:135], v10 offset:33792
    v_exp_f32 v153, v153
    v_exp_f32 v154, v154
    ds_read_b128 a[204:207], v11 offset:15360
    v_exp_f32 v155, v155
    ds_read_b128 v[240:243], v11 offset:33792
    v_pk_mul_f32 v[156:157], v[120:121], v[136:137]
    v_pk_mul_f32 v[158:159], v[122:123], v[138:139]
    buffer_load_dwordx4 v[80:83], v184, s[48:51], s23 offen offset:1024 sc1
    v_pk_fma_f32 v[152:153], v[152:153], v[192:193], v[192:193] op_sel:[0,1,1] op_sel_hi:[1,1,1]
    v_pk_fma_f32 v[154:155], v[154:155], v[192:193], v[192:193] op_sel:[0,1,1] op_sel_hi:[1,1,1]
    v_rcp_f32 v152, v152
    v_rcp_f32 v153, v153
    v_rcp_f32 v154, v154
    v_rcp_f32 v155, v155
    buffer_load_dwordx4 v[84:87], v184, s[48:51], s23 offen offset:2048 sc1
    s_nop 0
    v_pk_mul_f32 v[156:157], v[156:157], v[152:153]
    v_pk_mul_f32 v[158:159], v[158:159], v[154:155]
    v_cvt_pk_bf16_f32 v160, v156, v157
    v_cvt_pk_bf16_f32 v161, v158, v159
    ds_write_b64 v12, v[160:161] offset:0
    buffer_load_dwordx4 v[104:107], v184, s[48:51], s23 offen offset:3072 sc1
    v_pk_mul_f32 v[162:163], v[124:125], v[124:125]
    v_pk_mul_f32 v[164:165], v[126:127], v[126:127]
    v_pk_fma_f32 v[162:163], v[162:163], v[8:9], v[4:5] op_sel:[0,1,1] op_sel_hi:[1,1,1]
    v_pk_fma_f32 v[164:165], v[164:165], v[8:9], v[4:5] op_sel:[0,1,1] op_sel_hi:[1,1,1]
    v_pk_mul_f32 v[162:163], v[124:125], v[162:163]
    v_pk_mul_f32 v[164:165], v[126:127], v[164:165]
    buffer_load_dwordx4 v[108:111], v185, s[48:51], s23 offen offset:0 sc1
    v_exp_f32 v162, v162
    v_exp_f32 v163, v163
    v_exp_f32 v164, v164
    v_exp_f32 v165, v165
    v_pk_mul_f32 v[166:167], v[124:125], v[140:141]
    v_pk_mul_f32 v[168:169], v[126:127], v[142:143]
    buffer_load_dwordx4 v[112:115], v185, s[48:51], s23 offen offset:1024 sc1
    v_pk_fma_f32 v[162:163], v[162:163], v[194:195], v[194:195] op_sel:[0,0,0] op_sel_hi:[1,0,0]
    v_pk_fma_f32 v[164:165], v[164:165], v[194:195], v[194:195] op_sel:[0,0,0] op_sel_hi:[1,0,0]
    v_rcp_f32 v162, v162
    v_rcp_f32 v163, v163
    v_rcp_f32 v164, v164
    v_rcp_f32 v165, v165
    buffer_load_dwordx4 v[116:119], v185, s[48:51], s23 offen offset:2048 sc1
    s_nop 0
    v_pk_mul_f32 v[166:167], v[166:167], v[162:163]
    v_pk_mul_f32 v[168:169], v[168:169], v[164:165]
    v_cvt_pk_bf16_f32 v170, v166, v167
    v_cvt_pk_bf16_f32 v171, v168, v169
    ds_write_b64 v12, v[170:171] offset:18432
    buffer_load_dwordx4 v[180:183], v185, s[48:51], s23 offen offset:3072 sc1
    v_pk_mul_f32 v[152:153], v[128:129], v[128:129]
    v_pk_mul_f32 v[154:155], v[130:131], v[130:131]
    v_pk_fma_f32 v[152:153], v[152:153], v[12:13], v[6:7] op_sel:[0,1,0] op_sel_hi:[1,1,0]
    v_pk_fma_f32 v[154:155], v[154:155], v[12:13], v[6:7] op_sel:[0,1,0] op_sel_hi:[1,1,0]
    v_pk_mul_f32 v[152:153], v[128:129], v[152:153]
    v_pk_mul_f32 v[154:155], v[130:131], v[154:155]
    buffer_load_dwordx4 v[196:199], v186, s[48:51], s23 offen offset:0 sc1
    v_exp_f32 v152, v152
    v_exp_f32 v153, v153
    v_exp_f32 v154, v154
    v_exp_f32 v155, v155
    v_pk_mul_f32 v[156:157], v[128:129], v[144:145]
    v_pk_mul_f32 v[158:159], v[130:131], v[146:147]
    buffer_load_dwordx4 v[200:203], v186, s[48:51], s23 offen offset:1024 sc1
    v_pk_fma_f32 v[152:153], v[152:153], v[194:195], v[194:195] op_sel:[0,1,1] op_sel_hi:[1,1,1]
    v_pk_fma_f32 v[154:155], v[154:155], v[194:195], v[194:195] op_sel:[0,1,1] op_sel_hi:[1,1,1]
    v_rcp_f32 v152, v152
    v_rcp_f32 v153, v153
    v_rcp_f32 v154, v154
    v_rcp_f32 v155, v155
    buffer_load_dwordx4 v[204:207], v186, s[48:51], s23 offen offset:2048 sc1
    s_nop 0
    v_pk_mul_f32 v[156:157], v[156:157], v[152:153]
    v_pk_mul_f32 v[158:159], v[158:159], v[154:155]
    v_cvt_pk_bf16_f32 v160, v156, v157
    v_cvt_pk_bf16_f32 v161, v158, v159
    ds_write_b64 v12, v[160:161] offset:36864
    buffer_load_dwordx4 v[208:211], v186, s[48:51], s23 offen offset:3072 sc1
    v_pk_mul_f32 v[162:163], v[132:133], v[132:133]
    v_pk_mul_f32 v[164:165], v[134:135], v[134:135]
    v_pk_fma_f32 v[162:163], v[162:163], v[14:15], v[6:7] op_sel:[0,0,1] op_sel_hi:[1,0,1]
    v_pk_fma_f32 v[164:165], v[164:165], v[14:15], v[6:7] op_sel:[0,0,1] op_sel_hi:[1,0,1]
    v_pk_mul_f32 v[162:163], v[132:133], v[162:163]
    v_pk_mul_f32 v[164:165], v[134:135], v[164:165]
    buffer_load_dwordx4 v[212:215], v187, s[48:51], s23 offen offset:0 sc1
    v_exp_f32 v162, v162
    v_exp_f32 v163, v163
    v_exp_f32 v164, v164
    v_exp_f32 v165, v165
    v_pk_mul_f32 v[166:167], v[132:133], v[148:149]
    v_pk_mul_f32 v[168:169], v[134:135], v[150:151]
    v_pk_fma_f32 v[162:163], v[162:163], v[252:253], v[252:253] op_sel:[0,0,0] op_sel_hi:[1,0,0]
    v_pk_fma_f32 v[164:165], v[164:165], v[252:253], v[252:253] op_sel:[0,0,0] op_sel_hi:[1,0,0]
    v_rcp_f32 v162, v162
    v_rcp_f32 v163, v163
    v_rcp_f32 v164, v164
    v_rcp_f32 v165, v165
    s_nop 0
    v_pk_mul_f32 v[166:167], v[166:167], v[162:163]
    v_pk_mul_f32 v[168:169], v[168:169], v[164:165]
    v_cvt_pk_bf16_f32 v170, v166, v167
    v_cvt_pk_bf16_f32 v171, v168, v169
    ds_write_b64 v12, v[170:171] offset:55296
    buffer_load_dwordx4 v[136:139], v187, s[48:51], s23 offen offset:1024 sc1
    buffer_load_dwordx4 v[140:143], v187, s[48:51], s23 offen offset:2048 sc1
    buffer_load_dwordx4 v[144:147], v187, s[48:51], s23 offen offset:3072 sc1
    buffer_load_dwordx4 v[160:163], v188, s[48:51], s23 offen offset:0 sc1
    buffer_load_dwordx4 v[164:167], v188, s[48:51], s23 offen offset:1024 sc1
    s_add_u32 s23, s23, 18432
    s_waitcnt lgkmcnt(0)
    s_barrier
    ds_read_b128 a[64:67], v10 offset:16384
    ds_read_b128 a[136:139], v10 offset:34816
    ds_read_b128 a[208:211], v11 offset:16384
    ds_read_b128 v[244:247], v11 offset:34816
    ds_read_b128 a[68:71], v10 offset:17408
    ds_read_b128 a[140:143], v10 offset:35840
    ds_read_b128 a[212:215], v11 offset:17408
    ds_read_b128 v[248:251], v11 offset:35840
    s_mov_b32 s25, 0
    s_waitcnt lgkmcnt(0)
    s_branch L_ffn_dn_mid_36
L_ffn_dn_35:
    s_waitcnt vmcnt(32)
    v_mfma_f32_16x16x32_bf16 v[88:91], v[104:107], a[0:3], 0
    v_mfma_f32_16x16x32_bf16 v[88:91], v[108:111], a[4:7], v[88:91]
    buffer_load_dwordx4 v[76:79], v184, s[48:51], s23 offen offset:0 sc1
    v_mfma_f32_16x16x32_bf16 v[88:91], v[112:115], a[8:11], v[88:91]
    v_mfma_f32_16x16x32_bf16 v[92:95], v[104:107], a[72:75], 0
    v_mfma_f32_16x16x32_bf16 v[92:95], v[108:111], a[76:79], v[92:95]
    v_mfma_f32_16x16x32_bf16 v[92:95], v[112:115], a[80:83], v[92:95]
    buffer_load_dwordx4 v[80:83], v184, s[48:51], s23 offen offset:1024 sc1
    v_mfma_f32_16x16x32_bf16 v[96:99], v[104:107], a[144:147], 0
    v_cvt_pk_bf16_f32 v152, v120, v121
    v_cvt_pk_bf16_f32 v153, v122, v123
    v_mfma_f32_16x16x32_bf16 v[96:99], v[108:111], a[148:151], v[96:99]
    v_cvt_pk_bf16_f32 v154, v124, v125
    v_cvt_pk_bf16_f32 v155, v126, v127
    v_mfma_f32_16x16x32_bf16 v[96:99], v[112:115], a[152:155], v[96:99]
    s_nop 0
    v_permlane16_swap_b32 v152, v154
    v_mfma_f32_16x16x32_bf16 v[100:103], v[104:107], a[216:219], 0
    buffer_load_dwordx4 v[84:87], v184, s[48:51], s23 offen offset:2048 sc1
    v_mfma_f32_16x16x32_bf16 v[100:103], v[108:111], a[220:223], v[100:103]
    v_permlane16_swap_b32 v153, v155
    v_mfma_f32_16x16x32_bf16 v[100:103], v[112:115], a[224:227], v[100:103]
    buffer_store_dwordx4 v[152:155], v178, s[72:75], s27 offen sc1
    s_waitcnt vmcnt(33)
    v_mfma_f32_16x16x32_bf16 v[88:91], v[116:119], a[12:15], v[88:91]
    ds_write_b128 v216, v[152:155]
    v_mfma_f32_16x16x32_bf16 v[88:91], v[180:183], a[16:19], v[88:91]
    buffer_load_dwordx4 v[104:107], v184, s[48:51], s23 offen offset:3072 sc1
    v_mfma_f32_16x16x32_bf16 v[88:91], v[196:199], a[20:23], v[88:91]
    v_add_u32 v216, v216, v218
    v_mfma_f32_16x16x32_bf16 v[92:95], v[116:119], a[84:87], v[92:95]
    v_mfma_f32_16x16x32_bf16 v[92:95], v[180:183], a[88:91], v[92:95]
    v_mfma_f32_16x16x32_bf16 v[92:95], v[196:199], a[92:95], v[92:95]
    buffer_load_dwordx4 v[108:111], v185, s[48:51], s23 offen offset:0 sc1
    v_mfma_f32_16x16x32_bf16 v[96:99], v[116:119], a[156:159], v[96:99]
    v_mfma_f32_16x16x32_bf16 v[96:99], v[180:183], a[160:163], v[96:99]
    v_mfma_f32_16x16x32_bf16 v[96:99], v[196:199], a[164:167], v[96:99]
    v_mfma_f32_16x16x32_bf16 v[100:103], v[116:119], a[228:231], v[100:103]
    buffer_load_dwordx4 v[112:115], v185, s[48:51], s23 offen offset:1024 sc1
    v_mfma_f32_16x16x32_bf16 v[100:103], v[180:183], a[232:235], v[100:103]
    v_mfma_f32_16x16x32_bf16 v[100:103], v[196:199], a[236:239], v[100:103]
    s_waitcnt vmcnt(33)
    v_mfma_f32_16x16x32_bf16 v[88:91], v[200:203], a[24:27], v[88:91]
    v_mfma_f32_16x16x32_bf16 v[88:91], v[204:207], a[28:31], v[88:91]
    buffer_load_dwordx4 v[116:119], v185, s[48:51], s23 offen offset:2048 sc1
    v_mfma_f32_16x16x32_bf16 v[88:91], v[208:211], a[32:35], v[88:91]
    v_mfma_f32_16x16x32_bf16 v[92:95], v[200:203], a[96:99], v[92:95]
    v_mfma_f32_16x16x32_bf16 v[92:95], v[204:207], a[100:103], v[92:95]
    v_mfma_f32_16x16x32_bf16 v[92:95], v[208:211], a[104:107], v[92:95]
    buffer_load_dwordx4 v[180:183], v185, s[48:51], s23 offen offset:3072 sc1
    v_mfma_f32_16x16x32_bf16 v[96:99], v[200:203], a[168:171], v[96:99]
    v_mfma_f32_16x16x32_bf16 v[96:99], v[204:207], a[172:175], v[96:99]
    v_mfma_f32_16x16x32_bf16 v[96:99], v[208:211], a[176:179], v[96:99]
    v_mfma_f32_16x16x32_bf16 v[100:103], v[200:203], a[240:243], v[100:103]
    buffer_load_dwordx4 v[196:199], v186, s[48:51], s23 offen offset:0 sc1
    v_mfma_f32_16x16x32_bf16 v[100:103], v[204:207], a[244:247], v[100:103]
    v_mfma_f32_16x16x32_bf16 v[100:103], v[208:211], a[248:251], v[100:103]
    s_waitcnt vmcnt(33)
    v_mfma_f32_16x16x32_bf16 v[88:91], v[212:215], a[36:39], v[88:91]
    v_mfma_f32_16x16x32_bf16 v[88:91], v[136:139], a[40:43], v[88:91]
    buffer_load_dwordx4 v[200:203], v186, s[48:51], s23 offen offset:1024 sc1
    v_mfma_f32_16x16x32_bf16 v[88:91], v[140:143], a[44:47], v[88:91]
    v_mfma_f32_16x16x32_bf16 v[92:95], v[212:215], a[108:111], v[92:95]
    v_mfma_f32_16x16x32_bf16 v[92:95], v[136:139], a[112:115], v[92:95]
    v_cvt_pk_bf16_f32 v156, v128, v129
    v_cvt_pk_bf16_f32 v157, v130, v131
    v_mfma_f32_16x16x32_bf16 v[92:95], v[140:143], a[116:119], v[92:95]
    buffer_load_dwordx4 v[204:207], v186, s[48:51], s23 offen offset:2048 sc1
    v_mfma_f32_16x16x32_bf16 v[96:99], v[212:215], a[180:183], v[96:99]
    v_cvt_pk_bf16_f32 v158, v132, v133
    v_cvt_pk_bf16_f32 v159, v134, v135
    v_mfma_f32_16x16x32_bf16 v[96:99], v[136:139], a[184:187], v[96:99]
    s_nop 0
    v_permlane16_swap_b32 v156, v158
    v_mfma_f32_16x16x32_bf16 v[96:99], v[140:143], a[188:191], v[96:99]
    v_permlane16_swap_b32 v157, v159
    v_mfma_f32_16x16x32_bf16 v[100:103], v[212:215], a[252:255], v[100:103]
    buffer_load_dwordx4 v[208:211], v186, s[48:51], s23 offen offset:3072 sc1
    v_mfma_f32_16x16x32_bf16 v[100:103], v[136:139], v[220:223], v[100:103]
    buffer_store_dwordx4 v[156:159], v179, s[72:75], s27 offen sc1
    v_mfma_f32_16x16x32_bf16 v[100:103], v[140:143], v[224:227], v[100:103]
    ds_write_b128 v217, v[156:159]
    s_waitcnt vmcnt(34)
    v_mfma_f32_16x16x32_bf16 v[88:91], v[144:147], a[48:51], v[88:91]
    v_add_u32 v217, v217, v219
    v_mfma_f32_16x16x32_bf16 v[88:91], v[160:163], a[52:55], v[88:91]
    buffer_load_dwordx4 v[212:215], v187, s[48:51], s23 offen offset:0 sc1
    v_mfma_f32_16x16x32_bf16 v[88:91], v[164:167], a[56:59], v[88:91]
    v_mfma_f32_16x16x32_bf16 v[92:95], v[144:147], a[120:123], v[92:95]
    v_mfma_f32_16x16x32_bf16 v[92:95], v[160:163], a[124:127], v[92:95]
    v_mfma_f32_16x16x32_bf16 v[92:95], v[164:167], a[128:131], v[92:95]
    buffer_load_dwordx4 v[136:139], v187, s[48:51], s23 offen offset:1024 sc1
    v_mfma_f32_16x16x32_bf16 v[96:99], v[144:147], a[192:195], v[96:99]
    v_mfma_f32_16x16x32_bf16 v[96:99], v[160:163], a[196:199], v[96:99]
    v_mfma_f32_16x16x32_bf16 v[96:99], v[164:167], a[200:203], v[96:99]
    v_mfma_f32_16x16x32_bf16 v[100:103], v[144:147], v[228:231], v[100:103]
    buffer_load_dwordx4 v[140:143], v187, s[48:51], s23 offen offset:2048 sc1
    v_mfma_f32_16x16x32_bf16 v[100:103], v[160:163], v[232:235], v[100:103]
    v_mfma_f32_16x16x32_bf16 v[100:103], v[164:167], v[236:239], v[100:103]
    s_waitcnt vmcnt(34)
    v_mfma_f32_16x16x32_bf16 v[88:91], v[168:171], a[60:63], v[88:91]
    v_mfma_f32_16x16x32_bf16 v[88:91], v[148:151], a[64:67], v[88:91]
    buffer_load_dwordx4 v[144:147], v187, s[48:51], s23 offen offset:3072 sc1
    v_mfma_f32_16x16x32_bf16 v[120:123], v[4:7], a[68:71], v[88:91]
    v_mfma_f32_16x16x32_bf16 v[92:95], v[168:171], a[132:135], v[92:95]
    v_mfma_f32_16x16x32_bf16 v[92:95], v[148:151], a[136:139], v[92:95]
    v_mfma_f32_16x16x32_bf16 v[124:127], v[4:7], a[140:143], v[92:95]
    buffer_load_dwordx4 v[160:163], v188, s[48:51], s23 offen offset:0 sc1
    v_mfma_f32_16x16x32_bf16 v[96:99], v[168:171], a[204:207], v[96:99]
    s_mov_b32 s74, 268435456
    v_mfma_f32_16x16x32_bf16 v[96:99], v[148:151], a[208:211], v[96:99]
    s_add_u32 s27, s27, 1024
    v_mfma_f32_16x16x32_bf16 v[128:131], v[4:7], a[212:215], v[96:99]
    s_add_u32 s25, s25, 1
    v_mfma_f32_16x16x32_bf16 v[100:103], v[168:171], v[240:243], v[100:103]
    buffer_load_dwordx4 v[164:167], v188, s[48:51], s23 offen offset:1024 sc1
    v_mfma_f32_16x16x32_bf16 v[100:103], v[148:151], v[244:247], v[100:103]
    s_add_u32 s23, s23, 18432
    v_mfma_f32_16x16x32_bf16 v[132:135], v[4:7], v[248:251], v[100:103]
L_ffn_dn_mid_36:
    s_waitcnt vmcnt(30)
    v_mfma_f32_16x16x32_bf16 v[88:91], v[16:19], a[0:3], 0
    v_mfma_f32_16x16x32_bf16 v[88:91], v[20:23], a[4:7], v[88:91]
    buffer_load_dwordx4 v[168:171], v184, s[48:51], s23 offen offset:0 sc1
    v_mfma_f32_16x16x32_bf16 v[88:91], v[24:27], a[8:11], v[88:91]
    v_mfma_f32_16x16x32_bf16 v[92:95], v[16:19], a[72:75], 0
    v_mfma_f32_16x16x32_bf16 v[92:95], v[20:23], a[76:79], v[92:95]
    v_mfma_f32_16x16x32_bf16 v[92:95], v[24:27], a[80:83], v[92:95]
    buffer_load_dwordx4 v[148:151], v184, s[48:51], s23 offen offset:1024 sc1
    v_mfma_f32_16x16x32_bf16 v[96:99], v[16:19], a[144:147], 0
    v_cvt_pk_bf16_f32 v152, v120, v121
    v_cvt_pk_bf16_f32 v153, v122, v123
    v_mfma_f32_16x16x32_bf16 v[96:99], v[20:23], a[148:151], v[96:99]
    v_cvt_pk_bf16_f32 v154, v124, v125
    v_cvt_pk_bf16_f32 v155, v126, v127
    v_mfma_f32_16x16x32_bf16 v[96:99], v[24:27], a[152:155], v[96:99]
    s_nop 0
    v_permlane16_swap_b32 v152, v154
    v_mfma_f32_16x16x32_bf16 v[100:103], v[16:19], a[216:219], 0
    buffer_load_dwordx4 v[4:7], v184, s[48:51], s23 offen offset:2048 sc1
    v_mfma_f32_16x16x32_bf16 v[100:103], v[20:23], a[220:223], v[100:103]
    v_permlane16_swap_b32 v153, v155
    v_mfma_f32_16x16x32_bf16 v[100:103], v[24:27], a[224:227], v[100:103]
    buffer_store_dwordx4 v[152:155], v178, s[72:75], s27 offen sc1
    s_waitcnt vmcnt(31)
    v_mfma_f32_16x16x32_bf16 v[88:91], v[28:31], a[12:15], v[88:91]
    ds_write_b128 v216, v[152:155]
    v_mfma_f32_16x16x32_bf16 v[88:91], v[32:35], a[16:19], v[88:91]
    buffer_load_dwordx4 v[16:19], v184, s[48:51], s23 offen offset:3072 sc1
    v_mfma_f32_16x16x32_bf16 v[88:91], v[36:39], a[20:23], v[88:91]
    v_add_u32 v216, v216, v218
    v_mfma_f32_16x16x32_bf16 v[92:95], v[28:31], a[84:87], v[92:95]
    v_mfma_f32_16x16x32_bf16 v[92:95], v[32:35], a[88:91], v[92:95]
    v_mfma_f32_16x16x32_bf16 v[92:95], v[36:39], a[92:95], v[92:95]
    buffer_load_dwordx4 v[20:23], v185, s[48:51], s23 offen offset:0 sc1
    v_mfma_f32_16x16x32_bf16 v[96:99], v[28:31], a[156:159], v[96:99]
    v_mfma_f32_16x16x32_bf16 v[96:99], v[32:35], a[160:163], v[96:99]
    v_mfma_f32_16x16x32_bf16 v[96:99], v[36:39], a[164:167], v[96:99]
    v_mfma_f32_16x16x32_bf16 v[100:103], v[28:31], a[228:231], v[100:103]
    buffer_load_dwordx4 v[24:27], v185, s[48:51], s23 offen offset:1024 sc1
    v_mfma_f32_16x16x32_bf16 v[100:103], v[32:35], a[232:235], v[100:103]
    v_mfma_f32_16x16x32_bf16 v[100:103], v[36:39], a[236:239], v[100:103]
    s_waitcnt vmcnt(31)
    v_mfma_f32_16x16x32_bf16 v[88:91], v[40:43], a[24:27], v[88:91]
    v_mfma_f32_16x16x32_bf16 v[88:91], v[44:47], a[28:31], v[88:91]
    buffer_load_dwordx4 v[28:31], v185, s[48:51], s23 offen offset:2048 sc1
    v_mfma_f32_16x16x32_bf16 v[88:91], v[48:51], a[32:35], v[88:91]
    v_mfma_f32_16x16x32_bf16 v[92:95], v[40:43], a[96:99], v[92:95]
    v_mfma_f32_16x16x32_bf16 v[92:95], v[44:47], a[100:103], v[92:95]
    v_mfma_f32_16x16x32_bf16 v[92:95], v[48:51], a[104:107], v[92:95]
    buffer_load_dwordx4 v[32:35], v185, s[48:51], s23 offen offset:3072 sc1
    v_mfma_f32_16x16x32_bf16 v[96:99], v[40:43], a[168:171], v[96:99]
    v_mfma_f32_16x16x32_bf16 v[96:99], v[44:47], a[172:175], v[96:99]
    v_mfma_f32_16x16x32_bf16 v[96:99], v[48:51], a[176:179], v[96:99]
    v_mfma_f32_16x16x32_bf16 v[100:103], v[40:43], a[240:243], v[100:103]
    buffer_load_dwordx4 v[36:39], v186, s[48:51], s23 offen offset:0 sc1
    v_mfma_f32_16x16x32_bf16 v[100:103], v[44:47], a[244:247], v[100:103]
    v_mfma_f32_16x16x32_bf16 v[100:103], v[48:51], a[248:251], v[100:103]
    s_waitcnt vmcnt(31)
    s_cmp_lg_u32 s25, 6
    s_cbranch_scc1 L_early_37
    s_waitcnt vmcnt(16)
    s_barrier
    s_cmp_lg_u32 s3, 0
    s_cbranch_scc1 L_early_37
    v_lshlrev_b32 v15, 7, v0
    v_mov_b32 v1, s76
    s_mov_b64 exec, 0xff
    buffer_store_dword v1, v15, s[8:11], s29 offen sc1
    s_mov_b64 exec, -1
L_early_37:
    v_mfma_f32_16x16x32_bf16 v[88:91], v[52:55], a[36:39], v[88:91]
    v_mfma_f32_16x16x32_bf16 v[88:91], v[56:59], a[40:43], v[88:91]
    buffer_load_dwordx4 v[40:43], v186, s[48:51], s23 offen offset:1024 sc1
    v_mfma_f32_16x16x32_bf16 v[88:91], v[60:63], a[44:47], v[88:91]
    v_mfma_f32_16x16x32_bf16 v[92:95], v[52:55], a[108:111], v[92:95]
    v_mfma_f32_16x16x32_bf16 v[92:95], v[56:59], a[112:115], v[92:95]
    v_cvt_pk_bf16_f32 v156, v128, v129
    v_cvt_pk_bf16_f32 v157, v130, v131
    v_mfma_f32_16x16x32_bf16 v[92:95], v[60:63], a[116:119], v[92:95]
    buffer_load_dwordx4 v[44:47], v186, s[48:51], s23 offen offset:2048 sc1
    v_mfma_f32_16x16x32_bf16 v[96:99], v[52:55], a[180:183], v[96:99]
    v_cvt_pk_bf16_f32 v158, v132, v133
    v_cvt_pk_bf16_f32 v159, v134, v135
    v_mfma_f32_16x16x32_bf16 v[96:99], v[56:59], a[184:187], v[96:99]
    s_nop 0
    v_permlane16_swap_b32 v156, v158
    v_mfma_f32_16x16x32_bf16 v[96:99], v[60:63], a[188:191], v[96:99]
    v_permlane16_swap_b32 v157, v159
    v_mfma_f32_16x16x32_bf16 v[100:103], v[52:55], a[252:255], v[100:103]
    buffer_load_dwordx4 v[48:51], v186, s[48:51], s23 offen offset:3072 sc1
    v_mfma_f32_16x16x32_bf16 v[100:103], v[56:59], v[220:223], v[100:103]
    buffer_store_dwordx4 v[156:159], v179, s[72:75], s27 offen sc1
    v_mfma_f32_16x16x32_bf16 v[100:103], v[60:63], v[224:227], v[100:103]
    ds_write_b128 v217, v[156:159]
    s_waitcnt vmcnt(32)
    v_mfma_f32_16x16x32_bf16 v[88:91], v[64:67], a[48:51], v[88:91]
    v_add_u32 v217, v217, v219
    v_mfma_f32_16x16x32_bf16 v[88:91], v[68:71], a[52:55], v[88:91]
    buffer_load_dwordx4 v[52:55], v187, s[48:51], s23 offen offset:0 sc1
    v_mfma_f32_16x16x32_bf16 v[88:91], v[72:75], a[56:59], v[88:91]
    v_mfma_f32_16x16x32_bf16 v[92:95], v[64:67], a[120:123], v[92:95]
    v_mfma_f32_16x16x32_bf16 v[92:95], v[68:71], a[124:127], v[92:95]
    v_mfma_f32_16x16x32_bf16 v[92:95], v[72:75], a[128:131], v[92:95]
    buffer_load_dwordx4 v[56:59], v187, s[48:51], s23 offen offset:1024 sc1
    v_mfma_f32_16x16x32_bf16 v[96:99], v[64:67], a[192:195], v[96:99]
    v_mfma_f32_16x16x32_bf16 v[96:99], v[68:71], a[196:199], v[96:99]
    v_mfma_f32_16x16x32_bf16 v[96:99], v[72:75], a[200:203], v[96:99]
    v_mfma_f32_16x16x32_bf16 v[100:103], v[64:67], v[228:231], v[100:103]
    buffer_load_dwordx4 v[60:63], v187, s[48:51], s23 offen offset:2048 sc1
    v_mfma_f32_16x16x32_bf16 v[100:103], v[68:71], v[232:235], v[100:103]
    v_mfma_f32_16x16x32_bf16 v[100:103], v[72:75], v[236:239], v[100:103]
    s_waitcnt vmcnt(32)
    v_mfma_f32_16x16x32_bf16 v[88:91], v[76:79], a[60:63], v[88:91]
    v_mfma_f32_16x16x32_bf16 v[88:91], v[80:83], a[64:67], v[88:91]
    buffer_load_dwordx4 v[64:67], v187, s[48:51], s23 offen offset:3072 sc1
    v_mfma_f32_16x16x32_bf16 v[120:123], v[84:87], a[68:71], v[88:91]
    v_mfma_f32_16x16x32_bf16 v[92:95], v[76:79], a[132:135], v[92:95]
    v_mfma_f32_16x16x32_bf16 v[92:95], v[80:83], a[136:139], v[92:95]
    v_mfma_f32_16x16x32_bf16 v[124:127], v[84:87], a[140:143], v[92:95]
    buffer_load_dwordx4 v[68:71], v188, s[48:51], s23 offen offset:0 sc1
    v_mfma_f32_16x16x32_bf16 v[96:99], v[76:79], a[204:207], v[96:99]
    s_mov_b32 s74, 268435456
    v_mfma_f32_16x16x32_bf16 v[96:99], v[80:83], a[208:211], v[96:99]
    s_add_u32 s27, s27, 1024
    v_mfma_f32_16x16x32_bf16 v[128:131], v[84:87], a[212:215], v[96:99]
    s_add_u32 s25, s25, 1
    v_mfma_f32_16x16x32_bf16 v[100:103], v[76:79], v[240:243], v[100:103]
    buffer_load_dwordx4 v[72:75], v188, s[48:51], s23 offen offset:1024 sc1
    v_mfma_f32_16x16x32_bf16 v[100:103], v[80:83], v[244:247], v[100:103]
    s_add_u32 s23, s23, 18432
    v_mfma_f32_16x16x32_bf16 v[132:135], v[84:87], v[248:251], v[100:103]
    s_cmp_lt_u32 s25, 7
    s_cbranch_scc1 L_ffn_dn_35
    s_waitcnt vmcnt(33)
    v_mfma_f32_16x16x32_bf16 v[88:91], v[104:107], a[0:3], 0
    v_mfma_f32_16x16x32_bf16 v[88:91], v[108:111], a[4:7], v[88:91]
    buffer_load_dwordx4 v[76:79], v184, s[48:51], s23 offen offset:0 sc1
    v_mfma_f32_16x16x32_bf16 v[88:91], v[112:115], a[8:11], v[88:91]
    v_mfma_f32_16x16x32_bf16 v[92:95], v[104:107], a[72:75], 0
    v_mfma_f32_16x16x32_bf16 v[92:95], v[108:111], a[76:79], v[92:95]
    v_mfma_f32_16x16x32_bf16 v[92:95], v[112:115], a[80:83], v[92:95]
    buffer_load_dwordx4 v[80:83], v184, s[48:51], s23 offen offset:1024 sc1
    v_mfma_f32_16x16x32_bf16 v[96:99], v[104:107], a[144:147], 0
    v_cvt_pk_bf16_f32 v152, v120, v121
    v_cvt_pk_bf16_f32 v153, v122, v123
    v_mfma_f32_16x16x32_bf16 v[96:99], v[108:111], a[148:151], v[96:99]
    v_cvt_pk_bf16_f32 v154, v124, v125
    v_cvt_pk_bf16_f32 v155, v126, v127
    v_mfma_f32_16x16x32_bf16 v[96:99], v[112:115], a[152:155], v[96:99]
    s_nop 0
    v_permlane16_swap_b32 v152, v154
    v_mfma_f32_16x16x32_bf16 v[100:103], v[104:107], a[216:219], 0
    buffer_load_dwordx4 v[84:87], v184, s[48:51], s23 offen offset:2048 sc1
    v_mfma_f32_16x16x32_bf16 v[100:103], v[108:111], a[220:223], v[100:103]
    v_permlane16_swap_b32 v153, v155
    v_mfma_f32_16x16x32_bf16 v[100:103], v[112:115], a[224:227], v[100:103]
    buffer_store_dwordx4 v[152:155], v178, s[72:75], s27 offen sc1
    s_waitcnt vmcnt(34)
    v_mfma_f32_16x16x32_bf16 v[88:91], v[116:119], a[12:15], v[88:91]
    ds_write_b128 v216, v[152:155]
    v_mfma_f32_16x16x32_bf16 v[88:91], v[180:183], a[16:19], v[88:91]
    v_add_u32 v216, v216, v218
    v_cvt_pk_bf16_f32 v156, v128, v129
    v_mfma_f32_16x16x32_bf16 v[88:91], v[196:199], a[20:23], v[88:91]
    v_cvt_pk_bf16_f32 v157, v130, v131
    v_cvt_pk_bf16_f32 v158, v132, v133
    s_load_dwordx8 s[56:63], s[38:39], 0 glc
    v_mfma_f32_16x16x32_bf16 v[92:95], v[116:119], a[84:87], v[92:95]
    v_cvt_pk_bf16_f32 v159, v134, v135
    s_mov_b32 s6, 0
    v_mfma_f32_16x16x32_bf16 v[92:95], v[180:183], a[88:91], v[92:95]
    s_nop 0
    v_permlane16_swap_b32 v156, v158
    v_mfma_f32_16x16x32_bf16 v[92:95], v[196:199], a[92:95], v[92:95]
    v_permlane16_swap_b32 v157, v159
    v_mfma_f32_16x16x32_bf16 v[96:99], v[116:119], a[156:159], v[96:99]
    buffer_store_dwordx4 v[156:159], v179, s[72:75], s27 offen sc1
    v_mfma_f32_16x16x32_bf16 v[96:99], v[180:183], a[160:163], v[96:99]
    ds_write_b128 v217, v[156:159]
    v_mfma_f32_16x16x32_bf16 v[96:99], v[196:199], a[164:167], v[96:99]
    v_add_u32 v217, v217, v219
    v_mfma_f32_16x16x32_bf16 v[100:103], v[116:119], a[228:231], v[100:103]
    v_mfma_f32_16x16x32_bf16 v[100:103], v[180:183], a[232:235], v[100:103]
    v_mfma_f32_16x16x32_bf16 v[100:103], v[196:199], a[236:239], v[100:103]
    s_waitcnt vmcnt(32)
L_epoll_38:
    s_waitcnt lgkmcnt(0)
    s_xor_b64 s[56:57], s[56:57], s[76:77]
    s_xor_b64 s[58:59], s[58:59], s[76:77]
    s_xor_b64 s[60:61], s[60:61], s[76:77]
    s_xor_b64 s[62:63], s[62:63], s[76:77]
    s_or_b64 s[56:57], s[56:57], s[58:59]
    s_or_b64 s[60:61], s[60:61], s[62:63]
    s_or_b64 s[56:57], s[56:57], s[60:61]
    s_cbranch_scc0 L_epolled_39
    s_load_dwordx8 s[56:63], s[38:39], 0 glc
    s_add_u32 s6, s6, 1
    s_cmp_lt_u32 s6, 1048576
    s_cbranch_scc1 L_epoll_38
    s_branch L_main_end
L_epolled_39:
    v_mfma_f32_16x16x32_bf16 v[88:91], v[200:203], a[24:27], v[88:91]
    v_mfma_f32_16x16x32_bf16 v[88:91], v[204:207], a[28:31], v[88:91]
    s_add_u32 s7, s40, 1
    s_and_b32 s7, s7, 7
    s_mul_i32 s7, s7, 9216
    s_add_u32 s19, s7, s20
    buffer_load_dwordx4 v[104:107], v172, s[8:11], s19 offen sc1
    v_mfma_f32_16x16x32_bf16 v[88:91], v[208:211], a[32:35], v[88:91]
    v_mfma_f32_16x16x32_bf16 v[92:95], v[200:203], a[96:99], v[92:95]
    v_mfma_f32_16x16x32_bf16 v[92:95], v[204:207], a[100:103], v[92:95]
    v_mfma_f32_16x16x32_bf16 v[92:95], v[208:211], a[104:107], v[92:95]
    buffer_load_dwordx4 v[108:111], v173, s[8:11], s19 offen sc1
    v_mfma_f32_16x16x32_bf16 v[96:99], v[200:203], a[168:171], v[96:99]
    v_mfma_f32_16x16x32_bf16 v[96:99], v[204:207], a[172:175], v[96:99]
    v_mfma_f32_16x16x32_bf16 v[96:99], v[208:211], a[176:179], v[96:99]
    v_mfma_f32_16x16x32_bf16 v[100:103], v[200:203], a[240:243], v[100:103]
    s_add_u32 s7, s40, 2
    s_and_b32 s7, s7, 7
    s_mul_i32 s7, s7, 9216
    s_add_u32 s19, s7, s20
    buffer_load_dwordx4 v[112:115], v172, s[8:11], s19 offen sc1
    v_mfma_f32_16x16x32_bf16 v[100:103], v[204:207], a[244:247], v[100:103]
    v_mfma_f32_16x16x32_bf16 v[100:103], v[208:211], a[248:251], v[100:103]
    s_waitcnt vmcnt(31)
    v_mfma_f32_16x16x32_bf16 v[88:91], v[212:215], a[36:39], v[88:91]
    v_mfma_f32_16x16x32_bf16 v[88:91], v[136:139], a[40:43], v[88:91]
    buffer_load_dwordx4 v[116:119], v173, s[8:11], s19 offen sc1
    v_mfma_f32_16x16x32_bf16 v[88:91], v[140:143], a[44:47], v[88:91]
    v_mfma_f32_16x16x32_bf16 v[92:95], v[212:215], a[108:111], v[92:95]
    v_mfma_f32_16x16x32_bf16 v[92:95], v[136:139], a[112:115], v[92:95]
    v_mfma_f32_16x16x32_bf16 v[92:95], v[140:143], a[116:119], v[92:95]
    s_add_u32 s7, s40, 3
    s_and_b32 s7, s7, 7
    s_mul_i32 s7, s7, 9216
    s_add_u32 s19, s7, s20
    buffer_load_dwordx4 v[180:183], v172, s[8:11], s19 offen sc1
    v_mfma_f32_16x16x32_bf16 v[96:99], v[212:215], a[180:183], v[96:99]
    v_mfma_f32_16x16x32_bf16 v[96:99], v[136:139], a[184:187], v[96:99]
    v_mfma_f32_16x16x32_bf16 v[96:99], v[140:143], a[188:191], v[96:99]
    v_mfma_f32_16x16x32_bf16 v[100:103], v[212:215], a[252:255], v[100:103]
    buffer_load_dwordx4 v[196:199], v173, s[8:11], s19 offen sc1
    v_mfma_f32_16x16x32_bf16 v[100:103], v[136:139], v[220:223], v[100:103]
    v_mfma_f32_16x16x32_bf16 v[100:103], v[140:143], v[224:227], v[100:103]
    s_waitcnt vmcnt(31)
    v_mfma_f32_16x16x32_bf16 v[88:91], v[144:147], a[48:51], v[88:91]
    v_mfma_f32_16x16x32_bf16 v[88:91], v[160:163], a[52:55], v[88:91]
    s_add_u32 s7, s40, 4
    s_and_b32 s7, s7, 7
    s_mul_i32 s7, s7, 9216
    s_add_u32 s19, s7, s20
    buffer_load_dwordx4 v[200:203], v172, s[8:11], s19 offen sc1
    v_mfma_f32_16x16x32_bf16 v[88:91], v[164:167], a[56:59], v[88:91]
    v_mfma_f32_16x16x32_bf16 v[92:95], v[144:147], a[120:123], v[92:95]
    v_mfma_f32_16x16x32_bf16 v[92:95], v[160:163], a[124:127], v[92:95]
    v_mfma_f32_16x16x32_bf16 v[92:95], v[164:167], a[128:131], v[92:95]
    buffer_load_dwordx4 v[204:207], v173, s[8:11], s19 offen sc1
    v_mfma_f32_16x16x32_bf16 v[96:99], v[144:147], a[192:195], v[96:99]
    v_mfma_f32_16x16x32_bf16 v[96:99], v[160:163], a[196:199], v[96:99]
    v_mfma_f32_16x16x32_bf16 v[96:99], v[164:167], a[200:203], v[96:99]
    v_mfma_f32_16x16x32_bf16 v[100:103], v[144:147], v[228:231], v[100:103]
    s_add_u32 s7, s40, 5
    s_and_b32 s7, s7, 7
    s_mul_i32 s7, s7, 9216
    s_add_u32 s19, s7, s20
    buffer_load_dwordx4 v[208:211], v172, s[8:11], s19 offen sc1
    v_mfma_f32_16x16x32_bf16 v[100:103], v[160:163], v[232:235], v[100:103]
    v_mfma_f32_16x16x32_bf16 v[100:103], v[164:167], v[236:239], v[100:103]
    s_waitcnt vmcnt(31)
    v_mfma_f32_16x16x32_bf16 v[88:91], v[168:171], a[60:63], v[88:91]
    v_mfma_f32_16x16x32_bf16 v[88:91], v[148:151], a[64:67], v[88:91]
    buffer_load_dwordx4 v[212:215], v173, s[8:11], s19 offen sc1
    v_mfma_f32_16x16x32_bf16 v[120:123], v[4:7], a[68:71], v[88:91]
    v_mfma_f32_16x16x32_bf16 v[92:95], v[168:171], a[132:135], v[92:95]
    v_mfma_f32_16x16x32_bf16 v[92:95], v[148:151], a[136:139], v[92:95]
    v_mfma_f32_16x16x32_bf16 v[124:127], v[4:7], a[140:143], v[92:95]
    s_add_u32 s7, s40, 6
    s_and_b32 s7, s7, 7
    s_mul_i32 s7, s7, 9216
    s_add_u32 s19, s7, s20
    buffer_load_dwordx4 v[136:139], v172, s[8:11], s19 offen sc1
    v_mfma_f32_16x16x32_bf16 v[96:99], v[168:171], a[204:207], v[96:99]
    s_mov_b32 s74, 268435456
    v_mfma_f32_16x16x32_bf16 v[96:99], v[148:151], a[208:211], v[96:99]
    s_add_u32 s27, s27, 1024
    v_mfma_f32_16x16x32_bf16 v[128:131], v[4:7], a[212:215], v[96:99]
    s_add_u32 s25, s25, 1
    v_mfma_f32_16x16x32_bf16 v[100:103], v[168:171], v[240:243], v[100:103]
    buffer_load_dwordx4 v[140:143], v173, s[8:11], s19 offen sc1
    v_mfma_f32_16x16x32_bf16 v[100:103], v[148:151], v[244:247], v[100:103]
    s_add_u32 s23, s23, 18432
    v_mfma_f32_16x16x32_bf16 v[132:135], v[4:7], v[248:251], v[100:103]
    s_waitcnt vmcnt(30)
    v_mfma_f32_16x16x32_bf16 v[88:91], v[16:19], a[0:3], 0
    v_mfma_f32_16x16x32_bf16 v[88:91], v[20:23], a[4:7], v[88:91]
    s_add_u32 s7, s40, 7
    s_and_b32 s7, s7, 7
    s_mul_i32 s7, s7, 9216
    s_add_u32 s19, s7, s20
    buffer_load_dwordx4 v[144:147], v172, s[8:11], s19 offen sc1
    v_mfma_f32_16x16x32_bf16 v[88:91], v[24:27], a[8:11], v[88:91]
    v_mfma_f32_16x16x32_bf16 v[92:95], v[16:19], a[72:75], 0
    v_mfma_f32_16x16x32_bf16 v[92:95], v[20:23], a[76:79], v[92:95]
    v_mfma_f32_16x16x32_bf16 v[92:95], v[24:27], a[80:83], v[92:95]
    buffer_load_dwordx4 v[160:163], v173, s[8:11], s19 offen sc1
    v_mfma_f32_16x16x32_bf16 v[96:99], v[16:19], a[144:147], 0
    v_cvt_pk_bf16_f32 v152, v120, v121
    v_cvt_pk_bf16_f32 v153, v122, v123
    v_mfma_f32_16x16x32_bf16 v[96:99], v[20:23], a[148:151], v[96:99]
    v_cvt_pk_bf16_f32 v154, v124, v125
    v_cvt_pk_bf16_f32 v155, v126, v127
    v_mfma_f32_16x16x32_bf16 v[96:99], v[24:27], a[152:155], v[96:99]
    s_nop 0
    v_permlane16_swap_b32 v152, v154
    v_mfma_f32_16x16x32_bf16 v[100:103], v[16:19], a[216:219], 0
    v_permlane16_swap_b32 v153, v155
    v_mfma_f32_16x16x32_bf16 v[100:103], v[20:23], a[220:223], v[100:103]
    buffer_store_dwordx4 v[152:155], v178, s[72:75], s27 offen sc1
    v_mfma_f32_16x16x32_bf16 v[100:103], v[24:27], a[224:227], v[100:103]
    ds_write_b128 v216, v[152:155]
    s_waitcnt vmcnt(30)
    v_mfma_f32_16x16x32_bf16 v[88:91], v[28:31], a[12:15], v[88:91]
    v_add_u32 v216, v216, v218
    v_cvt_pk_bf16_f32 v156, v128, v129
    v_mfma_f32_16x16x32_bf16 v[88:91], v[32:35], a[16:19], v[88:91]
    v_cvt_pk_bf16_f32 v157, v130, v131
    v_cvt_pk_bf16_f32 v158, v132, v133
    v_mfma_f32_16x16x32_bf16 v[88:91], v[36:39], a[20:23], v[88:91]
    v_cvt_pk_bf16_f32 v159, v134, v135
    v_mfma_f32_16x16x32_bf16 v[92:95], v[28:31], a[84:87], v[92:95]
    s_nop 0
    v_permlane16_swap_b32 v156, v158
    v_mfma_f32_16x16x32_bf16 v[92:95], v[32:35], a[88:91], v[92:95]
    v_permlane16_swap_b32 v157, v159
    v_mfma_f32_16x16x32_bf16 v[92:95], v[36:39], a[92:95], v[92:95]
    buffer_store_dwordx4 v[156:159], v179, s[72:75], s27 offen sc1
    v_mfma_f32_16x16x32_bf16 v[96:99], v[28:31], a[156:159], v[96:99]
    ds_write_b128 v217, v[156:159]
    v_mfma_f32_16x16x32_bf16 v[96:99], v[32:35], a[160:163], v[96:99]
    v_add_u32 v217, v217, v219
    v_mfma_f32_16x16x32_bf16 v[96:99], v[36:39], a[164:167], v[96:99]
    v_mfma_f32_16x16x32_bf16 v[100:103], v[28:31], a[228:231], v[100:103]
    v_mfma_f32_16x16x32_bf16 v[100:103], v[32:35], a[232:235], v[100:103]
    v_mfma_f32_16x16x32_bf16 v[100:103], v[36:39], a[236:239], v[100:103]
    s_waitcnt vmcnt(28)
    v_mfma_f32_16x16x32_bf16 v[88:91], v[40:43], a[24:27], v[88:91]
    v_mfma_f32_16x16x32_bf16 v[88:91], v[44:47], a[28:31], v[88:91]
    v_mfma_f32_16x16x32_bf16 v[88:91], v[48:51], a[32:35], v[88:91]
    v_mfma_f32_16x16x32_bf16 v[92:95], v[40:43], a[96:99], v[92:95]
    v_mfma_f32_16x16x32_bf16 v[92:95], v[44:47], a[100:103], v[92:95]
    v_mfma_f32_16x16x32_bf16 v[92:95], v[48:51], a[104:107], v[92:95]
    v_mfma_f32_16x16x32_bf16 v[96:99], v[40:43], a[168:171], v[96:99]
    v_mfma_f32_16x16x32_bf16 v[96:99], v[44:47], a[172:175], v[96:99]
    v_mfma_f32_16x16x32_bf16 v[96:99], v[48:51], a[176:179], v[96:99]
    v_mfma_f32_16x16x32_bf16 v[100:103], v[40:43], a[240:243], v[100:103]
    v_mfma_f32_16x16x32_bf16 v[100:103], v[44:47], a[244:247], v[100:103]
    v_mfma_f32_16x16x32_bf16 v[100:103], v[48:51], a[248:251], v[100:103]
    s_waitcnt vmcnt(24)
    v_mfma_f32_16x16x32_bf16 v[88:91], v[52:55], a[36:39], v[88:91]
    v_mfma_f32_16x16x32_bf16 v[88:91], v[56:59], a[40:43], v[88:91]
    v_mfma_f32_16x16x32_bf16 v[88:91], v[60:63], a[44:47], v[88:91]
    v_mfma_f32_16x16x32_bf16 v[92:95], v[52:55], a[108:111], v[92:95]
    v_mfma_f32_16x16x32_bf16 v[92:95], v[56:59], a[112:115], v[92:95]
    v_mfma_f32_16x16x32_bf16 v[92:95], v[60:63], a[116:119], v[92:95]
    v_mfma_f32_16x16x32_bf16 v[96:99], v[52:55], a[180:183], v[96:99]
    v_mfma_f32_16x16x32_bf16 v[96:99], v[56:59], a[184:187], v[96:99]
    v_mfma_f32_16x16x32_bf16 v[96:99], v[60:63], a[188:191], v[96:99]
    v_mfma_f32_16x16x32_bf16 v[100:103], v[52:55], a[252:255], v[100:103]
    v_mfma_f32_16x16x32_bf16 v[100:103], v[56:59], v[220:223], v[100:103]
    v_mfma_f32_16x16x32_bf16 v[100:103], v[60:63], v[224:227], v[100:103]
    s_waitcnt vmcnt(21)
    v_mfma_f32_16x16x32_bf16 v[88:91], v[64:67], a[48:51], v[88:91]
    v_mfma_f32_16x16x32_bf16 v[88:91], v[68:71], a[52:55], v[88:91]
    v_mfma_f32_16x16x32_bf16 v[88:91], v[72:75], a[56:59], v[88:91]
    v_mfma_f32_16x16x32_bf16 v[92:95], v[64:67], a[120:123], v[92:95]
    v_mfma_f32_16x16x32_bf16 v[92:95], v[68:71], a[124:127], v[92:95]
    v_mfma_f32_16x16x32_bf16 v[92:95], v[72:75], a[128:131], v[92:95]
    v_mfma_f32_16x16x32_bf16 v[96:99], v[64:67], a[192:195], v[96:99]
    v_mfma_f32_16x16x32_bf16 v[96:99], v[68:71], a[196:199], v[96:99]
    v_mfma_f32_16x16x32_bf16 v[96:99], v[72:75], a[200:203], v[96:99]
    v_mfma_f32_16x16x32_bf16 v[100:103], v[64:67], v[228:231], v[100:103]
    v_mfma_f32_16x16x32_bf16 v[100:103], v[68:71], v[232:235], v[100:103]
    v_mfma_f32_16x16x32_bf16 v[100:103], v[72:75], v[236:239], v[100:103]
    s_waitcnt vmcnt(18)
    v_mfma_f32_16x16x32_bf16 v[88:91], v[76:79], a[60:63], v[88:91]
    v_mfma_f32_16x16x32_bf16 v[88:91], v[80:83], a[64:67], v[88:91]
    v_mfma_f32_16x16x32_bf16 v[120:123], v[84:87], a[68:71], v[88:91]
    v_mfma_f32_16x16x32_bf16 v[92:95], v[76:79], a[132:135], v[92:95]
    v_mfma_f32_16x16x32_bf16 v[92:95], v[80:83], a[136:139], v[92:95]
    v_mfma_f32_16x16x32_bf16 v[124:127], v[84:87], a[140:143], v[92:95]
    v_mfma_f32_16x16x32_bf16 v[96:99], v[76:79], a[204:207], v[96:99]
    s_mov_b32 s74, 268435456
    v_mfma_f32_16x16x32_bf16 v[96:99], v[80:83], a[208:211], v[96:99]
    s_add_u32 s27, s27, 1024
    v_mfma_f32_16x16x32_bf16 v[128:131], v[84:87], a[212:215], v[96:99]
    s_add_u32 s25, s25, 1
    v_mfma_f32_16x16x32_bf16 v[100:103], v[76:79], v[240:243], v[100:103]
    v_mfma_f32_16x16x32_bf16 v[100:103], v[80:83], v[244:247], v[100:103]
    s_add_u32 s23, s23, 18432
    v_mfma_f32_16x16x32_bf16 v[132:135], v[84:87], v[248:251], v[100:103]
    s_nop 7
    v_cvt_pk_bf16_f32 v152, v120, v121
    v_cvt_pk_bf16_f32 v153, v122, v123
    v_cvt_pk_bf16_f32 v154, v124, v125
    v_cvt_pk_bf16_f32 v155, v126, v127
    v_cvt_pk_bf16_f32 v156, v128, v129
    v_cvt_pk_bf16_f32 v157, v130, v131
    v_cvt_pk_bf16_f32 v158, v132, v133
    v_cvt_pk_bf16_f32 v159, v134, v135
    s_nop 0
    v_permlane16_swap_b32 v152, v154
    v_permlane16_swap_b32 v153, v155
    buffer_store_dwordx4 v[152:155], v178, s[72:75], s27 offen sc1
    s_nop 0
    v_permlane16_swap_b32 v156, v158
    v_permlane16_swap_b32 v157, v159
    buffer_store_dwordx4 v[156:159], v179, s[72:75], s27 offen sc1
    ds_write_b128 v216, v[152:155]
    ds_write_b128 v217, v[156:159]
    s_waitcnt lgkmcnt(0)
    v_lshlrev_b32 v15, 7, v0
    s_lshl_b32 s6, s40, 2
    s_add_u32 s6, s6, s44
    s_add_u32 s6, s6, 65536
    v_mov_b32 v1, s76
    s_mov_b64 vcc, 0xff
    s_waitcnt vmcnt(0)
    s_barrier
    s_cmp_lg_u32 s3, 0
    s_cbranch_scc1 L_pub_40
    s_mov_b64 exec, vcc
    buffer_store_dword v1, v15, s[8:11], s6 offen sc1
L_pub_40:
    s_mov_b64 exec, -1
    s_add_u32 s19, s18, s43
    s_add_u32 s22, s19, 45875200
    s_lshl_b32 s23, s21, 5
    s_add_u32 s23, s23, s43
    s_add_u32 s23, s23, 48431104
    v_and_b32 v12, 7, v0
    v_lshlrev_b32 v12, 2, v12
    buffer_load_dword v10, v12, s[8:11], s23 offen sc1
    buffer_load_dwordx4 v[92:95], v172, s[8:11], s22 offen sc1
    buffer_load_dwordx4 v[96:99], v173, s[8:11], s22 offen sc1
    buffer_load_dwordx4 v[100:103], v174, s[8:11], s22 offen sc1
    v_min_u32 v13, 9216, v173
    ds_read_b128 v[148:151], v172 offset:4096
    ds_read_b128 v[152:155], v13 offset:4096
    ds_read_b128 v[156:159], v174 offset:4096
    s_lshl_b32 s28, s40, 2
    s_add_u32 s28, s28, s3
    s_mul_i32 s28, s28, 73728
    s_mul_i32 s7, s42, 1073741824
    v_add_u32 v3, s7, v253
    v_lshlrev_b32 v16, 16, v104
    v_and_b32 v17, s16, v104
    v_lshlrev_b32 v18, 16, v105
    v_and_b32 v19, s16, v105
    v_lshlrev_b32 v20, 16, v106
    v_and_b32 v21, s16, v106
    v_lshlrev_b32 v22, 16, v107
    v_and_b32 v23, s16, v107
    v_lshlrev_b32 v24, 16, v108
    v_and_b32 v25, s16, v108
    v_lshlrev_b32 v26, 16, v109
    v_and_b32 v27, s16, v109
    v_lshlrev_b32 v28, 16, v110
    v_and_b32 v29, s16, v110
    v_lshlrev_b32 v30, 16, v111
    v_and_b32 v31, s16, v111
    s_cmp_lg_u32 s42, 0
    s_cbranch_scc1 L_nopf_41
    buffer_load_dwordx4 a[0:3], v3, s[8:11], s28 offen offset:0 sc1
    buffer_load_dwordx4 a[4:7], v3, s[8:11], s28 offen offset:1024 sc1
    buffer_load_dwordx4 a[8:11], v3, s[8:11], s28 offen offset:2048 sc1
    buffer_load_dwordx4 a[12:15], v3, s[8:11], s28 offen offset:3072 sc1
    s_add_u32 s28, s28, 4096
    buffer_load_dwordx4 a[16:19], v3, s[8:11], s28 offen offset:0 sc1
    buffer_load_dwordx4 a[20:23], v3, s[8:11], s28 offen offset:1024 sc1
    buffer_load_dwordx4 a[24:27], v3, s[8:11], s28 offen offset:2048 sc1
    buffer_load_dwordx4 a[28:31], v3, s[8:11], s28 offen offset:3072 sc1
L_nopf_41:
    v_lshlrev_b32 v40, 16, v112
    v_and_b32 v41, s16, v112
    v_lshlrev_b32 v42, 16, v113
    v_and_b32 v43, s16, v113
    v_lshlrev_b32 v44, 16, v114
    v_and_b32 v45, s16, v114
    v_lshlrev_b32 v46, 16, v115
    v_and_b32 v47, s16, v115
    v_pk_add_f32 v[16:17], v[16:17], v[40:41]
    v_pk_add_f32 v[18:19], v[18:19], v[42:43]
    v_pk_add_f32 v[20:21], v[20:21], v[44:45]
    v_pk_add_f32 v[22:23], v[22:23], v[46:47]
    v_lshlrev_b32 v40, 16, v116
    v_and_b32 v41, s16, v116
    v_lshlrev_b32 v42, 16, v117
    v_and_b32 v43, s16, v117
    v_lshlrev_b32 v44, 16, v118
    v_and_b32 v45, s16, v118
    v_lshlrev_b32 v46, 16, v119
    v_and_b32 v47, s16, v119
    v_pk_add_f32 v[24:25], v[24:25], v[40:41]
    v_pk_add_f32 v[26:27], v[26:27], v[42:43]
    v_pk_add_f32 v[28:29], v[28:29], v[44:45]
    v_pk_add_f32 v[30:31], v[30:31], v[46:47]
    s_cmp_lg_u32 s42, 0
    s_cbranch_scc1 L_nopf_42
    s_add_u32 s28, s28, 4096
    buffer_load_dwordx4 a[32:35], v3, s[8:11], s28 offen offset:0 sc1
    buffer_load_dwordx4 a[36:39], v3, s[8:11], s28 offen offset:1024 sc1
    buffer_load_dwordx4 a[40:43], v3, s[8:11], s28 offen offset:2048 sc1
    buffer_load_dwordx4 a[44:47], v3, s[8:11], s28 offen offset:3072 sc1
    s_add_u32 s28, s28, 4096
    buffer_load_dwordx4 a[48:51], v3, s[8:11], s28 offen offset:0 sc1
    buffer_load_dwordx4 a[52:55], v3, s[8:11], s28 offen offset:1024 sc1
    buffer_load_dwordx4 a[56:59], v3, s[8:11], s28 offen offset:2048 sc1
    buffer_load_dwordx4 a[60:63], v3, s[8:11], s28 offen offset:3072 sc1
L_nopf_42:
    v_lshlrev_b32 v40, 16, v180
    v_and_b32 v41, s16, v180
    v_lshlrev_b32 v42, 16, v181
    v_and_b32 v43, s16, v181
    v_lshlrev_b32 v44, 16, v182
    v_and_b32 v45, s16, v182
    v_lshlrev_b32 v46, 16, v183
    v_and_b32 v47, s16, v183
    v_pk_add_f32 v[16:17], v[16:17], v[40:41]
    v_pk_add_f32 v[18:19], v[18:19], v[42:43]
    v_pk_add_f32 v[20:21], v[20:21], v[44:45]
    v_pk_add_f32 v[22:23], v[22:23], v[46:47]
    v_lshlrev_b32 v40, 16, v196
    v_and_b32 v41, s16, v196
    v_lshlrev_b32 v42, 16, v197
    v_and_b32 v43, s16, v197
    v_lshlrev_b32 v44, 16, v198
    v_and_b32 v45, s16, v198
    v_lshlrev_b32 v46, 16, v199
    v_and_b32 v47, s16, v199
    v_pk_add_f32 v[24:25], v[24:25], v[40:41]
    v_pk_add_f32 v[26:27], v[26:27], v[42:43]
    v_pk_add_f32 v[28:29], v[28:29], v[44:45]
    v_pk_add_f32 v[30:31], v[30:31], v[46:47]
    v_lshlrev_b32 v40, 16, v200
    v_and_b32 v41, s16, v200
    v_lshlrev_b32 v42, 16, v201
    v_and_b32 v43, s16, v201
    v_lshlrev_b32 v44, 16, v202
    v_and_b32 v45, s16, v202
    v_lshlrev_b32 v46, 16, v203
    v_and_b32 v47, s16, v203
    v_pk_add_f32 v[16:17], v[16:17], v[40:41]
    v_pk_add_f32 v[18:19], v[18:19], v[42:43]
    v_pk_add_f32 v[20:21], v[20:21], v[44:45]
    v_pk_add_f32 v[22:23], v[22:23], v[46:47]
    v_lshlrev_b32 v40, 16, v204
    v_and_b32 v41, s16, v204
    v_lshlrev_b32 v42, 16, v205
    v_and_b32 v43, s16, v205
    v_lshlrev_b32 v44, 16, v206
    v_and_b32 v45, s16, v206
    v_lshlrev_b32 v46, 16, v207
    v_and_b32 v47, s16, v207
    v_pk_add_f32 v[24:25], v[24:25], v[40:41]
    v_pk_add_f32 v[26:27], v[26:27], v[42:43]
    v_pk_add_f32 v[28:29], v[28:29], v[44:45]
    v_pk_add_f32 v[30:31], v[30:31], v[46:47]
    s_cmp_lg_u32 s3, 3
    s_cbranch_scc1 L_pollout_45
    s_lshl_b32 s7, s40, 7
    s_add_u32 s7, s7, s44
    s_add_u32 s7, s7, 65536
    s_add_u32 s52, s4, s7
    s_addc_u32 s53, s5, 0
    s_mov_b32 s6, 0
L_poll_43:
    s_load_dwordx8 s[56:63], s[52:53], 0 glc
    s_add_u32 s6, s6, 1
    s_waitcnt lgkmcnt(0)
    s_xor_b64 s[56:57], s[56:57], s[76:77]
    s_xor_b64 s[58:59], s[58:59], s[76:77]
    s_xor_b64 s[60:61], s[60:61], s[76:77]
    s_xor_b64 s[62:63], s[62:63], s[76:77]
    s_or_b64 s[56:57], s[56:57], s[58:59]
    s_or_b64 s[60:61], s[60:61], s[62:63]
    s_or_b64 s[56:57], s[56:57], s[60:61]
    s_cbranch_scc0 L_polled_44
    s_cmp_lt_u32 s6, 1048576
    s_cbranch_scc1 L_poll_43
    s_branch L_main_end
L_polled_44:
L_pollout_45:
    s_barrier
    s_add_u32 s7, s40, 1
    s_and_b32 s7, s7, 7
    s_mul_i32 s7, s7, 9216
    s_add_u32 s19, s7, s20
    buffer_load_dwordx4 v[60:63], v174, s[8:11], s19 offen sc1
    s_add_u32 s7, s40, 2
    s_and_b32 s7, s7, 7
    s_mul_i32 s7, s7, 9216
    s_add_u32 s19, s7, s20
    buffer_load_dwordx4 v[64:67], v174, s[8:11], s19 offen sc1
    s_add_u32 s7, s40, 3
    s_and_b32 s7, s7, 7
    s_mul_i32 s7, s7, 9216
    s_add_u32 s19, s7, s20
    buffer_load_dwordx4 v[68:71], v174, s[8:11], s19 offen sc1
    s_add_u32 s7, s40, 4
    s_and_b32 s7, s7, 7
    s_mul_i32 s7, s7, 9216
    s_add_u32 s19, s7, s20
    buffer_load_dwordx4 v[72:75], v174, s[8:11], s19 offen sc1
    s_add_u32 s7, s40, 5
    s_and_b32 s7, s7, 7
    s_mul_i32 s7, s7, 9216
    s_add_u32 s19, s7, s20
    buffer_load_dwordx4 v[76:79], v174, s[8:11], s19 offen sc1
    s_add_u32 s7, s40, 6
    s_and_b32 s7, s7, 7
    s_mul_i32 s7, s7, 9216
    s_add_u32 s19, s7, s20
    buffer_load_dwordx4 v[80:83], v174, s[8:11], s19 offen sc1
    s_add_u32 s7, s40, 7
    s_and_b32 s7, s7, 7
    s_mul_i32 s7, s7, 9216
    s_add_u32 s19, s7, s20
    buffer_load_dwordx4 v[84:87], v174, s[8:11], s19 offen sc1
    v_lshlrev_b32 v40, 16, v208
    v_and_b32 v41, s16, v208
    v_lshlrev_b32 v42, 16, v209
    v_and_b32 v43, s16, v209
    v_lshlrev_b32 v44, 16, v210
    v_and_b32 v45, s16, v210
    v_lshlrev_b32 v46, 16, v211
    v_and_b32 v47, s16, v211
    v_pk_add_f32 v[16:17], v[16:17], v[40:41]
    v_pk_add_f32 v[18:19], v[18:19], v[42:43]
    v_pk_add_f32 v[20:21], v[20:21], v[44:45]
    v_pk_add_f32 v[22:23], v[22:23], v[46:47]
    v_lshlrev_b32 v40, 16, v212
    v_and_b32 v41, s16, v212
    v_lshlrev_b32 v42, 16, v213
    v_and_b32 v43, s16, v213
    v_lshlrev_b32 v44, 16, v214
    v_and_b32 v45, s16, v214
    v_lshlrev_b32 v46, 16, v215
    v_and_b32 v47, s16, v215
    v_pk_add_f32 v[24:25], v[24:25], v[40:41]
    v_pk_add_f32 v[26:27], v[26:27], v[42:43]
    v_pk_add_f32 v[28:29], v[28:29], v[44:45]
    v_pk_add_f32 v[30:31], v[30:31], v[46:47]
    v_lshlrev_b32 v40, 16, v136
    v_and_b32 v41, s16, v136
    v_lshlrev_b32 v42, 16, v137
    v_and_b32 v43, s16, v137
    v_lshlrev_b32 v44, 16, v138
    v_and_b32 v45, s16, v138
    v_lshlrev_b32 v46, 16, v139
    v_and_b32 v47, s16, v139
    v_pk_add_f32 v[16:17], v[16:17], v[40:41]
    v_pk_add_f32 v[18:19], v[18:19], v[42:43]
    v_pk_add_f32 v[20:21], v[20:21], v[44:45]
    v_pk_add_f32 v[22:23], v[22:23], v[46:47]
    v_lshlrev_b32 v40, 16, v140
    v_and_b32 v41, s16, v140
    v_lshlrev_b32 v42, 16, v141
    v_and_b32 v43, s16, v141
    v_lshlrev_b32 v44, 16, v142
    v_and_b32 v45, s16, v142
    v_lshlrev_b32 v46, 16, v143
    v_and_b32 v47, s16, v143
    v_pk_add_f32 v[24:25], v[24:25], v[40:41]
    v_pk_add_f32 v[26:27], v[26:27], v[42:43]
    v_pk_add_f32 v[28:29], v[28:29], v[44:45]
    v_pk_add_f32 v[30:31], v[30:31], v[46:47]
    v_lshlrev_b32 v40, 16, v144
    v_and_b32 v41, s16, v144
    v_lshlrev_b32 v42, 16, v145
    v_and_b32 v43, s16, v145
    v_lshlrev_b32 v44, 16, v146
    v_and_b32 v45, s16, v146
    v_lshlrev_b32 v46, 16, v147
    v_and_b32 v47, s16, v147
    v_pk_add_f32 v[16:17], v[16:17], v[40:41]
    v_pk_add_f32 v[18:19], v[18:19], v[42:43]
    v_pk_add_f32 v[20:21], v[20:21], v[44:45]
    v_pk_add_f32 v[22:23], v[22:23], v[46:47]
    v_lshlrev_b32 v40, 16, v160
    v_and_b32 v41, s16, v160
    v_lshlrev_b32 v42, 16, v161
    v_and_b32 v43, s16, v161
    v_lshlrev_b32 v44, 16, v162
    v_and_b32 v45, s16, v162
    v_lshlrev_b32 v46, 16, v163
    v_and_b32 v47, s16, v163
    v_pk_add_f32 v[24:25], v[24:25], v[40:41]
    v_pk_add_f32 v[26:27], v[26:27], v[42:43]
    v_pk_add_f32 v[28:29], v[28:29], v[44:45]
    v_pk_add_f32 v[30:31], v[30:31], v[46:47]
    s_cmp_eq_u32 s3, 0
    s_cselect_b32 s7, 1.0, 0
    s_cselect_b32 s6, -1, 0
    s_waitcnt vmcnt(7) lgkmcnt(0)
    v_and_b32 v152, s6, v152
    v_and_b32 v153, s6, v153
    v_and_b32 v154, s6, v154
    v_and_b32 v155, s6, v155
    v_mul_f32 v11, s7, v10
    v_lshlrev_b32 v40, 16, v92
    v_and_b32 v41, s16, v92
    v_lshlrev_b32 v42, 16, v93
    v_and_b32 v43, s16, v93
    v_lshlrev_b32 v44, 16, v94
    v_and_b32 v45, s16, v94
    v_lshlrev_b32 v46, 16, v95
    v_and_b32 v47, s16, v95
    v_pk_add_f32 v[16:17], v[16:17], v[40:41]
    v_pk_add_f32 v[18:19], v[18:19], v[42:43]
    v_pk_add_f32 v[20:21], v[20:21], v[44:45]
    v_pk_add_f32 v[22:23], v[22:23], v[46:47]
    v_lshlrev_b32 v40, 16, v96
    v_and_b32 v41, s16, v96
    v_lshlrev_b32 v42, 16, v97
    v_and_b32 v43, s16, v97
    v_lshlrev_b32 v44, 16, v98
    v_and_b32 v45, s16, v98
    v_lshlrev_b32 v46, 16, v99
    v_and_b32 v47, s16, v99
    v_pk_add_f32 v[24:25], v[24:25], v[40:41]
    v_pk_add_f32 v[26:27], v[26:27], v[42:43]
    v_pk_add_f32 v[28:29], v[28:29], v[44:45]
    v_pk_add_f32 v[30:31], v[30:31], v[46:47]
    v_lshlrev_b32 v32, 16, v100
    v_and_b32 v33, s16, v100
    v_lshlrev_b32 v34, 16, v101
    v_and_b32 v35, s16, v101
    v_lshlrev_b32 v36, 16, v102
    v_and_b32 v37, s16, v102
    v_lshlrev_b32 v38, 16, v103
    v_and_b32 v39, s16, v103
    v_lshlrev_b32 v40, 16, v148
    v_and_b32 v41, s16, v148
    v_lshlrev_b32 v42, 16, v149
    v_and_b32 v43, s16, v149
    v_lshlrev_b32 v44, 16, v150
    v_and_b32 v45, s16, v150
    v_lshlrev_b32 v46, 16, v151
    v_and_b32 v47, s16, v151
    v_pk_add_f32 v[16:17], v[16:17], v[40:41]
    v_pk_add_f32 v[18:19], v[18:19], v[42:43]
    v_pk_add_f32 v[20:21], v[20:21], v[44:45]
    v_pk_add_f32 v[22:23], v[22:23], v[46:47]
    v_lshlrev_b32 v40, 16, v152
    v_and_b32 v41, s16, v152
    v_lshlrev_b32 v42, 16, v153
    v_and_b32 v43, s16, v153
    v_lshlrev_b32 v44, 16, v154
    v_and_b32 v45, s16, v154
    v_lshlrev_b32 v46, 16, v155
    v_and_b32 v47, s16, v155
    v_pk_add_f32 v[24:25], v[24:25], v[40:41]
    v_pk_add_f32 v[26:27], v[26:27], v[42:43]
    v_pk_add_f32 v[28:29], v[28:29], v[44:45]
    v_pk_add_f32 v[30:31], v[30:31], v[46:47]
    v_lshlrev_b32 v40, 16, v156
    v_and_b32 v41, s16, v156
    v_lshlrev_b32 v42, 16, v157
    v_and_b32 v43, s16, v157
    v_lshlrev_b32 v44, 16, v158
    v_and_b32 v45, s16, v158
    v_lshlrev_b32 v46, 16, v159
    v_and_b32 v47, s16, v159
    v_pk_add_f32 v[32:33], v[32:33], v[40:41]
    v_pk_add_f32 v[34:35], v[34:35], v[42:43]
    v_pk_add_f32 v[36:37], v[36:37], v[44:45]
    v_pk_add_f32 v[38:39], v[38:39], v[46:47]
    v_pk_add_f32 v[16:17], v[16:17], v[10:11] op_sel_hi:[1,0]
    v_pk_add_f32 v[18:19], v[18:19], v[10:11] op_sel_hi:[1,0]
    v_pk_add_f32 v[20:21], v[20:21], v[10:11] op_sel_hi:[1,0]
    v_pk_add_f32 v[22:23], v[22:23], v[10:11] op_sel_hi:[1,0]
    v_pk_add_f32 v[24:25], v[24:25], v[10:11] op_sel:[0,1] op_sel_hi:[1,1]
    v_pk_add_f32 v[26:27], v[26:27], v[10:11] op_sel:[0,1] op_sel_hi:[1,1]
    v_pk_add_f32 v[28:29], v[28:29], v[10:11] op_sel:[0,1] op_sel_hi:[1,1]
    v_pk_add_f32 v[30:31], v[30:31], v[10:11] op_sel:[0,1] op_sel_hi:[1,1]
    v_pk_add_f32 v[32:33], v[32:33], v[10:11] op_sel_hi:[1,0]
    v_pk_add_f32 v[34:35], v[34:35], v[10:11] op_sel_hi:[1,0]
    v_pk_add_f32 v[36:37], v[36:37], v[10:11] op_sel_hi:[1,0]
    v_pk_add_f32 v[38:39], v[38:39], v[10:11] op_sel_hi:[1,0]
    s_waitcnt vmcnt(6)
    s_add_u32 s28, s28, 4096
    buffer_load_dwordx4 a[64:67], v3, s[8:11], s28 offen offset:0 sc1
    v_lshlrev_b32 v40, 16, v60
    v_and_b32 v41, s16, v60
    v_lshlrev_b32 v42, 16, v61
    v_and_b32 v43, s16, v61
    v_lshlrev_b32 v44, 16, v62
    v_and_b32 v45, s16, v62
    v_lshlrev_b32 v46, 16, v63
    v_and_b32 v47, s16, v63
    v_pk_add_f32 v[32:33], v[32:33], v[40:41]
    v_pk_add_f32 v[34:35], v[34:35], v[42:43]
    v_pk_add_f32 v[36:37], v[36:37], v[44:45]
    v_pk_add_f32 v[38:39], v[38:39], v[46:47]
    s_waitcnt vmcnt(6)
    buffer_load_dwordx4 a[68:71], v3, s[8:11], s28 offen offset:1024 sc1
    v_lshlrev_b32 v40, 16, v64
    v_and_b32 v41, s16, v64
    v_lshlrev_b32 v42, 16, v65
    v_and_b32 v43, s16, v65
    v_lshlrev_b32 v44, 16, v66
    v_and_b32 v45, s16, v66
    v_lshlrev_b32 v46, 16, v67
    v_and_b32 v47, s16, v67
    v_pk_add_f32 v[32:33], v[32:33], v[40:41]
    v_pk_add_f32 v[34:35], v[34:35], v[42:43]
    v_pk_add_f32 v[36:37], v[36:37], v[44:45]
    v_pk_add_f32 v[38:39], v[38:39], v[46:47]
    s_waitcnt vmcnt(6)
    buffer_load_dwordx4 a[72:75], v3, s[8:11], s28 offen offset:2048 sc1
    v_lshlrev_b32 v40, 16, v68
    v_and_b32 v41, s16, v68
    v_lshlrev_b32 v42, 16, v69
    v_and_b32 v43, s16, v69
    v_lshlrev_b32 v44, 16, v70
    v_and_b32 v45, s16, v70
    v_lshlrev_b32 v46, 16, v71
    v_and_b32 v47, s16, v71
    v_pk_add_f32 v[32:33], v[32:33], v[40:41]
    v_pk_add_f32 v[34:35], v[34:35], v[42:43]
    v_pk_add_f32 v[36:37], v[36:37], v[44:45]
    v_pk_add_f32 v[38:39], v[38:39], v[46:47]
    s_waitcnt vmcnt(6)
    buffer_load_dwordx4 a[76:79], v3, s[8:11], s28 offen offset:3072 sc1
    v_lshlrev_b32 v40, 16, v72
    v_and_b32 v41, s16, v72
    v_lshlrev_b32 v42, 16, v73
    v_and_b32 v43, s16, v73
    v_lshlrev_b32 v44, 16, v74
    v_and_b32 v45, s16, v74
    v_lshlrev_b32 v46, 16, v75
    v_and_b32 v47, s16, v75
    v_pk_add_f32 v[32:33], v[32:33], v[40:41]
    v_pk_add_f32 v[34:35], v[34:35], v[42:43]
    v_pk_add_f32 v[36:37], v[36:37], v[44:45]
    v_pk_add_f32 v[38:39], v[38:39], v[46:47]
    s_waitcnt vmcnt(6)
    s_add_u32 s28, s28, 4096
    buffer_load_dwordx4 a[80:83], v3, s[8:11], s28 offen offset:0 sc1
    v_lshlrev_b32 v40, 16, v76
    v_and_b32 v41, s16, v76
    v_lshlrev_b32 v42, 16, v77
    v_and_b32 v43, s16, v77
    v_lshlrev_b32 v44, 16, v78
    v_and_b32 v45, s16, v78
    v_lshlrev_b32 v46, 16, v79
    v_and_b32 v47, s16, v79
    v_pk_add_f32 v[32:33], v[32:33], v[40:41]
    v_pk_add_f32 v[34:35], v[34:35], v[42:43]
    v_pk_add_f32 v[36:37], v[36:37], v[44:45]
    v_pk_add_f32 v[38:39], v[38:39], v[46:47]
    s_waitcnt vmcnt(6)
    buffer_load_dwordx4 a[84:87], v3, s[8:11], s28 offen offset:1024 sc1
    v_lshlrev_b32 v40, 16, v80
    v_and_b32 v41, s16, v80
    v_lshlrev_b32 v42, 16, v81
    v_and_b32 v43, s16, v81
    v_lshlrev_b32 v44, 16, v82
    v_and_b32 v45, s16, v82
    v_lshlrev_b32 v46, 16, v83
    v_and_b32 v47, s16, v83
    v_pk_add_f32 v[32:33], v[32:33], v[40:41]
    v_pk_add_f32 v[34:35], v[34:35], v[42:43]
    v_pk_add_f32 v[36:37], v[36:37], v[44:45]
    v_pk_add_f32 v[38:39], v[38:39], v[46:47]
    s_waitcnt vmcnt(6)
    buffer_load_dwordx4 a[88:91], v3, s[8:11], s28 offen offset:2048 sc1
    v_lshlrev_b32 v40, 16, v84
    v_and_b32 v41, s16, v84
    v_lshlrev_b32 v42, 16, v85
    v_and_b32 v43, s16, v85
    v_lshlrev_b32 v44, 16, v86
    v_and_b32 v45, s16, v86
    v_lshlrev_b32 v46, 16, v87
    v_and_b32 v47, s16, v87
    v_pk_add_f32 v[32:33], v[32:33], v[40:41]
    v_pk_add_f32 v[34:35], v[34:35], v[42:43]
    v_pk_add_f32 v[36:37], v[36:37], v[44:45]
    v_pk_add_f32 v[38:39], v[38:39], v[46:47]
    buffer_load_dwordx4 a[92:95], v3, s[8:11], s28 offen offset:3072 sc1
    v_cvt_pk_bf16_f32 v120, v16, v17
    v_cvt_pk_bf16_f32 v121, v18, v19
    v_cvt_pk_bf16_f32 v122, v20, v21
    v_cvt_pk_bf16_f32 v123, v22, v23
    v_cvt_pk_bf16_f32 v124, v24, v25
    v_cvt_pk_bf16_f32 v125, v26, v27
    v_cvt_pk_bf16_f32 v126, v28, v29
    v_cvt_pk_bf16_f32 v127, v30, v31
    v_cvt_pk_bf16_f32 v128, v32, v33
    v_cvt_pk_bf16_f32 v129, v34, v35
    v_cvt_pk_bf16_f32 v130, v36, v37
    v_cvt_pk_bf16_f32 v131, v38, v39
    s_cmp_lg_u32 s42, 0
    s_cbranch_scc1 L_main_last
    s_add_u32 s19, s18, 43515904
    s_add_u32 s20, s18, 38797312
    s_lshl_b32 s22, s21, 7
    s_add_u32 s22, s22, 48234496
    buffer_store_dwordx4 v[120:123], v172, s[8:11], s19 offen sc1
    buffer_store_dwordx4 v[124:127], v173, s[8:11], s19 offen sc1
    buffer_store_dwordx4 v[128:131], v174, s[8:11], s19 offen sc1
    s_mov_b32 s17, 0x3f803f80
    v_mov_b32 v8, 0
    v_mov_b32 v9, 0
    v_mov_b32 v10, 0
    v_mov_b32 v11, 0
    v_dot2c_f32_bf16 v8, s17, v120
    v_dot2c_f32_bf16 v9, v120, v120
    v_dot2c_f32_bf16 v10, s17, v121
    v_dot2c_f32_bf16 v11, v121, v121
    v_dot2c_f32_bf16 v8, s17, v122
    v_dot2c_f32_bf16 v9, v122, v122
    v_dot2c_f32_bf16 v10, s17, v123
    v_dot2c_f32_bf16 v11, v123, v123
    v_dot2c_f32_bf16 v8, s17, v124
    v_dot2c_f32_bf16 v9, v124, v124
    v_dot2c_f32_bf16 v10, s17, v125
    v_dot2c_f32_bf16 v11, v125, v125
    v_dot2c_f32_bf16 v8, s17, v126
    v_dot2c_f32_bf16 v9, v126, v126
    v_dot2c_f32_bf16 v10, s17, v127
    v_dot2c_f32_bf16 v11, v127, v127
    v_dot2c_f32_bf16 v8, s17, v128
    v_dot2c_f32_bf16 v9, v128, v128
    v_dot2c_f32_bf16 v10, s17, v129
    v_dot2c_f32_bf16 v11, v129, v129
    v_dot2c_f32_bf16 v8, s17, v130
    v_dot2c_f32_bf16 v9, v130, v130
    v_dot2c_f32_bf16 v10, s17, v131
    v_dot2c_f32_bf16 v11, v131, v131
    v_and_b32 v12, 7, v0
    v_lshlrev_b32 v12, 3, v12
    s_lshl_b32 s7, s3, 6
    v_add_u32 v13, s7, v12
    v_pk_add_f32 v[8:9], v[8:9], v[10:11]
    s_nop 1
    v_add_f32_dpp v8, v8, v8 row_ror:8 row_mask:0xf bank_mask:0xf
    v_add_f32_dpp v9, v9, v9 row_ror:8 row_mask:0xf bank_mask:0xf
    v_mov_b32 v10, v8
    v_mov_b32 v11, v9
    s_nop 1
    v_permlane32_swap_b32 v10, v8
    v_permlane32_swap_b32 v11, v9
    v_add_f32 v8, v8, v10
    v_add_f32 v9, v9, v11
    v_mov_b32 v10, v8
    v_mov_b32 v11, v9
    s_nop 1
    v_permlane16_swap_b32 v10, v8
    v_permlane16_swap_b32 v11, v9
    v_add_f32 v8, v8, v10
    v_add_f32 v9, v9, v11
    ds_write_b64 v13, v[8:9]
    s_waitcnt lgkmcnt(0)
    s_barrier
    ds_read_b64 v[40:41], v12 offset:0
    ds_read_b64 v[42:43], v12 offset:64
    ds_read_b64 v[44:45], v12 offset:128
    ds_read_b64 v[46:47], v12 offset:192
    s_waitcnt lgkmcnt(0)
    v_pk_add_f32 v[40:41], v[40:41], v[42:43]
    v_pk_add_f32 v[44:45], v[44:45], v[46:47]
    v_pk_add_f32 v[8:9], v[40:41], v[44:45]
    v_mul_f32 v8, 0x3ae38e39, v8
    v_mul_f32 v9, 0x3ae38e39, v9
    v_fma_f32 v9, -v8, v8, v9
    v_max_f32 v9, 0, v9
    v_add_f32 v9, 0x3727c5ac, v9
    v_rsq_f32 v10, v9
    s_nop 0
    v_mul_f32 v12, v8, v10
    v_mov_b32 v11, v10
    v_sub_f32 v12, 0, v12
    v_mov_b32 v13, v12
    s_cmp_eq_u32 s3, 0
    s_cselect_b32 s7, 32, 0
    v_lshlrev_b32 v14, 2, v0
    v_cmp_gt_u32 vcc, s7, v0
    v_mov_b32 v9, 1073741824
    s_nop 0
    v_cndmask_b32 v14, v9, v14, vcc
    buffer_store_dword v8, v14, s[8:11], s22 offen sc1
    v_lshlrev_b32 v40, 16, v120
    v_and_b32 v41, s16, v120
    v_lshlrev_b32 v42, 16, v121
    v_and_b32 v43, s16, v121
    v_lshlrev_b32 v44, 16, v122
    v_and_b32 v45, s16, v122
    v_lshlrev_b32 v46, 16, v123
    v_and_b32 v47, s16, v123
    v_pk_fma_f32 v[40:41], v[40:41], v[10:11], v[12:13]
    v_pk_fma_f32 v[42:43], v[42:43], v[10:11], v[12:13]
    v_pk_fma_f32 v[44:45], v[44:45], v[10:11], v[12:13]
    v_pk_fma_f32 v[46:47], v[46:47], v[10:11], v[12:13]
    v_cvt_pk_bf16_f32 v48, v40, v41
    v_cvt_pk_bf16_f32 v49, v42, v43
    v_cvt_pk_bf16_f32 v50, v44, v45
    v_cvt_pk_bf16_f32 v51, v46, v47
    v_lshlrev_b32 v40, 16, v124
    v_and_b32 v41, s16, v124
    v_lshlrev_b32 v42, 16, v125
    v_and_b32 v43, s16, v125
    v_lshlrev_b32 v44, 16, v126
    v_and_b32 v45, s16, v126
    v_lshlrev_b32 v46, 16, v127
    v_and_b32 v47, s16, v127
    v_pk_fma_f32 v[40:41], v[40:41], v[10:11], v[12:13]
    v_pk_fma_f32 v[42:43], v[42:43], v[10:11], v[12:13]
    v_pk_fma_f32 v[44:45], v[44:45], v[10:11], v[12:13]
    v_pk_fma_f32 v[46:47], v[46:47], v[10:11], v[12:13]
    v_cvt_pk_bf16_f32 v52, v40, v41
    v_cvt_pk_bf16_f32 v53, v42, v43
    v_cvt_pk_bf16_f32 v54, v44, v45
    v_cvt_pk_bf16_f32 v55, v46, v47
    v_lshlrev_b32 v40, 16, v128
    v_and_b32 v41, s16, v128
    v_lshlrev_b32 v42, 16, v129
    v_and_b32 v43, s16, v129
    v_lshlrev_b32 v44, 16, v130
    v_and_b32 v45, s16, v130
    v_lshlrev_b32 v46, 16, v131
    v_and_b32 v47, s16, v131
    v_pk_fma_f32 v[40:41], v[40:41], v[10:11], v[12:13]
    v_pk_fma_f32 v[42:43], v[42:43], v[10:11], v[12:13]
    v_pk_fma_f32 v[44:45], v[44:45], v[10:11], v[12:13]
    v_pk_fma_f32 v[46:47], v[46:47], v[10:11], v[12:13]
    v_cvt_pk_bf16_f32 v56, v40, v41
    v_cvt_pk_bf16_f32 v57, v42, v43
    v_cvt_pk_bf16_f32 v58, v44, v45
    v_cvt_pk_bf16_f32 v59, v46, v47
    buffer_store_dwordx4 v[48:51], v172, s[8:11], s20 offen sc1
    buffer_store_dwordx4 v[52:55], v173, s[8:11], s20 offen sc1
    buffer_store_dwordx4 v[56:59], v174, s[8:11], s20 offen sc1
    v_lshlrev_b32 v15, 7, v0
    s_lshl_b32 s6, s40, 2
    s_add_u32 s6, s6, s44
    s_add_u32 s6, s6, 98304
    v_mov_b32 v1, s76
    s_mov_b64 vcc, 0xff
    v_lshrrev_b32 v14, 3, v0
    v_lshl_add_u32 v15, v14, 3, v15
    s_cmp_ge_u32 s40, 6
    s_cselect_b32 s7, s41, 31
    s_cmp_lt_u32 s7, 31
    s_cmov_b64 vcc, 0xffff
    s_waitcnt vmcnt(0)
    s_barrier
    s_cmp_lg_u32 s3, 0
    s_cbranch_scc1 L_pub_46
    s_mov_b64 exec, vcc
    buffer_store_dword v1, v15, s[8:11], s6 offen sc1
L_pub_46:
    s_mov_b64 exec, -1
    s_add_u32 s28, s28, 4096
    buffer_load_dwordx4 a[96:99], v3, s[8:11], s28 offen offset:0 sc1
    buffer_load_dwordx4 a[100:103], v3, s[8:11], s28 offen offset:1024 sc1
    buffer_load_dwordx4 a[104:107], v3, s[8:11], s28 offen offset:2048 sc1
    buffer_load_dwordx4 a[108:111], v3, s[8:11], s28 offen offset:3072 sc1
    s_add_u32 s28, s28, 4096
    buffer_load_dwordx4 a[112:115], v3, s[8:11], s28 offen offset:0 sc1
    buffer_load_dwordx4 a[116:119], v3, s[8:11], s28 offen offset:1024 sc1
    buffer_load_dwordx4 a[120:123], v3, s[8:11], s28 offen offset:2048 sc1
    buffer_load_dwordx4 a[124:127], v3, s[8:11], s28 offen offset:3072 sc1
    s_add_u32 s28, s28, 4096
    buffer_load_dwordx4 a[128:131], v3, s[8:11], s28 offen offset:0 sc1
    buffer_load_dwordx4 a[132:135], v3, s[8:11], s28 offen offset:1024 sc1
    buffer_load_dwordx4 a[136:139], v3, s[8:11], s28 offen offset:2048 sc1
    buffer_load_dwordx4 a[140:143], v3, s[8:11], s28 offen offset:3072 sc1
    s_add_u32 s28, s28, 4096
    s_mov_b32 s42, 1
    s_mov_b32 s43, 0
    s_add_u32 s44, s44, 131072
    s_mov_b32 s74, 0
    s_branch L_main_layer
L_main_last:
    buffer_store_dwordx4 v[120:123], v175, s[12:15], s18 offen sc0 sc1
    buffer_store_dwordx4 v[124:127], v176, s[12:15], s18 offen sc0 sc1
    buffer_store_dwordx4 v[128:131], v177, s[12:15], s18 offen sc0 sc1
    s_or_b32 s7, s40, s41
    s_or_b32 s7, s7, s3
    s_cbranch_scc1 L_done_47
    v_mov_b32 v1, s76
    s_mov_b32 s7, 19660800
    s_mov_b64 exec, 1
    buffer_store_dword v1, off, s[8:11], s7 sc1
    s_mov_b64 exec, -1
L_done_47:
L_main_end:
    s_endpgm
L_main_code_end:
.section .rodata,"a"
.p2align 6
.amdhsa_kernel interleave_layers__sliding_local_dilated__glu_gated_geglu__prompt_kernel
.amdhsa_next_free_vgpr 512
.amdhsa_next_free_sgpr 102
.amdhsa_accum_offset 256
.amdhsa_group_segment_fixed_size 0
.amdhsa_kernarg_size 80
.amdhsa_user_sgpr_count 2
.amdhsa_user_sgpr_kernarg_segment_ptr 1
.amdhsa_system_sgpr_workgroup_id_x 1
.amdhsa_float_denorm_mode_32 3
.amdhsa_float_denorm_mode_16_64 3
.end_amdhsa_kernel
```

```asm
; @launch grid=(256,1,1) block=(256,1,1) lds=163840
.amdgcn_target "amdgcn-amd-amdhsa--gfx950"
.text
.globl interleave_layers__sliding_local_dilated__glu_gated_geglu__prompt_kernel
.p2align 8
.type interleave_layers__sliding_local_dilated__glu_gated_geglu__prompt_kernel,@function
interleave_layers__sliding_local_dilated__glu_gated_geglu__prompt_kernel:
    s_cmp_ge_u32 s2, 256
    s_cbranch_scc1 L_main_end
    s_load_dwordx2 s[4:5], s[0:1], 72
    s_load_dwordx4 s[16:19], s[0:1], 0
    s_load_dwordx2 s[22:23], s[0:1], 16
    s_load_dwordx8 s[24:31], s[0:1], 32
    s_getpc_b64 s[96:97]
L_main_pc:
    s_sub_u32 s96, s96, L_main_pc-interleave_layers__sliding_local_dilated__glu_gated_geglu__prompt_kernel
    s_subb_u32 s97, s97, 0
    s_and_b32 s97, s97, 0xffff
    s_mov_b32 s98, L_main_code_end-interleave_layers__sliding_local_dilated__glu_gated_geglu__prompt_kernel
    s_mov_b32 s99, 0x20000
    s_lshr_b32 s7, s2, 3
    s_lshl_b32 s7, s7, 11
    v_lshl_add_u32 v253, v0, 3, s7
    buffer_load_dwordx2 v[2:3], v253, s[96:99], 0 offen
    v_lshrrev_b32 v1, 6, v0
    v_and_b32 v0, 63, v0
    v_readfirstlane_b32 s3, v1
    s_waitcnt lgkmcnt(0)
    s_mov_b32 s8, s4
    s_and_b32 s9, s5, 0xffff
    s_mov_b32 s10, 268435456
    s_mov_b32 s11, 0x20000
    s_mov_b32 s7, 19660800
    s_load_dword s76, s[4:5], s7
    s_mov_b64 s[20:21], s[18:19]
    s_mov_b64 s[18:19], s[16:17]
    s_mov_b32 s48, s4
    s_and_b32 s49, s5, 0xffff
    s_mov_b32 s50, 268435456
    s_mov_b32 s51, 0x20000
    s_and_b32 s40, s2, 3
    s_lshl_b32 s40, s40, 1
    s_bfe_u32 s7, s2, 65539
    s_add_u32 s40, s40, s7
    s_bfe_u32 s41, s2, 65538
    s_lshl_b32 s41, s41, 4
    s_lshr_b32 s7, s2, 4
    s_add_u32 s41, s41, s7
    s_mov_b32 s42, 0
    s_mov_b32 s43, 0
    s_lshl_b32 s44, s41, 10
    s_add_u32 s44, s44, 19169280
    v_lshlrev_b32 v253, 4, v0
    s_mov_b32 s12, s18
    s_and_b32 s13, s19, 0xffff
    s_mov_b32 s14, 2359296
    s_mov_b32 s15, 0x20000
    s_mov_b32 s64, s20
    s_and_b32 s65, s21, 0xffff
    s_mov_b32 s66, 1990656
    s_mov_b32 s67, 0x20000
    s_mov_b32 s68, s22
    s_and_b32 s69, s23, 0xffff
    s_mov_b32 s70, 663552
    s_mov_b32 s71, 0x20000
    s_mov_b32 s16, 0xffff0000
    s_lshl_b32 s7, s3, 10
    v_add_u32 v172, s7, v253
    v_add_u32 v174, 5120, v172
    v_and_b32 v178, 7, v0
    v_mul_u32_u24 v178, 1152, v178
    v_lshrrev_b32 v179, 3, v0
    v_lshl_add_u32 v178, v179, 4, v178
    s_lshl_b32 s7, s3, 7
    v_add_u32 v175, s7, v178
    v_add_u32 v177, 640, v175
    s_cmp_eq_u32 s3, 0
    s_mov_b32 s17, 1073741824
    s_cmov_b32 s17, 4096
    v_add_u32 v173, s17, v172
    s_mov_b32 s17, 1073741824
    s_cmov_b32 s17, 512
    v_add_u32 v176, s17, v175
    s_lshl_b32 s21, s41, 3
    s_add_u32 s21, s21, s40
    s_mul_i32 s18, s21, 9216
    buffer_load_dwordx4 v[16:19], v175, s[12:15], s18 offen nt
    buffer_load_dwordx4 v[20:23], v176, s[12:15], s18 offen nt
    buffer_load_dwordx4 v[24:27], v177, s[12:15], s18 offen nt
    s_mov_b32 s12, s30
    s_and_b32 s13, s31, 0xffff
    s_mov_b32 s14, 2359296
    s_mov_b32 s15, 0x20000
    s_lshl_b32 s79, s3, 14
    s_add_u32 s79, s79, 98304
    s_sub_u32 s36, s21, 144
    s_cmp_ge_u32 s41, 18
    s_cbranch_scc1 L_prep_o_1
    s_mul_i32 s35, s41, 110592
    s_mul_i32 s7, s40, 144
    s_and_b32 s46, s7, 127
    s_sub_u32 s7, s7, s46
    s_add_u32 s35, s35, s7
    s_mul_i32 s7, s3, 13824
    s_add_u32 s35, s35, s7
    v_lshrrev_b32 v8, 4, v0
    v_mul_u32_u24 v8, 3456, v8
    v_and_b32 v9, 15, v0
    v_lshl_add_u32 v8, v9, 4, v8
    s_lshl_b32 s34, s3, 10
    s_add_u32 m0, s34, 8192
    s_add_u32 s7, s35, 0
    buffer_load_dwordx4 v8, s[64:67], s7 offen nt lds
    s_add_u32 m0, s34, 12288
    s_add_u32 s7, s35, 55296
    buffer_load_dwordx4 v8, s[64:67], s7 offen nt lds
    s_add_u32 m0, s34, 16384
    s_add_u32 s7, s35, 1152
    buffer_load_dwordx4 v8, s[64:67], s7 offen nt lds
    s_add_u32 m0, s34, 20480
    s_add_u32 s7, s35, 56448
    buffer_load_dwordx4 v8, s[64:67], s7 offen nt lds
    s_add_u32 m0, s34, 24576
    s_add_u32 s7, s35, 2304
    buffer_load_dwordx4 v8, s[64:67], s7 offen nt lds
    s_add_u32 m0, s34, 28672
    s_add_u32 s7, s35, 57600
    buffer_load_dwordx4 v8, s[64:67], s7 offen nt lds
    s_branch L_prep_go_3
L_prep_o_1:
    s_cmp_ge_u32 s36, 54
    s_cbranch_scc1 L_prep_m_2
    s_mul_i32 s33, s36, 349526
    s_lshr_b32 s33, s33, 20
    s_mul_i32 s34, s33, 3
    s_sub_u32 s34, s36, s34
    s_lshl_b32 s7, s33, 2
    s_add_u32 s7, s7, s3
    v_mov_b32 v8, s7
    v_lshrrev_b32 v9, 3, v0
    v_mul_u32_u24 v11, 7282, v8
    v_lshrrev_b32 v11, 16, v11
    v_mul_u32_u24 v12, 9, v11
    v_sub_u32 v12, v8, v12
    v_mul_u32_u24 v11, 72, v11
    v_cmp_eq_u32 vcc, 8, v12
    v_lshrrev_b32 v10, 1, v12
    v_mad_u32_u24 v10, v10, 18, v11
    v_and_b32 v12, 1, v12
    v_lshl_add_u32 v10, v12, 3, v10
    v_add_u32 v10, v10, v9
    v_lshrrev_b32 v12, 1, v9
    v_mad_u32_u24 v11, v12, 18, v11
    v_and_b32 v12, 1, v9
    v_add3_u32 v11, v11, v12, 16
    v_cndmask_b32 v10, v10, v11, vcc
    v_mul_u32_u24 v10, 1152, v10
    v_and_b32 v9, 7, v0
    v_lshl_add_u32 v10, v9, 4, v10
    s_mul_i32 s35, s34, 384
    s_lshl_b32 s6, s3, 10
    s_add_u32 m0, s6, 8192
    s_add_u32 s7, s35, 0
    buffer_load_dwordx4 v10, s[68:71], s7 offen nt lds
    s_add_u32 m0, s6, 12288
    s_add_u32 s7, s35, 128
    buffer_load_dwordx4 v10, s[68:71], s7 offen nt lds
    s_add_u32 m0, s6, 16384
    s_add_u32 s7, s35, 256
    buffer_load_dwordx4 v10, s[68:71], s7 offen nt lds
    s_branch L_prep_go_3
L_prep_m_2:
    s_sub_u32 s37, s36, 54
    s_lshl_b32 s7, s3, 6
    s_add_u32 s37, s37, s7
    s_cmp_ge_u32 s37, 36
    s_cbranch_scc1 L_prep_go_3
    s_lshl_b32 s7, s37, 1
    v_bfe_u32 v8, v0, 3, 1
    v_add_u32 v8, s7, v8
    v_and_b32 v9, 7, v0
    v_mul_u32_u24 v11, 7282, v8
    v_lshrrev_b32 v11, 16, v11
    v_mul_u32_u24 v12, 9, v11
    v_sub_u32 v12, v8, v12
    v_mul_u32_u24 v11, 72, v11
    v_cmp_eq_u32 vcc, 8, v12
    v_lshrrev_b32 v10, 1, v12
    v_mad_u32_u24 v10, v10, 18, v11
    v_and_b32 v12, 1, v12
    v_lshl_add_u32 v10, v12, 3, v10
    v_add_u32 v10, v10, v9
    v_lshrrev_b32 v12, 1, v9
    v_mad_u32_u24 v11, v12, 18, v11
    v_and_b32 v12, 1, v9
    v_add3_u32 v11, v11, v12, 16
    v_cndmask_b32 v10, v10, v11, vcc
    v_mul_u32_u24 v10, 1152, v10
    v_lshrrev_b32 v9, 4, v0
    v_lshl_add_u32 v10, v9, 4, v10
    buffer_load_dwordx4 v[64:67], v10, s[68:71], 0 offen offset:0
    buffer_load_dwordx4 v[68:71], v10, s[68:71], 0 offen offset:64
    buffer_load_dwordx4 v[72:75], v10, s[68:71], 0 offen offset:128
    buffer_load_dwordx4 v[76:79], v10, s[68:71], 0 offen offset:192
    buffer_load_dwordx4 v[80:83], v10, s[68:71], 0 offen offset:256
    buffer_load_dwordx4 v[84:87], v10, s[68:71], 0 offen offset:320
    buffer_load_dwordx4 v[88:91], v10, s[68:71], 0 offen offset:384
    buffer_load_dwordx4 v[92:95], v10, s[68:71], 0 offen offset:448
    buffer_load_dwordx4 v[96:99], v10, s[68:71], 0 offen offset:512
    buffer_load_dwordx4 v[100:103], v10, s[68:71], 0 offen offset:576
    buffer_load_dwordx4 v[104:107], v10, s[68:71], 0 offen offset:640
    buffer_load_dwordx4 v[108:111], v10, s[68:71], 0 offen offset:704
    buffer_load_dwordx4 v[112:115], v10, s[68:71], 0 offen offset:768
    buffer_load_dwordx4 v[116:119], v10, s[68:71], 0 offen offset:832
    buffer_load_dwordx4 v[120:123], v10, s[68:71], 0 offen offset:896
    buffer_load_dwordx4 v[124:127], v10, s[68:71], 0 offen offset:960
    buffer_load_dwordx4 v[128:131], v10, s[68:71], 0 offen offset:1024
    buffer_load_dwordx4 v[132:135], v10, s[68:71], 0 offen offset:1088
L_prep_go_3:
    s_lshl_b32 s7, s41, 2
    s_add_u32 s7, s7, s3
    s_mul_i32 s93, s7, 25576
    s_lshr_b32 s93, s93, 20
    s_min_u32 s93, s93, 2
    s_mul_i32 s6, s93, 41
    s_sub_u32 s7, s7, s6
    s_lshl_b32 s17, s7, 2
    s_cmp_eq_u32 s93, 1
    s_cselect_b32 s72, s26, s24
    s_cselect_b32 s73, s27, s25
    s_cmp_eq_u32 s93, 2
    s_cselect_b32 s72, s28, s72
    s_cselect_b32 s73, s29, s73
    s_mov_b32 s92, 73728
    s_cmov_b32 s92, 9216
    s_mov_b32 s47, 1152
    s_cmov_b32 s47, 663552
    s_and_b32 s73, s73, 0xffff
    s_mov_b32 s74, 5308416
    s_mov_b32 s75, 0x20000
    s_mul_i32 s47, s47, s40
    s_add_u32 s7, s17, 0
    s_min_u32 s7, s7, 161
    s_mul_i32 s84, s7, 116509
    s_lshr_b32 s84, s84, 20
    s_mul_i32 s88, s84, 9
    s_sub_u32 s88, s7, s88
    s_mul_i32 s7, s84, s92
    s_lshl_b32 s7, s7, 2
    s_add_u32 s7, s7, s47
    s_lshl_b32 s6, s88, 7
    s_add_u32 s80, s7, s6
    s_add_u32 s7, s17, 1
    s_min_u32 s7, s7, 161
    s_mul_i32 s85, s7, 116509
    s_lshr_b32 s85, s85, 20
    s_mul_i32 s89, s85, 9
    s_sub_u32 s89, s7, s89
    s_mul_i32 s7, s85, s92
    s_lshl_b32 s7, s7, 2
    s_add_u32 s7, s7, s47
    s_lshl_b32 s6, s89, 7
    s_add_u32 s81, s7, s6
    s_add_u32 s7, s17, 2
    s_min_u32 s7, s7, 161
    s_mul_i32 s86, s7, 116509
    s_lshr_b32 s86, s86, 20
    s_mul_i32 s90, s86, 9
    s_sub_u32 s90, s7, s90
    s_mul_i32 s7, s86, s92
    s_lshl_b32 s7, s7, 2
    s_add_u32 s7, s7, s47
    s_lshl_b32 s6, s90, 7
    s_add_u32 s82, s7, s6
    s_add_u32 s7, s17, 3
    s_min_u32 s7, s7, 161
    s_mul_i32 s87, s7, 116509
    s_lshr_b32 s87, s87, 20
    s_mul_i32 s91, s87, 9
    s_sub_u32 s91, s7, s91
    s_mul_i32 s7, s87, s92
    s_lshl_b32 s7, s7, 2
    s_add_u32 s7, s7, s47
    s_lshl_b32 s6, s91, 7
    s_add_u32 s83, s7, s6
    s_lshr_b32 s7, s92, 3
    v_lshrrev_b32 v224, 3, v0
    v_mul_lo_u32 v224, v224, s7
    v_and_b32 v8, 7, v0
    v_lshl_add_u32 v224, v8, 4, v224
    s_waitcnt lgkmcnt(0)
    s_mul_i32 s76, s76, 0x9e3779b1
    s_add_u32 s76, s76, 0x7f4a7c15
    s_mov_b32 s77, s76
    s_add_u32 m0, s79, 0
    s_mov_b32 s71, s80
    buffer_load_dwordx4 v224, s[72:75], s71 offen nt lds
    s_add_u32 m0, s79, 1024
    s_add_u32 s71, s71, s92
    buffer_load_dwordx4 v224, s[72:75], s71 offen nt lds
    s_add_u32 m0, s79, 2048
    s_add_u32 s71, s71, s92
    buffer_load_dwordx4 v224, s[72:75], s71 offen nt lds
    s_waitcnt vmcnt(3)
    s_barrier
    s_cmp_ge_u32 s41, 18
    s_cbranch_scc1 L_prep_o_4
    s_mul_i32 s7, s3, 36
    s_add_u32 s7, s7, s46
    v_lshrrev_b32 v8, 4, v0
    v_lshlrev_b32 v8, 11, v8
    v_add_u32 v8, s7, v8
    v_and_b32 v9, 15, v0
    v_cmp_gt_u32 s[22:23], 6, v9
    v_lshrrev_b32 v10, 1, v9
    v_min_u32 v10, 2, v10
    v_lshl_add_u32 v10, v10, 13, v8
    v_and_b32 v11, 1, v0
    v_lshl_add_u32 v10, v11, 1, v10
    v_lshl_add_u32 v8, v9, 1, v8
    ds_read_u16 v136, v8 offset:8192
    ds_read_u16 v137, v8 offset:8448
    ds_read_u16 v138, v8 offset:8704
    ds_read_u16 v139, v8 offset:8960
    ds_read_u16 v140, v8 offset:9216
    ds_read_u16 v141, v8 offset:9472
    ds_read_u16 v142, v8 offset:9728
    ds_read_u16 v143, v8 offset:9984
    s_lshl_b32 s33, s40, 2
    s_add_u32 s33, s33, s3
    s_mul_i32 s33, s33, 18
    s_add_u32 s33, s33, s41
    s_lshl_b32 s33, s33, 12
    ds_read_u16 v144, v8 offset:16384
    ds_read_u16 v145, v8 offset:16640
    ds_read_u16 v146, v8 offset:16896
    ds_read_u16 v147, v8 offset:17152
    ds_read_u16 v148, v8 offset:17408
    ds_read_u16 v149, v8 offset:17664
    ds_read_u16 v150, v8 offset:17920
    ds_read_u16 v151, v8 offset:18176
    s_waitcnt lgkmcnt(8)
    v_lshl_or_b32 v32, v137, 16, v136
    v_lshl_or_b32 v33, v139, 16, v138
    v_lshl_or_b32 v34, v141, 16, v140
    v_lshl_or_b32 v35, v143, 16, v142
    buffer_store_dwordx4 v[32:35], v253, s[8:11], s33 offen offset:0 sc1
    ds_read_u16 v152, v8 offset:24576
    ds_read_u16 v153, v8 offset:24832
    ds_read_u16 v154, v8 offset:25088
    ds_read_u16 v155, v8 offset:25344
    ds_read_u16 v156, v8 offset:25600
    ds_read_u16 v157, v8 offset:25856
    ds_read_u16 v158, v8 offset:26112
    ds_read_u16 v159, v8 offset:26368
    s_waitcnt lgkmcnt(8)
    v_lshl_or_b32 v36, v145, 16, v144
    v_lshl_or_b32 v37, v147, 16, v146
    v_lshl_or_b32 v38, v149, 16, v148
    v_lshl_or_b32 v39, v151, 16, v150
    buffer_store_dwordx4 v[36:39], v253, s[8:11], s33 offen offset:1024 sc1
    ds_read_u16 v160, v10 offset:8224
    ds_read_u16 v161, v10 offset:8480
    ds_read_u16 v162, v10 offset:8736
    ds_read_u16 v163, v10 offset:8992
    ds_read_u16 v164, v10 offset:9248
    ds_read_u16 v165, v10 offset:9504
    ds_read_u16 v166, v10 offset:9760
    ds_read_u16 v167, v10 offset:10016
    s_waitcnt lgkmcnt(8)
    v_lshl_or_b32 v40, v153, 16, v152
    v_lshl_or_b32 v41, v155, 16, v154
    v_lshl_or_b32 v42, v157, 16, v156
    v_lshl_or_b32 v43, v159, 16, v158
    buffer_store_dwordx4 v[40:43], v253, s[8:11], s33 offen offset:2048 sc1
    s_waitcnt lgkmcnt(0)
    v_lshl_or_b32 v44, v161, 16, v160
    v_cndmask_b32 v44, 0, v44, s[22:23]
    v_lshl_or_b32 v45, v163, 16, v162
    v_cndmask_b32 v45, 0, v45, s[22:23]
    v_lshl_or_b32 v46, v165, 16, v164
    v_cndmask_b32 v46, 0, v46, s[22:23]
    v_lshl_or_b32 v47, v167, 16, v166
    v_cndmask_b32 v47, 0, v47, s[22:23]
    buffer_store_dwordx4 v[44:47], v253, s[8:11], s33 offen offset:3072 sc1
    s_branch L_prep_done_6
L_prep_o_4:
    s_cmp_ge_u32 s36, 54
    s_cbranch_scc1 L_prep_m_5
    v_lshrrev_b32 v8, 4, v0
    v_lshlrev_b32 v8, 3, v8
    v_bfe_u32 v9, v0, 2, 2
    v_add_u32 v8, v8, v9
    v_mul_u32_u24 v8, 128, v8
    v_and_b32 v9, 3, v0
    v_lshl_add_u32 v8, v9, 3, v8
    s_lshl_b32 s7, s3, 5
    v_add_u32 v8, s7, v8
    ds_read_b64_tr_b16 v[32:33], v8 offset:8192
    ds_read_b64_tr_b16 v[34:35], v8 offset:8704
    ds_read_b64_tr_b16 v[36:37], v8 offset:12288
    ds_read_b64_tr_b16 v[38:39], v8 offset:12800
    ds_read_b64_tr_b16 v[40:41], v8 offset:16384
    ds_read_b64_tr_b16 v[42:43], v8 offset:16896
    s_mul_i32 s34, s34, 12
    s_add_u32 s34, s34, s3
    s_mul_i32 s34, s34, 18
    s_add_u32 s34, s34, s33
    s_lshl_b32 s34, s34, 10
    s_add_u32 s7, s34, 2359296
    s_waitcnt lgkmcnt(4)
    buffer_store_dwordx4 v[32:35], v253, s[8:11], s7 offen sc1
    s_add_u32 s7, s34, 2433024
    s_waitcnt lgkmcnt(2)
    buffer_store_dwordx4 v[36:39], v253, s[8:11], s7 offen sc1
    s_add_u32 s7, s34, 2506752
    s_waitcnt lgkmcnt(0)
    buffer_store_dwordx4 v[40:43], v253, s[8:11], s7 offen sc1
    s_branch L_prep_done_6
L_prep_m_5:
    s_cmp_ge_u32 s37, 36
    s_cbranch_scc1 L_prep_done_6
    v_mov_b32 v28, 0x3f803f80
    v_mov_b32 v29, 0x3f803f80
    v_mov_b32 v30, 0x3f803f80
    v_mov_b32 v31, 0x3f803f80
    v_and_b32 v9, 15, v0
    v_cmp_eq_u32 vcc, 0, v9
    v_cmp_eq_u32 s[22:23], 1, v9
    v_mfma_f32_16x16x32_bf16 v[32:35], v[64:67], v[28:31], 0
    v_mfma_f32_16x16x32_bf16 v[32:35], v[68:71], v[28:31], v[32:35]
    v_mfma_f32_16x16x32_bf16 v[32:35], v[72:75], v[28:31], v[32:35]
    v_mfma_f32_16x16x32_bf16 v[32:35], v[76:79], v[28:31], v[32:35]
    v_mfma_f32_16x16x32_bf16 v[32:35], v[80:83], v[28:31], v[32:35]
    v_mfma_f32_16x16x32_bf16 v[32:35], v[84:87], v[28:31], v[32:35]
    v_mfma_f32_16x16x32_bf16 v[32:35], v[88:91], v[28:31], v[32:35]
    v_mfma_f32_16x16x32_bf16 v[32:35], v[92:95], v[28:31], v[32:35]
    v_mfma_f32_16x16x32_bf16 v[32:35], v[96:99], v[28:31], v[32:35]
    v_mfma_f32_16x16x32_bf16 v[32:35], v[100:103], v[28:31], v[32:35]
    v_mfma_f32_16x16x32_bf16 v[32:35], v[104:107], v[28:31], v[32:35]
    v_mfma_f32_16x16x32_bf16 v[32:35], v[108:111], v[28:31], v[32:35]
    v_mfma_f32_16x16x32_bf16 v[32:35], v[112:115], v[28:31], v[32:35]
    v_mfma_f32_16x16x32_bf16 v[32:35], v[116:119], v[28:31], v[32:35]
    v_mfma_f32_16x16x32_bf16 v[32:35], v[120:123], v[28:31], v[32:35]
    v_mfma_f32_16x16x32_bf16 v[32:35], v[124:127], v[28:31], v[32:35]
    v_mfma_f32_16x16x32_bf16 v[32:35], v[128:131], v[28:31], v[32:35]
    v_mfma_f32_16x16x32_bf16 v[32:35], v[132:135], v[28:31], v[32:35]
    v_lshrrev_b32 v10, 5, v0
    v_lshlrev_b32 v10, 8, v10
    v_lshl_add_u32 v10, v9, 4, v10
    v_bfe_u32 v9, v0, 4, 1
    v_lshl_add_u32 v10, v9, 3, v10
    s_lshl_b32 s7, s37, 9
    s_add_u32 s7, s7, 3022848
    s_nop 0
    v_mul_f32 v32, 0x3ae38e39, v32
    v_mul_f32 v33, 0x3ae38e39, v33
    v_mul_f32 v34, 0x3ae38e39, v34
    v_mul_f32 v35, 0x3ae38e39, v35
    v_cvt_pk_bf16_f32 v36, v32, v33
    v_cvt_pk_bf16_f32 v37, v34, v35
    v_lshlrev_b32 v38, 16, v36
    v_and_b32 v39, s16, v36
    v_sub_f32 v38, v32, v38
    v_sub_f32 v39, v33, v39
    v_cvt_pk_bf16_f32 v28, v38, v39
    v_cndmask_b32 v28, 0, v28, s[22:23]
    v_cndmask_b32 v28, v28, v36, vcc
    v_lshlrev_b32 v38, 16, v37
    v_and_b32 v39, s16, v37
    v_sub_f32 v38, v34, v38
    v_sub_f32 v39, v35, v39
    v_cvt_pk_bf16_f32 v29, v38, v39
    v_cndmask_b32 v29, 0, v29, s[22:23]
    v_cndmask_b32 v29, v29, v37, vcc
    buffer_store_dwordx2 v[28:29], v10, s[8:11], s7 offen sc1
L_prep_done_6:
    s_add_u32 s19, s18, 43515904
    s_add_u32 s20, s18, 38797312
    s_lshl_b32 s22, s21, 7
    s_add_u32 s22, s22, 48234496
    buffer_store_dwordx4 v[16:19], v172, s[8:11], s19 offen sc1
    buffer_store_dwordx4 v[20:23], v173, s[8:11], s19 offen sc1
    buffer_store_dwordx4 v[24:27], v174, s[8:11], s19 offen sc1
    s_mov_b32 s17, 0x3f803f80
    v_mov_b32 v8, 0
    v_mov_b32 v9, 0
    v_mov_b32 v10, 0
    v_mov_b32 v11, 0
    v_dot2c_f32_bf16 v8, s17, v16
    v_dot2c_f32_bf16 v9, v16, v16
    v_dot2c_f32_bf16 v10, s17, v17
    v_dot2c_f32_bf16 v11, v17, v17
    v_dot2c_f32_bf16 v8, s17, v18
    v_dot2c_f32_bf16 v9, v18, v18
    v_dot2c_f32_bf16 v10, s17, v19
    v_dot2c_f32_bf16 v11, v19, v19
    v_dot2c_f32_bf16 v8, s17, v20
    v_dot2c_f32_bf16 v9, v20, v20
    v_dot2c_f32_bf16 v10, s17, v21
    v_dot2c_f32_bf16 v11, v21, v21
    v_dot2c_f32_bf16 v8, s17, v22
    v_dot2c_f32_bf16 v9, v22, v22
    v_dot2c_f32_bf16 v10, s17, v23
    v_dot2c_f32_bf16 v11, v23, v23
    v_dot2c_f32_bf16 v8, s17, v24
    v_dot2c_f32_bf16 v9, v24, v24
    v_dot2c_f32_bf16 v10, s17, v25
    v_dot2c_f32_bf16 v11, v25, v25
    v_dot2c_f32_bf16 v8, s17, v26
    v_dot2c_f32_bf16 v9, v26, v26
    v_dot2c_f32_bf16 v10, s17, v27
    v_dot2c_f32_bf16 v11, v27, v27
    v_and_b32 v12, 7, v0
    v_lshlrev_b32 v12, 3, v12
    s_lshl_b32 s7, s3, 6
    v_add_u32 v13, s7, v12
    v_pk_add_f32 v[8:9], v[8:9], v[10:11]
    s_nop 1
    v_add_f32_dpp v8, v8, v8 row_ror:8 row_mask:0xf bank_mask:0xf
    v_add_f32_dpp v9, v9, v9 row_ror:8 row_mask:0xf bank_mask:0xf
    v_mov_b32 v10, v8
    v_mov_b32 v11, v9
    s_nop 1
    v_permlane32_swap_b32 v10, v8
    v_permlane32_swap_b32 v11, v9
    v_add_f32 v8, v8, v10
    v_add_f32 v9, v9, v11
    v_mov_b32 v10, v8
    v_mov_b32 v11, v9
    s_nop 1
    v_permlane16_swap_b32 v10, v8
    v_permlane16_swap_b32 v11, v9
    v_add_f32 v8, v8, v10
    v_add_f32 v9, v9, v11
    ds_write_b64 v13, v[8:9]
    s_waitcnt lgkmcnt(0)
    s_barrier
    ds_read_b64 v[40:41], v12 offset:0
    ds_read_b64 v[42:43], v12 offset:64
    ds_read_b64 v[44:45], v12 offset:128
    ds_read_b64 v[46:47], v12 offset:192
    s_waitcnt lgkmcnt(0)
    v_pk_add_f32 v[40:41], v[40:41], v[42:43]
    v_pk_add_f32 v[44:45], v[44:45], v[46:47]
    v_pk_add_f32 v[8:9], v[40:41], v[44:45]
    v_mul_f32 v8, 0x3ae38e39, v8
    v_mul_f32 v9, 0x3ae38e39, v9
    v_fma_f32 v9, -v8, v8, v9
    v_max_f32 v9, 0, v9
    v_add_f32 v9, 0x3727c5ac, v9
    v_rsq_f32 v10, v9
    s_nop 0
    v_mul_f32 v12, v8, v10
    v_mov_b32 v11, v10
    v_sub_f32 v12, 0, v12
    v_mov_b32 v13, v12
    s_cmp_eq_u32 s3, 0
    s_cselect_b32 s7, 32, 0
    v_lshlrev_b32 v14, 2, v0
    v_cmp_gt_u32 vcc, s7, v0
    v_mov_b32 v9, 1073741824
    s_nop 0
    v_cndmask_b32 v14, v9, v14, vcc
    buffer_store_dword v8, v14, s[8:11], s22 offen sc1
    v_lshlrev_b32 v40, 16, v16
    v_and_b32 v41, s16, v16
    v_lshlrev_b32 v42, 16, v17
    v_and_b32 v43, s16, v17
    v_lshlrev_b32 v44, 16, v18
    v_and_b32 v45, s16, v18
    v_lshlrev_b32 v46, 16, v19
    v_and_b32 v47, s16, v19
    v_pk_fma_f32 v[40:41], v[40:41], v[10:11], v[12:13]
    v_pk_fma_f32 v[42:43], v[42:43], v[10:11], v[12:13]
    v_pk_fma_f32 v[44:45], v[44:45], v[10:11], v[12:13]
    v_pk_fma_f32 v[46:47], v[46:47], v[10:11], v[12:13]
    v_cvt_pk_bf16_f32 v48, v40, v41
    v_cvt_pk_bf16_f32 v49, v42, v43
    v_cvt_pk_bf16_f32 v50, v44, v45
    v_cvt_pk_bf16_f32 v51, v46, v47
    v_lshlrev_b32 v40, 16, v20
    v_and_b32 v41, s16, v20
    v_lshlrev_b32 v42, 16, v21
    v_and_b32 v43, s16, v21
    v_lshlrev_b32 v44, 16, v22
    v_and_b32 v45, s16, v22
    v_lshlrev_b32 v46, 16, v23
    v_and_b32 v47, s16, v23
    v_pk_fma_f32 v[40:41], v[40:41], v[10:11], v[12:13]
    v_pk_fma_f32 v[42:43], v[42:43], v[10:11], v[12:13]
    v_pk_fma_f32 v[44:45], v[44:45], v[10:11], v[12:13]
    v_pk_fma_f32 v[46:47], v[46:47], v[10:11], v[12:13]
    v_cvt_pk_bf16_f32 v52, v40, v41
    v_cvt_pk_bf16_f32 v53, v42, v43
    v_cvt_pk_bf16_f32 v54, v44, v45
    v_cvt_pk_bf16_f32 v55, v46, v47
    v_lshlrev_b32 v40, 16, v24
    v_and_b32 v41, s16, v24
    v_lshlrev_b32 v42, 16, v25
    v_and_b32 v43, s16, v25
    v_lshlrev_b32 v44, 16, v26
    v_and_b32 v45, s16, v26
    v_lshlrev_b32 v46, 16, v27
    v_and_b32 v47, s16, v27
    v_pk_fma_f32 v[40:41], v[40:41], v[10:11], v[12:13]
    v_pk_fma_f32 v[42:43], v[42:43], v[10:11], v[12:13]
    v_pk_fma_f32 v[44:45], v[44:45], v[10:11], v[12:13]
    v_pk_fma_f32 v[46:47], v[46:47], v[10:11], v[12:13]
    v_cvt_pk_bf16_f32 v56, v40, v41
    v_cvt_pk_bf16_f32 v57, v42, v43
    v_cvt_pk_bf16_f32 v58, v44, v45
    v_cvt_pk_bf16_f32 v59, v46, v47
    buffer_store_dwordx4 v[48:51], v172, s[8:11], s20 offen sc1
    buffer_store_dwordx4 v[52:55], v173, s[8:11], s20 offen sc1
    buffer_store_dwordx4 v[56:59], v174, s[8:11], s20 offen sc1
    v_lshlrev_b32 v15, 7, v0
    s_lshl_b32 s6, s40, 2
    s_add_u32 s6, s6, s44
    s_sub_u32 s6, s6, 32768
    v_mov_b32 v1, s76
    s_mov_b64 vcc, 0xff
    v_lshrrev_b32 v14, 3, v0
    v_lshl_add_u32 v15, v14, 3, v15
    s_cmp_ge_u32 s40, 6
    s_cselect_b32 s7, s41, 31
    s_cmp_lt_u32 s7, 31
    s_cmov_b64 vcc, 0xffff
    s_waitcnt vmcnt(0)
    s_barrier
    s_cmp_lg_u32 s3, 0
    s_cbranch_scc1 L_pub_7
    s_mov_b64 exec, vcc
    buffer_store_dword v1, v15, s[8:11], s6 offen sc1
    v_lshlrev_b32 v15, 10, v0
    s_lshl_b32 s6, s40, 7
    s_lshl_b32 s7, s41, 2
    s_add_u32 s6, s6, s7
    s_add_u32 s6, s6, 19431424
    s_mov_b64 exec, 0xffffffff
    v_lshlrev_b32 v15, 10, v0
    v_mov_b32 v1, s76
    buffer_store_dword v1, v15, s[8:11], s6 offen sc1
    s_cmp_lt_u32 s41, 18
    s_cbranch_scc1 L_pub_7
    s_lshl_b32 s6, s36, 2
    s_add_u32 s6, s6, 19496960
    s_mov_b64 exec, 1
    buffer_store_dword v1, off, s[8:11], s6 sc1
L_pub_7:
    s_mov_b64 exec, -1
    s_add_u32 m0, s79, 3072
    s_add_u32 s71, s71, s92
    buffer_load_dwordx4 v224, s[72:75], s71 offen nt lds
    s_add_u32 m0, s79, 4096
    s_mov_b32 s71, s81
    buffer_load_dwordx4 v224, s[72:75], s71 offen nt lds
    s_add_u32 m0, s79, 5120
    s_add_u32 s71, s71, s92
    buffer_load_dwordx4 v224, s[72:75], s71 offen nt lds
    s_add_u32 m0, s79, 6144
    s_add_u32 s71, s71, s92
    buffer_load_dwordx4 v224, s[72:75], s71 offen nt lds
    s_add_u32 m0, s79, 7168
    s_add_u32 s71, s71, s92
    buffer_load_dwordx4 v224, s[72:75], s71 offen nt lds
    s_add_u32 m0, s79, 8192
    s_mov_b32 s71, s82
    buffer_load_dwordx4 v224, s[72:75], s71 offen nt lds
    s_add_u32 m0, s79, 9216
    s_add_u32 s71, s71, s92
    buffer_load_dwordx4 v224, s[72:75], s71 offen nt lds
    s_add_u32 m0, s79, 10240
    s_add_u32 s71, s71, s92
    buffer_load_dwordx4 v224, s[72:75], s71 offen nt lds
    s_add_u32 m0, s79, 11264
    s_add_u32 s71, s71, s92
    buffer_load_dwordx4 v224, s[72:75], s71 offen nt lds
    s_add_u32 m0, s79, 12288
    s_mov_b32 s71, s83
    buffer_load_dwordx4 v224, s[72:75], s71 offen nt lds
    s_add_u32 m0, s79, 13312
    s_add_u32 s71, s71, s92
    buffer_load_dwordx4 v224, s[72:75], s71 offen nt lds
    s_add_u32 m0, s79, 14336
    s_add_u32 s71, s71, s92
    buffer_load_dwordx4 v224, s[72:75], s71 offen nt lds
    s_add_u32 m0, s79, 15360
    s_add_u32 s71, s71, s92
    buffer_load_dwordx4 v224, s[72:75], s71 offen nt lds
    s_cmp_lg_u32 s3, 0
    s_cbranch_scc1 L_wq_ready_8
    s_lshl_b32 s7, s41, 3
    s_add_u32 s7, s7, s40
    s_lshl_b32 s7, s7, 7
    s_add_u32 s7, s7, 19431424
    s_add_u32 s68, s4, s7
    s_addc_u32 s69, s5, 0
    s_mov_b32 s6, 0
    s_mov_b32 s7, 0
L_cpoll_9:
    s_load_dwordx16 s[52:67], s[68:69], s7 glc
    s_add_u32 s6, s6, 1
    s_waitcnt lgkmcnt(0)
    s_xor_b64 s[52:53], s[52:53], s[76:77]
    s_xor_b64 s[54:55], s[54:55], s[76:77]
    s_xor_b64 s[56:57], s[56:57], s[76:77]
    s_xor_b64 s[58:59], s[58:59], s[76:77]
    s_xor_b64 s[60:61], s[60:61], s[76:77]
    s_xor_b64 s[62:63], s[62:63], s[76:77]
    s_xor_b64 s[64:65], s[64:65], s[76:77]
    s_xor_b64 s[66:67], s[66:67], s[76:77]
    s_or_b64 s[52:53], s[52:53], s[60:61]
    s_or_b64 s[54:55], s[54:55], s[62:63]
    s_or_b64 s[56:57], s[56:57], s[64:65]
    s_or_b64 s[58:59], s[58:59], s[66:67]
    s_or_b64 s[52:53], s[52:53], s[56:57]
    s_or_b64 s[54:55], s[54:55], s[58:59]
    s_or_b64 s[52:53], s[52:53], s[54:55]
    s_cbranch_scc1 L_cpoll_10
    s_add_u32 s7, s7, 8
    s_cmp_eq_u32 s7, 16
    s_cbranch_scc1 L_cpolled_11
L_cpoll_10:
    s_cmp_lt_u32 s6, 1048576
    s_cbranch_scc1 L_cpoll_9
    s_branch L_main_end
L_cpolled_11:
L_wq_ready_8:
    s_barrier
    s_lshl_b32 s28, s40, 2
    s_add_u32 s28, s28, s3
    s_mul_i32 s28, s28, 73728
    buffer_load_dwordx4 a[0:3], v253, s[8:11], s28 offen offset:0 sc1
    buffer_load_dwordx4 a[4:7], v253, s[8:11], s28 offen offset:1024 sc1
    buffer_load_dwordx4 a[8:11], v253, s[8:11], s28 offen offset:2048 sc1
    buffer_load_dwordx4 a[12:15], v253, s[8:11], s28 offen offset:3072 sc1
    s_add_u32 s28, s28, 4096
    buffer_load_dwordx4 a[16:19], v253, s[8:11], s28 offen offset:0 sc1
    buffer_load_dwordx4 a[20:23], v253, s[8:11], s28 offen offset:1024 sc1
    buffer_load_dwordx4 a[24:27], v253, s[8:11], s28 offen offset:2048 sc1
    buffer_load_dwordx4 a[28:31], v253, s[8:11], s28 offen offset:3072 sc1
    s_add_u32 s28, s28, 4096
    buffer_load_dwordx4 a[32:35], v253, s[8:11], s28 offen offset:0 sc1
    buffer_load_dwordx4 a[36:39], v253, s[8:11], s28 offen offset:1024 sc1
    buffer_load_dwordx4 a[40:43], v253, s[8:11], s28 offen offset:2048 sc1
    buffer_load_dwordx4 a[44:47], v253, s[8:11], s28 offen offset:3072 sc1
    s_add_u32 s28, s28, 4096
    buffer_load_dwordx4 a[48:51], v253, s[8:11], s28 offen offset:0 sc1
    buffer_load_dwordx4 a[52:55], v253, s[8:11], s28 offen offset:1024 sc1
    buffer_load_dwordx4 a[56:59], v253, s[8:11], s28 offen offset:2048 sc1
    buffer_load_dwordx4 a[60:63], v253, s[8:11], s28 offen offset:3072 sc1
    s_add_u32 s28, s28, 4096
    buffer_load_dwordx4 a[64:67], v253, s[8:11], s28 offen offset:0 sc1
    buffer_load_dwordx4 a[68:71], v253, s[8:11], s28 offen offset:1024 sc1
    buffer_load_dwordx4 a[72:75], v253, s[8:11], s28 offen offset:2048 sc1
    buffer_load_dwordx4 a[76:79], v253, s[8:11], s28 offen offset:3072 sc1
    s_add_u32 s28, s28, 4096
    buffer_load_dwordx4 a[80:83], v253, s[8:11], s28 offen offset:0 sc1
    buffer_load_dwordx4 a[84:87], v253, s[8:11], s28 offen offset:1024 sc1
    buffer_load_dwordx4 a[88:91], v253, s[8:11], s28 offen offset:2048 sc1
    buffer_load_dwordx4 a[92:95], v253, s[8:11], s28 offen offset:3072 sc1
    s_add_u32 s28, s28, 4096
    buffer_load_dwordx4 a[96:99], v253, s[8:11], s28 offen offset:0 sc1
    buffer_load_dwordx4 a[100:103], v253, s[8:11], s28 offen offset:1024 sc1
    buffer_load_dwordx4 a[104:107], v253, s[8:11], s28 offen offset:2048 sc1
    buffer_load_dwordx4 a[108:111], v253, s[8:11], s28 offen offset:3072 sc1
    s_add_u32 s28, s28, 4096
    buffer_load_dwordx4 a[112:115], v253, s[8:11], s28 offen offset:0 sc1
    buffer_load_dwordx4 a[116:119], v253, s[8:11], s28 offen offset:1024 sc1
    buffer_load_dwordx4 a[120:123], v253, s[8:11], s28 offen offset:2048 sc1
    buffer_load_dwordx4 a[124:127], v253, s[8:11], s28 offen offset:3072 sc1
    s_add_u32 s28, s28, 4096
    buffer_load_dwordx4 a[128:131], v253, s[8:11], s28 offen offset:0 sc1
    buffer_load_dwordx4 a[132:135], v253, s[8:11], s28 offen offset:1024 sc1
    buffer_load_dwordx4 a[136:139], v253, s[8:11], s28 offen offset:2048 sc1
    buffer_load_dwordx4 a[140:143], v253, s[8:11], s28 offen offset:3072 sc1
    s_add_u32 s28, s28, 4096
L_main_layer:
    v_bfe_u32 v3, v0, 3, 1
    v_mul_u32_u24 v2, 9216, v3
    v_lshrrev_b32 v3, 4, v0
    v_lshl_add_u32 v2, v3, 7, v2
    v_and_b32 v3, 7, v0
    v_lshl_add_u32 v2, v3, 4, v2
    v_bfe_u32 v3, v0, 3, 2
    s_mov_b32 s7, 9216
    v_mul_lo_u32 v9, v3, s7
    v_lshrrev_b32 v3, 5, v0
    v_lshl_add_u32 v9, v3, 7, v9
    v_and_b32 v3, 7, v0
    v_lshl_add_u32 v9, v3, 4, v9
    s_mul_i32 s22, s41, 73728
    s_add_u32 s22, s22, s43
    s_add_u32 s23, s22, 38797312
    s_mul_i32 s7, s3, 18432
    s_add_u32 s24, s23, s7
    s_cmp_eq_u32 s41, 0
    s_cselect_b32 s7, 0, 18432
    s_sub_u32 s23, s23, s7
    s_lshl_b32 s25, s3, 10
    s_add_u32 s25, s25, 1024
    s_mul_i32 s26, s3, 5120
    s_lshl_b32 s7, s3, 9
    s_add_u32 s27, s23, s7
    s_and_b32 s7, s3, 1
    s_add_u32 s7, s7, 4
    s_mul_i32 s29, s7, 5120
    s_lshl_b32 s7, s7, 9
    s_add_u32 s23, s23, s7
    s_cmp_lg_u32 s3, 3
    s_cbranch_scc1 L_pollout_14
    s_lshl_b32 s7, s40, 7
    s_add_u32 s7, s7, s44
    s_sub_u32 s7, s7, 32768
    s_add_u32 s52, s4, s7
    s_addc_u32 s53, s5, 0
    s_cmp_eq_u32 s41, 0
    s_cselect_b32 s7, 0, 32
    s_mov_b32 s6, 0
L_poll_12:
    s_load_dwordx8 s[56:63], s[52:53], 0 glc
    s_load_dwordx2 s[54:55], s[52:53], s7 glc
    s_add_u32 s6, s6, 1
    s_waitcnt lgkmcnt(0)
    s_xor_b64 s[54:55], s[54:55], s[76:77]
    s_xor_b64 s[56:57], s[56:57], s[76:77]
    s_xor_b64 s[58:59], s[58:59], s[76:77]
    s_xor_b64 s[60:61], s[60:61], s[76:77]
    s_xor_b64 s[62:63], s[62:63], s[76:77]
    s_or_b64 s[56:57], s[56:57], s[58:59]
    s_or_b64 s[60:61], s[60:61], s[62:63]
    s_or_b64 s[56:57], s[56:57], s[54:55]
    s_or_b64 s[56:57], s[56:57], s[60:61]
    s_cbranch_scc0 L_polled_13
    s_cmp_lt_u32 s6, 1048576
    s_cbranch_scc1 L_poll_12
    s_branch L_main_end
L_polled_13:
L_pollout_14:
    s_barrier
    s_add_u32 m0, s25, 0
    s_nop 0
    buffer_load_dwordx4 v2, s[8:11], s24 offen offset:0 sc1 lds
    s_add_u32 m0, s25, 4608
    s_nop 0
    buffer_load_dwordx4 v2, s[8:11], s24 offen offset:512 sc1 lds
    s_add_u32 m0, s25, 9216
    s_nop 0
    buffer_load_dwordx4 v2, s[8:11], s24 offen offset:1024 sc1 lds
    s_add_u32 m0, s25, 13824
    s_nop 0
    buffer_load_dwordx4 v2, s[8:11], s24 offen offset:1536 sc1 lds
    s_add_u32 m0, s25, 18432
    s_nop 0
    buffer_load_dwordx4 v2, s[8:11], s24 offen offset:2048 sc1 lds
    s_add_u32 m0, s25, 23040
    s_nop 0
    buffer_load_dwordx4 v2, s[8:11], s24 offen offset:2560 sc1 lds
    s_add_u32 m0, s26, 0
    s_add_u32 s7, s27, 0
    buffer_load_dwordx4 v2, s[8:11], s7 offen sc1 lds
    s_add_u32 m0, s29, 0
    s_add_u32 s7, s23, 0
    buffer_load_dwordx4 v2, s[8:11], s7 offen sc1 lds
    v_add_u32 v6, 46080, v253
    s_waitcnt vmcnt(0)
    s_barrier
    ds_read_b128 v[16:19], v253 offset:0
    ds_read_b128 v[20:23], v253 offset:1024
    ds_read_b128 v[24:27], v253 offset:2048
    ds_read_b128 v[28:31], v253 offset:3072
    ds_read_b128 v[32:35], v253 offset:4096
    s_waitcnt lgkmcnt(0)
    v_mfma_f32_16x16x32_bf16 v[56:59], a[0:3], v[20:23], 0
    ds_read_b128 v[36:39], v253 offset:5120
    v_mfma_f32_16x16x32_bf16 v[60:63], a[0:3], v[24:27], 0
    ds_read_b128 v[40:43], v253 offset:6144
    v_mfma_f32_16x16x32_bf16 v[64:67], a[0:3], v[28:31], 0
    ds_read_b128 v[44:47], v253 offset:7168
    v_mfma_f32_16x16x32_bf16 v[68:71], a[0:3], v[32:35], 0
    ds_read_b128 v[48:51], v253 offset:8192
    v_mfma_f32_16x16x32_bf16 v[72:75], a[4:7], v[16:19], 0
    ds_read_b128 v[52:55], v253 offset:9216
    v_mfma_f32_16x16x32_bf16 v[76:79], a[4:7], v[20:23], 0
    s_add_u32 m0, s25, 27648
    s_nop 0
    buffer_load_dwordx4 v2, s[8:11], s24 offen offset:3072 sc1 lds
    v_mfma_f32_16x16x32_bf16 v[80:83], a[4:7], v[24:27], 0
    v_mov_b32 v132, 0
    v_mov_b32 v133, 0
    v_mfma_f32_16x16x32_bf16 v[84:87], a[4:7], v[28:31], 0
    s_add_u32 m0, s25, 32256
    s_nop 0
    buffer_load_dwordx4 v2, s[8:11], s24 offen offset:3584 sc1 lds
    v_mfma_f32_16x16x32_bf16 v[88:91], a[4:7], v[32:35], 0
    v_mov_b32 v192, 0
    v_mov_b32 v193, 0
    v_mfma_f32_16x16x32_bf16 v[92:95], v[16:19], a[8:11], 0
    buffer_load_dwordx4 a[144:147], v253, s[8:11], s28 offen offset:0 sc1
    v_mfma_f32_16x16x32_bf16 v[96:99], v[20:23], a[8:11], 0
    v_mov_b32 v195, 0
    v_mov_b32 v135, 0
    v_mfma_f32_16x16x32_bf16 v[100:103], v[24:27], a[8:11], 0
    buffer_load_dwordx4 a[148:151], v253, s[8:11], s28 offen offset:1024 sc1
    v_mfma_f32_16x16x32_bf16 v[104:107], v[28:31], a[8:11], 0
    v_mov_b32 v139, 0
    v_mov_b32 v143, 0
    v_mfma_f32_16x16x32_bf16 v[108:111], v[32:35], a[8:11], 0
    buffer_load_dwordx4 a[152:155], v253, s[8:11], s28 offen offset:2048 sc1
    v_mfma_f32_16x16x32_bf16 v[112:115], a[12:15], v[16:19], 0
    v_mov_b32 v147, 0
    v_mov_b32 v151, 0
    v_mfma_f32_16x16x32_bf16 v[116:119], a[12:15], v[20:23], 0
    v_mov_b32 v155, 0
    v_mov_b32 v159, 0
    v_mfma_f32_16x16x32_bf16 v[120:123], a[12:15], v[24:27], 0
    v_mov_b32 v163, 0
    v_mov_b32 v167, 0
    v_mfma_f32_16x16x32_bf16 v[124:127], a[12:15], v[28:31], 0
    v_mov_b32 v171, 0
    v_cmp_eq_u32 vcc, 16, v0
    v_mov_b32 v10, 0x3f80
    v_mfma_f32_16x16x32_bf16 v[128:131], a[12:15], v[32:35], 0
    v_cmp_eq_u32 s[20:21], 17, v0
    v_cndmask_b32 v194, 0, v10, vcc
    v_and_b32 v11, 3, v0
    s_waitcnt lgkmcnt(0)
    v_mfma_f32_16x16x32_bf16 v[56:59], a[16:19], v[40:43], v[56:59]
    ds_read_b128 v[16:19], v253 offset:10240
    v_mfma_f32_16x16x32_bf16 v[60:63], a[16:19], v[44:47], v[60:63]
    ds_read_b128 v[20:23], v253 offset:11264
    v_mfma_f32_16x16x32_bf16 v[64:67], a[16:19], v[48:51], v[64:67]
    ds_read_b128 v[24:27], v253 offset:12288
    v_mfma_f32_16x16x32_bf16 v[68:71], a[16:19], v[52:55], v[68:71]
    ds_read_b128 v[28:31], v253 offset:13312
    v_mfma_f32_16x16x32_bf16 v[72:75], a[20:23], v[36:39], v[72:75]
    ds_read_b128 v[32:35], v253 offset:14336
    v_mfma_f32_16x16x32_bf16 v[76:79], a[20:23], v[40:43], v[76:79]
    s_add_u32 m0, s25, 40960
    s_add_u32 s24, s24, 4096
    buffer_load_dwordx4 v2, s[8:11], s24 offen offset:0 sc1 lds
    v_mfma_f32_16x16x32_bf16 v[80:83], a[20:23], v[44:47], v[80:83]
    v_cndmask_b32 v194, v194, 1.0, s[20:21]
    v_cmp_eq_u32 vcc, 2, v11
    v_and_b32 v10, 15, v0
    v_mfma_f32_16x16x32_bf16 v[84:87], a[20:23], v[48:51], v[84:87]
    s_add_u32 m0, s25, 45568
    s_nop 0
    buffer_load_dwordx4 v2, s[8:11], s24 offen offset:512 sc1 lds
    v_mfma_f32_16x16x32_bf16 v[88:91], a[20:23], v[52:55], v[88:91]
    v_lshrrev_b32 v11, 4, v0
    v_cndmask_b32 v196, 0, 1.0, vcc
    v_mfma_f32_16x16x32_bf16 v[92:95], v[36:39], a[24:27], v[92:95]
    buffer_load_dwordx4 a[156:159], v253, s[8:11], s28 offen offset:3072 sc1
    s_add_u32 s28, s28, 4096
    v_mfma_f32_16x16x32_bf16 v[96:99], v[40:43], a[24:27], v[96:99]
    v_cndmask_b32 v197, 0, 1.0, vcc
    v_cndmask_b32 v198, 0, 1.0, vcc
    v_mfma_f32_16x16x32_bf16 v[100:103], v[44:47], a[24:27], v[100:103]
    buffer_load_dwordx4 a[0:3], v253, s[8:11], s28 offen offset:0 sc1
    v_mfma_f32_16x16x32_bf16 v[104:107], v[48:51], a[24:27], v[104:107]
    v_cndmask_b32 v199, 0, 1.0, vcc
    v_lshlrev_b32 v11, 2, v11
    v_mfma_f32_16x16x32_bf16 v[108:111], v[52:55], a[24:27], v[108:111]
    buffer_load_dwordx4 a[4:7], v253, s[8:11], s28 offen offset:1024 sc1
    v_mfma_f32_16x16x32_bf16 v[112:115], a[28:31], v[36:39], v[112:115]
    v_sub_u32 v10, v11, v10
    v_mov_b32 v12, 0xf149f2ca
    v_mfma_f32_16x16x32_bf16 v[116:119], a[28:31], v[40:43], v[116:119]
    s_cmp_eq_u32 s41, 0
    s_cselect_b64 s[38:39], 0, -1
    v_add_u32 v11, 0, v10
    v_and_b32 v13, 1, v11
    v_mfma_f32_16x16x32_bf16 v[120:123], a[28:31], v[44:47], v[120:123]
    v_cmp_eq_u32 s[20:21], 0, v13
    v_cmp_lt_i32 vcc, 1, v11
    v_cmp_gt_i32 s[18:19], 1, v11
    s_and_b64 vcc, vcc, s[20:21]
    s_and_b64 s[18:19], s[18:19], s[20:21]
    s_and_b64 s[20:21], vcc, s[38:39]
    v_cndmask_b32 v200, v12, 0, vcc
    v_cndmask_b32 v204, v12, 0, s[18:19]
    v_mfma_f32_16x16x32_bf16 v[124:127], a[28:31], v[48:51], v[124:127]
    v_cndmask_b32 v208, v12, 0, s[20:21]
    v_add_u32 v11, 1, v10
    v_mfma_f32_16x16x32_bf16 v[128:131], a[28:31], v[52:55], v[128:131]
    v_and_b32 v13, 1, v11
    v_cmp_eq_u32 s[20:21], 0, v13
    v_cmp_lt_i32 vcc, 1, v11
    v_cmp_gt_i32 s[18:19], 1, v11
    s_and_b64 vcc, vcc, s[20:21]
    s_and_b64 s[18:19], s[18:19], s[20:21]
    s_and_b64 s[20:21], vcc, s[38:39]
    v_cndmask_b32 v201, v12, 0, vcc
    s_waitcnt lgkmcnt(0)
    v_mfma_f32_16x16x32_bf16 v[56:59], a[32:35], v[20:23], v[56:59]
    ds_read_b128 v[36:39], v253 offset:15360
    v_mfma_f32_16x16x32_bf16 v[60:63], a[32:35], v[24:27], v[60:63]
    ds_read_b128 v[40:43], v253 offset:16384
    v_mfma_f32_16x16x32_bf16 v[64:67], a[32:35], v[28:31], v[64:67]
    ds_read_b128 v[44:47], v253 offset:17408
    v_mfma_f32_16x16x32_bf16 v[68:71], a[32:35], v[32:35], v[68:71]
    ds_read_b128 v[48:51], v253 offset:18432
    v_mfma_f32_16x16x32_bf16 v[72:75], a[36:39], v[16:19], v[72:75]
    ds_read_b128 v[52:55], v253 offset:19456
    v_mfma_f32_16x16x32_bf16 v[76:79], a[36:39], v[20:23], v[76:79]
    s_add_u32 m0, s25, 50176
    s_nop 0
    buffer_load_dwordx4 v2, s[8:11], s24 offen offset:1024 sc1 lds
    v_mfma_f32_16x16x32_bf16 v[80:83], a[36:39], v[24:27], v[80:83]
    v_cndmask_b32 v205, v12, 0, s[18:19]
    v_cndmask_b32 v209, v12, 0, s[20:21]
    v_mfma_f32_16x16x32_bf16 v[84:87], a[36:39], v[28:31], v[84:87]
    s_add_u32 m0, s25, 54784
    s_nop 0
    buffer_load_dwordx4 v2, s[8:11], s24 offen offset:1536 sc1 lds
    v_mfma_f32_16x16x32_bf16 v[88:91], a[36:39], v[32:35], v[88:91]
    v_add_u32 v11, 2, v10
    v_and_b32 v13, 1, v11
    v_mfma_f32_16x16x32_bf16 v[92:95], v[16:19], a[40:43], v[92:95]
    buffer_load_dwordx4 a[8:11], v253, s[8:11], s28 offen offset:2048 sc1
    v_mfma_f32_16x16x32_bf16 v[96:99], v[20:23], a[40:43], v[96:99]
    v_cmp_eq_u32 s[20:21], 0, v13
    v_cmp_lt_i32 vcc, 1, v11
    v_cmp_gt_i32 s[18:19], 1, v11
    s_and_b64 vcc, vcc, s[20:21]
    s_and_b64 s[18:19], s[18:19], s[20:21]
    s_and_b64 s[20:21], vcc, s[38:39]
    v_cndmask_b32 v202, v12, 0, vcc
    v_cndmask_b32 v206, v12, 0, s[18:19]
    v_mfma_f32_16x16x32_bf16 v[100:103], v[24:27], a[40:43], v[100:103]
    buffer_load_dwordx4 a[12:15], v253, s[8:11], s28 offen offset:3072 sc1
    s_add_u32 s28, s28, 4096
    v_mfma_f32_16x16x32_bf16 v[104:107], v[28:31], a[40:43], v[104:107]
    v_cndmask_b32 v210, v12, 0, s[20:21]
    v_add_u32 v11, 3, v10
    v_mfma_f32_16x16x32_bf16 v[108:111], v[32:35], a[40:43], v[108:111]
    buffer_load_dwordx4 a[16:19], v253, s[8:11], s28 offen offset:0 sc1
    v_mfma_f32_16x16x32_bf16 v[112:115], a[44:47], v[16:19], v[112:115]
    v_and_b32 v13, 1, v11
    v_cmp_eq_u32 s[20:21], 0, v13
    v_cmp_lt_i32 vcc, 1, v11
    v_cmp_gt_i32 s[18:19], 1, v11
    s_and_b64 vcc, vcc, s[20:21]
    s_and_b64 s[18:19], s[18:19], s[20:21]
    s_and_b64 s[20:21], vcc, s[38:39]
    v_cndmask_b32 v203, v12, 0, vcc
    v_mfma_f32_16x16x32_bf16 v[116:119], a[44:47], v[20:23], v[116:119]
    v_cndmask_b32 v207, v12, 0, s[18:19]
    v_cndmask_b32 v211, v12, 0, s[20:21]
    v_mfma_f32_16x16x32_bf16 v[120:123], a[44:47], v[24:27], v[120:123]
    s_lshl_b32 s45, s41, 1
    s_lshr_b32 s7, s40, 2
    s_add_u32 s45, s45, s7
    s_mul_i32 s30, s45, 36864
    s_add_u32 s30, s30, s43
    s_and_b32 s31, s40, 3
    s_mul_i32 s31, s31, 9
    s_add_u32 s31, s31, s3
    s_mul_i32 s32, s31, 18432
    s_add_u32 s32, s32, 2359296
    s_add_u32 s33, s32, 73728
    s_add_u32 s34, s32, 147456
    s_mov_b32 s39, 19496960
    v_min_u32 v228, 44, v0
    v_lshlrev_b32 v228, 3, v228
    v_mfma_f32_16x16x32_bf16 v[124:127], a[44:47], v[28:31], v[124:127]
    s_cmp_eq_u32 s3, 1
    s_cmov_b32 s34, 3022848
    s_cmp_lt_u32 s3, 2
    s_cselect_b32 s35, 0, 1073741824
    v_add_u32 v5, s35, v253
    s_cmp_eq_u32 s3, 0
    s_cselect_b32 s35, 0, 1073741824
    v_add_u32 v7, s35, v9
    v_mfma_f32_16x16x32_bf16 v[128:131], a[44:47], v[32:35], v[128:131]
    s_lshl_b32 s7, s31, 8
    s_add_u32 s36, s30, s7
    s_add_u32 s37, s36, 43515904
    s_add_u32 s46, s36, 45875200
    s_lshl_b32 s36, s45, 7
    s_add_u32 s36, s36, s43
    s_add_u32 s36, s36, 48431104
    s_lshl_b32 s47, s45, 9
    s_add_u32 s47, s47, s43
    s_add_u32 s47, s47, 48234496
    v_bfe_u32 v10, v0, 3, 2
    v_and_b32 v8, 7, v0
    s_waitcnt lgkmcnt(0)
    v_mfma_f32_16x16x32_bf16 v[56:59], a[48:51], v[40:43], v[56:59]
    ds_read_b128 v[16:19], v253 offset:20480
    v_mfma_f32_16x16x32_bf16 v[60:63], a[48:51], v[44:47], v[60:63]
    ds_read_b128 v[20:23], v253 offset:21504
    v_mfma_f32_16x16x32_bf16 v[64:67], a[48:51], v[48:51], v[64:67]
    ds_read_b128 v[24:27], v253 offset:22528
    v_mfma_f32_16x16x32_bf16 v[68:71], a[48:51], v[52:55], v[68:71]
    ds_read_b128 v[28:31], v253 offset:23552
    v_mfma_f32_16x16x32_bf16 v[72:75], a[52:55], v[36:39], v[72:75]
    ds_read_b128 v[32:35], v253 offset:24576
    v_mfma_f32_16x16x32_bf16 v[76:79], a[52:55], v[40:43], v[76:79]
    s_add_u32 m0, s26, 30720
    s_add_u32 s7, s27, 3072
    buffer_load_dwordx4 v2, s[8:11], s7 offen sc1 lds
    v_mfma_f32_16x16x32_bf16 v[80:83], a[52:55], v[44:47], v[80:83]
    v_lshlrev_b32 v8, 2, v8
    v_lshl_add_u32 v8, v10, 7, v8
    v_mfma_f32_16x16x32_bf16 v[84:87], a[52:55], v[48:51], v[84:87]
    s_add_u32 m0, s29, 30720
    s_add_u32 s7, s23, 3072
    buffer_load_dwordx4 v2, s[8:11], s7 offen sc1 lds
    v_mfma_f32_16x16x32_bf16 v[88:91], a[52:55], v[52:55], v[88:91]
    v_mfma_f32_16x16x32_bf16 v[92:95], v[36:39], a[56:59], v[92:95]
    buffer_load_dwordx4 a[20:23], v253, s[8:11], s28 offen offset:1024 sc1
    v_mfma_f32_16x16x32_bf16 v[96:99], v[40:43], a[56:59], v[96:99]
    v_mfma_f32_16x16x32_bf16 v[100:103], v[44:47], a[56:59], v[100:103]
    buffer_load_dwordx4 a[24:27], v253, s[8:11], s28 offen offset:2048 sc1
    v_mfma_f32_16x16x32_bf16 v[104:107], v[48:51], a[56:59], v[104:107]
    v_mfma_f32_16x16x32_bf16 v[108:111], v[52:55], a[56:59], v[108:111]
    buffer_load_dwordx4 a[28:31], v253, s[8:11], s28 offen offset:3072 sc1
    s_add_u32 s28, s28, 4096
    v_mfma_f32_16x16x32_bf16 v[112:115], a[60:63], v[36:39], v[112:115]
    v_mfma_f32_16x16x32_bf16 v[116:119], a[60:63], v[40:43], v[116:119]
    v_mfma_f32_16x16x32_bf16 v[120:123], a[60:63], v[44:47], v[120:123]
    v_mfma_f32_16x16x32_bf16 v[124:127], a[60:63], v[48:51], v[124:127]
    v_mfma_f32_16x16x32_bf16 v[128:131], a[60:63], v[52:55], v[128:131]
    s_waitcnt lgkmcnt(0)
    v_mfma_f32_16x16x32_bf16 v[56:59], a[64:67], v[20:23], v[56:59]
    ds_read_b128 v[36:39], v253 offset:25600
    v_mfma_f32_16x16x32_bf16 v[60:63], a[64:67], v[24:27], v[60:63]
    ds_read_b128 v[40:43], v253 offset:26624
    v_mfma_f32_16x16x32_bf16 v[64:67], a[64:67], v[28:31], v[64:67]
    ds_read_b128 v[44:47], v253 offset:27648
    v_mfma_f32_16x16x32_bf16 v[68:71], a[64:67], v[32:35], v[68:71]
    ds_read_b128 v[48:51], v253 offset:28672
    v_mfma_f32_16x16x32_bf16 v[72:75], a[68:71], v[16:19], v[72:75]
    ds_read_b128 v[52:55], v253 offset:29696
    v_mfma_f32_16x16x32_bf16 v[76:79], a[68:71], v[20:23], v[76:79]
    buffer_load_dwordx4 a[32:35], v253, s[8:11], s28 offen offset:0 sc1
    v_mfma_f32_16x16x32_bf16 v[80:83], a[68:71], v[24:27], v[80:83]
    v_mfma_f32_16x16x32_bf16 v[84:87], a[68:71], v[28:31], v[84:87]
    buffer_load_dwordx4 a[36:39], v253, s[8:11], s28 offen offset:1024 sc1
    v_mfma_f32_16x16x32_bf16 v[88:91], a[68:71], v[32:35], v[88:91]
    v_mfma_f32_16x16x32_bf16 v[92:95], v[16:19], a[72:75], v[92:95]
    buffer_load_dwordx4 a[40:43], v253, s[8:11], s28 offen offset:2048 sc1
    v_mfma_f32_16x16x32_bf16 v[96:99], v[20:23], a[72:75], v[96:99]
    v_mfma_f32_16x16x32_bf16 v[100:103], v[24:27], a[72:75], v[100:103]
    v_mfma_f32_16x16x32_bf16 v[104:107], v[28:31], a[72:75], v[104:107]
    v_mfma_f32_16x16x32_bf16 v[108:111], v[32:35], a[72:75], v[108:111]
    v_mfma_f32_16x16x32_bf16 v[112:115], a[76:79], v[16:19], v[112:115]
    v_mfma_f32_16x16x32_bf16 v[116:119], a[76:79], v[20:23], v[116:119]
    v_mfma_f32_16x16x32_bf16 v[120:123], a[76:79], v[24:27], v[120:123]
    v_mfma_f32_16x16x32_bf16 v[124:127], a[76:79], v[28:31], v[124:127]
    v_mfma_f32_16x16x32_bf16 v[128:131], a[76:79], v[32:35], v[128:131]
    s_waitcnt vmcnt(6) lgkmcnt(0)
    s_barrier
    v_mfma_f32_16x16x32_bf16 v[56:59], a[80:83], v[40:43], v[56:59]
    ds_read_b128 v[16:19], v253 offset:30720
    v_mfma_f32_16x16x32_bf16 v[60:63], a[80:83], v[44:47], v[60:63]
    ds_read_b128 v[20:23], v253 offset:31744
    v_mfma_f32_16x16x32_bf16 v[64:67], a[80:83], v[48:51], v[64:67]
    ds_read_b128 v[24:27], v253 offset:32768
    v_mfma_f32_16x16x32_bf16 v[68:71], a[80:83], v[52:55], v[68:71]
    ds_read_b128 v[28:31], v253 offset:33792
    v_mfma_f32_16x16x32_bf16 v[72:75], a[84:87], v[36:39], v[72:75]
    ds_read_b128 v[32:35], v253 offset:34816
    v_mfma_f32_16x16x32_bf16 v[76:79], a[84:87], v[40:43], v[76:79]
    s_add_u32 m0, s25, 59392
    s_nop 0
    buffer_load_dwordx4 v2, s[8:11], s24 offen offset:2048 sc1 lds
    v_mfma_f32_16x16x32_bf16 v[80:83], a[84:87], v[44:47], v[80:83]
    v_mfma_f32_16x16x32_bf16 v[84:87], a[84:87], v[48:51], v[84:87]
    s_add_u32 m0, s25, 64000
    s_nop 0
    buffer_load_dwordx4 v2, s[8:11], s24 offen offset:2560 sc1 lds
    v_mfma_f32_16x16x32_bf16 v[88:91], a[84:87], v[52:55], v[88:91]
    v_mfma_f32_16x16x32_bf16 v[92:95], v[36:39], a[88:91], v[92:95]
    buffer_load_dwordx4 a[44:47], v253, s[8:11], s28 offen offset:3072 sc1
    s_add_u32 s28, s28, 4096
    v_mfma_f32_16x16x32_bf16 v[96:99], v[40:43], a[88:91], v[96:99]
    v_mfma_f32_16x16x32_bf16 v[100:103], v[44:47], a[88:91], v[100:103]
    buffer_load_dwordx4 a[48:51], v253, s[8:11], s28 offen offset:0 sc1
    v_mfma_f32_16x16x32_bf16 v[104:107], v[48:51], a[88:91], v[104:107]
    v_mfma_f32_16x16x32_bf16 v[108:111], v[52:55], a[88:91], v[108:111]
    buffer_load_dwordx4 a[52:55], v253, s[8:11], s28 offen offset:1024 sc1
    v_mfma_f32_16x16x32_bf16 v[112:115], a[92:95], v[36:39], v[112:115]
    v_mfma_f32_16x16x32_bf16 v[116:119], a[92:95], v[40:43], v[116:119]
    v_mfma_f32_16x16x32_bf16 v[120:123], a[92:95], v[44:47], v[120:123]
    v_mfma_f32_16x16x32_bf16 v[124:127], a[92:95], v[48:51], v[124:127]
    v_mfma_f32_16x16x32_bf16 v[128:131], a[92:95], v[52:55], v[128:131]
    s_waitcnt lgkmcnt(0)
    v_mfma_f32_16x16x32_bf16 v[56:59], a[96:99], v[20:23], v[56:59]
    ds_read_b128 v[36:39], v253 offset:35840
    v_mfma_f32_16x16x32_bf16 v[60:63], a[96:99], v[24:27], v[60:63]
    ds_read_b128 v[40:43], v253 offset:36864
    v_mfma_f32_16x16x32_bf16 v[64:67], a[96:99], v[28:31], v[64:67]
    ds_read_b128 v[44:47], v253 offset:37888
    v_mfma_f32_16x16x32_bf16 v[68:71], a[96:99], v[32:35], v[68:71]
    ds_read_b128 v[48:51], v253 offset:38912
    v_mfma_f32_16x16x32_bf16 v[72:75], a[100:103], v[16:19], v[72:75]
    ds_read_b128 v[52:55], v253 offset:39936
    v_mfma_f32_16x16x32_bf16 v[76:79], a[100:103], v[20:23], v[76:79]
    s_add_u32 m0, s25, 68608
    s_nop 0
    buffer_load_dwordx4 v2, s[8:11], s24 offen offset:3072 sc1 lds
    v_mfma_f32_16x16x32_bf16 v[80:83], a[100:103], v[24:27], v[80:83]
    v_mfma_f32_16x16x32_bf16 v[84:87], a[100:103], v[28:31], v[84:87]
    s_add_u32 m0, s25, 73216
    s_nop 0
    buffer_load_dwordx4 v2, s[8:11], s24 offen offset:3584 sc1 lds
    v_mfma_f32_16x16x32_bf16 v[88:91], a[100:103], v[32:35], v[88:91]
    v_mfma_f32_16x16x32_bf16 v[92:95], v[16:19], a[104:107], v[92:95]
    buffer_load_dwordx4 a[56:59], v253, s[8:11], s28 offen offset:2048 sc1
    v_mfma_f32_16x16x32_bf16 v[96:99], v[20:23], a[104:107], v[96:99]
    v_mfma_f32_16x16x32_bf16 v[100:103], v[24:27], a[104:107], v[100:103]
    buffer_load_dwordx4 a[60:63], v253, s[8:11], s28 offen offset:3072 sc1
    s_add_u32 s28, s28, 4096
    v_mfma_f32_16x16x32_bf16 v[104:107], v[28:31], a[104:107], v[104:107]
    v_mfma_f32_16x16x32_bf16 v[108:111], v[32:35], a[104:107], v[108:111]
    buffer_load_dwordx4 a[64:67], v253, s[8:11], s28 offen offset:0 sc1
    v_mfma_f32_16x16x32_bf16 v[112:115], a[108:111], v[16:19], v[112:115]
    v_mfma_f32_16x16x32_bf16 v[116:119], a[108:111], v[20:23], v[116:119]
    buffer_load_dwordx2 v[226:227], v228, s[8:11], s39 offen sc1
    v_mfma_f32_16x16x32_bf16 v[120:123], a[108:111], v[24:27], v[120:123]
    v_mfma_f32_16x16x32_bf16 v[124:127], a[108:111], v[28:31], v[124:127]
    v_mfma_f32_16x16x32_bf16 v[128:131], a[108:111], v[32:35], v[128:131]
    s_waitcnt lgkmcnt(0)
    v_mfma_f32_16x16x32_bf16 v[56:59], a[112:115], v[40:43], v[56:59]
    ds_read_b128 v[16:19], v253 offset:40960
    v_mfma_f32_16x16x32_bf16 v[60:63], a[112:115], v[44:47], v[60:63]
    ds_read_b128 v[20:23], v253 offset:41984
    v_mfma_f32_16x16x32_bf16 v[64:67], a[112:115], v[48:51], v[64:67]
    ds_read_b128 v[24:27], v253 offset:43008
    v_mfma_f32_16x16x32_bf16 v[68:71], a[112:115], v[52:55], v[68:71]
    ds_read_b128 v[28:31], v253 offset:44032
    v_mfma_f32_16x16x32_bf16 v[72:75], a[116:119], v[36:39], v[72:75]
    ds_read_b128 v[32:35], v253 offset:45056
    v_mfma_f32_16x16x32_bf16 v[76:79], a[116:119], v[40:43], v[76:79]
    s_add_u32 m0, s25, 81920
    s_add_u32 s24, s24, 4096
    buffer_load_dwordx4 v2, s[8:11], s24 offen offset:0 sc1 lds
    v_mfma_f32_16x16x32_bf16 v[80:83], a[116:119], v[44:47], v[80:83]
    v_mfma_f32_16x16x32_bf16 v[84:87], a[116:119], v[48:51], v[84:87]
    s_add_u32 m0, s25, 86528
    s_nop 0
    buffer_load_dwordx4 v2, s[8:11], s24 offen offset:512 sc1 lds
    v_mfma_f32_16x16x32_bf16 v[88:91], a[116:119], v[52:55], v[88:91]
    v_mfma_f32_16x16x32_bf16 v[92:95], v[36:39], a[120:123], v[92:95]
    buffer_load_dwordx4 a[68:71], v253, s[8:11], s28 offen offset:1024 sc1
    v_mfma_f32_16x16x32_bf16 v[96:99], v[40:43], a[120:123], v[96:99]
    v_mfma_f32_16x16x32_bf16 v[100:103], v[44:47], a[120:123], v[100:103]
    buffer_load_dwordx4 a[72:75], v253, s[8:11], s28 offen offset:2048 sc1
    v_mfma_f32_16x16x32_bf16 v[104:107], v[48:51], a[120:123], v[104:107]
    v_mfma_f32_16x16x32_bf16 v[108:111], v[52:55], a[120:123], v[108:111]
    buffer_load_dwordx4 a[76:79], v253, s[8:11], s28 offen offset:3072 sc1
    s_add_u32 s28, s28, 4096
    v_mfma_f32_16x16x32_bf16 v[112:115], a[124:127], v[36:39], v[112:115]
    v_mfma_f32_16x16x32_bf16 v[116:119], a[124:127], v[40:43], v[116:119]
    v_mfma_f32_16x16x32_bf16 v[120:123], a[124:127], v[44:47], v[120:123]
    v_mfma_f32_16x16x32_bf16 v[124:127], a[124:127], v[48:51], v[124:127]
    v_mfma_f32_16x16x32_bf16 v[128:131], a[124:127], v[52:55], v[128:131]
    s_waitcnt lgkmcnt(0)
    v_mfma_f32_16x16x32_bf16 v[56:59], a[128:131], v[20:23], v[56:59]
    ds_read_b128 v[36:39], v6 offset:0
    v_mfma_f32_16x16x32_bf16 v[60:63], a[128:131], v[24:27], v[60:63]
    ds_read_b128 v[40:43], v6 offset:1024
    v_mfma_f32_16x16x32_bf16 v[64:67], a[128:131], v[28:31], v[64:67]
    ds_read_b128 v[44:47], v6 offset:2048
    v_mfma_f32_16x16x32_bf16 v[68:71], a[128:131], v[32:35], v[68:71]
    ds_read_b128 v[48:51], v6 offset:3072
    v_mfma_f32_16x16x32_bf16 v[72:75], a[132:135], v[16:19], v[72:75]
    ds_read_b128 v[52:55], v6 offset:4096
    v_mfma_f32_16x16x32_bf16 v[76:79], a[132:135], v[20:23], v[76:79]
    s_add_u32 m0, s26, 61440
    s_add_u32 s7, s27, 6144
    buffer_load_dwordx4 v2, s[8:11], s7 offen sc1 lds
    v_mfma_f32_16x16x32_bf16 v[80:83], a[132:135], v[24:27], v[80:83]
    v_mfma_f32_16x16x32_bf16 v[84:87], a[132:135], v[28:31], v[84:87]
    s_add_u32 m0, s29, 61440
    s_add_u32 s7, s23, 6144
    buffer_load_dwordx4 v2, s[8:11], s7 offen sc1 lds
    v_mfma_f32_16x16x32_bf16 v[88:91], a[132:135], v[32:35], v[88:91]
    v_mfma_f32_16x16x32_bf16 v[92:95], v[16:19], a[136:139], v[92:95]
    buffer_load_dwordx4 a[80:83], v253, s[8:11], s28 offen offset:0 sc1
    v_mfma_f32_16x16x32_bf16 v[96:99], v[20:23], a[136:139], v[96:99]
    v_mfma_f32_16x16x32_bf16 v[100:103], v[24:27], a[136:139], v[100:103]
    buffer_load_dwordx4 a[84:87], v253, s[8:11], s28 offen offset:1024 sc1
    v_mfma_f32_16x16x32_bf16 v[104:107], v[28:31], a[136:139], v[104:107]
    v_mfma_f32_16x16x32_bf16 v[108:111], v[32:35], a[136:139], v[108:111]
    buffer_load_dwordx4 a[88:91], v253, s[8:11], s28 offen offset:2048 sc1
    v_mfma_f32_16x16x32_bf16 v[112:115], a[140:143], v[16:19], v[112:115]
    v_mfma_f32_16x16x32_bf16 v[116:119], a[140:143], v[20:23], v[116:119]
    v_mfma_f32_16x16x32_bf16 v[120:123], a[140:143], v[24:27], v[120:123]
    v_mfma_f32_16x16x32_bf16 v[124:127], a[140:143], v[28:31], v[124:127]
    v_mfma_f32_16x16x32_bf16 v[128:131], a[140:143], v[32:35], v[128:131]
    s_waitcnt vmcnt(10) lgkmcnt(0)
    s_mov_b32 s6, 0
L_wo_poll_15:
    v_cmp_eq_u32 vcc, s76, v226
    v_cmp_eq_u32 s[20:21], s76, v227
    s_and_b64 vcc, vcc, s[20:21]
    s_cmp_eq_u64 vcc, exec
    s_cbranch_scc1 L_wo_ready_16
    buffer_load_dwordx2 v[226:227], v228, s[8:11], s39 offen sc1
    s_add_u32 s6, s6, 1
    s_cmp_lt_u32 s6, 1048576
    s_waitcnt vmcnt(0)
    s_cbranch_scc1 L_wo_poll_15
    s_branch L_main_end
L_wo_ready_16:
    v_mfma_f32_16x16x32_bf16 v[56:59], a[144:147], v[40:43], v[56:59]
    ds_read_b128 v[16:19], v6 offset:5120
    v_mfma_f32_16x16x32_bf16 v[60:63], a[144:147], v[44:47], v[60:63]
    ds_read_b128 v[20:23], v6 offset:6144
    v_mfma_f32_16x16x32_bf16 v[64:67], a[144:147], v[48:51], v[64:67]
    ds_read_b128 v[24:27], v6 offset:7168
    v_mfma_f32_16x16x32_bf16 v[68:71], a[144:147], v[52:55], v[68:71]
    ds_read_b128 v[28:31], v6 offset:8192
    v_mfma_f32_16x16x32_bf16 v[72:75], a[148:151], v[36:39], v[72:75]
    ds_read_b128 v[32:35], v6 offset:9216
    v_mfma_f32_16x16x32_bf16 v[76:79], a[148:151], v[40:43], v[76:79]
    buffer_load_dwordx4 a[92:95], v253, s[8:11], s28 offen offset:3072 sc1
    s_add_u32 s28, s28, 4096
    v_mfma_f32_16x16x32_bf16 v[80:83], a[148:151], v[44:47], v[80:83]
    v_mfma_f32_16x16x32_bf16 v[84:87], a[148:151], v[48:51], v[84:87]
    buffer_load_dwordx4 a[96:99], v253, s[8:11], s28 offen offset:0 sc1
    v_mfma_f32_16x16x32_bf16 v[88:91], a[148:151], v[52:55], v[88:91]
    v_mfma_f32_16x16x32_bf16 v[92:95], v[36:39], a[152:155], v[92:95]
    buffer_load_dwordx4 a[100:103], v253, s[8:11], s28 offen offset:1024 sc1
    v_mfma_f32_16x16x32_bf16 v[96:99], v[40:43], a[152:155], v[96:99]
    v_mfma_f32_16x16x32_bf16 v[100:103], v[44:47], a[152:155], v[100:103]
    buffer_load_dwordx4 a[160:163], v253, s[8:11], s32 offen offset:0 sc1
    v_mfma_f32_16x16x32_bf16 v[104:107], v[48:51], a[152:155], v[104:107]
    v_mfma_f32_16x16x32_bf16 v[108:111], v[52:55], a[152:155], v[108:111]
    v_mfma_f32_16x16x32_bf16 v[112:115], a[156:159], v[36:39], v[112:115]
    v_mfma_f32_16x16x32_bf16 v[116:119], a[156:159], v[40:43], v[116:119]
    v_mfma_f32_16x16x32_bf16 v[120:123], a[156:159], v[44:47], v[120:123]
    v_mfma_f32_16x16x32_bf16 v[124:127], a[156:159], v[48:51], v[124:127]
    v_mfma_f32_16x16x32_bf16 v[128:131], a[156:159], v[52:55], v[128:131]
    s_waitcnt vmcnt(34) lgkmcnt(0)
    v_mfma_f32_16x16x32_bf16 v[56:59], a[0:3], v[20:23], v[56:59]
    ds_read_b128 v[36:39], v6 offset:10240
    v_mfma_f32_16x16x32_bf16 v[60:63], a[0:3], v[24:27], v[60:63]
    ds_read_b128 v[40:43], v6 offset:11264
    v_mfma_f32_16x16x32_bf16 v[64:67], a[0:3], v[28:31], v[64:67]
    ds_read_b128 v[44:47], v6 offset:12288
    v_mfma_f32_16x16x32_bf16 v[68:71], a[0:3], v[32:35], v[68:71]
    ds_read_b128 v[48:51], v6 offset:13312
    v_mfma_f32_16x16x32_bf16 v[72:75], a[4:7], v[16:19], v[72:75]
    ds_read_b128 v[52:55], v6 offset:14336
    v_mfma_f32_16x16x32_bf16 v[76:79], a[4:7], v[20:23], v[76:79]
    buffer_load_dwordx4 a[104:107], v253, s[8:11], s28 offen offset:2048 sc1
    v_mfma_f32_16x16x32_bf16 v[80:83], a[4:7], v[24:27], v[80:83]
    v_mfma_f32_16x16x32_bf16 v[84:87], a[4:7], v[28:31], v[84:87]
    buffer_load_dwordx4 a[108:111], v253, s[8:11], s28 offen offset:3072 sc1
    s_add_u32 s28, s28, 4096
    v_mfma_f32_16x16x32_bf16 v[88:91], a[4:7], v[32:35], v[88:91]
    v_mfma_f32_16x16x32_bf16 v[92:95], v[16:19], a[8:11], v[92:95]
    buffer_load_dwordx4 a[112:115], v253, s[8:11], s28 offen offset:0 sc1
    v_mfma_f32_16x16x32_bf16 v[96:99], v[20:23], a[8:11], v[96:99]
    v_mfma_f32_16x16x32_bf16 v[100:103], v[24:27], a[8:11], v[100:103]
    buffer_load_dwordx4 a[164:167], v253, s[8:11], s33 offen offset:0 sc1
    v_mfma_f32_16x16x32_bf16 v[104:107], v[28:31], a[8:11], v[104:107]
    v_mfma_f32_16x16x32_bf16 v[108:111], v[32:35], a[8:11], v[108:111]
    v_mfma_f32_16x16x32_bf16 v[112:115], a[12:15], v[16:19], v[112:115]
    v_mfma_f32_16x16x32_bf16 v[116:119], a[12:15], v[20:23], v[116:119]
    v_mfma_f32_16x16x32_bf16 v[120:123], a[12:15], v[24:27], v[120:123]
    v_mfma_f32_16x16x32_bf16 v[124:127], a[12:15], v[28:31], v[124:127]
    v_mfma_f32_16x16x32_bf16 v[128:131], a[12:15], v[32:35], v[128:131]
    s_waitcnt vmcnt(11) lgkmcnt(0)
    s_barrier
    v_mfma_f32_16x16x32_bf16 v[56:59], a[16:19], v[40:43], v[56:59]
    ds_read_b128 v[16:19], v6 offset:15360
    v_mfma_f32_16x16x32_bf16 v[60:63], a[16:19], v[44:47], v[60:63]
    ds_read_b128 v[20:23], v6 offset:16384
    v_mfma_f32_16x16x32_bf16 v[64:67], a[16:19], v[48:51], v[64:67]
    ds_read_b128 v[24:27], v6 offset:17408
    v_mfma_f32_16x16x32_bf16 v[68:71], a[16:19], v[52:55], v[68:71]
    ds_read_b128 v[28:31], v6 offset:18432
    v_mfma_f32_16x16x32_bf16 v[72:75], a[20:23], v[36:39], v[72:75]
    ds_read_b128 v[32:35], v6 offset:19456
    v_mfma_f32_16x16x32_bf16 v[76:79], a[20:23], v[40:43], v[76:79]
    buffer_load_dwordx4 a[116:119], v253, s[8:11], s28 offen offset:1024 sc1
    v_mfma_f32_16x16x32_bf16 v[80:83], a[20:23], v[44:47], v[80:83]
    v_mfma_f32_16x16x32_bf16 v[84:87], a[20:23], v[48:51], v[84:87]
    buffer_load_dwordx4 a[120:123], v253, s[8:11], s28 offen offset:2048 sc1
    v_mfma_f32_16x16x32_bf16 v[88:91], a[20:23], v[52:55], v[88:91]
    v_mfma_f32_16x16x32_bf16 v[92:95], v[36:39], a[24:27], v[92:95]
    buffer_load_dwordx4 a[124:127], v253, s[8:11], s28 offen offset:3072 sc1
    s_add_u32 s28, s28, 4096
    v_mfma_f32_16x16x32_bf16 v[96:99], v[40:43], a[24:27], v[96:99]
    v_mfma_f32_16x16x32_bf16 v[100:103], v[44:47], a[24:27], v[100:103]
    buffer_load_dwordx4 a[168:171], v5, s[8:11], s34 offen offset:0 sc1
    v_mfma_f32_16x16x32_bf16 v[104:107], v[48:51], a[24:27], v[104:107]
    v_mfma_f32_16x16x32_bf16 v[108:111], v[52:55], a[24:27], v[108:111]
    v_mfma_f32_16x16x32_bf16 v[112:115], a[28:31], v[36:39], v[112:115]
    v_mfma_f32_16x16x32_bf16 v[116:119], a[28:31], v[40:43], v[116:119]
    v_mfma_f32_16x16x32_bf16 v[120:123], a[28:31], v[44:47], v[120:123]
    v_mfma_f32_16x16x32_bf16 v[124:127], a[28:31], v[48:51], v[124:127]
    v_mfma_f32_16x16x32_bf16 v[128:131], a[28:31], v[52:55], v[128:131]
    s_waitcnt vmcnt(30) lgkmcnt(0)
    v_mfma_f32_16x16x32_bf16 v[56:59], a[32:35], v[20:23], v[56:59]
    ds_read_b128 v[36:39], v6 offset:20480
    v_mfma_f32_16x16x32_bf16 v[60:63], a[32:35], v[24:27], v[60:63]
    ds_read_b128 v[40:43], v6 offset:21504
    v_mfma_f32_16x16x32_bf16 v[64:67], a[32:35], v[28:31], v[64:67]
    ds_read_b128 v[44:47], v6 offset:22528
    v_mfma_f32_16x16x32_bf16 v[68:71], a[32:35], v[32:35], v[68:71]
    ds_read_b128 v[48:51], v6 offset:23552
    v_mfma_f32_16x16x32_bf16 v[72:75], a[36:39], v[16:19], v[72:75]
    ds_read_b128 v[52:55], v6 offset:24576
    v_mfma_f32_16x16x32_bf16 v[76:79], a[36:39], v[20:23], v[76:79]
    buffer_load_dwordx4 a[172:175], v253, s[8:11], s32 offen offset:1024 sc1
    v_mfma_f32_16x16x32_bf16 v[80:83], a[36:39], v[24:27], v[80:83]
    v_mfma_f32_16x16x32_bf16 v[84:87], a[36:39], v[28:31], v[84:87]
    buffer_load_dwordx4 a[176:179], v253, s[8:11], s33 offen offset:1024 sc1
    v_mfma_f32_16x16x32_bf16 v[88:91], a[36:39], v[32:35], v[88:91]
    v_mfma_f32_16x16x32_bf16 v[92:95], v[16:19], a[40:43], v[92:95]
    buffer_load_dwordx4 a[180:183], v5, s[8:11], s34 offen offset:1024 sc1
    v_mfma_f32_16x16x32_bf16 v[96:99], v[20:23], a[40:43], v[96:99]
    v_mfma_f32_16x16x32_bf16 v[100:103], v[24:27], a[40:43], v[100:103]
    buffer_load_dwordx4 a[184:187], v253, s[8:11], s32 offen offset:2048 sc1
    v_mfma_f32_16x16x32_bf16 v[104:107], v[28:31], a[40:43], v[104:107]
    v_mfma_f32_16x16x32_bf16 v[108:111], v[32:35], a[40:43], v[108:111]
    v_mfma_f32_16x16x32_bf16 v[112:115], a[44:47], v[16:19], v[112:115]
    v_mfma_f32_16x16x32_bf16 v[116:119], a[44:47], v[20:23], v[116:119]
    v_mfma_f32_16x16x32_bf16 v[120:123], a[44:47], v[24:27], v[120:123]
    v_mfma_f32_16x16x32_bf16 v[124:127], a[44:47], v[28:31], v[124:127]
    v_mfma_f32_16x16x32_bf16 v[128:131], a[44:47], v[32:35], v[128:131]
    s_waitcnt vmcnt(28) lgkmcnt(0)
    v_mfma_f32_16x16x32_bf16 v[56:59], a[48:51], v[40:43], v[56:59]
    ds_read_b128 v[16:19], v6 offset:25600
    v_mfma_f32_16x16x32_bf16 v[60:63], a[48:51], v[44:47], v[60:63]
    ds_read_b128 v[20:23], v6 offset:26624
    v_mfma_f32_16x16x32_bf16 v[64:67], a[48:51], v[48:51], v[64:67]
    ds_read_b128 v[24:27], v6 offset:27648
    v_mfma_f32_16x16x32_bf16 v[68:71], a[48:51], v[52:55], v[68:71]
    ds_read_b128 v[28:31], v6 offset:28672
    v_mfma_f32_16x16x32_bf16 v[72:75], a[52:55], v[36:39], v[72:75]
    ds_read_b128 v[32:35], v6 offset:29696
    v_mfma_f32_16x16x32_bf16 v[76:79], a[52:55], v[40:43], v[76:79]
    buffer_load_dwordx4 a[188:191], v253, s[8:11], s33 offen offset:2048 sc1
    v_mfma_f32_16x16x32_bf16 v[80:83], a[52:55], v[44:47], v[80:83]
    v_mfma_f32_16x16x32_bf16 v[84:87], a[52:55], v[48:51], v[84:87]
    buffer_load_dwordx4 a[192:195], v5, s[8:11], s34 offen offset:2048 sc1
    v_mfma_f32_16x16x32_bf16 v[88:91], a[52:55], v[52:55], v[88:91]
    v_mfma_f32_16x16x32_bf16 v[92:95], v[36:39], a[56:59], v[92:95]
    buffer_load_dwordx4 a[196:199], v253, s[8:11], s32 offen offset:3072 sc1
    s_add_u32 s32, s32, 4096
    v_mfma_f32_16x16x32_bf16 v[96:99], v[40:43], a[56:59], v[96:99]
    v_mfma_f32_16x16x32_bf16 v[100:103], v[44:47], a[56:59], v[100:103]
    buffer_load_dwordx4 a[200:203], v253, s[8:11], s33 offen offset:3072 sc1
    s_add_u32 s33, s33, 4096
    v_mfma_f32_16x16x32_bf16 v[104:107], v[48:51], a[56:59], v[104:107]
    v_mfma_f32_16x16x32_bf16 v[108:111], v[52:55], a[56:59], v[108:111]
    v_mfma_f32_16x16x32_bf16 v[112:115], a[60:63], v[36:39], v[112:115]
    v_mfma_f32_16x16x32_bf16 v[116:119], a[60:63], v[40:43], v[116:119]
    v_mfma_f32_16x16x32_bf16 v[120:123], a[60:63], v[44:47], v[120:123]
    v_mfma_f32_16x16x32_bf16 v[124:127], a[60:63], v[48:51], v[124:127]
    v_mfma_f32_16x16x32_bf16 v[128:131], a[60:63], v[52:55], v[128:131]
    s_waitcnt vmcnt(25) lgkmcnt(0)
    v_mfma_f32_16x16x32_bf16 v[56:59], a[64:67], v[20:23], v[56:59]
    ds_read_b128 v[36:39], v6 offset:30720
    v_mfma_f32_16x16x32_bf16 v[60:63], a[64:67], v[24:27], v[60:63]
    ds_read_b128 v[40:43], v6 offset:31744
    v_mfma_f32_16x16x32_bf16 v[64:67], a[64:67], v[28:31], v[64:67]
    ds_read_b128 v[44:47], v6 offset:32768
    v_mfma_f32_16x16x32_bf16 v[68:71], a[64:67], v[32:35], v[68:71]
    ds_read_b128 v[48:51], v6 offset:33792
    v_mfma_f32_16x16x32_bf16 v[72:75], a[68:71], v[16:19], v[72:75]
    ds_read_b128 v[52:55], v6 offset:34816
    v_mfma_f32_16x16x32_bf16 v[76:79], a[68:71], v[20:23], v[76:79]
    buffer_load_dwordx4 a[204:207], v5, s[8:11], s34 offen offset:3072 sc1
    s_add_u32 s34, s34, 4096
    v_mfma_f32_16x16x32_bf16 v[80:83], a[68:71], v[24:27], v[80:83]
    v_mfma_f32_16x16x32_bf16 v[84:87], a[68:71], v[28:31], v[84:87]
    buffer_load_dwordx4 a[208:211], v253, s[8:11], s32 offen offset:0 sc1
    v_mfma_f32_16x16x32_bf16 v[88:91], a[68:71], v[32:35], v[88:91]
    v_mfma_f32_16x16x32_bf16 v[92:95], v[16:19], a[72:75], v[92:95]
    buffer_load_dwordx4 a[212:215], v253, s[8:11], s33 offen offset:0 sc1
    v_mfma_f32_16x16x32_bf16 v[96:99], v[20:23], a[72:75], v[96:99]
    v_mfma_f32_16x16x32_bf16 v[100:103], v[24:27], a[72:75], v[100:103]
    buffer_load_dwordx4 a[216:219], v5, s[8:11], s34 offen offset:0 sc1
    v_mfma_f32_16x16x32_bf16 v[104:107], v[28:31], a[72:75], v[104:107]
    v_mfma_f32_16x16x32_bf16 v[108:111], v[32:35], a[72:75], v[108:111]
    v_mfma_f32_16x16x32_bf16 v[112:115], a[76:79], v[16:19], v[112:115]
    v_mfma_f32_16x16x32_bf16 v[116:119], a[76:79], v[20:23], v[116:119]
    v_mfma_f32_16x16x32_bf16 v[120:123], a[76:79], v[24:27], v[120:123]
    v_mfma_f32_16x16x32_bf16 v[124:127], a[76:79], v[28:31], v[124:127]
    v_mfma_f32_16x16x32_bf16 v[128:131], a[76:79], v[32:35], v[128:131]
    s_waitcnt vmcnt(23) lgkmcnt(0)
    v_mfma_f32_16x16x32_bf16 v[56:59], a[80:83], v[40:43], v[56:59]
    ds_read_b128 v[16:19], v6 offset:35840
    v_mfma_f32_16x16x32_bf16 v[60:63], a[80:83], v[44:47], v[60:63]
    ds_read_b128 v[20:23], v6 offset:36864
    v_mfma_f32_16x16x32_bf16 v[64:67], a[80:83], v[48:51], v[64:67]
    ds_read_b128 v[24:27], v6 offset:37888
    v_mfma_f32_16x16x32_bf16 v[68:71], a[80:83], v[52:55], v[68:71]
    ds_read_b128 v[28:31], v6 offset:38912
    v_mfma_f32_16x16x32_bf16 v[72:75], a[84:87], v[36:39], v[72:75]
    ds_read_b128 v[32:35], v6 offset:39936
    v_mfma_f32_16x16x32_bf16 v[76:79], a[84:87], v[40:43], v[76:79]
    buffer_load_dwordx4 a[220:223], v253, s[8:11], s32 offen offset:1024 sc1
    v_mfma_f32_16x16x32_bf16 v[80:83], a[84:87], v[44:47], v[80:83]
    v_mfma_f32_16x16x32_bf16 v[84:87], a[84:87], v[48:51], v[84:87]
    buffer_load_dwordx4 a[224:227], v253, s[8:11], s33 offen offset:1024 sc1
    v_mfma_f32_16x16x32_bf16 v[88:91], a[84:87], v[52:55], v[88:91]
    v_mfma_f32_16x16x32_bf16 v[92:95], v[36:39], a[88:91], v[92:95]
    buffer_load_dwordx4 a[228:231], v5, s[8:11], s34 offen offset:1024 sc1
    v_mfma_f32_16x16x32_bf16 v[96:99], v[40:43], a[88:91], v[96:99]
    v_mfma_f32_16x16x32_bf16 v[100:103], v[44:47], a[88:91], v[100:103]
    buffer_load_dwordx4 a[232:235], v253, s[8:11], s32 offen offset:2048 sc1
    v_mfma_f32_16x16x32_bf16 v[104:107], v[48:51], a[88:91], v[104:107]
    v_mfma_f32_16x16x32_bf16 v[108:111], v[52:55], a[88:91], v[108:111]
    v_mfma_f32_16x16x32_bf16 v[112:115], a[92:95], v[36:39], v[112:115]
    v_mfma_f32_16x16x32_bf16 v[116:119], a[92:95], v[40:43], v[116:119]
    v_mfma_f32_16x16x32_bf16 v[120:123], a[92:95], v[44:47], v[120:123]
    v_mfma_f32_16x16x32_bf16 v[124:127], a[92:95], v[48:51], v[124:127]
    v_mfma_f32_16x16x32_bf16 v[128:131], a[92:95], v[52:55], v[128:131]
    s_waitcnt vmcnt(22) lgkmcnt(0)
    v_mfma_f32_16x16x32_bf16 v[56:59], a[96:99], v[20:23], v[56:59]
    ds_read_b128 v[36:39], v6 offset:40960
    v_mfma_f32_16x16x32_bf16 v[60:63], a[96:99], v[24:27], v[60:63]
    ds_read_b128 v[40:43], v6 offset:41984
    v_mfma_f32_16x16x32_bf16 v[64:67], a[96:99], v[28:31], v[64:67]
    ds_read_b128 v[44:47], v6 offset:43008
    v_mfma_f32_16x16x32_bf16 v[68:71], a[96:99], v[32:35], v[68:71]
    ds_read_b128 v[48:51], v6 offset:44032
    v_mfma_f32_16x16x32_bf16 v[72:75], a[100:103], v[16:19], v[72:75]
    ds_read_b128 v[52:55], v6 offset:45056
    v_mfma_f32_16x16x32_bf16 v[76:79], a[100:103], v[20:23], v[76:79]
    buffer_load_dwordx4 a[236:239], v253, s[8:11], s33 offen offset:2048 sc1
    v_mfma_f32_16x16x32_bf16 v[80:83], a[100:103], v[24:27], v[80:83]
    v_mfma_f32_16x16x32_bf16 v[84:87], a[100:103], v[28:31], v[84:87]
    buffer_load_dwordx4 a[240:243], v5, s[8:11], s34 offen offset:2048 sc1
    v_mfma_f32_16x16x32_bf16 v[88:91], a[100:103], v[32:35], v[88:91]
    v_mfma_f32_16x16x32_bf16 v[92:95], v[16:19], a[104:107], v[92:95]
    buffer_load_dwordx4 a[244:247], v253, s[8:11], s32 offen offset:3072 sc1
    s_add_u32 s32, s32, 4096
    v_mfma_f32_16x16x32_bf16 v[96:99], v[20:23], a[104:107], v[96:99]
    v_mfma_f32_16x16x32_bf16 v[100:103], v[24:27], a[104:107], v[100:103]
    buffer_load_dwordx4 a[248:251], v253, s[8:11], s33 offen offset:3072 sc1
    s_add_u32 s33, s33, 4096
    v_mfma_f32_16x16x32_bf16 v[104:107], v[28:31], a[104:107], v[104:107]
    v_mfma_f32_16x16x32_bf16 v[108:111], v[32:35], a[104:107], v[108:111]
    v_mfma_f32_16x16x32_bf16 v[112:115], a[108:111], v[16:19], v[112:115]
    v_mfma_f32_16x16x32_bf16 v[116:119], a[108:111], v[20:23], v[116:119]
    v_mfma_f32_16x16x32_bf16 v[120:123], a[108:111], v[24:27], v[120:123]
    v_mfma_f32_16x16x32_bf16 v[124:127], a[108:111], v[28:31], v[124:127]
    v_mfma_f32_16x16x32_bf16 v[128:131], a[108:111], v[32:35], v[128:131]
    s_waitcnt vmcnt(21) lgkmcnt(0)
    v_mfma_f32_16x16x32_bf16 v[56:59], a[112:115], v[40:43], v[56:59]
    v_mfma_f32_16x16x32_bf16 v[60:63], a[112:115], v[44:47], v[60:63]
    v_mfma_f32_16x16x32_bf16 v[64:67], a[112:115], v[48:51], v[64:67]
    v_mfma_f32_16x16x32_bf16 v[68:71], a[112:115], v[52:55], v[68:71]
    v_mfma_f32_16x16x32_bf16 v[72:75], a[116:119], v[36:39], v[72:75]
    v_mfma_f32_16x16x32_bf16 v[76:79], a[116:119], v[40:43], v[76:79]
    buffer_load_dwordx4 a[252:255], v5, s[8:11], s34 offen offset:3072 sc1
    s_add_u32 s34, s34, 4096
    v_mfma_f32_16x16x32_bf16 v[80:83], a[116:119], v[44:47], v[80:83]
    v_mfma_f32_16x16x32_bf16 v[84:87], a[116:119], v[48:51], v[84:87]
    buffer_load_dwordx4 a[128:131], v253, s[8:11], s32 offen offset:0 sc1
    v_mfma_f32_16x16x32_bf16 v[88:91], a[116:119], v[52:55], v[88:91]
    v_mfma_f32_16x16x32_bf16 v[92:95], v[36:39], a[120:123], v[92:95]
    buffer_load_dwordx4 a[132:135], v253, s[8:11], s33 offen offset:0 sc1
    v_mfma_f32_16x16x32_bf16 v[96:99], v[40:43], a[120:123], v[96:99]
    v_mfma_f32_16x16x32_bf16 v[100:103], v[44:47], a[120:123], v[100:103]
    buffer_load_dwordx4 a[136:139], v5, s[8:11], s34 offen offset:0 sc1
    v_mfma_f32_16x16x32_bf16 v[104:107], v[48:51], a[120:123], v[104:107]
    v_mfma_f32_16x16x32_bf16 v[108:111], v[52:55], a[120:123], v[108:111]
    v_mfma_f32_16x16x32_bf16 v[112:115], a[124:127], v[36:39], v[112:115]
    v_mfma_f32_16x16x32_bf16 v[116:119], a[124:127], v[40:43], v[116:119]
    v_mfma_f32_16x16x32_bf16 v[120:123], a[124:127], v[44:47], v[120:123]
    v_mfma_f32_16x16x32_bf16 v[124:127], a[124:127], v[48:51], v[124:127]
    v_mfma_f32_16x16x32_bf16 v[128:131], a[124:127], v[52:55], v[128:131]
    v_cvt_pk_bf16_f32 v136, v56, v57
    v_cvt_pk_bf16_f32 v137, v58, v59
    v_cvt_pk_bf16_f32 v140, v60, v61
    v_cvt_pk_bf16_f32 v141, v62, v63
    v_cvt_pk_bf16_f32 v144, v64, v65
    v_cvt_pk_bf16_f32 v145, v66, v67
    v_cvt_pk_bf16_f32 v148, v68, v69
    v_cvt_pk_bf16_f32 v149, v70, v71
    v_cvt_pk_bf16_f32 v152, v72, v73
    buffer_load_dwordx4 a[140:143], v253, s[8:11], s32 offen offset:1024 sc1
    v_cvt_pk_bf16_f32 v153, v74, v75
    v_cvt_pk_bf16_f32 v156, v76, v77
    v_cvt_pk_bf16_f32 v157, v78, v79
    v_cvt_pk_bf16_f32 v160, v80, v81
    v_cvt_pk_bf16_f32 v161, v82, v83
    v_cvt_pk_bf16_f32 v164, v84, v85
    v_cvt_pk_bf16_f32 v165, v86, v87
    v_cvt_pk_bf16_f32 v168, v88, v89
    v_cvt_pk_bf16_f32 v169, v90, v91
    buffer_load_dwordx4 a[144:147], v253, s[8:11], s33 offen offset:1024 sc1
    v_cvt_pk_bf16_f32 v134, v112, v113
    v_cvt_pk_bf16_f32 v154, v114, v115
    v_cvt_pk_bf16_f32 v138, v116, v117
    v_cvt_pk_bf16_f32 v158, v118, v119
    v_cvt_pk_bf16_f32 v142, v120, v121
    v_cvt_pk_bf16_f32 v162, v122, v123
    v_cvt_pk_bf16_f32 v146, v124, v125
    v_cvt_pk_bf16_f32 v166, v126, v127
    v_cvt_pk_bf16_f32 v150, v128, v129
    buffer_load_dwordx4 a[148:151], v5, s[8:11], s34 offen offset:1024 sc1
    v_cvt_pk_bf16_f32 v170, v130, v131
    v_cvt_pk_bf16_f32 v172, v92, v93
    v_cvt_pk_bf16_f32 v173, v94, v95
    v_cvt_pk_bf16_f32 v174, v96, v97
    v_cvt_pk_bf16_f32 v175, v98, v99
    v_cvt_pk_bf16_f32 v176, v100, v101
    v_cvt_pk_bf16_f32 v177, v102, v103
    v_cvt_pk_bf16_f32 v178, v104, v105
    v_cvt_pk_bf16_f32 v179, v106, v107
    buffer_load_dwordx4 a[152:155], v253, s[8:11], s32 offen offset:2048 sc1
    v_cvt_pk_bf16_f32 v180, v108, v109
    v_cvt_pk_bf16_f32 v181, v110, v111
    v_mfma_f32_16x16x32_bf16 v[16:19], v[152:155], v[136:139], v[208:211]
    v_mfma_f32_16x16x32_bf16 v[20:23], v[156:159], v[136:139], v[204:207]
    v_mfma_f32_16x16x32_bf16 v[24:27], v[156:159], v[140:143], v[200:203]
    v_mfma_f32_16x16x32_bf16 v[28:31], v[160:163], v[140:143], v[204:207]
    v_mfma_f32_16x16x32_bf16 v[32:35], v[160:163], v[144:147], v[200:203]
    v_mfma_f32_16x16x32_bf16 v[36:39], v[164:167], v[144:147], v[204:207]
    v_mfma_f32_16x16x32_bf16 v[40:43], v[164:167], v[148:151], v[200:203]
    buffer_load_dwordx4 a[156:159], v253, s[8:11], s33 offen offset:2048 sc1
    v_mfma_f32_16x16x32_bf16 v[44:47], v[168:171], v[148:151], v[204:207]
    v_mfma_f32_16x16x32_bf16 v[56:59], v[132:135], v[192:195], v[196:199]
    v_mfma_f32_16x16x32_bf16 v[60:63], v[136:139], v[192:195], v[196:199]
    v_mfma_f32_16x16x32_bf16 v[64:67], v[140:143], v[192:195], v[196:199]
    v_mfma_f32_16x16x32_bf16 v[68:71], v[144:147], v[192:195], v[196:199]
    v_mfma_f32_16x16x32_bf16 v[72:75], v[148:151], v[192:195], v[196:199]
    v_max3_f32 v92, v16, v17, v18
    v_max3_f32 v96, v19, v20, v21
    v_max3_f32 v93, v24, v25, v26
    buffer_load_dwordx4 a[0:3], v5, s[8:11], s34 offen offset:2048 sc1
    v_max3_f32 v97, v27, v28, v29
    v_max3_f32 v94, v32, v33, v34
    v_max3_f32 v98, v35, v36, v37
    v_max3_f32 v95, v40, v41, v42
    v_max3_f32 v99, v43, v44, v45
    v_max3_f32 v92, v92, v22, v23
    v_max3_f32 v93, v93, v30, v31
    v_max3_f32 v94, v94, v38, v39
    v_max3_f32 v95, v95, v46, v47
    buffer_load_dwordx4 a[4:7], v253, s[8:11], s32 offen offset:3072 sc1
    s_add_u32 s32, s32, 4096
    v_max_f32 v92, v92, v96
    v_max_f32 v93, v93, v97
    v_max_f32 v94, v94, v98
    v_max_f32 v95, v95, v99
    s_mov_b32 s18, 0x3eae1a93
    v_cvt_pk_bf16_f32 v182, v56, v57
    v_permlane32_swap_b32 v92, v93
    v_permlane32_swap_b32 v94, v95
    v_max_f32 v92, v92, v93
    buffer_load_dwordx4 a[8:11], v253, s[8:11], s33 offen offset:3072 sc1
    s_add_u32 s33, s33, 4096
    v_max_f32 v94, v94, v95
    v_cvt_pk_bf16_f32 v183, v58, v59
    v_cvt_pk_bf16_f32 v184, v60, v61
    v_permlane16_swap_b32 v92, v94
    v_max_f32 v92, v92, v94
    v_mul_f32 v92, 0xbeae1a93, v92
    v_mov_b32 v94, v92
    v_cvt_pk_bf16_f32 v185, v62, v63
    v_cvt_pk_bf16_f32 v186, v64, v65
    buffer_load_dwordx4 a[12:15], v5, s[8:11], s34 offen offset:3072 sc1
    s_add_u32 s34, s34, 4096
    v_permlane16_swap_b32 v92, v94
    v_mov_b32 v93, v92
    v_mov_b32 v95, v94
    v_cvt_pk_bf16_f32 v187, v66, v67
    v_cvt_pk_bf16_f32 v188, v68, v69
    v_permlane32_swap_b32 v92, v93
    v_permlane32_swap_b32 v94, v95
    v_cvt_pk_bf16_f32 v189, v70, v71
    v_cvt_pk_bf16_f32 v190, v72, v73
    buffer_load_dwordx4 a[16:19], v253, s[8:11], s32 offen offset:0 sc1
    v_cvt_pk_bf16_f32 v191, v74, v75
    v_fma_f32 v16, v16, s18, v92
    v_fma_f32 v17, v17, s18, v92
    v_fma_f32 v18, v18, s18, v92
    v_fma_f32 v19, v19, s18, v92
    v_fma_f32 v20, v20, s18, v92
    v_fma_f32 v21, v21, s18, v92
    v_fma_f32 v22, v22, s18, v92
    v_fma_f32 v23, v23, s18, v92
    buffer_load_dwordx4 a[20:23], v253, s[8:11], s33 offen offset:0 sc1
    v_exp_f32 v16, v16
    v_exp_f32 v17, v17
    v_exp_f32 v18, v18
    v_exp_f32 v19, v19
    v_exp_f32 v20, v20
    v_exp_f32 v21, v21
    v_exp_f32 v22, v22
    v_exp_f32 v23, v23
    s_nop 0
    buffer_load_dwordx4 a[24:27], v5, s[8:11], s34 offen offset:0 sc1
    v_cvt_pk_bf16_f32 v76, v16, v17
    v_cvt_pk_bf16_f32 v77, v18, v19
    v_cvt_pk_bf16_f32 v78, v20, v21
    v_cvt_pk_bf16_f32 v79, v22, v23
    v_fma_f32 v24, v24, s18, v93
    v_fma_f32 v25, v25, s18, v93
    v_fma_f32 v26, v26, s18, v93
    v_fma_f32 v27, v27, s18, v93
    v_fma_f32 v28, v28, s18, v93
    buffer_load_dwordx4 a[28:31], v253, s[8:11], s32 offen offset:1024 sc1
    v_fma_f32 v29, v29, s18, v93
    v_fma_f32 v30, v30, s18, v93
    v_fma_f32 v31, v31, s18, v93
    v_exp_f32 v24, v24
    v_exp_f32 v25, v25
    v_exp_f32 v26, v26
    v_exp_f32 v27, v27
    v_exp_f32 v28, v28
    v_exp_f32 v29, v29
    buffer_load_dwordx4 a[32:35], v253, s[8:11], s33 offen offset:1024 sc1
    v_exp_f32 v30, v30
    v_exp_f32 v31, v31
    v_mfma_f32_16x16x32_bf16 v[100:103], v[172:175], v[76:79], 0
    v_mfma_f32_16x16x32_bf16 v[116:119], v[182:185], v[76:79], 0
    v_cvt_pk_bf16_f32 v80, v24, v25
    v_cvt_pk_bf16_f32 v81, v26, v27
    v_cvt_pk_bf16_f32 v82, v28, v29
    v_cvt_pk_bf16_f32 v83, v30, v31
    v_fma_f32 v32, v32, s18, v94
    buffer_load_dwordx4 a[36:39], v5, s[8:11], s34 offen offset:1024 sc1
    v_fma_f32 v33, v33, s18, v94
    v_fma_f32 v34, v34, s18, v94
    v_fma_f32 v35, v35, s18, v94
    v_fma_f32 v36, v36, s18, v94
    v_fma_f32 v37, v37, s18, v94
    v_fma_f32 v38, v38, s18, v94
    v_fma_f32 v39, v39, s18, v94
    v_exp_f32 v32, v32
    v_exp_f32 v33, v33
    buffer_load_dwordx4 a[40:43], v253, s[8:11], s32 offen offset:2048 sc1
    v_exp_f32 v34, v34
    v_exp_f32 v35, v35
    v_exp_f32 v36, v36
    v_exp_f32 v37, v37
    v_exp_f32 v38, v38
    v_exp_f32 v39, v39
    v_mfma_f32_16x16x32_bf16 v[104:107], v[174:177], v[80:83], 0
    v_mfma_f32_16x16x32_bf16 v[120:123], v[184:187], v[80:83], 0
    v_cvt_pk_bf16_f32 v84, v32, v33
    buffer_load_dwordx4 a[44:47], v253, s[8:11], s33 offen offset:2048 sc1
    v_cvt_pk_bf16_f32 v85, v34, v35
    v_cvt_pk_bf16_f32 v86, v36, v37
    v_cvt_pk_bf16_f32 v87, v38, v39
    v_fma_f32 v40, v40, s18, v95
    v_fma_f32 v41, v41, s18, v95
    v_fma_f32 v42, v42, s18, v95
    v_fma_f32 v43, v43, s18, v95
    v_fma_f32 v44, v44, s18, v95
    v_fma_f32 v45, v45, s18, v95
    buffer_load_dwordx4 a[48:51], v5, s[8:11], s34 offen offset:2048 sc1
    v_fma_f32 v46, v46, s18, v95
    v_fma_f32 v47, v47, s18, v95
    v_exp_f32 v40, v40
    v_exp_f32 v41, v41
    v_exp_f32 v42, v42
    v_exp_f32 v43, v43
    v_exp_f32 v44, v44
    v_exp_f32 v45, v45
    v_exp_f32 v46, v46
    buffer_load_dwordx4 a[52:55], v253, s[8:11], s32 offen offset:3072 sc1
    s_add_u32 s32, s32, 4096
    v_exp_f32 v47, v47
    v_mfma_f32_16x16x32_bf16 v[108:111], v[176:179], v[84:87], 0
    v_mfma_f32_16x16x32_bf16 v[124:127], v[186:189], v[84:87], 0
    v_cvt_pk_bf16_f32 v88, v40, v41
    v_cvt_pk_bf16_f32 v89, v42, v43
    v_cvt_pk_bf16_f32 v90, v44, v45
    v_cvt_pk_bf16_f32 v91, v46, v47
    v_rcp_f32 v96, v118
    v_rcp_f32 v97, v122
    buffer_load_dwordx4 v[240:243], v9, s[8:11], s37 offen offset:0 sc1
    v_mfma_f32_16x16x32_bf16 v[112:115], v[178:181], v[88:91], 0
    v_mfma_f32_16x16x32_bf16 v[128:131], v[188:191], v[88:91], 0
    v_pk_mul_f32 v[100:101], v[96:97], v[100:101] op_sel:[0,0] op_sel_hi:[0,1]
    v_pk_mul_f32 v[102:103], v[96:97], v[102:103] op_sel:[0,0] op_sel_hi:[0,1]
    v_pk_mul_f32 v[116:117], v[96:97], v[116:117] op_sel:[0,0] op_sel_hi:[0,1]
    v_cvt_pk_bf16_f32 v212, v100, v101
    v_cvt_pk_bf16_f32 v213, v102, v103
    v_cvt_pk_bf16_f32 v220, v116, v117
    v_rcp_f32 v98, v126
    buffer_load_dwordx4 v[244:247], v9, s[8:11], s37 offen offset:1024 sc1
    v_pk_mul_f32 v[104:105], v[96:97], v[104:105] op_sel:[1,0] op_sel_hi:[1,1]
    v_pk_mul_f32 v[106:107], v[96:97], v[106:107] op_sel:[1,0] op_sel_hi:[1,1]
    v_pk_mul_f32 v[120:121], v[96:97], v[120:121] op_sel:[1,0] op_sel_hi:[1,1]
    v_cvt_pk_bf16_f32 v214, v104, v105
    v_cvt_pk_bf16_f32 v215, v106, v107
    v_cvt_pk_bf16_f32 v221, v120, v121
    v_rcp_f32 v99, v130
    v_permlane16_swap_b32 v212, v214
    v_permlane16_swap_b32 v213, v215
    buffer_load_dwordx4 v[248:251], v7, s[8:11], s37 offen offset:2048 sc1
    v_pk_mul_f32 v[108:109], v[98:99], v[108:109] op_sel:[0,0] op_sel_hi:[0,1]
    v_pk_mul_f32 v[110:111], v[98:99], v[110:111] op_sel:[0,0] op_sel_hi:[0,1]
    v_pk_mul_f32 v[124:125], v[98:99], v[124:125] op_sel:[0,0] op_sel_hi:[0,1]
    v_cvt_pk_bf16_f32 v216, v108, v109
    v_cvt_pk_bf16_f32 v217, v110, v111
    v_cvt_pk_bf16_f32 v222, v124, v125
    v_pk_mul_f32 v[112:113], v[98:99], v[112:113] op_sel:[1,0] op_sel_hi:[1,1]
    v_pk_mul_f32 v[114:115], v[98:99], v[114:115] op_sel:[1,0] op_sel_hi:[1,1]
    v_pk_mul_f32 v[128:129], v[98:99], v[128:129] op_sel:[1,0] op_sel_hi:[1,1]
    buffer_load_dword v252, v8, s[8:11], s47 offen sc1
    v_cvt_pk_bf16_f32 v218, v112, v113
    v_cvt_pk_bf16_f32 v219, v114, v115
    v_cvt_pk_bf16_f32 v223, v128, v129
    s_lshl_b32 s7, s3, 2
    s_add_u32 s7, s7, 94208
    v_permlane16_swap_b32 v220, v221
    v_permlane16_swap_b32 v222, v223
    v_add_u32 v11, s7, v253
    v_lshrrev_b32 v10, 3, v0
    v_permlane32_swap_b32 v220, v222
    v_mul_u32_u24 v10, 9216, v10
    ds_write_b32 v11, v220
    v_permlane16_swap_b32 v216, v218
    v_permlane16_swap_b32 v217, v219
    s_mul_i32 s7, s40, 1152
    s_add_u32 s22, s22, s7
    s_add_u32 s22, s22, 41156608
    s_lshl_b32 s7, s3, 8
    s_add_u32 s23, s22, s7
    s_add_u32 s24, s23, 36864
    buffer_store_dwordx4 v[212:215], v9, s[8:11], s23 offen sc1
    buffer_store_dwordx4 v[216:219], v9, s[8:11], s24 offen sc1
    v_and_b32 v11, 7, v0
    v_lshl_add_u32 v10, v11, 4, v10
    s_cmp_eq_u32 s3, 3
    s_cselect_b32 s7, 0, 1073741824
    v_add_u32 v10, s7, v10
    v_add_u32 v11, 94208, v253
    s_waitcnt lgkmcnt(0)
    s_barrier
    ds_read_b128 v[220:223], v11
    s_waitcnt lgkmcnt(0)
    buffer_store_dwordx4 v[220:223], v10, s[8:11], s22 offen offset:1024 sc1
    v_lshlrev_b32 v15, 7, v0
    s_lshl_b32 s6, s40, 2
    s_add_u32 s6, s6, s44
    v_mov_b32 v1, s76
    s_mov_b64 vcc, 0xff
    s_waitcnt vmcnt(0)
    s_barrier
    s_cmp_lg_u32 s3, 0
    s_cbranch_scc1 L_pub_17
    s_mov_b64 exec, vcc
    buffer_store_dword v1, v15, s[8:11], s6 offen sc1
L_pub_17:
    s_mov_b64 exec, -1
    buffer_load_dwordx4 a[56:59], v253, s[8:11], s33 offen offset:3072 sc1
    s_add_u32 s33, s33, 4096
    buffer_load_dwordx4 a[60:63], v5, s[8:11], s34 offen offset:3072 sc1
    s_add_u32 s34, s34, 4096
    buffer_load_dwordx4 a[64:67], v253, s[8:11], s32 offen offset:0 sc1
    buffer_load_dwordx4 a[68:71], v253, s[8:11], s33 offen offset:0 sc1
    buffer_load_dwordx4 a[72:75], v5, s[8:11], s34 offen offset:0 sc1
    buffer_load_dwordx4 a[76:79], v253, s[8:11], s32 offen offset:1024 sc1
    buffer_load_dwordx4 a[80:83], v253, s[8:11], s33 offen offset:1024 sc1
    buffer_load_dwordx4 a[84:87], v5, s[8:11], s34 offen offset:1024 sc1
    s_cmp_lg_u32 s42, 0
    s_cbranch_scc1 L_swz_18
    s_cmp_eq_u32 s93, 2
    s_cselect_b32 s6, 2, 3
    s_mov_b32 s7, 512
    s_cmov_b32 s7, 2048
    v_lshrrev_b32 v14, 4, v0
    v_lshlrev_b32 v14, s6, v14
    v_bfe_u32 v15, v0, 2, 2
    v_add_u32 v14, v14, v15
    v_mul_u32_u24 v14, 128, v14
    v_and_b32 v15, 3, v0
    v_lshl_add_u32 v14, v15, 3, v14
    v_add_u32 v14, s79, v14
    v_add_u32 v15, s7, v14
    ds_read_b64_tr_b16 v[76:77], v14 offset:0
    ds_read_b64_tr_b16 v[78:79], v15 offset:0
    ds_read_b64_tr_b16 v[80:81], v14 offset:32
    ds_read_b64_tr_b16 v[82:83], v15 offset:32
    ds_read_b64_tr_b16 v[84:85], v14 offset:64
    ds_read_b64_tr_b16 v[86:87], v15 offset:64
    ds_read_b64_tr_b16 v[88:89], v14 offset:96
    ds_read_b64_tr_b16 v[90:91], v15 offset:96
    ds_read_b64_tr_b16 v[92:93], v14 offset:4096
    ds_read_b64_tr_b16 v[94:95], v15 offset:4096
    ds_read_b64_tr_b16 v[96:97], v14 offset:4128
    ds_read_b64_tr_b16 v[98:99], v15 offset:4128
    ds_read_b64_tr_b16 v[176:177], v14 offset:4160
    ds_read_b64_tr_b16 v[178:179], v15 offset:4160
    ds_read_b64_tr_b16 v[180:181], v14 offset:4192
    ds_read_b64_tr_b16 v[182:183], v15 offset:4192
    ds_read_b64_tr_b16 v[196:197], v14 offset:8192
    ds_read_b64_tr_b16 v[198:199], v15 offset:8192
    ds_read_b64_tr_b16 v[200:201], v14 offset:8224
    ds_read_b64_tr_b16 v[202:203], v15 offset:8224
    ds_read_b64_tr_b16 v[204:205], v14 offset:8256
    ds_read_b64_tr_b16 v[206:207], v15 offset:8256
    ds_read_b64_tr_b16 v[208:209], v14 offset:8288
    ds_read_b64_tr_b16 v[210:211], v15 offset:8288
    ds_read_b64_tr_b16 v[212:213], v14 offset:12288
    ds_read_b64_tr_b16 v[214:215], v15 offset:12288
    ds_read_b64_tr_b16 v[216:217], v14 offset:12320
    ds_read_b64_tr_b16 v[218:219], v15 offset:12320
    ds_read_b64_tr_b16 v[220:221], v14 offset:12352
    ds_read_b64_tr_b16 v[222:223], v15 offset:12352
    ds_read_b64_tr_b16 v[228:229], v14 offset:12384
    ds_read_b64_tr_b16 v[230:231], v15 offset:12384
    s_mul_i32 s68, s40, 1990656
    s_add_u32 s68, s68, 3145728
    s_cmp_eq_u32 s93, 2
    s_cbranch_scc1 L_swz_down_19
    s_mul_i32 s6, s84, 349526
    s_lshr_b32 s6, s6, 20
    s_mul_i32 s7, s6, 3
    s_sub_u32 s7, s84, s7
    s_mul_i32 s6, s6, 6
    s_add_u32 s7, s7, s6
    s_mul_i32 s6, s88, 36
    s_add_u32 s7, s7, s6
    s_mul_i32 s6, s93, 3
    s_add_u32 s7, s7, s6
    s_lshl_b32 s7, s7, 10
    s_add_u32 s7, s7, s68
    s_add_u32 s80, s7, 0
    s_add_u32 s81, s7, 497664
    s_add_u32 s82, s7, 995328
    s_add_u32 s83, s7, 1492992
    s_mul_i32 s6, s85, 349526
    s_lshr_b32 s6, s6, 20
    s_mul_i32 s7, s6, 3
    s_sub_u32 s7, s85, s7
    s_mul_i32 s6, s6, 6
    s_add_u32 s7, s7, s6
    s_mul_i32 s6, s89, 36
    s_add_u32 s7, s7, s6
    s_mul_i32 s6, s93, 3
    s_add_u32 s7, s7, s6
    s_lshl_b32 s7, s7, 10
    s_add_u32 s7, s7, s68
    s_add_u32 s64, s7, 0
    s_add_u32 s65, s7, 497664
    s_add_u32 s18, s7, 995328
    s_add_u32 s19, s7, 1492992
    s_mul_i32 s6, s86, 349526
    s_lshr_b32 s6, s6, 20
    s_mul_i32 s7, s6, 3
    s_sub_u32 s7, s86, s7
    s_mul_i32 s6, s6, 6
    s_add_u32 s7, s7, s6
    s_mul_i32 s6, s90, 36
    s_add_u32 s7, s7, s6
    s_mul_i32 s6, s93, 3
    s_add_u32 s7, s7, s6
    s_lshl_b32 s7, s7, 10
    s_add_u32 s7, s7, s68
    s_add_u32 s20, s7, 0
    s_add_u32 s21, s7, 497664
    s_add_u32 s22, s7, 995328
    s_add_u32 s25, s7, 1492992
    s_mul_i32 s6, s87, 349526
    s_lshr_b32 s6, s6, 20
    s_mul_i32 s7, s6, 3
    s_sub_u32 s7, s87, s7
    s_mul_i32 s6, s6, 6
    s_add_u32 s7, s7, s6
    s_mul_i32 s6, s91, 36
    s_add_u32 s7, s7, s6
    s_mul_i32 s6, s93, 3
    s_add_u32 s7, s7, s6
    s_lshl_b32 s7, s7, 10
    s_add_u32 s7, s7, s68
    s_add_u32 s26, s7, 0
    s_add_u32 s27, s7, 497664
    s_add_u32 s28, s7, 995328
    s_add_u32 s29, s7, 1492992
    s_branch L_swz_dest_20
L_swz_down_19:
    s_mul_i32 s7, s88, 18
    s_add_u32 s7, s7, s84
    s_add_u32 s7, s7, 324
    s_lshl_b32 s7, s7, 10
    s_add_u32 s7, s7, s68
    s_add_u32 s80, s7, 0
    s_add_u32 s81, s7, 497664
    s_add_u32 s82, s7, 995328
    s_add_u32 s83, s7, 1492992
    s_mul_i32 s7, s89, 18
    s_add_u32 s7, s7, s85
    s_add_u32 s7, s7, 324
    s_lshl_b32 s7, s7, 10
    s_add_u32 s7, s7, s68
    s_add_u32 s64, s7, 0
    s_add_u32 s65, s7, 497664
    s_add_u32 s18, s7, 995328
    s_add_u32 s19, s7, 1492992
    s_mul_i32 s7, s90, 18
    s_add_u32 s7, s7, s86
    s_add_u32 s7, s7, 324
    s_lshl_b32 s7, s7, 10
    s_add_u32 s7, s7, s68
    s_add_u32 s20, s7, 0
    s_add_u32 s21, s7, 497664
    s_add_u32 s22, s7, 995328
    s_add_u32 s25, s7, 1492992
    s_mul_i32 s7, s91, 18
    s_add_u32 s7, s7, s87
    s_add_u32 s7, s7, 324
    s_lshl_b32 s7, s7, 10
    s_add_u32 s7, s7, s68
    s_add_u32 s26, s7, 0
    s_add_u32 s27, s7, 497664
    s_add_u32 s28, s7, 995328
    s_add_u32 s29, s7, 1492992
L_swz_dest_20:
    s_mov_b32 s72, s8
    s_mov_b32 s73, s9
    s_mov_b32 s74, 268435456
    s_waitcnt lgkmcnt(0)
    buffer_store_dwordx4 v[76:79], v253, s[72:75], s80 offen sc1
    buffer_store_dwordx4 v[80:83], v253, s[72:75], s81 offen sc1
    buffer_store_dwordx4 v[84:87], v253, s[72:75], s82 offen sc1
    buffer_store_dwordx4 v[88:91], v253, s[72:75], s83 offen sc1
    buffer_store_dwordx4 v[92:95], v253, s[72:75], s64 offen sc1
    buffer_store_dwordx4 v[96:99], v253, s[72:75], s65 offen sc1
    buffer_store_dwordx4 v[176:179], v253, s[72:75], s18 offen sc1
    buffer_store_dwordx4 v[180:183], v253, s[72:75], s19 offen sc1
    buffer_store_dwordx4 v[196:199], v253, s[72:75], s20 offen sc1
    buffer_store_dwordx4 v[200:203], v253, s[72:75], s21 offen sc1
    buffer_store_dwordx4 v[204:207], v253, s[72:75], s22 offen sc1
    buffer_store_dwordx4 v[208:211], v253, s[72:75], s25 offen sc1
    buffer_store_dwordx4 v[212:215], v253, s[72:75], s26 offen sc1
    buffer_store_dwordx4 v[216:219], v253, s[72:75], s27 offen sc1
    buffer_store_dwordx4 v[220:223], v253, s[72:75], s28 offen sc1
    buffer_store_dwordx4 v[228:231], v253, s[72:75], s29 offen sc1
    s_lshr_b32 s7, s2, 3
    s_lshl_b32 s7, s7, 2
    s_add_u32 s7, s7, s3
    s_lshl_b32 s7, s7, 9
    v_lshrrev_b32 v1, 1, v253
    v_add_u32 v1, s7, v1
    buffer_load_dwordx2 v[14:15], v1, s[96:99], 0 offen
L_swz_18:
    s_and_b32 s7, s3, 1
    s_mul_i32 s7, s7, 18432
    s_add_u32 s24, s30, s7
    s_lshr_b32 s7, s3, 1
    s_lshl_b32 s7, s7, 9
    s_add_u32 s24, s24, s7
    s_add_u32 s24, s24, 41156608
    s_mov_b32 s16, 0xffff0000
    v_lshlrev_b32 v124, 16, v240
    v_and_b32 v125, s16, v240
    v_lshlrev_b32 v126, 16, v241
    v_and_b32 v127, s16, v241
    v_lshlrev_b32 v128, 16, v242
    v_and_b32 v129, s16, v242
    v_lshlrev_b32 v130, 16, v243
    v_and_b32 v131, s16, v243
    v_lshlrev_b32 v132, 16, v244
    v_and_b32 v133, s16, v244
    v_lshlrev_b32 v134, 16, v245
    v_and_b32 v135, s16, v245
    v_lshlrev_b32 v136, 16, v246
    v_and_b32 v137, s16, v246
    v_lshlrev_b32 v138, 16, v247
    v_and_b32 v139, s16, v247
    v_lshlrev_b32 v140, 16, v248
    v_and_b32 v141, s16, v248
    v_lshlrev_b32 v142, 16, v249
    v_and_b32 v143, s16, v249
    v_lshlrev_b32 v144, 16, v250
    v_and_b32 v145, s16, v250
    v_lshlrev_b32 v146, 16, v251
    v_and_b32 v147, s16, v251
    s_cmp_eq_u32 s3, 1
    s_cselect_b32 s7, 16, 0
    v_lshlrev_b32 v12, 2, v0
    v_cmp_gt_u32 vcc, s7, v0
    v_add_u32 v10, 40960, v12
    v_add_u32 v11, 41472, v12
    v_cndmask_b32 v10, v11, v10, vcc
    v_and_b32 v11, 0x7c, v12
    v_cmp_gt_u32 vcc, 32, v0
    v_mov_b32 v13, 1073741824
    s_and_b32 s7, s40, 3
    s_lshl_b32 s45, s45, 2
    v_cndmask_b32 v8, v13, v12, vcc
    s_add_u32 s6, s7, s3
    s_cmp_eq_u32 s6, 0
    s_cselect_b32 s6, 0, 1073741824
    v_add_u32 v6, s6, v8
    s_add_u32 s45, s45, s7
    s_lshl_b32 s45, s45, 2
    s_add_u32 s45, s45, s3
    s_lshl_b32 s45, s45, 7
    s_add_u32 s45, s45, s43
    s_add_u32 s45, s45, 48300032
    s_cmp_eq_u32 s3, 0
    s_cselect_b32 s35, 1.0, 0
    s_lshl_b32 s7, s40, 2
    s_add_u32 s7, s7, s3
    s_mul_i32 s23, s7, 497664
    s_add_u32 s23, s23, 3145728
    s_add_u32 s50, s23, 497664
    s_mul_i32 s50, s50, s42
    v_mov_b32 v184, v253
    v_add_u32 v185, 4096, v253
    v_add_u32 v186, 8192, v253
    v_add_u32 v187, 12288, v253
    v_add_u32 v188, 16384, v253
    v_add_u32 v189, 20480, v253
    v_add_u32 v190, 24576, v253
    v_add_u32 v191, 28672, v253
    v_add_u32 v192, 32768, v253
    s_cmp_lg_u32 s3, 3
    s_cbranch_scc1 L_pollout_23
    s_lshl_b32 s7, s40, 7
    s_add_u32 s7, s7, s44
    s_add_u32 s52, s4, s7
    s_addc_u32 s53, s5, 0
    s_mov_b32 s6, 0
L_poll_21:
    s_load_dwordx8 s[56:63], s[52:53], 0 glc
    s_add_u32 s6, s6, 1
    s_waitcnt lgkmcnt(0)
    s_xor_b64 s[56:57], s[56:57], s[76:77]
    s_xor_b64 s[58:59], s[58:59], s[76:77]
    s_xor_b64 s[60:61], s[60:61], s[76:77]
    s_xor_b64 s[62:63], s[62:63], s[76:77]
    s_or_b64 s[56:57], s[56:57], s[58:59]
    s_or_b64 s[60:61], s[60:61], s[62:63]
    s_or_b64 s[56:57], s[56:57], s[60:61]
    s_cbranch_scc0 L_polled_22
    s_cmp_lt_u32 s6, 1048576
    s_cbranch_scc1 L_poll_21
    s_branch L_main_end
L_polled_22:
L_pollout_23:
    s_barrier
    s_lshl_b32 m0, s3, 10
    s_nop 0
    buffer_load_dwordx4 v2, s[8:11], s24 offen sc1 lds
    s_add_u32 m0, m0, 4096
    s_add_u32 s24, s24, 1024
    buffer_load_dwordx4 v2, s[8:11], s24 offen sc1 lds
    s_add_u32 m0, m0, 4096
    s_add_u32 s24, s24, 1024
    buffer_load_dwordx4 v2, s[8:11], s24 offen sc1 lds
    s_add_u32 m0, m0, 4096
    s_add_u32 s24, s24, 1024
    buffer_load_dwordx4 v2, s[8:11], s24 offen sc1 lds
    s_add_u32 m0, m0, 4096
    s_add_u32 s24, s24, 1024
    buffer_load_dwordx4 v2, s[8:11], s24 offen sc1 lds
    s_add_u32 m0, m0, 4096
    s_add_u32 s24, s24, 1024
    buffer_load_dwordx4 v2, s[8:11], s24 offen sc1 lds
    s_add_u32 m0, m0, 4096
    s_add_u32 s24, s24, 1024
    buffer_load_dwordx4 v2, s[8:11], s24 offen sc1 lds
    s_add_u32 m0, m0, 4096
    s_add_u32 s24, s24, 1024
    buffer_load_dwordx4 v2, s[8:11], s24 offen sc1 lds
    s_add_u32 m0, m0, 4096
    s_add_u32 s24, s24, 1024
    buffer_load_dwordx4 v2, s[8:11], s24 offen sc1 lds
    s_waitcnt vmcnt(4)
    s_barrier
    ds_read_b128 v[160:163], v253 offset:0
    ds_read_b128 v[164:167], v253 offset:1024
    s_waitcnt lgkmcnt(0)
    v_mfma_f32_16x16x32_bf16 v[100:103], a[160:163], v[160:163], 0
    ds_read_b128 v[168:171], v253 offset:2048
    v_mfma_f32_16x16x32_bf16 v[104:107], a[160:163], v[164:167], 0
    ds_read_b128 v[172:175], v253 offset:3072
    v_mfma_f32_16x16x32_bf16 v[108:111], a[164:167], v[160:163], 0
    v_mfma_f32_16x16x32_bf16 v[112:115], a[164:167], v[164:167], 0
    buffer_load_dwordx4 v[16:19], v184, s[48:51], s23 offen offset:0 sc1
    v_mfma_f32_16x16x32_bf16 v[116:119], a[168:171], v[160:163], 0
    v_mfma_f32_16x16x32_bf16 v[120:123], a[168:171], v[164:167], 0
    s_waitcnt lgkmcnt(0)
    v_mfma_f32_16x16x32_bf16 v[100:103], a[172:175], v[168:171], v[100:103]
    ds_read_b128 v[160:163], v253 offset:4096
    v_mfma_f32_16x16x32_bf16 v[104:107], a[172:175], v[172:175], v[104:107]
    ds_read_b128 v[164:167], v253 offset:5120
    v_mfma_f32_16x16x32_bf16 v[108:111], a[176:179], v[168:171], v[108:111]
    v_mfma_f32_16x16x32_bf16 v[112:115], a[176:179], v[172:175], v[112:115]
    buffer_load_dwordx4 v[20:23], v184, s[48:51], s23 offen offset:1024 sc1
    v_mfma_f32_16x16x32_bf16 v[116:119], a[180:183], v[168:171], v[116:119]
    v_mfma_f32_16x16x32_bf16 v[120:123], a[180:183], v[172:175], v[120:123]
    s_waitcnt lgkmcnt(0)
    v_mfma_f32_16x16x32_bf16 v[100:103], a[184:187], v[160:163], v[100:103]
    ds_read_b128 v[168:171], v253 offset:6144
    v_mfma_f32_16x16x32_bf16 v[104:107], a[184:187], v[164:167], v[104:107]
    ds_read_b128 v[172:175], v253 offset:7168
    v_mfma_f32_16x16x32_bf16 v[108:111], a[188:191], v[160:163], v[108:111]
    v_mfma_f32_16x16x32_bf16 v[112:115], a[188:191], v[164:167], v[112:115]
    buffer_load_dwordx4 v[24:27], v184, s[48:51], s23 offen offset:2048 sc1
    v_mfma_f32_16x16x32_bf16 v[116:119], a[192:195], v[160:163], v[116:119]
    v_mfma_f32_16x16x32_bf16 v[120:123], a[192:195], v[164:167], v[120:123]
    s_waitcnt lgkmcnt(0)
    v_mfma_f32_16x16x32_bf16 v[100:103], a[196:199], v[168:171], v[100:103]
    ds_read_b128 v[160:163], v253 offset:8192
    v_mfma_f32_16x16x32_bf16 v[104:107], a[196:199], v[172:175], v[104:107]
    ds_read_b128 v[164:167], v253 offset:9216
    v_mfma_f32_16x16x32_bf16 v[108:111], a[200:203], v[168:171], v[108:111]
    v_mfma_f32_16x16x32_bf16 v[112:115], a[200:203], v[172:175], v[112:115]
    buffer_load_dwordx4 v[28:31], v184, s[48:51], s23 offen offset:3072 sc1
    v_mfma_f32_16x16x32_bf16 v[116:119], a[204:207], v[168:171], v[116:119]
    v_mfma_f32_16x16x32_bf16 v[120:123], a[204:207], v[172:175], v[120:123]
    s_waitcnt lgkmcnt(0)
    v_mfma_f32_16x16x32_bf16 v[100:103], a[208:211], v[160:163], v[100:103]
    ds_read_b128 v[168:171], v253 offset:10240
    v_mfma_f32_16x16x32_bf16 v[104:107], a[208:211], v[164:167], v[104:107]
    ds_read_b128 v[172:175], v253 offset:11264
    v_mfma_f32_16x16x32_bf16 v[108:111], a[212:215], v[160:163], v[108:111]
    v_mfma_f32_16x16x32_bf16 v[112:115], a[212:215], v[164:167], v[112:115]
    buffer_load_dwordx4 v[32:35], v185, s[48:51], s23 offen offset:0 sc1
    v_mfma_f32_16x16x32_bf16 v[116:119], a[216:219], v[160:163], v[116:119]
    v_mfma_f32_16x16x32_bf16 v[120:123], a[216:219], v[164:167], v[120:123]
    s_waitcnt lgkmcnt(0)
    v_mfma_f32_16x16x32_bf16 v[100:103], a[220:223], v[168:171], v[100:103]
    ds_read_b128 v[160:163], v253 offset:12288
    v_mfma_f32_16x16x32_bf16 v[104:107], a[220:223], v[172:175], v[104:107]
    ds_read_b128 v[164:167], v253 offset:13312
    v_mfma_f32_16x16x32_bf16 v[108:111], a[224:227], v[168:171], v[108:111]
    v_mfma_f32_16x16x32_bf16 v[112:115], a[224:227], v[172:175], v[112:115]
    buffer_load_dwordx4 v[36:39], v185, s[48:51], s23 offen offset:1024 sc1
    v_mfma_f32_16x16x32_bf16 v[116:119], a[228:231], v[168:171], v[116:119]
    v_mfma_f32_16x16x32_bf16 v[120:123], a[228:231], v[172:175], v[120:123]
    s_waitcnt lgkmcnt(0)
    v_mfma_f32_16x16x32_bf16 v[100:103], a[232:235], v[160:163], v[100:103]
    ds_read_b128 v[168:171], v253 offset:14336
    v_mfma_f32_16x16x32_bf16 v[104:107], a[232:235], v[164:167], v[104:107]
    ds_read_b128 v[172:175], v253 offset:15360
    v_mfma_f32_16x16x32_bf16 v[108:111], a[236:239], v[160:163], v[108:111]
    v_mfma_f32_16x16x32_bf16 v[112:115], a[236:239], v[164:167], v[112:115]
    buffer_load_dwordx4 v[40:43], v185, s[48:51], s23 offen offset:2048 sc1
    v_mfma_f32_16x16x32_bf16 v[116:119], a[240:243], v[160:163], v[116:119]
    v_mfma_f32_16x16x32_bf16 v[120:123], a[240:243], v[164:167], v[120:123]
    s_waitcnt lgkmcnt(0)
    v_mfma_f32_16x16x32_bf16 v[100:103], a[244:247], v[168:171], v[100:103]
    ds_read_b128 v[160:163], v253 offset:16384
    v_mfma_f32_16x16x32_bf16 v[104:107], a[244:247], v[172:175], v[104:107]
    ds_read_b128 v[164:167], v253 offset:17408
    v_mfma_f32_16x16x32_bf16 v[108:111], a[248:251], v[168:171], v[108:111]
    v_mfma_f32_16x16x32_bf16 v[112:115], a[248:251], v[172:175], v[112:115]
    buffer_load_dwordx4 v[44:47], v185, s[48:51], s23 offen offset:3072 sc1
    v_mfma_f32_16x16x32_bf16 v[116:119], a[252:255], v[168:171], v[116:119]
    v_mfma_f32_16x16x32_bf16 v[120:123], a[252:255], v[172:175], v[120:123]
    s_waitcnt lgkmcnt(0)
    v_mfma_f32_16x16x32_bf16 v[100:103], a[128:131], v[160:163], v[100:103]
    ds_read_b128 v[168:171], v253 offset:18432
    v_mfma_f32_16x16x32_bf16 v[104:107], a[128:131], v[164:167], v[104:107]
    ds_read_b128 v[172:175], v253 offset:19456
    v_mfma_f32_16x16x32_bf16 v[108:111], a[132:135], v[160:163], v[108:111]
    v_mfma_f32_16x16x32_bf16 v[112:115], a[132:135], v[164:167], v[112:115]
    buffer_load_dwordx4 v[48:51], v186, s[48:51], s23 offen offset:0 sc1
    v_mfma_f32_16x16x32_bf16 v[116:119], a[136:139], v[160:163], v[116:119]
    v_mfma_f32_16x16x32_bf16 v[120:123], a[136:139], v[164:167], v[120:123]
    s_waitcnt vmcnt(9) lgkmcnt(0)
    s_barrier
    s_xor_b32 s7, s3, 0
    s_or_b32 s7, s7, s42
    s_cbranch_scc1 L_swz_24
    v_lshlrev_b32 v15, 10, v0
    s_lshl_b32 s6, s40, 7
    s_lshl_b32 s7, s41, 2
    s_add_u32 s6, s6, s7
    s_add_u32 s6, s6, 19464192
    s_mov_b64 exec, 0xffffffff
    v_lshlrev_b32 v15, 10, v0
    v_mov_b32 v1, s76
    buffer_store_dword v1, v15, s[8:11], s6 offen sc1
    s_mov_b64 exec, -1
L_swz_24:
    v_mfma_f32_16x16x32_bf16 v[100:103], a[140:143], v[168:171], v[100:103]
    ds_read_b128 v[160:163], v253 offset:20480
    v_mfma_f32_16x16x32_bf16 v[104:107], a[140:143], v[172:175], v[104:107]
    ds_read_b128 v[164:167], v253 offset:21504
    v_mfma_f32_16x16x32_bf16 v[108:111], a[144:147], v[168:171], v[108:111]
    v_mfma_f32_16x16x32_bf16 v[112:115], a[144:147], v[172:175], v[112:115]
    buffer_load_dwordx4 v[52:55], v186, s[48:51], s23 offen offset:1024 sc1
    v_mfma_f32_16x16x32_bf16 v[116:119], a[148:151], v[168:171], v[116:119]
    v_mfma_f32_16x16x32_bf16 v[120:123], a[148:151], v[172:175], v[120:123]
    s_waitcnt lgkmcnt(0)
    v_mfma_f32_16x16x32_bf16 v[100:103], a[152:155], v[160:163], v[100:103]
    ds_read_b128 v[168:171], v253 offset:22528
    v_mfma_f32_16x16x32_bf16 v[104:107], a[152:155], v[164:167], v[104:107]
    ds_read_b128 v[172:175], v253 offset:23552
    v_mfma_f32_16x16x32_bf16 v[108:111], a[156:159], v[160:163], v[108:111]
    v_mfma_f32_16x16x32_bf16 v[112:115], a[156:159], v[164:167], v[112:115]
    buffer_load_dwordx4 v[56:59], v186, s[48:51], s23 offen offset:2048 sc1
    v_mfma_f32_16x16x32_bf16 v[116:119], a[0:3], v[160:163], v[116:119]
    v_mfma_f32_16x16x32_bf16 v[120:123], a[0:3], v[164:167], v[120:123]
    s_waitcnt lgkmcnt(0)
    v_mfma_f32_16x16x32_bf16 v[100:103], a[4:7], v[168:171], v[100:103]
    ds_read_b128 v[160:163], v253 offset:24576
    v_mfma_f32_16x16x32_bf16 v[104:107], a[4:7], v[172:175], v[104:107]
    ds_read_b128 v[164:167], v253 offset:25600
    v_mfma_f32_16x16x32_bf16 v[108:111], a[8:11], v[168:171], v[108:111]
    v_mfma_f32_16x16x32_bf16 v[112:115], a[8:11], v[172:175], v[112:115]
    buffer_load_dwordx4 v[60:63], v186, s[48:51], s23 offen offset:3072 sc1
    v_mfma_f32_16x16x32_bf16 v[116:119], a[12:15], v[168:171], v[116:119]
    v_mfma_f32_16x16x32_bf16 v[120:123], a[12:15], v[172:175], v[120:123]
    s_waitcnt lgkmcnt(0)
    v_mfma_f32_16x16x32_bf16 v[100:103], a[16:19], v[160:163], v[100:103]
    ds_read_b128 v[168:171], v253 offset:26624
    v_mfma_f32_16x16x32_bf16 v[104:107], a[16:19], v[164:167], v[104:107]
    ds_read_b128 v[172:175], v253 offset:27648
    v_mfma_f32_16x16x32_bf16 v[108:111], a[20:23], v[160:163], v[108:111]
    v_mfma_f32_16x16x32_bf16 v[112:115], a[20:23], v[164:167], v[112:115]
    buffer_load_dwordx4 v[64:67], v187, s[48:51], s23 offen offset:0 sc1
    v_mfma_f32_16x16x32_bf16 v[116:119], a[24:27], v[160:163], v[116:119]
    v_mfma_f32_16x16x32_bf16 v[120:123], a[24:27], v[164:167], v[120:123]
    s_waitcnt lgkmcnt(0)
    v_mfma_f32_16x16x32_bf16 v[100:103], a[28:31], v[168:171], v[100:103]
    ds_read_b128 v[160:163], v253 offset:28672
    v_mfma_f32_16x16x32_bf16 v[104:107], a[28:31], v[172:175], v[104:107]
    ds_read_b128 v[164:167], v253 offset:29696
    v_mfma_f32_16x16x32_bf16 v[108:111], a[32:35], v[168:171], v[108:111]
    v_mfma_f32_16x16x32_bf16 v[112:115], a[32:35], v[172:175], v[112:115]
    buffer_load_dwordx4 v[68:71], v187, s[48:51], s23 offen offset:1024 sc1
    v_mfma_f32_16x16x32_bf16 v[116:119], a[36:39], v[168:171], v[116:119]
    v_mfma_f32_16x16x32_bf16 v[120:123], a[36:39], v[172:175], v[120:123]
    s_waitcnt lgkmcnt(0)
    v_mfma_f32_16x16x32_bf16 v[100:103], a[40:43], v[160:163], v[100:103]
    ds_read_b128 v[168:171], v253 offset:30720
    v_mfma_f32_16x16x32_bf16 v[104:107], a[40:43], v[164:167], v[104:107]
    ds_read_b128 v[172:175], v253 offset:31744
    v_mfma_f32_16x16x32_bf16 v[108:111], a[44:47], v[160:163], v[108:111]
    v_mfma_f32_16x16x32_bf16 v[112:115], a[44:47], v[164:167], v[112:115]
    buffer_load_dwordx4 v[72:75], v187, s[48:51], s23 offen offset:2048 sc1
    v_mfma_f32_16x16x32_bf16 v[116:119], a[48:51], v[160:163], v[116:119]
    v_mfma_f32_16x16x32_bf16 v[120:123], a[48:51], v[164:167], v[120:123]
    s_waitcnt lgkmcnt(0)
    v_mfma_f32_16x16x32_bf16 v[100:103], a[52:55], v[168:171], v[100:103]
    ds_read_b128 v[160:163], v253 offset:32768
    v_mfma_f32_16x16x32_bf16 v[104:107], a[52:55], v[172:175], v[104:107]
    ds_read_b128 v[164:167], v253 offset:33792
    v_mfma_f32_16x16x32_bf16 v[108:111], a[56:59], v[168:171], v[108:111]
    v_mfma_f32_16x16x32_bf16 v[112:115], a[56:59], v[172:175], v[112:115]
    v_mfma_f32_16x16x32_bf16 v[116:119], a[60:63], v[168:171], v[116:119]
    v_mfma_f32_16x16x32_bf16 v[120:123], a[60:63], v[172:175], v[120:123]
    s_waitcnt lgkmcnt(0)
    v_mfma_f32_16x16x32_bf16 v[100:103], a[64:67], v[160:163], v[100:103]
    ds_read_b128 v[168:171], v253 offset:34816
    v_mfma_f32_16x16x32_bf16 v[104:107], a[64:67], v[164:167], v[104:107]
    ds_read_b128 v[172:175], v253 offset:35840
    v_mfma_f32_16x16x32_bf16 v[108:111], a[68:71], v[160:163], v[108:111]
    v_mfma_f32_16x16x32_bf16 v[112:115], a[68:71], v[164:167], v[112:115]
    v_mfma_f32_16x16x32_bf16 v[116:119], a[72:75], v[160:163], v[116:119]
    v_mfma_f32_16x16x32_bf16 v[120:123], a[72:75], v[164:167], v[120:123]
    s_waitcnt lgkmcnt(0)
    v_mfma_f32_16x16x32_bf16 v[100:103], a[76:79], v[168:171], v[100:103]
    v_mfma_f32_16x16x32_bf16 v[104:107], a[76:79], v[172:175], v[104:107]
    v_mfma_f32_16x16x32_bf16 v[108:111], a[80:83], v[168:171], v[108:111]
    v_mfma_f32_16x16x32_bf16 v[112:115], a[80:83], v[172:175], v[112:115]
    v_mfma_f32_16x16x32_bf16 v[116:119], a[84:87], v[168:171], v[116:119]
    v_mfma_f32_16x16x32_bf16 v[120:123], a[84:87], v[172:175], v[120:123]
    s_nop 3
    v_permlane16_swap_b32 v100, v104
    v_permlane16_swap_b32 v101, v105
    v_permlane16_swap_b32 v102, v106
    v_permlane16_swap_b32 v103, v107
    v_add_f32 v12, v116, v117
    v_add_f32 v13, v120, v121
    ds_write_b32 v10, v12
    ds_write_b32 v10, v13 offset:64
    v_permlane16_swap_b32 v108, v112
    v_permlane16_swap_b32 v109, v113
    v_permlane16_swap_b32 v110, v114
    v_permlane16_swap_b32 v111, v115
    v_permlane16_swap_b32 v116, v120
    v_permlane16_swap_b32 v117, v121
    v_permlane16_swap_b32 v118, v122
    v_permlane16_swap_b32 v119, v123
    s_waitcnt lgkmcnt(0)
    s_barrier
    ds_read_b32 v12, v11 offset:40960
    v_pk_add_f32 v[124:125], v[124:125], v[100:101]
    v_pk_add_f32 v[126:127], v[126:127], v[102:103]
    v_pk_add_f32 v[128:129], v[128:129], v[104:105]
    v_pk_add_f32 v[130:131], v[130:131], v[106:107]
    v_pk_add_f32 v[132:133], v[132:133], v[108:109]
    v_pk_add_f32 v[134:135], v[134:135], v[110:111]
    v_pk_add_f32 v[136:137], v[136:137], v[112:113]
    v_pk_add_f32 v[138:139], v[138:139], v[114:115]
    v_pk_add_f32 v[140:141], v[140:141], v[116:117]
    v_pk_add_f32 v[142:143], v[142:143], v[118:119]
    v_pk_add_f32 v[144:145], v[144:145], v[120:121]
    v_pk_add_f32 v[146:147], v[146:147], v[122:123]
    v_mov_b32 v14, 0
    v_mov_b32 v15, 0
    s_waitcnt lgkmcnt(0)
    v_add_f32 v12, v12, v252
    v_pk_add_f32 v[100:101], v[124:125], v[12:13] op_sel_hi:[1,0] neg_lo:[0,1] neg_hi:[0,1]
    v_pk_add_f32 v[102:103], v[126:127], v[12:13] op_sel_hi:[1,0] neg_lo:[0,1] neg_hi:[0,1]
    v_pk_add_f32 v[104:105], v[128:129], v[12:13] op_sel_hi:[1,0] neg_lo:[0,1] neg_hi:[0,1]
    v_pk_add_f32 v[106:107], v[130:131], v[12:13] op_sel_hi:[1,0] neg_lo:[0,1] neg_hi:[0,1]
    v_cvt_pk_bf16_f32 v148, v100, v101
    v_cvt_pk_bf16_f32 v149, v102, v103
    v_cvt_pk_bf16_f32 v150, v104, v105
    v_cvt_pk_bf16_f32 v151, v106, v107
    buffer_store_dwordx4 v[148:151], v9, s[8:11], s46 offen offset:0 sc1
    v_pk_add_f32 v[108:109], v[132:133], v[12:13] op_sel_hi:[1,0] neg_lo:[0,1] neg_hi:[0,1]
    v_pk_add_f32 v[110:111], v[134:135], v[12:13] op_sel_hi:[1,0] neg_lo:[0,1] neg_hi:[0,1]
    v_pk_add_f32 v[112:113], v[136:137], v[12:13] op_sel_hi:[1,0] neg_lo:[0,1] neg_hi:[0,1]
    v_pk_add_f32 v[114:115], v[138:139], v[12:13] op_sel_hi:[1,0] neg_lo:[0,1] neg_hi:[0,1]
    v_cvt_pk_bf16_f32 v152, v108, v109
    v_cvt_pk_bf16_f32 v153, v110, v111
    v_cvt_pk_bf16_f32 v154, v112, v113
    v_cvt_pk_bf16_f32 v155, v114, v115
    buffer_store_dwordx4 v[152:155], v9, s[8:11], s46 offen offset:1024 sc1
    v_pk_add_f32 v[116:117], v[140:141], v[12:13] op_sel_hi:[1,0] neg_lo:[0,1] neg_hi:[0,1]
    v_pk_add_f32 v[118:119], v[142:143], v[12:13] op_sel_hi:[1,0] neg_lo:[0,1] neg_hi:[0,1]
    v_pk_add_f32 v[120:121], v[144:145], v[12:13] op_sel_hi:[1,0] neg_lo:[0,1] neg_hi:[0,1]
    v_pk_add_f32 v[122:123], v[146:147], v[12:13] op_sel_hi:[1,0] neg_lo:[0,1] neg_hi:[0,1]
    v_cvt_pk_bf16_f32 v156, v116, v117
    v_cvt_pk_bf16_f32 v157, v118, v119
    v_cvt_pk_bf16_f32 v158, v120, v121
    v_cvt_pk_bf16_f32 v159, v122, v123
    buffer_store_dwordx4 v[156:159], v7, s[8:11], s46 offen offset:2048 sc1
    v_dot2c_f32_bf16 v14, v148, v148
    v_dot2c_f32_bf16 v14, v149, v149
    v_dot2c_f32_bf16 v14, v150, v150
    v_dot2c_f32_bf16 v14, v151, v151
    v_dot2c_f32_bf16 v14, v152, v152
    v_dot2c_f32_bf16 v14, v153, v153
    v_dot2c_f32_bf16 v14, v154, v154
    v_dot2c_f32_bf16 v14, v155, v155
    v_dot2c_f32_bf16 v15, v156, v156
    v_dot2c_f32_bf16 v15, v157, v157
    v_dot2c_f32_bf16 v15, v158, v158
    v_dot2c_f32_bf16 v15, v159, v159
    buffer_store_dword v12, v6, s[8:11], s36 offen sc1
    s_nop 1
    v_fma_f32 v14, v15, s35, v14
    v_mov_b32 v15, v14
    s_nop 1
    v_permlane32_swap_b32 v14, v15
    v_add_f32 v14, v14, v15
    buffer_store_dword v14, v8, s[8:11], s45 offen sc1
    v_lshlrev_b32 v15, 7, v0
    s_lshl_b32 s6, s40, 2
    s_add_u32 s6, s6, s44
    s_add_u32 s6, s6, 32768
    v_mov_b32 v1, s76
    s_mov_b64 vcc, 0xff
    s_waitcnt vmcnt(0)
    s_barrier
    s_cmp_lg_u32 s3, 0
    s_cbranch_scc1 L_pub_25
    s_mov_b64 exec, vcc
    buffer_store_dword v1, v15, s[8:11], s6 offen sc1
L_pub_25:
    s_mov_b64 exec, -1
    s_lshl_b32 s7, s41, 2
    s_add_u32 s7, s7, s3
    s_mul_i32 s22, s7, 18432
    s_add_u32 s22, s22, s43
    s_add_u32 s22, s22, 45875200
    s_mul_i32 s24, s3, 18432
    s_lshl_b32 s25, s41, 12
    s_add_u32 s25, s25, s43
    s_add_u32 s25, s25, 48300032
    v_lshrrev_b32 v3, 5, v0
    v_and_b32 v10, 31, v0
    v_lshlrev_b32 v10, 2, v10
    v_lshl_add_u32 v3, v3, 11, v10
    v_add_u32 v11, 36864, v184
    s_mov_b32 s16, 0xffff0000
    s_lshl_b32 s7, s3, 10
    v_add_u32 v172, s7, v253
    v_add_u32 v174, 5120, v172
    v_and_b32 v178, 7, v0
    v_mul_u32_u24 v178, 1152, v178
    v_lshrrev_b32 v179, 3, v0
    v_lshl_add_u32 v178, v179, 4, v178
    s_lshl_b32 s7, s3, 7
    v_add_u32 v175, s7, v178
    v_add_u32 v177, 640, v175
    s_cmp_eq_u32 s3, 0
    s_mov_b32 s17, 1073741824
    s_cmov_b32 s17, 4096
    v_add_u32 v173, s17, v172
    s_mov_b32 s17, 1073741824
    s_cmov_b32 s17, 512
    v_add_u32 v176, s17, v175
    s_lshl_b32 s21, s41, 3
    s_add_u32 s21, s21, s40
    s_mul_i32 s18, s21, 9216
    s_mul_i32 s20, s21, 73728
    s_add_u32 s20, s20, 19922944
    v_bfe_u32 v1, v0, 3, 2
    s_mov_b32 s7, 73728
    v_mul_lo_u32 v178, v1, s7
    v_lshrrev_b32 v1, 5, v0
    v_lshl_add_u32 v178, v1, 7, v178
    v_and_b32 v1, 7, v0
    v_lshl_add_u32 v178, v1, 4, v178
    v_add_u32 v179, 294912, v178
    v_lshrrev_b32 v1, 5, v0
    v_and_b32 v15, 7, v0
    v_lshlrev_b32 v15, 4, v15
    v_lshl_add_u32 v15, v1, 7, v15
    s_lshl_b32 s7, s3, 8
    s_add_u32 s7, s7, 3072
    v_add_u32 v15, s7, v15
    v_bfe_u32 v1, v0, 3, 2
    v_mov_b32 v182, 1073741824
    v_add_u32 v183, 14336, v253
    s_sub_u32 s7, s40, 0
    v_cmp_eq_u32 vcc, s7, v1
    s_nop 1
    v_cndmask_b32 v178, v178, v182, vcc
    v_cndmask_b32 v216, v183, v15, vcc
    v_cndmask_b32 v218, 0, 1, vcc
    v_lshlrev_b32 v218, 10, v218
    s_sub_u32 s7, s40, 4
    v_cmp_eq_u32 vcc, s7, v1
    s_nop 1
    v_cndmask_b32 v179, v179, v182, vcc
    v_cndmask_b32 v217, v183, v15, vcc
    v_cndmask_b32 v219, 0, 1, vcc
    v_lshlrev_b32 v219, 10, v219
    s_mul_i32 s26, s41, 589824
    s_mul_i32 s7, s40, 9216
    s_add_u32 s26, s26, s7
    s_lshl_b32 s7, s3, 8
    s_add_u32 s27, s26, s7
    s_add_u32 s27, s27, 19921920
    s_mov_b32 s74, 0
    s_mul_i32 s7, s42, 98304
    s_sub_u32 s29, s44, s7
    s_add_u32 s29, s29, 360448
    s_lshl_b32 s7, s40, 7
    s_add_u32 s7, s7, s29
    s_add_u32 s38, s4, s7
    s_addc_u32 s39, s5, 0
    s_lshl_b32 s7, s40, 2
    s_add_u32 s29, s29, s7
    s_add_u32 s50, s23, 497664
    s_cmp_lg_u32 s42, 0
    s_cbranch_scc1 L_ring_26
    s_cmp_lg_u32 s3, 0
    s_cbranch_scc1 L_ring_27
    s_lshl_b32 s7, s41, 3
    s_add_u32 s7, s7, s40
    s_lshl_b32 s7, s7, 7
    s_add_u32 s7, s7, 19464192
    s_add_u32 s68, s4, s7
    s_addc_u32 s69, s5, 0
    s_mov_b32 s6, 0
    s_mov_b32 s7, 0
L_cpoll_28:
    s_load_dwordx16 s[52:67], s[68:69], s7 glc
    s_add_u32 s6, s6, 1
    s_waitcnt lgkmcnt(0)
    s_xor_b64 s[52:53], s[52:53], s[76:77]
    s_xor_b64 s[54:55], s[54:55], s[76:77]
    s_xor_b64 s[56:57], s[56:57], s[76:77]
    s_xor_b64 s[58:59], s[58:59], s[76:77]
    s_xor_b64 s[60:61], s[60:61], s[76:77]
    s_xor_b64 s[62:63], s[62:63], s[76:77]
    s_xor_b64 s[64:65], s[64:65], s[76:77]
    s_xor_b64 s[66:67], s[66:67], s[76:77]
    s_or_b64 s[52:53], s[52:53], s[60:61]
    s_or_b64 s[54:55], s[54:55], s[62:63]
    s_or_b64 s[56:57], s[56:57], s[64:65]
    s_or_b64 s[58:59], s[58:59], s[66:67]
    s_or_b64 s[52:53], s[52:53], s[56:57]
    s_or_b64 s[54:55], s[54:55], s[58:59]
    s_or_b64 s[52:53], s[52:53], s[54:55]
    s_cbranch_scc1 L_cpoll_29
    s_add_u32 s7, s7, 64
    s_cmp_eq_u32 s7, 128
    s_cbranch_scc1 L_cpolled_30
L_cpoll_29:
    s_cmp_lt_u32 s6, 1048576
    s_cbranch_scc1 L_cpoll_28
    s_branch L_main_end
L_cpolled_30:
L_ring_27:
    s_barrier
    buffer_load_dwordx4 v[16:19], v184, s[48:51], s23 offen offset:0 sc1
    buffer_load_dwordx4 v[20:23], v184, s[48:51], s23 offen offset:1024 sc1
    buffer_load_dwordx4 v[24:27], v184, s[48:51], s23 offen offset:2048 sc1
    buffer_load_dwordx4 v[28:31], v184, s[48:51], s23 offen offset:3072 sc1
    buffer_load_dwordx4 v[32:35], v185, s[48:51], s23 offen offset:0 sc1
    buffer_load_dwordx4 v[36:39], v185, s[48:51], s23 offen offset:1024 sc1
    buffer_load_dwordx4 v[40:43], v185, s[48:51], s23 offen offset:2048 sc1
    buffer_load_dwordx4 v[44:47], v185, s[48:51], s23 offen offset:3072 sc1
    buffer_load_dwordx4 v[48:51], v186, s[48:51], s23 offen offset:0 sc1
    buffer_load_dwordx4 v[52:55], v186, s[48:51], s23 offen offset:1024 sc1
    buffer_load_dwordx4 v[56:59], v186, s[48:51], s23 offen offset:2048 sc1
    buffer_load_dwordx4 v[60:63], v186, s[48:51], s23 offen offset:3072 sc1
    buffer_load_dwordx4 v[64:67], v187, s[48:51], s23 offen offset:0 sc1
    buffer_load_dwordx4 v[68:71], v187, s[48:51], s23 offen offset:1024 sc1
    buffer_load_dwordx4 v[72:75], v187, s[48:51], s23 offen offset:2048 sc1
L_ring_26:
    s_cmp_lg_u32 s3, 3
    s_cbranch_scc1 L_pollout_33
    s_lshl_b32 s7, s40, 7
    s_add_u32 s7, s7, s44
    s_add_u32 s7, s7, 32768
    s_add_u32 s52, s4, s7
    s_addc_u32 s53, s5, 0
    s_mov_b32 s6, 0
L_poll_31:
    s_load_dwordx8 s[56:63], s[52:53], 0 glc
    s_add_u32 s6, s6, 1
    s_waitcnt lgkmcnt(0)
    s_xor_b64 s[56:57], s[56:57], s[76:77]
    s_xor_b64 s[58:59], s[58:59], s[76:77]
    s_xor_b64 s[60:61], s[60:61], s[76:77]
    s_xor_b64 s[62:63], s[62:63], s[76:77]
    s_or_b64 s[56:57], s[56:57], s[58:59]
    s_or_b64 s[60:61], s[60:61], s[62:63]
    s_or_b64 s[56:57], s[56:57], s[60:61]
    s_cbranch_scc0 L_polled_32
    s_cmp_lt_u32 s6, 1048576
    s_cbranch_scc1 L_poll_31
    s_branch L_main_end
L_polled_32:
L_pollout_33:
    s_barrier
    s_add_u32 m0, s24, 0
    s_nop 0
    buffer_load_dwordx4 v2, s[8:11], s22 offen offset:0 sc1 lds
    s_add_u32 m0, s24, 512
    s_nop 0
    buffer_load_dwordx4 v2, s[8:11], s22 offen offset:512 sc1 lds
    s_add_u32 m0, s24, 1024
    s_nop 0
    buffer_load_dwordx4 v2, s[8:11], s22 offen offset:1024 sc1 lds
    s_add_u32 m0, s24, 1536
    s_nop 0
    buffer_load_dwordx4 v2, s[8:11], s22 offen offset:1536 sc1 lds
    s_add_u32 m0, s24, 2048
    s_nop 0
    buffer_load_dwordx4 v2, s[8:11], s22 offen offset:2048 sc1 lds
    s_add_u32 m0, s24, 2560
    s_nop 0
    buffer_load_dwordx4 v2, s[8:11], s22 offen offset:2560 sc1 lds
    s_add_u32 m0, s24, 3072
    s_nop 0
    buffer_load_dwordx4 v2, s[8:11], s22 offen offset:3072 sc1 lds
    s_add_u32 m0, s24, 3584
    s_nop 0
    buffer_load_dwordx4 v2, s[8:11], s22 offen offset:3584 sc1 lds
    s_add_u32 m0, s24, 8192
    s_add_u32 s22, s22, 4096
    buffer_load_dwordx4 v2, s[8:11], s22 offen offset:0 sc1 lds
    s_add_u32 m0, s24, 8704
    s_nop 0
    buffer_load_dwordx4 v2, s[8:11], s22 offen offset:512 sc1 lds
    s_add_u32 m0, s24, 9216
    s_nop 0
    buffer_load_dwordx4 v2, s[8:11], s22 offen offset:1024 sc1 lds
    s_add_u32 m0, s24, 9728
    s_nop 0
    buffer_load_dwordx4 v2, s[8:11], s22 offen offset:1536 sc1 lds
    s_add_u32 s23, s23, 15360
    s_lshr_b32 s7, s3, 1
    s_lshl_b32 s7, s7, 10
    s_and_b32 s6, s3, 1
    s_lshl_b32 s6, s6, 3
    s_add_u32 s28, s7, s6
    s_add_u32 s28, s28, 73728
    s_waitcnt vmcnt(6)
    s_barrier
    ds_read_b128 a[0:3], v184 offset:0
    ds_read_b128 a[72:75], v184 offset:18432
    ds_read_b128 a[144:147], v11 offset:0
    ds_read_b128 a[216:219], v11 offset:18432
    ds_read_b128 a[4:7], v184 offset:1024
    ds_read_b128 a[76:79], v184 offset:19456
    ds_read_b128 a[148:151], v11 offset:1024
    ds_read_b128 a[220:223], v11 offset:19456
    ds_read_b128 a[8:11], v184 offset:2048
    ds_read_b128 a[80:83], v184 offset:20480
    ds_read_b128 a[152:155], v11 offset:2048
    ds_read_b128 a[224:227], v11 offset:20480
    s_waitcnt vmcnt(24) lgkmcnt(0)
    v_mfma_f32_16x16x32_bf16 v[88:91], v[16:19], a[0:3], 0
    ds_read_b128 a[12:15], v184 offset:3072
    v_mfma_f32_16x16x32_bf16 v[88:91], v[20:23], a[4:7], v[88:91]
    buffer_load_dwordx4 v[76:79], v184, s[48:51], s23 offen offset:0 sc1
    v_mfma_f32_16x16x32_bf16 v[88:91], v[24:27], a[8:11], v[88:91]
    ds_read_b128 a[84:87], v184 offset:21504
    v_mfma_f32_16x16x32_bf16 v[92:95], v[16:19], a[72:75], 0
    s_add_u32 m0, s24, 10240
    s_nop 0
    buffer_load_dwordx4 v2, s[8:11], s22 offen offset:2048 sc1 lds
    v_mfma_f32_16x16x32_bf16 v[92:95], v[20:23], a[76:79], v[92:95]
    ds_read_b128 a[156:159], v11 offset:3072
    ds_read_b128 a[228:231], v11 offset:21504
    v_mfma_f32_16x16x32_bf16 v[92:95], v[24:27], a[80:83], v[92:95]
    buffer_load_dwordx4 v[80:83], v184, s[48:51], s23 offen offset:1024 sc1
    v_mfma_f32_16x16x32_bf16 v[96:99], v[16:19], a[144:147], 0
    ds_read_b128 a[16:19], v184 offset:4096
    v_mfma_f32_16x16x32_bf16 v[96:99], v[20:23], a[148:151], v[96:99]
    s_add_u32 m0, s24, 10752
    s_nop 0
    buffer_load_dwordx4 v2, s[8:11], s22 offen offset:2560 sc1 lds
    v_mfma_f32_16x16x32_bf16 v[96:99], v[24:27], a[152:155], v[96:99]
    ds_read_b128 a[88:91], v184 offset:22528
    v_mfma_f32_16x16x32_bf16 v[100:103], v[16:19], a[216:219], 0
    buffer_load_dwordx4 v[84:87], v184, s[48:51], s23 offen offset:2048 sc1
    v_mfma_f32_16x16x32_bf16 v[100:103], v[20:23], a[220:223], v[100:103]
    ds_read_b128 a[160:163], v11 offset:4096
    ds_read_b128 a[232:235], v11 offset:22528
    v_mfma_f32_16x16x32_bf16 v[100:103], v[24:27], a[224:227], v[100:103]
    s_add_u32 m0, s24, 11264
    s_nop 0
    buffer_load_dwordx4 v2, s[8:11], s22 offen offset:3072 sc1 lds
    s_waitcnt vmcnt(27) lgkmcnt(8)
    v_mfma_f32_16x16x32_bf16 v[104:107], v[28:31], a[0:3], 0
    ds_read_b128 a[20:23], v184 offset:5120
    v_mfma_f32_16x16x32_bf16 v[104:107], v[32:35], a[4:7], v[104:107]
    buffer_load_dwordx4 v[16:19], v184, s[48:51], s23 offen offset:3072 sc1
    v_mfma_f32_16x16x32_bf16 v[104:107], v[36:39], a[8:11], v[104:107]
    ds_read_b128 a[92:95], v184 offset:23552
    v_mfma_f32_16x16x32_bf16 v[108:111], v[28:31], a[72:75], 0
    s_add_u32 m0, s24, 11776
    s_nop 0
    buffer_load_dwordx4 v2, s[8:11], s22 offen offset:3584 sc1 lds
    v_mfma_f32_16x16x32_bf16 v[108:111], v[32:35], a[76:79], v[108:111]
    ds_read_b128 a[164:167], v11 offset:5120
    ds_read_b128 a[236:239], v11 offset:23552
    v_mfma_f32_16x16x32_bf16 v[108:111], v[36:39], a[80:83], v[108:111]
    buffer_load_dwordx4 v[20:23], v185, s[48:51], s23 offen offset:0 sc1
    v_mfma_f32_16x16x32_bf16 v[112:115], v[28:31], a[144:147], 0
    v_mfma_f32_16x16x32_bf16 v[112:115], v[32:35], a[148:151], v[112:115]
    s_add_u32 m0, s24, 16384
    s_add_u32 s22, s22, 4096
    buffer_load_dwordx4 v2, s[8:11], s22 offen offset:0 sc1 lds
    v_mfma_f32_16x16x32_bf16 v[112:115], v[36:39], a[152:155], v[112:115]
    v_mfma_f32_16x16x32_bf16 v[116:119], v[28:31], a[216:219], 0
    buffer_load_dwordx4 v[24:27], v185, s[48:51], s23 offen offset:1024 sc1
    v_mfma_f32_16x16x32_bf16 v[116:119], v[32:35], a[220:223], v[116:119]
    v_mfma_f32_16x16x32_bf16 v[116:119], v[36:39], a[224:227], v[116:119]
    s_add_u32 m0, s24, 16896
    s_nop 0
    buffer_load_dwordx4 v2, s[8:11], s22 offen offset:512 sc1 lds
    s_waitcnt vmcnt(12) lgkmcnt(0)
    s_barrier
    v_mfma_f32_16x16x32_bf16 v[88:91], v[40:43], a[12:15], v[88:91]
    ds_read_b128 a[24:27], v184 offset:6144
    v_mfma_f32_16x16x32_bf16 v[88:91], v[44:47], a[16:19], v[88:91]
    buffer_load_dwordx4 v[28:31], v185, s[48:51], s23 offen offset:2048 sc1
    v_mfma_f32_16x16x32_bf16 v[88:91], v[48:51], a[20:23], v[88:91]
    ds_read_b128 a[96:99], v184 offset:24576
    v_mfma_f32_16x16x32_bf16 v[92:95], v[40:43], a[84:87], v[92:95]
    buffer_load_dword v136, v3, s[8:11], s25 offen offset:0 sc1
    v_mfma_f32_16x16x32_bf16 v[92:95], v[44:47], a[88:91], v[92:95]
    ds_read_b128 a[168:171], v11 offset:6144
    ds_read_b128 a[240:243], v11 offset:24576
    v_mfma_f32_16x16x32_bf16 v[92:95], v[48:51], a[92:95], v[92:95]
    buffer_load_dwordx4 v[32:35], v185, s[48:51], s23 offen offset:3072 sc1
    v_mfma_f32_16x16x32_bf16 v[96:99], v[40:43], a[156:159], v[96:99]
    buffer_load_dword v137, v3, s[8:11], s25 offen offset:128 sc1
    v_mfma_f32_16x16x32_bf16 v[96:99], v[44:47], a[160:163], v[96:99]
    buffer_load_dword v138, v3, s[8:11], s25 offen offset:256 sc1
    v_mfma_f32_16x16x32_bf16 v[96:99], v[48:51], a[164:167], v[96:99]
    ds_read_b128 a[28:31], v184 offset:7168
    ds_read_b128 a[100:103], v184 offset:25600
    v_mfma_f32_16x16x32_bf16 v[100:103], v[40:43], a[228:231], v[100:103]
    buffer_load_dwordx4 v[36:39], v186, s[48:51], s23 offen offset:0 sc1
    v_mfma_f32_16x16x32_bf16 v[100:103], v[44:47], a[232:235], v[100:103]
    buffer_load_dword v139, v3, s[8:11], s25 offen offset:384 sc1
    v_mfma_f32_16x16x32_bf16 v[100:103], v[48:51], a[236:239], v[100:103]
    buffer_load_dword v140, v3, s[8:11], s25 offen offset:512 sc1
    s_waitcnt vmcnt(35) lgkmcnt(6)
    v_mfma_f32_16x16x32_bf16 v[104:107], v[52:55], a[12:15], v[104:107]
    ds_read_b128 a[172:175], v11 offset:7168
    ds_read_b128 a[244:247], v11 offset:25600
    v_mfma_f32_16x16x32_bf16 v[104:107], v[56:59], a[16:19], v[104:107]
    buffer_load_dwordx4 v[40:43], v186, s[48:51], s23 offen offset:1024 sc1
    v_mfma_f32_16x16x32_bf16 v[104:107], v[60:63], a[20:23], v[104:107]
    ds_read_b128 a[32:35], v184 offset:8192
    ds_read_b128 a[104:107], v184 offset:26624
    v_mfma_f32_16x16x32_bf16 v[108:111], v[52:55], a[84:87], v[108:111]
    buffer_load_dword v141, v3, s[8:11], s25 offen offset:640 sc1
    v_mfma_f32_16x16x32_bf16 v[108:111], v[56:59], a[88:91], v[108:111]
    ds_read_b128 a[176:179], v11 offset:8192
    ds_read_b128 a[248:251], v11 offset:26624
    v_mfma_f32_16x16x32_bf16 v[108:111], v[60:63], a[92:95], v[108:111]
    buffer_load_dwordx4 v[44:47], v186, s[48:51], s23 offen offset:2048 sc1
    v_mfma_f32_16x16x32_bf16 v[112:115], v[52:55], a[156:159], v[112:115]
    buffer_load_dword v142, v3, s[8:11], s25 offen offset:768 sc1
    v_mfma_f32_16x16x32_bf16 v[112:115], v[56:59], a[160:163], v[112:115]
    buffer_load_dword v143, v3, s[8:11], s25 offen offset:896 sc1
    v_mfma_f32_16x16x32_bf16 v[112:115], v[60:63], a[164:167], v[112:115]
    v_mfma_f32_16x16x32_bf16 v[116:119], v[52:55], a[228:231], v[116:119]
    buffer_load_dwordx4 v[48:51], v186, s[48:51], s23 offen offset:3072 sc1
    v_mfma_f32_16x16x32_bf16 v[116:119], v[56:59], a[232:235], v[116:119]
    buffer_load_dword v144, v3, s[8:11], s25 offen offset:1024 sc1
    v_mfma_f32_16x16x32_bf16 v[116:119], v[60:63], a[236:239], v[116:119]
    buffer_load_dword v145, v3, s[8:11], s25 offen offset:1152 sc1
    s_waitcnt vmcnt(40) lgkmcnt(0)
    v_mfma_f32_16x16x32_bf16 v[88:91], v[64:67], a[24:27], v[88:91]
    ds_read_b128 a[36:39], v184 offset:9216
    v_mfma_f32_16x16x32_bf16 v[88:91], v[68:71], a[28:31], v[88:91]
    buffer_load_dwordx4 v[52:55], v187, s[48:51], s23 offen offset:0 sc1
    v_mfma_f32_16x16x32_bf16 v[88:91], v[72:75], a[32:35], v[88:91]
    ds_read_b128 a[108:111], v184 offset:27648
    v_mfma_f32_16x16x32_bf16 v[92:95], v[64:67], a[96:99], v[92:95]
    buffer_load_dword v146, v3, s[8:11], s25 offen offset:1280 sc1
    v_mfma_f32_16x16x32_bf16 v[92:95], v[68:71], a[100:103], v[92:95]
    ds_read_b128 a[180:183], v11 offset:9216
    ds_read_b128 a[252:255], v11 offset:27648
    v_mfma_f32_16x16x32_bf16 v[92:95], v[72:75], a[104:107], v[92:95]
    buffer_load_dwordx4 v[56:59], v187, s[48:51], s23 offen offset:1024 sc1
    v_mfma_f32_16x16x32_bf16 v[96:99], v[64:67], a[168:171], v[96:99]
    buffer_load_dword v147, v3, s[8:11], s25 offen offset:1408 sc1
    v_mfma_f32_16x16x32_bf16 v[96:99], v[68:71], a[172:175], v[96:99]
    buffer_load_dword v148, v3, s[8:11], s25 offen offset:1536 sc1
    v_mfma_f32_16x16x32_bf16 v[96:99], v[72:75], a[176:179], v[96:99]
    ds_read_b128 a[40:43], v184 offset:10240
    ds_read_b128 a[112:115], v184 offset:28672
    v_mfma_f32_16x16x32_bf16 v[100:103], v[64:67], a[240:243], v[100:103]
    buffer_load_dwordx4 v[60:63], v187, s[48:51], s23 offen offset:2048 sc1
    v_mfma_f32_16x16x32_bf16 v[100:103], v[68:71], a[244:247], v[100:103]
    buffer_load_dword v149, v3, s[8:11], s25 offen offset:1664 sc1
    v_mfma_f32_16x16x32_bf16 v[100:103], v[72:75], a[248:251], v[100:103]
    buffer_load_dword v150, v3, s[8:11], s25 offen offset:1792 sc1
    s_waitcnt vmcnt(31) lgkmcnt(6)
    v_mfma_f32_16x16x32_bf16 v[104:107], v[76:79], a[24:27], v[104:107]
    ds_read_b128 a[184:187], v11 offset:10240
    ds_read_b128 v[220:223], v11 offset:28672
    v_mfma_f32_16x16x32_bf16 v[104:107], v[80:83], a[28:31], v[104:107]
    buffer_load_dwordx4 v[64:67], v187, s[48:51], s23 offen offset:3072 sc1
    v_mfma_f32_16x16x32_bf16 v[104:107], v[84:87], a[32:35], v[104:107]
    ds_read_b128 a[44:47], v184 offset:11264
    ds_read_b128 a[116:119], v184 offset:29696
    v_mfma_f32_16x16x32_bf16 v[108:111], v[76:79], a[96:99], v[108:111]
    buffer_load_dword v151, v3, s[8:11], s25 offen offset:1920 sc1
    v_mfma_f32_16x16x32_bf16 v[108:111], v[80:83], a[100:103], v[108:111]
    ds_read_b128 a[188:191], v11 offset:11264
    ds_read_b128 v[224:227], v11 offset:29696
    v_mfma_f32_16x16x32_bf16 v[108:111], v[84:87], a[104:107], v[108:111]
    buffer_load_dwordx4 v[68:71], v188, s[48:51], s23 offen offset:0 sc1
    v_mfma_f32_16x16x32_bf16 v[112:115], v[76:79], a[168:171], v[112:115]
    v_mfma_f32_16x16x32_bf16 v[112:115], v[80:83], a[172:175], v[112:115]
    v_mfma_f32_16x16x32_bf16 v[112:115], v[84:87], a[176:179], v[112:115]
    v_mfma_f32_16x16x32_bf16 v[116:119], v[76:79], a[240:243], v[116:119]
    buffer_load_dwordx4 v[72:75], v188, s[48:51], s23 offen offset:1024 sc1
    v_mfma_f32_16x16x32_bf16 v[116:119], v[80:83], a[244:247], v[116:119]
    v_mfma_f32_16x16x32_bf16 v[116:119], v[84:87], a[248:251], v[116:119]
    s_waitcnt vmcnt(28) lgkmcnt(0)
    s_barrier
    v_mfma_f32_16x16x32_bf16 v[88:91], v[16:19], a[36:39], v[88:91]
    ds_read_b128 a[48:51], v184 offset:12288
    v_mfma_f32_16x16x32_bf16 v[88:91], v[20:23], a[40:43], v[88:91]
    buffer_load_dwordx4 v[76:79], v188, s[48:51], s23 offen offset:2048 sc1
    v_mfma_f32_16x16x32_bf16 v[88:91], v[24:27], a[44:47], v[88:91]
    ds_read_b128 a[120:123], v184 offset:30720
    v_mfma_f32_16x16x32_bf16 v[92:95], v[16:19], a[108:111], v[92:95]
    ds_read_b128 a[192:195], v11 offset:12288
    v_mfma_f32_16x16x32_bf16 v[92:95], v[20:23], a[112:115], v[92:95]
    ds_read_b128 v[228:231], v11 offset:30720
    v_mfma_f32_16x16x32_bf16 v[92:95], v[24:27], a[116:119], v[92:95]
    buffer_load_dwordx4 v[80:83], v188, s[48:51], s23 offen offset:3072 sc1
    v_mfma_f32_16x16x32_bf16 v[96:99], v[16:19], a[180:183], v[96:99]
    ds_read_b128 a[52:55], v184 offset:13312
    v_mfma_f32_16x16x32_bf16 v[96:99], v[20:23], a[184:187], v[96:99]
    ds_read_b128 a[124:127], v184 offset:31744
    v_mfma_f32_16x16x32_bf16 v[96:99], v[24:27], a[188:191], v[96:99]
    v_mfma_f32_16x16x32_bf16 v[100:103], v[16:19], a[252:255], v[100:103]
    buffer_load_dwordx4 v[84:87], v189, s[48:51], s23 offen offset:0 sc1
    v_mfma_f32_16x16x32_bf16 v[100:103], v[20:23], v[220:223], v[100:103]
    ds_read_b128 a[196:199], v11 offset:13312
    ds_read_b128 v[232:235], v11 offset:31744
    v_mfma_f32_16x16x32_bf16 v[100:103], v[24:27], v[224:227], v[100:103]
    s_waitcnt vmcnt(25) lgkmcnt(8)
    v_mfma_f32_16x16x32_bf16 v[104:107], v[28:31], a[36:39], v[104:107]
    ds_read_b128 a[56:59], v184 offset:14336
    v_mfma_f32_16x16x32_bf16 v[104:107], v[32:35], a[40:43], v[104:107]
    buffer_load_dwordx4 v[16:19], v189, s[48:51], s23 offen offset:1024 sc1
    v_mfma_f32_16x16x32_bf16 v[104:107], v[36:39], a[44:47], v[104:107]
    ds_read_b128 a[128:131], v184 offset:32768
    v_mfma_f32_16x16x32_bf16 v[108:111], v[28:31], a[108:111], v[108:111]
    ds_read_b128 a[200:203], v11 offset:14336
    v_mfma_f32_16x16x32_bf16 v[108:111], v[32:35], a[112:115], v[108:111]
    ds_read_b128 v[236:239], v11 offset:32768
    v_mfma_f32_16x16x32_bf16 v[108:111], v[36:39], a[116:119], v[108:111]
    buffer_load_dwordx4 v[20:23], v189, s[48:51], s23 offen offset:2048 sc1
    v_mfma_f32_16x16x32_bf16 v[112:115], v[28:31], a[180:183], v[112:115]
    v_mfma_f32_16x16x32_bf16 v[112:115], v[32:35], a[184:187], v[112:115]
    v_mfma_f32_16x16x32_bf16 v[112:115], v[36:39], a[188:191], v[112:115]
    v_mfma_f32_16x16x32_bf16 v[116:119], v[28:31], a[252:255], v[116:119]
    buffer_load_dwordx4 v[24:27], v189, s[48:51], s23 offen offset:3072 sc1
    v_mfma_f32_16x16x32_bf16 v[116:119], v[32:35], v[220:223], v[116:119]
    v_mfma_f32_16x16x32_bf16 v[116:119], v[36:39], v[224:227], v[116:119]
    s_waitcnt vmcnt(8) lgkmcnt(0)
    v_mfma_f32_16x16x32_bf16 v[88:91], v[40:43], a[48:51], v[88:91]
    ds_read_b128 a[60:63], v184 offset:15360
    v_add_f32 v136, v136, v144
    v_mfma_f32_16x16x32_bf16 v[88:91], v[44:47], a[52:55], v[88:91]
    buffer_load_dwordx4 v[28:31], v190, s[48:51], s23 offen offset:0 sc1
    v_mfma_f32_16x16x32_bf16 v[88:91], v[48:51], a[56:59], v[88:91]
    ds_read_b128 a[132:135], v184 offset:33792
    v_add_f32 v137, v137, v145
    v_mfma_f32_16x16x32_bf16 v[92:95], v[40:43], a[120:123], v[92:95]
    ds_read_b128 a[204:207], v11 offset:15360
    v_add_f32 v138, v138, v146
    v_mfma_f32_16x16x32_bf16 v[92:95], v[44:47], a[124:127], v[92:95]
    ds_read_b128 v[240:243], v11 offset:33792
    v_add_f32 v139, v139, v147
    v_mfma_f32_16x16x32_bf16 v[92:95], v[48:51], a[128:131], v[92:95]
    buffer_load_dwordx4 v[32:35], v190, s[48:51], s23 offen offset:1024 sc1
    v_mfma_f32_16x16x32_bf16 v[96:99], v[40:43], a[192:195], v[96:99]
    ds_read_b128 a[64:67], v184 offset:16384
    v_add_f32 v140, v140, v148
    v_mfma_f32_16x16x32_bf16 v[96:99], v[44:47], a[196:199], v[96:99]
    ds_read_b128 a[136:139], v184 offset:34816
    v_add_f32 v141, v141, v149
    v_mfma_f32_16x16x32_bf16 v[96:99], v[48:51], a[200:203], v[96:99]
    v_add_f32 v142, v142, v150
    v_add_f32 v143, v143, v151
    v_mfma_f32_16x16x32_bf16 v[100:103], v[40:43], v[228:231], v[100:103]
    buffer_load_dwordx4 v[36:39], v190, s[48:51], s23 offen offset:2048 sc1
    v_mfma_f32_16x16x32_bf16 v[100:103], v[44:47], v[232:235], v[100:103]
    ds_read_b128 a[208:211], v11 offset:16384
    ds_read_b128 v[244:247], v11 offset:34816
    v_mfma_f32_16x16x32_bf16 v[100:103], v[48:51], v[236:239], v[100:103]
    v_add_f32 v136, v136, v140
    v_add_f32 v137, v137, v141
    s_waitcnt vmcnt(15) lgkmcnt(8)
    v_mfma_f32_16x16x32_bf16 v[104:107], v[52:55], a[48:51], v[104:107]
    ds_read_b128 a[68:71], v184 offset:17408
    v_add_f32 v138, v138, v142
    v_mfma_f32_16x16x32_bf16 v[104:107], v[56:59], a[52:55], v[104:107]
    buffer_load_dwordx4 v[40:43], v190, s[48:51], s23 offen offset:3072 sc1
    v_mfma_f32_16x16x32_bf16 v[104:107], v[60:63], a[56:59], v[104:107]
    ds_read_b128 a[140:143], v184 offset:35840
    v_add_f32 v139, v139, v143
    v_mfma_f32_16x16x32_bf16 v[108:111], v[52:55], a[120:123], v[108:111]
    ds_read_b128 a[212:215], v11 offset:17408
    v_add_f32 v136, v136, v138
    v_mfma_f32_16x16x32_bf16 v[108:111], v[56:59], a[124:127], v[108:111]
    ds_read_b128 v[248:251], v11 offset:35840
    v_add_f32 v137, v137, v139
    v_mfma_f32_16x16x32_bf16 v[108:111], v[60:63], a[128:131], v[108:111]
    buffer_load_dwordx4 v[44:47], v191, s[48:51], s23 offen offset:0 sc1
    v_mfma_f32_16x16x32_bf16 v[112:115], v[52:55], a[192:195], v[112:115]
    v_add_f32 v136, v136, v137
    v_mov_b32 v137, 0x3727c5ac
    v_mfma_f32_16x16x32_bf16 v[112:115], v[56:59], a[196:199], v[112:115]
    v_fmac_f32 v137, 0x3ae38e39, v136
    v_mov_b32 v193, v137
    v_mfma_f32_16x16x32_bf16 v[112:115], v[60:63], a[200:203], v[112:115]
    s_nop 0
    v_permlane16_swap_b32 v193, v137
    v_mfma_f32_16x16x32_bf16 v[116:119], v[52:55], v[228:231], v[116:119]
    buffer_load_dwordx4 v[48:51], v191, s[48:51], s23 offen offset:1024 sc1
    v_mfma_f32_16x16x32_bf16 v[116:119], v[56:59], v[232:235], v[116:119]
    v_mov_b32 v195, v193
    v_mov_b32 v194, v137
    v_mfma_f32_16x16x32_bf16 v[116:119], v[60:63], v[236:239], v[116:119]
    v_mov_b32 v252, v137
    s_waitcnt vmcnt(12) lgkmcnt(0)
    v_mfma_f32_16x16x32_bf16 v[88:91], v[64:67], a[60:63], v[88:91]
    s_nop 0
    v_permlane32_swap_b32 v193, v195
    v_mfma_f32_16x16x32_bf16 v[88:91], v[68:71], a[64:67], v[88:91]
    buffer_load_dwordx4 v[52:55], v191, s[48:51], s23 offen offset:2048 sc1
    v_mfma_f32_16x16x32_bf16 v[120:123], v[72:75], a[68:71], v[88:91]
    v_permlane32_swap_b32 v194, v252
    v_mfma_f32_16x16x32_bf16 v[92:95], v[64:67], a[132:135], v[92:95]
    v_rsq_f32 v4, v193
    v_mfma_f32_16x16x32_bf16 v[92:95], v[68:71], a[136:139], v[92:95]
    v_rsq_f32 v5, v194
    v_mfma_f32_16x16x32_bf16 v[124:127], v[72:75], a[140:143], v[92:95]
    buffer_load_dwordx4 v[56:59], v191, s[48:51], s23 offen offset:3072 sc1
    v_mfma_f32_16x16x32_bf16 v[96:99], v[64:67], a[204:207], v[96:99]
    v_rsq_f32 v6, v195
    v_mfma_f32_16x16x32_bf16 v[96:99], v[68:71], a[208:211], v[96:99]
    v_rsq_f32 v7, v252
    v_mfma_f32_16x16x32_bf16 v[128:131], v[72:75], a[212:215], v[96:99]
    v_mul_f32 v8, v4, v4
    v_mul_f32 v9, v5, v5
    v_mfma_f32_16x16x32_bf16 v[100:103], v[64:67], v[240:243], v[100:103]
    buffer_load_dwordx4 v[60:63], v192, s[48:51], s23 offen offset:0 sc1
    v_mfma_f32_16x16x32_bf16 v[100:103], v[68:71], v[244:247], v[100:103]
    v_mul_f32 v13, v6, v6
    v_mul_f32 v14, v7, v7
    v_mfma_f32_16x16x32_bf16 v[132:135], v[72:75], v[248:251], v[100:103]
    v_mul_f32 v4, 0xc0135761, v4
    v_mul_f32 v5, 0xc0135761, v5
    s_waitcnt vmcnt(12) lgkmcnt(0)
    v_mfma_f32_16x16x32_bf16 v[104:107], v[76:79], a[60:63], v[104:107]
    v_mul_f32 v6, 0xc0135761, v6
    v_mul_f32 v7, 0xc0135761, v7
    v_mfma_f32_16x16x32_bf16 v[104:107], v[80:83], a[64:67], v[104:107]
    buffer_load_dwordx4 v[64:67], v192, s[48:51], s23 offen offset:1024 sc1
    v_mfma_f32_16x16x32_bf16 v[136:139], v[84:87], a[68:71], v[104:107]
    v_mul_f32 v8, 0x3d372713, v8
    v_mul_f32 v9, 0x3d372713, v9
    v_mfma_f32_16x16x32_bf16 v[108:111], v[76:79], a[132:135], v[108:111]
    v_mul_f32 v13, 0x3d372713, v13
    v_mul_f32 v14, 0x3d372713, v14
    v_mfma_f32_16x16x32_bf16 v[108:111], v[80:83], a[136:139], v[108:111]
    v_mul_f32 v8, v8, v4
    v_mul_f32 v9, v9, v5
    v_mfma_f32_16x16x32_bf16 v[140:143], v[84:87], a[140:143], v[108:111]
    buffer_load_dwordx4 v[68:71], v192, s[48:51], s23 offen offset:2048 sc1
    v_mfma_f32_16x16x32_bf16 v[112:115], v[76:79], a[204:207], v[112:115]
    v_mul_f32 v13, v13, v6
    v_mul_f32 v14, v14, v7
    v_mfma_f32_16x16x32_bf16 v[112:115], v[80:83], a[208:211], v[112:115]
    s_mov_b32 s25, 0
    v_mfma_f32_16x16x32_bf16 v[144:147], v[84:87], a[212:215], v[112:115]
    s_mov_b32 s7, s28
    v_mfma_f32_16x16x32_bf16 v[116:119], v[76:79], v[240:243], v[116:119]
    buffer_load_dwordx4 v[72:75], v192, s[48:51], s23 offen offset:3072 sc1
    v_mfma_f32_16x16x32_bf16 v[116:119], v[80:83], v[244:247], v[116:119]
    s_add_u32 s23, s23, 36864
    v_mfma_f32_16x16x32_bf16 v[148:151], v[84:87], v[248:251], v[116:119]
    v_add_u32 v12, s7, v184
    s_add_u32 s25, s25, 1
L_ffn_gu_34:
    s_waitcnt vmcnt(12)
    v_mfma_f32_16x16x32_bf16 v[88:91], v[16:19], a[0:3], 0
    v_mfma_f32_16x16x32_bf16 v[88:91], v[20:23], a[4:7], v[88:91]
    buffer_load_dwordx4 v[76:79], v184, s[48:51], s23 offen offset:0 sc1
    v_mfma_f32_16x16x32_bf16 v[88:91], v[24:27], a[8:11], v[88:91]
    v_mul_f32 v152, v120, v120
    v_mul_f32 v153, v121, v121
    v_mfma_f32_16x16x32_bf16 v[92:95], v[16:19], a[72:75], 0
    v_mul_f32 v154, v122, v122
    v_mul_f32 v155, v123, v123
    v_mfma_f32_16x16x32_bf16 v[92:95], v[20:23], a[76:79], v[92:95]
    v_fma_f32 v152, v152, v8, v4
    v_fma_f32 v153, v153, v8, v4
    v_mfma_f32_16x16x32_bf16 v[92:95], v[24:27], a[80:83], v[92:95]
    buffer_load_dwordx4 v[80:83], v184, s[48:51], s23 offen offset:1024 sc1
    v_mfma_f32_16x16x32_bf16 v[96:99], v[16:19], a[144:147], 0
    v_fma_f32 v154, v154, v8, v4
    v_fma_f32 v155, v155, v8, v4
    v_mfma_f32_16x16x32_bf16 v[96:99], v[20:23], a[148:151], v[96:99]
    v_mul_f32 v152, v120, v152
    v_mul_f32 v153, v121, v153
    v_mfma_f32_16x16x32_bf16 v[96:99], v[24:27], a[152:155], v[96:99]
    v_mul_f32 v154, v122, v154
    v_mul_f32 v155, v123, v155
    v_mfma_f32_16x16x32_bf16 v[100:103], v[16:19], a[216:219], 0
    buffer_load_dwordx4 v[84:87], v184, s[48:51], s23 offen offset:2048 sc1
    v_mfma_f32_16x16x32_bf16 v[100:103], v[20:23], a[220:223], v[100:103]
    v_exp_f32 v152, v152
    v_mfma_f32_16x16x32_bf16 v[100:103], v[24:27], a[224:227], v[100:103]
    v_exp_f32 v153, v153
    s_waitcnt vmcnt(12)
    v_mfma_f32_16x16x32_bf16 v[104:107], v[28:31], a[0:3], 0
    v_exp_f32 v154, v154
    v_mfma_f32_16x16x32_bf16 v[104:107], v[32:35], a[4:7], v[104:107]
    buffer_load_dwordx4 v[16:19], v184, s[48:51], s23 offen offset:3072 sc1
    v_mfma_f32_16x16x32_bf16 v[104:107], v[36:39], a[8:11], v[104:107]
    v_exp_f32 v155, v155
    v_mfma_f32_16x16x32_bf16 v[108:111], v[28:31], a[72:75], 0
    v_mul_f32 v156, v120, v136
    v_mul_f32 v157, v121, v137
    v_mfma_f32_16x16x32_bf16 v[108:111], v[32:35], a[76:79], v[108:111]
    v_mul_f32 v158, v122, v138
    v_mul_f32 v159, v123, v139
    v_mfma_f32_16x16x32_bf16 v[108:111], v[36:39], a[80:83], v[108:111]
    buffer_load_dwordx4 v[20:23], v185, s[48:51], s23 offen offset:0 sc1
    v_mfma_f32_16x16x32_bf16 v[112:115], v[28:31], a[144:147], 0
    v_fma_f32 v152, v152, v193, v193
    v_fma_f32 v153, v153, v193, v193
    v_mfma_f32_16x16x32_bf16 v[112:115], v[32:35], a[148:151], v[112:115]
    v_fma_f32 v154, v154, v193, v193
    v_fma_f32 v155, v155, v193, v193
    v_mfma_f32_16x16x32_bf16 v[112:115], v[36:39], a[152:155], v[112:115]
    v_rcp_f32 v152, v152
    v_mfma_f32_16x16x32_bf16 v[116:119], v[28:31], a[216:219], 0
    buffer_load_dwordx4 v[24:27], v185, s[48:51], s23 offen offset:1024 sc1
    v_mfma_f32_16x16x32_bf16 v[116:119], v[32:35], a[220:223], v[116:119]
    v_rcp_f32 v153, v153
    v_mfma_f32_16x16x32_bf16 v[116:119], v[36:39], a[224:227], v[116:119]
    v_rcp_f32 v154, v154
    s_waitcnt vmcnt(12)
    v_mfma_f32_16x16x32_bf16 v[88:91], v[40:43], a[12:15], v[88:91]
    v_rcp_f32 v155, v155
    v_mfma_f32_16x16x32_bf16 v[88:91], v[44:47], a[16:19], v[88:91]
    buffer_load_dwordx4 v[28:31], v185, s[48:51], s23 offen offset:2048 sc1
    v_mfma_f32_16x16x32_bf16 v[88:91], v[48:51], a[20:23], v[88:91]
    v_mul_f32 v156, v156, v152
    v_mul_f32 v157, v157, v153
    v_mfma_f32_16x16x32_bf16 v[92:95], v[40:43], a[84:87], v[92:95]
    v_mul_f32 v158, v158, v154
    v_mul_f32 v159, v159, v155
    v_mfma_f32_16x16x32_bf16 v[92:95], v[44:47], a[88:91], v[92:95]
    v_cvt_pk_bf16_f32 v160, v156, v157
    v_cvt_pk_bf16_f32 v161, v158, v159
    v_mfma_f32_16x16x32_bf16 v[92:95], v[48:51], a[92:95], v[92:95]
    buffer_load_dwordx4 v[32:35], v185, s[48:51], s23 offen offset:3072 sc1
    v_mfma_f32_16x16x32_bf16 v[96:99], v[40:43], a[156:159], v[96:99]
    ds_write_b64 v12, v[160:161] offset:0
    v_mfma_f32_16x16x32_bf16 v[96:99], v[44:47], a[160:163], v[96:99]
    v_mul_f32 v162, v124, v124
    v_mul_f32 v163, v125, v125
    v_mfma_f32_16x16x32_bf16 v[96:99], v[48:51], a[164:167], v[96:99]
    v_mul_f32 v164, v126, v126
    v_mul_f32 v165, v127, v127
    v_mfma_f32_16x16x32_bf16 v[100:103], v[40:43], a[228:231], v[100:103]
    buffer_load_dwordx4 v[36:39], v186, s[48:51], s23 offen offset:0 sc1
    v_mfma_f32_16x16x32_bf16 v[100:103], v[44:47], a[232:235], v[100:103]
    v_fma_f32 v162, v162, v9, v5
    v_fma_f32 v163, v163, v9, v5
    v_mfma_f32_16x16x32_bf16 v[100:103], v[48:51], a[236:239], v[100:103]
    v_fma_f32 v164, v164, v9, v5
    v_fma_f32 v165, v165, v9, v5
    s_waitcnt vmcnt(12)
    v_mfma_f32_16x16x32_bf16 v[104:107], v[52:55], a[12:15], v[104:107]
    v_mul_f32 v162, v124, v162
    v_mul_f32 v163, v125, v163
    v_mfma_f32_16x16x32_bf16 v[104:107], v[56:59], a[16:19], v[104:107]
    buffer_load_dwordx4 v[40:43], v186, s[48:51], s23 offen offset:1024 sc1
    v_mfma_f32_16x16x32_bf16 v[104:107], v[60:63], a[20:23], v[104:107]
    v_mul_f32 v164, v126, v164
    v_mul_f32 v165, v127, v165
    v_mfma_f32_16x16x32_bf16 v[108:111], v[52:55], a[84:87], v[108:111]
    v_exp_f32 v162, v162
    v_mfma_f32_16x16x32_bf16 v[108:111], v[56:59], a[88:91], v[108:111]
    v_exp_f32 v163, v163
    v_mfma_f32_16x16x32_bf16 v[108:111], v[60:63], a[92:95], v[108:111]
    buffer_load_dwordx4 v[44:47], v186, s[48:51], s23 offen offset:2048 sc1
    v_mfma_f32_16x16x32_bf16 v[112:115], v[52:55], a[156:159], v[112:115]
    v_exp_f32 v164, v164
    v_mfma_f32_16x16x32_bf16 v[112:115], v[56:59], a[160:163], v[112:115]
    v_exp_f32 v165, v165
    v_mfma_f32_16x16x32_bf16 v[112:115], v[60:63], a[164:167], v[112:115]
    v_mul_f32 v166, v124, v140
    v_mul_f32 v167, v125, v141
    v_mfma_f32_16x16x32_bf16 v[116:119], v[52:55], a[228:231], v[116:119]
    buffer_load_dwordx4 v[48:51], v186, s[48:51], s23 offen offset:3072 sc1
    v_mfma_f32_16x16x32_bf16 v[116:119], v[56:59], a[232:235], v[116:119]
    v_mul_f32 v168, v126, v142
    v_mul_f32 v169, v127, v143
    v_mfma_f32_16x16x32_bf16 v[116:119], v[60:63], a[236:239], v[116:119]
    v_fma_f32 v162, v162, v194, v194
    v_fma_f32 v163, v163, v194, v194
    s_waitcnt vmcnt(12)
    v_mfma_f32_16x16x32_bf16 v[88:91], v[64:67], a[24:27], v[88:91]
    v_fma_f32 v164, v164, v194, v194
    v_fma_f32 v165, v165, v194, v194
    v_mfma_f32_16x16x32_bf16 v[88:91], v[68:71], a[28:31], v[88:91]
    buffer_load_dwordx4 v[52:55], v187, s[48:51], s23 offen offset:0 sc1
    v_mfma_f32_16x16x32_bf16 v[88:91], v[72:75], a[32:35], v[88:91]
    v_rcp_f32 v162, v162
    v_mfma_f32_16x16x32_bf16 v[92:95], v[64:67], a[96:99], v[92:95]
    v_rcp_f32 v163, v163
    v_mfma_f32_16x16x32_bf16 v[92:95], v[68:71], a[100:103], v[92:95]
    v_rcp_f32 v164, v164
    v_mfma_f32_16x16x32_bf16 v[92:95], v[72:75], a[104:107], v[92:95]
    buffer_load_dwordx4 v[56:59], v187, s[48:51], s23 offen offset:1024 sc1
    v_mfma_f32_16x16x32_bf16 v[96:99], v[64:67], a[168:171], v[96:99]
    v_rcp_f32 v165, v165
    v_mfma_f32_16x16x32_bf16 v[96:99], v[68:71], a[172:175], v[96:99]
    v_mul_f32 v166, v166, v162
    v_mul_f32 v167, v167, v163
    v_mfma_f32_16x16x32_bf16 v[96:99], v[72:75], a[176:179], v[96:99]
    v_mul_f32 v168, v168, v164
    v_mul_f32 v169, v169, v165
    v_mfma_f32_16x16x32_bf16 v[100:103], v[64:67], a[240:243], v[100:103]
    buffer_load_dwordx4 v[60:63], v187, s[48:51], s23 offen offset:2048 sc1
    v_mfma_f32_16x16x32_bf16 v[100:103], v[68:71], a[244:247], v[100:103]
    v_cvt_pk_bf16_f32 v170, v166, v167
    v_cvt_pk_bf16_f32 v171, v168, v169
    v_mfma_f32_16x16x32_bf16 v[100:103], v[72:75], a[248:251], v[100:103]
    ds_write_b64 v12, v[170:171] offset:18432
    s_waitcnt vmcnt(12)
    v_mfma_f32_16x16x32_bf16 v[104:107], v[76:79], a[24:27], v[104:107]
    v_mul_f32 v152, v128, v128
    v_mul_f32 v153, v129, v129
    v_mfma_f32_16x16x32_bf16 v[104:107], v[80:83], a[28:31], v[104:107]
    buffer_load_dwordx4 v[64:67], v187, s[48:51], s23 offen offset:3072 sc1
    v_mfma_f32_16x16x32_bf16 v[104:107], v[84:87], a[32:35], v[104:107]
    v_mul_f32 v154, v130, v130
    v_mul_f32 v155, v131, v131
    v_mfma_f32_16x16x32_bf16 v[108:111], v[76:79], a[96:99], v[108:111]
    v_fma_f32 v152, v152, v13, v6
    v_fma_f32 v153, v153, v13, v6
    v_mfma_f32_16x16x32_bf16 v[108:111], v[80:83], a[100:103], v[108:111]
    v_fma_f32 v154, v154, v13, v6
    v_fma_f32 v155, v155, v13, v6
    v_mfma_f32_16x16x32_bf16 v[108:111], v[84:87], a[104:107], v[108:111]
    buffer_load_dwordx4 v[68:71], v188, s[48:51], s23 offen offset:0 sc1
    v_mfma_f32_16x16x32_bf16 v[112:115], v[76:79], a[168:171], v[112:115]
    v_mul_f32 v152, v128, v152
    v_mul_f32 v153, v129, v153
    v_mfma_f32_16x16x32_bf16 v[112:115], v[80:83], a[172:175], v[112:115]
    v_mul_f32 v154, v130, v154
    v_mul_f32 v155, v131, v155
    v_mfma_f32_16x16x32_bf16 v[112:115], v[84:87], a[176:179], v[112:115]
    v_exp_f32 v152, v152
    v_mfma_f32_16x16x32_bf16 v[116:119], v[76:79], a[240:243], v[116:119]
    buffer_load_dwordx4 v[72:75], v188, s[48:51], s23 offen offset:1024 sc1
    v_mfma_f32_16x16x32_bf16 v[116:119], v[80:83], a[244:247], v[116:119]
    v_exp_f32 v153, v153
    v_mfma_f32_16x16x32_bf16 v[116:119], v[84:87], a[248:251], v[116:119]
    v_exp_f32 v154, v154
    s_waitcnt vmcnt(12)
    v_mfma_f32_16x16x32_bf16 v[88:91], v[16:19], a[36:39], v[88:91]
    v_exp_f32 v155, v155
    v_mfma_f32_16x16x32_bf16 v[88:91], v[20:23], a[40:43], v[88:91]
    buffer_load_dwordx4 v[76:79], v188, s[48:51], s23 offen offset:2048 sc1
    v_mfma_f32_16x16x32_bf16 v[88:91], v[24:27], a[44:47], v[88:91]
    v_mul_f32 v156, v128, v144
    v_mul_f32 v157, v129, v145
    v_mfma_f32_16x16x32_bf16 v[92:95], v[16:19], a[108:111], v[92:95]
    v_mul_f32 v158, v130, v146
    v_mul_f32 v159, v131, v147
    v_mfma_f32_16x16x32_bf16 v[92:95], v[20:23], a[112:115], v[92:95]
    v_fma_f32 v152, v152, v195, v195
    v_fma_f32 v153, v153, v195, v195
    v_mfma_f32_16x16x32_bf16 v[92:95], v[24:27], a[116:119], v[92:95]
    buffer_load_dwordx4 v[80:83], v188, s[48:51], s23 offen offset:3072 sc1
    v_mfma_f32_16x16x32_bf16 v[96:99], v[16:19], a[180:183], v[96:99]
    v_fma_f32 v154, v154, v195, v195
    v_fma_f32 v155, v155, v195, v195
    v_mfma_f32_16x16x32_bf16 v[96:99], v[20:23], a[184:187], v[96:99]
    v_rcp_f32 v152, v152
    v_mfma_f32_16x16x32_bf16 v[96:99], v[24:27], a[188:191], v[96:99]
    v_rcp_f32 v153, v153
    v_mfma_f32_16x16x32_bf16 v[100:103], v[16:19], a[252:255], v[100:103]
    buffer_load_dwordx4 v[84:87], v189, s[48:51], s23 offen offset:0 sc1
    v_mfma_f32_16x16x32_bf16 v[100:103], v[20:23], v[220:223], v[100:103]
    v_rcp_f32 v154, v154
    v_mfma_f32_16x16x32_bf16 v[100:103], v[24:27], v[224:227], v[100:103]
    v_rcp_f32 v155, v155
    s_waitcnt vmcnt(12)
    v_mfma_f32_16x16x32_bf16 v[104:107], v[28:31], a[36:39], v[104:107]
    v_mul_f32 v156, v156, v152
    v_mul_f32 v157, v157, v153
    v_mfma_f32_16x16x32_bf16 v[104:107], v[32:35], a[40:43], v[104:107]
    buffer_load_dwordx4 v[16:19], v189, s[48:51], s23 offen offset:1024 sc1
    v_mfma_f32_16x16x32_bf16 v[104:107], v[36:39], a[44:47], v[104:107]
    v_mul_f32 v158, v158, v154
    v_mul_f32 v159, v159, v155
    v_mfma_f32_16x16x32_bf16 v[108:111], v[28:31], a[108:111], v[108:111]
    v_cvt_pk_bf16_f32 v160, v156, v157
    v_cvt_pk_bf16_f32 v161, v158, v159
    v_mfma_f32_16x16x32_bf16 v[108:111], v[32:35], a[112:115], v[108:111]
    ds_write_b64 v12, v[160:161] offset:36864
    v_mfma_f32_16x16x32_bf16 v[108:111], v[36:39], a[116:119], v[108:111]
    buffer_load_dwordx4 v[20:23], v189, s[48:51], s23 offen offset:2048 sc1
    v_mfma_f32_16x16x32_bf16 v[112:115], v[28:31], a[180:183], v[112:115]
    v_mul_f32 v162, v132, v132
    v_mul_f32 v163, v133, v133
    v_mfma_f32_16x16x32_bf16 v[112:115], v[32:35], a[184:187], v[112:115]
    v_mul_f32 v164, v134, v134
    v_mul_f32 v165, v135, v135
    v_mfma_f32_16x16x32_bf16 v[112:115], v[36:39], a[188:191], v[112:115]
    v_fma_f32 v162, v162, v14, v7
    v_fma_f32 v163, v163, v14, v7
    v_mfma_f32_16x16x32_bf16 v[116:119], v[28:31], a[252:255], v[116:119]
    buffer_load_dwordx4 v[24:27], v189, s[48:51], s23 offen offset:3072 sc1
    v_mfma_f32_16x16x32_bf16 v[116:119], v[32:35], v[220:223], v[116:119]
    v_fma_f32 v164, v164, v14, v7
    v_fma_f32 v165, v165, v14, v7
    v_mfma_f32_16x16x32_bf16 v[116:119], v[36:39], v[224:227], v[116:119]
    v_mul_f32 v162, v132, v162
    v_mul_f32 v163, v133, v163
    s_waitcnt vmcnt(12)
    v_mfma_f32_16x16x32_bf16 v[88:91], v[40:43], a[48:51], v[88:91]
    v_mul_f32 v164, v134, v164
    v_mul_f32 v165, v135, v165
    v_mfma_f32_16x16x32_bf16 v[88:91], v[44:47], a[52:55], v[88:91]
    buffer_load_dwordx4 v[28:31], v190, s[48:51], s23 offen offset:0 sc1
    v_mfma_f32_16x16x32_bf16 v[88:91], v[48:51], a[56:59], v[88:91]
    v_exp_f32 v162, v162
    v_mfma_f32_16x16x32_bf16 v[92:95], v[40:43], a[120:123], v[92:95]
    v_exp_f32 v163, v163
    v_mfma_f32_16x16x32_bf16 v[92:95], v[44:47], a[124:127], v[92:95]
    v_exp_f32 v164, v164
    v_mfma_f32_16x16x32_bf16 v[92:95], v[48:51], a[128:131], v[92:95]
    buffer_load_dwordx4 v[32:35], v190, s[48:51], s23 offen offset:1024 sc1
    v_mfma_f32_16x16x32_bf16 v[96:99], v[40:43], a[192:195], v[96:99]
    v_exp_f32 v165, v165
    v_mfma_f32_16x16x32_bf16 v[96:99], v[44:47], a[196:199], v[96:99]
    v_mul_f32 v166, v132, v148
    v_mul_f32 v167, v133, v149
    v_mfma_f32_16x16x32_bf16 v[96:99], v[48:51], a[200:203], v[96:99]
    v_mul_f32 v168, v134, v150
    v_mul_f32 v169, v135, v151
    v_mfma_f32_16x16x32_bf16 v[100:103], v[40:43], v[228:231], v[100:103]
    buffer_load_dwordx4 v[36:39], v190, s[48:51], s23 offen offset:2048 sc1
    v_mfma_f32_16x16x32_bf16 v[100:103], v[44:47], v[232:235], v[100:103]
    v_fma_f32 v162, v162, v252, v252
    v_fma_f32 v163, v163, v252, v252
    v_mfma_f32_16x16x32_bf16 v[100:103], v[48:51], v[236:239], v[100:103]
    v_fma_f32 v164, v164, v252, v252
    v_fma_f32 v165, v165, v252, v252
    s_waitcnt vmcnt(12)
    v_mfma_f32_16x16x32_bf16 v[104:107], v[52:55], a[48:51], v[104:107]
    v_rcp_f32 v162, v162
    v_mfma_f32_16x16x32_bf16 v[104:107], v[56:59], a[52:55], v[104:107]
    buffer_load_dwordx4 v[40:43], v190, s[48:51], s23 offen offset:3072 sc1
    v_mfma_f32_16x16x32_bf16 v[104:107], v[60:63], a[56:59], v[104:107]
    v_rcp_f32 v163, v163
    v_mfma_f32_16x16x32_bf16 v[108:111], v[52:55], a[120:123], v[108:111]
    v_rcp_f32 v164, v164
    v_mfma_f32_16x16x32_bf16 v[108:111], v[56:59], a[124:127], v[108:111]
    v_rcp_f32 v165, v165
    v_mfma_f32_16x16x32_bf16 v[108:111], v[60:63], a[128:131], v[108:111]
    buffer_load_dwordx4 v[44:47], v191, s[48:51], s23 offen offset:0 sc1
    v_mfma_f32_16x16x32_bf16 v[112:115], v[52:55], a[192:195], v[112:115]
    v_mul_f32 v166, v166, v162
    v_mul_f32 v167, v167, v163
    v_mfma_f32_16x16x32_bf16 v[112:115], v[56:59], a[196:199], v[112:115]
    v_mul_f32 v168, v168, v164
    v_mul_f32 v169, v169, v165
    v_mfma_f32_16x16x32_bf16 v[112:115], v[60:63], a[200:203], v[112:115]
    v_cvt_pk_bf16_f32 v170, v166, v167
    v_cvt_pk_bf16_f32 v171, v168, v169
    v_mfma_f32_16x16x32_bf16 v[116:119], v[52:55], v[228:231], v[116:119]
    buffer_load_dwordx4 v[48:51], v191, s[48:51], s23 offen offset:1024 sc1
    v_mfma_f32_16x16x32_bf16 v[116:119], v[56:59], v[232:235], v[116:119]
    ds_write_b64 v12, v[170:171] offset:55296
    v_mfma_f32_16x16x32_bf16 v[116:119], v[60:63], v[236:239], v[116:119]
    s_waitcnt vmcnt(12)
    v_mfma_f32_16x16x32_bf16 v[88:91], v[64:67], a[60:63], v[88:91]
    v_mfma_f32_16x16x32_bf16 v[88:91], v[68:71], a[64:67], v[88:91]
    buffer_load_dwordx4 v[52:55], v191, s[48:51], s23 offen offset:2048 sc1
    v_mfma_f32_16x16x32_bf16 v[120:123], v[72:75], a[68:71], v[88:91]
    v_mfma_f32_16x16x32_bf16 v[92:95], v[64:67], a[132:135], v[92:95]
    v_mfma_f32_16x16x32_bf16 v[92:95], v[68:71], a[136:139], v[92:95]
    v_mfma_f32_16x16x32_bf16 v[124:127], v[72:75], a[140:143], v[92:95]
    buffer_load_dwordx4 v[56:59], v191, s[48:51], s23 offen offset:3072 sc1
    v_mfma_f32_16x16x32_bf16 v[96:99], v[64:67], a[204:207], v[96:99]
    v_mfma_f32_16x16x32_bf16 v[96:99], v[68:71], a[208:211], v[96:99]
    v_mfma_f32_16x16x32_bf16 v[128:131], v[72:75], a[212:215], v[96:99]
    v_mfma_f32_16x16x32_bf16 v[100:103], v[64:67], v[240:243], v[100:103]
    buffer_load_dwordx4 v[60:63], v192, s[48:51], s23 offen offset:0 sc1
    v_mfma_f32_16x16x32_bf16 v[100:103], v[68:71], v[244:247], v[100:103]
    v_mfma_f32_16x16x32_bf16 v[132:135], v[72:75], v[248:251], v[100:103]
    s_waitcnt vmcnt(12)
    v_mfma_f32_16x16x32_bf16 v[104:107], v[76:79], a[60:63], v[104:107]
    v_mfma_f32_16x16x32_bf16 v[104:107], v[80:83], a[64:67], v[104:107]
    buffer_load_dwordx4 v[64:67], v192, s[48:51], s23 offen offset:1024 sc1
    v_mfma_f32_16x16x32_bf16 v[136:139], v[84:87], a[68:71], v[104:107]
    v_mfma_f32_16x16x32_bf16 v[108:111], v[76:79], a[132:135], v[108:111]
    v_mfma_f32_16x16x32_bf16 v[108:111], v[80:83], a[136:139], v[108:111]
    v_mfma_f32_16x16x32_bf16 v[140:143], v[84:87], a[140:143], v[108:111]
    buffer_load_dwordx4 v[68:71], v192, s[48:51], s23 offen offset:2048 sc1
    v_mfma_f32_16x16x32_bf16 v[112:115], v[76:79], a[204:207], v[112:115]
    v_mfma_f32_16x16x32_bf16 v[112:115], v[80:83], a[208:211], v[112:115]
    s_lshl_b32 s7, s25, 11
    v_mfma_f32_16x16x32_bf16 v[144:147], v[84:87], a[212:215], v[112:115]
    s_add_u32 s7, s7, s28
    v_mfma_f32_16x16x32_bf16 v[116:119], v[76:79], v[240:243], v[116:119]
    buffer_load_dwordx4 v[72:75], v192, s[48:51], s23 offen offset:3072 sc1
    v_mfma_f32_16x16x32_bf16 v[116:119], v[80:83], v[244:247], v[116:119]
    s_add_u32 s23, s23, 36864
    v_mfma_f32_16x16x32_bf16 v[148:151], v[84:87], v[248:251], v[116:119]
    v_add_u32 v12, s7, v184
    s_add_u32 s25, s25, 1
    s_cmp_lt_u32 s25, 8
    s_cbranch_scc1 L_ffn_gu_34
    v_add_u32 v10, 73728, v184
    v_add_u32 v11, 110592, v184
    s_lshr_b32 s7, s2, 3
    s_lshl_b32 s7, s7, 2
    s_add_u32 s7, s7, s3
    s_lshl_b32 s7, s7, 9
    v_lshrrev_b32 v1, 1, v253
    v_add_u32 v1, s7, v1
    buffer_load_dwordx2 v[2:3], v1, s[96:99], 0 offen
    s_waitcnt lgkmcnt(0)
    s_barrier
    s_waitcnt vmcnt(12)
    v_mfma_f32_16x16x32_bf16 v[88:91], v[16:19], a[0:3], 0
    v_mfma_f32_16x16x32_bf16 v[88:91], v[20:23], a[4:7], v[88:91]
    buffer_load_dwordx4 v[76:79], v184, s[48:51], s23 offen offset:0 sc1
    v_mfma_f32_16x16x32_bf16 v[88:91], v[24:27], a[8:11], v[88:91]
    v_mul_f32 v152, v120, v120
    v_mul_f32 v153, v121, v121
    v_mfma_f32_16x16x32_bf16 v[92:95], v[16:19], a[72:75], 0
    v_mul_f32 v154, v122, v122
    v_mul_f32 v155, v123, v123
    v_mfma_f32_16x16x32_bf16 v[92:95], v[20:23], a[76:79], v[92:95]
    v_fma_f32 v152, v152, v8, v4
    v_fma_f32 v153, v153, v8, v4
    v_mfma_f32_16x16x32_bf16 v[92:95], v[24:27], a[80:83], v[92:95]
    buffer_load_dwordx4 v[80:83], v184, s[48:51], s23 offen offset:1024 sc1
    v_mfma_f32_16x16x32_bf16 v[96:99], v[16:19], a[144:147], 0
    v_fma_f32 v154, v154, v8, v4
    v_fma_f32 v155, v155, v8, v4
    v_mfma_f32_16x16x32_bf16 v[96:99], v[20:23], a[148:151], v[96:99]
    v_mul_f32 v152, v120, v152
    v_mul_f32 v153, v121, v153
    v_mfma_f32_16x16x32_bf16 v[96:99], v[24:27], a[152:155], v[96:99]
    v_mul_f32 v154, v122, v154
    v_mul_f32 v155, v123, v155
    v_mfma_f32_16x16x32_bf16 v[100:103], v[16:19], a[216:219], 0
    buffer_load_dwordx4 v[84:87], v184, s[48:51], s23 offen offset:2048 sc1
    v_mfma_f32_16x16x32_bf16 v[100:103], v[20:23], a[220:223], v[100:103]
    v_exp_f32 v152, v152
    v_mfma_f32_16x16x32_bf16 v[100:103], v[24:27], a[224:227], v[100:103]
    v_exp_f32 v153, v153
    s_waitcnt vmcnt(12)
    v_mfma_f32_16x16x32_bf16 v[104:107], v[28:31], a[0:3], 0
    v_exp_f32 v154, v154
    ds_read_b128 a[0:3], v10 offset:0
    v_mfma_f32_16x16x32_bf16 v[104:107], v[32:35], a[4:7], v[104:107]
    buffer_load_dwordx4 v[16:19], v184, s[48:51], s23 offen offset:3072 sc1
    v_mfma_f32_16x16x32_bf16 v[104:107], v[36:39], a[8:11], v[104:107]
    v_exp_f32 v155, v155
    v_mfma_f32_16x16x32_bf16 v[108:111], v[28:31], a[72:75], 0
    v_mul_f32 v156, v120, v136
    v_mul_f32 v157, v121, v137
    ds_read_b128 a[72:75], v10 offset:18432
    v_mfma_f32_16x16x32_bf16 v[108:111], v[32:35], a[76:79], v[108:111]
    v_mul_f32 v158, v122, v138
    v_mul_f32 v159, v123, v139
    v_mfma_f32_16x16x32_bf16 v[108:111], v[36:39], a[80:83], v[108:111]
    buffer_load_dwordx4 v[20:23], v185, s[48:51], s23 offen offset:0 sc1
    v_mfma_f32_16x16x32_bf16 v[112:115], v[28:31], a[144:147], 0
    v_fma_f32 v152, v152, v193, v193
    v_fma_f32 v153, v153, v193, v193
    ds_read_b128 a[144:147], v11 offset:0
    v_mfma_f32_16x16x32_bf16 v[112:115], v[32:35], a[148:151], v[112:115]
    v_fma_f32 v154, v154, v193, v193
    v_fma_f32 v155, v155, v193, v193
    v_mfma_f32_16x16x32_bf16 v[112:115], v[36:39], a[152:155], v[112:115]
    v_rcp_f32 v152, v152
    v_mfma_f32_16x16x32_bf16 v[116:119], v[28:31], a[216:219], 0
    buffer_load_dwordx4 v[24:27], v185, s[48:51], s23 offen offset:1024 sc1
    v_mfma_f32_16x16x32_bf16 v[116:119], v[32:35], a[220:223], v[116:119]
    v_rcp_f32 v153, v153
    ds_read_b128 a[216:219], v11 offset:18432
    v_mfma_f32_16x16x32_bf16 v[116:119], v[36:39], a[224:227], v[116:119]
    v_rcp_f32 v154, v154
    ds_read_b128 a[4:7], v10 offset:1024
    s_waitcnt vmcnt(12)
    v_mfma_f32_16x16x32_bf16 v[88:91], v[40:43], a[12:15], v[88:91]
    v_rcp_f32 v155, v155
    ds_read_b128 a[76:79], v10 offset:19456
    v_mfma_f32_16x16x32_bf16 v[88:91], v[44:47], a[16:19], v[88:91]
    buffer_load_dwordx4 v[28:31], v185, s[48:51], s23 offen offset:2048 sc1
    v_mfma_f32_16x16x32_bf16 v[88:91], v[48:51], a[20:23], v[88:91]
    v_mul_f32 v156, v156, v152
    v_mul_f32 v157, v157, v153
    ds_read_b128 a[148:151], v11 offset:1024
    v_mfma_f32_16x16x32_bf16 v[92:95], v[40:43], a[84:87], v[92:95]
    v_mul_f32 v158, v158, v154
    v_mul_f32 v159, v159, v155
    ds_read_b128 a[220:223], v11 offset:19456
    v_mfma_f32_16x16x32_bf16 v[92:95], v[44:47], a[88:91], v[92:95]
    v_cvt_pk_bf16_f32 v160, v156, v157
    v_cvt_pk_bf16_f32 v161, v158, v159
    ds_read_b128 a[8:11], v10 offset:2048
    v_mfma_f32_16x16x32_bf16 v[92:95], v[48:51], a[92:95], v[92:95]
    buffer_load_dwordx4 v[32:35], v185, s[48:51], s23 offen offset:3072 sc1
    v_mfma_f32_16x16x32_bf16 v[96:99], v[40:43], a[156:159], v[96:99]
    ds_write_b64 v12, v[160:161] offset:0
    v_mfma_f32_16x16x32_bf16 v[96:99], v[44:47], a[160:163], v[96:99]
    v_mul_f32 v162, v124, v124
    v_mul_f32 v163, v125, v125
    ds_read_b128 a[80:83], v10 offset:20480
    v_mfma_f32_16x16x32_bf16 v[96:99], v[48:51], a[164:167], v[96:99]
    v_mul_f32 v164, v126, v126
    v_mul_f32 v165, v127, v127
    ds_read_b128 a[152:155], v11 offset:2048
    v_mfma_f32_16x16x32_bf16 v[100:103], v[40:43], a[228:231], v[100:103]
    buffer_load_dwordx4 v[36:39], v186, s[48:51], s23 offen offset:0 sc1
    v_mfma_f32_16x16x32_bf16 v[100:103], v[44:47], a[232:235], v[100:103]
    v_fma_f32 v162, v162, v9, v5
    v_fma_f32 v163, v163, v9, v5
    ds_read_b128 a[224:227], v11 offset:20480
    v_mfma_f32_16x16x32_bf16 v[100:103], v[48:51], a[236:239], v[100:103]
    v_fma_f32 v164, v164, v9, v5
    v_fma_f32 v165, v165, v9, v5
    s_waitcnt vmcnt(12)
    v_mfma_f32_16x16x32_bf16 v[104:107], v[52:55], a[12:15], v[104:107]
    v_mul_f32 v162, v124, v162
    v_mul_f32 v163, v125, v163
    ds_read_b128 a[12:15], v10 offset:3072
    v_mfma_f32_16x16x32_bf16 v[104:107], v[56:59], a[16:19], v[104:107]
    buffer_load_dwordx4 v[40:43], v186, s[48:51], s23 offen offset:1024 sc1
    v_mfma_f32_16x16x32_bf16 v[104:107], v[60:63], a[20:23], v[104:107]
    v_mul_f32 v164, v126, v164
    v_mul_f32 v165, v127, v165
    v_mfma_f32_16x16x32_bf16 v[108:111], v[52:55], a[84:87], v[108:111]
    v_exp_f32 v162, v162
    ds_read_b128 a[84:87], v10 offset:21504
    v_mfma_f32_16x16x32_bf16 v[108:111], v[56:59], a[88:91], v[108:111]
    v_exp_f32 v163, v163
    v_mfma_f32_16x16x32_bf16 v[108:111], v[60:63], a[92:95], v[108:111]
    buffer_load_dwordx4 v[44:47], v186, s[48:51], s23 offen offset:2048 sc1
    v_mfma_f32_16x16x32_bf16 v[112:115], v[52:55], a[156:159], v[112:115]
    v_exp_f32 v164, v164
    ds_read_b128 a[156:159], v11 offset:3072
    v_mfma_f32_16x16x32_bf16 v[112:115], v[56:59], a[160:163], v[112:115]
    v_exp_f32 v165, v165
    v_mfma_f32_16x16x32_bf16 v[112:115], v[60:63], a[164:167], v[112:115]
    v_mul_f32 v166, v124, v140
    v_mul_f32 v167, v125, v141
    v_mfma_f32_16x16x32_bf16 v[116:119], v[52:55], a[228:231], v[116:119]
    buffer_load_dwordx4 v[48:51], v186, s[48:51], s23 offen offset:3072 sc1
    v_mfma_f32_16x16x32_bf16 v[116:119], v[56:59], a[232:235], v[116:119]
    v_mul_f32 v168, v126, v142
    v_mul_f32 v169, v127, v143
    ds_read_b128 a[228:231], v11 offset:21504
    v_mfma_f32_16x16x32_bf16 v[116:119], v[60:63], a[236:239], v[116:119]
    v_fma_f32 v162, v162, v194, v194
    v_fma_f32 v163, v163, v194, v194
    ds_read_b128 a[16:19], v10 offset:4096
    s_waitcnt vmcnt(12)
    v_mfma_f32_16x16x32_bf16 v[88:91], v[64:67], a[24:27], v[88:91]
    v_fma_f32 v164, v164, v194, v194
    v_fma_f32 v165, v165, v194, v194
    ds_read_b128 a[88:91], v10 offset:22528
    v_mfma_f32_16x16x32_bf16 v[88:91], v[68:71], a[28:31], v[88:91]
    buffer_load_dwordx4 v[52:55], v187, s[48:51], s23 offen offset:0 sc1
    v_mfma_f32_16x16x32_bf16 v[88:91], v[72:75], a[32:35], v[88:91]
    v_rcp_f32 v162, v162
    ds_read_b128 a[160:163], v11 offset:4096
    v_mfma_f32_16x16x32_bf16 v[92:95], v[64:67], a[96:99], v[92:95]
    v_rcp_f32 v163, v163
    ds_read_b128 a[232:235], v11 offset:22528
    v_mfma_f32_16x16x32_bf16 v[92:95], v[68:71], a[100:103], v[92:95]
    v_rcp_f32 v164, v164
    ds_read_b128 a[20:23], v10 offset:5120
    v_mfma_f32_16x16x32_bf16 v[92:95], v[72:75], a[104:107], v[92:95]
    buffer_load_dwordx4 v[56:59], v187, s[48:51], s23 offen offset:1024 sc1
    v_mfma_f32_16x16x32_bf16 v[96:99], v[64:67], a[168:171], v[96:99]
    v_rcp_f32 v165, v165
    ds_read_b128 a[92:95], v10 offset:23552
    v_mfma_f32_16x16x32_bf16 v[96:99], v[68:71], a[172:175], v[96:99]
    v_mul_f32 v166, v166, v162
    v_mul_f32 v167, v167, v163
    ds_read_b128 a[164:167], v11 offset:5120
    v_mfma_f32_16x16x32_bf16 v[96:99], v[72:75], a[176:179], v[96:99]
    v_mul_f32 v168, v168, v164
    v_mul_f32 v169, v169, v165
    ds_read_b128 a[236:239], v11 offset:23552
    v_mfma_f32_16x16x32_bf16 v[100:103], v[64:67], a[240:243], v[100:103]
    buffer_load_dwordx4 v[60:63], v187, s[48:51], s23 offen offset:2048 sc1
    v_mfma_f32_16x16x32_bf16 v[100:103], v[68:71], a[244:247], v[100:103]
    v_cvt_pk_bf16_f32 v170, v166, v167
    v_cvt_pk_bf16_f32 v171, v168, v169
    v_mfma_f32_16x16x32_bf16 v[100:103], v[72:75], a[248:251], v[100:103]
    ds_write_b64 v12, v[170:171] offset:18432
    s_waitcnt vmcnt(12)
    v_mfma_f32_16x16x32_bf16 v[104:107], v[76:79], a[24:27], v[104:107]
    v_mul_f32 v152, v128, v128
    v_mul_f32 v153, v129, v129
    ds_read_b128 a[24:27], v10 offset:6144
    v_mfma_f32_16x16x32_bf16 v[104:107], v[80:83], a[28:31], v[104:107]
    buffer_load_dwordx4 v[64:67], v187, s[48:51], s23 offen offset:3072 sc1
    v_mfma_f32_16x16x32_bf16 v[104:107], v[84:87], a[32:35], v[104:107]
    v_mul_f32 v154, v130, v130
    v_mul_f32 v155, v131, v131
    v_mfma_f32_16x16x32_bf16 v[108:111], v[76:79], a[96:99], v[108:111]
    v_fma_f32 v152, v152, v13, v6
    v_fma_f32 v153, v153, v13, v6
    ds_read_b128 a[96:99], v10 offset:24576
    v_mfma_f32_16x16x32_bf16 v[108:111], v[80:83], a[100:103], v[108:111]
    v_fma_f32 v154, v154, v13, v6
    v_fma_f32 v155, v155, v13, v6
    v_mfma_f32_16x16x32_bf16 v[108:111], v[84:87], a[104:107], v[108:111]
    buffer_load_dwordx4 v[68:71], v188, s[48:51], s23 offen offset:0 sc1
    v_mfma_f32_16x16x32_bf16 v[112:115], v[76:79], a[168:171], v[112:115]
    v_mul_f32 v152, v128, v152
    v_mul_f32 v153, v129, v153
    ds_read_b128 a[168:171], v11 offset:6144
    v_mfma_f32_16x16x32_bf16 v[112:115], v[80:83], a[172:175], v[112:115]
    v_mul_f32 v154, v130, v154
    v_mul_f32 v155, v131, v155
    v_mfma_f32_16x16x32_bf16 v[112:115], v[84:87], a[176:179], v[112:115]
    v_exp_f32 v152, v152
    v_mfma_f32_16x16x32_bf16 v[116:119], v[76:79], a[240:243], v[116:119]
    buffer_load_dwordx4 v[72:75], v188, s[48:51], s23 offen offset:1024 sc1
    v_mfma_f32_16x16x32_bf16 v[116:119], v[80:83], a[244:247], v[116:119]
    v_exp_f32 v153, v153
    ds_read_b128 a[240:243], v11 offset:24576
    v_mfma_f32_16x16x32_bf16 v[116:119], v[84:87], a[248:251], v[116:119]
    v_exp_f32 v154, v154
    ds_read_b128 a[28:31], v10 offset:7168
    s_waitcnt vmcnt(12)
    v_mfma_f32_16x16x32_bf16 v[88:91], v[16:19], a[36:39], v[88:91]
    v_exp_f32 v155, v155
    ds_read_b128 a[100:103], v10 offset:25600
    v_mfma_f32_16x16x32_bf16 v[88:91], v[20:23], a[40:43], v[88:91]
    buffer_load_dwordx4 v[76:79], v188, s[48:51], s23 offen offset:2048 sc1
    v_mfma_f32_16x16x32_bf16 v[88:91], v[24:27], a[44:47], v[88:91]
    v_mul_f32 v156, v128, v144
    v_mul_f32 v157, v129, v145
    ds_read_b128 a[172:175], v11 offset:7168
    v_mfma_f32_16x16x32_bf16 v[92:95], v[16:19], a[108:111], v[92:95]
    v_mul_f32 v158, v130, v146
    v_mul_f32 v159, v131, v147
    ds_read_b128 a[244:247], v11 offset:25600
    v_mfma_f32_16x16x32_bf16 v[92:95], v[20:23], a[112:115], v[92:95]
    v_fma_f32 v152, v152, v195, v195
    v_fma_f32 v153, v153, v195, v195
    ds_read_b128 a[32:35], v10 offset:8192
    v_mfma_f32_16x16x32_bf16 v[92:95], v[24:27], a[116:119], v[92:95]
    buffer_load_dwordx4 v[80:83], v188, s[48:51], s23 offen offset:3072 sc1
    v_mfma_f32_16x16x32_bf16 v[96:99], v[16:19], a[180:183], v[96:99]
    v_fma_f32 v154, v154, v195, v195
    v_fma_f32 v155, v155, v195, v195
    ds_read_b128 a[104:107], v10 offset:26624
    v_mfma_f32_16x16x32_bf16 v[96:99], v[20:23], a[184:187], v[96:99]
    v_rcp_f32 v152, v152
    ds_read_b128 a[176:179], v11 offset:8192
    v_mfma_f32_16x16x32_bf16 v[96:99], v[24:27], a[188:191], v[96:99]
    v_rcp_f32 v153, v153
    ds_read_b128 a[248:251], v11 offset:26624
    v_mfma_f32_16x16x32_bf16 v[100:103], v[16:19], a[252:255], v[100:103]
    buffer_load_dwordx4 v[84:87], v189, s[48:51], s23 offen offset:0 sc1
    v_mfma_f32_16x16x32_bf16 v[100:103], v[20:23], v[220:223], v[100:103]
    v_rcp_f32 v154, v154
    v_mfma_f32_16x16x32_bf16 v[100:103], v[24:27], v[224:227], v[100:103]
    v_rcp_f32 v155, v155
    s_waitcnt vmcnt(12)
    v_mfma_f32_16x16x32_bf16 v[104:107], v[28:31], a[36:39], v[104:107]
    v_mul_f32 v156, v156, v152
    v_mul_f32 v157, v157, v153
    ds_read_b128 a[36:39], v10 offset:9216
    v_mfma_f32_16x16x32_bf16 v[104:107], v[32:35], a[40:43], v[104:107]
    buffer_load_dwordx4 v[16:19], v189, s[48:51], s23 offen offset:1024 sc1
    v_mfma_f32_16x16x32_bf16 v[104:107], v[36:39], a[44:47], v[104:107]
    v_mul_f32 v158, v158, v154
    v_mul_f32 v159, v159, v155
    v_mfma_f32_16x16x32_bf16 v[108:111], v[28:31], a[108:111], v[108:111]
    v_cvt_pk_bf16_f32 v160, v156, v157
    v_cvt_pk_bf16_f32 v161, v158, v159
    ds_read_b128 a[108:111], v10 offset:27648
    v_mfma_f32_16x16x32_bf16 v[108:111], v[32:35], a[112:115], v[108:111]
    ds_write_b64 v12, v[160:161] offset:36864
    v_mfma_f32_16x16x32_bf16 v[108:111], v[36:39], a[116:119], v[108:111]
    buffer_load_dwordx4 v[20:23], v189, s[48:51], s23 offen offset:2048 sc1
    v_mfma_f32_16x16x32_bf16 v[112:115], v[28:31], a[180:183], v[112:115]
    v_mul_f32 v162, v132, v132
    v_mul_f32 v163, v133, v133
    ds_read_b128 a[180:183], v11 offset:9216
    v_mfma_f32_16x16x32_bf16 v[112:115], v[32:35], a[184:187], v[112:115]
    v_mul_f32 v164, v134, v134
    v_mul_f32 v165, v135, v135
    v_mfma_f32_16x16x32_bf16 v[112:115], v[36:39], a[188:191], v[112:115]
    v_fma_f32 v162, v162, v14, v7
    v_fma_f32 v163, v163, v14, v7
    v_mfma_f32_16x16x32_bf16 v[116:119], v[28:31], a[252:255], v[116:119]
    buffer_load_dwordx4 v[24:27], v189, s[48:51], s23 offen offset:3072 sc1
    v_mfma_f32_16x16x32_bf16 v[116:119], v[32:35], v[220:223], v[116:119]
    v_fma_f32 v164, v164, v14, v7
    v_fma_f32 v165, v165, v14, v7
    ds_read_b128 a[252:255], v11 offset:27648
    v_mfma_f32_16x16x32_bf16 v[116:119], v[36:39], v[224:227], v[116:119]
    v_mul_f32 v162, v132, v162
    v_mul_f32 v163, v133, v163
    ds_read_b128 a[40:43], v10 offset:10240
    s_waitcnt vmcnt(12)
    v_mfma_f32_16x16x32_bf16 v[88:91], v[40:43], a[48:51], v[88:91]
    v_mul_f32 v164, v134, v164
    v_mul_f32 v165, v135, v165
    ds_read_b128 a[112:115], v10 offset:28672
    v_mfma_f32_16x16x32_bf16 v[88:91], v[44:47], a[52:55], v[88:91]
    buffer_load_dwordx4 v[28:31], v190, s[48:51], s23 offen offset:0 sc1
    v_mfma_f32_16x16x32_bf16 v[88:91], v[48:51], a[56:59], v[88:91]
    v_exp_f32 v162, v162
    ds_read_b128 a[184:187], v11 offset:10240
    v_mfma_f32_16x16x32_bf16 v[92:95], v[40:43], a[120:123], v[92:95]
    v_exp_f32 v163, v163
    ds_read_b128 v[220:223], v11 offset:28672
    v_mfma_f32_16x16x32_bf16 v[92:95], v[44:47], a[124:127], v[92:95]
    v_exp_f32 v164, v164
    ds_read_b128 a[44:47], v10 offset:11264
    v_mfma_f32_16x16x32_bf16 v[92:95], v[48:51], a[128:131], v[92:95]
    buffer_load_dwordx4 v[32:35], v190, s[48:51], s23 offen offset:1024 sc1
    v_mfma_f32_16x16x32_bf16 v[96:99], v[40:43], a[192:195], v[96:99]
    v_exp_f32 v165, v165
    ds_read_b128 a[116:119], v10 offset:29696
    v_mfma_f32_16x16x32_bf16 v[96:99], v[44:47], a[196:199], v[96:99]
    v_mul_f32 v166, v132, v148
    v_mul_f32 v167, v133, v149
    ds_read_b128 a[188:191], v11 offset:11264
    v_mfma_f32_16x16x32_bf16 v[96:99], v[48:51], a[200:203], v[96:99]
    v_mul_f32 v168, v134, v150
    v_mul_f32 v169, v135, v151
    ds_read_b128 v[224:227], v11 offset:29696
    v_mfma_f32_16x16x32_bf16 v[100:103], v[40:43], v[228:231], v[100:103]
    buffer_load_dwordx4 v[36:39], v190, s[48:51], s23 offen offset:2048 sc1
    v_mfma_f32_16x16x32_bf16 v[100:103], v[44:47], v[232:235], v[100:103]
    v_fma_f32 v162, v162, v252, v252
    v_fma_f32 v163, v163, v252, v252
    v_mfma_f32_16x16x32_bf16 v[100:103], v[48:51], v[236:239], v[100:103]
    v_fma_f32 v164, v164, v252, v252
    v_fma_f32 v165, v165, v252, v252
    s_waitcnt vmcnt(12)
    v_mfma_f32_16x16x32_bf16 v[104:107], v[52:55], a[48:51], v[104:107]
    v_rcp_f32 v162, v162
    ds_read_b128 a[48:51], v10 offset:12288
    v_mfma_f32_16x16x32_bf16 v[104:107], v[56:59], a[52:55], v[104:107]
    buffer_load_dwordx4 v[40:43], v190, s[48:51], s23 offen offset:3072 sc1
    v_mfma_f32_16x16x32_bf16 v[104:107], v[60:63], a[56:59], v[104:107]
    v_rcp_f32 v163, v163
    v_mfma_f32_16x16x32_bf16 v[108:111], v[52:55], a[120:123], v[108:111]
    v_rcp_f32 v164, v164
    ds_read_b128 a[120:123], v10 offset:30720
    v_mfma_f32_16x16x32_bf16 v[108:111], v[56:59], a[124:127], v[108:111]
    v_rcp_f32 v165, v165
    v_mfma_f32_16x16x32_bf16 v[108:111], v[60:63], a[128:131], v[108:111]
    buffer_load_dwordx4 v[44:47], v191, s[48:51], s23 offen offset:0 sc1
    v_mfma_f32_16x16x32_bf16 v[112:115], v[52:55], a[192:195], v[112:115]
    v_mul_f32 v166, v166, v162
    v_mul_f32 v167, v167, v163
    ds_read_b128 a[192:195], v11 offset:12288
    v_mfma_f32_16x16x32_bf16 v[112:115], v[56:59], a[196:199], v[112:115]
    v_mul_f32 v168, v168, v164
    v_mul_f32 v169, v169, v165
    v_mfma_f32_16x16x32_bf16 v[112:115], v[60:63], a[200:203], v[112:115]
    v_cvt_pk_bf16_f32 v170, v166, v167
    v_cvt_pk_bf16_f32 v171, v168, v169
    v_mfma_f32_16x16x32_bf16 v[116:119], v[52:55], v[228:231], v[116:119]
    buffer_load_dwordx4 v[48:51], v191, s[48:51], s23 offen offset:1024 sc1
    v_mfma_f32_16x16x32_bf16 v[116:119], v[56:59], v[232:235], v[116:119]
    ds_write_b64 v12, v[170:171] offset:55296
    v_mfma_f32_16x16x32_bf16 v[116:119], v[60:63], v[236:239], v[116:119]
    ds_read_b128 v[228:231], v11 offset:30720
    s_waitcnt vmcnt(12)
    v_mfma_f32_16x16x32_bf16 v[88:91], v[64:67], a[60:63], v[88:91]
    ds_read_b128 a[52:55], v10 offset:13312
    v_mfma_f32_16x16x32_bf16 v[88:91], v[68:71], a[64:67], v[88:91]
    buffer_load_dwordx4 v[52:55], v191, s[48:51], s23 offen offset:2048 sc1
    v_mfma_f32_16x16x32_bf16 v[120:123], v[72:75], a[68:71], v[88:91]
    ds_read_b128 a[124:127], v10 offset:31744
    v_mfma_f32_16x16x32_bf16 v[92:95], v[64:67], a[132:135], v[92:95]
    ds_read_b128 a[196:199], v11 offset:13312
    v_mfma_f32_16x16x32_bf16 v[92:95], v[68:71], a[136:139], v[92:95]
    ds_read_b128 v[232:235], v11 offset:31744
    v_mfma_f32_16x16x32_bf16 v[124:127], v[72:75], a[140:143], v[92:95]
    buffer_load_dwordx4 v[56:59], v191, s[48:51], s23 offen offset:3072 sc1
    v_mfma_f32_16x16x32_bf16 v[96:99], v[64:67], a[204:207], v[96:99]
    v_mfma_f32_16x16x32_bf16 v[96:99], v[68:71], a[208:211], v[96:99]
    v_mfma_f32_16x16x32_bf16 v[128:131], v[72:75], a[212:215], v[96:99]
    v_mfma_f32_16x16x32_bf16 v[100:103], v[64:67], v[240:243], v[100:103]
    buffer_load_dwordx4 v[60:63], v192, s[48:51], s23 offen offset:0 sc1
    v_mfma_f32_16x16x32_bf16 v[100:103], v[68:71], v[244:247], v[100:103]
    v_mfma_f32_16x16x32_bf16 v[132:135], v[72:75], v[248:251], v[100:103]
    s_waitcnt vmcnt(12)
    v_mfma_f32_16x16x32_bf16 v[104:107], v[76:79], a[60:63], v[104:107]
    v_mfma_f32_16x16x32_bf16 v[104:107], v[80:83], a[64:67], v[104:107]
    buffer_load_dwordx4 v[64:67], v192, s[48:51], s23 offen offset:1024 sc1
    v_mfma_f32_16x16x32_bf16 v[136:139], v[84:87], a[68:71], v[104:107]
    v_mfma_f32_16x16x32_bf16 v[108:111], v[76:79], a[132:135], v[108:111]
    v_mfma_f32_16x16x32_bf16 v[108:111], v[80:83], a[136:139], v[108:111]
    v_mfma_f32_16x16x32_bf16 v[140:143], v[84:87], a[140:143], v[108:111]
    buffer_load_dwordx4 v[68:71], v192, s[48:51], s23 offen offset:2048 sc1
    v_mfma_f32_16x16x32_bf16 v[112:115], v[76:79], a[204:207], v[112:115]
    v_mfma_f32_16x16x32_bf16 v[112:115], v[80:83], a[208:211], v[112:115]
    s_lshl_b32 s7, s25, 11
    v_mfma_f32_16x16x32_bf16 v[144:147], v[84:87], a[212:215], v[112:115]
    s_add_u32 s7, s7, s28
    v_mfma_f32_16x16x32_bf16 v[116:119], v[76:79], v[240:243], v[116:119]
    buffer_load_dwordx4 v[72:75], v192, s[48:51], s23 offen offset:3072 sc1
    v_mfma_f32_16x16x32_bf16 v[116:119], v[80:83], v[244:247], v[116:119]
    s_add_u32 s23, s23, 36864
    v_mfma_f32_16x16x32_bf16 v[148:151], v[84:87], v[248:251], v[116:119]
    v_add_u32 v12, s7, v184
    s_add_u32 s25, s25, 1
    s_waitcnt lgkmcnt(0)
    s_barrier
    v_pk_mul_f32 v[152:153], v[120:121], v[120:121]
    ds_read_b128 a[56:59], v10 offset:14336
    v_pk_mul_f32 v[154:155], v[122:123], v[122:123]
    ds_read_b128 a[128:131], v10 offset:32768
    v_pk_fma_f32 v[152:153], v[152:153], v[8:9], v[4:5] op_sel:[0,0,0] op_sel_hi:[1,0,0]
    ds_read_b128 a[200:203], v11 offset:14336
    v_pk_fma_f32 v[154:155], v[154:155], v[8:9], v[4:5] op_sel:[0,0,0] op_sel_hi:[1,0,0]
    v_pk_mul_f32 v[152:153], v[120:121], v[152:153]
    ds_read_b128 v[236:239], v11 offset:32768
    v_pk_mul_f32 v[154:155], v[122:123], v[154:155]
    ds_read_b128 a[60:63], v10 offset:15360
    buffer_load_dwordx4 v[76:79], v184, s[48:51], s23 offen offset:0 sc1
    v_exp_f32 v152, v152
    ds_read_b128 a[132:135], v10 offset:33792
    v_exp_f32 v153, v153
    v_exp_f32 v154, v154
    ds_read_b128 a[204:207], v11 offset:15360
    v_exp_f32 v155, v155
    ds_read_b128 v[240:243], v11 offset:33792
    v_pk_mul_f32 v[156:157], v[120:121], v[136:137]
    v_pk_mul_f32 v[158:159], v[122:123], v[138:139]
    buffer_load_dwordx4 v[80:83], v184, s[48:51], s23 offen offset:1024 sc1
    v_pk_fma_f32 v[152:153], v[152:153], v[192:193], v[192:193] op_sel:[0,1,1] op_sel_hi:[1,1,1]
    v_pk_fma_f32 v[154:155], v[154:155], v[192:193], v[192:193] op_sel:[0,1,1] op_sel_hi:[1,1,1]
    v_rcp_f32 v152, v152
    v_rcp_f32 v153, v153
    v_rcp_f32 v154, v154
    v_rcp_f32 v155, v155
    buffer_load_dwordx4 v[84:87], v184, s[48:51], s23 offen offset:2048 sc1
    s_nop 0
    v_pk_mul_f32 v[156:157], v[156:157], v[152:153]
    v_pk_mul_f32 v[158:159], v[158:159], v[154:155]
    v_cvt_pk_bf16_f32 v160, v156, v157
    v_cvt_pk_bf16_f32 v161, v158, v159
    ds_write_b64 v12, v[160:161] offset:0
    buffer_load_dwordx4 v[104:107], v184, s[48:51], s23 offen offset:3072 sc1
    v_pk_mul_f32 v[162:163], v[124:125], v[124:125]
    v_pk_mul_f32 v[164:165], v[126:127], v[126:127]
    v_pk_fma_f32 v[162:163], v[162:163], v[8:9], v[4:5] op_sel:[0,1,1] op_sel_hi:[1,1,1]
    v_pk_fma_f32 v[164:165], v[164:165], v[8:9], v[4:5] op_sel:[0,1,1] op_sel_hi:[1,1,1]
    v_pk_mul_f32 v[162:163], v[124:125], v[162:163]
    v_pk_mul_f32 v[164:165], v[126:127], v[164:165]
    buffer_load_dwordx4 v[108:111], v185, s[48:51], s23 offen offset:0 sc1
    v_exp_f32 v162, v162
    v_exp_f32 v163, v163
    v_exp_f32 v164, v164
    v_exp_f32 v165, v165
    v_pk_mul_f32 v[166:167], v[124:125], v[140:141]
    v_pk_mul_f32 v[168:169], v[126:127], v[142:143]
    buffer_load_dwordx4 v[112:115], v185, s[48:51], s23 offen offset:1024 sc1
    v_pk_fma_f32 v[162:163], v[162:163], v[194:195], v[194:195] op_sel:[0,0,0] op_sel_hi:[1,0,0]
    v_pk_fma_f32 v[164:165], v[164:165], v[194:195], v[194:195] op_sel:[0,0,0] op_sel_hi:[1,0,0]
    v_rcp_f32 v162, v162
    v_rcp_f32 v163, v163
    v_rcp_f32 v164, v164
    v_rcp_f32 v165, v165
    buffer_load_dwordx4 v[116:119], v185, s[48:51], s23 offen offset:2048 sc1
    s_nop 0
    v_pk_mul_f32 v[166:167], v[166:167], v[162:163]
    v_pk_mul_f32 v[168:169], v[168:169], v[164:165]
    v_cvt_pk_bf16_f32 v170, v166, v167
    v_cvt_pk_bf16_f32 v171, v168, v169
    ds_write_b64 v12, v[170:171] offset:18432
    buffer_load_dwordx4 v[180:183], v185, s[48:51], s23 offen offset:3072 sc1
    v_pk_mul_f32 v[152:153], v[128:129], v[128:129]
    v_pk_mul_f32 v[154:155], v[130:131], v[130:131]
    v_pk_fma_f32 v[152:153], v[152:153], v[12:13], v[6:7] op_sel:[0,1,0] op_sel_hi:[1,1,0]
    v_pk_fma_f32 v[154:155], v[154:155], v[12:13], v[6:7] op_sel:[0,1,0] op_sel_hi:[1,1,0]
    v_pk_mul_f32 v[152:153], v[128:129], v[152:153]
    v_pk_mul_f32 v[154:155], v[130:131], v[154:155]
    buffer_load_dwordx4 v[196:199], v186, s[48:51], s23 offen offset:0 sc1
    v_exp_f32 v152, v152
    v_exp_f32 v153, v153
    v_exp_f32 v154, v154
    v_exp_f32 v155, v155
    v_pk_mul_f32 v[156:157], v[128:129], v[144:145]
    v_pk_mul_f32 v[158:159], v[130:131], v[146:147]
    buffer_load_dwordx4 v[200:203], v186, s[48:51], s23 offen offset:1024 sc1
    v_pk_fma_f32 v[152:153], v[152:153], v[194:195], v[194:195] op_sel:[0,1,1] op_sel_hi:[1,1,1]
    v_pk_fma_f32 v[154:155], v[154:155], v[194:195], v[194:195] op_sel:[0,1,1] op_sel_hi:[1,1,1]
    v_rcp_f32 v152, v152
    v_rcp_f32 v153, v153
    v_rcp_f32 v154, v154
    v_rcp_f32 v155, v155
    buffer_load_dwordx4 v[204:207], v186, s[48:51], s23 offen offset:2048 sc1
    s_nop 0
    v_pk_mul_f32 v[156:157], v[156:157], v[152:153]
    v_pk_mul_f32 v[158:159], v[158:159], v[154:155]
    v_cvt_pk_bf16_f32 v160, v156, v157
    v_cvt_pk_bf16_f32 v161, v158, v159
    ds_write_b64 v12, v[160:161] offset:36864
    buffer_load_dwordx4 v[208:211], v186, s[48:51], s23 offen offset:3072 sc1
    v_pk_mul_f32 v[162:163], v[132:133], v[132:133]
    v_pk_mul_f32 v[164:165], v[134:135], v[134:135]
    v_pk_fma_f32 v[162:163], v[162:163], v[14:15], v[6:7] op_sel:[0,0,1] op_sel_hi:[1,0,1]
    v_pk_fma_f32 v[164:165], v[164:165], v[14:15], v[6:7] op_sel:[0,0,1] op_sel_hi:[1,0,1]
    v_pk_mul_f32 v[162:163], v[132:133], v[162:163]
    v_pk_mul_f32 v[164:165], v[134:135], v[164:165]
    buffer_load_dwordx4 v[212:215], v187, s[48:51], s23 offen offset:0 sc1
    v_exp_f32 v162, v162
    v_exp_f32 v163, v163
    v_exp_f32 v164, v164
    v_exp_f32 v165, v165
    v_pk_mul_f32 v[166:167], v[132:133], v[148:149]
    v_pk_mul_f32 v[168:169], v[134:135], v[150:151]
    v_pk_fma_f32 v[162:163], v[162:163], v[252:253], v[252:253] op_sel:[0,0,0] op_sel_hi:[1,0,0]
    v_pk_fma_f32 v[164:165], v[164:165], v[252:253], v[252:253] op_sel:[0,0,0] op_sel_hi:[1,0,0]
    v_rcp_f32 v162, v162
    v_rcp_f32 v163, v163
    v_rcp_f32 v164, v164
    v_rcp_f32 v165, v165
    s_nop 0
    v_pk_mul_f32 v[166:167], v[166:167], v[162:163]
    v_pk_mul_f32 v[168:169], v[168:169], v[164:165]
    v_cvt_pk_bf16_f32 v170, v166, v167
    v_cvt_pk_bf16_f32 v171, v168, v169
    ds_write_b64 v12, v[170:171] offset:55296
    buffer_load_dwordx4 v[136:139], v187, s[48:51], s23 offen offset:1024 sc1
    buffer_load_dwordx4 v[140:143], v187, s[48:51], s23 offen offset:2048 sc1
    buffer_load_dwordx4 v[144:147], v187, s[48:51], s23 offen offset:3072 sc1
    buffer_load_dwordx4 v[160:163], v188, s[48:51], s23 offen offset:0 sc1
    buffer_load_dwordx4 v[164:167], v188, s[48:51], s23 offen offset:1024 sc1
    s_add_u32 s23, s23, 18432
    s_waitcnt lgkmcnt(0)
    s_barrier
    ds_read_b128 a[64:67], v10 offset:16384
    ds_read_b128 a[136:139], v10 offset:34816
    ds_read_b128 a[208:211], v11 offset:16384
    ds_read_b128 v[244:247], v11 offset:34816
    ds_read_b128 a[68:71], v10 offset:17408
    ds_read_b128 a[140:143], v10 offset:35840
    ds_read_b128 a[212:215], v11 offset:17408
    ds_read_b128 v[248:251], v11 offset:35840
    s_mov_b32 s25, 0
    s_waitcnt lgkmcnt(0)
    s_branch L_ffn_dn_mid_36
L_ffn_dn_35:
    s_waitcnt vmcnt(32)
    v_mfma_f32_16x16x32_bf16 v[88:91], v[104:107], a[0:3], 0
    v_mfma_f32_16x16x32_bf16 v[88:91], v[108:111], a[4:7], v[88:91]
    buffer_load_dwordx4 v[76:79], v184, s[48:51], s23 offen offset:0 sc1
    v_mfma_f32_16x16x32_bf16 v[88:91], v[112:115], a[8:11], v[88:91]
    v_mfma_f32_16x16x32_bf16 v[92:95], v[104:107], a[72:75], 0
    v_mfma_f32_16x16x32_bf16 v[92:95], v[108:111], a[76:79], v[92:95]
    v_mfma_f32_16x16x32_bf16 v[92:95], v[112:115], a[80:83], v[92:95]
    buffer_load_dwordx4 v[80:83], v184, s[48:51], s23 offen offset:1024 sc1
    v_mfma_f32_16x16x32_bf16 v[96:99], v[104:107], a[144:147], 0
    v_cvt_pk_bf16_f32 v152, v120, v121
    v_cvt_pk_bf16_f32 v153, v122, v123
    v_mfma_f32_16x16x32_bf16 v[96:99], v[108:111], a[148:151], v[96:99]
    v_cvt_pk_bf16_f32 v154, v124, v125
    v_cvt_pk_bf16_f32 v155, v126, v127
    v_mfma_f32_16x16x32_bf16 v[96:99], v[112:115], a[152:155], v[96:99]
    s_nop 0
    v_permlane16_swap_b32 v152, v154
    v_mfma_f32_16x16x32_bf16 v[100:103], v[104:107], a[216:219], 0
    buffer_load_dwordx4 v[84:87], v184, s[48:51], s23 offen offset:2048 sc1
    v_mfma_f32_16x16x32_bf16 v[100:103], v[108:111], a[220:223], v[100:103]
    v_permlane16_swap_b32 v153, v155
    v_mfma_f32_16x16x32_bf16 v[100:103], v[112:115], a[224:227], v[100:103]
    buffer_store_dwordx4 v[152:155], v178, s[72:75], s27 offen sc1
    s_waitcnt vmcnt(33)
    v_mfma_f32_16x16x32_bf16 v[88:91], v[116:119], a[12:15], v[88:91]
    ds_write_b128 v216, v[152:155]
    v_mfma_f32_16x16x32_bf16 v[88:91], v[180:183], a[16:19], v[88:91]
    buffer_load_dwordx4 v[104:107], v184, s[48:51], s23 offen offset:3072 sc1
    v_mfma_f32_16x16x32_bf16 v[88:91], v[196:199], a[20:23], v[88:91]
    v_add_u32 v216, v216, v218
    v_mfma_f32_16x16x32_bf16 v[92:95], v[116:119], a[84:87], v[92:95]
    v_mfma_f32_16x16x32_bf16 v[92:95], v[180:183], a[88:91], v[92:95]
    v_mfma_f32_16x16x32_bf16 v[92:95], v[196:199], a[92:95], v[92:95]
    buffer_load_dwordx4 v[108:111], v185, s[48:51], s23 offen offset:0 sc1
    v_mfma_f32_16x16x32_bf16 v[96:99], v[116:119], a[156:159], v[96:99]
    v_mfma_f32_16x16x32_bf16 v[96:99], v[180:183], a[160:163], v[96:99]
    v_mfma_f32_16x16x32_bf16 v[96:99], v[196:199], a[164:167], v[96:99]
    v_mfma_f32_16x16x32_bf16 v[100:103], v[116:119], a[228:231], v[100:103]
    buffer_load_dwordx4 v[112:115], v185, s[48:51], s23 offen offset:1024 sc1
    v_mfma_f32_16x16x32_bf16 v[100:103], v[180:183], a[232:235], v[100:103]
    v_mfma_f32_16x16x32_bf16 v[100:103], v[196:199], a[236:239], v[100:103]
    s_waitcnt vmcnt(33)
    v_mfma_f32_16x16x32_bf16 v[88:91], v[200:203], a[24:27], v[88:91]
    v_mfma_f32_16x16x32_bf16 v[88:91], v[204:207], a[28:31], v[88:91]
    buffer_load_dwordx4 v[116:119], v185, s[48:51], s23 offen offset:2048 sc1
    v_mfma_f32_16x16x32_bf16 v[88:91], v[208:211], a[32:35], v[88:91]
    v_mfma_f32_16x16x32_bf16 v[92:95], v[200:203], a[96:99], v[92:95]
    v_mfma_f32_16x16x32_bf16 v[92:95], v[204:207], a[100:103], v[92:95]
    v_mfma_f32_16x16x32_bf16 v[92:95], v[208:211], a[104:107], v[92:95]
    buffer_load_dwordx4 v[180:183], v185, s[48:51], s23 offen offset:3072 sc1
    v_mfma_f32_16x16x32_bf16 v[96:99], v[200:203], a[168:171], v[96:99]
    v_mfma_f32_16x16x32_bf16 v[96:99], v[204:207], a[172:175], v[96:99]
    v_mfma_f32_16x16x32_bf16 v[96:99], v[208:211], a[176:179], v[96:99]
    v_mfma_f32_16x16x32_bf16 v[100:103], v[200:203], a[240:243], v[100:103]
    buffer_load_dwordx4 v[196:199], v186, s[48:51], s23 offen offset:0 sc1
    v_mfma_f32_16x16x32_bf16 v[100:103], v[204:207], a[244:247], v[100:103]
    v_mfma_f32_16x16x32_bf16 v[100:103], v[208:211], a[248:251], v[100:103]
    s_waitcnt vmcnt(33)
    v_mfma_f32_16x16x32_bf16 v[88:91], v[212:215], a[36:39], v[88:91]
    v_mfma_f32_16x16x32_bf16 v[88:91], v[136:139], a[40:43], v[88:91]
    buffer_load_dwordx4 v[200:203], v186, s[48:51], s23 offen offset:1024 sc1
    v_mfma_f32_16x16x32_bf16 v[88:91], v[140:143], a[44:47], v[88:91]
    v_mfma_f32_16x16x32_bf16 v[92:95], v[212:215], a[108:111], v[92:95]
    v_mfma_f32_16x16x32_bf16 v[92:95], v[136:139], a[112:115], v[92:95]
    v_cvt_pk_bf16_f32 v156, v128, v129
    v_cvt_pk_bf16_f32 v157, v130, v131
    v_mfma_f32_16x16x32_bf16 v[92:95], v[140:143], a[116:119], v[92:95]
    buffer_load_dwordx4 v[204:207], v186, s[48:51], s23 offen offset:2048 sc1
    v_mfma_f32_16x16x32_bf16 v[96:99], v[212:215], a[180:183], v[96:99]
    v_cvt_pk_bf16_f32 v158, v132, v133
    v_cvt_pk_bf16_f32 v159, v134, v135
    v_mfma_f32_16x16x32_bf16 v[96:99], v[136:139], a[184:187], v[96:99]
    s_nop 0
    v_permlane16_swap_b32 v156, v158
    v_mfma_f32_16x16x32_bf16 v[96:99], v[140:143], a[188:191], v[96:99]
    v_permlane16_swap_b32 v157, v159
    v_mfma_f32_16x16x32_bf16 v[100:103], v[212:215], a[252:255], v[100:103]
    buffer_load_dwordx4 v[208:211], v186, s[48:51], s23 offen offset:3072 sc1
    v_mfma_f32_16x16x32_bf16 v[100:103], v[136:139], v[220:223], v[100:103]
    buffer_store_dwordx4 v[156:159], v179, s[72:75], s27 offen sc1
    v_mfma_f32_16x16x32_bf16 v[100:103], v[140:143], v[224:227], v[100:103]
    ds_write_b128 v217, v[156:159]
    s_waitcnt vmcnt(34)
    v_mfma_f32_16x16x32_bf16 v[88:91], v[144:147], a[48:51], v[88:91]
    v_add_u32 v217, v217, v219
    v_mfma_f32_16x16x32_bf16 v[88:91], v[160:163], a[52:55], v[88:91]
    buffer_load_dwordx4 v[212:215], v187, s[48:51], s23 offen offset:0 sc1
    v_mfma_f32_16x16x32_bf16 v[88:91], v[164:167], a[56:59], v[88:91]
    v_mfma_f32_16x16x32_bf16 v[92:95], v[144:147], a[120:123], v[92:95]
    v_mfma_f32_16x16x32_bf16 v[92:95], v[160:163], a[124:127], v[92:95]
    v_mfma_f32_16x16x32_bf16 v[92:95], v[164:167], a[128:131], v[92:95]
    buffer_load_dwordx4 v[136:139], v187, s[48:51], s23 offen offset:1024 sc1
    v_mfma_f32_16x16x32_bf16 v[96:99], v[144:147], a[192:195], v[96:99]
    v_mfma_f32_16x16x32_bf16 v[96:99], v[160:163], a[196:199], v[96:99]
    v_mfma_f32_16x16x32_bf16 v[96:99], v[164:167], a[200:203], v[96:99]
    v_mfma_f32_16x16x32_bf16 v[100:103], v[144:147], v[228:231], v[100:103]
    buffer_load_dwordx4 v[140:143], v187, s[48:51], s23 offen offset:2048 sc1
    v_mfma_f32_16x16x32_bf16 v[100:103], v[160:163], v[232:235], v[100:103]
    v_mfma_f32_16x16x32_bf16 v[100:103], v[164:167], v[236:239], v[100:103]
    s_waitcnt vmcnt(34)
    v_mfma_f32_16x16x32_bf16 v[88:91], v[168:171], a[60:63], v[88:91]
    v_mfma_f32_16x16x32_bf16 v[88:91], v[148:151], a[64:67], v[88:91]
    buffer_load_dwordx4 v[144:147], v187, s[48:51], s23 offen offset:3072 sc1
    v_mfma_f32_16x16x32_bf16 v[120:123], v[4:7], a[68:71], v[88:91]
    v_mfma_f32_16x16x32_bf16 v[92:95], v[168:171], a[132:135], v[92:95]
    v_mfma_f32_16x16x32_bf16 v[92:95], v[148:151], a[136:139], v[92:95]
    v_mfma_f32_16x16x32_bf16 v[124:127], v[4:7], a[140:143], v[92:95]
    buffer_load_dwordx4 v[160:163], v188, s[48:51], s23 offen offset:0 sc1
    v_mfma_f32_16x16x32_bf16 v[96:99], v[168:171], a[204:207], v[96:99]
    s_mov_b32 s74, 268435456
    v_mfma_f32_16x16x32_bf16 v[96:99], v[148:151], a[208:211], v[96:99]
    s_add_u32 s27, s27, 1024
    v_mfma_f32_16x16x32_bf16 v[128:131], v[4:7], a[212:215], v[96:99]
    s_add_u32 s25, s25, 1
    v_mfma_f32_16x16x32_bf16 v[100:103], v[168:171], v[240:243], v[100:103]
    buffer_load_dwordx4 v[164:167], v188, s[48:51], s23 offen offset:1024 sc1
    v_mfma_f32_16x16x32_bf16 v[100:103], v[148:151], v[244:247], v[100:103]
    s_add_u32 s23, s23, 18432
    v_mfma_f32_16x16x32_bf16 v[132:135], v[4:7], v[248:251], v[100:103]
L_ffn_dn_mid_36:
    s_waitcnt vmcnt(30)
    v_mfma_f32_16x16x32_bf16 v[88:91], v[16:19], a[0:3], 0
    v_mfma_f32_16x16x32_bf16 v[88:91], v[20:23], a[4:7], v[88:91]
    buffer_load_dwordx4 v[168:171], v184, s[48:51], s23 offen offset:0 sc1
    v_mfma_f32_16x16x32_bf16 v[88:91], v[24:27], a[8:11], v[88:91]
    v_mfma_f32_16x16x32_bf16 v[92:95], v[16:19], a[72:75], 0
    v_mfma_f32_16x16x32_bf16 v[92:95], v[20:23], a[76:79], v[92:95]
    v_mfma_f32_16x16x32_bf16 v[92:95], v[24:27], a[80:83], v[92:95]
    buffer_load_dwordx4 v[148:151], v184, s[48:51], s23 offen offset:1024 sc1
    v_mfma_f32_16x16x32_bf16 v[96:99], v[16:19], a[144:147], 0
    v_cvt_pk_bf16_f32 v152, v120, v121
    v_cvt_pk_bf16_f32 v153, v122, v123
    v_mfma_f32_16x16x32_bf16 v[96:99], v[20:23], a[148:151], v[96:99]
    v_cvt_pk_bf16_f32 v154, v124, v125
    v_cvt_pk_bf16_f32 v155, v126, v127
    v_mfma_f32_16x16x32_bf16 v[96:99], v[24:27], a[152:155], v[96:99]
    s_nop 0
    v_permlane16_swap_b32 v152, v154
    v_mfma_f32_16x16x32_bf16 v[100:103], v[16:19], a[216:219], 0
    buffer_load_dwordx4 v[4:7], v184, s[48:51], s23 offen offset:2048 sc1
    v_mfma_f32_16x16x32_bf16 v[100:103], v[20:23], a[220:223], v[100:103]
    v_permlane16_swap_b32 v153, v155
    v_mfma_f32_16x16x32_bf16 v[100:103], v[24:27], a[224:227], v[100:103]
    buffer_store_dwordx4 v[152:155], v178, s[72:75], s27 offen sc1
    s_waitcnt vmcnt(31)
    v_mfma_f32_16x16x32_bf16 v[88:91], v[28:31], a[12:15], v[88:91]
    ds_write_b128 v216, v[152:155]
    v_mfma_f32_16x16x32_bf16 v[88:91], v[32:35], a[16:19], v[88:91]
    buffer_load_dwordx4 v[16:19], v184, s[48:51], s23 offen offset:3072 sc1
    v_mfma_f32_16x16x32_bf16 v[88:91], v[36:39], a[20:23], v[88:91]
    v_add_u32 v216, v216, v218
    v_mfma_f32_16x16x32_bf16 v[92:95], v[28:31], a[84:87], v[92:95]
    v_mfma_f32_16x16x32_bf16 v[92:95], v[32:35], a[88:91], v[92:95]
    v_mfma_f32_16x16x32_bf16 v[92:95], v[36:39], a[92:95], v[92:95]
    buffer_load_dwordx4 v[20:23], v185, s[48:51], s23 offen offset:0 sc1
    v_mfma_f32_16x16x32_bf16 v[96:99], v[28:31], a[156:159], v[96:99]
    v_mfma_f32_16x16x32_bf16 v[96:99], v[32:35], a[160:163], v[96:99]
    v_mfma_f32_16x16x32_bf16 v[96:99], v[36:39], a[164:167], v[96:99]
    v_mfma_f32_16x16x32_bf16 v[100:103], v[28:31], a[228:231], v[100:103]
    buffer_load_dwordx4 v[24:27], v185, s[48:51], s23 offen offset:1024 sc1
    v_mfma_f32_16x16x32_bf16 v[100:103], v[32:35], a[232:235], v[100:103]
    v_mfma_f32_16x16x32_bf16 v[100:103], v[36:39], a[236:239], v[100:103]
    s_waitcnt vmcnt(31)
    v_mfma_f32_16x16x32_bf16 v[88:91], v[40:43], a[24:27], v[88:91]
    v_mfma_f32_16x16x32_bf16 v[88:91], v[44:47], a[28:31], v[88:91]
    buffer_load_dwordx4 v[28:31], v185, s[48:51], s23 offen offset:2048 sc1
    v_mfma_f32_16x16x32_bf16 v[88:91], v[48:51], a[32:35], v[88:91]
    v_mfma_f32_16x16x32_bf16 v[92:95], v[40:43], a[96:99], v[92:95]
    v_mfma_f32_16x16x32_bf16 v[92:95], v[44:47], a[100:103], v[92:95]
    v_mfma_f32_16x16x32_bf16 v[92:95], v[48:51], a[104:107], v[92:95]
    buffer_load_dwordx4 v[32:35], v185, s[48:51], s23 offen offset:3072 sc1
    v_mfma_f32_16x16x32_bf16 v[96:99], v[40:43], a[168:171], v[96:99]
    v_mfma_f32_16x16x32_bf16 v[96:99], v[44:47], a[172:175], v[96:99]
    v_mfma_f32_16x16x32_bf16 v[96:99], v[48:51], a[176:179], v[96:99]
    v_mfma_f32_16x16x32_bf16 v[100:103], v[40:43], a[240:243], v[100:103]
    buffer_load_dwordx4 v[36:39], v186, s[48:51], s23 offen offset:0 sc1
    v_mfma_f32_16x16x32_bf16 v[100:103], v[44:47], a[244:247], v[100:103]
    v_mfma_f32_16x16x32_bf16 v[100:103], v[48:51], a[248:251], v[100:103]
    s_waitcnt vmcnt(31)
    s_cmp_lg_u32 s25, 6
    s_cbranch_scc1 L_early_37
    s_waitcnt vmcnt(16)
    s_barrier
    s_cmp_lg_u32 s3, 0
    s_cbranch_scc1 L_early_37
    v_lshlrev_b32 v15, 7, v0
    v_mov_b32 v1, s76
    s_mov_b64 exec, 0xff
    buffer_store_dword v1, v15, s[8:11], s29 offen sc1
    s_mov_b64 exec, -1
L_early_37:
    v_mfma_f32_16x16x32_bf16 v[88:91], v[52:55], a[36:39], v[88:91]
    v_mfma_f32_16x16x32_bf16 v[88:91], v[56:59], a[40:43], v[88:91]
    buffer_load_dwordx4 v[40:43], v186, s[48:51], s23 offen offset:1024 sc1
    v_mfma_f32_16x16x32_bf16 v[88:91], v[60:63], a[44:47], v[88:91]
    v_mfma_f32_16x16x32_bf16 v[92:95], v[52:55], a[108:111], v[92:95]
    v_mfma_f32_16x16x32_bf16 v[92:95], v[56:59], a[112:115], v[92:95]
    v_cvt_pk_bf16_f32 v156, v128, v129
    v_cvt_pk_bf16_f32 v157, v130, v131
    v_mfma_f32_16x16x32_bf16 v[92:95], v[60:63], a[116:119], v[92:95]
    buffer_load_dwordx4 v[44:47], v186, s[48:51], s23 offen offset:2048 sc1
    v_mfma_f32_16x16x32_bf16 v[96:99], v[52:55], a[180:183], v[96:99]
    v_cvt_pk_bf16_f32 v158, v132, v133
    v_cvt_pk_bf16_f32 v159, v134, v135
    v_mfma_f32_16x16x32_bf16 v[96:99], v[56:59], a[184:187], v[96:99]
    s_nop 0
    v_permlane16_swap_b32 v156, v158
    v_mfma_f32_16x16x32_bf16 v[96:99], v[60:63], a[188:191], v[96:99]
    v_permlane16_swap_b32 v157, v159
    v_mfma_f32_16x16x32_bf16 v[100:103], v[52:55], a[252:255], v[100:103]
    buffer_load_dwordx4 v[48:51], v186, s[48:51], s23 offen offset:3072 sc1
    v_mfma_f32_16x16x32_bf16 v[100:103], v[56:59], v[220:223], v[100:103]
    buffer_store_dwordx4 v[156:159], v179, s[72:75], s27 offen sc1
    v_mfma_f32_16x16x32_bf16 v[100:103], v[60:63], v[224:227], v[100:103]
    ds_write_b128 v217, v[156:159]
    s_waitcnt vmcnt(32)
    v_mfma_f32_16x16x32_bf16 v[88:91], v[64:67], a[48:51], v[88:91]
    v_add_u32 v217, v217, v219
    v_mfma_f32_16x16x32_bf16 v[88:91], v[68:71], a[52:55], v[88:91]
    buffer_load_dwordx4 v[52:55], v187, s[48:51], s23 offen offset:0 sc1
    v_mfma_f32_16x16x32_bf16 v[88:91], v[72:75], a[56:59], v[88:91]
    v_mfma_f32_16x16x32_bf16 v[92:95], v[64:67], a[120:123], v[92:95]
    v_mfma_f32_16x16x32_bf16 v[92:95], v[68:71], a[124:127], v[92:95]
    v_mfma_f32_16x16x32_bf16 v[92:95], v[72:75], a[128:131], v[92:95]
    buffer_load_dwordx4 v[56:59], v187, s[48:51], s23 offen offset:1024 sc1
    v_mfma_f32_16x16x32_bf16 v[96:99], v[64:67], a[192:195], v[96:99]
    v_mfma_f32_16x16x32_bf16 v[96:99], v[68:71], a[196:199], v[96:99]
    v_mfma_f32_16x16x32_bf16 v[96:99], v[72:75], a[200:203], v[96:99]
    v_mfma_f32_16x16x32_bf16 v[100:103], v[64:67], v[228:231], v[100:103]
    buffer_load_dwordx4 v[60:63], v187, s[48:51], s23 offen offset:2048 sc1
    v_mfma_f32_16x16x32_bf16 v[100:103], v[68:71], v[232:235], v[100:103]
    v_mfma_f32_16x16x32_bf16 v[100:103], v[72:75], v[236:239], v[100:103]
    s_waitcnt vmcnt(32)
    v_mfma_f32_16x16x32_bf16 v[88:91], v[76:79], a[60:63], v[88:91]
    v_mfma_f32_16x16x32_bf16 v[88:91], v[80:83], a[64:67], v[88:91]
    buffer_load_dwordx4 v[64:67], v187, s[48:51], s23 offen offset:3072 sc1
    v_mfma_f32_16x16x32_bf16 v[120:123], v[84:87], a[68:71], v[88:91]
    v_mfma_f32_16x16x32_bf16 v[92:95], v[76:79], a[132:135], v[92:95]
    v_mfma_f32_16x16x32_bf16 v[92:95], v[80:83], a[136:139], v[92:95]
    v_mfma_f32_16x16x32_bf16 v[124:127], v[84:87], a[140:143], v[92:95]
    buffer_load_dwordx4 v[68:71], v188, s[48:51], s23 offen offset:0 sc1
    v_mfma_f32_16x16x32_bf16 v[96:99], v[76:79], a[204:207], v[96:99]
    s_mov_b32 s74, 268435456
    v_mfma_f32_16x16x32_bf16 v[96:99], v[80:83], a[208:211], v[96:99]
    s_add_u32 s27, s27, 1024
    v_mfma_f32_16x16x32_bf16 v[128:131], v[84:87], a[212:215], v[96:99]
    s_add_u32 s25, s25, 1
    v_mfma_f32_16x16x32_bf16 v[100:103], v[76:79], v[240:243], v[100:103]
    buffer_load_dwordx4 v[72:75], v188, s[48:51], s23 offen offset:1024 sc1
    v_mfma_f32_16x16x32_bf16 v[100:103], v[80:83], v[244:247], v[100:103]
    s_add_u32 s23, s23, 18432
    v_mfma_f32_16x16x32_bf16 v[132:135], v[84:87], v[248:251], v[100:103]
    s_cmp_lt_u32 s25, 7
    s_cbranch_scc1 L_ffn_dn_35
    s_waitcnt vmcnt(33)
    v_mfma_f32_16x16x32_bf16 v[88:91], v[104:107], a[0:3], 0
    v_mfma_f32_16x16x32_bf16 v[88:91], v[108:111], a[4:7], v[88:91]
    buffer_load_dwordx4 v[76:79], v184, s[48:51], s23 offen offset:0 sc1
    v_mfma_f32_16x16x32_bf16 v[88:91], v[112:115], a[8:11], v[88:91]
    v_mfma_f32_16x16x32_bf16 v[92:95], v[104:107], a[72:75], 0
    v_mfma_f32_16x16x32_bf16 v[92:95], v[108:111], a[76:79], v[92:95]
    v_mfma_f32_16x16x32_bf16 v[92:95], v[112:115], a[80:83], v[92:95]
    buffer_load_dwordx4 v[80:83], v184, s[48:51], s23 offen offset:1024 sc1
    v_mfma_f32_16x16x32_bf16 v[96:99], v[104:107], a[144:147], 0
    v_cvt_pk_bf16_f32 v152, v120, v121
    v_cvt_pk_bf16_f32 v153, v122, v123
    v_mfma_f32_16x16x32_bf16 v[96:99], v[108:111], a[148:151], v[96:99]
    v_cvt_pk_bf16_f32 v154, v124, v125
    v_cvt_pk_bf16_f32 v155, v126, v127
    v_mfma_f32_16x16x32_bf16 v[96:99], v[112:115], a[152:155], v[96:99]
    s_nop 0
    v_permlane16_swap_b32 v152, v154
    v_mfma_f32_16x16x32_bf16 v[100:103], v[104:107], a[216:219], 0
    buffer_load_dwordx4 v[84:87], v184, s[48:51], s23 offen offset:2048 sc1
    v_mfma_f32_16x16x32_bf16 v[100:103], v[108:111], a[220:223], v[100:103]
    v_permlane16_swap_b32 v153, v155
    v_mfma_f32_16x16x32_bf16 v[100:103], v[112:115], a[224:227], v[100:103]
    buffer_store_dwordx4 v[152:155], v178, s[72:75], s27 offen sc1
    s_waitcnt vmcnt(34)
    v_mfma_f32_16x16x32_bf16 v[88:91], v[116:119], a[12:15], v[88:91]
    ds_write_b128 v216, v[152:155]
    v_mfma_f32_16x16x32_bf16 v[88:91], v[180:183], a[16:19], v[88:91]
    v_add_u32 v216, v216, v218
    v_cvt_pk_bf16_f32 v156, v128, v129
    v_mfma_f32_16x16x32_bf16 v[88:91], v[196:199], a[20:23], v[88:91]
    v_cvt_pk_bf16_f32 v157, v130, v131
    v_cvt_pk_bf16_f32 v158, v132, v133
    s_load_dwordx8 s[56:63], s[38:39], 0 glc
    v_mfma_f32_16x16x32_bf16 v[92:95], v[116:119], a[84:87], v[92:95]
    v_cvt_pk_bf16_f32 v159, v134, v135
    s_mov_b32 s6, 0
    v_mfma_f32_16x16x32_bf16 v[92:95], v[180:183], a[88:91], v[92:95]
    s_nop 0
    v_permlane16_swap_b32 v156, v158
    v_mfma_f32_16x16x32_bf16 v[92:95], v[196:199], a[92:95], v[92:95]
    v_permlane16_swap_b32 v157, v159
    v_mfma_f32_16x16x32_bf16 v[96:99], v[116:119], a[156:159], v[96:99]
    buffer_store_dwordx4 v[156:159], v179, s[72:75], s27 offen sc1
    v_mfma_f32_16x16x32_bf16 v[96:99], v[180:183], a[160:163], v[96:99]
    ds_write_b128 v217, v[156:159]
    v_mfma_f32_16x16x32_bf16 v[96:99], v[196:199], a[164:167], v[96:99]
    v_add_u32 v217, v217, v219
    v_mfma_f32_16x16x32_bf16 v[100:103], v[116:119], a[228:231], v[100:103]
    v_mfma_f32_16x16x32_bf16 v[100:103], v[180:183], a[232:235], v[100:103]
    v_mfma_f32_16x16x32_bf16 v[100:103], v[196:199], a[236:239], v[100:103]
    s_waitcnt vmcnt(32)
L_epoll_38:
    s_waitcnt lgkmcnt(0)
    s_xor_b64 s[56:57], s[56:57], s[76:77]
    s_xor_b64 s[58:59], s[58:59], s[76:77]
    s_xor_b64 s[60:61], s[60:61], s[76:77]
    s_xor_b64 s[62:63], s[62:63], s[76:77]
    s_or_b64 s[56:57], s[56:57], s[58:59]
    s_or_b64 s[60:61], s[60:61], s[62:63]
    s_or_b64 s[56:57], s[56:57], s[60:61]
    s_cbranch_scc0 L_epolled_39
    s_load_dwordx8 s[56:63], s[38:39], 0 glc
    s_add_u32 s6, s6, 1
    s_cmp_lt_u32 s6, 1048576
    s_cbranch_scc1 L_epoll_38
    s_branch L_main_end
L_epolled_39:
    v_mfma_f32_16x16x32_bf16 v[88:91], v[200:203], a[24:27], v[88:91]
    v_mfma_f32_16x16x32_bf16 v[88:91], v[204:207], a[28:31], v[88:91]
    s_add_u32 s7, s40, 1
    s_and_b32 s7, s7, 7
    s_mul_i32 s7, s7, 9216
    s_add_u32 s19, s7, s20
    buffer_load_dwordx4 v[104:107], v172, s[8:11], s19 offen sc1
    v_mfma_f32_16x16x32_bf16 v[88:91], v[208:211], a[32:35], v[88:91]
    v_mfma_f32_16x16x32_bf16 v[92:95], v[200:203], a[96:99], v[92:95]
    v_mfma_f32_16x16x32_bf16 v[92:95], v[204:207], a[100:103], v[92:95]
    v_mfma_f32_16x16x32_bf16 v[92:95], v[208:211], a[104:107], v[92:95]
    buffer_load_dwordx4 v[108:111], v173, s[8:11], s19 offen sc1
    v_mfma_f32_16x16x32_bf16 v[96:99], v[200:203], a[168:171], v[96:99]
    v_mfma_f32_16x16x32_bf16 v[96:99], v[204:207], a[172:175], v[96:99]
    v_mfma_f32_16x16x32_bf16 v[96:99], v[208:211], a[176:179], v[96:99]
    v_mfma_f32_16x16x32_bf16 v[100:103], v[200:203], a[240:243], v[100:103]
    s_add_u32 s7, s40, 2
    s_and_b32 s7, s7, 7
    s_mul_i32 s7, s7, 9216
    s_add_u32 s19, s7, s20
    buffer_load_dwordx4 v[112:115], v172, s[8:11], s19 offen sc1
    v_mfma_f32_16x16x32_bf16 v[100:103], v[204:207], a[244:247], v[100:103]
    v_mfma_f32_16x16x32_bf16 v[100:103], v[208:211], a[248:251], v[100:103]
    s_waitcnt vmcnt(31)
    v_mfma_f32_16x16x32_bf16 v[88:91], v[212:215], a[36:39], v[88:91]
    v_mfma_f32_16x16x32_bf16 v[88:91], v[136:139], a[40:43], v[88:91]
    buffer_load_dwordx4 v[116:119], v173, s[8:11], s19 offen sc1
    v_mfma_f32_16x16x32_bf16 v[88:91], v[140:143], a[44:47], v[88:91]
    v_mfma_f32_16x16x32_bf16 v[92:95], v[212:215], a[108:111], v[92:95]
    v_mfma_f32_16x16x32_bf16 v[92:95], v[136:139], a[112:115], v[92:95]
    v_mfma_f32_16x16x32_bf16 v[92:95], v[140:143], a[116:119], v[92:95]
    s_add_u32 s7, s40, 3
    s_and_b32 s7, s7, 7
    s_mul_i32 s7, s7, 9216
    s_add_u32 s19, s7, s20
    buffer_load_dwordx4 v[180:183], v172, s[8:11], s19 offen sc1
    v_mfma_f32_16x16x32_bf16 v[96:99], v[212:215], a[180:183], v[96:99]
    v_mfma_f32_16x16x32_bf16 v[96:99], v[136:139], a[184:187], v[96:99]
    v_mfma_f32_16x16x32_bf16 v[96:99], v[140:143], a[188:191], v[96:99]
    v_mfma_f32_16x16x32_bf16 v[100:103], v[212:215], a[252:255], v[100:103]
    buffer_load_dwordx4 v[196:199], v173, s[8:11], s19 offen sc1
    v_mfma_f32_16x16x32_bf16 v[100:103], v[136:139], v[220:223], v[100:103]
    v_mfma_f32_16x16x32_bf16 v[100:103], v[140:143], v[224:227], v[100:103]
    s_waitcnt vmcnt(31)
    v_mfma_f32_16x16x32_bf16 v[88:91], v[144:147], a[48:51], v[88:91]
    v_mfma_f32_16x16x32_bf16 v[88:91], v[160:163], a[52:55], v[88:91]
    s_add_u32 s7, s40, 4
    s_and_b32 s7, s7, 7
    s_mul_i32 s7, s7, 9216
    s_add_u32 s19, s7, s20
    buffer_load_dwordx4 v[200:203], v172, s[8:11], s19 offen sc1
    v_mfma_f32_16x16x32_bf16 v[88:91], v[164:167], a[56:59], v[88:91]
    v_mfma_f32_16x16x32_bf16 v[92:95], v[144:147], a[120:123], v[92:95]
    v_mfma_f32_16x16x32_bf16 v[92:95], v[160:163], a[124:127], v[92:95]
    v_mfma_f32_16x16x32_bf16 v[92:95], v[164:167], a[128:131], v[92:95]
    buffer_load_dwordx4 v[204:207], v173, s[8:11], s19 offen sc1
    v_mfma_f32_16x16x32_bf16 v[96:99], v[144:147], a[192:195], v[96:99]
    v_mfma_f32_16x16x32_bf16 v[96:99], v[160:163], a[196:199], v[96:99]
    v_mfma_f32_16x16x32_bf16 v[96:99], v[164:167], a[200:203], v[96:99]
    v_mfma_f32_16x16x32_bf16 v[100:103], v[144:147], v[228:231], v[100:103]
    s_add_u32 s7, s40, 5
    s_and_b32 s7, s7, 7
    s_mul_i32 s7, s7, 9216
    s_add_u32 s19, s7, s20
    buffer_load_dwordx4 v[208:211], v172, s[8:11], s19 offen sc1
    v_mfma_f32_16x16x32_bf16 v[100:103], v[160:163], v[232:235], v[100:103]
    v_mfma_f32_16x16x32_bf16 v[100:103], v[164:167], v[236:239], v[100:103]
    s_waitcnt vmcnt(31)
    v_mfma_f32_16x16x32_bf16 v[88:91], v[168:171], a[60:63], v[88:91]
    v_mfma_f32_16x16x32_bf16 v[88:91], v[148:151], a[64:67], v[88:91]
    buffer_load_dwordx4 v[212:215], v173, s[8:11], s19 offen sc1
    v_mfma_f32_16x16x32_bf16 v[120:123], v[4:7], a[68:71], v[88:91]
    v_mfma_f32_16x16x32_bf16 v[92:95], v[168:171], a[132:135], v[92:95]
    v_mfma_f32_16x16x32_bf16 v[92:95], v[148:151], a[136:139], v[92:95]
    v_mfma_f32_16x16x32_bf16 v[124:127], v[4:7], a[140:143], v[92:95]
    s_add_u32 s7, s40, 6
    s_and_b32 s7, s7, 7
    s_mul_i32 s7, s7, 9216
    s_add_u32 s19, s7, s20
    buffer_load_dwordx4 v[136:139], v172, s[8:11], s19 offen sc1
    v_mfma_f32_16x16x32_bf16 v[96:99], v[168:171], a[204:207], v[96:99]
    s_mov_b32 s74, 268435456
    v_mfma_f32_16x16x32_bf16 v[96:99], v[148:151], a[208:211], v[96:99]
    s_add_u32 s27, s27, 1024
    v_mfma_f32_16x16x32_bf16 v[128:131], v[4:7], a[212:215], v[96:99]
    s_add_u32 s25, s25, 1
    v_mfma_f32_16x16x32_bf16 v[100:103], v[168:171], v[240:243], v[100:103]
    buffer_load_dwordx4 v[140:143], v173, s[8:11], s19 offen sc1
    v_mfma_f32_16x16x32_bf16 v[100:103], v[148:151], v[244:247], v[100:103]
    s_add_u32 s23, s23, 18432
    v_mfma_f32_16x16x32_bf16 v[132:135], v[4:7], v[248:251], v[100:103]
    s_waitcnt vmcnt(30)
    v_mfma_f32_16x16x32_bf16 v[88:91], v[16:19], a[0:3], 0
    v_mfma_f32_16x16x32_bf16 v[88:91], v[20:23], a[4:7], v[88:91]
    s_add_u32 s7, s40, 7
    s_and_b32 s7, s7, 7
    s_mul_i32 s7, s7, 9216
    s_add_u32 s19, s7, s20
    buffer_load_dwordx4 v[144:147], v172, s[8:11], s19 offen sc1
    v_mfma_f32_16x16x32_bf16 v[88:91], v[24:27], a[8:11], v[88:91]
    v_mfma_f32_16x16x32_bf16 v[92:95], v[16:19], a[72:75], 0
    v_mfma_f32_16x16x32_bf16 v[92:95], v[20:23], a[76:79], v[92:95]
    v_mfma_f32_16x16x32_bf16 v[92:95], v[24:27], a[80:83], v[92:95]
    buffer_load_dwordx4 v[160:163], v173, s[8:11], s19 offen sc1
    v_mfma_f32_16x16x32_bf16 v[96:99], v[16:19], a[144:147], 0
    v_cvt_pk_bf16_f32 v152, v120, v121
    v_cvt_pk_bf16_f32 v153, v122, v123
    v_mfma_f32_16x16x32_bf16 v[96:99], v[20:23], a[148:151], v[96:99]
    v_cvt_pk_bf16_f32 v154, v124, v125
    v_cvt_pk_bf16_f32 v155, v126, v127
    v_mfma_f32_16x16x32_bf16 v[96:99], v[24:27], a[152:155], v[96:99]
    s_nop 0
    v_permlane16_swap_b32 v152, v154
    v_mfma_f32_16x16x32_bf16 v[100:103], v[16:19], a[216:219], 0
    v_permlane16_swap_b32 v153, v155
    v_mfma_f32_16x16x32_bf16 v[100:103], v[20:23], a[220:223], v[100:103]
    buffer_store_dwordx4 v[152:155], v178, s[72:75], s27 offen sc1
    v_mfma_f32_16x16x32_bf16 v[100:103], v[24:27], a[224:227], v[100:103]
    ds_write_b128 v216, v[152:155]
    s_waitcnt vmcnt(30)
    v_mfma_f32_16x16x32_bf16 v[88:91], v[28:31], a[12:15], v[88:91]
    v_add_u32 v216, v216, v218
    v_cvt_pk_bf16_f32 v156, v128, v129
    v_mfma_f32_16x16x32_bf16 v[88:91], v[32:35], a[16:19], v[88:91]
    v_cvt_pk_bf16_f32 v157, v130, v131
    v_cvt_pk_bf16_f32 v158, v132, v133
    v_mfma_f32_16x16x32_bf16 v[88:91], v[36:39], a[20:23], v[88:91]
    v_cvt_pk_bf16_f32 v159, v134, v135
    v_mfma_f32_16x16x32_bf16 v[92:95], v[28:31], a[84:87], v[92:95]
    s_nop 0
    v_permlane16_swap_b32 v156, v158
    v_mfma_f32_16x16x32_bf16 v[92:95], v[32:35], a[88:91], v[92:95]
    v_permlane16_swap_b32 v157, v159
    v_mfma_f32_16x16x32_bf16 v[92:95], v[36:39], a[92:95], v[92:95]
    buffer_store_dwordx4 v[156:159], v179, s[72:75], s27 offen sc1
    v_mfma_f32_16x16x32_bf16 v[96:99], v[28:31], a[156:159], v[96:99]
    ds_write_b128 v217, v[156:159]
    v_mfma_f32_16x16x32_bf16 v[96:99], v[32:35], a[160:163], v[96:99]
    v_add_u32 v217, v217, v219
    v_mfma_f32_16x16x32_bf16 v[96:99], v[36:39], a[164:167], v[96:99]
    v_mfma_f32_16x16x32_bf16 v[100:103], v[28:31], a[228:231], v[100:103]
    v_mfma_f32_16x16x32_bf16 v[100:103], v[32:35], a[232:235], v[100:103]
    v_mfma_f32_16x16x32_bf16 v[100:103], v[36:39], a[236:239], v[100:103]
    s_waitcnt vmcnt(28)
    v_mfma_f32_16x16x32_bf16 v[88:91], v[40:43], a[24:27], v[88:91]
    v_mfma_f32_16x16x32_bf16 v[88:91], v[44:47], a[28:31], v[88:91]
    v_mfma_f32_16x16x32_bf16 v[88:91], v[48:51], a[32:35], v[88:91]
    v_mfma_f32_16x16x32_bf16 v[92:95], v[40:43], a[96:99], v[92:95]
    v_mfma_f32_16x16x32_bf16 v[92:95], v[44:47], a[100:103], v[92:95]
    v_mfma_f32_16x16x32_bf16 v[92:95], v[48:51], a[104:107], v[92:95]
    v_mfma_f32_16x16x32_bf16 v[96:99], v[40:43], a[168:171], v[96:99]
    v_mfma_f32_16x16x32_bf16 v[96:99], v[44:47], a[172:175], v[96:99]
    v_mfma_f32_16x16x32_bf16 v[96:99], v[48:51], a[176:179], v[96:99]
    v_mfma_f32_16x16x32_bf16 v[100:103], v[40:43], a[240:243], v[100:103]
    v_mfma_f32_16x16x32_bf16 v[100:103], v[44:47], a[244:247], v[100:103]
    v_mfma_f32_16x16x32_bf16 v[100:103], v[48:51], a[248:251], v[100:103]
    s_waitcnt vmcnt(24)
    v_mfma_f32_16x16x32_bf16 v[88:91], v[52:55], a[36:39], v[88:91]
    v_mfma_f32_16x16x32_bf16 v[88:91], v[56:59], a[40:43], v[88:91]
    v_mfma_f32_16x16x32_bf16 v[88:91], v[60:63], a[44:47], v[88:91]
    v_mfma_f32_16x16x32_bf16 v[92:95], v[52:55], a[108:111], v[92:95]
    v_mfma_f32_16x16x32_bf16 v[92:95], v[56:59], a[112:115], v[92:95]
    v_mfma_f32_16x16x32_bf16 v[92:95], v[60:63], a[116:119], v[92:95]
    v_mfma_f32_16x16x32_bf16 v[96:99], v[52:55], a[180:183], v[96:99]
    v_mfma_f32_16x16x32_bf16 v[96:99], v[56:59], a[184:187], v[96:99]
    v_mfma_f32_16x16x32_bf16 v[96:99], v[60:63], a[188:191], v[96:99]
    v_mfma_f32_16x16x32_bf16 v[100:103], v[52:55], a[252:255], v[100:103]
    v_mfma_f32_16x16x32_bf16 v[100:103], v[56:59], v[220:223], v[100:103]
    v_mfma_f32_16x16x32_bf16 v[100:103], v[60:63], v[224:227], v[100:103]
    s_waitcnt vmcnt(21)
    v_mfma_f32_16x16x32_bf16 v[88:91], v[64:67], a[48:51], v[88:91]
    v_mfma_f32_16x16x32_bf16 v[88:91], v[68:71], a[52:55], v[88:91]
    v_mfma_f32_16x16x32_bf16 v[88:91], v[72:75], a[56:59], v[88:91]
    v_mfma_f32_16x16x32_bf16 v[92:95], v[64:67], a[120:123], v[92:95]
    v_mfma_f32_16x16x32_bf16 v[92:95], v[68:71], a[124:127], v[92:95]
    v_mfma_f32_16x16x32_bf16 v[92:95], v[72:75], a[128:131], v[92:95]
    v_mfma_f32_16x16x32_bf16 v[96:99], v[64:67], a[192:195], v[96:99]
    v_mfma_f32_16x16x32_bf16 v[96:99], v[68:71], a[196:199], v[96:99]
    v_mfma_f32_16x16x32_bf16 v[96:99], v[72:75], a[200:203], v[96:99]
    v_mfma_f32_16x16x32_bf16 v[100:103], v[64:67], v[228:231], v[100:103]
    v_mfma_f32_16x16x32_bf16 v[100:103], v[68:71], v[232:235], v[100:103]
    v_mfma_f32_16x16x32_bf16 v[100:103], v[72:75], v[236:239], v[100:103]
    s_waitcnt vmcnt(18)
    v_mfma_f32_16x16x32_bf16 v[88:91], v[76:79], a[60:63], v[88:91]
    v_mfma_f32_16x16x32_bf16 v[88:91], v[80:83], a[64:67], v[88:91]
    v_mfma_f32_16x16x32_bf16 v[120:123], v[84:87], a[68:71], v[88:91]
    v_mfma_f32_16x16x32_bf16 v[92:95], v[76:79], a[132:135], v[92:95]
    v_mfma_f32_16x16x32_bf16 v[92:95], v[80:83], a[136:139], v[92:95]
    v_mfma_f32_16x16x32_bf16 v[124:127], v[84:87], a[140:143], v[92:95]
    v_mfma_f32_16x16x32_bf16 v[96:99], v[76:79], a[204:207], v[96:99]
    s_mov_b32 s74, 268435456
    v_mfma_f32_16x16x32_bf16 v[96:99], v[80:83], a[208:211], v[96:99]
    s_add_u32 s27, s27, 1024
    v_mfma_f32_16x16x32_bf16 v[128:131], v[84:87], a[212:215], v[96:99]
    s_add_u32 s25, s25, 1
    v_mfma_f32_16x16x32_bf16 v[100:103], v[76:79], v[240:243], v[100:103]
    v_mfma_f32_16x16x32_bf16 v[100:103], v[80:83], v[244:247], v[100:103]
    s_add_u32 s23, s23, 18432
    v_mfma_f32_16x16x32_bf16 v[132:135], v[84:87], v[248:251], v[100:103]
    s_nop 7
    v_cvt_pk_bf16_f32 v152, v120, v121
    v_cvt_pk_bf16_f32 v153, v122, v123
    v_cvt_pk_bf16_f32 v154, v124, v125
    v_cvt_pk_bf16_f32 v155, v126, v127
    v_cvt_pk_bf16_f32 v156, v128, v129
    v_cvt_pk_bf16_f32 v157, v130, v131
    v_cvt_pk_bf16_f32 v158, v132, v133
    v_cvt_pk_bf16_f32 v159, v134, v135
    s_nop 0
    v_permlane16_swap_b32 v152, v154
    v_permlane16_swap_b32 v153, v155
    buffer_store_dwordx4 v[152:155], v178, s[72:75], s27 offen sc1
    s_nop 0
    v_permlane16_swap_b32 v156, v158
    v_permlane16_swap_b32 v157, v159
    buffer_store_dwordx4 v[156:159], v179, s[72:75], s27 offen sc1
    ds_write_b128 v216, v[152:155]
    ds_write_b128 v217, v[156:159]
    s_waitcnt lgkmcnt(0)
    v_lshlrev_b32 v15, 7, v0
    s_lshl_b32 s6, s40, 2
    s_add_u32 s6, s6, s44
    s_add_u32 s6, s6, 65536
    v_mov_b32 v1, s76
    s_mov_b64 vcc, 0xff
    s_waitcnt vmcnt(0)
    s_barrier
    s_cmp_lg_u32 s3, 0
    s_cbranch_scc1 L_pub_40
    s_mov_b64 exec, vcc
    buffer_store_dword v1, v15, s[8:11], s6 offen sc1
L_pub_40:
    s_mov_b64 exec, -1
    s_add_u32 s19, s18, s43
    s_add_u32 s22, s19, 45875200
    s_lshl_b32 s23, s21, 5
    s_add_u32 s23, s23, s43
    s_add_u32 s23, s23, 48431104
    v_and_b32 v12, 7, v0
    v_lshlrev_b32 v12, 2, v12
    buffer_load_dword v10, v12, s[8:11], s23 offen sc1
    buffer_load_dwordx4 v[92:95], v172, s[8:11], s22 offen sc1
    buffer_load_dwordx4 v[96:99], v173, s[8:11], s22 offen sc1
    buffer_load_dwordx4 v[100:103], v174, s[8:11], s22 offen sc1
    v_min_u32 v13, 9216, v173
    ds_read_b128 v[148:151], v172 offset:4096
    ds_read_b128 v[152:155], v13 offset:4096
    ds_read_b128 v[156:159], v174 offset:4096
    s_lshl_b32 s28, s40, 2
    s_add_u32 s28, s28, s3
    s_mul_i32 s28, s28, 73728
    s_mul_i32 s7, s42, 1073741824
    v_add_u32 v3, s7, v253
    v_lshlrev_b32 v16, 16, v104
    v_and_b32 v17, s16, v104
    v_lshlrev_b32 v18, 16, v105
    v_and_b32 v19, s16, v105
    v_lshlrev_b32 v20, 16, v106
    v_and_b32 v21, s16, v106
    v_lshlrev_b32 v22, 16, v107
    v_and_b32 v23, s16, v107
    v_lshlrev_b32 v24, 16, v108
    v_and_b32 v25, s16, v108
    v_lshlrev_b32 v26, 16, v109
    v_and_b32 v27, s16, v109
    v_lshlrev_b32 v28, 16, v110
    v_and_b32 v29, s16, v110
    v_lshlrev_b32 v30, 16, v111
    v_and_b32 v31, s16, v111
    s_cmp_lg_u32 s42, 0
    s_cbranch_scc1 L_nopf_41
    buffer_load_dwordx4 a[0:3], v3, s[8:11], s28 offen offset:0 sc1
    buffer_load_dwordx4 a[4:7], v3, s[8:11], s28 offen offset:1024 sc1
    buffer_load_dwordx4 a[8:11], v3, s[8:11], s28 offen offset:2048 sc1
    buffer_load_dwordx4 a[12:15], v3, s[8:11], s28 offen offset:3072 sc1
    s_add_u32 s28, s28, 4096
    buffer_load_dwordx4 a[16:19], v3, s[8:11], s28 offen offset:0 sc1
    buffer_load_dwordx4 a[20:23], v3, s[8:11], s28 offen offset:1024 sc1
    buffer_load_dwordx4 a[24:27], v3, s[8:11], s28 offen offset:2048 sc1
    buffer_load_dwordx4 a[28:31], v3, s[8:11], s28 offen offset:3072 sc1
L_nopf_41:
    v_lshlrev_b32 v40, 16, v112
    v_and_b32 v41, s16, v112
    v_lshlrev_b32 v42, 16, v113
    v_and_b32 v43, s16, v113
    v_lshlrev_b32 v44, 16, v114
    v_and_b32 v45, s16, v114
    v_lshlrev_b32 v46, 16, v115
    v_and_b32 v47, s16, v115
    v_pk_add_f32 v[16:17], v[16:17], v[40:41]
    v_pk_add_f32 v[18:19], v[18:19], v[42:43]
    v_pk_add_f32 v[20:21], v[20:21], v[44:45]
    v_pk_add_f32 v[22:23], v[22:23], v[46:47]
    v_lshlrev_b32 v40, 16, v116
    v_and_b32 v41, s16, v116
    v_lshlrev_b32 v42, 16, v117
    v_and_b32 v43, s16, v117
    v_lshlrev_b32 v44, 16, v118
    v_and_b32 v45, s16, v118
    v_lshlrev_b32 v46, 16, v119
    v_and_b32 v47, s16, v119
    v_pk_add_f32 v[24:25], v[24:25], v[40:41]
    v_pk_add_f32 v[26:27], v[26:27], v[42:43]
    v_pk_add_f32 v[28:29], v[28:29], v[44:45]
    v_pk_add_f32 v[30:31], v[30:31], v[46:47]
    s_cmp_lg_u32 s42, 0
    s_cbranch_scc1 L_nopf_42
    s_add_u32 s28, s28, 4096
    buffer_load_dwordx4 a[32:35], v3, s[8:11], s28 offen offset:0 sc1
    buffer_load_dwordx4 a[36:39], v3, s[8:11], s28 offen offset:1024 sc1
    buffer_load_dwordx4 a[40:43], v3, s[8:11], s28 offen offset:2048 sc1
    buffer_load_dwordx4 a[44:47], v3, s[8:11], s28 offen offset:3072 sc1
    s_add_u32 s28, s28, 4096
    buffer_load_dwordx4 a[48:51], v3, s[8:11], s28 offen offset:0 sc1
    buffer_load_dwordx4 a[52:55], v3, s[8:11], s28 offen offset:1024 sc1
    buffer_load_dwordx4 a[56:59], v3, s[8:11], s28 offen offset:2048 sc1
    buffer_load_dwordx4 a[60:63], v3, s[8:11], s28 offen offset:3072 sc1
L_nopf_42:
    v_lshlrev_b32 v40, 16, v180
    v_and_b32 v41, s16, v180
    v_lshlrev_b32 v42, 16, v181
    v_and_b32 v43, s16, v181
    v_lshlrev_b32 v44, 16, v182
    v_and_b32 v45, s16, v182
    v_lshlrev_b32 v46, 16, v183
    v_and_b32 v47, s16, v183
    v_pk_add_f32 v[16:17], v[16:17], v[40:41]
    v_pk_add_f32 v[18:19], v[18:19], v[42:43]
    v_pk_add_f32 v[20:21], v[20:21], v[44:45]
    v_pk_add_f32 v[22:23], v[22:23], v[46:47]
    v_lshlrev_b32 v40, 16, v196
    v_and_b32 v41, s16, v196
    v_lshlrev_b32 v42, 16, v197
    v_and_b32 v43, s16, v197
    v_lshlrev_b32 v44, 16, v198
    v_and_b32 v45, s16, v198
    v_lshlrev_b32 v46, 16, v199
    v_and_b32 v47, s16, v199
    v_pk_add_f32 v[24:25], v[24:25], v[40:41]
    v_pk_add_f32 v[26:27], v[26:27], v[42:43]
    v_pk_add_f32 v[28:29], v[28:29], v[44:45]
    v_pk_add_f32 v[30:31], v[30:31], v[46:47]
    v_lshlrev_b32 v40, 16, v200
    v_and_b32 v41, s16, v200
    v_lshlrev_b32 v42, 16, v201
    v_and_b32 v43, s16, v201
    v_lshlrev_b32 v44, 16, v202
    v_and_b32 v45, s16, v202
    v_lshlrev_b32 v46, 16, v203
    v_and_b32 v47, s16, v203
    v_pk_add_f32 v[16:17], v[16:17], v[40:41]
    v_pk_add_f32 v[18:19], v[18:19], v[42:43]
    v_pk_add_f32 v[20:21], v[20:21], v[44:45]
    v_pk_add_f32 v[22:23], v[22:23], v[46:47]
    v_lshlrev_b32 v40, 16, v204
    v_and_b32 v41, s16, v204
    v_lshlrev_b32 v42, 16, v205
    v_and_b32 v43, s16, v205
    v_lshlrev_b32 v44, 16, v206
    v_and_b32 v45, s16, v206
    v_lshlrev_b32 v46, 16, v207
    v_and_b32 v47, s16, v207
    v_pk_add_f32 v[24:25], v[24:25], v[40:41]
    v_pk_add_f32 v[26:27], v[26:27], v[42:43]
    v_pk_add_f32 v[28:29], v[28:29], v[44:45]
    v_pk_add_f32 v[30:31], v[30:31], v[46:47]
    s_cmp_lg_u32 s3, 3
    s_cbranch_scc1 L_pollout_45
    s_lshl_b32 s7, s40, 7
    s_add_u32 s7, s7, s44
    s_add_u32 s7, s7, 65536
    s_add_u32 s52, s4, s7
    s_addc_u32 s53, s5, 0
    s_mov_b32 s6, 0
L_poll_43:
    s_load_dwordx8 s[56:63], s[52:53], 0 glc
    s_add_u32 s6, s6, 1
    s_waitcnt lgkmcnt(0)
    s_xor_b64 s[56:57], s[56:57], s[76:77]
    s_xor_b64 s[58:59], s[58:59], s[76:77]
    s_xor_b64 s[60:61], s[60:61], s[76:77]
    s_xor_b64 s[62:63], s[62:63], s[76:77]
    s_or_b64 s[56:57], s[56:57], s[58:59]
    s_or_b64 s[60:61], s[60:61], s[62:63]
    s_or_b64 s[56:57], s[56:57], s[60:61]
    s_cbranch_scc0 L_polled_44
    s_cmp_lt_u32 s6, 1048576
    s_cbranch_scc1 L_poll_43
    s_branch L_main_end
L_polled_44:
L_pollout_45:
    s_barrier
    s_add_u32 s7, s40, 1
    s_and_b32 s7, s7, 7
    s_mul_i32 s7, s7, 9216
    s_add_u32 s19, s7, s20
    buffer_load_dwordx4 v[60:63], v174, s[8:11], s19 offen sc1
    s_add_u32 s7, s40, 2
    s_and_b32 s7, s7, 7
    s_mul_i32 s7, s7, 9216
    s_add_u32 s19, s7, s20
    buffer_load_dwordx4 v[64:67], v174, s[8:11], s19 offen sc1
    s_add_u32 s7, s40, 3
    s_and_b32 s7, s7, 7
    s_mul_i32 s7, s7, 9216
    s_add_u32 s19, s7, s20
    buffer_load_dwordx4 v[68:71], v174, s[8:11], s19 offen sc1
    s_add_u32 s7, s40, 4
    s_and_b32 s7, s7, 7
    s_mul_i32 s7, s7, 9216
    s_add_u32 s19, s7, s20
    buffer_load_dwordx4 v[72:75], v174, s[8:11], s19 offen sc1
    s_add_u32 s7, s40, 5
    s_and_b32 s7, s7, 7
    s_mul_i32 s7, s7, 9216
    s_add_u32 s19, s7, s20
    buffer_load_dwordx4 v[76:79], v174, s[8:11], s19 offen sc1
    s_add_u32 s7, s40, 6
    s_and_b32 s7, s7, 7
    s_mul_i32 s7, s7, 9216
    s_add_u32 s19, s7, s20
    buffer_load_dwordx4 v[80:83], v174, s[8:11], s19 offen sc1
    s_add_u32 s7, s40, 7
    s_and_b32 s7, s7, 7
    s_mul_i32 s7, s7, 9216
    s_add_u32 s19, s7, s20
    buffer_load_dwordx4 v[84:87], v174, s[8:11], s19 offen sc1
    v_lshlrev_b32 v40, 16, v208
    v_and_b32 v41, s16, v208
    v_lshlrev_b32 v42, 16, v209
    v_and_b32 v43, s16, v209
    v_lshlrev_b32 v44, 16, v210
    v_and_b32 v45, s16, v210
    v_lshlrev_b32 v46, 16, v211
    v_and_b32 v47, s16, v211
    v_pk_add_f32 v[16:17], v[16:17], v[40:41]
    v_pk_add_f32 v[18:19], v[18:19], v[42:43]
    v_pk_add_f32 v[20:21], v[20:21], v[44:45]
    v_pk_add_f32 v[22:23], v[22:23], v[46:47]
    v_lshlrev_b32 v40, 16, v212
    v_and_b32 v41, s16, v212
    v_lshlrev_b32 v42, 16, v213
    v_and_b32 v43, s16, v213
    v_lshlrev_b32 v44, 16, v214
    v_and_b32 v45, s16, v214
    v_lshlrev_b32 v46, 16, v215
    v_and_b32 v47, s16, v215
    v_pk_add_f32 v[24:25], v[24:25], v[40:41]
    v_pk_add_f32 v[26:27], v[26:27], v[42:43]
    v_pk_add_f32 v[28:29], v[28:29], v[44:45]
    v_pk_add_f32 v[30:31], v[30:31], v[46:47]
    v_lshlrev_b32 v40, 16, v136
    v_and_b32 v41, s16, v136
    v_lshlrev_b32 v42, 16, v137
    v_and_b32 v43, s16, v137
    v_lshlrev_b32 v44, 16, v138
    v_and_b32 v45, s16, v138
    v_lshlrev_b32 v46, 16, v139
    v_and_b32 v47, s16, v139
    v_pk_add_f32 v[16:17], v[16:17], v[40:41]
    v_pk_add_f32 v[18:19], v[18:19], v[42:43]
    v_pk_add_f32 v[20:21], v[20:21], v[44:45]
    v_pk_add_f32 v[22:23], v[22:23], v[46:47]
    v_lshlrev_b32 v40, 16, v140
    v_and_b32 v41, s16, v140
    v_lshlrev_b32 v42, 16, v141
    v_and_b32 v43, s16, v141
    v_lshlrev_b32 v44, 16, v142
    v_and_b32 v45, s16, v142
    v_lshlrev_b32 v46, 16, v143
    v_and_b32 v47, s16, v143
    v_pk_add_f32 v[24:25], v[24:25], v[40:41]
    v_pk_add_f32 v[26:27], v[26:27], v[42:43]
    v_pk_add_f32 v[28:29], v[28:29], v[44:45]
    v_pk_add_f32 v[30:31], v[30:31], v[46:47]
    v_lshlrev_b32 v40, 16, v144
    v_and_b32 v41, s16, v144
    v_lshlrev_b32 v42, 16, v145
    v_and_b32 v43, s16, v145
    v_lshlrev_b32 v44, 16, v146
    v_and_b32 v45, s16, v146
    v_lshlrev_b32 v46, 16, v147
    v_and_b32 v47, s16, v147
    v_pk_add_f32 v[16:17], v[16:17], v[40:41]
    v_pk_add_f32 v[18:19], v[18:19], v[42:43]
    v_pk_add_f32 v[20:21], v[20:21], v[44:45]
    v_pk_add_f32 v[22:23], v[22:23], v[46:47]
    v_lshlrev_b32 v40, 16, v160
    v_and_b32 v41, s16, v160
    v_lshlrev_b32 v42, 16, v161
    v_and_b32 v43, s16, v161
    v_lshlrev_b32 v44, 16, v162
    v_and_b32 v45, s16, v162
    v_lshlrev_b32 v46, 16, v163
    v_and_b32 v47, s16, v163
    v_pk_add_f32 v[24:25], v[24:25], v[40:41]
    v_pk_add_f32 v[26:27], v[26:27], v[42:43]
    v_pk_add_f32 v[28:29], v[28:29], v[44:45]
    v_pk_add_f32 v[30:31], v[30:31], v[46:47]
    s_cmp_eq_u32 s3, 0
    s_cselect_b32 s7, 1.0, 0
    s_cselect_b32 s6, -1, 0
    s_waitcnt vmcnt(7) lgkmcnt(0)
    v_and_b32 v152, s6, v152
    v_and_b32 v153, s6, v153
    v_and_b32 v154, s6, v154
    v_and_b32 v155, s6, v155
    v_mul_f32 v11, s7, v10
    v_lshlrev_b32 v40, 16, v92
    v_and_b32 v41, s16, v92
    v_lshlrev_b32 v42, 16, v93
    v_and_b32 v43, s16, v93
    v_lshlrev_b32 v44, 16, v94
    v_and_b32 v45, s16, v94
    v_lshlrev_b32 v46, 16, v95
    v_and_b32 v47, s16, v95
    v_pk_add_f32 v[16:17], v[16:17], v[40:41]
    v_pk_add_f32 v[18:19], v[18:19], v[42:43]
    v_pk_add_f32 v[20:21], v[20:21], v[44:45]
    v_pk_add_f32 v[22:23], v[22:23], v[46:47]
    v_lshlrev_b32 v40, 16, v96
    v_and_b32 v41, s16, v96
    v_lshlrev_b32 v42, 16, v97
    v_and_b32 v43, s16, v97
    v_lshlrev_b32 v44, 16, v98
    v_and_b32 v45, s16, v98
    v_lshlrev_b32 v46, 16, v99
    v_and_b32 v47, s16, v99
    v_pk_add_f32 v[24:25], v[24:25], v[40:41]
    v_pk_add_f32 v[26:27], v[26:27], v[42:43]
    v_pk_add_f32 v[28:29], v[28:29], v[44:45]
    v_pk_add_f32 v[30:31], v[30:31], v[46:47]
    v_lshlrev_b32 v32, 16, v100
    v_and_b32 v33, s16, v100
    v_lshlrev_b32 v34, 16, v101
    v_and_b32 v35, s16, v101
    v_lshlrev_b32 v36, 16, v102
    v_and_b32 v37, s16, v102
    v_lshlrev_b32 v38, 16, v103
    v_and_b32 v39, s16, v103
    v_lshlrev_b32 v40, 16, v148
    v_and_b32 v41, s16, v148
    v_lshlrev_b32 v42, 16, v149
    v_and_b32 v43, s16, v149
    v_lshlrev_b32 v44, 16, v150
    v_and_b32 v45, s16, v150
    v_lshlrev_b32 v46, 16, v151
    v_and_b32 v47, s16, v151
    v_pk_add_f32 v[16:17], v[16:17], v[40:41]
    v_pk_add_f32 v[18:19], v[18:19], v[42:43]
    v_pk_add_f32 v[20:21], v[20:21], v[44:45]
    v_pk_add_f32 v[22:23], v[22:23], v[46:47]
    v_lshlrev_b32 v40, 16, v152
    v_and_b32 v41, s16, v152
    v_lshlrev_b32 v42, 16, v153
    v_and_b32 v43, s16, v153
    v_lshlrev_b32 v44, 16, v154
    v_and_b32 v45, s16, v154
    v_lshlrev_b32 v46, 16, v155
    v_and_b32 v47, s16, v155
    v_pk_add_f32 v[24:25], v[24:25], v[40:41]
    v_pk_add_f32 v[26:27], v[26:27], v[42:43]
    v_pk_add_f32 v[28:29], v[28:29], v[44:45]
    v_pk_add_f32 v[30:31], v[30:31], v[46:47]
    v_lshlrev_b32 v40, 16, v156
    v_and_b32 v41, s16, v156
    v_lshlrev_b32 v42, 16, v157
    v_and_b32 v43, s16, v157
    v_lshlrev_b32 v44, 16, v158
    v_and_b32 v45, s16, v158
    v_lshlrev_b32 v46, 16, v159
    v_and_b32 v47, s16, v159
    v_pk_add_f32 v[32:33], v[32:33], v[40:41]
    v_pk_add_f32 v[34:35], v[34:35], v[42:43]
    v_pk_add_f32 v[36:37], v[36:37], v[44:45]
    v_pk_add_f32 v[38:39], v[38:39], v[46:47]
    v_pk_add_f32 v[16:17], v[16:17], v[10:11] op_sel_hi:[1,0]
    v_pk_add_f32 v[18:19], v[18:19], v[10:11] op_sel_hi:[1,0]
    v_pk_add_f32 v[20:21], v[20:21], v[10:11] op_sel_hi:[1,0]
    v_pk_add_f32 v[22:23], v[22:23], v[10:11] op_sel_hi:[1,0]
    v_pk_add_f32 v[24:25], v[24:25], v[10:11] op_sel:[0,1] op_sel_hi:[1,1]
    v_pk_add_f32 v[26:27], v[26:27], v[10:11] op_sel:[0,1] op_sel_hi:[1,1]
    v_pk_add_f32 v[28:29], v[28:29], v[10:11] op_sel:[0,1] op_sel_hi:[1,1]
    v_pk_add_f32 v[30:31], v[30:31], v[10:11] op_sel:[0,1] op_sel_hi:[1,1]
    v_pk_add_f32 v[32:33], v[32:33], v[10:11] op_sel_hi:[1,0]
    v_pk_add_f32 v[34:35], v[34:35], v[10:11] op_sel_hi:[1,0]
    v_pk_add_f32 v[36:37], v[36:37], v[10:11] op_sel_hi:[1,0]
    v_pk_add_f32 v[38:39], v[38:39], v[10:11] op_sel_hi:[1,0]
    s_waitcnt vmcnt(6)
    s_add_u32 s28, s28, 4096
    buffer_load_dwordx4 a[64:67], v3, s[8:11], s28 offen offset:0 sc1
    v_lshlrev_b32 v40, 16, v60
    v_and_b32 v41, s16, v60
    v_lshlrev_b32 v42, 16, v61
    v_and_b32 v43, s16, v61
    v_lshlrev_b32 v44, 16, v62
    v_and_b32 v45, s16, v62
    v_lshlrev_b32 v46, 16, v63
    v_and_b32 v47, s16, v63
    v_pk_add_f32 v[32:33], v[32:33], v[40:41]
    v_pk_add_f32 v[34:35], v[34:35], v[42:43]
    v_pk_add_f32 v[36:37], v[36:37], v[44:45]
    v_pk_add_f32 v[38:39], v[38:39], v[46:47]
    s_waitcnt vmcnt(6)
    buffer_load_dwordx4 a[68:71], v3, s[8:11], s28 offen offset:1024 sc1
    v_lshlrev_b32 v40, 16, v64
    v_and_b32 v41, s16, v64
    v_lshlrev_b32 v42, 16, v65
    v_and_b32 v43, s16, v65
    v_lshlrev_b32 v44, 16, v66
    v_and_b32 v45, s16, v66
    v_lshlrev_b32 v46, 16, v67
    v_and_b32 v47, s16, v67
    v_pk_add_f32 v[32:33], v[32:33], v[40:41]
    v_pk_add_f32 v[34:35], v[34:35], v[42:43]
    v_pk_add_f32 v[36:37], v[36:37], v[44:45]
    v_pk_add_f32 v[38:39], v[38:39], v[46:47]
    s_waitcnt vmcnt(6)
    buffer_load_dwordx4 a[72:75], v3, s[8:11], s28 offen offset:2048 sc1
    v_lshlrev_b32 v40, 16, v68
    v_and_b32 v41, s16, v68
    v_lshlrev_b32 v42, 16, v69
    v_and_b32 v43, s16, v69
    v_lshlrev_b32 v44, 16, v70
    v_and_b32 v45, s16, v70
    v_lshlrev_b32 v46, 16, v71
    v_and_b32 v47, s16, v71
    v_pk_add_f32 v[32:33], v[32:33], v[40:41]
    v_pk_add_f32 v[34:35], v[34:35], v[42:43]
    v_pk_add_f32 v[36:37], v[36:37], v[44:45]
    v_pk_add_f32 v[38:39], v[38:39], v[46:47]
    s_waitcnt vmcnt(6)
    buffer_load_dwordx4 a[76:79], v3, s[8:11], s28 offen offset:3072 sc1
    v_lshlrev_b32 v40, 16, v72
    v_and_b32 v41, s16, v72
    v_lshlrev_b32 v42, 16, v73
    v_and_b32 v43, s16, v73
    v_lshlrev_b32 v44, 16, v74
    v_and_b32 v45, s16, v74
    v_lshlrev_b32 v46, 16, v75
    v_and_b32 v47, s16, v75
    v_pk_add_f32 v[32:33], v[32:33], v[40:41]
    v_pk_add_f32 v[34:35], v[34:35], v[42:43]
    v_pk_add_f32 v[36:37], v[36:37], v[44:45]
    v_pk_add_f32 v[38:39], v[38:39], v[46:47]
    s_waitcnt vmcnt(6)
    s_add_u32 s28, s28, 4096
    buffer_load_dwordx4 a[80:83], v3, s[8:11], s28 offen offset:0 sc1
    v_lshlrev_b32 v40, 16, v76
    v_and_b32 v41, s16, v76
    v_lshlrev_b32 v42, 16, v77
    v_and_b32 v43, s16, v77
    v_lshlrev_b32 v44, 16, v78
    v_and_b32 v45, s16, v78
    v_lshlrev_b32 v46, 16, v79
    v_and_b32 v47, s16, v79
    v_pk_add_f32 v[32:33], v[32:33], v[40:41]
    v_pk_add_f32 v[34:35], v[34:35], v[42:43]
    v_pk_add_f32 v[36:37], v[36:37], v[44:45]
    v_pk_add_f32 v[38:39], v[38:39], v[46:47]
    s_waitcnt vmcnt(6)
    buffer_load_dwordx4 a[84:87], v3, s[8:11], s28 offen offset:1024 sc1
    v_lshlrev_b32 v40, 16, v80
    v_and_b32 v41, s16, v80
    v_lshlrev_b32 v42, 16, v81
    v_and_b32 v43, s16, v81
    v_lshlrev_b32 v44, 16, v82
    v_and_b32 v45, s16, v82
    v_lshlrev_b32 v46, 16, v83
    v_and_b32 v47, s16, v83
    v_pk_add_f32 v[32:33], v[32:33], v[40:41]
    v_pk_add_f32 v[34:35], v[34:35], v[42:43]
    v_pk_add_f32 v[36:37], v[36:37], v[44:45]
    v_pk_add_f32 v[38:39], v[38:39], v[46:47]
    s_waitcnt vmcnt(6)
    buffer_load_dwordx4 a[88:91], v3, s[8:11], s28 offen offset:2048 sc1
    v_lshlrev_b32 v40, 16, v84
    v_and_b32 v41, s16, v84
    v_lshlrev_b32 v42, 16, v85
    v_and_b32 v43, s16, v85
    v_lshlrev_b32 v44, 16, v86
    v_and_b32 v45, s16, v86
    v_lshlrev_b32 v46, 16, v87
    v_and_b32 v47, s16, v87
    v_pk_add_f32 v[32:33], v[32:33], v[40:41]
    v_pk_add_f32 v[34:35], v[34:35], v[42:43]
    v_pk_add_f32 v[36:37], v[36:37], v[44:45]
    v_pk_add_f32 v[38:39], v[38:39], v[46:47]
    buffer_load_dwordx4 a[92:95], v3, s[8:11], s28 offen offset:3072 sc1
    v_cvt_pk_bf16_f32 v120, v16, v17
    v_cvt_pk_bf16_f32 v121, v18, v19
    v_cvt_pk_bf16_f32 v122, v20, v21
    v_cvt_pk_bf16_f32 v123, v22, v23
    v_cvt_pk_bf16_f32 v124, v24, v25
    v_cvt_pk_bf16_f32 v125, v26, v27
    v_cvt_pk_bf16_f32 v126, v28, v29
    v_cvt_pk_bf16_f32 v127, v30, v31
    v_cvt_pk_bf16_f32 v128, v32, v33
    v_cvt_pk_bf16_f32 v129, v34, v35
    v_cvt_pk_bf16_f32 v130, v36, v37
    v_cvt_pk_bf16_f32 v131, v38, v39
    s_cmp_lg_u32 s42, 0
    s_cbranch_scc1 L_main_last
    s_add_u32 s19, s18, 43515904
    s_add_u32 s20, s18, 38797312
    s_lshl_b32 s22, s21, 7
    s_add_u32 s22, s22, 48234496
    buffer_store_dwordx4 v[120:123], v172, s[8:11], s19 offen sc1
    buffer_store_dwordx4 v[124:127], v173, s[8:11], s19 offen sc1
    buffer_store_dwordx4 v[128:131], v174, s[8:11], s19 offen sc1
    s_mov_b32 s17, 0x3f803f80
    v_mov_b32 v8, 0
    v_mov_b32 v9, 0
    v_mov_b32 v10, 0
    v_mov_b32 v11, 0
    v_dot2c_f32_bf16 v8, s17, v120
    v_dot2c_f32_bf16 v9, v120, v120
    v_dot2c_f32_bf16 v10, s17, v121
    v_dot2c_f32_bf16 v11, v121, v121
    v_dot2c_f32_bf16 v8, s17, v122
    v_dot2c_f32_bf16 v9, v122, v122
    v_dot2c_f32_bf16 v10, s17, v123
    v_dot2c_f32_bf16 v11, v123, v123
    v_dot2c_f32_bf16 v8, s17, v124
    v_dot2c_f32_bf16 v9, v124, v124
    v_dot2c_f32_bf16 v10, s17, v125
    v_dot2c_f32_bf16 v11, v125, v125
    v_dot2c_f32_bf16 v8, s17, v126
    v_dot2c_f32_bf16 v9, v126, v126
    v_dot2c_f32_bf16 v10, s17, v127
    v_dot2c_f32_bf16 v11, v127, v127
    v_dot2c_f32_bf16 v8, s17, v128
    v_dot2c_f32_bf16 v9, v128, v128
    v_dot2c_f32_bf16 v10, s17, v129
    v_dot2c_f32_bf16 v11, v129, v129
    v_dot2c_f32_bf16 v8, s17, v130
    v_dot2c_f32_bf16 v9, v130, v130
    v_dot2c_f32_bf16 v10, s17, v131
    v_dot2c_f32_bf16 v11, v131, v131
    v_and_b32 v12, 7, v0
    v_lshlrev_b32 v12, 3, v12
    s_lshl_b32 s7, s3, 6
    v_add_u32 v13, s7, v12
    v_pk_add_f32 v[8:9], v[8:9], v[10:11]
    s_nop 1
    v_add_f32_dpp v8, v8, v8 row_ror:8 row_mask:0xf bank_mask:0xf
    v_add_f32_dpp v9, v9, v9 row_ror:8 row_mask:0xf bank_mask:0xf
    v_mov_b32 v10, v8
    v_mov_b32 v11, v9
    s_nop 1
    v_permlane32_swap_b32 v10, v8
    v_permlane32_swap_b32 v11, v9
    v_add_f32 v8, v8, v10
    v_add_f32 v9, v9, v11
    v_mov_b32 v10, v8
    v_mov_b32 v11, v9
    s_nop 1
    v_permlane16_swap_b32 v10, v8
    v_permlane16_swap_b32 v11, v9
    v_add_f32 v8, v8, v10
    v_add_f32 v9, v9, v11
    ds_write_b64 v13, v[8:9]
    s_waitcnt lgkmcnt(0)
    s_barrier
    ds_read_b64 v[40:41], v12 offset:0
    ds_read_b64 v[42:43], v12 offset:64
    ds_read_b64 v[44:45], v12 offset:128
    ds_read_b64 v[46:47], v12 offset:192
    s_waitcnt lgkmcnt(0)
    v_pk_add_f32 v[40:41], v[40:41], v[42:43]
    v_pk_add_f32 v[44:45], v[44:45], v[46:47]
    v_pk_add_f32 v[8:9], v[40:41], v[44:45]
    v_mul_f32 v8, 0x3ae38e39, v8
    v_mul_f32 v9, 0x3ae38e39, v9
    v_fma_f32 v9, -v8, v8, v9
    v_max_f32 v9, 0, v9
    v_add_f32 v9, 0x3727c5ac, v9
    v_rsq_f32 v10, v9
    s_nop 0
    v_mul_f32 v12, v8, v10
    v_mov_b32 v11, v10
    v_sub_f32 v12, 0, v12
    v_mov_b32 v13, v12
    s_cmp_eq_u32 s3, 0
    s_cselect_b32 s7, 32, 0
    v_lshlrev_b32 v14, 2, v0
    v_cmp_gt_u32 vcc, s7, v0
    v_mov_b32 v9, 1073741824
    s_nop 0
    v_cndmask_b32 v14, v9, v14, vcc
    buffer_store_dword v8, v14, s[8:11], s22 offen sc1
    v_lshlrev_b32 v40, 16, v120
    v_and_b32 v41, s16, v120
    v_lshlrev_b32 v42, 16, v121
    v_and_b32 v43, s16, v121
    v_lshlrev_b32 v44, 16, v122
    v_and_b32 v45, s16, v122
    v_lshlrev_b32 v46, 16, v123
    v_and_b32 v47, s16, v123
    v_pk_fma_f32 v[40:41], v[40:41], v[10:11], v[12:13]
    v_pk_fma_f32 v[42:43], v[42:43], v[10:11], v[12:13]
    v_pk_fma_f32 v[44:45], v[44:45], v[10:11], v[12:13]
    v_pk_fma_f32 v[46:47], v[46:47], v[10:11], v[12:13]
    v_cvt_pk_bf16_f32 v48, v40, v41
    v_cvt_pk_bf16_f32 v49, v42, v43
    v_cvt_pk_bf16_f32 v50, v44, v45
    v_cvt_pk_bf16_f32 v51, v46, v47
    v_lshlrev_b32 v40, 16, v124
    v_and_b32 v41, s16, v124
    v_lshlrev_b32 v42, 16, v125
    v_and_b32 v43, s16, v125
    v_lshlrev_b32 v44, 16, v126
    v_and_b32 v45, s16, v126
    v_lshlrev_b32 v46, 16, v127
    v_and_b32 v47, s16, v127
    v_pk_fma_f32 v[40:41], v[40:41], v[10:11], v[12:13]
    v_pk_fma_f32 v[42:43], v[42:43], v[10:11], v[12:13]
    v_pk_fma_f32 v[44:45], v[44:45], v[10:11], v[12:13]
    v_pk_fma_f32 v[46:47], v[46:47], v[10:11], v[12:13]
    v_cvt_pk_bf16_f32 v52, v40, v41
    v_cvt_pk_bf16_f32 v53, v42, v43
    v_cvt_pk_bf16_f32 v54, v44, v45
    v_cvt_pk_bf16_f32 v55, v46, v47
    v_lshlrev_b32 v40, 16, v128
    v_and_b32 v41, s16, v128
    v_lshlrev_b32 v42, 16, v129
    v_and_b32 v43, s16, v129
    v_lshlrev_b32 v44, 16, v130
    v_and_b32 v45, s16, v130
    v_lshlrev_b32 v46, 16, v131
    v_and_b32 v47, s16, v131
    v_pk_fma_f32 v[40:41], v[40:41], v[10:11], v[12:13]
    v_pk_fma_f32 v[42:43], v[42:43], v[10:11], v[12:13]
    v_pk_fma_f32 v[44:45], v[44:45], v[10:11], v[12:13]
    v_pk_fma_f32 v[46:47], v[46:47], v[10:11], v[12:13]
    v_cvt_pk_bf16_f32 v56, v40, v41
    v_cvt_pk_bf16_f32 v57, v42, v43
    v_cvt_pk_bf16_f32 v58, v44, v45
    v_cvt_pk_bf16_f32 v59, v46, v47
    buffer_store_dwordx4 v[48:51], v172, s[8:11], s20 offen sc1
    buffer_store_dwordx4 v[52:55], v173, s[8:11], s20 offen sc1
    buffer_store_dwordx4 v[56:59], v174, s[8:11], s20 offen sc1
    v_lshlrev_b32 v15, 7, v0
    s_lshl_b32 s6, s40, 2
    s_add_u32 s6, s6, s44
    s_add_u32 s6, s6, 98304
    v_mov_b32 v1, s76
    s_mov_b64 vcc, 0xff
    v_lshrrev_b32 v14, 3, v0
    v_lshl_add_u32 v15, v14, 3, v15
    s_cmp_ge_u32 s40, 6
    s_cselect_b32 s7, s41, 31
    s_cmp_lt_u32 s7, 31
    s_cmov_b64 vcc, 0xffff
    s_waitcnt vmcnt(0)
    s_barrier
    s_cmp_lg_u32 s3, 0
    s_cbranch_scc1 L_pub_46
    s_mov_b64 exec, vcc
    buffer_store_dword v1, v15, s[8:11], s6 offen sc1
L_pub_46:
    s_mov_b64 exec, -1
    s_add_u32 s28, s28, 4096
    buffer_load_dwordx4 a[96:99], v3, s[8:11], s28 offen offset:0 sc1
    buffer_load_dwordx4 a[100:103], v3, s[8:11], s28 offen offset:1024 sc1
    buffer_load_dwordx4 a[104:107], v3, s[8:11], s28 offen offset:2048 sc1
    buffer_load_dwordx4 a[108:111], v3, s[8:11], s28 offen offset:3072 sc1
    s_add_u32 s28, s28, 4096
    buffer_load_dwordx4 a[112:115], v3, s[8:11], s28 offen offset:0 sc1
    buffer_load_dwordx4 a[116:119], v3, s[8:11], s28 offen offset:1024 sc1
    buffer_load_dwordx4 a[120:123], v3, s[8:11], s28 offen offset:2048 sc1
    buffer_load_dwordx4 a[124:127], v3, s[8:11], s28 offen offset:3072 sc1
    s_add_u32 s28, s28, 4096
    buffer_load_dwordx4 a[128:131], v3, s[8:11], s28 offen offset:0 sc1
    buffer_load_dwordx4 a[132:135], v3, s[8:11], s28 offen offset:1024 sc1
    buffer_load_dwordx4 a[136:139], v3, s[8:11], s28 offen offset:2048 sc1
    buffer_load_dwordx4 a[140:143], v3, s[8:11], s28 offen offset:3072 sc1
    s_add_u32 s28, s28, 4096
    s_mov_b32 s42, 1
    s_mov_b32 s43, 0
    s_add_u32 s44, s44, 131072
    s_mov_b32 s74, 0
    s_branch L_main_layer
L_main_last:
    buffer_store_dwordx4 v[120:123], v175, s[12:15], s18 offen sc0 sc1
    buffer_store_dwordx4 v[124:127], v176, s[12:15], s18 offen sc0 sc1
    buffer_store_dwordx4 v[128:131], v177, s[12:15], s18 offen sc0 sc1
    s_or_b32 s7, s40, s41
    s_or_b32 s7, s7, s3
    s_cbranch_scc1 L_done_47
    v_mov_b32 v1, s76
    s_mov_b32 s7, 19660800
    s_mov_b64 exec, 1
    buffer_store_dword v1, off, s[8:11], s7 sc1
    s_mov_b64 exec, -1
L_done_47:
L_main_end:
    s_endpgm
L_main_code_end:
.section .rodata,"a"
.p2align 6
.amdhsa_kernel interleave_layers__sliding_local_dilated__glu_gated_geglu__prompt_kernel
.amdhsa_next_free_vgpr 512
.amdhsa_next_free_sgpr 102
.amdhsa_accum_offset 256
.amdhsa_group_segment_fixed_size 0
.amdhsa_kernarg_size 80
.amdhsa_user_sgpr_count 2
.amdhsa_user_sgpr_kernarg_segment_ptr 1
.amdhsa_system_sgpr_workgroup_id_x 1
.amdhsa_float_denorm_mode_32 3
.amdhsa_float_denorm_mode_16_64 3
.end_amdhsa_kernel
```

```asm
; @launch grid=(256,1,1) block=(256,1,1) lds=163840
.amdgcn_target "amdgcn-amd-amdhsa--gfx950"
.text
.globl interleave_layers__sliding_local_dilated__glu_gated_geglu__prompt_kernel
.p2align 8
.type interleave_layers__sliding_local_dilated__glu_gated_geglu__prompt_kernel,@function
interleave_layers__sliding_local_dilated__glu_gated_geglu__prompt_kernel:
    s_cmp_ge_u32 s2, 256
    s_cbranch_scc1 L_main_end
    s_load_dwordx2 s[4:5], s[0:1], 72
    s_load_dwordx4 s[16:19], s[0:1], 0
    s_load_dwordx2 s[22:23], s[0:1], 16
    s_load_dwordx8 s[24:31], s[0:1], 32
    s_getpc_b64 s[96:97]
L_main_pc:
    s_sub_u32 s96, s96, L_main_pc-interleave_layers__sliding_local_dilated__glu_gated_geglu__prompt_kernel
    s_subb_u32 s97, s97, 0
    s_and_b32 s97, s97, 0xffff
    s_mov_b32 s98, L_main_code_end-interleave_layers__sliding_local_dilated__glu_gated_geglu__prompt_kernel
    s_mov_b32 s99, 0x20000
    s_lshr_b32 s7, s2, 3
    s_lshl_b32 s7, s7, 11
    v_lshl_add_u32 v253, v0, 3, s7
    buffer_load_dwordx2 v[2:3], v253, s[96:99], 0 offen
    v_lshrrev_b32 v1, 6, v0
    v_and_b32 v0, 63, v0
    v_readfirstlane_b32 s3, v1
    s_waitcnt lgkmcnt(0)
    s_mov_b32 s8, s4
    s_and_b32 s9, s5, 0xffff
    s_mov_b32 s10, 268435456
    s_mov_b32 s11, 0x20000
    s_mov_b32 s7, 19660800
    s_load_dword s76, s[4:5], s7
    s_mov_b64 s[20:21], s[18:19]
    s_mov_b64 s[18:19], s[16:17]
    s_mov_b32 s48, s4
    s_and_b32 s49, s5, 0xffff
    s_mov_b32 s50, 268435456
    s_mov_b32 s51, 0x20000
    s_and_b32 s40, s2, 3
    s_lshl_b32 s40, s40, 1
    s_bfe_u32 s7, s2, 65539
    s_add_u32 s40, s40, s7
    s_bfe_u32 s41, s2, 65538
    s_lshl_b32 s41, s41, 4
    s_lshr_b32 s7, s2, 4
    s_add_u32 s41, s41, s7
    s_mov_b32 s42, 0
    s_mov_b32 s43, 0
    s_lshl_b32 s44, s41, 10
    s_add_u32 s44, s44, 19169280
    v_lshlrev_b32 v253, 4, v0
    s_mov_b32 s12, s18
    s_and_b32 s13, s19, 0xffff
    s_mov_b32 s14, 2359296
    s_mov_b32 s15, 0x20000
    s_mov_b32 s64, s20
    s_and_b32 s65, s21, 0xffff
    s_mov_b32 s66, 1990656
    s_mov_b32 s67, 0x20000
    s_mov_b32 s68, s22
    s_and_b32 s69, s23, 0xffff
    s_mov_b32 s70, 663552
    s_mov_b32 s71, 0x20000
    s_mov_b32 s16, 0xffff0000
    s_lshl_b32 s7, s3, 10
    v_add_u32 v172, s7, v253
    v_add_u32 v174, 5120, v172
    v_and_b32 v178, 7, v0
    v_mul_u32_u24 v178, 1152, v178
    v_lshrrev_b32 v179, 3, v0
    v_lshl_add_u32 v178, v179, 4, v178
    s_lshl_b32 s7, s3, 7
    v_add_u32 v175, s7, v178
    v_add_u32 v177, 640, v175
    s_cmp_eq_u32 s3, 0
    s_mov_b32 s17, 1073741824
    s_cmov_b32 s17, 4096
    v_add_u32 v173, s17, v172
    s_mov_b32 s17, 1073741824
    s_cmov_b32 s17, 512
    v_add_u32 v176, s17, v175
    s_lshl_b32 s21, s41, 3
    s_add_u32 s21, s21, s40
    s_mul_i32 s18, s21, 9216
    buffer_load_dwordx4 v[16:19], v175, s[12:15], s18 offen nt
    buffer_load_dwordx4 v[20:23], v176, s[12:15], s18 offen nt
    buffer_load_dwordx4 v[24:27], v177, s[12:15], s18 offen nt
    s_mov_b32 s12, s30
    s_and_b32 s13, s31, 0xffff
    s_mov_b32 s14, 2359296
    s_mov_b32 s15, 0x20000
    s_lshl_b32 s79, s3, 14
    s_add_u32 s79, s79, 98304
    s_sub_u32 s36, s21, 144
    s_cmp_ge_u32 s41, 18
    s_cbranch_scc1 L_prep_o_1
    s_mul_i32 s35, s41, 110592
    s_mul_i32 s7, s40, 144
    s_and_b32 s46, s7, 127
    s_sub_u32 s7, s7, s46
    s_add_u32 s35, s35, s7
    s_mul_i32 s7, s3, 13824
    s_add_u32 s35, s35, s7
    v_lshrrev_b32 v8, 4, v0
    v_mul_u32_u24 v8, 3456, v8
    v_and_b32 v9, 15, v0
    v_lshl_add_u32 v8, v9, 4, v8
    s_lshl_b32 s34, s3, 10
    s_add_u32 m0, s34, 8192
    s_add_u32 s7, s35, 0
    buffer_load_dwordx4 v8, s[64:67], s7 offen nt lds
    s_add_u32 m0, s34, 12288
    s_add_u32 s7, s35, 55296
    buffer_load_dwordx4 v8, s[64:67], s7 offen nt lds
    s_add_u32 m0, s34, 16384
    s_add_u32 s7, s35, 1152
    buffer_load_dwordx4 v8, s[64:67], s7 offen nt lds
    s_add_u32 m0, s34, 20480
    s_add_u32 s7, s35, 56448
    buffer_load_dwordx4 v8, s[64:67], s7 offen nt lds
    s_add_u32 m0, s34, 24576
    s_add_u32 s7, s35, 2304
    buffer_load_dwordx4 v8, s[64:67], s7 offen nt lds
    s_add_u32 m0, s34, 28672
    s_add_u32 s7, s35, 57600
    buffer_load_dwordx4 v8, s[64:67], s7 offen nt lds
    s_branch L_prep_go_3
L_prep_o_1:
    s_cmp_ge_u32 s36, 54
    s_cbranch_scc1 L_prep_m_2
    s_mul_i32 s33, s36, 349526
    s_lshr_b32 s33, s33, 20
    s_mul_i32 s34, s33, 3
    s_sub_u32 s34, s36, s34
    s_lshl_b32 s7, s33, 2
    s_add_u32 s7, s7, s3
    v_mov_b32 v8, s7
    v_lshrrev_b32 v9, 3, v0
    v_mul_u32_u24 v11, 7282, v8
    v_lshrrev_b32 v11, 16, v11
    v_mul_u32_u24 v12, 9, v11
    v_sub_u32 v12, v8, v12
    v_mul_u32_u24 v11, 72, v11
    v_cmp_eq_u32 vcc, 8, v12
    v_lshrrev_b32 v10, 1, v12
    v_mad_u32_u24 v10, v10, 18, v11
    v_and_b32 v12, 1, v12
    v_lshl_add_u32 v10, v12, 3, v10
    v_add_u32 v10, v10, v9
    v_lshrrev_b32 v12, 1, v9
    v_mad_u32_u24 v11, v12, 18, v11
    v_and_b32 v12, 1, v9
    v_add3_u32 v11, v11, v12, 16
    v_cndmask_b32 v10, v10, v11, vcc
    v_mul_u32_u24 v10, 1152, v10
    v_and_b32 v9, 7, v0
    v_lshl_add_u32 v10, v9, 4, v10
    s_mul_i32 s35, s34, 384
    s_lshl_b32 s6, s3, 10
    s_add_u32 m0, s6, 8192
    s_add_u32 s7, s35, 0
    buffer_load_dwordx4 v10, s[68:71], s7 offen nt lds
    s_add_u32 m0, s6, 12288
    s_add_u32 s7, s35, 128
    buffer_load_dwordx4 v10, s[68:71], s7 offen nt lds
    s_add_u32 m0, s6, 16384
    s_add_u32 s7, s35, 256
    buffer_load_dwordx4 v10, s[68:71], s7 offen nt lds
    s_branch L_prep_go_3
L_prep_m_2:
    s_sub_u32 s37, s36, 54
    s_lshl_b32 s7, s3, 6
    s_add_u32 s37, s37, s7
    s_cmp_ge_u32 s37, 36
    s_cbranch_scc1 L_prep_go_3
    s_lshl_b32 s7, s37, 1
    v_bfe_u32 v8, v0, 3, 1
    v_add_u32 v8, s7, v8
    v_and_b32 v9, 7, v0
    v_mul_u32_u24 v11, 7282, v8
    v_lshrrev_b32 v11, 16, v11
    v_mul_u32_u24 v12, 9, v11
    v_sub_u32 v12, v8, v12
    v_mul_u32_u24 v11, 72, v11
    v_cmp_eq_u32 vcc, 8, v12
    v_lshrrev_b32 v10, 1, v12
    v_mad_u32_u24 v10, v10, 18, v11
    v_and_b32 v12, 1, v12
    v_lshl_add_u32 v10, v12, 3, v10
    v_add_u32 v10, v10, v9
    v_lshrrev_b32 v12, 1, v9
    v_mad_u32_u24 v11, v12, 18, v11
    v_and_b32 v12, 1, v9
    v_add3_u32 v11, v11, v12, 16
    v_cndmask_b32 v10, v10, v11, vcc
    v_mul_u32_u24 v10, 1152, v10
    v_lshrrev_b32 v9, 4, v0
    v_lshl_add_u32 v10, v9, 4, v10
    buffer_load_dwordx4 v[64:67], v10, s[68:71], 0 offen offset:0
    buffer_load_dwordx4 v[68:71], v10, s[68:71], 0 offen offset:64
    buffer_load_dwordx4 v[72:75], v10, s[68:71], 0 offen offset:128
    buffer_load_dwordx4 v[76:79], v10, s[68:71], 0 offen offset:192
    buffer_load_dwordx4 v[80:83], v10, s[68:71], 0 offen offset:256
    buffer_load_dwordx4 v[84:87], v10, s[68:71], 0 offen offset:320
    buffer_load_dwordx4 v[88:91], v10, s[68:71], 0 offen offset:384
    buffer_load_dwordx4 v[92:95], v10, s[68:71], 0 offen offset:448
    buffer_load_dwordx4 v[96:99], v10, s[68:71], 0 offen offset:512
    buffer_load_dwordx4 v[100:103], v10, s[68:71], 0 offen offset:576
    buffer_load_dwordx4 v[104:107], v10, s[68:71], 0 offen offset:640
    buffer_load_dwordx4 v[108:111], v10, s[68:71], 0 offen offset:704
    buffer_load_dwordx4 v[112:115], v10, s[68:71], 0 offen offset:768
    buffer_load_dwordx4 v[116:119], v10, s[68:71], 0 offen offset:832
    buffer_load_dwordx4 v[120:123], v10, s[68:71], 0 offen offset:896
    buffer_load_dwordx4 v[124:127], v10, s[68:71], 0 offen offset:960
    buffer_load_dwordx4 v[128:131], v10, s[68:71], 0 offen offset:1024
    buffer_load_dwordx4 v[132:135], v10, s[68:71], 0 offen offset:1088
L_prep_go_3:
    s_lshl_b32 s7, s41, 2
    s_add_u32 s7, s7, s3
    s_mul_i32 s93, s7, 25576
    s_lshr_b32 s93, s93, 20
    s_min_u32 s93, s93, 2
    s_mul_i32 s6, s93, 41
    s_sub_u32 s7, s7, s6
    s_lshl_b32 s17, s7, 2
    s_cmp_eq_u32 s93, 1
    s_cselect_b32 s72, s26, s24
    s_cselect_b32 s73, s27, s25
    s_cmp_eq_u32 s93, 2
    s_cselect_b32 s72, s28, s72
    s_cselect_b32 s73, s29, s73
    s_mov_b32 s92, 73728
    s_cmov_b32 s92, 9216
    s_mov_b32 s47, 1152
    s_cmov_b32 s47, 663552
    s_and_b32 s73, s73, 0xffff
    s_mov_b32 s74, 5308416
    s_mov_b32 s75, 0x20000
    s_mul_i32 s47, s47, s40
    s_add_u32 s7, s17, 0
    s_min_u32 s7, s7, 161
    s_mul_i32 s84, s7, 116509
    s_lshr_b32 s84, s84, 20
    s_mul_i32 s88, s84, 9
    s_sub_u32 s88, s7, s88
    s_mul_i32 s7, s84, s92
    s_lshl_b32 s7, s7, 2
    s_add_u32 s7, s7, s47
    s_lshl_b32 s6, s88, 7
    s_add_u32 s80, s7, s6
    s_add_u32 s7, s17, 1
    s_min_u32 s7, s7, 161
    s_mul_i32 s85, s7, 116509
    s_lshr_b32 s85, s85, 20
    s_mul_i32 s89, s85, 9
    s_sub_u32 s89, s7, s89
    s_mul_i32 s7, s85, s92
    s_lshl_b32 s7, s7, 2
    s_add_u32 s7, s7, s47
    s_lshl_b32 s6, s89, 7
    s_add_u32 s81, s7, s6
    s_add_u32 s7, s17, 2
    s_min_u32 s7, s7, 161
    s_mul_i32 s86, s7, 116509
    s_lshr_b32 s86, s86, 20
    s_mul_i32 s90, s86, 9
    s_sub_u32 s90, s7, s90
    s_mul_i32 s7, s86, s92
    s_lshl_b32 s7, s7, 2
    s_add_u32 s7, s7, s47
    s_lshl_b32 s6, s90, 7
    s_add_u32 s82, s7, s6
    s_add_u32 s7, s17, 3
    s_min_u32 s7, s7, 161
    s_mul_i32 s87, s7, 116509
    s_lshr_b32 s87, s87, 20
    s_mul_i32 s91, s87, 9
    s_sub_u32 s91, s7, s91
    s_mul_i32 s7, s87, s92
    s_lshl_b32 s7, s7, 2
    s_add_u32 s7, s7, s47
    s_lshl_b32 s6, s91, 7
    s_add_u32 s83, s7, s6
    s_lshr_b32 s7, s92, 3
    v_lshrrev_b32 v224, 3, v0
    v_mul_lo_u32 v224, v224, s7
    v_and_b32 v8, 7, v0
    v_lshl_add_u32 v224, v8, 4, v224
    s_waitcnt lgkmcnt(0)
    s_mul_i32 s76, s76, 0x9e3779b1
    s_add_u32 s76, s76, 0x7f4a7c15
    s_mov_b32 s77, s76
    s_add_u32 m0, s79, 0
    s_mov_b32 s71, s80
    buffer_load_dwordx4 v224, s[72:75], s71 offen nt lds
    s_add_u32 m0, s79, 1024
    s_add_u32 s71, s71, s92
    buffer_load_dwordx4 v224, s[72:75], s71 offen nt lds
    s_add_u32 m0, s79, 2048
    s_add_u32 s71, s71, s92
    buffer_load_dwordx4 v224, s[72:75], s71 offen nt lds
    s_waitcnt vmcnt(3)
    s_barrier
    s_cmp_ge_u32 s41, 18
    s_cbranch_scc1 L_prep_o_4
    s_mul_i32 s7, s3, 36
    s_add_u32 s7, s7, s46
    v_lshrrev_b32 v8, 4, v0
    v_lshlrev_b32 v8, 11, v8
    v_add_u32 v8, s7, v8
    v_and_b32 v9, 15, v0
    v_cmp_gt_u32 s[22:23], 6, v9
    v_lshrrev_b32 v10, 1, v9
    v_min_u32 v10, 2, v10
    v_lshl_add_u32 v10, v10, 13, v8
    v_and_b32 v11, 1, v0
    v_lshl_add_u32 v10, v11, 1, v10
    v_lshl_add_u32 v8, v9, 1, v8
    ds_read_u16 v136, v8 offset:8192
    ds_read_u16 v137, v8 offset:8448
    ds_read_u16 v138, v8 offset:8704
    ds_read_u16 v139, v8 offset:8960
    ds_read_u16 v140, v8 offset:9216
    ds_read_u16 v141, v8 offset:9472
    ds_read_u16 v142, v8 offset:9728
    ds_read_u16 v143, v8 offset:9984
    s_lshl_b32 s33, s40, 2
    s_add_u32 s33, s33, s3
    s_mul_i32 s33, s33, 18
    s_add_u32 s33, s33, s41
    s_lshl_b32 s33, s33, 12
    ds_read_u16 v144, v8 offset:16384
    ds_read_u16 v145, v8 offset:16640
    ds_read_u16 v146, v8 offset:16896
    ds_read_u16 v147, v8 offset:17152
    ds_read_u16 v148, v8 offset:17408
    ds_read_u16 v149, v8 offset:17664
    ds_read_u16 v150, v8 offset:17920
    ds_read_u16 v151, v8 offset:18176
    s_waitcnt lgkmcnt(8)
    v_lshl_or_b32 v32, v137, 16, v136
    v_lshl_or_b32 v33, v139, 16, v138
    v_lshl_or_b32 v34, v141, 16, v140
    v_lshl_or_b32 v35, v143, 16, v142
    buffer_store_dwordx4 v[32:35], v253, s[8:11], s33 offen offset:0 sc1
    ds_read_u16 v152, v8 offset:24576
    ds_read_u16 v153, v8 offset:24832
    ds_read_u16 v154, v8 offset:25088
    ds_read_u16 v155, v8 offset:25344
    ds_read_u16 v156, v8 offset:25600
    ds_read_u16 v157, v8 offset:25856
    ds_read_u16 v158, v8 offset:26112
    ds_read_u16 v159, v8 offset:26368
    s_waitcnt lgkmcnt(8)
    v_lshl_or_b32 v36, v145, 16, v144
    v_lshl_or_b32 v37, v147, 16, v146
    v_lshl_or_b32 v38, v149, 16, v148
    v_lshl_or_b32 v39, v151, 16, v150
    buffer_store_dwordx4 v[36:39], v253, s[8:11], s33 offen offset:1024 sc1
    ds_read_u16 v160, v10 offset:8224
    ds_read_u16 v161, v10 offset:8480
    ds_read_u16 v162, v10 offset:8736
    ds_read_u16 v163, v10 offset:8992
    ds_read_u16 v164, v10 offset:9248
    ds_read_u16 v165, v10 offset:9504
    ds_read_u16 v166, v10 offset:9760
    ds_read_u16 v167, v10 offset:10016
    s_waitcnt lgkmcnt(8)
    v_lshl_or_b32 v40, v153, 16, v152
    v_lshl_or_b32 v41, v155, 16, v154
    v_lshl_or_b32 v42, v157, 16, v156
    v_lshl_or_b32 v43, v159, 16, v158
    buffer_store_dwordx4 v[40:43], v253, s[8:11], s33 offen offset:2048 sc1
    s_waitcnt lgkmcnt(0)
    v_lshl_or_b32 v44, v161, 16, v160
    v_cndmask_b32 v44, 0, v44, s[22:23]
    v_lshl_or_b32 v45, v163, 16, v162
    v_cndmask_b32 v45, 0, v45, s[22:23]
    v_lshl_or_b32 v46, v165, 16, v164
    v_cndmask_b32 v46, 0, v46, s[22:23]
    v_lshl_or_b32 v47, v167, 16, v166
    v_cndmask_b32 v47, 0, v47, s[22:23]
    buffer_store_dwordx4 v[44:47], v253, s[8:11], s33 offen offset:3072 sc1
    s_branch L_prep_done_6
L_prep_o_4:
    s_cmp_ge_u32 s36, 54
    s_cbranch_scc1 L_prep_m_5
    v_lshrrev_b32 v8, 4, v0
    v_lshlrev_b32 v8, 3, v8
    v_bfe_u32 v9, v0, 2, 2
    v_add_u32 v8, v8, v9
    v_mul_u32_u24 v8, 128, v8
    v_and_b32 v9, 3, v0
    v_lshl_add_u32 v8, v9, 3, v8
    s_lshl_b32 s7, s3, 5
    v_add_u32 v8, s7, v8
    ds_read_b64_tr_b16 v[32:33], v8 offset:8192
    ds_read_b64_tr_b16 v[34:35], v8 offset:8704
    ds_read_b64_tr_b16 v[36:37], v8 offset:12288
    ds_read_b64_tr_b16 v[38:39], v8 offset:12800
    ds_read_b64_tr_b16 v[40:41], v8 offset:16384
    ds_read_b64_tr_b16 v[42:43], v8 offset:16896
    s_mul_i32 s34, s34, 12
    s_add_u32 s34, s34, s3
    s_mul_i32 s34, s34, 18
    s_add_u32 s34, s34, s33
    s_lshl_b32 s34, s34, 10
    s_add_u32 s7, s34, 2359296
    s_waitcnt lgkmcnt(4)
    buffer_store_dwordx4 v[32:35], v253, s[8:11], s7 offen sc1
    s_add_u32 s7, s34, 2433024
    s_waitcnt lgkmcnt(2)
    buffer_store_dwordx4 v[36:39], v253, s[8:11], s7 offen sc1
    s_add_u32 s7, s34, 2506752
    s_waitcnt lgkmcnt(0)
    buffer_store_dwordx4 v[40:43], v253, s[8:11], s7 offen sc1
    s_branch L_prep_done_6
L_prep_m_5:
    s_cmp_ge_u32 s37, 36
    s_cbranch_scc1 L_prep_done_6
    v_mov_b32 v28, 0x3f803f80
    v_mov_b32 v29, 0x3f803f80
    v_mov_b32 v30, 0x3f803f80
    v_mov_b32 v31, 0x3f803f80
    v_and_b32 v9, 15, v0
    v_cmp_eq_u32 vcc, 0, v9
    v_cmp_eq_u32 s[22:23], 1, v9
    v_mfma_f32_16x16x32_bf16 v[32:35], v[64:67], v[28:31], 0
    v_mfma_f32_16x16x32_bf16 v[32:35], v[68:71], v[28:31], v[32:35]
    v_mfma_f32_16x16x32_bf16 v[32:35], v[72:75], v[28:31], v[32:35]
    v_mfma_f32_16x16x32_bf16 v[32:35], v[76:79], v[28:31], v[32:35]
    v_mfma_f32_16x16x32_bf16 v[32:35], v[80:83], v[28:31], v[32:35]
    v_mfma_f32_16x16x32_bf16 v[32:35], v[84:87], v[28:31], v[32:35]
    v_mfma_f32_16x16x32_bf16 v[32:35], v[88:91], v[28:31], v[32:35]
    v_mfma_f32_16x16x32_bf16 v[32:35], v[92:95], v[28:31], v[32:35]
    v_mfma_f32_16x16x32_bf16 v[32:35], v[96:99], v[28:31], v[32:35]
    v_mfma_f32_16x16x32_bf16 v[32:35], v[100:103], v[28:31], v[32:35]
    v_mfma_f32_16x16x32_bf16 v[32:35], v[104:107], v[28:31], v[32:35]
    v_mfma_f32_16x16x32_bf16 v[32:35], v[108:111], v[28:31], v[32:35]
    v_mfma_f32_16x16x32_bf16 v[32:35], v[112:115], v[28:31], v[32:35]
    v_mfma_f32_16x16x32_bf16 v[32:35], v[116:119], v[28:31], v[32:35]
    v_mfma_f32_16x16x32_bf16 v[32:35], v[120:123], v[28:31], v[32:35]
    v_mfma_f32_16x16x32_bf16 v[32:35], v[124:127], v[28:31], v[32:35]
    v_mfma_f32_16x16x32_bf16 v[32:35], v[128:131], v[28:31], v[32:35]
    v_mfma_f32_16x16x32_bf16 v[32:35], v[132:135], v[28:31], v[32:35]
    v_lshrrev_b32 v10, 5, v0
    v_lshlrev_b32 v10, 8, v10
    v_lshl_add_u32 v10, v9, 4, v10
    v_bfe_u32 v9, v0, 4, 1
    v_lshl_add_u32 v10, v9, 3, v10
    s_lshl_b32 s7, s37, 9
    s_add_u32 s7, s7, 3022848
    s_nop 0
    v_mul_f32 v32, 0x3ae38e39, v32
    v_mul_f32 v33, 0x3ae38e39, v33
    v_mul_f32 v34, 0x3ae38e39, v34
    v_mul_f32 v35, 0x3ae38e39, v35
    v_cvt_pk_bf16_f32 v36, v32, v33
    v_cvt_pk_bf16_f32 v37, v34, v35
    v_lshlrev_b32 v38, 16, v36
    v_and_b32 v39, s16, v36
    v_sub_f32 v38, v32, v38
    v_sub_f32 v39, v33, v39
    v_cvt_pk_bf16_f32 v28, v38, v39
    v_cndmask_b32 v28, 0, v28, s[22:23]
    v_cndmask_b32 v28, v28, v36, vcc
    v_lshlrev_b32 v38, 16, v37
    v_and_b32 v39, s16, v37
    v_sub_f32 v38, v34, v38
    v_sub_f32 v39, v35, v39
    v_cvt_pk_bf16_f32 v29, v38, v39
    v_cndmask_b32 v29, 0, v29, s[22:23]
    v_cndmask_b32 v29, v29, v37, vcc
    buffer_store_dwordx2 v[28:29], v10, s[8:11], s7 offen sc1
L_prep_done_6:
    s_add_u32 s19, s18, 43515904
    s_add_u32 s20, s18, 38797312
    s_lshl_b32 s22, s21, 7
    s_add_u32 s22, s22, 48234496
    buffer_store_dwordx4 v[16:19], v172, s[8:11], s19 offen sc1
    buffer_store_dwordx4 v[20:23], v173, s[8:11], s19 offen sc1
    buffer_store_dwordx4 v[24:27], v174, s[8:11], s19 offen sc1
    s_mov_b32 s17, 0x3f803f80
    v_mov_b32 v8, 0
    v_mov_b32 v9, 0
    v_mov_b32 v10, 0
    v_mov_b32 v11, 0
    v_dot2c_f32_bf16 v8, s17, v16
    v_dot2c_f32_bf16 v9, v16, v16
    v_dot2c_f32_bf16 v10, s17, v17
    v_dot2c_f32_bf16 v11, v17, v17
    v_dot2c_f32_bf16 v8, s17, v18
    v_dot2c_f32_bf16 v9, v18, v18
    v_dot2c_f32_bf16 v10, s17, v19
    v_dot2c_f32_bf16 v11, v19, v19
    v_dot2c_f32_bf16 v8, s17, v20
    v_dot2c_f32_bf16 v9, v20, v20
    v_dot2c_f32_bf16 v10, s17, v21
    v_dot2c_f32_bf16 v11, v21, v21
    v_dot2c_f32_bf16 v8, s17, v22
    v_dot2c_f32_bf16 v9, v22, v22
    v_dot2c_f32_bf16 v10, s17, v23
    v_dot2c_f32_bf16 v11, v23, v23
    v_dot2c_f32_bf16 v8, s17, v24
    v_dot2c_f32_bf16 v9, v24, v24
    v_dot2c_f32_bf16 v10, s17, v25
    v_dot2c_f32_bf16 v11, v25, v25
    v_dot2c_f32_bf16 v8, s17, v26
    v_dot2c_f32_bf16 v9, v26, v26
    v_dot2c_f32_bf16 v10, s17, v27
    v_dot2c_f32_bf16 v11, v27, v27
    v_and_b32 v12, 7, v0
    v_lshlrev_b32 v12, 3, v12
    s_lshl_b32 s7, s3, 6
    v_add_u32 v13, s7, v12
    v_pk_add_f32 v[8:9], v[8:9], v[10:11]
    s_nop 1
    v_add_f32_dpp v8, v8, v8 row_ror:8 row_mask:0xf bank_mask:0xf
    v_add_f32_dpp v9, v9, v9 row_ror:8 row_mask:0xf bank_mask:0xf
    v_mov_b32 v10, v8
    v_mov_b32 v11, v9
    s_nop 1
    v_permlane32_swap_b32 v10, v8
    v_permlane32_swap_b32 v11, v9
    v_add_f32 v8, v8, v10
    v_add_f32 v9, v9, v11
    v_mov_b32 v10, v8
    v_mov_b32 v11, v9
    s_nop 1
    v_permlane16_swap_b32 v10, v8
    v_permlane16_swap_b32 v11, v9
    v_add_f32 v8, v8, v10
    v_add_f32 v9, v9, v11
    ds_write_b64 v13, v[8:9]
    s_waitcnt lgkmcnt(0)
    s_barrier
    ds_read_b64 v[40:41], v12 offset:0
    ds_read_b64 v[42:43], v12 offset:64
    ds_read_b64 v[44:45], v12 offset:128
    ds_read_b64 v[46:47], v12 offset:192
    s_waitcnt lgkmcnt(0)
    v_pk_add_f32 v[40:41], v[40:41], v[42:43]
    v_pk_add_f32 v[44:45], v[44:45], v[46:47]
    v_pk_add_f32 v[8:9], v[40:41], v[44:45]
    v_mul_f32 v8, 0x3ae38e39, v8
    v_mul_f32 v9, 0x3ae38e39, v9
    v_fma_f32 v9, -v8, v8, v9
    v_max_f32 v9, 0, v9
    v_add_f32 v9, 0x3727c5ac, v9
    v_rsq_f32 v10, v9
    s_nop 0
    v_mul_f32 v12, v8, v10
    v_mov_b32 v11, v10
    v_sub_f32 v12, 0, v12
    v_mov_b32 v13, v12
    s_cmp_eq_u32 s3, 0
    s_cselect_b32 s7, 32, 0
    v_lshlrev_b32 v14, 2, v0
    v_cmp_gt_u32 vcc, s7, v0
    v_mov_b32 v9, 1073741824
    s_nop 0
    v_cndmask_b32 v14, v9, v14, vcc
    buffer_store_dword v8, v14, s[8:11], s22 offen sc1
    v_lshlrev_b32 v40, 16, v16
    v_and_b32 v41, s16, v16
    v_lshlrev_b32 v42, 16, v17
    v_and_b32 v43, s16, v17
    v_lshlrev_b32 v44, 16, v18
    v_and_b32 v45, s16, v18
    v_lshlrev_b32 v46, 16, v19
    v_and_b32 v47, s16, v19
    v_pk_fma_f32 v[40:41], v[40:41], v[10:11], v[12:13]
    v_pk_fma_f32 v[42:43], v[42:43], v[10:11], v[12:13]
    v_pk_fma_f32 v[44:45], v[44:45], v[10:11], v[12:13]
    v_pk_fma_f32 v[46:47], v[46:47], v[10:11], v[12:13]
    v_cvt_pk_bf16_f32 v48, v40, v41
    v_cvt_pk_bf16_f32 v49, v42, v43
    v_cvt_pk_bf16_f32 v50, v44, v45
    v_cvt_pk_bf16_f32 v51, v46, v47
    v_lshlrev_b32 v40, 16, v20
    v_and_b32 v41, s16, v20
    v_lshlrev_b32 v42, 16, v21
    v_and_b32 v43, s16, v21
    v_lshlrev_b32 v44, 16, v22
    v_and_b32 v45, s16, v22
    v_lshlrev_b32 v46, 16, v23
    v_and_b32 v47, s16, v23
    v_pk_fma_f32 v[40:41], v[40:41], v[10:11], v[12:13]
    v_pk_fma_f32 v[42:43], v[42:43], v[10:11], v[12:13]
    v_pk_fma_f32 v[44:45], v[44:45], v[10:11], v[12:13]
    v_pk_fma_f32 v[46:47], v[46:47], v[10:11], v[12:13]
    v_cvt_pk_bf16_f32 v52, v40, v41
    v_cvt_pk_bf16_f32 v53, v42, v43
    v_cvt_pk_bf16_f32 v54, v44, v45
    v_cvt_pk_bf16_f32 v55, v46, v47
    v_lshlrev_b32 v40, 16, v24
    v_and_b32 v41, s16, v24
    v_lshlrev_b32 v42, 16, v25
    v_and_b32 v43, s16, v25
    v_lshlrev_b32 v44, 16, v26
    v_and_b32 v45, s16, v26
    v_lshlrev_b32 v46, 16, v27
    v_and_b32 v47, s16, v27
    v_pk_fma_f32 v[40:41], v[40:41], v[10:11], v[12:13]
    v_pk_fma_f32 v[42:43], v[42:43], v[10:11], v[12:13]
    v_pk_fma_f32 v[44:45], v[44:45], v[10:11], v[12:13]
    v_pk_fma_f32 v[46:47], v[46:47], v[10:11], v[12:13]
    v_cvt_pk_bf16_f32 v56, v40, v41
    v_cvt_pk_bf16_f32 v57, v42, v43
    v_cvt_pk_bf16_f32 v58, v44, v45
    v_cvt_pk_bf16_f32 v59, v46, v47
    buffer_store_dwordx4 v[48:51], v172, s[8:11], s20 offen sc1
    buffer_store_dwordx4 v[52:55], v173, s[8:11], s20 offen sc1
    buffer_store_dwordx4 v[56:59], v174, s[8:11], s20 offen sc1
    v_lshlrev_b32 v15, 7, v0
    s_lshl_b32 s6, s40, 2
    s_add_u32 s6, s6, s44
    s_sub_u32 s6, s6, 32768
    v_mov_b32 v1, s76
    s_mov_b64 vcc, 0xff
    v_lshrrev_b32 v14, 3, v0
    v_lshl_add_u32 v15, v14, 3, v15
    s_cmp_ge_u32 s40, 6
    s_cselect_b32 s7, s41, 31
    s_cmp_lt_u32 s7, 31
    s_cmov_b64 vcc, 0xffff
    s_waitcnt vmcnt(0)
    s_barrier
    s_cmp_lg_u32 s3, 0
    s_cbranch_scc1 L_pub_7
    s_mov_b64 exec, vcc
    buffer_store_dword v1, v15, s[8:11], s6 offen sc1
    v_lshlrev_b32 v15, 10, v0
    s_lshl_b32 s6, s40, 7
    s_lshl_b32 s7, s41, 2
    s_add_u32 s6, s6, s7
    s_add_u32 s6, s6, 19431424
    s_mov_b64 exec, 0xffffffff
    v_lshlrev_b32 v15, 10, v0
    v_mov_b32 v1, s76
    buffer_store_dword v1, v15, s[8:11], s6 offen sc1
    s_cmp_lt_u32 s41, 18
    s_cbranch_scc1 L_pub_7
    s_lshl_b32 s6, s36, 2
    s_add_u32 s6, s6, 19496960
    s_mov_b64 exec, 1
    buffer_store_dword v1, off, s[8:11], s6 sc1
L_pub_7:
    s_mov_b64 exec, -1
    s_add_u32 m0, s79, 3072
    s_add_u32 s71, s71, s92
    buffer_load_dwordx4 v224, s[72:75], s71 offen nt lds
    s_add_u32 m0, s79, 4096
    s_mov_b32 s71, s81
    buffer_load_dwordx4 v224, s[72:75], s71 offen nt lds
    s_add_u32 m0, s79, 5120
    s_add_u32 s71, s71, s92
    buffer_load_dwordx4 v224, s[72:75], s71 offen nt lds
    s_add_u32 m0, s79, 6144
    s_add_u32 s71, s71, s92
    buffer_load_dwordx4 v224, s[72:75], s71 offen nt lds
    s_add_u32 m0, s79, 7168
    s_add_u32 s71, s71, s92
    buffer_load_dwordx4 v224, s[72:75], s71 offen nt lds
    s_add_u32 m0, s79, 8192
    s_mov_b32 s71, s82
    buffer_load_dwordx4 v224, s[72:75], s71 offen nt lds
    s_add_u32 m0, s79, 9216
    s_add_u32 s71, s71, s92
    buffer_load_dwordx4 v224, s[72:75], s71 offen nt lds
    s_add_u32 m0, s79, 10240
    s_add_u32 s71, s71, s92
    buffer_load_dwordx4 v224, s[72:75], s71 offen nt lds
    s_add_u32 m0, s79, 11264
    s_add_u32 s71, s71, s92
    buffer_load_dwordx4 v224, s[72:75], s71 offen nt lds
    s_add_u32 m0, s79, 12288
    s_mov_b32 s71, s83
    buffer_load_dwordx4 v224, s[72:75], s71 offen nt lds
    s_add_u32 m0, s79, 13312
    s_add_u32 s71, s71, s92
    buffer_load_dwordx4 v224, s[72:75], s71 offen nt lds
    s_add_u32 m0, s79, 14336
    s_add_u32 s71, s71, s92
    buffer_load_dwordx4 v224, s[72:75], s71 offen nt lds
    s_add_u32 m0, s79, 15360
    s_add_u32 s71, s71, s92
    buffer_load_dwordx4 v224, s[72:75], s71 offen nt lds
    s_cmp_lg_u32 s3, 0
    s_cbranch_scc1 L_wq_ready_8
    s_lshl_b32 s7, s41, 3
    s_add_u32 s7, s7, s40
    s_lshl_b32 s7, s7, 7
    s_add_u32 s7, s7, 19431424
    s_add_u32 s68, s4, s7
    s_addc_u32 s69, s5, 0
    s_mov_b32 s6, 0
    s_mov_b32 s7, 0
L_cpoll_9:
    s_load_dwordx16 s[52:67], s[68:69], s7 glc
    s_add_u32 s6, s6, 1
    s_waitcnt lgkmcnt(0)
    s_xor_b64 s[52:53], s[52:53], s[76:77]
    s_xor_b64 s[54:55], s[54:55], s[76:77]
    s_xor_b64 s[56:57], s[56:57], s[76:77]
    s_xor_b64 s[58:59], s[58:59], s[76:77]
    s_xor_b64 s[60:61], s[60:61], s[76:77]
    s_xor_b64 s[62:63], s[62:63], s[76:77]
    s_xor_b64 s[64:65], s[64:65], s[76:77]
    s_xor_b64 s[66:67], s[66:67], s[76:77]
    s_or_b64 s[52:53], s[52:53], s[60:61]
    s_or_b64 s[54:55], s[54:55], s[62:63]
    s_or_b64 s[56:57], s[56:57], s[64:65]
    s_or_b64 s[58:59], s[58:59], s[66:67]
    s_or_b64 s[52:53], s[52:53], s[56:57]
    s_or_b64 s[54:55], s[54:55], s[58:59]
    s_or_b64 s[52:53], s[52:53], s[54:55]
    s_cbranch_scc1 L_cpoll_10
    s_add_u32 s7, s7, 8
    s_cmp_eq_u32 s7, 16
    s_cbranch_scc1 L_cpolled_11
L_cpoll_10:
    s_cmp_lt_u32 s6, 1048576
    s_cbranch_scc1 L_cpoll_9
    s_branch L_main_end
L_cpolled_11:
L_wq_ready_8:
    s_barrier
    s_lshl_b32 s28, s40, 2
    s_add_u32 s28, s28, s3
    s_mul_i32 s28, s28, 73728
    v_and_b32 v229, 8, v0
    v_lshl_add_u32 v229, v229, 27, v253
    buffer_load_dwordx4 a[0:3], v253, s[8:11], s28 offen offset:0 sc1
    buffer_load_dwordx4 a[4:7], v253, s[8:11], s28 offen offset:1024 sc1
    buffer_load_dwordx4 a[8:11], v253, s[8:11], s28 offen offset:2048 sc1
    buffer_load_dwordx4 a[12:15], v229, s[8:11], s28 offen offset:3072 sc1
    s_add_u32 s28, s28, 4096
    buffer_load_dwordx4 a[16:19], v253, s[8:11], s28 offen offset:0 sc1
    buffer_load_dwordx4 a[20:23], v253, s[8:11], s28 offen offset:1024 sc1
    buffer_load_dwordx4 a[24:27], v253, s[8:11], s28 offen offset:2048 sc1
    buffer_load_dwordx4 a[28:31], v229, s[8:11], s28 offen offset:3072 sc1
    s_add_u32 s28, s28, 4096
    buffer_load_dwordx4 a[32:35], v253, s[8:11], s28 offen offset:0 sc1
    buffer_load_dwordx4 a[36:39], v253, s[8:11], s28 offen offset:1024 sc1
    buffer_load_dwordx4 a[40:43], v253, s[8:11], s28 offen offset:2048 sc1
    buffer_load_dwordx4 a[44:47], v229, s[8:11], s28 offen offset:3072 sc1
    s_add_u32 s28, s28, 4096
    buffer_load_dwordx4 a[48:51], v253, s[8:11], s28 offen offset:0 sc1
    buffer_load_dwordx4 a[52:55], v253, s[8:11], s28 offen offset:1024 sc1
    buffer_load_dwordx4 a[56:59], v253, s[8:11], s28 offen offset:2048 sc1
    buffer_load_dwordx4 a[60:63], v229, s[8:11], s28 offen offset:3072 sc1
    s_add_u32 s28, s28, 4096
    buffer_load_dwordx4 a[64:67], v253, s[8:11], s28 offen offset:0 sc1
    buffer_load_dwordx4 a[68:71], v253, s[8:11], s28 offen offset:1024 sc1
    buffer_load_dwordx4 a[72:75], v253, s[8:11], s28 offen offset:2048 sc1
    buffer_load_dwordx4 a[76:79], v229, s[8:11], s28 offen offset:3072 sc1
    s_add_u32 s28, s28, 4096
    buffer_load_dwordx4 a[80:83], v253, s[8:11], s28 offen offset:0 sc1
    buffer_load_dwordx4 a[84:87], v253, s[8:11], s28 offen offset:1024 sc1
    buffer_load_dwordx4 a[88:91], v253, s[8:11], s28 offen offset:2048 sc1
    buffer_load_dwordx4 a[92:95], v229, s[8:11], s28 offen offset:3072 sc1
    s_add_u32 s28, s28, 4096
    buffer_load_dwordx4 a[96:99], v253, s[8:11], s28 offen offset:0 sc1
    buffer_load_dwordx4 a[100:103], v253, s[8:11], s28 offen offset:1024 sc1
    buffer_load_dwordx4 a[104:107], v253, s[8:11], s28 offen offset:2048 sc1
    buffer_load_dwordx4 a[108:111], v229, s[8:11], s28 offen offset:3072 sc1
    s_add_u32 s28, s28, 4096
    buffer_load_dwordx4 a[112:115], v253, s[8:11], s28 offen offset:0 sc1
    buffer_load_dwordx4 a[116:119], v253, s[8:11], s28 offen offset:1024 sc1
    buffer_load_dwordx4 a[120:123], v253, s[8:11], s28 offen offset:2048 sc1
    buffer_load_dwordx4 a[124:127], v229, s[8:11], s28 offen offset:3072 sc1
    s_add_u32 s28, s28, 4096
    buffer_load_dwordx4 a[128:131], v253, s[8:11], s28 offen offset:0 sc1
    buffer_load_dwordx4 a[132:135], v253, s[8:11], s28 offen offset:1024 sc1
    buffer_load_dwordx4 a[136:139], v253, s[8:11], s28 offen offset:2048 sc1
    buffer_load_dwordx4 a[140:143], v229, s[8:11], s28 offen offset:3072 sc1
    s_add_u32 s28, s28, 4096
L_main_layer:
    v_bfe_u32 v3, v0, 3, 1
    v_mul_u32_u24 v2, 9216, v3
    v_lshrrev_b32 v3, 4, v0
    v_lshl_add_u32 v2, v3, 7, v2
    v_and_b32 v3, 7, v0
    v_lshl_add_u32 v2, v3, 4, v2
    v_bfe_u32 v3, v0, 3, 2
    s_mov_b32 s7, 9216
    v_mul_lo_u32 v9, v3, s7
    v_lshrrev_b32 v3, 5, v0
    v_lshl_add_u32 v9, v3, 7, v9
    v_and_b32 v3, 7, v0
    v_lshl_add_u32 v9, v3, 4, v9
    s_mul_i32 s22, s41, 73728
    s_add_u32 s22, s22, s43
    s_add_u32 s23, s22, 38797312
    s_mul_i32 s7, s3, 18432
    s_add_u32 s24, s23, s7
    s_cmp_eq_u32 s41, 0
    s_cselect_b32 s7, 0, 18432
    s_sub_u32 s23, s23, s7
    s_lshl_b32 s25, s3, 10
    s_add_u32 s25, s25, 1024
    s_mul_i32 s26, s3, 5120
    s_lshl_b32 s7, s3, 9
    s_add_u32 s27, s23, s7
    s_and_b32 s7, s3, 1
    s_add_u32 s7, s7, 4
    s_mul_i32 s29, s7, 5120
    s_lshl_b32 s7, s7, 9
    s_add_u32 s23, s23, s7
    s_cmp_lg_u32 s3, 3
    s_cbranch_scc1 L_pollout_14
    s_lshl_b32 s7, s40, 7
    s_add_u32 s7, s7, s44
    s_sub_u32 s7, s7, 32768
    s_add_u32 s52, s4, s7
    s_addc_u32 s53, s5, 0
    s_cmp_eq_u32 s41, 0
    s_cselect_b32 s7, 0, 32
    s_mov_b32 s6, 0
L_poll_12:
    s_load_dwordx8 s[56:63], s[52:53], 0 glc
    s_load_dwordx2 s[54:55], s[52:53], s7 glc
    s_add_u32 s6, s6, 1
    s_waitcnt lgkmcnt(0)
    s_xor_b64 s[54:55], s[54:55], s[76:77]
    s_xor_b64 s[56:57], s[56:57], s[76:77]
    s_xor_b64 s[58:59], s[58:59], s[76:77]
    s_xor_b64 s[60:61], s[60:61], s[76:77]
    s_xor_b64 s[62:63], s[62:63], s[76:77]
    s_or_b64 s[56:57], s[56:57], s[58:59]
    s_or_b64 s[60:61], s[60:61], s[62:63]
    s_or_b64 s[56:57], s[56:57], s[54:55]
    s_or_b64 s[56:57], s[56:57], s[60:61]
    s_cbranch_scc0 L_polled_13
    s_cmp_lt_u32 s6, 1048576
    s_cbranch_scc1 L_poll_12
    s_branch L_main_end
L_polled_13:
L_pollout_14:
    s_barrier
    s_add_u32 m0, s25, 0
    s_nop 0
    buffer_load_dwordx4 v2, s[8:11], s24 offen offset:0 sc1 lds
    s_add_u32 m0, s25, 4608
    s_nop 0
    buffer_load_dwordx4 v2, s[8:11], s24 offen offset:512 sc1 lds
    s_add_u32 m0, s25, 9216
    s_nop 0
    buffer_load_dwordx4 v2, s[8:11], s24 offen offset:1024 sc1 lds
    s_add_u32 m0, s25, 13824
    s_nop 0
    buffer_load_dwordx4 v2, s[8:11], s24 offen offset:1536 sc1 lds
    s_add_u32 m0, s25, 18432
    s_nop 0
    buffer_load_dwordx4 v2, s[8:11], s24 offen offset:2048 sc1 lds
    s_add_u32 m0, s25, 23040
    s_nop 0
    buffer_load_dwordx4 v2, s[8:11], s24 offen offset:2560 sc1 lds
    s_add_u32 m0, s26, 0
    s_add_u32 s7, s27, 0
    buffer_load_dwordx4 v2, s[8:11], s7 offen sc1 lds
    s_add_u32 m0, s29, 0
    s_add_u32 s7, s23, 0
    buffer_load_dwordx4 v2, s[8:11], s7 offen sc1 lds
    v_add_u32 v6, 46080, v253
    s_waitcnt vmcnt(0)
    s_barrier
    ds_read_b128 v[16:19], v253 offset:0
    ds_read_b128 v[20:23], v253 offset:1024
    ds_read_b128 v[24:27], v253 offset:2048
    ds_read_b128 v[28:31], v253 offset:3072
    ds_read_b128 v[32:35], v253 offset:4096
    s_waitcnt lgkmcnt(0)
    v_mfma_f32_16x16x32_bf16 v[56:59], a[0:3], v[20:23], 0
    ds_read_b128 v[36:39], v253 offset:5120
    v_mfma_f32_16x16x32_bf16 v[60:63], a[0:3], v[24:27], 0
    ds_read_b128 v[40:43], v253 offset:6144
    v_mfma_f32_16x16x32_bf16 v[64:67], a[0:3], v[28:31], 0
    ds_read_b128 v[44:47], v253 offset:7168
    v_mfma_f32_16x16x32_bf16 v[68:71], a[0:3], v[32:35], 0
    ds_read_b128 v[48:51], v253 offset:8192
    v_mfma_f32_16x16x32_bf16 v[72:75], a[4:7], v[16:19], 0
    ds_read_b128 v[52:55], v253 offset:9216
    v_mfma_f32_16x16x32_bf16 v[76:79], a[4:7], v[20:23], 0
    s_add_u32 m0, s25, 27648
    s_nop 0
    buffer_load_dwordx4 v2, s[8:11], s24 offen offset:3072 sc1 lds
    v_mfma_f32_16x16x32_bf16 v[80:83], a[4:7], v[24:27], 0
    v_mov_b32 v132, 0
    v_mov_b32 v133, 0
    v_mfma_f32_16x16x32_bf16 v[84:87], a[4:7], v[28:31], 0
    s_add_u32 m0, s25, 32256
    s_nop 0
    buffer_load_dwordx4 v2, s[8:11], s24 offen offset:3584 sc1 lds
    v_mfma_f32_16x16x32_bf16 v[88:91], a[4:7], v[32:35], 0
    v_mov_b32 v192, 0
    v_mov_b32 v193, 0
    v_mfma_f32_16x16x32_bf16 v[92:95], v[16:19], a[8:11], 0
    buffer_load_dwordx4 a[144:147], v253, s[8:11], s28 offen offset:0 sc1
    v_mfma_f32_16x16x32_bf16 v[96:99], v[20:23], a[8:11], 0
    v_mov_b32 v195, 0
    v_mov_b32 v135, 0
    v_mfma_f32_16x16x32_bf16 v[100:103], v[24:27], a[8:11], 0
    buffer_load_dwordx4 a[148:151], v253, s[8:11], s28 offen offset:1024 sc1
    v_mfma_f32_16x16x32_bf16 v[104:107], v[28:31], a[8:11], 0
    v_mov_b32 v139, 0
    v_mov_b32 v143, 0
    v_mfma_f32_16x16x32_bf16 v[108:111], v[32:35], a[8:11], 0
    buffer_load_dwordx4 a[152:155], v253, s[8:11], s28 offen offset:2048 sc1
    v_mfma_f32_16x16x32_bf16 v[112:115], a[12:15], v[16:19], 0
    v_mov_b32 v147, 0
    v_mov_b32 v151, 0
    v_mfma_f32_16x16x32_bf16 v[116:119], a[12:15], v[20:23], 0
    v_mov_b32 v155, 0
    v_mov_b32 v159, 0
    v_mfma_f32_16x16x32_bf16 v[120:123], a[12:15], v[24:27], 0
    v_mov_b32 v163, 0
    v_mov_b32 v167, 0
    v_mfma_f32_16x16x32_bf16 v[124:127], a[12:15], v[28:31], 0
    v_mov_b32 v171, 0
    v_cmp_eq_u32 vcc, 16, v0
    v_mov_b32 v10, 0x3f80
    v_mfma_f32_16x16x32_bf16 v[128:131], a[12:15], v[32:35], 0
    v_cmp_eq_u32 s[20:21], 17, v0
    v_cndmask_b32 v194, 0, v10, vcc
    v_and_b32 v11, 3, v0
    s_waitcnt lgkmcnt(0)
    v_mfma_f32_16x16x32_bf16 v[56:59], a[16:19], v[40:43], v[56:59]
    ds_read_b128 v[16:19], v253 offset:10240
    v_mfma_f32_16x16x32_bf16 v[60:63], a[16:19], v[44:47], v[60:63]
    ds_read_b128 v[20:23], v253 offset:11264
    v_mfma_f32_16x16x32_bf16 v[64:67], a[16:19], v[48:51], v[64:67]
    ds_read_b128 v[24:27], v253 offset:12288
    v_mfma_f32_16x16x32_bf16 v[68:71], a[16:19], v[52:55], v[68:71]
    ds_read_b128 v[28:31], v253 offset:13312
    v_mfma_f32_16x16x32_bf16 v[72:75], a[20:23], v[36:39], v[72:75]
    ds_read_b128 v[32:35], v253 offset:14336
    v_mfma_f32_16x16x32_bf16 v[76:79], a[20:23], v[40:43], v[76:79]
    s_add_u32 m0, s25, 40960
    s_add_u32 s24, s24, 4096
    buffer_load_dwordx4 v2, s[8:11], s24 offen offset:0 sc1 lds
    v_mfma_f32_16x16x32_bf16 v[80:83], a[20:23], v[44:47], v[80:83]
    v_cndmask_b32 v194, v194, 1.0, s[20:21]
    v_cmp_eq_u32 vcc, 2, v11
    v_and_b32 v10, 15, v0
    v_mfma_f32_16x16x32_bf16 v[84:87], a[20:23], v[48:51], v[84:87]
    s_add_u32 m0, s25, 45568
    s_nop 0
    buffer_load_dwordx4 v2, s[8:11], s24 offen offset:512 sc1 lds
    v_mfma_f32_16x16x32_bf16 v[88:91], a[20:23], v[52:55], v[88:91]
    v_lshrrev_b32 v11, 4, v0
    v_cndmask_b32 v196, 0, 1.0, vcc
    v_mfma_f32_16x16x32_bf16 v[92:95], v[36:39], a[24:27], v[92:95]
    buffer_load_dwordx4 a[156:159], v229, s[8:11], s28 offen offset:3072 sc1
    s_add_u32 s28, s28, 4096
    v_mfma_f32_16x16x32_bf16 v[96:99], v[40:43], a[24:27], v[96:99]
    v_cndmask_b32 v197, 0, 1.0, vcc
    v_cndmask_b32 v198, 0, 1.0, vcc
    v_mfma_f32_16x16x32_bf16 v[100:103], v[44:47], a[24:27], v[100:103]
    buffer_load_dwordx4 a[0:3], v253, s[8:11], s28 offen offset:0 sc1
    v_mfma_f32_16x16x32_bf16 v[104:107], v[48:51], a[24:27], v[104:107]
    v_cndmask_b32 v199, 0, 1.0, vcc
    v_lshlrev_b32 v11, 2, v11
    v_mfma_f32_16x16x32_bf16 v[108:111], v[52:55], a[24:27], v[108:111]
    buffer_load_dwordx4 a[4:7], v253, s[8:11], s28 offen offset:1024 sc1
    v_mfma_f32_16x16x32_bf16 v[112:115], a[28:31], v[36:39], v[112:115]
    v_sub_u32 v10, v11, v10
    v_mov_b32 v12, 0xf149f2ca
    v_mfma_f32_16x16x32_bf16 v[116:119], a[28:31], v[40:43], v[116:119]
    s_cmp_eq_u32 s41, 0
    s_cselect_b64 s[38:39], 0, -1
    v_add_u32 v11, 0, v10
    v_and_b32 v13, 1, v11
    v_mfma_f32_16x16x32_bf16 v[120:123], a[28:31], v[44:47], v[120:123]
    v_cmp_eq_u32 s[20:21], 0, v13
    v_cmp_lt_i32 vcc, 1, v11
    v_cmp_gt_i32 s[18:19], 1, v11
    s_and_b64 vcc, vcc, s[20:21]
    s_and_b64 s[18:19], s[18:19], s[20:21]
    s_and_b64 s[20:21], vcc, s[38:39]
    v_cndmask_b32 v200, v12, 0, vcc
    v_cndmask_b32 v204, v12, 0, s[18:19]
    v_mfma_f32_16x16x32_bf16 v[124:127], a[28:31], v[48:51], v[124:127]
    v_cndmask_b32 v208, v12, 0, s[20:21]
    v_add_u32 v11, 1, v10
    v_mfma_f32_16x16x32_bf16 v[128:131], a[28:31], v[52:55], v[128:131]
    v_and_b32 v13, 1, v11
    v_cmp_eq_u32 s[20:21], 0, v13
    v_cmp_lt_i32 vcc, 1, v11
    v_cmp_gt_i32 s[18:19], 1, v11
    s_and_b64 vcc, vcc, s[20:21]
    s_and_b64 s[18:19], s[18:19], s[20:21]
    s_and_b64 s[20:21], vcc, s[38:39]
    v_cndmask_b32 v201, v12, 0, vcc
    s_waitcnt lgkmcnt(0)
    v_mfma_f32_16x16x32_bf16 v[56:59], a[32:35], v[20:23], v[56:59]
    ds_read_b128 v[36:39], v253 offset:15360
    v_mfma_f32_16x16x32_bf16 v[60:63], a[32:35], v[24:27], v[60:63]
    ds_read_b128 v[40:43], v253 offset:16384
    v_mfma_f32_16x16x32_bf16 v[64:67], a[32:35], v[28:31], v[64:67]
    ds_read_b128 v[44:47], v253 offset:17408
    v_mfma_f32_16x16x32_bf16 v[68:71], a[32:35], v[32:35], v[68:71]
    ds_read_b128 v[48:51], v253 offset:18432
    v_mfma_f32_16x16x32_bf16 v[72:75], a[36:39], v[16:19], v[72:75]
    ds_read_b128 v[52:55], v253 offset:19456
    v_mfma_f32_16x16x32_bf16 v[76:79], a[36:39], v[20:23], v[76:79]
    s_add_u32 m0, s25, 50176
    s_nop 0
    buffer_load_dwordx4 v2, s[8:11], s24 offen offset:1024 sc1 lds
    v_mfma_f32_16x16x32_bf16 v[80:83], a[36:39], v[24:27], v[80:83]
    v_cndmask_b32 v205, v12, 0, s[18:19]
    v_cndmask_b32 v209, v12, 0, s[20:21]
    v_mfma_f32_16x16x32_bf16 v[84:87], a[36:39], v[28:31], v[84:87]
    s_add_u32 m0, s25, 54784
    s_nop 0
    buffer_load_dwordx4 v2, s[8:11], s24 offen offset:1536 sc1 lds
    v_mfma_f32_16x16x32_bf16 v[88:91], a[36:39], v[32:35], v[88:91]
    v_add_u32 v11, 2, v10
    v_and_b32 v13, 1, v11
    v_mfma_f32_16x16x32_bf16 v[92:95], v[16:19], a[40:43], v[92:95]
    buffer_load_dwordx4 a[8:11], v253, s[8:11], s28 offen offset:2048 sc1
    v_mfma_f32_16x16x32_bf16 v[96:99], v[20:23], a[40:43], v[96:99]
    v_cmp_eq_u32 s[20:21], 0, v13
    v_cmp_lt_i32 vcc, 1, v11
    v_cmp_gt_i32 s[18:19], 1, v11
    s_and_b64 vcc, vcc, s[20:21]
    s_and_b64 s[18:19], s[18:19], s[20:21]
    s_and_b64 s[20:21], vcc, s[38:39]
    v_cndmask_b32 v202, v12, 0, vcc
    v_cndmask_b32 v206, v12, 0, s[18:19]
    v_mfma_f32_16x16x32_bf16 v[100:103], v[24:27], a[40:43], v[100:103]
    buffer_load_dwordx4 a[12:15], v229, s[8:11], s28 offen offset:3072 sc1
    s_add_u32 s28, s28, 4096
    v_mfma_f32_16x16x32_bf16 v[104:107], v[28:31], a[40:43], v[104:107]
    v_cndmask_b32 v210, v12, 0, s[20:21]
    v_add_u32 v11, 3, v10
    v_mfma_f32_16x16x32_bf16 v[108:111], v[32:35], a[40:43], v[108:111]
    buffer_load_dwordx4 a[16:19], v253, s[8:11], s28 offen offset:0 sc1
    v_mfma_f32_16x16x32_bf16 v[112:115], a[44:47], v[16:19], v[112:115]
    v_and_b32 v13, 1, v11
    v_cmp_eq_u32 s[20:21], 0, v13
    v_cmp_lt_i32 vcc, 1, v11
    v_cmp_gt_i32 s[18:19], 1, v11
    s_and_b64 vcc, vcc, s[20:21]
    s_and_b64 s[18:19], s[18:19], s[20:21]
    s_and_b64 s[20:21], vcc, s[38:39]
    v_cndmask_b32 v203, v12, 0, vcc
    v_mfma_f32_16x16x32_bf16 v[116:119], a[44:47], v[20:23], v[116:119]
    v_cndmask_b32 v207, v12, 0, s[18:19]
    v_cndmask_b32 v211, v12, 0, s[20:21]
    v_mfma_f32_16x16x32_bf16 v[120:123], a[44:47], v[24:27], v[120:123]
    s_lshl_b32 s45, s41, 1
    s_lshr_b32 s7, s40, 2
    s_add_u32 s45, s45, s7
    s_mul_i32 s30, s45, 36864
    s_add_u32 s30, s30, s43
    s_and_b32 s31, s40, 3
    s_mul_i32 s31, s31, 9
    s_add_u32 s31, s31, s3
    s_mul_i32 s32, s31, 18432
    s_add_u32 s32, s32, 2359296
    s_add_u32 s33, s32, 73728
    s_add_u32 s34, s32, 147456
    s_mov_b32 s39, 19496960
    v_min_u32 v228, 44, v0
    v_lshlrev_b32 v228, 3, v228
    v_mfma_f32_16x16x32_bf16 v[124:127], a[44:47], v[28:31], v[124:127]
    s_cmp_eq_u32 s3, 1
    s_cmov_b32 s34, 3022848
    s_cmp_lt_u32 s3, 2
    s_cselect_b32 s35, 0, 1073741824
    v_add_u32 v5, s35, v253
    s_cmp_eq_u32 s3, 1
    s_cselect_b32 s7, 8, 0
    v_and_b32 v10, s7, v0
    v_mfma_f32_16x16x32_bf16 v[128:131], a[44:47], v[32:35], v[128:131]
    v_lshl_add_u32 v5, v10, 27, v5
    s_cmp_eq_u32 s3, 0
    s_cselect_b32 s35, 0, 1073741824
    v_add_u32 v7, s35, v9
    s_waitcnt lgkmcnt(0)
    v_mfma_f32_16x16x32_bf16 v[56:59], a[48:51], v[40:43], v[56:59]
    ds_read_b128 v[16:19], v253 offset:20480
    v_mfma_f32_16x16x32_bf16 v[60:63], a[48:51], v[44:47], v[60:63]
    ds_read_b128 v[20:23], v253 offset:21504
    v_mfma_f32_16x16x32_bf16 v[64:67], a[48:51], v[48:51], v[64:67]
    ds_read_b128 v[24:27], v253 offset:22528
    v_mfma_f32_16x16x32_bf16 v[68:71], a[48:51], v[52:55], v[68:71]
    ds_read_b128 v[28:31], v253 offset:23552
    v_mfma_f32_16x16x32_bf16 v[72:75], a[52:55], v[36:39], v[72:75]
    ds_read_b128 v[32:35], v253 offset:24576
    v_mfma_f32_16x16x32_bf16 v[76:79], a[52:55], v[40:43], v[76:79]
    s_add_u32 m0, s26, 30720
    s_add_u32 s7, s27, 3072
    buffer_load_dwordx4 v2, s[8:11], s7 offen sc1 lds
    v_mfma_f32_16x16x32_bf16 v[80:83], a[52:55], v[44:47], v[80:83]
    s_lshl_b32 s7, s31, 8
    s_add_u32 s36, s30, s7
    s_add_u32 s37, s36, 43515904
    s_add_u32 s46, s36, 45875200
    s_lshl_b32 s36, s45, 7
    s_add_u32 s36, s36, s43
    s_add_u32 s36, s36, 48431104
    s_lshl_b32 s47, s45, 9
    s_add_u32 s47, s47, s43
    s_add_u32 s47, s47, 48234496
    v_bfe_u32 v10, v0, 3, 2
    v_and_b32 v8, 7, v0
    v_mfma_f32_16x16x32_bf16 v[84:87], a[52:55], v[48:51], v[84:87]
    s_add_u32 m0, s29, 30720
    s_add_u32 s7, s23, 3072
    buffer_load_dwordx4 v2, s[8:11], s7 offen sc1 lds
    v_mfma_f32_16x16x32_bf16 v[88:91], a[52:55], v[52:55], v[88:91]
    v_lshlrev_b32 v8, 2, v8
    v_lshl_add_u32 v8, v10, 7, v8
    v_mfma_f32_16x16x32_bf16 v[92:95], v[36:39], a[56:59], v[92:95]
    buffer_load_dwordx4 a[20:23], v253, s[8:11], s28 offen offset:1024 sc1
    v_mfma_f32_16x16x32_bf16 v[96:99], v[40:43], a[56:59], v[96:99]
    v_mfma_f32_16x16x32_bf16 v[100:103], v[44:47], a[56:59], v[100:103]
    buffer_load_dwordx4 a[24:27], v253, s[8:11], s28 offen offset:2048 sc1
    v_mfma_f32_16x16x32_bf16 v[104:107], v[48:51], a[56:59], v[104:107]
    v_mfma_f32_16x16x32_bf16 v[108:111], v[52:55], a[56:59], v[108:111]
    buffer_load_dwordx4 a[28:31], v229, s[8:11], s28 offen offset:3072 sc1
    s_add_u32 s28, s28, 4096
    v_mfma_f32_16x16x32_bf16 v[112:115], a[60:63], v[36:39], v[112:115]
    v_mfma_f32_16x16x32_bf16 v[116:119], a[60:63], v[40:43], v[116:119]
    v_mfma_f32_16x16x32_bf16 v[120:123], a[60:63], v[44:47], v[120:123]
    v_mfma_f32_16x16x32_bf16 v[124:127], a[60:63], v[48:51], v[124:127]
    v_mfma_f32_16x16x32_bf16 v[128:131], a[60:63], v[52:55], v[128:131]
    s_waitcnt lgkmcnt(0)
    v_mfma_f32_16x16x32_bf16 v[56:59], a[64:67], v[20:23], v[56:59]
    ds_read_b128 v[36:39], v253 offset:25600
    v_mfma_f32_16x16x32_bf16 v[60:63], a[64:67], v[24:27], v[60:63]
    ds_read_b128 v[40:43], v253 offset:26624
    v_mfma_f32_16x16x32_bf16 v[64:67], a[64:67], v[28:31], v[64:67]
    ds_read_b128 v[44:47], v253 offset:27648
    v_mfma_f32_16x16x32_bf16 v[68:71], a[64:67], v[32:35], v[68:71]
    ds_read_b128 v[48:51], v253 offset:28672
    v_mfma_f32_16x16x32_bf16 v[72:75], a[68:71], v[16:19], v[72:75]
    ds_read_b128 v[52:55], v253 offset:29696
    v_mfma_f32_16x16x32_bf16 v[76:79], a[68:71], v[20:23], v[76:79]
    buffer_load_dwordx4 a[32:35], v253, s[8:11], s28 offen offset:0 sc1
    v_mfma_f32_16x16x32_bf16 v[80:83], a[68:71], v[24:27], v[80:83]
    v_mfma_f32_16x16x32_bf16 v[84:87], a[68:71], v[28:31], v[84:87]
    buffer_load_dwordx4 a[36:39], v253, s[8:11], s28 offen offset:1024 sc1
    v_mfma_f32_16x16x32_bf16 v[88:91], a[68:71], v[32:35], v[88:91]
    v_mfma_f32_16x16x32_bf16 v[92:95], v[16:19], a[72:75], v[92:95]
    buffer_load_dwordx4 a[40:43], v253, s[8:11], s28 offen offset:2048 sc1
    v_mfma_f32_16x16x32_bf16 v[96:99], v[20:23], a[72:75], v[96:99]
    v_mfma_f32_16x16x32_bf16 v[100:103], v[24:27], a[72:75], v[100:103]
    v_mfma_f32_16x16x32_bf16 v[104:107], v[28:31], a[72:75], v[104:107]
    v_mfma_f32_16x16x32_bf16 v[108:111], v[32:35], a[72:75], v[108:111]
    v_mfma_f32_16x16x32_bf16 v[112:115], a[76:79], v[16:19], v[112:115]
    v_mfma_f32_16x16x32_bf16 v[116:119], a[76:79], v[20:23], v[116:119]
    v_mfma_f32_16x16x32_bf16 v[120:123], a[76:79], v[24:27], v[120:123]
    v_mfma_f32_16x16x32_bf16 v[124:127], a[76:79], v[28:31], v[124:127]
    v_mfma_f32_16x16x32_bf16 v[128:131], a[76:79], v[32:35], v[128:131]
    s_waitcnt vmcnt(6) lgkmcnt(0)
    s_barrier
    v_mfma_f32_16x16x32_bf16 v[56:59], a[80:83], v[40:43], v[56:59]
    ds_read_b128 v[16:19], v253 offset:30720
    v_mfma_f32_16x16x32_bf16 v[60:63], a[80:83], v[44:47], v[60:63]
    ds_read_b128 v[20:23], v253 offset:31744
    v_mfma_f32_16x16x32_bf16 v[64:67], a[80:83], v[48:51], v[64:67]
    ds_read_b128 v[24:27], v253 offset:32768
    v_mfma_f32_16x16x32_bf16 v[68:71], a[80:83], v[52:55], v[68:71]
    ds_read_b128 v[28:31], v253 offset:33792
    v_mfma_f32_16x16x32_bf16 v[72:75], a[84:87], v[36:39], v[72:75]
    ds_read_b128 v[32:35], v253 offset:34816
    v_mfma_f32_16x16x32_bf16 v[76:79], a[84:87], v[40:43], v[76:79]
    s_add_u32 m0, s25, 59392
    s_nop 0
    buffer_load_dwordx4 v2, s[8:11], s24 offen offset:2048 sc1 lds
    v_mfma_f32_16x16x32_bf16 v[80:83], a[84:87], v[44:47], v[80:83]
    v_mfma_f32_16x16x32_bf16 v[84:87], a[84:87], v[48:51], v[84:87]
    s_add_u32 m0, s25, 64000
    s_nop 0
    buffer_load_dwordx4 v2, s[8:11], s24 offen offset:2560 sc1 lds
    v_mfma_f32_16x16x32_bf16 v[88:91], a[84:87], v[52:55], v[88:91]
    v_mfma_f32_16x16x32_bf16 v[92:95], v[36:39], a[88:91], v[92:95]
    buffer_load_dwordx4 a[44:47], v229, s[8:11], s28 offen offset:3072 sc1
    s_add_u32 s28, s28, 4096
    v_mfma_f32_16x16x32_bf16 v[96:99], v[40:43], a[88:91], v[96:99]
    v_mfma_f32_16x16x32_bf16 v[100:103], v[44:47], a[88:91], v[100:103]
    buffer_load_dwordx4 a[48:51], v253, s[8:11], s28 offen offset:0 sc1
    v_mfma_f32_16x16x32_bf16 v[104:107], v[48:51], a[88:91], v[104:107]
    v_mfma_f32_16x16x32_bf16 v[108:111], v[52:55], a[88:91], v[108:111]
    buffer_load_dwordx4 a[52:55], v253, s[8:11], s28 offen offset:1024 sc1
    v_mfma_f32_16x16x32_bf16 v[112:115], a[92:95], v[36:39], v[112:115]
    v_mfma_f32_16x16x32_bf16 v[116:119], a[92:95], v[40:43], v[116:119]
    v_mfma_f32_16x16x32_bf16 v[120:123], a[92:95], v[44:47], v[120:123]
    v_mfma_f32_16x16x32_bf16 v[124:127], a[92:95], v[48:51], v[124:127]
    v_mfma_f32_16x16x32_bf16 v[128:131], a[92:95], v[52:55], v[128:131]
    s_waitcnt lgkmcnt(0)
    v_mfma_f32_16x16x32_bf16 v[56:59], a[96:99], v[20:23], v[56:59]
    ds_read_b128 v[36:39], v253 offset:35840
    v_mfma_f32_16x16x32_bf16 v[60:63], a[96:99], v[24:27], v[60:63]
    ds_read_b128 v[40:43], v253 offset:36864
    v_mfma_f32_16x16x32_bf16 v[64:67], a[96:99], v[28:31], v[64:67]
    ds_read_b128 v[44:47], v253 offset:37888
    v_mfma_f32_16x16x32_bf16 v[68:71], a[96:99], v[32:35], v[68:71]
    ds_read_b128 v[48:51], v253 offset:38912
    v_mfma_f32_16x16x32_bf16 v[72:75], a[100:103], v[16:19], v[72:75]
    ds_read_b128 v[52:55], v253 offset:39936
    v_mfma_f32_16x16x32_bf16 v[76:79], a[100:103], v[20:23], v[76:79]
    s_add_u32 m0, s25, 68608
    s_nop 0
    buffer_load_dwordx4 v2, s[8:11], s24 offen offset:3072 sc1 lds
    v_mfma_f32_16x16x32_bf16 v[80:83], a[100:103], v[24:27], v[80:83]
    v_mfma_f32_16x16x32_bf16 v[84:87], a[100:103], v[28:31], v[84:87]
    s_add_u32 m0, s25, 73216
    s_nop 0
    buffer_load_dwordx4 v2, s[8:11], s24 offen offset:3584 sc1 lds
    v_mfma_f32_16x16x32_bf16 v[88:91], a[100:103], v[32:35], v[88:91]
    v_mfma_f32_16x16x32_bf16 v[92:95], v[16:19], a[104:107], v[92:95]
    buffer_load_dwordx4 a[56:59], v253, s[8:11], s28 offen offset:2048 sc1
    v_mfma_f32_16x16x32_bf16 v[96:99], v[20:23], a[104:107], v[96:99]
    v_mfma_f32_16x16x32_bf16 v[100:103], v[24:27], a[104:107], v[100:103]
    buffer_load_dwordx4 a[60:63], v229, s[8:11], s28 offen offset:3072 sc1
    s_add_u32 s28, s28, 4096
    v_mfma_f32_16x16x32_bf16 v[104:107], v[28:31], a[104:107], v[104:107]
    v_mfma_f32_16x16x32_bf16 v[108:111], v[32:35], a[104:107], v[108:111]
    buffer_load_dwordx4 a[64:67], v253, s[8:11], s28 offen offset:0 sc1
    v_mfma_f32_16x16x32_bf16 v[112:115], a[108:111], v[16:19], v[112:115]
    v_mfma_f32_16x16x32_bf16 v[116:119], a[108:111], v[20:23], v[116:119]
    buffer_load_dwordx2 v[226:227], v228, s[8:11], s39 offen sc1
    v_mfma_f32_16x16x32_bf16 v[120:123], a[108:111], v[24:27], v[120:123]
    v_mfma_f32_16x16x32_bf16 v[124:127], a[108:111], v[28:31], v[124:127]
    v_mfma_f32_16x16x32_bf16 v[128:131], a[108:111], v[32:35], v[128:131]
    s_waitcnt lgkmcnt(0)
    v_mfma_f32_16x16x32_bf16 v[56:59], a[112:115], v[40:43], v[56:59]
    ds_read_b128 v[16:19], v253 offset:40960
    v_mfma_f32_16x16x32_bf16 v[60:63], a[112:115], v[44:47], v[60:63]
    ds_read_b128 v[20:23], v253 offset:41984
    v_mfma_f32_16x16x32_bf16 v[64:67], a[112:115], v[48:51], v[64:67]
    ds_read_b128 v[24:27], v253 offset:43008
    v_mfma_f32_16x16x32_bf16 v[68:71], a[112:115], v[52:55], v[68:71]
    ds_read_b128 v[28:31], v253 offset:44032
    v_mfma_f32_16x16x32_bf16 v[72:75], a[116:119], v[36:39], v[72:75]
    ds_read_b128 v[32:35], v253 offset:45056
    v_mfma_f32_16x16x32_bf16 v[76:79], a[116:119], v[40:43], v[76:79]
    s_add_u32 m0, s25, 81920
    s_add_u32 s24, s24, 4096
    buffer_load_dwordx4 v2, s[8:11], s24 offen offset:0 sc1 lds
    v_mfma_f32_16x16x32_bf16 v[80:83], a[116:119], v[44:47], v[80:83]
    v_mfma_f32_16x16x32_bf16 v[84:87], a[116:119], v[48:51], v[84:87]
    s_add_u32 m0, s25, 86528
    s_nop 0
    buffer_load_dwordx4 v2, s[8:11], s24 offen offset:512 sc1 lds
    v_mfma_f32_16x16x32_bf16 v[88:91], a[116:119], v[52:55], v[88:91]
    v_mfma_f32_16x16x32_bf16 v[92:95], v[36:39], a[120:123], v[92:95]
    buffer_load_dwordx4 a[68:71], v253, s[8:11], s28 offen offset:1024 sc1
    v_mfma_f32_16x16x32_bf16 v[96:99], v[40:43], a[120:123], v[96:99]
    v_mfma_f32_16x16x32_bf16 v[100:103], v[44:47], a[120:123], v[100:103]
    buffer_load_dwordx4 a[72:75], v253, s[8:11], s28 offen offset:2048 sc1
    v_mfma_f32_16x16x32_bf16 v[104:107], v[48:51], a[120:123], v[104:107]
    v_mfma_f32_16x16x32_bf16 v[108:111], v[52:55], a[120:123], v[108:111]
    buffer_load_dwordx4 a[76:79], v229, s[8:11], s28 offen offset:3072 sc1
    s_add_u32 s28, s28, 4096
    v_mfma_f32_16x16x32_bf16 v[112:115], a[124:127], v[36:39], v[112:115]
    v_mfma_f32_16x16x32_bf16 v[116:119], a[124:127], v[40:43], v[116:119]
    v_mfma_f32_16x16x32_bf16 v[120:123], a[124:127], v[44:47], v[120:123]
    v_mfma_f32_16x16x32_bf16 v[124:127], a[124:127], v[48:51], v[124:127]
    v_mfma_f32_16x16x32_bf16 v[128:131], a[124:127], v[52:55], v[128:131]
    s_waitcnt lgkmcnt(0)
    v_mfma_f32_16x16x32_bf16 v[56:59], a[128:131], v[20:23], v[56:59]
    ds_read_b128 v[36:39], v6 offset:0
    v_mfma_f32_16x16x32_bf16 v[60:63], a[128:131], v[24:27], v[60:63]
    ds_read_b128 v[40:43], v6 offset:1024
    v_mfma_f32_16x16x32_bf16 v[64:67], a[128:131], v[28:31], v[64:67]
    ds_read_b128 v[44:47], v6 offset:2048
    v_mfma_f32_16x16x32_bf16 v[68:71], a[128:131], v[32:35], v[68:71]
    ds_read_b128 v[48:51], v6 offset:3072
    v_mfma_f32_16x16x32_bf16 v[72:75], a[132:135], v[16:19], v[72:75]
    ds_read_b128 v[52:55], v6 offset:4096
    v_mfma_f32_16x16x32_bf16 v[76:79], a[132:135], v[20:23], v[76:79]
    s_add_u32 m0, s26, 61440
    s_add_u32 s7, s27, 6144
    buffer_load_dwordx4 v2, s[8:11], s7 offen sc1 lds
    v_mfma_f32_16x16x32_bf16 v[80:83], a[132:135], v[24:27], v[80:83]
    v_mfma_f32_16x16x32_bf16 v[84:87], a[132:135], v[28:31], v[84:87]
    s_add_u32 m0, s29, 61440
    s_add_u32 s7, s23, 6144
    buffer_load_dwordx4 v2, s[8:11], s7 offen sc1 lds
    v_mfma_f32_16x16x32_bf16 v[88:91], a[132:135], v[32:35], v[88:91]
    v_mfma_f32_16x16x32_bf16 v[92:95], v[16:19], a[136:139], v[92:95]
    buffer_load_dwordx4 a[80:83], v253, s[8:11], s28 offen offset:0 sc1
    v_mfma_f32_16x16x32_bf16 v[96:99], v[20:23], a[136:139], v[96:99]
    v_mfma_f32_16x16x32_bf16 v[100:103], v[24:27], a[136:139], v[100:103]
    buffer_load_dwordx4 a[84:87], v253, s[8:11], s28 offen offset:1024 sc1
    v_mfma_f32_16x16x32_bf16 v[104:107], v[28:31], a[136:139], v[104:107]
    v_mfma_f32_16x16x32_bf16 v[108:111], v[32:35], a[136:139], v[108:111]
    buffer_load_dwordx4 a[88:91], v253, s[8:11], s28 offen offset:2048 sc1
    v_mfma_f32_16x16x32_bf16 v[112:115], a[140:143], v[16:19], v[112:115]
    v_mfma_f32_16x16x32_bf16 v[116:119], a[140:143], v[20:23], v[116:119]
    v_mfma_f32_16x16x32_bf16 v[120:123], a[140:143], v[24:27], v[120:123]
    v_mfma_f32_16x16x32_bf16 v[124:127], a[140:143], v[28:31], v[124:127]
    v_mfma_f32_16x16x32_bf16 v[128:131], a[140:143], v[32:35], v[128:131]
    s_waitcnt vmcnt(10) lgkmcnt(0)
    s_mov_b32 s6, 0
L_wo_poll_15:
    v_cmp_eq_u32 vcc, s76, v226
    v_cmp_eq_u32 s[20:21], s76, v227
    s_and_b64 vcc, vcc, s[20:21]
    s_cmp_eq_u64 vcc, exec
    s_cbranch_scc1 L_wo_ready_16
    buffer_load_dwordx2 v[226:227], v228, s[8:11], s39 offen sc1
    s_add_u32 s6, s6, 1
    s_cmp_lt_u32 s6, 1048576
    s_waitcnt vmcnt(0)
    s_cbranch_scc1 L_wo_poll_15
    s_branch L_main_end
L_wo_ready_16:
    v_mfma_f32_16x16x32_bf16 v[56:59], a[144:147], v[40:43], v[56:59]
    ds_read_b128 v[16:19], v6 offset:5120
    v_mfma_f32_16x16x32_bf16 v[60:63], a[144:147], v[44:47], v[60:63]
    ds_read_b128 v[20:23], v6 offset:6144
    v_mfma_f32_16x16x32_bf16 v[64:67], a[144:147], v[48:51], v[64:67]
    ds_read_b128 v[24:27], v6 offset:7168
    v_mfma_f32_16x16x32_bf16 v[68:71], a[144:147], v[52:55], v[68:71]
    ds_read_b128 v[28:31], v6 offset:8192
    v_mfma_f32_16x16x32_bf16 v[72:75], a[148:151], v[36:39], v[72:75]
    ds_read_b128 v[32:35], v6 offset:9216
    v_mfma_f32_16x16x32_bf16 v[76:79], a[148:151], v[40:43], v[76:79]
    buffer_load_dwordx4 a[92:95], v229, s[8:11], s28 offen offset:3072 sc1
    s_add_u32 s28, s28, 4096
    v_mfma_f32_16x16x32_bf16 v[80:83], a[148:151], v[44:47], v[80:83]
    v_mfma_f32_16x16x32_bf16 v[84:87], a[148:151], v[48:51], v[84:87]
    buffer_load_dwordx4 a[96:99], v253, s[8:11], s28 offen offset:0 sc1
    v_mfma_f32_16x16x32_bf16 v[88:91], a[148:151], v[52:55], v[88:91]
    v_mfma_f32_16x16x32_bf16 v[92:95], v[36:39], a[152:155], v[92:95]
    buffer_load_dwordx4 a[100:103], v253, s[8:11], s28 offen offset:1024 sc1
    v_mfma_f32_16x16x32_bf16 v[96:99], v[40:43], a[152:155], v[96:99]
    v_mfma_f32_16x16x32_bf16 v[100:103], v[44:47], a[152:155], v[100:103]
    buffer_load_dwordx4 a[160:163], v253, s[8:11], s32 offen offset:0 sc1
    v_mfma_f32_16x16x32_bf16 v[104:107], v[48:51], a[152:155], v[104:107]
    v_mfma_f32_16x16x32_bf16 v[108:111], v[52:55], a[152:155], v[108:111]
    v_mfma_f32_16x16x32_bf16 v[112:115], a[156:159], v[36:39], v[112:115]
    v_mfma_f32_16x16x32_bf16 v[116:119], a[156:159], v[40:43], v[116:119]
    v_mfma_f32_16x16x32_bf16 v[120:123], a[156:159], v[44:47], v[120:123]
    v_mfma_f32_16x16x32_bf16 v[124:127], a[156:159], v[48:51], v[124:127]
    v_mfma_f32_16x16x32_bf16 v[128:131], a[156:159], v[52:55], v[128:131]
    s_waitcnt vmcnt(34) lgkmcnt(0)
    v_mfma_f32_16x16x32_bf16 v[56:59], a[0:3], v[20:23], v[56:59]
    ds_read_b128 v[36:39], v6 offset:10240
    v_mfma_f32_16x16x32_bf16 v[60:63], a[0:3], v[24:27], v[60:63]
    ds_read_b128 v[40:43], v6 offset:11264
    v_mfma_f32_16x16x32_bf16 v[64:67], a[0:3], v[28:31], v[64:67]
    ds_read_b128 v[44:47], v6 offset:12288
    v_mfma_f32_16x16x32_bf16 v[68:71], a[0:3], v[32:35], v[68:71]
    ds_read_b128 v[48:51], v6 offset:13312
    v_mfma_f32_16x16x32_bf16 v[72:75], a[4:7], v[16:19], v[72:75]
    ds_read_b128 v[52:55], v6 offset:14336
    v_mfma_f32_16x16x32_bf16 v[76:79], a[4:7], v[20:23], v[76:79]
    buffer_load_dwordx4 a[104:107], v253, s[8:11], s28 offen offset:2048 sc1
    v_mfma_f32_16x16x32_bf16 v[80:83], a[4:7], v[24:27], v[80:83]
    v_mfma_f32_16x16x32_bf16 v[84:87], a[4:7], v[28:31], v[84:87]
    buffer_load_dwordx4 a[108:111], v229, s[8:11], s28 offen offset:3072 sc1
    s_add_u32 s28, s28, 4096
    v_mfma_f32_16x16x32_bf16 v[88:91], a[4:7], v[32:35], v[88:91]
    v_mfma_f32_16x16x32_bf16 v[92:95], v[16:19], a[8:11], v[92:95]
    buffer_load_dwordx4 a[112:115], v253, s[8:11], s28 offen offset:0 sc1
    v_mfma_f32_16x16x32_bf16 v[96:99], v[20:23], a[8:11], v[96:99]
    v_mfma_f32_16x16x32_bf16 v[100:103], v[24:27], a[8:11], v[100:103]
    buffer_load_dwordx4 a[164:167], v253, s[8:11], s33 offen offset:0 sc1
    v_mfma_f32_16x16x32_bf16 v[104:107], v[28:31], a[8:11], v[104:107]
    v_mfma_f32_16x16x32_bf16 v[108:111], v[32:35], a[8:11], v[108:111]
    v_mfma_f32_16x16x32_bf16 v[112:115], a[12:15], v[16:19], v[112:115]
    v_mfma_f32_16x16x32_bf16 v[116:119], a[12:15], v[20:23], v[116:119]
    v_mfma_f32_16x16x32_bf16 v[120:123], a[12:15], v[24:27], v[120:123]
    v_mfma_f32_16x16x32_bf16 v[124:127], a[12:15], v[28:31], v[124:127]
    v_mfma_f32_16x16x32_bf16 v[128:131], a[12:15], v[32:35], v[128:131]
    s_waitcnt vmcnt(11) lgkmcnt(0)
    s_barrier
    v_mfma_f32_16x16x32_bf16 v[56:59], a[16:19], v[40:43], v[56:59]
    ds_read_b128 v[16:19], v6 offset:15360
    v_mfma_f32_16x16x32_bf16 v[60:63], a[16:19], v[44:47], v[60:63]
    ds_read_b128 v[20:23], v6 offset:16384
    v_mfma_f32_16x16x32_bf16 v[64:67], a[16:19], v[48:51], v[64:67]
    ds_read_b128 v[24:27], v6 offset:17408
    v_mfma_f32_16x16x32_bf16 v[68:71], a[16:19], v[52:55], v[68:71]
    ds_read_b128 v[28:31], v6 offset:18432
    v_mfma_f32_16x16x32_bf16 v[72:75], a[20:23], v[36:39], v[72:75]
    ds_read_b128 v[32:35], v6 offset:19456
    v_mfma_f32_16x16x32_bf16 v[76:79], a[20:23], v[40:43], v[76:79]
    buffer_load_dwordx4 a[116:119], v253, s[8:11], s28 offen offset:1024 sc1
    v_mfma_f32_16x16x32_bf16 v[80:83], a[20:23], v[44:47], v[80:83]
    v_mfma_f32_16x16x32_bf16 v[84:87], a[20:23], v[48:51], v[84:87]
    buffer_load_dwordx4 a[120:123], v253, s[8:11], s28 offen offset:2048 sc1
    v_mfma_f32_16x16x32_bf16 v[88:91], a[20:23], v[52:55], v[88:91]
    v_mfma_f32_16x16x32_bf16 v[92:95], v[36:39], a[24:27], v[92:95]
    buffer_load_dwordx4 a[124:127], v229, s[8:11], s28 offen offset:3072 sc1
    s_add_u32 s28, s28, 4096
    v_mfma_f32_16x16x32_bf16 v[96:99], v[40:43], a[24:27], v[96:99]
    v_mfma_f32_16x16x32_bf16 v[100:103], v[44:47], a[24:27], v[100:103]
    buffer_load_dwordx4 a[168:171], v5, s[8:11], s34 offen offset:0 sc1
    v_mfma_f32_16x16x32_bf16 v[104:107], v[48:51], a[24:27], v[104:107]
    v_mfma_f32_16x16x32_bf16 v[108:111], v[52:55], a[24:27], v[108:111]
    v_mfma_f32_16x16x32_bf16 v[112:115], a[28:31], v[36:39], v[112:115]
    v_mfma_f32_16x16x32_bf16 v[116:119], a[28:31], v[40:43], v[116:119]
    v_mfma_f32_16x16x32_bf16 v[120:123], a[28:31], v[44:47], v[120:123]
    v_mfma_f32_16x16x32_bf16 v[124:127], a[28:31], v[48:51], v[124:127]
    v_mfma_f32_16x16x32_bf16 v[128:131], a[28:31], v[52:55], v[128:131]
    s_waitcnt vmcnt(30) lgkmcnt(0)
    v_mfma_f32_16x16x32_bf16 v[56:59], a[32:35], v[20:23], v[56:59]
    ds_read_b128 v[36:39], v6 offset:20480
    v_mfma_f32_16x16x32_bf16 v[60:63], a[32:35], v[24:27], v[60:63]
    ds_read_b128 v[40:43], v6 offset:21504
    v_mfma_f32_16x16x32_bf16 v[64:67], a[32:35], v[28:31], v[64:67]
    ds_read_b128 v[44:47], v6 offset:22528
    v_mfma_f32_16x16x32_bf16 v[68:71], a[32:35], v[32:35], v[68:71]
    ds_read_b128 v[48:51], v6 offset:23552
    v_mfma_f32_16x16x32_bf16 v[72:75], a[36:39], v[16:19], v[72:75]
    ds_read_b128 v[52:55], v6 offset:24576
    v_mfma_f32_16x16x32_bf16 v[76:79], a[36:39], v[20:23], v[76:79]
    buffer_load_dwordx4 a[172:175], v253, s[8:11], s32 offen offset:1024 sc1
    v_mfma_f32_16x16x32_bf16 v[80:83], a[36:39], v[24:27], v[80:83]
    v_mfma_f32_16x16x32_bf16 v[84:87], a[36:39], v[28:31], v[84:87]
    buffer_load_dwordx4 a[176:179], v253, s[8:11], s33 offen offset:1024 sc1
    v_mfma_f32_16x16x32_bf16 v[88:91], a[36:39], v[32:35], v[88:91]
    v_mfma_f32_16x16x32_bf16 v[92:95], v[16:19], a[40:43], v[92:95]
    buffer_load_dwordx4 a[180:183], v5, s[8:11], s34 offen offset:1024 sc1
    v_mfma_f32_16x16x32_bf16 v[96:99], v[20:23], a[40:43], v[96:99]
    v_mfma_f32_16x16x32_bf16 v[100:103], v[24:27], a[40:43], v[100:103]
    buffer_load_dwordx4 a[184:187], v253, s[8:11], s32 offen offset:2048 sc1
    v_mfma_f32_16x16x32_bf16 v[104:107], v[28:31], a[40:43], v[104:107]
    v_mfma_f32_16x16x32_bf16 v[108:111], v[32:35], a[40:43], v[108:111]
    v_mfma_f32_16x16x32_bf16 v[112:115], a[44:47], v[16:19], v[112:115]
    v_mfma_f32_16x16x32_bf16 v[116:119], a[44:47], v[20:23], v[116:119]
    v_mfma_f32_16x16x32_bf16 v[120:123], a[44:47], v[24:27], v[120:123]
    v_mfma_f32_16x16x32_bf16 v[124:127], a[44:47], v[28:31], v[124:127]
    v_mfma_f32_16x16x32_bf16 v[128:131], a[44:47], v[32:35], v[128:131]
    s_waitcnt vmcnt(28) lgkmcnt(0)
    v_mfma_f32_16x16x32_bf16 v[56:59], a[48:51], v[40:43], v[56:59]
    ds_read_b128 v[16:19], v6 offset:25600
    v_mfma_f32_16x16x32_bf16 v[60:63], a[48:51], v[44:47], v[60:63]
    ds_read_b128 v[20:23], v6 offset:26624
    v_mfma_f32_16x16x32_bf16 v[64:67], a[48:51], v[48:51], v[64:67]
    ds_read_b128 v[24:27], v6 offset:27648
    v_mfma_f32_16x16x32_bf16 v[68:71], a[48:51], v[52:55], v[68:71]
    ds_read_b128 v[28:31], v6 offset:28672
    v_mfma_f32_16x16x32_bf16 v[72:75], a[52:55], v[36:39], v[72:75]
    ds_read_b128 v[32:35], v6 offset:29696
    v_mfma_f32_16x16x32_bf16 v[76:79], a[52:55], v[40:43], v[76:79]
    buffer_load_dwordx4 a[188:191], v253, s[8:11], s33 offen offset:2048 sc1
    v_mfma_f32_16x16x32_bf16 v[80:83], a[52:55], v[44:47], v[80:83]
    v_mfma_f32_16x16x32_bf16 v[84:87], a[52:55], v[48:51], v[84:87]
    buffer_load_dwordx4 a[192:195], v5, s[8:11], s34 offen offset:2048 sc1
    v_mfma_f32_16x16x32_bf16 v[88:91], a[52:55], v[52:55], v[88:91]
    v_mfma_f32_16x16x32_bf16 v[92:95], v[36:39], a[56:59], v[92:95]
    buffer_load_dwordx4 a[196:199], v253, s[8:11], s32 offen offset:3072 sc1
    s_add_u32 s32, s32, 4096
    v_mfma_f32_16x16x32_bf16 v[96:99], v[40:43], a[56:59], v[96:99]
    v_mfma_f32_16x16x32_bf16 v[100:103], v[44:47], a[56:59], v[100:103]
    buffer_load_dwordx4 a[200:203], v253, s[8:11], s33 offen offset:3072 sc1
    s_add_u32 s33, s33, 4096
    v_mfma_f32_16x16x32_bf16 v[104:107], v[48:51], a[56:59], v[104:107]
    v_mfma_f32_16x16x32_bf16 v[108:111], v[52:55], a[56:59], v[108:111]
    v_mfma_f32_16x16x32_bf16 v[112:115], a[60:63], v[36:39], v[112:115]
    v_mfma_f32_16x16x32_bf16 v[116:119], a[60:63], v[40:43], v[116:119]
    v_mfma_f32_16x16x32_bf16 v[120:123], a[60:63], v[44:47], v[120:123]
    v_mfma_f32_16x16x32_bf16 v[124:127], a[60:63], v[48:51], v[124:127]
    v_mfma_f32_16x16x32_bf16 v[128:131], a[60:63], v[52:55], v[128:131]
    s_waitcnt vmcnt(25) lgkmcnt(0)
    v_mfma_f32_16x16x32_bf16 v[56:59], a[64:67], v[20:23], v[56:59]
    ds_read_b128 v[36:39], v6 offset:30720
    v_mfma_f32_16x16x32_bf16 v[60:63], a[64:67], v[24:27], v[60:63]
    ds_read_b128 v[40:43], v6 offset:31744
    v_mfma_f32_16x16x32_bf16 v[64:67], a[64:67], v[28:31], v[64:67]
    ds_read_b128 v[44:47], v6 offset:32768
    v_mfma_f32_16x16x32_bf16 v[68:71], a[64:67], v[32:35], v[68:71]
    ds_read_b128 v[48:51], v6 offset:33792
    v_mfma_f32_16x16x32_bf16 v[72:75], a[68:71], v[16:19], v[72:75]
    ds_read_b128 v[52:55], v6 offset:34816
    v_mfma_f32_16x16x32_bf16 v[76:79], a[68:71], v[20:23], v[76:79]
    buffer_load_dwordx4 a[204:207], v5, s[8:11], s34 offen offset:3072 sc1
    s_add_u32 s34, s34, 4096
    v_mfma_f32_16x16x32_bf16 v[80:83], a[68:71], v[24:27], v[80:83]
    v_mfma_f32_16x16x32_bf16 v[84:87], a[68:71], v[28:31], v[84:87]
    buffer_load_dwordx4 a[208:211], v253, s[8:11], s32 offen offset:0 sc1
    v_mfma_f32_16x16x32_bf16 v[88:91], a[68:71], v[32:35], v[88:91]
    v_mfma_f32_16x16x32_bf16 v[92:95], v[16:19], a[72:75], v[92:95]
    buffer_load_dwordx4 a[212:215], v253, s[8:11], s33 offen offset:0 sc1
    v_mfma_f32_16x16x32_bf16 v[96:99], v[20:23], a[72:75], v[96:99]
    v_mfma_f32_16x16x32_bf16 v[100:103], v[24:27], a[72:75], v[100:103]
    buffer_load_dwordx4 a[216:219], v5, s[8:11], s34 offen offset:0 sc1
    v_mfma_f32_16x16x32_bf16 v[104:107], v[28:31], a[72:75], v[104:107]
    v_mfma_f32_16x16x32_bf16 v[108:111], v[32:35], a[72:75], v[108:111]
    v_mfma_f32_16x16x32_bf16 v[112:115], a[76:79], v[16:19], v[112:115]
    v_mfma_f32_16x16x32_bf16 v[116:119], a[76:79], v[20:23], v[116:119]
    v_mfma_f32_16x16x32_bf16 v[120:123], a[76:79], v[24:27], v[120:123]
    v_mfma_f32_16x16x32_bf16 v[124:127], a[76:79], v[28:31], v[124:127]
    v_mfma_f32_16x16x32_bf16 v[128:131], a[76:79], v[32:35], v[128:131]
    s_waitcnt vmcnt(23) lgkmcnt(0)
    v_mfma_f32_16x16x32_bf16 v[56:59], a[80:83], v[40:43], v[56:59]
    ds_read_b128 v[16:19], v6 offset:35840
    v_mfma_f32_16x16x32_bf16 v[60:63], a[80:83], v[44:47], v[60:63]
    ds_read_b128 v[20:23], v6 offset:36864
    v_mfma_f32_16x16x32_bf16 v[64:67], a[80:83], v[48:51], v[64:67]
    ds_read_b128 v[24:27], v6 offset:37888
    v_mfma_f32_16x16x32_bf16 v[68:71], a[80:83], v[52:55], v[68:71]
    ds_read_b128 v[28:31], v6 offset:38912
    v_mfma_f32_16x16x32_bf16 v[72:75], a[84:87], v[36:39], v[72:75]
    ds_read_b128 v[32:35], v6 offset:39936
    v_mfma_f32_16x16x32_bf16 v[76:79], a[84:87], v[40:43], v[76:79]
    buffer_load_dwordx4 a[220:223], v253, s[8:11], s32 offen offset:1024 sc1
    v_mfma_f32_16x16x32_bf16 v[80:83], a[84:87], v[44:47], v[80:83]
    v_mfma_f32_16x16x32_bf16 v[84:87], a[84:87], v[48:51], v[84:87]
    buffer_load_dwordx4 a[224:227], v253, s[8:11], s33 offen offset:1024 sc1
    v_mfma_f32_16x16x32_bf16 v[88:91], a[84:87], v[52:55], v[88:91]
    v_mfma_f32_16x16x32_bf16 v[92:95], v[36:39], a[88:91], v[92:95]
    buffer_load_dwordx4 a[228:231], v5, s[8:11], s34 offen offset:1024 sc1
    v_mfma_f32_16x16x32_bf16 v[96:99], v[40:43], a[88:91], v[96:99]
    v_mfma_f32_16x16x32_bf16 v[100:103], v[44:47], a[88:91], v[100:103]
    buffer_load_dwordx4 a[232:235], v253, s[8:11], s32 offen offset:2048 sc1
    v_mfma_f32_16x16x32_bf16 v[104:107], v[48:51], a[88:91], v[104:107]
    v_mfma_f32_16x16x32_bf16 v[108:111], v[52:55], a[88:91], v[108:111]
    v_mfma_f32_16x16x32_bf16 v[112:115], a[92:95], v[36:39], v[112:115]
    v_mfma_f32_16x16x32_bf16 v[116:119], a[92:95], v[40:43], v[116:119]
    v_mfma_f32_16x16x32_bf16 v[120:123], a[92:95], v[44:47], v[120:123]
    v_mfma_f32_16x16x32_bf16 v[124:127], a[92:95], v[48:51], v[124:127]
    v_mfma_f32_16x16x32_bf16 v[128:131], a[92:95], v[52:55], v[128:131]
    s_waitcnt vmcnt(22) lgkmcnt(0)
    v_mfma_f32_16x16x32_bf16 v[56:59], a[96:99], v[20:23], v[56:59]
    ds_read_b128 v[36:39], v6 offset:40960
    v_mfma_f32_16x16x32_bf16 v[60:63], a[96:99], v[24:27], v[60:63]
    ds_read_b128 v[40:43], v6 offset:41984
    v_mfma_f32_16x16x32_bf16 v[64:67], a[96:99], v[28:31], v[64:67]
    ds_read_b128 v[44:47], v6 offset:43008
    v_mfma_f32_16x16x32_bf16 v[68:71], a[96:99], v[32:35], v[68:71]
    ds_read_b128 v[48:51], v6 offset:44032
    v_mfma_f32_16x16x32_bf16 v[72:75], a[100:103], v[16:19], v[72:75]
    ds_read_b128 v[52:55], v6 offset:45056
    v_mfma_f32_16x16x32_bf16 v[76:79], a[100:103], v[20:23], v[76:79]
    buffer_load_dwordx4 a[236:239], v253, s[8:11], s33 offen offset:2048 sc1
    v_mfma_f32_16x16x32_bf16 v[80:83], a[100:103], v[24:27], v[80:83]
    v_mfma_f32_16x16x32_bf16 v[84:87], a[100:103], v[28:31], v[84:87]
    buffer_load_dwordx4 a[240:243], v5, s[8:11], s34 offen offset:2048 sc1
    v_mfma_f32_16x16x32_bf16 v[88:91], a[100:103], v[32:35], v[88:91]
    v_mfma_f32_16x16x32_bf16 v[92:95], v[16:19], a[104:107], v[92:95]
    buffer_load_dwordx4 a[244:247], v253, s[8:11], s32 offen offset:3072 sc1
    s_add_u32 s32, s32, 4096
    v_mfma_f32_16x16x32_bf16 v[96:99], v[20:23], a[104:107], v[96:99]
    v_mfma_f32_16x16x32_bf16 v[100:103], v[24:27], a[104:107], v[100:103]
    buffer_load_dwordx4 a[248:251], v253, s[8:11], s33 offen offset:3072 sc1
    s_add_u32 s33, s33, 4096
    v_mfma_f32_16x16x32_bf16 v[104:107], v[28:31], a[104:107], v[104:107]
    v_mfma_f32_16x16x32_bf16 v[108:111], v[32:35], a[104:107], v[108:111]
    v_mfma_f32_16x16x32_bf16 v[112:115], a[108:111], v[16:19], v[112:115]
    v_mfma_f32_16x16x32_bf16 v[116:119], a[108:111], v[20:23], v[116:119]
    v_mfma_f32_16x16x32_bf16 v[120:123], a[108:111], v[24:27], v[120:123]
    v_mfma_f32_16x16x32_bf16 v[124:127], a[108:111], v[28:31], v[124:127]
    v_mfma_f32_16x16x32_bf16 v[128:131], a[108:111], v[32:35], v[128:131]
    s_waitcnt vmcnt(21) lgkmcnt(0)
    v_mfma_f32_16x16x32_bf16 v[56:59], a[112:115], v[40:43], v[56:59]
    v_mfma_f32_16x16x32_bf16 v[60:63], a[112:115], v[44:47], v[60:63]
    v_mfma_f32_16x16x32_bf16 v[64:67], a[112:115], v[48:51], v[64:67]
    v_mfma_f32_16x16x32_bf16 v[68:71], a[112:115], v[52:55], v[68:71]
    v_mfma_f32_16x16x32_bf16 v[72:75], a[116:119], v[36:39], v[72:75]
    v_mfma_f32_16x16x32_bf16 v[76:79], a[116:119], v[40:43], v[76:79]
    buffer_load_dwordx4 a[252:255], v5, s[8:11], s34 offen offset:3072 sc1
    s_add_u32 s34, s34, 4096
    v_mfma_f32_16x16x32_bf16 v[80:83], a[116:119], v[44:47], v[80:83]
    v_mfma_f32_16x16x32_bf16 v[84:87], a[116:119], v[48:51], v[84:87]
    buffer_load_dwordx4 a[128:131], v253, s[8:11], s32 offen offset:0 sc1
    v_mfma_f32_16x16x32_bf16 v[88:91], a[116:119], v[52:55], v[88:91]
    v_mfma_f32_16x16x32_bf16 v[92:95], v[36:39], a[120:123], v[92:95]
    buffer_load_dwordx4 a[132:135], v253, s[8:11], s33 offen offset:0 sc1
    v_mfma_f32_16x16x32_bf16 v[96:99], v[40:43], a[120:123], v[96:99]
    v_mfma_f32_16x16x32_bf16 v[100:103], v[44:47], a[120:123], v[100:103]
    buffer_load_dwordx4 a[136:139], v5, s[8:11], s34 offen offset:0 sc1
    v_mfma_f32_16x16x32_bf16 v[104:107], v[48:51], a[120:123], v[104:107]
    v_mfma_f32_16x16x32_bf16 v[108:111], v[52:55], a[120:123], v[108:111]
    v_mfma_f32_16x16x32_bf16 v[112:115], a[124:127], v[36:39], v[112:115]
    v_mfma_f32_16x16x32_bf16 v[116:119], a[124:127], v[40:43], v[116:119]
    v_mfma_f32_16x16x32_bf16 v[120:123], a[124:127], v[44:47], v[120:123]
    v_mfma_f32_16x16x32_bf16 v[124:127], a[124:127], v[48:51], v[124:127]
    v_mfma_f32_16x16x32_bf16 v[128:131], a[124:127], v[52:55], v[128:131]
    v_cvt_pk_bf16_f32 v136, v56, v57
    v_cvt_pk_bf16_f32 v137, v58, v59
    v_cvt_pk_bf16_f32 v140, v60, v61
    v_cvt_pk_bf16_f32 v141, v62, v63
    v_cvt_pk_bf16_f32 v144, v64, v65
    v_cvt_pk_bf16_f32 v145, v66, v67
    v_cvt_pk_bf16_f32 v148, v68, v69
    v_cvt_pk_bf16_f32 v149, v70, v71
    v_cvt_pk_bf16_f32 v152, v72, v73
    buffer_load_dwordx4 a[140:143], v253, s[8:11], s32 offen offset:1024 sc1
    v_cvt_pk_bf16_f32 v153, v74, v75
    v_cvt_pk_bf16_f32 v156, v76, v77
    v_cvt_pk_bf16_f32 v157, v78, v79
    v_cvt_pk_bf16_f32 v160, v80, v81
    v_cvt_pk_bf16_f32 v161, v82, v83
    v_cvt_pk_bf16_f32 v164, v84, v85
    v_cvt_pk_bf16_f32 v165, v86, v87
    v_cvt_pk_bf16_f32 v168, v88, v89
    v_cvt_pk_bf16_f32 v169, v90, v91
    buffer_load_dwordx4 a[144:147], v253, s[8:11], s33 offen offset:1024 sc1
    v_cvt_pk_bf16_f32 v134, v112, v113
    v_cvt_pk_bf16_f32 v154, v114, v115
    v_cvt_pk_bf16_f32 v138, v116, v117
    v_cvt_pk_bf16_f32 v158, v118, v119
    v_cvt_pk_bf16_f32 v142, v120, v121
    v_cvt_pk_bf16_f32 v162, v122, v123
    v_cvt_pk_bf16_f32 v146, v124, v125
    v_cvt_pk_bf16_f32 v166, v126, v127
    v_cvt_pk_bf16_f32 v150, v128, v129
    buffer_load_dwordx4 a[148:151], v5, s[8:11], s34 offen offset:1024 sc1
    v_cvt_pk_bf16_f32 v170, v130, v131
    v_cvt_pk_bf16_f32 v172, v92, v93
    v_cvt_pk_bf16_f32 v173, v94, v95
    v_cvt_pk_bf16_f32 v174, v96, v97
    v_cvt_pk_bf16_f32 v175, v98, v99
    v_cvt_pk_bf16_f32 v176, v100, v101
    v_cvt_pk_bf16_f32 v177, v102, v103
    v_cvt_pk_bf16_f32 v178, v104, v105
    v_cvt_pk_bf16_f32 v179, v106, v107
    buffer_load_dwordx4 a[152:155], v253, s[8:11], s32 offen offset:2048 sc1
    v_cvt_pk_bf16_f32 v180, v108, v109
    v_cvt_pk_bf16_f32 v181, v110, v111
    v_mfma_f32_16x16x32_bf16 v[16:19], v[152:155], v[136:139], v[208:211]
    v_mfma_f32_16x16x32_bf16 v[20:23], v[156:159], v[136:139], v[204:207]
    v_mfma_f32_16x16x32_bf16 v[24:27], v[156:159], v[140:143], v[200:203]
    v_mfma_f32_16x16x32_bf16 v[28:31], v[160:163], v[140:143], v[204:207]
    v_mfma_f32_16x16x32_bf16 v[32:35], v[160:163], v[144:147], v[200:203]
    v_mfma_f32_16x16x32_bf16 v[36:39], v[164:167], v[144:147], v[204:207]
    v_mfma_f32_16x16x32_bf16 v[40:43], v[164:167], v[148:151], v[200:203]
    buffer_load_dwordx4 a[156:159], v253, s[8:11], s33 offen offset:2048 sc1
    v_mfma_f32_16x16x32_bf16 v[44:47], v[168:171], v[148:151], v[204:207]
    v_mfma_f32_16x16x32_bf16 v[56:59], v[132:135], v[192:195], v[196:199]
    v_mfma_f32_16x16x32_bf16 v[60:63], v[136:139], v[192:195], v[196:199]
    v_mfma_f32_16x16x32_bf16 v[64:67], v[140:143], v[192:195], v[196:199]
    v_mfma_f32_16x16x32_bf16 v[68:71], v[144:147], v[192:195], v[196:199]
    v_mfma_f32_16x16x32_bf16 v[72:75], v[148:151], v[192:195], v[196:199]
    v_max3_f32 v92, v16, v17, v18
    v_max3_f32 v96, v19, v20, v21
    v_max3_f32 v93, v24, v25, v26
    buffer_load_dwordx4 a[0:3], v5, s[8:11], s34 offen offset:2048 sc1
    v_max3_f32 v97, v27, v28, v29
    v_max3_f32 v94, v32, v33, v34
    v_max3_f32 v98, v35, v36, v37
    v_max3_f32 v95, v40, v41, v42
    v_max3_f32 v99, v43, v44, v45
    v_max3_f32 v92, v92, v22, v23
    v_max3_f32 v93, v93, v30, v31
    v_max3_f32 v94, v94, v38, v39
    v_max3_f32 v95, v95, v46, v47
    buffer_load_dwordx4 a[4:7], v253, s[8:11], s32 offen offset:3072 sc1
    s_add_u32 s32, s32, 4096
    v_max_f32 v92, v92, v96
    v_max_f32 v93, v93, v97
    v_max_f32 v94, v94, v98
    v_max_f32 v95, v95, v99
    s_mov_b32 s18, 0x3eae1a93
    v_cvt_pk_bf16_f32 v182, v56, v57
    v_permlane32_swap_b32 v92, v93
    v_permlane32_swap_b32 v94, v95
    v_max_f32 v92, v92, v93
    buffer_load_dwordx4 a[8:11], v253, s[8:11], s33 offen offset:3072 sc1
    s_add_u32 s33, s33, 4096
    v_max_f32 v94, v94, v95
    v_cvt_pk_bf16_f32 v183, v58, v59
    v_cvt_pk_bf16_f32 v184, v60, v61
    v_permlane16_swap_b32 v92, v94
    v_max_f32 v92, v92, v94
    v_mul_f32 v92, 0xbeae1a93, v92
    v_mov_b32 v94, v92
    v_cvt_pk_bf16_f32 v185, v62, v63
    v_cvt_pk_bf16_f32 v186, v64, v65
    buffer_load_dwordx4 a[12:15], v5, s[8:11], s34 offen offset:3072 sc1
    s_add_u32 s34, s34, 4096
    v_permlane16_swap_b32 v92, v94
    v_mov_b32 v93, v92
    v_mov_b32 v95, v94
    v_cvt_pk_bf16_f32 v187, v66, v67
    v_cvt_pk_bf16_f32 v188, v68, v69
    v_permlane32_swap_b32 v92, v93
    v_permlane32_swap_b32 v94, v95
    v_cvt_pk_bf16_f32 v189, v70, v71
    v_cvt_pk_bf16_f32 v190, v72, v73
    buffer_load_dwordx4 a[16:19], v253, s[8:11], s32 offen offset:0 sc1
    v_cvt_pk_bf16_f32 v191, v74, v75
    v_fma_f32 v16, v16, s18, v92
    v_fma_f32 v17, v17, s18, v92
    v_fma_f32 v18, v18, s18, v92
    v_fma_f32 v19, v19, s18, v92
    v_fma_f32 v20, v20, s18, v92
    v_fma_f32 v21, v21, s18, v92
    v_fma_f32 v22, v22, s18, v92
    v_fma_f32 v23, v23, s18, v92
    buffer_load_dwordx4 a[20:23], v253, s[8:11], s33 offen offset:0 sc1
    v_exp_f32 v16, v16
    v_exp_f32 v17, v17
    v_exp_f32 v18, v18
    v_exp_f32 v19, v19
    v_exp_f32 v20, v20
    v_exp_f32 v21, v21
    v_exp_f32 v22, v22
    v_exp_f32 v23, v23
    s_nop 0
    buffer_load_dwordx4 a[24:27], v5, s[8:11], s34 offen offset:0 sc1
    v_cvt_pk_bf16_f32 v76, v16, v17
    v_cvt_pk_bf16_f32 v77, v18, v19
    v_cvt_pk_bf16_f32 v78, v20, v21
    v_cvt_pk_bf16_f32 v79, v22, v23
    v_fma_f32 v24, v24, s18, v93
    v_fma_f32 v25, v25, s18, v93
    v_fma_f32 v26, v26, s18, v93
    v_fma_f32 v27, v27, s18, v93
    v_fma_f32 v28, v28, s18, v93
    buffer_load_dwordx4 a[28:31], v253, s[8:11], s32 offen offset:1024 sc1
    v_fma_f32 v29, v29, s18, v93
    v_fma_f32 v30, v30, s18, v93
    v_fma_f32 v31, v31, s18, v93
    v_exp_f32 v24, v24
    v_exp_f32 v25, v25
    v_exp_f32 v26, v26
    v_exp_f32 v27, v27
    v_exp_f32 v28, v28
    v_exp_f32 v29, v29
    buffer_load_dwordx4 a[32:35], v253, s[8:11], s33 offen offset:1024 sc1
    v_exp_f32 v30, v30
    v_exp_f32 v31, v31
    v_mfma_f32_16x16x32_bf16 v[100:103], v[172:175], v[76:79], 0
    v_mfma_f32_16x16x32_bf16 v[116:119], v[182:185], v[76:79], 0
    v_cvt_pk_bf16_f32 v80, v24, v25
    v_cvt_pk_bf16_f32 v81, v26, v27
    v_cvt_pk_bf16_f32 v82, v28, v29
    v_cvt_pk_bf16_f32 v83, v30, v31
    v_fma_f32 v32, v32, s18, v94
    buffer_load_dwordx4 a[36:39], v5, s[8:11], s34 offen offset:1024 sc1
    v_fma_f32 v33, v33, s18, v94
    v_fma_f32 v34, v34, s18, v94
    v_fma_f32 v35, v35, s18, v94
    v_fma_f32 v36, v36, s18, v94
    v_fma_f32 v37, v37, s18, v94
    v_fma_f32 v38, v38, s18, v94
    v_fma_f32 v39, v39, s18, v94
    v_exp_f32 v32, v32
    v_exp_f32 v33, v33
    buffer_load_dwordx4 a[40:43], v253, s[8:11], s32 offen offset:2048 sc1
    v_exp_f32 v34, v34
    v_exp_f32 v35, v35
    v_exp_f32 v36, v36
    v_exp_f32 v37, v37
    v_exp_f32 v38, v38
    v_exp_f32 v39, v39
    v_mfma_f32_16x16x32_bf16 v[104:107], v[174:177], v[80:83], 0
    v_mfma_f32_16x16x32_bf16 v[120:123], v[184:187], v[80:83], 0
    v_cvt_pk_bf16_f32 v84, v32, v33
    buffer_load_dwordx4 a[44:47], v253, s[8:11], s33 offen offset:2048 sc1
    v_cvt_pk_bf16_f32 v85, v34, v35
    v_cvt_pk_bf16_f32 v86, v36, v37
    v_cvt_pk_bf16_f32 v87, v38, v39
    v_fma_f32 v40, v40, s18, v95
    v_fma_f32 v41, v41, s18, v95
    v_fma_f32 v42, v42, s18, v95
    v_fma_f32 v43, v43, s18, v95
    v_fma_f32 v44, v44, s18, v95
    v_fma_f32 v45, v45, s18, v95
    buffer_load_dwordx4 a[48:51], v5, s[8:11], s34 offen offset:2048 sc1
    v_fma_f32 v46, v46, s18, v95
    v_fma_f32 v47, v47, s18, v95
    v_exp_f32 v40, v40
    v_exp_f32 v41, v41
    v_exp_f32 v42, v42
    v_exp_f32 v43, v43
    v_exp_f32 v44, v44
    v_exp_f32 v45, v45
    v_exp_f32 v46, v46
    buffer_load_dwordx4 a[52:55], v253, s[8:11], s32 offen offset:3072 sc1
    s_add_u32 s32, s32, 4096
    v_exp_f32 v47, v47
    v_mfma_f32_16x16x32_bf16 v[108:111], v[176:179], v[84:87], 0
    v_mfma_f32_16x16x32_bf16 v[124:127], v[186:189], v[84:87], 0
    v_cvt_pk_bf16_f32 v88, v40, v41
    v_cvt_pk_bf16_f32 v89, v42, v43
    v_cvt_pk_bf16_f32 v90, v44, v45
    v_cvt_pk_bf16_f32 v91, v46, v47
    v_rcp_f32 v96, v118
    v_rcp_f32 v97, v122
    buffer_load_dwordx4 v[240:243], v9, s[8:11], s37 offen offset:0 sc1
    v_mfma_f32_16x16x32_bf16 v[112:115], v[178:181], v[88:91], 0
    v_mfma_f32_16x16x32_bf16 v[128:131], v[188:191], v[88:91], 0
    v_pk_mul_f32 v[100:101], v[96:97], v[100:101] op_sel:[0,0] op_sel_hi:[0,1]
    v_pk_mul_f32 v[102:103], v[96:97], v[102:103] op_sel:[0,0] op_sel_hi:[0,1]
    v_pk_mul_f32 v[116:117], v[96:97], v[116:117] op_sel:[0,0] op_sel_hi:[0,1]
    v_cvt_pk_bf16_f32 v212, v100, v101
    v_cvt_pk_bf16_f32 v213, v102, v103
    v_cvt_pk_bf16_f32 v220, v116, v117
    v_rcp_f32 v98, v126
    buffer_load_dwordx4 v[244:247], v9, s[8:11], s37 offen offset:1024 sc1
    v_pk_mul_f32 v[104:105], v[96:97], v[104:105] op_sel:[1,0] op_sel_hi:[1,1]
    v_pk_mul_f32 v[106:107], v[96:97], v[106:107] op_sel:[1,0] op_sel_hi:[1,1]
    v_pk_mul_f32 v[120:121], v[96:97], v[120:121] op_sel:[1,0] op_sel_hi:[1,1]
    v_cvt_pk_bf16_f32 v214, v104, v105
    v_cvt_pk_bf16_f32 v215, v106, v107
    v_cvt_pk_bf16_f32 v221, v120, v121
    v_rcp_f32 v99, v130
    v_permlane16_swap_b32 v212, v214
    v_permlane16_swap_b32 v213, v215
    buffer_load_dwordx4 v[248:251], v7, s[8:11], s37 offen offset:2048 sc1
    v_pk_mul_f32 v[108:109], v[98:99], v[108:109] op_sel:[0,0] op_sel_hi:[0,1]
    v_pk_mul_f32 v[110:111], v[98:99], v[110:111] op_sel:[0,0] op_sel_hi:[0,1]
    v_pk_mul_f32 v[124:125], v[98:99], v[124:125] op_sel:[0,0] op_sel_hi:[0,1]
    v_cvt_pk_bf16_f32 v216, v108, v109
    v_cvt_pk_bf16_f32 v217, v110, v111
    v_cvt_pk_bf16_f32 v222, v124, v125
    v_pk_mul_f32 v[112:113], v[98:99], v[112:113] op_sel:[1,0] op_sel_hi:[1,1]
    v_pk_mul_f32 v[114:115], v[98:99], v[114:115] op_sel:[1,0] op_sel_hi:[1,1]
    v_pk_mul_f32 v[128:129], v[98:99], v[128:129] op_sel:[1,0] op_sel_hi:[1,1]
    buffer_load_dword v252, v8, s[8:11], s47 offen sc1
    v_cvt_pk_bf16_f32 v218, v112, v113
    v_cvt_pk_bf16_f32 v219, v114, v115
    v_cvt_pk_bf16_f32 v223, v128, v129
    s_lshl_b32 s7, s3, 2
    s_add_u32 s7, s7, 94208
    v_permlane16_swap_b32 v220, v221
    v_permlane16_swap_b32 v222, v223
    v_add_u32 v11, s7, v253
    v_lshrrev_b32 v10, 3, v0
    v_permlane32_swap_b32 v220, v222
    v_mul_u32_u24 v10, 9216, v10
    ds_write_b32 v11, v220
    v_permlane16_swap_b32 v216, v218
    v_permlane16_swap_b32 v217, v219
    s_mul_i32 s7, s40, 1152
    s_add_u32 s22, s22, s7
    s_add_u32 s22, s22, 41156608
    s_lshl_b32 s7, s3, 8
    s_add_u32 s23, s22, s7
    s_add_u32 s24, s23, 36864
    buffer_store_dwordx4 v[212:215], v9, s[8:11], s23 offen sc1
    buffer_store_dwordx4 v[216:219], v9, s[8:11], s24 offen sc1
    v_and_b32 v11, 7, v0
    v_lshl_add_u32 v10, v11, 4, v10
    s_cmp_eq_u32 s3, 3
    s_cselect_b32 s7, 0, 1073741824
    v_add_u32 v10, s7, v10
    v_add_u32 v11, 94208, v253
    s_waitcnt lgkmcnt(0)
    s_barrier
    ds_read_b128 v[220:223], v11
    s_waitcnt lgkmcnt(0)
    buffer_store_dwordx4 v[220:223], v10, s[8:11], s22 offen offset:1024 sc1
    v_lshlrev_b32 v15, 7, v0
    s_lshl_b32 s6, s40, 2
    s_add_u32 s6, s6, s44
    v_mov_b32 v1, s76
    s_mov_b64 vcc, 0xff
    s_waitcnt vmcnt(0)
    s_barrier
    s_cmp_lg_u32 s3, 0
    s_cbranch_scc1 L_pub_17
    s_mov_b64 exec, vcc
    buffer_store_dword v1, v15, s[8:11], s6 offen sc1
L_pub_17:
    s_mov_b64 exec, -1
    buffer_load_dwordx4 a[56:59], v253, s[8:11], s33 offen offset:3072 sc1
    s_add_u32 s33, s33, 4096
    buffer_load_dwordx4 a[60:63], v5, s[8:11], s34 offen offset:3072 sc1
    s_add_u32 s34, s34, 4096
    buffer_load_dwordx4 a[64:67], v253, s[8:11], s32 offen offset:0 sc1
    buffer_load_dwordx4 a[68:71], v253, s[8:11], s33 offen offset:0 sc1
    buffer_load_dwordx4 a[72:75], v5, s[8:11], s34 offen offset:0 sc1
    buffer_load_dwordx4 a[76:79], v253, s[8:11], s32 offen offset:1024 sc1
    buffer_load_dwordx4 a[80:83], v253, s[8:11], s33 offen offset:1024 sc1
    buffer_load_dwordx4 a[84:87], v5, s[8:11], s34 offen offset:1024 sc1
    s_cmp_lg_u32 s42, 0
    s_cbranch_scc1 L_swz_18
    s_cmp_eq_u32 s93, 2
    s_cselect_b32 s6, 2, 3
    s_mov_b32 s7, 512
    s_cmov_b32 s7, 2048
    v_lshrrev_b32 v14, 4, v0
    v_lshlrev_b32 v14, s6, v14
    v_bfe_u32 v15, v0, 2, 2
    v_add_u32 v14, v14, v15
    v_mul_u32_u24 v14, 128, v14
    v_and_b32 v15, 3, v0
    v_lshl_add_u32 v14, v15, 3, v14
    v_add_u32 v14, s79, v14
    v_add_u32 v15, s7, v14
    ds_read_b64_tr_b16 v[76:77], v14 offset:0
    ds_read_b64_tr_b16 v[78:79], v15 offset:0
    ds_read_b64_tr_b16 v[80:81], v14 offset:32
    ds_read_b64_tr_b16 v[82:83], v15 offset:32
    ds_read_b64_tr_b16 v[84:85], v14 offset:64
    ds_read_b64_tr_b16 v[86:87], v15 offset:64
    ds_read_b64_tr_b16 v[88:89], v14 offset:96
    ds_read_b64_tr_b16 v[90:91], v15 offset:96
    ds_read_b64_tr_b16 v[92:93], v14 offset:4096
    ds_read_b64_tr_b16 v[94:95], v15 offset:4096
    ds_read_b64_tr_b16 v[96:97], v14 offset:4128
    ds_read_b64_tr_b16 v[98:99], v15 offset:4128
    ds_read_b64_tr_b16 v[176:177], v14 offset:4160
    ds_read_b64_tr_b16 v[178:179], v15 offset:4160
    ds_read_b64_tr_b16 v[180:181], v14 offset:4192
    ds_read_b64_tr_b16 v[182:183], v15 offset:4192
    ds_read_b64_tr_b16 v[196:197], v14 offset:8192
    ds_read_b64_tr_b16 v[198:199], v15 offset:8192
    ds_read_b64_tr_b16 v[200:201], v14 offset:8224
    ds_read_b64_tr_b16 v[202:203], v15 offset:8224
    ds_read_b64_tr_b16 v[204:205], v14 offset:8256
    ds_read_b64_tr_b16 v[206:207], v15 offset:8256
    ds_read_b64_tr_b16 v[208:209], v14 offset:8288
    ds_read_b64_tr_b16 v[210:211], v15 offset:8288
    ds_read_b64_tr_b16 v[212:213], v14 offset:12288
    ds_read_b64_tr_b16 v[214:215], v15 offset:12288
    ds_read_b64_tr_b16 v[216:217], v14 offset:12320
    ds_read_b64_tr_b16 v[218:219], v15 offset:12320
    ds_read_b64_tr_b16 v[220:221], v14 offset:12352
    ds_read_b64_tr_b16 v[222:223], v15 offset:12352
    ds_read_b64_tr_b16 v[228:229], v14 offset:12384
    ds_read_b64_tr_b16 v[230:231], v15 offset:12384
    s_mul_i32 s68, s40, 1990656
    s_add_u32 s68, s68, 3145728
    s_cmp_eq_u32 s93, 2
    s_cbranch_scc1 L_swz_down_19
    s_mul_i32 s6, s84, 349526
    s_lshr_b32 s6, s6, 20
    s_mul_i32 s7, s6, 3
    s_sub_u32 s7, s84, s7
    s_mul_i32 s6, s6, 6
    s_add_u32 s7, s7, s6
    s_mul_i32 s6, s88, 36
    s_add_u32 s7, s7, s6
    s_mul_i32 s6, s93, 3
    s_add_u32 s7, s7, s6
    s_lshl_b32 s7, s7, 10
    s_add_u32 s7, s7, s68
    s_add_u32 s80, s7, 0
    s_add_u32 s81, s7, 497664
    s_add_u32 s82, s7, 995328
    s_add_u32 s83, s7, 1492992
    s_mul_i32 s6, s85, 349526
    s_lshr_b32 s6, s6, 20
    s_mul_i32 s7, s6, 3
    s_sub_u32 s7, s85, s7
    s_mul_i32 s6, s6, 6
    s_add_u32 s7, s7, s6
    s_mul_i32 s6, s89, 36
    s_add_u32 s7, s7, s6
    s_mul_i32 s6, s93, 3
    s_add_u32 s7, s7, s6
    s_lshl_b32 s7, s7, 10
    s_add_u32 s7, s7, s68
    s_add_u32 s64, s7, 0
    s_add_u32 s65, s7, 497664
    s_add_u32 s18, s7, 995328
    s_add_u32 s19, s7, 1492992
    s_mul_i32 s6, s86, 349526
    s_lshr_b32 s6, s6, 20
    s_mul_i32 s7, s6, 3
    s_sub_u32 s7, s86, s7
    s_mul_i32 s6, s6, 6
    s_add_u32 s7, s7, s6
    s_mul_i32 s6, s90, 36
    s_add_u32 s7, s7, s6
    s_mul_i32 s6, s93, 3
    s_add_u32 s7, s7, s6
    s_lshl_b32 s7, s7, 10
    s_add_u32 s7, s7, s68
    s_add_u32 s20, s7, 0
    s_add_u32 s21, s7, 497664
    s_add_u32 s22, s7, 995328
    s_add_u32 s25, s7, 1492992
    s_mul_i32 s6, s87, 349526
    s_lshr_b32 s6, s6, 20
    s_mul_i32 s7, s6, 3
    s_sub_u32 s7, s87, s7
    s_mul_i32 s6, s6, 6
    s_add_u32 s7, s7, s6
    s_mul_i32 s6, s91, 36
    s_add_u32 s7, s7, s6
    s_mul_i32 s6, s93, 3
    s_add_u32 s7, s7, s6
    s_lshl_b32 s7, s7, 10
    s_add_u32 s7, s7, s68
    s_add_u32 s26, s7, 0
    s_add_u32 s27, s7, 497664
    s_add_u32 s28, s7, 995328
    s_add_u32 s29, s7, 1492992
    s_branch L_swz_dest_20
L_swz_down_19:
    s_mul_i32 s7, s88, 18
    s_add_u32 s7, s7, s84
    s_add_u32 s7, s7, 324
    s_lshl_b32 s7, s7, 10
    s_add_u32 s7, s7, s68
    s_add_u32 s80, s7, 0
    s_add_u32 s81, s7, 497664
    s_add_u32 s82, s7, 995328
    s_add_u32 s83, s7, 1492992
    s_mul_i32 s7, s89, 18
    s_add_u32 s7, s7, s85
    s_add_u32 s7, s7, 324
    s_lshl_b32 s7, s7, 10
    s_add_u32 s7, s7, s68
    s_add_u32 s64, s7, 0
    s_add_u32 s65, s7, 497664
    s_add_u32 s18, s7, 995328
    s_add_u32 s19, s7, 1492992
    s_mul_i32 s7, s90, 18
    s_add_u32 s7, s7, s86
    s_add_u32 s7, s7, 324
    s_lshl_b32 s7, s7, 10
    s_add_u32 s7, s7, s68
    s_add_u32 s20, s7, 0
    s_add_u32 s21, s7, 497664
    s_add_u32 s22, s7, 995328
    s_add_u32 s25, s7, 1492992
    s_mul_i32 s7, s91, 18
    s_add_u32 s7, s7, s87
    s_add_u32 s7, s7, 324
    s_lshl_b32 s7, s7, 10
    s_add_u32 s7, s7, s68
    s_add_u32 s26, s7, 0
    s_add_u32 s27, s7, 497664
    s_add_u32 s28, s7, 995328
    s_add_u32 s29, s7, 1492992
L_swz_dest_20:
    s_mov_b32 s72, s8
    s_mov_b32 s73, s9
    s_mov_b32 s74, 268435456
    s_waitcnt lgkmcnt(0)
    buffer_store_dwordx4 v[76:79], v253, s[72:75], s80 offen sc1
    buffer_store_dwordx4 v[80:83], v253, s[72:75], s81 offen sc1
    buffer_store_dwordx4 v[84:87], v253, s[72:75], s82 offen sc1
    buffer_store_dwordx4 v[88:91], v253, s[72:75], s83 offen sc1
    buffer_store_dwordx4 v[92:95], v253, s[72:75], s64 offen sc1
    buffer_store_dwordx4 v[96:99], v253, s[72:75], s65 offen sc1
    buffer_store_dwordx4 v[176:179], v253, s[72:75], s18 offen sc1
    buffer_store_dwordx4 v[180:183], v253, s[72:75], s19 offen sc1
    buffer_store_dwordx4 v[196:199], v253, s[72:75], s20 offen sc1
    buffer_store_dwordx4 v[200:203], v253, s[72:75], s21 offen sc1
    buffer_store_dwordx4 v[204:207], v253, s[72:75], s22 offen sc1
    buffer_store_dwordx4 v[208:211], v253, s[72:75], s25 offen sc1
    buffer_store_dwordx4 v[212:215], v253, s[72:75], s26 offen sc1
    buffer_store_dwordx4 v[216:219], v253, s[72:75], s27 offen sc1
    buffer_store_dwordx4 v[220:223], v253, s[72:75], s28 offen sc1
    buffer_store_dwordx4 v[228:231], v253, s[72:75], s29 offen sc1
    s_lshr_b32 s7, s2, 3
    s_lshl_b32 s7, s7, 2
    s_add_u32 s7, s7, s3
    s_lshl_b32 s7, s7, 9
    v_lshrrev_b32 v1, 1, v253
    v_add_u32 v1, s7, v1
    buffer_load_dwordx2 v[14:15], v1, s[96:99], 0 offen
L_swz_18:
    s_and_b32 s7, s3, 1
    s_mul_i32 s7, s7, 18432
    s_add_u32 s24, s30, s7
    s_lshr_b32 s7, s3, 1
    s_lshl_b32 s7, s7, 9
    s_add_u32 s24, s24, s7
    s_add_u32 s24, s24, 41156608
    s_mov_b32 s16, 0xffff0000
    v_lshlrev_b32 v124, 16, v240
    v_and_b32 v125, s16, v240
    v_lshlrev_b32 v126, 16, v241
    v_and_b32 v127, s16, v241
    v_lshlrev_b32 v128, 16, v242
    v_and_b32 v129, s16, v242
    v_lshlrev_b32 v130, 16, v243
    v_and_b32 v131, s16, v243
    v_lshlrev_b32 v132, 16, v244
    v_and_b32 v133, s16, v244
    v_lshlrev_b32 v134, 16, v245
    v_and_b32 v135, s16, v245
    v_lshlrev_b32 v136, 16, v246
    v_and_b32 v137, s16, v246
    v_lshlrev_b32 v138, 16, v247
    v_and_b32 v139, s16, v247
    v_lshlrev_b32 v140, 16, v248
    v_and_b32 v141, s16, v248
    v_lshlrev_b32 v142, 16, v249
    v_and_b32 v143, s16, v249
    v_lshlrev_b32 v144, 16, v250
    v_and_b32 v145, s16, v250
    v_lshlrev_b32 v146, 16, v251
    v_and_b32 v147, s16, v251
    s_cmp_eq_u32 s3, 1
    s_cselect_b32 s7, 16, 0
    v_lshlrev_b32 v12, 2, v0
    v_cmp_gt_u32 vcc, s7, v0
    v_add_u32 v10, 40960, v12
    v_add_u32 v11, 41472, v12
    v_cndmask_b32 v10, v11, v10, vcc
    v_and_b32 v11, 0x7c, v12
    v_cmp_gt_u32 vcc, 32, v0
    v_mov_b32 v13, 1073741824
    s_and_b32 s7, s40, 3
    s_lshl_b32 s45, s45, 2
    v_cndmask_b32 v8, v13, v12, vcc
    s_add_u32 s6, s7, s3
    s_cmp_eq_u32 s6, 0
    s_cselect_b32 s6, 0, 1073741824
    v_add_u32 v6, s6, v8
    s_add_u32 s45, s45, s7
    s_lshl_b32 s45, s45, 2
    s_add_u32 s45, s45, s3
    s_lshl_b32 s45, s45, 7
    s_add_u32 s45, s45, s43
    s_add_u32 s45, s45, 48300032
    s_cmp_eq_u32 s3, 0
    s_cselect_b32 s35, 1.0, 0
    s_lshl_b32 s7, s40, 2
    s_add_u32 s7, s7, s3
    s_mul_i32 s23, s7, 497664
    s_add_u32 s23, s23, 3145728
    s_add_u32 s50, s23, 497664
    s_mul_i32 s50, s50, s42
    v_mov_b32 v184, v253
    v_add_u32 v185, 4096, v253
    v_add_u32 v186, 8192, v253
    v_add_u32 v187, 12288, v253
    v_add_u32 v188, 16384, v253
    v_add_u32 v189, 20480, v253
    v_add_u32 v190, 24576, v253
    v_add_u32 v191, 28672, v253
    v_add_u32 v192, 32768, v253
    s_cmp_lg_u32 s3, 3
    s_cbranch_scc1 L_pollout_23
    s_lshl_b32 s7, s40, 7
    s_add_u32 s7, s7, s44
    s_add_u32 s52, s4, s7
    s_addc_u32 s53, s5, 0
    s_mov_b32 s6, 0
L_poll_21:
    s_load_dwordx8 s[56:63], s[52:53], 0 glc
    s_add_u32 s6, s6, 1
    s_waitcnt lgkmcnt(0)
    s_xor_b64 s[56:57], s[56:57], s[76:77]
    s_xor_b64 s[58:59], s[58:59], s[76:77]
    s_xor_b64 s[60:61], s[60:61], s[76:77]
    s_xor_b64 s[62:63], s[62:63], s[76:77]
    s_or_b64 s[56:57], s[56:57], s[58:59]
    s_or_b64 s[60:61], s[60:61], s[62:63]
    s_or_b64 s[56:57], s[56:57], s[60:61]
    s_cbranch_scc0 L_polled_22
    s_cmp_lt_u32 s6, 1048576
    s_cbranch_scc1 L_poll_21
    s_branch L_main_end
L_polled_22:
L_pollout_23:
    s_barrier
    s_lshl_b32 m0, s3, 10
    s_nop 0
    buffer_load_dwordx4 v2, s[8:11], s24 offen sc1 lds
    s_add_u32 m0, m0, 4096
    s_add_u32 s24, s24, 1024
    buffer_load_dwordx4 v2, s[8:11], s24 offen sc1 lds
    s_add_u32 m0, m0, 4096
    s_add_u32 s24, s24, 1024
    buffer_load_dwordx4 v2, s[8:11], s24 offen sc1 lds
    s_add_u32 m0, m0, 4096
    s_add_u32 s24, s24, 1024
    buffer_load_dwordx4 v2, s[8:11], s24 offen sc1 lds
    s_add_u32 m0, m0, 4096
    s_add_u32 s24, s24, 1024
    buffer_load_dwordx4 v2, s[8:11], s24 offen sc1 lds
    s_add_u32 m0, m0, 4096
    s_add_u32 s24, s24, 1024
    buffer_load_dwordx4 v2, s[8:11], s24 offen sc1 lds
    s_add_u32 m0, m0, 4096
    s_add_u32 s24, s24, 1024
    buffer_load_dwordx4 v2, s[8:11], s24 offen sc1 lds
    s_add_u32 m0, m0, 4096
    s_add_u32 s24, s24, 1024
    buffer_load_dwordx4 v2, s[8:11], s24 offen sc1 lds
    s_add_u32 m0, m0, 4096
    s_add_u32 s24, s24, 1024
    buffer_load_dwordx4 v2, s[8:11], s24 offen sc1 lds
    s_waitcnt vmcnt(4)
    s_barrier
    ds_read_b128 v[160:163], v253 offset:0
    ds_read_b128 v[164:167], v253 offset:1024
    s_waitcnt lgkmcnt(0)
    v_mfma_f32_16x16x32_bf16 v[100:103], a[160:163], v[160:163], 0
    ds_read_b128 v[168:171], v253 offset:2048
    v_mfma_f32_16x16x32_bf16 v[104:107], a[160:163], v[164:167], 0
    ds_read_b128 v[172:175], v253 offset:3072
    v_mfma_f32_16x16x32_bf16 v[108:111], a[164:167], v[160:163], 0
    v_mfma_f32_16x16x32_bf16 v[112:115], a[164:167], v[164:167], 0
    buffer_load_dwordx4 v[16:19], v184, s[48:51], s23 offen offset:0 sc1
    v_mfma_f32_16x16x32_bf16 v[116:119], a[168:171], v[160:163], 0
    v_mfma_f32_16x16x32_bf16 v[120:123], a[168:171], v[164:167], 0
    s_waitcnt lgkmcnt(0)
    v_mfma_f32_16x16x32_bf16 v[100:103], a[172:175], v[168:171], v[100:103]
    ds_read_b128 v[160:163], v253 offset:4096
    v_mfma_f32_16x16x32_bf16 v[104:107], a[172:175], v[172:175], v[104:107]
    ds_read_b128 v[164:167], v253 offset:5120
    v_mfma_f32_16x16x32_bf16 v[108:111], a[176:179], v[168:171], v[108:111]
    v_mfma_f32_16x16x32_bf16 v[112:115], a[176:179], v[172:175], v[112:115]
    buffer_load_dwordx4 v[20:23], v184, s[48:51], s23 offen offset:1024 sc1
    v_mfma_f32_16x16x32_bf16 v[116:119], a[180:183], v[168:171], v[116:119]
    v_mfma_f32_16x16x32_bf16 v[120:123], a[180:183], v[172:175], v[120:123]
    s_waitcnt lgkmcnt(0)
    v_mfma_f32_16x16x32_bf16 v[100:103], a[184:187], v[160:163], v[100:103]
    ds_read_b128 v[168:171], v253 offset:6144
    v_mfma_f32_16x16x32_bf16 v[104:107], a[184:187], v[164:167], v[104:107]
    ds_read_b128 v[172:175], v253 offset:7168
    v_mfma_f32_16x16x32_bf16 v[108:111], a[188:191], v[160:163], v[108:111]
    v_mfma_f32_16x16x32_bf16 v[112:115], a[188:191], v[164:167], v[112:115]
    buffer_load_dwordx4 v[24:27], v184, s[48:51], s23 offen offset:2048 sc1
    v_mfma_f32_16x16x32_bf16 v[116:119], a[192:195], v[160:163], v[116:119]
    v_mfma_f32_16x16x32_bf16 v[120:123], a[192:195], v[164:167], v[120:123]
    s_waitcnt lgkmcnt(0)
    v_mfma_f32_16x16x32_bf16 v[100:103], a[196:199], v[168:171], v[100:103]
    ds_read_b128 v[160:163], v253 offset:8192
    v_mfma_f32_16x16x32_bf16 v[104:107], a[196:199], v[172:175], v[104:107]
    ds_read_b128 v[164:167], v253 offset:9216
    v_mfma_f32_16x16x32_bf16 v[108:111], a[200:203], v[168:171], v[108:111]
    v_mfma_f32_16x16x32_bf16 v[112:115], a[200:203], v[172:175], v[112:115]
    buffer_load_dwordx4 v[28:31], v184, s[48:51], s23 offen offset:3072 sc1
    v_mfma_f32_16x16x32_bf16 v[116:119], a[204:207], v[168:171], v[116:119]
    v_mfma_f32_16x16x32_bf16 v[120:123], a[204:207], v[172:175], v[120:123]
    s_waitcnt lgkmcnt(0)
    v_mfma_f32_16x16x32_bf16 v[100:103], a[208:211], v[160:163], v[100:103]
    ds_read_b128 v[168:171], v253 offset:10240
    v_mfma_f32_16x16x32_bf16 v[104:107], a[208:211], v[164:167], v[104:107]
    ds_read_b128 v[172:175], v253 offset:11264
    v_mfma_f32_16x16x32_bf16 v[108:111], a[212:215], v[160:163], v[108:111]
    v_mfma_f32_16x16x32_bf16 v[112:115], a[212:215], v[164:167], v[112:115]
    buffer_load_dwordx4 v[32:35], v185, s[48:51], s23 offen offset:0 sc1
    v_mfma_f32_16x16x32_bf16 v[116:119], a[216:219], v[160:163], v[116:119]
    v_mfma_f32_16x16x32_bf16 v[120:123], a[216:219], v[164:167], v[120:123]
    s_waitcnt lgkmcnt(0)
    v_mfma_f32_16x16x32_bf16 v[100:103], a[220:223], v[168:171], v[100:103]
    ds_read_b128 v[160:163], v253 offset:12288
    v_mfma_f32_16x16x32_bf16 v[104:107], a[220:223], v[172:175], v[104:107]
    ds_read_b128 v[164:167], v253 offset:13312
    v_mfma_f32_16x16x32_bf16 v[108:111], a[224:227], v[168:171], v[108:111]
    v_mfma_f32_16x16x32_bf16 v[112:115], a[224:227], v[172:175], v[112:115]
    buffer_load_dwordx4 v[36:39], v185, s[48:51], s23 offen offset:1024 sc1
    v_mfma_f32_16x16x32_bf16 v[116:119], a[228:231], v[168:171], v[116:119]
    v_mfma_f32_16x16x32_bf16 v[120:123], a[228:231], v[172:175], v[120:123]
    s_waitcnt lgkmcnt(0)
    v_mfma_f32_16x16x32_bf16 v[100:103], a[232:235], v[160:163], v[100:103]
    ds_read_b128 v[168:171], v253 offset:14336
    v_mfma_f32_16x16x32_bf16 v[104:107], a[232:235], v[164:167], v[104:107]
    ds_read_b128 v[172:175], v253 offset:15360
    v_mfma_f32_16x16x32_bf16 v[108:111], a[236:239], v[160:163], v[108:111]
    v_mfma_f32_16x16x32_bf16 v[112:115], a[236:239], v[164:167], v[112:115]
    buffer_load_dwordx4 v[40:43], v185, s[48:51], s23 offen offset:2048 sc1
    v_mfma_f32_16x16x32_bf16 v[116:119], a[240:243], v[160:163], v[116:119]
    v_mfma_f32_16x16x32_bf16 v[120:123], a[240:243], v[164:167], v[120:123]
    s_waitcnt lgkmcnt(0)
    v_mfma_f32_16x16x32_bf16 v[100:103], a[244:247], v[168:171], v[100:103]
    ds_read_b128 v[160:163], v253 offset:16384
    v_mfma_f32_16x16x32_bf16 v[104:107], a[244:247], v[172:175], v[104:107]
    ds_read_b128 v[164:167], v253 offset:17408
    v_mfma_f32_16x16x32_bf16 v[108:111], a[248:251], v[168:171], v[108:111]
    v_mfma_f32_16x16x32_bf16 v[112:115], a[248:251], v[172:175], v[112:115]
    buffer_load_dwordx4 v[44:47], v185, s[48:51], s23 offen offset:3072 sc1
    v_mfma_f32_16x16x32_bf16 v[116:119], a[252:255], v[168:171], v[116:119]
    v_mfma_f32_16x16x32_bf16 v[120:123], a[252:255], v[172:175], v[120:123]
    s_waitcnt lgkmcnt(0)
    v_mfma_f32_16x16x32_bf16 v[100:103], a[128:131], v[160:163], v[100:103]
    ds_read_b128 v[168:171], v253 offset:18432
    v_mfma_f32_16x16x32_bf16 v[104:107], a[128:131], v[164:167], v[104:107]
    ds_read_b128 v[172:175], v253 offset:19456
    v_mfma_f32_16x16x32_bf16 v[108:111], a[132:135], v[160:163], v[108:111]
    v_mfma_f32_16x16x32_bf16 v[112:115], a[132:135], v[164:167], v[112:115]
    buffer_load_dwordx4 v[48:51], v186, s[48:51], s23 offen offset:0 sc1
    v_mfma_f32_16x16x32_bf16 v[116:119], a[136:139], v[160:163], v[116:119]
    v_mfma_f32_16x16x32_bf16 v[120:123], a[136:139], v[164:167], v[120:123]
    s_waitcnt vmcnt(9) lgkmcnt(0)
    s_barrier
    s_xor_b32 s7, s3, 0
    s_or_b32 s7, s7, s42
    s_cbranch_scc1 L_swz_24
    v_lshlrev_b32 v15, 10, v0
    s_lshl_b32 s6, s40, 7
    s_lshl_b32 s7, s41, 2
    s_add_u32 s6, s6, s7
    s_add_u32 s6, s6, 19464192
    s_mov_b64 exec, 0xffffffff
    v_lshlrev_b32 v15, 10, v0
    v_mov_b32 v1, s76
    buffer_store_dword v1, v15, s[8:11], s6 offen sc1
    s_mov_b64 exec, -1
L_swz_24:
    v_mfma_f32_16x16x32_bf16 v[100:103], a[140:143], v[168:171], v[100:103]
    ds_read_b128 v[160:163], v253 offset:20480
    v_mfma_f32_16x16x32_bf16 v[104:107], a[140:143], v[172:175], v[104:107]
    ds_read_b128 v[164:167], v253 offset:21504
    v_mfma_f32_16x16x32_bf16 v[108:111], a[144:147], v[168:171], v[108:111]
    v_mfma_f32_16x16x32_bf16 v[112:115], a[144:147], v[172:175], v[112:115]
    buffer_load_dwordx4 v[52:55], v186, s[48:51], s23 offen offset:1024 sc1
    v_mfma_f32_16x16x32_bf16 v[116:119], a[148:151], v[168:171], v[116:119]
    v_mfma_f32_16x16x32_bf16 v[120:123], a[148:151], v[172:175], v[120:123]
    s_waitcnt lgkmcnt(0)
    v_mfma_f32_16x16x32_bf16 v[100:103], a[152:155], v[160:163], v[100:103]
    ds_read_b128 v[168:171], v253 offset:22528
    v_mfma_f32_16x16x32_bf16 v[104:107], a[152:155], v[164:167], v[104:107]
    ds_read_b128 v[172:175], v253 offset:23552
    v_mfma_f32_16x16x32_bf16 v[108:111], a[156:159], v[160:163], v[108:111]
    v_mfma_f32_16x16x32_bf16 v[112:115], a[156:159], v[164:167], v[112:115]
    buffer_load_dwordx4 v[56:59], v186, s[48:51], s23 offen offset:2048 sc1
    v_mfma_f32_16x16x32_bf16 v[116:119], a[0:3], v[160:163], v[116:119]
    v_mfma_f32_16x16x32_bf16 v[120:123], a[0:3], v[164:167], v[120:123]
    s_waitcnt lgkmcnt(0)
    v_mfma_f32_16x16x32_bf16 v[100:103], a[4:7], v[168:171], v[100:103]
    ds_read_b128 v[160:163], v253 offset:24576
    v_mfma_f32_16x16x32_bf16 v[104:107], a[4:7], v[172:175], v[104:107]
    ds_read_b128 v[164:167], v253 offset:25600
    v_mfma_f32_16x16x32_bf16 v[108:111], a[8:11], v[168:171], v[108:111]
    v_mfma_f32_16x16x32_bf16 v[112:115], a[8:11], v[172:175], v[112:115]
    buffer_load_dwordx4 v[60:63], v186, s[48:51], s23 offen offset:3072 sc1
    v_mfma_f32_16x16x32_bf16 v[116:119], a[12:15], v[168:171], v[116:119]
    v_mfma_f32_16x16x32_bf16 v[120:123], a[12:15], v[172:175], v[120:123]
    s_waitcnt lgkmcnt(0)
    v_mfma_f32_16x16x32_bf16 v[100:103], a[16:19], v[160:163], v[100:103]
    ds_read_b128 v[168:171], v253 offset:26624
    v_mfma_f32_16x16x32_bf16 v[104:107], a[16:19], v[164:167], v[104:107]
    ds_read_b128 v[172:175], v253 offset:27648
    v_mfma_f32_16x16x32_bf16 v[108:111], a[20:23], v[160:163], v[108:111]
    v_mfma_f32_16x16x32_bf16 v[112:115], a[20:23], v[164:167], v[112:115]
    buffer_load_dwordx4 v[64:67], v187, s[48:51], s23 offen offset:0 sc1
    v_mfma_f32_16x16x32_bf16 v[116:119], a[24:27], v[160:163], v[116:119]
    v_mfma_f32_16x16x32_bf16 v[120:123], a[24:27], v[164:167], v[120:123]
    s_waitcnt lgkmcnt(0)
    v_mfma_f32_16x16x32_bf16 v[100:103], a[28:31], v[168:171], v[100:103]
    ds_read_b128 v[160:163], v253 offset:28672
    v_mfma_f32_16x16x32_bf16 v[104:107], a[28:31], v[172:175], v[104:107]
    ds_read_b128 v[164:167], v253 offset:29696
    v_mfma_f32_16x16x32_bf16 v[108:111], a[32:35], v[168:171], v[108:111]
    v_mfma_f32_16x16x32_bf16 v[112:115], a[32:35], v[172:175], v[112:115]
    buffer_load_dwordx4 v[68:71], v187, s[48:51], s23 offen offset:1024 sc1
    v_mfma_f32_16x16x32_bf16 v[116:119], a[36:39], v[168:171], v[116:119]
    v_mfma_f32_16x16x32_bf16 v[120:123], a[36:39], v[172:175], v[120:123]
    s_waitcnt lgkmcnt(0)
    v_mfma_f32_16x16x32_bf16 v[100:103], a[40:43], v[160:163], v[100:103]
    ds_read_b128 v[168:171], v253 offset:30720
    v_mfma_f32_16x16x32_bf16 v[104:107], a[40:43], v[164:167], v[104:107]
    ds_read_b128 v[172:175], v253 offset:31744
    v_mfma_f32_16x16x32_bf16 v[108:111], a[44:47], v[160:163], v[108:111]
    v_mfma_f32_16x16x32_bf16 v[112:115], a[44:47], v[164:167], v[112:115]
    buffer_load_dwordx4 v[72:75], v187, s[48:51], s23 offen offset:2048 sc1
    v_mfma_f32_16x16x32_bf16 v[116:119], a[48:51], v[160:163], v[116:119]
    v_mfma_f32_16x16x32_bf16 v[120:123], a[48:51], v[164:167], v[120:123]
    s_waitcnt lgkmcnt(0)
    v_mfma_f32_16x16x32_bf16 v[100:103], a[52:55], v[168:171], v[100:103]
    ds_read_b128 v[160:163], v253 offset:32768
    v_mfma_f32_16x16x32_bf16 v[104:107], a[52:55], v[172:175], v[104:107]
    ds_read_b128 v[164:167], v253 offset:33792
    v_mfma_f32_16x16x32_bf16 v[108:111], a[56:59], v[168:171], v[108:111]
    v_mfma_f32_16x16x32_bf16 v[112:115], a[56:59], v[172:175], v[112:115]
    v_mfma_f32_16x16x32_bf16 v[116:119], a[60:63], v[168:171], v[116:119]
    v_mfma_f32_16x16x32_bf16 v[120:123], a[60:63], v[172:175], v[120:123]
    s_waitcnt lgkmcnt(0)
    v_mfma_f32_16x16x32_bf16 v[100:103], a[64:67], v[160:163], v[100:103]
    ds_read_b128 v[168:171], v253 offset:34816
    v_mfma_f32_16x16x32_bf16 v[104:107], a[64:67], v[164:167], v[104:107]
    ds_read_b128 v[172:175], v253 offset:35840
    v_mfma_f32_16x16x32_bf16 v[108:111], a[68:71], v[160:163], v[108:111]
    v_mfma_f32_16x16x32_bf16 v[112:115], a[68:71], v[164:167], v[112:115]
    v_mfma_f32_16x16x32_bf16 v[116:119], a[72:75], v[160:163], v[116:119]
    v_mfma_f32_16x16x32_bf16 v[120:123], a[72:75], v[164:167], v[120:123]
    s_waitcnt lgkmcnt(0)
    v_mfma_f32_16x16x32_bf16 v[100:103], a[76:79], v[168:171], v[100:103]
    v_mfma_f32_16x16x32_bf16 v[104:107], a[76:79], v[172:175], v[104:107]
    v_mfma_f32_16x16x32_bf16 v[108:111], a[80:83], v[168:171], v[108:111]
    v_mfma_f32_16x16x32_bf16 v[112:115], a[80:83], v[172:175], v[112:115]
    v_mfma_f32_16x16x32_bf16 v[116:119], a[84:87], v[168:171], v[116:119]
    v_mfma_f32_16x16x32_bf16 v[120:123], a[84:87], v[172:175], v[120:123]
    s_nop 3
    v_permlane16_swap_b32 v100, v104
    v_permlane16_swap_b32 v101, v105
    v_permlane16_swap_b32 v102, v106
    v_permlane16_swap_b32 v103, v107
    v_add_f32 v12, v116, v117
    v_add_f32 v13, v120, v121
    ds_write_b32 v10, v12
    ds_write_b32 v10, v13 offset:64
    v_permlane16_swap_b32 v108, v112
    v_permlane16_swap_b32 v109, v113
    v_permlane16_swap_b32 v110, v114
    v_permlane16_swap_b32 v111, v115
    v_permlane16_swap_b32 v116, v120
    v_permlane16_swap_b32 v117, v121
    v_permlane16_swap_b32 v118, v122
    v_permlane16_swap_b32 v119, v123
    s_waitcnt lgkmcnt(0)
    s_barrier
    ds_read_b32 v12, v11 offset:40960
    v_pk_add_f32 v[124:125], v[124:125], v[100:101]
    v_pk_add_f32 v[126:127], v[126:127], v[102:103]
    v_pk_add_f32 v[128:129], v[128:129], v[104:105]
    v_pk_add_f32 v[130:131], v[130:131], v[106:107]
    v_pk_add_f32 v[132:133], v[132:133], v[108:109]
    v_pk_add_f32 v[134:135], v[134:135], v[110:111]
    v_pk_add_f32 v[136:137], v[136:137], v[112:113]
    v_pk_add_f32 v[138:139], v[138:139], v[114:115]
    v_pk_add_f32 v[140:141], v[140:141], v[116:117]
    v_pk_add_f32 v[142:143], v[142:143], v[118:119]
    v_pk_add_f32 v[144:145], v[144:145], v[120:121]
    v_pk_add_f32 v[146:147], v[146:147], v[122:123]
    v_mov_b32 v14, 0
    v_mov_b32 v15, 0
    s_waitcnt lgkmcnt(0)
    v_add_f32 v12, v12, v252
    v_pk_add_f32 v[100:101], v[124:125], v[12:13] op_sel_hi:[1,0] neg_lo:[0,1] neg_hi:[0,1]
    v_pk_add_f32 v[102:103], v[126:127], v[12:13] op_sel_hi:[1,0] neg_lo:[0,1] neg_hi:[0,1]
    v_pk_add_f32 v[104:105], v[128:129], v[12:13] op_sel_hi:[1,0] neg_lo:[0,1] neg_hi:[0,1]
    v_pk_add_f32 v[106:107], v[130:131], v[12:13] op_sel_hi:[1,0] neg_lo:[0,1] neg_hi:[0,1]
    v_cvt_pk_bf16_f32 v148, v100, v101
    v_cvt_pk_bf16_f32 v149, v102, v103
    v_cvt_pk_bf16_f32 v150, v104, v105
    v_cvt_pk_bf16_f32 v151, v106, v107
    buffer_store_dwordx4 v[148:151], v9, s[8:11], s46 offen offset:0 sc1
    v_pk_add_f32 v[108:109], v[132:133], v[12:13] op_sel_hi:[1,0] neg_lo:[0,1] neg_hi:[0,1]
    v_pk_add_f32 v[110:111], v[134:135], v[12:13] op_sel_hi:[1,0] neg_lo:[0,1] neg_hi:[0,1]
    v_pk_add_f32 v[112:113], v[136:137], v[12:13] op_sel_hi:[1,0] neg_lo:[0,1] neg_hi:[0,1]
    v_pk_add_f32 v[114:115], v[138:139], v[12:13] op_sel_hi:[1,0] neg_lo:[0,1] neg_hi:[0,1]
    v_cvt_pk_bf16_f32 v152, v108, v109
    v_cvt_pk_bf16_f32 v153, v110, v111
    v_cvt_pk_bf16_f32 v154, v112, v113
    v_cvt_pk_bf16_f32 v155, v114, v115
    buffer_store_dwordx4 v[152:155], v9, s[8:11], s46 offen offset:1024 sc1
    v_pk_add_f32 v[116:117], v[140:141], v[12:13] op_sel_hi:[1,0] neg_lo:[0,1] neg_hi:[0,1]
    v_pk_add_f32 v[118:119], v[142:143], v[12:13] op_sel_hi:[1,0] neg_lo:[0,1] neg_hi:[0,1]
    v_pk_add_f32 v[120:121], v[144:145], v[12:13] op_sel_hi:[1,0] neg_lo:[0,1] neg_hi:[0,1]
    v_pk_add_f32 v[122:123], v[146:147], v[12:13] op_sel_hi:[1,0] neg_lo:[0,1] neg_hi:[0,1]
    v_cvt_pk_bf16_f32 v156, v116, v117
    v_cvt_pk_bf16_f32 v157, v118, v119
    v_cvt_pk_bf16_f32 v158, v120, v121
    v_cvt_pk_bf16_f32 v159, v122, v123
    buffer_store_dwordx4 v[156:159], v7, s[8:11], s46 offen offset:2048 sc1
    v_dot2c_f32_bf16 v14, v148, v148
    v_dot2c_f32_bf16 v14, v149, v149
    v_dot2c_f32_bf16 v14, v150, v150
    v_dot2c_f32_bf16 v14, v151, v151
    v_dot2c_f32_bf16 v14, v152, v152
    v_dot2c_f32_bf16 v14, v153, v153
    v_dot2c_f32_bf16 v14, v154, v154
    v_dot2c_f32_bf16 v14, v155, v155
    v_dot2c_f32_bf16 v15, v156, v156
    v_dot2c_f32_bf16 v15, v157, v157
    v_dot2c_f32_bf16 v15, v158, v158
    v_dot2c_f32_bf16 v15, v159, v159
    buffer_store_dword v12, v6, s[8:11], s36 offen sc1
    s_nop 1
    v_fma_f32 v14, v15, s35, v14
    v_mov_b32 v15, v14
    s_nop 1
    v_permlane32_swap_b32 v14, v15
    v_add_f32 v14, v14, v15
    buffer_store_dword v14, v8, s[8:11], s45 offen sc1
    v_lshlrev_b32 v15, 7, v0
    s_lshl_b32 s6, s40, 2
    s_add_u32 s6, s6, s44
    s_add_u32 s6, s6, 32768
    v_mov_b32 v1, s76
    s_mov_b64 vcc, 0xff
    s_waitcnt vmcnt(0)
    s_barrier
    s_cmp_lg_u32 s3, 0
    s_cbranch_scc1 L_pub_25
    s_mov_b64 exec, vcc
    buffer_store_dword v1, v15, s[8:11], s6 offen sc1
L_pub_25:
    s_mov_b64 exec, -1
    s_lshl_b32 s7, s41, 2
    s_add_u32 s7, s7, s3
    s_mul_i32 s22, s7, 18432
    s_add_u32 s22, s22, s43
    s_add_u32 s22, s22, 45875200
    s_mul_i32 s24, s3, 18432
    s_lshl_b32 s25, s41, 12
    s_add_u32 s25, s25, s43
    s_add_u32 s25, s25, 48300032
    v_lshrrev_b32 v3, 5, v0
    v_and_b32 v10, 31, v0
    v_lshlrev_b32 v10, 2, v10
    v_lshl_add_u32 v3, v3, 11, v10
    v_add_u32 v11, 36864, v184
    s_mov_b32 s16, 0xffff0000
    s_lshl_b32 s7, s3, 10
    v_add_u32 v172, s7, v253
    v_add_u32 v174, 5120, v172
    v_and_b32 v178, 7, v0
    v_mul_u32_u24 v178, 1152, v178
    v_lshrrev_b32 v179, 3, v0
    v_lshl_add_u32 v178, v179, 4, v178
    s_lshl_b32 s7, s3, 7
    v_add_u32 v175, s7, v178
    v_add_u32 v177, 640, v175
    s_cmp_eq_u32 s3, 0
    s_mov_b32 s17, 1073741824
    s_cmov_b32 s17, 4096
    v_add_u32 v173, s17, v172
    s_mov_b32 s17, 1073741824
    s_cmov_b32 s17, 512
    v_add_u32 v176, s17, v175
    s_lshl_b32 s21, s41, 3
    s_add_u32 s21, s21, s40
    s_mul_i32 s18, s21, 9216
    s_mul_i32 s20, s21, 73728
    s_add_u32 s20, s20, 19922944
    v_bfe_u32 v1, v0, 3, 2
    s_mov_b32 s7, 73728
    v_mul_lo_u32 v178, v1, s7
    v_lshrrev_b32 v1, 5, v0
    v_lshl_add_u32 v178, v1, 7, v178
    v_and_b32 v1, 7, v0
    v_lshl_add_u32 v178, v1, 4, v178
    v_add_u32 v179, 294912, v178
    v_lshrrev_b32 v1, 5, v0
    v_and_b32 v15, 7, v0
    v_lshlrev_b32 v15, 4, v15
    v_lshl_add_u32 v15, v1, 7, v15
    s_lshl_b32 s7, s3, 8
    s_add_u32 s7, s7, 3072
    v_add_u32 v15, s7, v15
    v_bfe_u32 v1, v0, 3, 2
    v_mov_b32 v182, 1073741824
    v_add_u32 v183, 14336, v253
    s_sub_u32 s7, s40, 0
    v_cmp_eq_u32 vcc, s7, v1
    s_nop 1
    v_cndmask_b32 v178, v178, v182, vcc
    v_cndmask_b32 v216, v183, v15, vcc
    v_cndmask_b32 v218, 0, 1, vcc
    v_lshlrev_b32 v218, 10, v218
    s_sub_u32 s7, s40, 4
    v_cmp_eq_u32 vcc, s7, v1
    s_nop 1
    v_cndmask_b32 v179, v179, v182, vcc
    v_cndmask_b32 v217, v183, v15, vcc
    v_cndmask_b32 v219, 0, 1, vcc
    v_lshlrev_b32 v219, 10, v219
    s_mul_i32 s26, s41, 589824
    s_mul_i32 s7, s40, 9216
    s_add_u32 s26, s26, s7
    s_lshl_b32 s7, s3, 8
    s_add_u32 s27, s26, s7
    s_add_u32 s27, s27, 19921920
    s_mov_b32 s74, 0
    s_mul_i32 s7, s42, 98304
    s_sub_u32 s29, s44, s7
    s_add_u32 s29, s29, 360448
    s_lshl_b32 s7, s40, 7
    s_add_u32 s7, s7, s29
    s_add_u32 s38, s4, s7
    s_addc_u32 s39, s5, 0
    s_lshl_b32 s7, s40, 2
    s_add_u32 s29, s29, s7
    s_add_u32 s50, s23, 497664
    s_cmp_lg_u32 s42, 0
    s_cbranch_scc1 L_ring_26
    s_cmp_lg_u32 s3, 0
    s_cbranch_scc1 L_ring_27
    s_lshl_b32 s7, s41, 3
    s_add_u32 s7, s7, s40
    s_lshl_b32 s7, s7, 7
    s_add_u32 s7, s7, 19464192
    s_add_u32 s68, s4, s7
    s_addc_u32 s69, s5, 0
    s_mov_b32 s6, 0
    s_mov_b32 s7, 0
L_cpoll_28:
    s_load_dwordx16 s[52:67], s[68:69], s7 glc
    s_add_u32 s6, s6, 1
    s_waitcnt lgkmcnt(0)
    s_xor_b64 s[52:53], s[52:53], s[76:77]
    s_xor_b64 s[54:55], s[54:55], s[76:77]
    s_xor_b64 s[56:57], s[56:57], s[76:77]
    s_xor_b64 s[58:59], s[58:59], s[76:77]
    s_xor_b64 s[60:61], s[60:61], s[76:77]
    s_xor_b64 s[62:63], s[62:63], s[76:77]
    s_xor_b64 s[64:65], s[64:65], s[76:77]
    s_xor_b64 s[66:67], s[66:67], s[76:77]
    s_or_b64 s[52:53], s[52:53], s[60:61]
    s_or_b64 s[54:55], s[54:55], s[62:63]
    s_or_b64 s[56:57], s[56:57], s[64:65]
    s_or_b64 s[58:59], s[58:59], s[66:67]
    s_or_b64 s[52:53], s[52:53], s[56:57]
    s_or_b64 s[54:55], s[54:55], s[58:59]
    s_or_b64 s[52:53], s[52:53], s[54:55]
    s_cbranch_scc1 L_cpoll_29
    s_add_u32 s7, s7, 64
    s_cmp_eq_u32 s7, 128
    s_cbranch_scc1 L_cpolled_30
L_cpoll_29:
    s_cmp_lt_u32 s6, 1048576
    s_cbranch_scc1 L_cpoll_28
    s_branch L_main_end
L_cpolled_30:
L_ring_27:
    s_barrier
    buffer_load_dwordx4 v[16:19], v184, s[48:51], s23 offen offset:0 sc1
    buffer_load_dwordx4 v[20:23], v184, s[48:51], s23 offen offset:1024 sc1
    buffer_load_dwordx4 v[24:27], v184, s[48:51], s23 offen offset:2048 sc1
    buffer_load_dwordx4 v[28:31], v184, s[48:51], s23 offen offset:3072 sc1
    buffer_load_dwordx4 v[32:35], v185, s[48:51], s23 offen offset:0 sc1
    buffer_load_dwordx4 v[36:39], v185, s[48:51], s23 offen offset:1024 sc1
    buffer_load_dwordx4 v[40:43], v185, s[48:51], s23 offen offset:2048 sc1
    buffer_load_dwordx4 v[44:47], v185, s[48:51], s23 offen offset:3072 sc1
    buffer_load_dwordx4 v[48:51], v186, s[48:51], s23 offen offset:0 sc1
    buffer_load_dwordx4 v[52:55], v186, s[48:51], s23 offen offset:1024 sc1
    buffer_load_dwordx4 v[56:59], v186, s[48:51], s23 offen offset:2048 sc1
    buffer_load_dwordx4 v[60:63], v186, s[48:51], s23 offen offset:3072 sc1
    buffer_load_dwordx4 v[64:67], v187, s[48:51], s23 offen offset:0 sc1
    buffer_load_dwordx4 v[68:71], v187, s[48:51], s23 offen offset:1024 sc1
    buffer_load_dwordx4 v[72:75], v187, s[48:51], s23 offen offset:2048 sc1
L_ring_26:
    s_cmp_lg_u32 s3, 3
    s_cbranch_scc1 L_pollout_33
    s_lshl_b32 s7, s40, 7
    s_add_u32 s7, s7, s44
    s_add_u32 s7, s7, 32768
    s_add_u32 s52, s4, s7
    s_addc_u32 s53, s5, 0
    s_mov_b32 s6, 0
L_poll_31:
    s_load_dwordx8 s[56:63], s[52:53], 0 glc
    s_add_u32 s6, s6, 1
    s_waitcnt lgkmcnt(0)
    s_xor_b64 s[56:57], s[56:57], s[76:77]
    s_xor_b64 s[58:59], s[58:59], s[76:77]
    s_xor_b64 s[60:61], s[60:61], s[76:77]
    s_xor_b64 s[62:63], s[62:63], s[76:77]
    s_or_b64 s[56:57], s[56:57], s[58:59]
    s_or_b64 s[60:61], s[60:61], s[62:63]
    s_or_b64 s[56:57], s[56:57], s[60:61]
    s_cbranch_scc0 L_polled_32
    s_cmp_lt_u32 s6, 1048576
    s_cbranch_scc1 L_poll_31
    s_branch L_main_end
L_polled_32:
L_pollout_33:
    s_barrier
    s_add_u32 m0, s24, 0
    s_nop 0
    buffer_load_dwordx4 v2, s[8:11], s22 offen offset:0 sc1 lds
    s_add_u32 m0, s24, 512
    s_nop 0
    buffer_load_dwordx4 v2, s[8:11], s22 offen offset:512 sc1 lds
    s_add_u32 m0, s24, 1024
    s_nop 0
    buffer_load_dwordx4 v2, s[8:11], s22 offen offset:1024 sc1 lds
    s_add_u32 m0, s24, 1536
    s_nop 0
    buffer_load_dwordx4 v2, s[8:11], s22 offen offset:1536 sc1 lds
    s_add_u32 m0, s24, 2048
    s_nop 0
    buffer_load_dwordx4 v2, s[8:11], s22 offen offset:2048 sc1 lds
    s_add_u32 m0, s24, 2560
    s_nop 0
    buffer_load_dwordx4 v2, s[8:11], s22 offen offset:2560 sc1 lds
    s_add_u32 m0, s24, 3072
    s_nop 0
    buffer_load_dwordx4 v2, s[8:11], s22 offen offset:3072 sc1 lds
    s_add_u32 m0, s24, 3584
    s_nop 0
    buffer_load_dwordx4 v2, s[8:11], s22 offen offset:3584 sc1 lds
    s_add_u32 m0, s24, 8192
    s_add_u32 s22, s22, 4096
    buffer_load_dwordx4 v2, s[8:11], s22 offen offset:0 sc1 lds
    s_add_u32 m0, s24, 8704
    s_nop 0
    buffer_load_dwordx4 v2, s[8:11], s22 offen offset:512 sc1 lds
    s_add_u32 m0, s24, 9216
    s_nop 0
    buffer_load_dwordx4 v2, s[8:11], s22 offen offset:1024 sc1 lds
    s_add_u32 m0, s24, 9728
    s_nop 0
    buffer_load_dwordx4 v2, s[8:11], s22 offen offset:1536 sc1 lds
    s_add_u32 s23, s23, 15360
    s_lshr_b32 s7, s3, 1
    s_lshl_b32 s7, s7, 10
    s_and_b32 s6, s3, 1
    s_lshl_b32 s6, s6, 3
    s_add_u32 s28, s7, s6
    s_add_u32 s28, s28, 73728
    s_waitcnt vmcnt(6)
    s_barrier
    ds_read_b128 a[0:3], v184 offset:0
    ds_read_b128 a[72:75], v184 offset:18432
    ds_read_b128 a[144:147], v11 offset:0
    ds_read_b128 a[216:219], v11 offset:18432
    ds_read_b128 a[4:7], v184 offset:1024
    ds_read_b128 a[76:79], v184 offset:19456
    ds_read_b128 a[148:151], v11 offset:1024
    ds_read_b128 a[220:223], v11 offset:19456
    ds_read_b128 a[8:11], v184 offset:2048
    ds_read_b128 a[80:83], v184 offset:20480
    ds_read_b128 a[152:155], v11 offset:2048
    ds_read_b128 a[224:227], v11 offset:20480
    s_waitcnt vmcnt(24) lgkmcnt(0)
    v_mfma_f32_16x16x32_bf16 v[88:91], v[16:19], a[0:3], 0
    ds_read_b128 a[12:15], v184 offset:3072
    v_mfma_f32_16x16x32_bf16 v[88:91], v[20:23], a[4:7], v[88:91]
    buffer_load_dwordx4 v[76:79], v184, s[48:51], s23 offen offset:0 sc1
    v_mfma_f32_16x16x32_bf16 v[88:91], v[24:27], a[8:11], v[88:91]
    ds_read_b128 a[84:87], v184 offset:21504
    v_mfma_f32_16x16x32_bf16 v[92:95], v[16:19], a[72:75], 0
    s_add_u32 m0, s24, 10240
    s_nop 0
    buffer_load_dwordx4 v2, s[8:11], s22 offen offset:2048 sc1 lds
    v_mfma_f32_16x16x32_bf16 v[92:95], v[20:23], a[76:79], v[92:95]
    ds_read_b128 a[156:159], v11 offset:3072
    ds_read_b128 a[228:231], v11 offset:21504
    v_mfma_f32_16x16x32_bf16 v[92:95], v[24:27], a[80:83], v[92:95]
    buffer_load_dwordx4 v[80:83], v184, s[48:51], s23 offen offset:1024 sc1
    v_mfma_f32_16x16x32_bf16 v[96:99], v[16:19], a[144:147], 0
    ds_read_b128 a[16:19], v184 offset:4096
    v_mfma_f32_16x16x32_bf16 v[96:99], v[20:23], a[148:151], v[96:99]
    s_add_u32 m0, s24, 10752
    s_nop 0
    buffer_load_dwordx4 v2, s[8:11], s22 offen offset:2560 sc1 lds
    v_mfma_f32_16x16x32_bf16 v[96:99], v[24:27], a[152:155], v[96:99]
    ds_read_b128 a[88:91], v184 offset:22528
    v_mfma_f32_16x16x32_bf16 v[100:103], v[16:19], a[216:219], 0
    buffer_load_dwordx4 v[84:87], v184, s[48:51], s23 offen offset:2048 sc1
    v_mfma_f32_16x16x32_bf16 v[100:103], v[20:23], a[220:223], v[100:103]
    ds_read_b128 a[160:163], v11 offset:4096
    ds_read_b128 a[232:235], v11 offset:22528
    v_mfma_f32_16x16x32_bf16 v[100:103], v[24:27], a[224:227], v[100:103]
    s_add_u32 m0, s24, 11264
    s_nop 0
    buffer_load_dwordx4 v2, s[8:11], s22 offen offset:3072 sc1 lds
    s_waitcnt vmcnt(27) lgkmcnt(8)
    v_mfma_f32_16x16x32_bf16 v[104:107], v[28:31], a[0:3], 0
    ds_read_b128 a[20:23], v184 offset:5120
    v_mfma_f32_16x16x32_bf16 v[104:107], v[32:35], a[4:7], v[104:107]
    buffer_load_dwordx4 v[16:19], v184, s[48:51], s23 offen offset:3072 sc1
    v_mfma_f32_16x16x32_bf16 v[104:107], v[36:39], a[8:11], v[104:107]
    ds_read_b128 a[92:95], v184 offset:23552
    v_mfma_f32_16x16x32_bf16 v[108:111], v[28:31], a[72:75], 0
    s_add_u32 m0, s24, 11776
    s_nop 0
    buffer_load_dwordx4 v2, s[8:11], s22 offen offset:3584 sc1 lds
    v_mfma_f32_16x16x32_bf16 v[108:111], v[32:35], a[76:79], v[108:111]
    ds_read_b128 a[164:167], v11 offset:5120
    ds_read_b128 a[236:239], v11 offset:23552
    v_mfma_f32_16x16x32_bf16 v[108:111], v[36:39], a[80:83], v[108:111]
    buffer_load_dwordx4 v[20:23], v185, s[48:51], s23 offen offset:0 sc1
    v_mfma_f32_16x16x32_bf16 v[112:115], v[28:31], a[144:147], 0
    v_mfma_f32_16x16x32_bf16 v[112:115], v[32:35], a[148:151], v[112:115]
    s_add_u32 m0, s24, 16384
    s_add_u32 s22, s22, 4096
    buffer_load_dwordx4 v2, s[8:11], s22 offen offset:0 sc1 lds
    v_mfma_f32_16x16x32_bf16 v[112:115], v[36:39], a[152:155], v[112:115]
    v_mfma_f32_16x16x32_bf16 v[116:119], v[28:31], a[216:219], 0
    buffer_load_dwordx4 v[24:27], v185, s[48:51], s23 offen offset:1024 sc1
    v_mfma_f32_16x16x32_bf16 v[116:119], v[32:35], a[220:223], v[116:119]
    v_mfma_f32_16x16x32_bf16 v[116:119], v[36:39], a[224:227], v[116:119]
    s_add_u32 m0, s24, 16896
    s_nop 0
    buffer_load_dwordx4 v2, s[8:11], s22 offen offset:512 sc1 lds
    s_waitcnt vmcnt(12) lgkmcnt(0)
    s_barrier
    v_mfma_f32_16x16x32_bf16 v[88:91], v[40:43], a[12:15], v[88:91]
    ds_read_b128 a[24:27], v184 offset:6144
    v_mfma_f32_16x16x32_bf16 v[88:91], v[44:47], a[16:19], v[88:91]
    buffer_load_dwordx4 v[28:31], v185, s[48:51], s23 offen offset:2048 sc1
    v_mfma_f32_16x16x32_bf16 v[88:91], v[48:51], a[20:23], v[88:91]
    ds_read_b128 a[96:99], v184 offset:24576
    v_mfma_f32_16x16x32_bf16 v[92:95], v[40:43], a[84:87], v[92:95]
    buffer_load_dword v136, v3, s[8:11], s25 offen offset:0 sc1
    v_mfma_f32_16x16x32_bf16 v[92:95], v[44:47], a[88:91], v[92:95]
    ds_read_b128 a[168:171], v11 offset:6144
    ds_read_b128 a[240:243], v11 offset:24576
    v_mfma_f32_16x16x32_bf16 v[92:95], v[48:51], a[92:95], v[92:95]
    buffer_load_dwordx4 v[32:35], v185, s[48:51], s23 offen offset:3072 sc1
    v_mfma_f32_16x16x32_bf16 v[96:99], v[40:43], a[156:159], v[96:99]
    buffer_load_dword v137, v3, s[8:11], s25 offen offset:128 sc1
    v_mfma_f32_16x16x32_bf16 v[96:99], v[44:47], a[160:163], v[96:99]
    buffer_load_dword v138, v3, s[8:11], s25 offen offset:256 sc1
    v_mfma_f32_16x16x32_bf16 v[96:99], v[48:51], a[164:167], v[96:99]
    ds_read_b128 a[28:31], v184 offset:7168
    ds_read_b128 a[100:103], v184 offset:25600
    v_mfma_f32_16x16x32_bf16 v[100:103], v[40:43], a[228:231], v[100:103]
    buffer_load_dwordx4 v[36:39], v186, s[48:51], s23 offen offset:0 sc1
    v_mfma_f32_16x16x32_bf16 v[100:103], v[44:47], a[232:235], v[100:103]
    buffer_load_dword v139, v3, s[8:11], s25 offen offset:384 sc1
    v_mfma_f32_16x16x32_bf16 v[100:103], v[48:51], a[236:239], v[100:103]
    buffer_load_dword v140, v3, s[8:11], s25 offen offset:512 sc1
    s_waitcnt vmcnt(35) lgkmcnt(6)
    v_mfma_f32_16x16x32_bf16 v[104:107], v[52:55], a[12:15], v[104:107]
    ds_read_b128 a[172:175], v11 offset:7168
    ds_read_b128 a[244:247], v11 offset:25600
    v_mfma_f32_16x16x32_bf16 v[104:107], v[56:59], a[16:19], v[104:107]
    buffer_load_dwordx4 v[40:43], v186, s[48:51], s23 offen offset:1024 sc1
    v_mfma_f32_16x16x32_bf16 v[104:107], v[60:63], a[20:23], v[104:107]
    ds_read_b128 a[32:35], v184 offset:8192
    ds_read_b128 a[104:107], v184 offset:26624
    v_mfma_f32_16x16x32_bf16 v[108:111], v[52:55], a[84:87], v[108:111]
    buffer_load_dword v141, v3, s[8:11], s25 offen offset:640 sc1
    v_mfma_f32_16x16x32_bf16 v[108:111], v[56:59], a[88:91], v[108:111]
    ds_read_b128 a[176:179], v11 offset:8192
    ds_read_b128 a[248:251], v11 offset:26624
    v_mfma_f32_16x16x32_bf16 v[108:111], v[60:63], a[92:95], v[108:111]
    buffer_load_dwordx4 v[44:47], v186, s[48:51], s23 offen offset:2048 sc1
    v_mfma_f32_16x16x32_bf16 v[112:115], v[52:55], a[156:159], v[112:115]
    buffer_load_dword v142, v3, s[8:11], s25 offen offset:768 sc1
    v_mfma_f32_16x16x32_bf16 v[112:115], v[56:59], a[160:163], v[112:115]
    buffer_load_dword v143, v3, s[8:11], s25 offen offset:896 sc1
    v_mfma_f32_16x16x32_bf16 v[112:115], v[60:63], a[164:167], v[112:115]
    v_mfma_f32_16x16x32_bf16 v[116:119], v[52:55], a[228:231], v[116:119]
    buffer_load_dwordx4 v[48:51], v186, s[48:51], s23 offen offset:3072 sc1
    v_mfma_f32_16x16x32_bf16 v[116:119], v[56:59], a[232:235], v[116:119]
    buffer_load_dword v144, v3, s[8:11], s25 offen offset:1024 sc1
    v_mfma_f32_16x16x32_bf16 v[116:119], v[60:63], a[236:239], v[116:119]
    buffer_load_dword v145, v3, s[8:11], s25 offen offset:1152 sc1
    s_waitcnt vmcnt(40) lgkmcnt(0)
    v_mfma_f32_16x16x32_bf16 v[88:91], v[64:67], a[24:27], v[88:91]
    ds_read_b128 a[36:39], v184 offset:9216
    v_mfma_f32_16x16x32_bf16 v[88:91], v[68:71], a[28:31], v[88:91]
    buffer_load_dwordx4 v[52:55], v187, s[48:51], s23 offen offset:0 sc1
    v_mfma_f32_16x16x32_bf16 v[88:91], v[72:75], a[32:35], v[88:91]
    ds_read_b128 a[108:111], v184 offset:27648
    v_mfma_f32_16x16x32_bf16 v[92:95], v[64:67], a[96:99], v[92:95]
    buffer_load_dword v146, v3, s[8:11], s25 offen offset:1280 sc1
    v_mfma_f32_16x16x32_bf16 v[92:95], v[68:71], a[100:103], v[92:95]
    ds_read_b128 a[180:183], v11 offset:9216
    ds_read_b128 a[252:255], v11 offset:27648
    v_mfma_f32_16x16x32_bf16 v[92:95], v[72:75], a[104:107], v[92:95]
    buffer_load_dwordx4 v[56:59], v187, s[48:51], s23 offen offset:1024 sc1
    v_mfma_f32_16x16x32_bf16 v[96:99], v[64:67], a[168:171], v[96:99]
    buffer_load_dword v147, v3, s[8:11], s25 offen offset:1408 sc1
    v_mfma_f32_16x16x32_bf16 v[96:99], v[68:71], a[172:175], v[96:99]
    buffer_load_dword v148, v3, s[8:11], s25 offen offset:1536 sc1
    v_mfma_f32_16x16x32_bf16 v[96:99], v[72:75], a[176:179], v[96:99]
    ds_read_b128 a[40:43], v184 offset:10240
    ds_read_b128 a[112:115], v184 offset:28672
    v_mfma_f32_16x16x32_bf16 v[100:103], v[64:67], a[240:243], v[100:103]
    buffer_load_dwordx4 v[60:63], v187, s[48:51], s23 offen offset:2048 sc1
    v_mfma_f32_16x16x32_bf16 v[100:103], v[68:71], a[244:247], v[100:103]
    buffer_load_dword v149, v3, s[8:11], s25 offen offset:1664 sc1
    v_mfma_f32_16x16x32_bf16 v[100:103], v[72:75], a[248:251], v[100:103]
    buffer_load_dword v150, v3, s[8:11], s25 offen offset:1792 sc1
    s_waitcnt vmcnt(31) lgkmcnt(6)
    v_mfma_f32_16x16x32_bf16 v[104:107], v[76:79], a[24:27], v[104:107]
    ds_read_b128 a[184:187], v11 offset:10240
    ds_read_b128 v[220:223], v11 offset:28672
    v_mfma_f32_16x16x32_bf16 v[104:107], v[80:83], a[28:31], v[104:107]
    buffer_load_dwordx4 v[64:67], v187, s[48:51], s23 offen offset:3072 sc1
    v_mfma_f32_16x16x32_bf16 v[104:107], v[84:87], a[32:35], v[104:107]
    ds_read_b128 a[44:47], v184 offset:11264
    ds_read_b128 a[116:119], v184 offset:29696
    v_mfma_f32_16x16x32_bf16 v[108:111], v[76:79], a[96:99], v[108:111]
    buffer_load_dword v151, v3, s[8:11], s25 offen offset:1920 sc1
    v_mfma_f32_16x16x32_bf16 v[108:111], v[80:83], a[100:103], v[108:111]
    ds_read_b128 a[188:191], v11 offset:11264
    ds_read_b128 v[224:227], v11 offset:29696
    v_mfma_f32_16x16x32_bf16 v[108:111], v[84:87], a[104:107], v[108:111]
    buffer_load_dwordx4 v[68:71], v188, s[48:51], s23 offen offset:0 sc1
    v_mfma_f32_16x16x32_bf16 v[112:115], v[76:79], a[168:171], v[112:115]
    v_mfma_f32_16x16x32_bf16 v[112:115], v[80:83], a[172:175], v[112:115]
    v_mfma_f32_16x16x32_bf16 v[112:115], v[84:87], a[176:179], v[112:115]
    v_mfma_f32_16x16x32_bf16 v[116:119], v[76:79], a[240:243], v[116:119]
    buffer_load_dwordx4 v[72:75], v188, s[48:51], s23 offen offset:1024 sc1
    v_mfma_f32_16x16x32_bf16 v[116:119], v[80:83], a[244:247], v[116:119]
    v_mfma_f32_16x16x32_bf16 v[116:119], v[84:87], a[248:251], v[116:119]
    s_waitcnt vmcnt(28) lgkmcnt(0)
    s_barrier
    v_mfma_f32_16x16x32_bf16 v[88:91], v[16:19], a[36:39], v[88:91]
    ds_read_b128 a[48:51], v184 offset:12288
    v_mfma_f32_16x16x32_bf16 v[88:91], v[20:23], a[40:43], v[88:91]
    buffer_load_dwordx4 v[76:79], v188, s[48:51], s23 offen offset:2048 sc1
    v_mfma_f32_16x16x32_bf16 v[88:91], v[24:27], a[44:47], v[88:91]
    ds_read_b128 a[120:123], v184 offset:30720
    v_mfma_f32_16x16x32_bf16 v[92:95], v[16:19], a[108:111], v[92:95]
    ds_read_b128 a[192:195], v11 offset:12288
    v_mfma_f32_16x16x32_bf16 v[92:95], v[20:23], a[112:115], v[92:95]
    ds_read_b128 v[228:231], v11 offset:30720
    v_mfma_f32_16x16x32_bf16 v[92:95], v[24:27], a[116:119], v[92:95]
    buffer_load_dwordx4 v[80:83], v188, s[48:51], s23 offen offset:3072 sc1
    v_mfma_f32_16x16x32_bf16 v[96:99], v[16:19], a[180:183], v[96:99]
    ds_read_b128 a[52:55], v184 offset:13312
    v_mfma_f32_16x16x32_bf16 v[96:99], v[20:23], a[184:187], v[96:99]
    ds_read_b128 a[124:127], v184 offset:31744
    v_mfma_f32_16x16x32_bf16 v[96:99], v[24:27], a[188:191], v[96:99]
    v_mfma_f32_16x16x32_bf16 v[100:103], v[16:19], a[252:255], v[100:103]
    buffer_load_dwordx4 v[84:87], v189, s[48:51], s23 offen offset:0 sc1
    v_mfma_f32_16x16x32_bf16 v[100:103], v[20:23], v[220:223], v[100:103]
    ds_read_b128 a[196:199], v11 offset:13312
    ds_read_b128 v[232:235], v11 offset:31744
    v_mfma_f32_16x16x32_bf16 v[100:103], v[24:27], v[224:227], v[100:103]
    s_waitcnt vmcnt(25) lgkmcnt(8)
    v_mfma_f32_16x16x32_bf16 v[104:107], v[28:31], a[36:39], v[104:107]
    ds_read_b128 a[56:59], v184 offset:14336
    v_mfma_f32_16x16x32_bf16 v[104:107], v[32:35], a[40:43], v[104:107]
    buffer_load_dwordx4 v[16:19], v189, s[48:51], s23 offen offset:1024 sc1
    v_mfma_f32_16x16x32_bf16 v[104:107], v[36:39], a[44:47], v[104:107]
    ds_read_b128 a[128:131], v184 offset:32768
    v_mfma_f32_16x16x32_bf16 v[108:111], v[28:31], a[108:111], v[108:111]
    ds_read_b128 a[200:203], v11 offset:14336
    v_mfma_f32_16x16x32_bf16 v[108:111], v[32:35], a[112:115], v[108:111]
    ds_read_b128 v[236:239], v11 offset:32768
    v_mfma_f32_16x16x32_bf16 v[108:111], v[36:39], a[116:119], v[108:111]
    buffer_load_dwordx4 v[20:23], v189, s[48:51], s23 offen offset:2048 sc1
    v_mfma_f32_16x16x32_bf16 v[112:115], v[28:31], a[180:183], v[112:115]
    v_mfma_f32_16x16x32_bf16 v[112:115], v[32:35], a[184:187], v[112:115]
    v_mfma_f32_16x16x32_bf16 v[112:115], v[36:39], a[188:191], v[112:115]
    v_mfma_f32_16x16x32_bf16 v[116:119], v[28:31], a[252:255], v[116:119]
    buffer_load_dwordx4 v[24:27], v189, s[48:51], s23 offen offset:3072 sc1
    v_mfma_f32_16x16x32_bf16 v[116:119], v[32:35], v[220:223], v[116:119]
    v_mfma_f32_16x16x32_bf16 v[116:119], v[36:39], v[224:227], v[116:119]
    s_waitcnt vmcnt(8) lgkmcnt(0)
    v_mfma_f32_16x16x32_bf16 v[88:91], v[40:43], a[48:51], v[88:91]
    ds_read_b128 a[60:63], v184 offset:15360
    v_add_f32 v136, v136, v144
    v_mfma_f32_16x16x32_bf16 v[88:91], v[44:47], a[52:55], v[88:91]
    buffer_load_dwordx4 v[28:31], v190, s[48:51], s23 offen offset:0 sc1
    v_mfma_f32_16x16x32_bf16 v[88:91], v[48:51], a[56:59], v[88:91]
    ds_read_b128 a[132:135], v184 offset:33792
    v_add_f32 v137, v137, v145
    v_mfma_f32_16x16x32_bf16 v[92:95], v[40:43], a[120:123], v[92:95]
    ds_read_b128 a[204:207], v11 offset:15360
    v_add_f32 v138, v138, v146
    v_mfma_f32_16x16x32_bf16 v[92:95], v[44:47], a[124:127], v[92:95]
    ds_read_b128 v[240:243], v11 offset:33792
    v_add_f32 v139, v139, v147
    v_mfma_f32_16x16x32_bf16 v[92:95], v[48:51], a[128:131], v[92:95]
    buffer_load_dwordx4 v[32:35], v190, s[48:51], s23 offen offset:1024 sc1
    v_mfma_f32_16x16x32_bf16 v[96:99], v[40:43], a[192:195], v[96:99]
    ds_read_b128 a[64:67], v184 offset:16384
    v_add_f32 v140, v140, v148
    v_mfma_f32_16x16x32_bf16 v[96:99], v[44:47], a[196:199], v[96:99]
    ds_read_b128 a[136:139], v184 offset:34816
    v_add_f32 v141, v141, v149
    v_mfma_f32_16x16x32_bf16 v[96:99], v[48:51], a[200:203], v[96:99]
    v_add_f32 v142, v142, v150
    v_add_f32 v143, v143, v151
    v_mfma_f32_16x16x32_bf16 v[100:103], v[40:43], v[228:231], v[100:103]
    buffer_load_dwordx4 v[36:39], v190, s[48:51], s23 offen offset:2048 sc1
    v_mfma_f32_16x16x32_bf16 v[100:103], v[44:47], v[232:235], v[100:103]
    ds_read_b128 a[208:211], v11 offset:16384
    ds_read_b128 v[244:247], v11 offset:34816
    v_mfma_f32_16x16x32_bf16 v[100:103], v[48:51], v[236:239], v[100:103]
    v_add_f32 v136, v136, v140
    v_add_f32 v137, v137, v141
    s_waitcnt vmcnt(15) lgkmcnt(8)
    v_mfma_f32_16x16x32_bf16 v[104:107], v[52:55], a[48:51], v[104:107]
    ds_read_b128 a[68:71], v184 offset:17408
    v_add_f32 v138, v138, v142
    v_mfma_f32_16x16x32_bf16 v[104:107], v[56:59], a[52:55], v[104:107]
    buffer_load_dwordx4 v[40:43], v190, s[48:51], s23 offen offset:3072 sc1
    v_mfma_f32_16x16x32_bf16 v[104:107], v[60:63], a[56:59], v[104:107]
    ds_read_b128 a[140:143], v184 offset:35840
    v_add_f32 v139, v139, v143
    v_mfma_f32_16x16x32_bf16 v[108:111], v[52:55], a[120:123], v[108:111]
    ds_read_b128 a[212:215], v11 offset:17408
    v_add_f32 v136, v136, v138
    v_mfma_f32_16x16x32_bf16 v[108:111], v[56:59], a[124:127], v[108:111]
    ds_read_b128 v[248:251], v11 offset:35840
    v_add_f32 v137, v137, v139
    v_mfma_f32_16x16x32_bf16 v[108:111], v[60:63], a[128:131], v[108:111]
    buffer_load_dwordx4 v[44:47], v191, s[48:51], s23 offen offset:0 sc1
    v_mfma_f32_16x16x32_bf16 v[112:115], v[52:55], a[192:195], v[112:115]
    v_add_f32 v136, v136, v137
    v_mov_b32 v137, 0x3727c5ac
    v_mfma_f32_16x16x32_bf16 v[112:115], v[56:59], a[196:199], v[112:115]
    v_fmac_f32 v137, 0x3ae38e39, v136
    v_mov_b32 v193, v137
    v_mfma_f32_16x16x32_bf16 v[112:115], v[60:63], a[200:203], v[112:115]
    s_nop 0
    v_permlane16_swap_b32 v193, v137
    v_mfma_f32_16x16x32_bf16 v[116:119], v[52:55], v[228:231], v[116:119]
    buffer_load_dwordx4 v[48:51], v191, s[48:51], s23 offen offset:1024 sc1
    v_mfma_f32_16x16x32_bf16 v[116:119], v[56:59], v[232:235], v[116:119]
    v_mov_b32 v195, v193
    v_mov_b32 v194, v137
    v_mfma_f32_16x16x32_bf16 v[116:119], v[60:63], v[236:239], v[116:119]
    v_mov_b32 v252, v137
    s_waitcnt vmcnt(12) lgkmcnt(0)
    v_mfma_f32_16x16x32_bf16 v[88:91], v[64:67], a[60:63], v[88:91]
    s_nop 0
    v_permlane32_swap_b32 v193, v195
    v_mfma_f32_16x16x32_bf16 v[88:91], v[68:71], a[64:67], v[88:91]
    buffer_load_dwordx4 v[52:55], v191, s[48:51], s23 offen offset:2048 sc1
    v_mfma_f32_16x16x32_bf16 v[120:123], v[72:75], a[68:71], v[88:91]
    v_permlane32_swap_b32 v194, v252
    v_mfma_f32_16x16x32_bf16 v[92:95], v[64:67], a[132:135], v[92:95]
    v_rsq_f32 v4, v193
    v_mfma_f32_16x16x32_bf16 v[92:95], v[68:71], a[136:139], v[92:95]
    v_rsq_f32 v5, v194
    v_mfma_f32_16x16x32_bf16 v[124:127], v[72:75], a[140:143], v[92:95]
    buffer_load_dwordx4 v[56:59], v191, s[48:51], s23 offen offset:3072 sc1
    v_mfma_f32_16x16x32_bf16 v[96:99], v[64:67], a[204:207], v[96:99]
    v_rsq_f32 v6, v195
    v_mfma_f32_16x16x32_bf16 v[96:99], v[68:71], a[208:211], v[96:99]
    v_rsq_f32 v7, v252
    v_mfma_f32_16x16x32_bf16 v[128:131], v[72:75], a[212:215], v[96:99]
    v_mul_f32 v8, v4, v4
    v_mul_f32 v9, v5, v5
    v_mfma_f32_16x16x32_bf16 v[100:103], v[64:67], v[240:243], v[100:103]
    buffer_load_dwordx4 v[60:63], v192, s[48:51], s23 offen offset:0 sc1
    v_mfma_f32_16x16x32_bf16 v[100:103], v[68:71], v[244:247], v[100:103]
    v_mul_f32 v13, v6, v6
    v_mul_f32 v14, v7, v7
    v_mfma_f32_16x16x32_bf16 v[132:135], v[72:75], v[248:251], v[100:103]
    v_mul_f32 v4, 0xc0135761, v4
    v_mul_f32 v5, 0xc0135761, v5
    s_waitcnt vmcnt(12) lgkmcnt(0)
    v_mfma_f32_16x16x32_bf16 v[104:107], v[76:79], a[60:63], v[104:107]
    v_mul_f32 v6, 0xc0135761, v6
    v_mul_f32 v7, 0xc0135761, v7
    v_mfma_f32_16x16x32_bf16 v[104:107], v[80:83], a[64:67], v[104:107]
    buffer_load_dwordx4 v[64:67], v192, s[48:51], s23 offen offset:1024 sc1
    v_mfma_f32_16x16x32_bf16 v[136:139], v[84:87], a[68:71], v[104:107]
    v_mul_f32 v8, 0x3d372713, v8
    v_mul_f32 v9, 0x3d372713, v9
    v_mfma_f32_16x16x32_bf16 v[108:111], v[76:79], a[132:135], v[108:111]
    v_mul_f32 v13, 0x3d372713, v13
    v_mul_f32 v14, 0x3d372713, v14
    v_mfma_f32_16x16x32_bf16 v[108:111], v[80:83], a[136:139], v[108:111]
    v_mul_f32 v8, v8, v4
    v_mul_f32 v9, v9, v5
    v_mfma_f32_16x16x32_bf16 v[140:143], v[84:87], a[140:143], v[108:111]
    buffer_load_dwordx4 v[68:71], v192, s[48:51], s23 offen offset:2048 sc1
    v_mfma_f32_16x16x32_bf16 v[112:115], v[76:79], a[204:207], v[112:115]
    v_mul_f32 v13, v13, v6
    v_mul_f32 v14, v14, v7
    v_mfma_f32_16x16x32_bf16 v[112:115], v[80:83], a[208:211], v[112:115]
    s_mov_b32 s25, 0
    v_mfma_f32_16x16x32_bf16 v[144:147], v[84:87], a[212:215], v[112:115]
    s_mov_b32 s7, s28
    v_mfma_f32_16x16x32_bf16 v[116:119], v[76:79], v[240:243], v[116:119]
    buffer_load_dwordx4 v[72:75], v192, s[48:51], s23 offen offset:3072 sc1
    v_mfma_f32_16x16x32_bf16 v[116:119], v[80:83], v[244:247], v[116:119]
    s_add_u32 s23, s23, 36864
    v_mfma_f32_16x16x32_bf16 v[148:151], v[84:87], v[248:251], v[116:119]
    v_add_u32 v12, s7, v184
    s_add_u32 s25, s25, 1
L_ffn_gu_34:
    s_waitcnt vmcnt(12)
    v_mfma_f32_16x16x32_bf16 v[88:91], v[16:19], a[0:3], 0
    v_mfma_f32_16x16x32_bf16 v[88:91], v[20:23], a[4:7], v[88:91]
    buffer_load_dwordx4 v[76:79], v184, s[48:51], s23 offen offset:0 sc1
    v_mfma_f32_16x16x32_bf16 v[88:91], v[24:27], a[8:11], v[88:91]
    v_mul_f32 v152, v120, v120
    v_mul_f32 v153, v121, v121
    v_mfma_f32_16x16x32_bf16 v[92:95], v[16:19], a[72:75], 0
    v_mul_f32 v154, v122, v122
    v_mul_f32 v155, v123, v123
    v_mfma_f32_16x16x32_bf16 v[92:95], v[20:23], a[76:79], v[92:95]
    v_fma_f32 v152, v152, v8, v4
    v_fma_f32 v153, v153, v8, v4
    v_mfma_f32_16x16x32_bf16 v[92:95], v[24:27], a[80:83], v[92:95]
    buffer_load_dwordx4 v[80:83], v184, s[48:51], s23 offen offset:1024 sc1
    v_mfma_f32_16x16x32_bf16 v[96:99], v[16:19], a[144:147], 0
    v_fma_f32 v154, v154, v8, v4
    v_fma_f32 v155, v155, v8, v4
    v_mfma_f32_16x16x32_bf16 v[96:99], v[20:23], a[148:151], v[96:99]
    v_mul_f32 v152, v120, v152
    v_mul_f32 v153, v121, v153
    v_mfma_f32_16x16x32_bf16 v[96:99], v[24:27], a[152:155], v[96:99]
    v_mul_f32 v154, v122, v154
    v_mul_f32 v155, v123, v155
    v_mfma_f32_16x16x32_bf16 v[100:103], v[16:19], a[216:219], 0
    buffer_load_dwordx4 v[84:87], v184, s[48:51], s23 offen offset:2048 sc1
    v_mfma_f32_16x16x32_bf16 v[100:103], v[20:23], a[220:223], v[100:103]
    v_exp_f32 v152, v152
    v_mfma_f32_16x16x32_bf16 v[100:103], v[24:27], a[224:227], v[100:103]
    v_exp_f32 v153, v153
    s_waitcnt vmcnt(12)
    v_mfma_f32_16x16x32_bf16 v[104:107], v[28:31], a[0:3], 0
    v_exp_f32 v154, v154
    v_mfma_f32_16x16x32_bf16 v[104:107], v[32:35], a[4:7], v[104:107]
    buffer_load_dwordx4 v[16:19], v184, s[48:51], s23 offen offset:3072 sc1
    v_mfma_f32_16x16x32_bf16 v[104:107], v[36:39], a[8:11], v[104:107]
    v_exp_f32 v155, v155
    v_mfma_f32_16x16x32_bf16 v[108:111], v[28:31], a[72:75], 0
    v_mul_f32 v156, v120, v136
    v_mul_f32 v157, v121, v137
    v_mfma_f32_16x16x32_bf16 v[108:111], v[32:35], a[76:79], v[108:111]
    v_mul_f32 v158, v122, v138
    v_mul_f32 v159, v123, v139
    v_mfma_f32_16x16x32_bf16 v[108:111], v[36:39], a[80:83], v[108:111]
    buffer_load_dwordx4 v[20:23], v185, s[48:51], s23 offen offset:0 sc1
    v_mfma_f32_16x16x32_bf16 v[112:115], v[28:31], a[144:147], 0
    v_fma_f32 v152, v152, v193, v193
    v_fma_f32 v153, v153, v193, v193
    v_mfma_f32_16x16x32_bf16 v[112:115], v[32:35], a[148:151], v[112:115]
    v_fma_f32 v154, v154, v193, v193
    v_fma_f32 v155, v155, v193, v193
    v_mfma_f32_16x16x32_bf16 v[112:115], v[36:39], a[152:155], v[112:115]
    v_rcp_f32 v152, v152
    v_mfma_f32_16x16x32_bf16 v[116:119], v[28:31], a[216:219], 0
    buffer_load_dwordx4 v[24:27], v185, s[48:51], s23 offen offset:1024 sc1
    v_mfma_f32_16x16x32_bf16 v[116:119], v[32:35], a[220:223], v[116:119]
    v_rcp_f32 v153, v153
    v_mfma_f32_16x16x32_bf16 v[116:119], v[36:39], a[224:227], v[116:119]
    v_rcp_f32 v154, v154
    s_waitcnt vmcnt(12)
    v_mfma_f32_16x16x32_bf16 v[88:91], v[40:43], a[12:15], v[88:91]
    v_rcp_f32 v155, v155
    v_mfma_f32_16x16x32_bf16 v[88:91], v[44:47], a[16:19], v[88:91]
    buffer_load_dwordx4 v[28:31], v185, s[48:51], s23 offen offset:2048 sc1
    v_mfma_f32_16x16x32_bf16 v[88:91], v[48:51], a[20:23], v[88:91]
    v_mul_f32 v156, v156, v152
    v_mul_f32 v157, v157, v153
    v_mfma_f32_16x16x32_bf16 v[92:95], v[40:43], a[84:87], v[92:95]
    v_mul_f32 v158, v158, v154
    v_mul_f32 v159, v159, v155
    v_mfma_f32_16x16x32_bf16 v[92:95], v[44:47], a[88:91], v[92:95]
    v_cvt_pk_bf16_f32 v160, v156, v157
    v_cvt_pk_bf16_f32 v161, v158, v159
    v_mfma_f32_16x16x32_bf16 v[92:95], v[48:51], a[92:95], v[92:95]
    buffer_load_dwordx4 v[32:35], v185, s[48:51], s23 offen offset:3072 sc1
    v_mfma_f32_16x16x32_bf16 v[96:99], v[40:43], a[156:159], v[96:99]
    ds_write_b64 v12, v[160:161] offset:0
    v_mfma_f32_16x16x32_bf16 v[96:99], v[44:47], a[160:163], v[96:99]
    v_mul_f32 v162, v124, v124
    v_mul_f32 v163, v125, v125
    v_mfma_f32_16x16x32_bf16 v[96:99], v[48:51], a[164:167], v[96:99]
    v_mul_f32 v164, v126, v126
    v_mul_f32 v165, v127, v127
    v_mfma_f32_16x16x32_bf16 v[100:103], v[40:43], a[228:231], v[100:103]
    buffer_load_dwordx4 v[36:39], v186, s[48:51], s23 offen offset:0 sc1
    v_mfma_f32_16x16x32_bf16 v[100:103], v[44:47], a[232:235], v[100:103]
    v_fma_f32 v162, v162, v9, v5
    v_fma_f32 v163, v163, v9, v5
    v_mfma_f32_16x16x32_bf16 v[100:103], v[48:51], a[236:239], v[100:103]
    v_fma_f32 v164, v164, v9, v5
    v_fma_f32 v165, v165, v9, v5
    s_waitcnt vmcnt(12)
    v_mfma_f32_16x16x32_bf16 v[104:107], v[52:55], a[12:15], v[104:107]
    v_mul_f32 v162, v124, v162
    v_mul_f32 v163, v125, v163
    v_mfma_f32_16x16x32_bf16 v[104:107], v[56:59], a[16:19], v[104:107]
    buffer_load_dwordx4 v[40:43], v186, s[48:51], s23 offen offset:1024 sc1
    v_mfma_f32_16x16x32_bf16 v[104:107], v[60:63], a[20:23], v[104:107]
    v_mul_f32 v164, v126, v164
    v_mul_f32 v165, v127, v165
    v_mfma_f32_16x16x32_bf16 v[108:111], v[52:55], a[84:87], v[108:111]
    v_exp_f32 v162, v162
    v_mfma_f32_16x16x32_bf16 v[108:111], v[56:59], a[88:91], v[108:111]
    v_exp_f32 v163, v163
    v_mfma_f32_16x16x32_bf16 v[108:111], v[60:63], a[92:95], v[108:111]
    buffer_load_dwordx4 v[44:47], v186, s[48:51], s23 offen offset:2048 sc1
    v_mfma_f32_16x16x32_bf16 v[112:115], v[52:55], a[156:159], v[112:115]
    v_exp_f32 v164, v164
    v_mfma_f32_16x16x32_bf16 v[112:115], v[56:59], a[160:163], v[112:115]
    v_exp_f32 v165, v165
    v_mfma_f32_16x16x32_bf16 v[112:115], v[60:63], a[164:167], v[112:115]
    v_mul_f32 v166, v124, v140
    v_mul_f32 v167, v125, v141
    v_mfma_f32_16x16x32_bf16 v[116:119], v[52:55], a[228:231], v[116:119]
    buffer_load_dwordx4 v[48:51], v186, s[48:51], s23 offen offset:3072 sc1
    v_mfma_f32_16x16x32_bf16 v[116:119], v[56:59], a[232:235], v[116:119]
    v_mul_f32 v168, v126, v142
    v_mul_f32 v169, v127, v143
    v_mfma_f32_16x16x32_bf16 v[116:119], v[60:63], a[236:239], v[116:119]
    v_fma_f32 v162, v162, v194, v194
    v_fma_f32 v163, v163, v194, v194
    s_waitcnt vmcnt(12)
    v_mfma_f32_16x16x32_bf16 v[88:91], v[64:67], a[24:27], v[88:91]
    v_fma_f32 v164, v164, v194, v194
    v_fma_f32 v165, v165, v194, v194
    v_mfma_f32_16x16x32_bf16 v[88:91], v[68:71], a[28:31], v[88:91]
    buffer_load_dwordx4 v[52:55], v187, s[48:51], s23 offen offset:0 sc1
    v_mfma_f32_16x16x32_bf16 v[88:91], v[72:75], a[32:35], v[88:91]
    v_rcp_f32 v162, v162
    v_mfma_f32_16x16x32_bf16 v[92:95], v[64:67], a[96:99], v[92:95]
    v_rcp_f32 v163, v163
    v_mfma_f32_16x16x32_bf16 v[92:95], v[68:71], a[100:103], v[92:95]
    v_rcp_f32 v164, v164
    v_mfma_f32_16x16x32_bf16 v[92:95], v[72:75], a[104:107], v[92:95]
    buffer_load_dwordx4 v[56:59], v187, s[48:51], s23 offen offset:1024 sc1
    v_mfma_f32_16x16x32_bf16 v[96:99], v[64:67], a[168:171], v[96:99]
    v_rcp_f32 v165, v165
    v_mfma_f32_16x16x32_bf16 v[96:99], v[68:71], a[172:175], v[96:99]
    v_mul_f32 v166, v166, v162
    v_mul_f32 v167, v167, v163
    v_mfma_f32_16x16x32_bf16 v[96:99], v[72:75], a[176:179], v[96:99]
    v_mul_f32 v168, v168, v164
    v_mul_f32 v169, v169, v165
    v_mfma_f32_16x16x32_bf16 v[100:103], v[64:67], a[240:243], v[100:103]
    buffer_load_dwordx4 v[60:63], v187, s[48:51], s23 offen offset:2048 sc1
    v_mfma_f32_16x16x32_bf16 v[100:103], v[68:71], a[244:247], v[100:103]
    v_cvt_pk_bf16_f32 v170, v166, v167
    v_cvt_pk_bf16_f32 v171, v168, v169
    v_mfma_f32_16x16x32_bf16 v[100:103], v[72:75], a[248:251], v[100:103]
    ds_write_b64 v12, v[170:171] offset:18432
    s_waitcnt vmcnt(12)
    v_mfma_f32_16x16x32_bf16 v[104:107], v[76:79], a[24:27], v[104:107]
    v_mul_f32 v152, v128, v128
    v_mul_f32 v153, v129, v129
    v_mfma_f32_16x16x32_bf16 v[104:107], v[80:83], a[28:31], v[104:107]
    buffer_load_dwordx4 v[64:67], v187, s[48:51], s23 offen offset:3072 sc1
    v_mfma_f32_16x16x32_bf16 v[104:107], v[84:87], a[32:35], v[104:107]
    v_mul_f32 v154, v130, v130
    v_mul_f32 v155, v131, v131
    v_mfma_f32_16x16x32_bf16 v[108:111], v[76:79], a[96:99], v[108:111]
    v_fma_f32 v152, v152, v13, v6
    v_fma_f32 v153, v153, v13, v6
    v_mfma_f32_16x16x32_bf16 v[108:111], v[80:83], a[100:103], v[108:111]
    v_fma_f32 v154, v154, v13, v6
    v_fma_f32 v155, v155, v13, v6
    v_mfma_f32_16x16x32_bf16 v[108:111], v[84:87], a[104:107], v[108:111]
    buffer_load_dwordx4 v[68:71], v188, s[48:51], s23 offen offset:0 sc1
    v_mfma_f32_16x16x32_bf16 v[112:115], v[76:79], a[168:171], v[112:115]
    v_mul_f32 v152, v128, v152
    v_mul_f32 v153, v129, v153
    v_mfma_f32_16x16x32_bf16 v[112:115], v[80:83], a[172:175], v[112:115]
    v_mul_f32 v154, v130, v154
    v_mul_f32 v155, v131, v155
    v_mfma_f32_16x16x32_bf16 v[112:115], v[84:87], a[176:179], v[112:115]
    v_exp_f32 v152, v152
    v_mfma_f32_16x16x32_bf16 v[116:119], v[76:79], a[240:243], v[116:119]
    buffer_load_dwordx4 v[72:75], v188, s[48:51], s23 offen offset:1024 sc1
    v_mfma_f32_16x16x32_bf16 v[116:119], v[80:83], a[244:247], v[116:119]
    v_exp_f32 v153, v153
    v_mfma_f32_16x16x32_bf16 v[116:119], v[84:87], a[248:251], v[116:119]
    v_exp_f32 v154, v154
    s_waitcnt vmcnt(12)
    v_mfma_f32_16x16x32_bf16 v[88:91], v[16:19], a[36:39], v[88:91]
    v_exp_f32 v155, v155
    v_mfma_f32_16x16x32_bf16 v[88:91], v[20:23], a[40:43], v[88:91]
    buffer_load_dwordx4 v[76:79], v188, s[48:51], s23 offen offset:2048 sc1
    v_mfma_f32_16x16x32_bf16 v[88:91], v[24:27], a[44:47], v[88:91]
    v_mul_f32 v156, v128, v144
    v_mul_f32 v157, v129, v145
    v_mfma_f32_16x16x32_bf16 v[92:95], v[16:19], a[108:111], v[92:95]
    v_mul_f32 v158, v130, v146
    v_mul_f32 v159, v131, v147
    v_mfma_f32_16x16x32_bf16 v[92:95], v[20:23], a[112:115], v[92:95]
    v_fma_f32 v152, v152, v195, v195
    v_fma_f32 v153, v153, v195, v195
    v_mfma_f32_16x16x32_bf16 v[92:95], v[24:27], a[116:119], v[92:95]
    buffer_load_dwordx4 v[80:83], v188, s[48:51], s23 offen offset:3072 sc1
    v_mfma_f32_16x16x32_bf16 v[96:99], v[16:19], a[180:183], v[96:99]
    v_fma_f32 v154, v154, v195, v195
    v_fma_f32 v155, v155, v195, v195
    v_mfma_f32_16x16x32_bf16 v[96:99], v[20:23], a[184:187], v[96:99]
    v_rcp_f32 v152, v152
    v_mfma_f32_16x16x32_bf16 v[96:99], v[24:27], a[188:191], v[96:99]
    v_rcp_f32 v153, v153
    v_mfma_f32_16x16x32_bf16 v[100:103], v[16:19], a[252:255], v[100:103]
    buffer_load_dwordx4 v[84:87], v189, s[48:51], s23 offen offset:0 sc1
    v_mfma_f32_16x16x32_bf16 v[100:103], v[20:23], v[220:223], v[100:103]
    v_rcp_f32 v154, v154
    v_mfma_f32_16x16x32_bf16 v[100:103], v[24:27], v[224:227], v[100:103]
    v_rcp_f32 v155, v155
    s_waitcnt vmcnt(12)
    v_mfma_f32_16x16x32_bf16 v[104:107], v[28:31], a[36:39], v[104:107]
    v_mul_f32 v156, v156, v152
    v_mul_f32 v157, v157, v153
    v_mfma_f32_16x16x32_bf16 v[104:107], v[32:35], a[40:43], v[104:107]
    buffer_load_dwordx4 v[16:19], v189, s[48:51], s23 offen offset:1024 sc1
    v_mfma_f32_16x16x32_bf16 v[104:107], v[36:39], a[44:47], v[104:107]
    v_mul_f32 v158, v158, v154
    v_mul_f32 v159, v159, v155
    v_mfma_f32_16x16x32_bf16 v[108:111], v[28:31], a[108:111], v[108:111]
    v_cvt_pk_bf16_f32 v160, v156, v157
    v_cvt_pk_bf16_f32 v161, v158, v159
    v_mfma_f32_16x16x32_bf16 v[108:111], v[32:35], a[112:115], v[108:111]
    ds_write_b64 v12, v[160:161] offset:36864
    v_mfma_f32_16x16x32_bf16 v[108:111], v[36:39], a[116:119], v[108:111]
    buffer_load_dwordx4 v[20:23], v189, s[48:51], s23 offen offset:2048 sc1
    v_mfma_f32_16x16x32_bf16 v[112:115], v[28:31], a[180:183], v[112:115]
    v_mul_f32 v162, v132, v132
    v_mul_f32 v163, v133, v133
    v_mfma_f32_16x16x32_bf16 v[112:115], v[32:35], a[184:187], v[112:115]
    v_mul_f32 v164, v134, v134
    v_mul_f32 v165, v135, v135
    v_mfma_f32_16x16x32_bf16 v[112:115], v[36:39], a[188:191], v[112:115]
    v_fma_f32 v162, v162, v14, v7
    v_fma_f32 v163, v163, v14, v7
    v_mfma_f32_16x16x32_bf16 v[116:119], v[28:31], a[252:255], v[116:119]
    buffer_load_dwordx4 v[24:27], v189, s[48:51], s23 offen offset:3072 sc1
    v_mfma_f32_16x16x32_bf16 v[116:119], v[32:35], v[220:223], v[116:119]
    v_fma_f32 v164, v164, v14, v7
    v_fma_f32 v165, v165, v14, v7
    v_mfma_f32_16x16x32_bf16 v[116:119], v[36:39], v[224:227], v[116:119]
    v_mul_f32 v162, v132, v162
    v_mul_f32 v163, v133, v163
    s_waitcnt vmcnt(12)
    v_mfma_f32_16x16x32_bf16 v[88:91], v[40:43], a[48:51], v[88:91]
    v_mul_f32 v164, v134, v164
    v_mul_f32 v165, v135, v165
    v_mfma_f32_16x16x32_bf16 v[88:91], v[44:47], a[52:55], v[88:91]
    buffer_load_dwordx4 v[28:31], v190, s[48:51], s23 offen offset:0 sc1
    v_mfma_f32_16x16x32_bf16 v[88:91], v[48:51], a[56:59], v[88:91]
    v_exp_f32 v162, v162
    v_mfma_f32_16x16x32_bf16 v[92:95], v[40:43], a[120:123], v[92:95]
    v_exp_f32 v163, v163
    v_mfma_f32_16x16x32_bf16 v[92:95], v[44:47], a[124:127], v[92:95]
    v_exp_f32 v164, v164
    v_mfma_f32_16x16x32_bf16 v[92:95], v[48:51], a[128:131], v[92:95]
    buffer_load_dwordx4 v[32:35], v190, s[48:51], s23 offen offset:1024 sc1
    v_mfma_f32_16x16x32_bf16 v[96:99], v[40:43], a[192:195], v[96:99]
    v_exp_f32 v165, v165
    v_mfma_f32_16x16x32_bf16 v[96:99], v[44:47], a[196:199], v[96:99]
    v_mul_f32 v166, v132, v148
    v_mul_f32 v167, v133, v149
    v_mfma_f32_16x16x32_bf16 v[96:99], v[48:51], a[200:203], v[96:99]
    v_mul_f32 v168, v134, v150
    v_mul_f32 v169, v135, v151
    v_mfma_f32_16x16x32_bf16 v[100:103], v[40:43], v[228:231], v[100:103]
    buffer_load_dwordx4 v[36:39], v190, s[48:51], s23 offen offset:2048 sc1
    v_mfma_f32_16x16x32_bf16 v[100:103], v[44:47], v[232:235], v[100:103]
    v_fma_f32 v162, v162, v252, v252
    v_fma_f32 v163, v163, v252, v252
    v_mfma_f32_16x16x32_bf16 v[100:103], v[48:51], v[236:239], v[100:103]
    v_fma_f32 v164, v164, v252, v252
    v_fma_f32 v165, v165, v252, v252
    s_waitcnt vmcnt(12)
    v_mfma_f32_16x16x32_bf16 v[104:107], v[52:55], a[48:51], v[104:107]
    v_rcp_f32 v162, v162
    v_mfma_f32_16x16x32_bf16 v[104:107], v[56:59], a[52:55], v[104:107]
    buffer_load_dwordx4 v[40:43], v190, s[48:51], s23 offen offset:3072 sc1
    v_mfma_f32_16x16x32_bf16 v[104:107], v[60:63], a[56:59], v[104:107]
    v_rcp_f32 v163, v163
    v_mfma_f32_16x16x32_bf16 v[108:111], v[52:55], a[120:123], v[108:111]
    v_rcp_f32 v164, v164
    v_mfma_f32_16x16x32_bf16 v[108:111], v[56:59], a[124:127], v[108:111]
    v_rcp_f32 v165, v165
    v_mfma_f32_16x16x32_bf16 v[108:111], v[60:63], a[128:131], v[108:111]
    buffer_load_dwordx4 v[44:47], v191, s[48:51], s23 offen offset:0 sc1
    v_mfma_f32_16x16x32_bf16 v[112:115], v[52:55], a[192:195], v[112:115]
    v_mul_f32 v166, v166, v162
    v_mul_f32 v167, v167, v163
    v_mfma_f32_16x16x32_bf16 v[112:115], v[56:59], a[196:199], v[112:115]
    v_mul_f32 v168, v168, v164
    v_mul_f32 v169, v169, v165
    v_mfma_f32_16x16x32_bf16 v[112:115], v[60:63], a[200:203], v[112:115]
    v_cvt_pk_bf16_f32 v170, v166, v167
    v_cvt_pk_bf16_f32 v171, v168, v169
    v_mfma_f32_16x16x32_bf16 v[116:119], v[52:55], v[228:231], v[116:119]
    buffer_load_dwordx4 v[48:51], v191, s[48:51], s23 offen offset:1024 sc1
    v_mfma_f32_16x16x32_bf16 v[116:119], v[56:59], v[232:235], v[116:119]
    ds_write_b64 v12, v[170:171] offset:55296
    v_mfma_f32_16x16x32_bf16 v[116:119], v[60:63], v[236:239], v[116:119]
    s_waitcnt vmcnt(12)
    v_mfma_f32_16x16x32_bf16 v[88:91], v[64:67], a[60:63], v[88:91]
    v_mfma_f32_16x16x32_bf16 v[88:91], v[68:71], a[64:67], v[88:91]
    buffer_load_dwordx4 v[52:55], v191, s[48:51], s23 offen offset:2048 sc1
    v_mfma_f32_16x16x32_bf16 v[120:123], v[72:75], a[68:71], v[88:91]
    v_mfma_f32_16x16x32_bf16 v[92:95], v[64:67], a[132:135], v[92:95]
    v_mfma_f32_16x16x32_bf16 v[92:95], v[68:71], a[136:139], v[92:95]
    v_mfma_f32_16x16x32_bf16 v[124:127], v[72:75], a[140:143], v[92:95]
    buffer_load_dwordx4 v[56:59], v191, s[48:51], s23 offen offset:3072 sc1
    v_mfma_f32_16x16x32_bf16 v[96:99], v[64:67], a[204:207], v[96:99]
    v_mfma_f32_16x16x32_bf16 v[96:99], v[68:71], a[208:211], v[96:99]
    v_mfma_f32_16x16x32_bf16 v[128:131], v[72:75], a[212:215], v[96:99]
    v_mfma_f32_16x16x32_bf16 v[100:103], v[64:67], v[240:243], v[100:103]
    buffer_load_dwordx4 v[60:63], v192, s[48:51], s23 offen offset:0 sc1
    v_mfma_f32_16x16x32_bf16 v[100:103], v[68:71], v[244:247], v[100:103]
    v_mfma_f32_16x16x32_bf16 v[132:135], v[72:75], v[248:251], v[100:103]
    s_waitcnt vmcnt(12)
    v_mfma_f32_16x16x32_bf16 v[104:107], v[76:79], a[60:63], v[104:107]
    v_mfma_f32_16x16x32_bf16 v[104:107], v[80:83], a[64:67], v[104:107]
    buffer_load_dwordx4 v[64:67], v192, s[48:51], s23 offen offset:1024 sc1
    v_mfma_f32_16x16x32_bf16 v[136:139], v[84:87], a[68:71], v[104:107]
    v_mfma_f32_16x16x32_bf16 v[108:111], v[76:79], a[132:135], v[108:111]
    v_mfma_f32_16x16x32_bf16 v[108:111], v[80:83], a[136:139], v[108:111]
    v_mfma_f32_16x16x32_bf16 v[140:143], v[84:87], a[140:143], v[108:111]
    buffer_load_dwordx4 v[68:71], v192, s[48:51], s23 offen offset:2048 sc1
    v_mfma_f32_16x16x32_bf16 v[112:115], v[76:79], a[204:207], v[112:115]
    v_mfma_f32_16x16x32_bf16 v[112:115], v[80:83], a[208:211], v[112:115]
    s_lshl_b32 s7, s25, 11
    v_mfma_f32_16x16x32_bf16 v[144:147], v[84:87], a[212:215], v[112:115]
    s_add_u32 s7, s7, s28
    v_mfma_f32_16x16x32_bf16 v[116:119], v[76:79], v[240:243], v[116:119]
    buffer_load_dwordx4 v[72:75], v192, s[48:51], s23 offen offset:3072 sc1
    v_mfma_f32_16x16x32_bf16 v[116:119], v[80:83], v[244:247], v[116:119]
    s_add_u32 s23, s23, 36864
    v_mfma_f32_16x16x32_bf16 v[148:151], v[84:87], v[248:251], v[116:119]
    v_add_u32 v12, s7, v184
    s_add_u32 s25, s25, 1
    s_cmp_lt_u32 s25, 8
    s_cbranch_scc1 L_ffn_gu_34
    v_add_u32 v10, 73728, v184
    v_add_u32 v11, 110592, v184
    s_lshr_b32 s7, s2, 3
    s_lshl_b32 s7, s7, 2
    s_add_u32 s7, s7, s3
    s_lshl_b32 s7, s7, 9
    v_lshrrev_b32 v1, 1, v253
    v_add_u32 v1, s7, v1
    buffer_load_dwordx2 v[2:3], v1, s[96:99], 0 offen
    s_waitcnt lgkmcnt(0)
    s_barrier
    s_waitcnt vmcnt(12)
    v_mfma_f32_16x16x32_bf16 v[88:91], v[16:19], a[0:3], 0
    v_mfma_f32_16x16x32_bf16 v[88:91], v[20:23], a[4:7], v[88:91]
    buffer_load_dwordx4 v[76:79], v184, s[48:51], s23 offen offset:0 sc1
    v_mfma_f32_16x16x32_bf16 v[88:91], v[24:27], a[8:11], v[88:91]
    v_mul_f32 v152, v120, v120
    v_mul_f32 v153, v121, v121
    v_mfma_f32_16x16x32_bf16 v[92:95], v[16:19], a[72:75], 0
    v_mul_f32 v154, v122, v122
    v_mul_f32 v155, v123, v123
    v_mfma_f32_16x16x32_bf16 v[92:95], v[20:23], a[76:79], v[92:95]
    v_fma_f32 v152, v152, v8, v4
    v_fma_f32 v153, v153, v8, v4
    v_mfma_f32_16x16x32_bf16 v[92:95], v[24:27], a[80:83], v[92:95]
    buffer_load_dwordx4 v[80:83], v184, s[48:51], s23 offen offset:1024 sc1
    v_mfma_f32_16x16x32_bf16 v[96:99], v[16:19], a[144:147], 0
    v_fma_f32 v154, v154, v8, v4
    v_fma_f32 v155, v155, v8, v4
    v_mfma_f32_16x16x32_bf16 v[96:99], v[20:23], a[148:151], v[96:99]
    v_mul_f32 v152, v120, v152
    v_mul_f32 v153, v121, v153
    v_mfma_f32_16x16x32_bf16 v[96:99], v[24:27], a[152:155], v[96:99]
    v_mul_f32 v154, v122, v154
    v_mul_f32 v155, v123, v155
    v_mfma_f32_16x16x32_bf16 v[100:103], v[16:19], a[216:219], 0
    buffer_load_dwordx4 v[84:87], v184, s[48:51], s23 offen offset:2048 sc1
    v_mfma_f32_16x16x32_bf16 v[100:103], v[20:23], a[220:223], v[100:103]
    v_exp_f32 v152, v152
    v_mfma_f32_16x16x32_bf16 v[100:103], v[24:27], a[224:227], v[100:103]
    v_exp_f32 v153, v153
    s_waitcnt vmcnt(12)
    v_mfma_f32_16x16x32_bf16 v[104:107], v[28:31], a[0:3], 0
    v_exp_f32 v154, v154
    ds_read_b128 a[0:3], v10 offset:0
    v_mfma_f32_16x16x32_bf16 v[104:107], v[32:35], a[4:7], v[104:107]
    buffer_load_dwordx4 v[16:19], v184, s[48:51], s23 offen offset:3072 sc1
    v_mfma_f32_16x16x32_bf16 v[104:107], v[36:39], a[8:11], v[104:107]
    v_exp_f32 v155, v155
    v_mfma_f32_16x16x32_bf16 v[108:111], v[28:31], a[72:75], 0
    v_mul_f32 v156, v120, v136
    v_mul_f32 v157, v121, v137
    ds_read_b128 a[72:75], v10 offset:18432
    v_mfma_f32_16x16x32_bf16 v[108:111], v[32:35], a[76:79], v[108:111]
    v_mul_f32 v158, v122, v138
    v_mul_f32 v159, v123, v139
    v_mfma_f32_16x16x32_bf16 v[108:111], v[36:39], a[80:83], v[108:111]
    buffer_load_dwordx4 v[20:23], v185, s[48:51], s23 offen offset:0 sc1
    v_mfma_f32_16x16x32_bf16 v[112:115], v[28:31], a[144:147], 0
    v_fma_f32 v152, v152, v193, v193
    v_fma_f32 v153, v153, v193, v193
    ds_read_b128 a[144:147], v11 offset:0
    v_mfma_f32_16x16x32_bf16 v[112:115], v[32:35], a[148:151], v[112:115]
    v_fma_f32 v154, v154, v193, v193
    v_fma_f32 v155, v155, v193, v193
    v_mfma_f32_16x16x32_bf16 v[112:115], v[36:39], a[152:155], v[112:115]
    v_rcp_f32 v152, v152
    v_mfma_f32_16x16x32_bf16 v[116:119], v[28:31], a[216:219], 0
    buffer_load_dwordx4 v[24:27], v185, s[48:51], s23 offen offset:1024 sc1
    v_mfma_f32_16x16x32_bf16 v[116:119], v[32:35], a[220:223], v[116:119]
    v_rcp_f32 v153, v153
    ds_read_b128 a[216:219], v11 offset:18432
    v_mfma_f32_16x16x32_bf16 v[116:119], v[36:39], a[224:227], v[116:119]
    v_rcp_f32 v154, v154
    ds_read_b128 a[4:7], v10 offset:1024
    s_waitcnt vmcnt(12)
    v_mfma_f32_16x16x32_bf16 v[88:91], v[40:43], a[12:15], v[88:91]
    v_rcp_f32 v155, v155
    ds_read_b128 a[76:79], v10 offset:19456
    v_mfma_f32_16x16x32_bf16 v[88:91], v[44:47], a[16:19], v[88:91]
    buffer_load_dwordx4 v[28:31], v185, s[48:51], s23 offen offset:2048 sc1
    v_mfma_f32_16x16x32_bf16 v[88:91], v[48:51], a[20:23], v[88:91]
    v_mul_f32 v156, v156, v152
    v_mul_f32 v157, v157, v153
    ds_read_b128 a[148:151], v11 offset:1024
    v_mfma_f32_16x16x32_bf16 v[92:95], v[40:43], a[84:87], v[92:95]
    v_mul_f32 v158, v158, v154
    v_mul_f32 v159, v159, v155
    ds_read_b128 a[220:223], v11 offset:19456
    v_mfma_f32_16x16x32_bf16 v[92:95], v[44:47], a[88:91], v[92:95]
    v_cvt_pk_bf16_f32 v160, v156, v157
    v_cvt_pk_bf16_f32 v161, v158, v159
    ds_read_b128 a[8:11], v10 offset:2048
    v_mfma_f32_16x16x32_bf16 v[92:95], v[48:51], a[92:95], v[92:95]
    buffer_load_dwordx4 v[32:35], v185, s[48:51], s23 offen offset:3072 sc1
    v_mfma_f32_16x16x32_bf16 v[96:99], v[40:43], a[156:159], v[96:99]
    ds_write_b64 v12, v[160:161] offset:0
    v_mfma_f32_16x16x32_bf16 v[96:99], v[44:47], a[160:163], v[96:99]
    v_mul_f32 v162, v124, v124
    v_mul_f32 v163, v125, v125
    ds_read_b128 a[80:83], v10 offset:20480
    v_mfma_f32_16x16x32_bf16 v[96:99], v[48:51], a[164:167], v[96:99]
    v_mul_f32 v164, v126, v126
    v_mul_f32 v165, v127, v127
    ds_read_b128 a[152:155], v11 offset:2048
    v_mfma_f32_16x16x32_bf16 v[100:103], v[40:43], a[228:231], v[100:103]
    buffer_load_dwordx4 v[36:39], v186, s[48:51], s23 offen offset:0 sc1
    v_mfma_f32_16x16x32_bf16 v[100:103], v[44:47], a[232:235], v[100:103]
    v_fma_f32 v162, v162, v9, v5
    v_fma_f32 v163, v163, v9, v5
    ds_read_b128 a[224:227], v11 offset:20480
    v_mfma_f32_16x16x32_bf16 v[100:103], v[48:51], a[236:239], v[100:103]
    v_fma_f32 v164, v164, v9, v5
    v_fma_f32 v165, v165, v9, v5
    s_waitcnt vmcnt(12)
    v_mfma_f32_16x16x32_bf16 v[104:107], v[52:55], a[12:15], v[104:107]
    v_mul_f32 v162, v124, v162
    v_mul_f32 v163, v125, v163
    ds_read_b128 a[12:15], v10 offset:3072
    v_mfma_f32_16x16x32_bf16 v[104:107], v[56:59], a[16:19], v[104:107]
    buffer_load_dwordx4 v[40:43], v186, s[48:51], s23 offen offset:1024 sc1
    v_mfma_f32_16x16x32_bf16 v[104:107], v[60:63], a[20:23], v[104:107]
    v_mul_f32 v164, v126, v164
    v_mul_f32 v165, v127, v165
    v_mfma_f32_16x16x32_bf16 v[108:111], v[52:55], a[84:87], v[108:111]
    v_exp_f32 v162, v162
    ds_read_b128 a[84:87], v10 offset:21504
    v_mfma_f32_16x16x32_bf16 v[108:111], v[56:59], a[88:91], v[108:111]
    v_exp_f32 v163, v163
    v_mfma_f32_16x16x32_bf16 v[108:111], v[60:63], a[92:95], v[108:111]
    buffer_load_dwordx4 v[44:47], v186, s[48:51], s23 offen offset:2048 sc1
    v_mfma_f32_16x16x32_bf16 v[112:115], v[52:55], a[156:159], v[112:115]
    v_exp_f32 v164, v164
    ds_read_b128 a[156:159], v11 offset:3072
    v_mfma_f32_16x16x32_bf16 v[112:115], v[56:59], a[160:163], v[112:115]
    v_exp_f32 v165, v165
    v_mfma_f32_16x16x32_bf16 v[112:115], v[60:63], a[164:167], v[112:115]
    v_mul_f32 v166, v124, v140
    v_mul_f32 v167, v125, v141
    v_mfma_f32_16x16x32_bf16 v[116:119], v[52:55], a[228:231], v[116:119]
    buffer_load_dwordx4 v[48:51], v186, s[48:51], s23 offen offset:3072 sc1
    v_mfma_f32_16x16x32_bf16 v[116:119], v[56:59], a[232:235], v[116:119]
    v_mul_f32 v168, v126, v142
    v_mul_f32 v169, v127, v143
    ds_read_b128 a[228:231], v11 offset:21504
    v_mfma_f32_16x16x32_bf16 v[116:119], v[60:63], a[236:239], v[116:119]
    v_fma_f32 v162, v162, v194, v194
    v_fma_f32 v163, v163, v194, v194
    ds_read_b128 a[16:19], v10 offset:4096
    s_waitcnt vmcnt(12)
    v_mfma_f32_16x16x32_bf16 v[88:91], v[64:67], a[24:27], v[88:91]
    v_fma_f32 v164, v164, v194, v194
    v_fma_f32 v165, v165, v194, v194
    ds_read_b128 a[88:91], v10 offset:22528
    v_mfma_f32_16x16x32_bf16 v[88:91], v[68:71], a[28:31], v[88:91]
    buffer_load_dwordx4 v[52:55], v187, s[48:51], s23 offen offset:0 sc1
    v_mfma_f32_16x16x32_bf16 v[88:91], v[72:75], a[32:35], v[88:91]
    v_rcp_f32 v162, v162
    ds_read_b128 a[160:163], v11 offset:4096
    v_mfma_f32_16x16x32_bf16 v[92:95], v[64:67], a[96:99], v[92:95]
    v_rcp_f32 v163, v163
    ds_read_b128 a[232:235], v11 offset:22528
    v_mfma_f32_16x16x32_bf16 v[92:95], v[68:71], a[100:103], v[92:95]
    v_rcp_f32 v164, v164
    ds_read_b128 a[20:23], v10 offset:5120
    v_mfma_f32_16x16x32_bf16 v[92:95], v[72:75], a[104:107], v[92:95]
    buffer_load_dwordx4 v[56:59], v187, s[48:51], s23 offen offset:1024 sc1
    v_mfma_f32_16x16x32_bf16 v[96:99], v[64:67], a[168:171], v[96:99]
    v_rcp_f32 v165, v165
    ds_read_b128 a[92:95], v10 offset:23552
    v_mfma_f32_16x16x32_bf16 v[96:99], v[68:71], a[172:175], v[96:99]
    v_mul_f32 v166, v166, v162
    v_mul_f32 v167, v167, v163
    ds_read_b128 a[164:167], v11 offset:5120
    v_mfma_f32_16x16x32_bf16 v[96:99], v[72:75], a[176:179], v[96:99]
    v_mul_f32 v168, v168, v164
    v_mul_f32 v169, v169, v165
    ds_read_b128 a[236:239], v11 offset:23552
    v_mfma_f32_16x16x32_bf16 v[100:103], v[64:67], a[240:243], v[100:103]
    buffer_load_dwordx4 v[60:63], v187, s[48:51], s23 offen offset:2048 sc1
    v_mfma_f32_16x16x32_bf16 v[100:103], v[68:71], a[244:247], v[100:103]
    v_cvt_pk_bf16_f32 v170, v166, v167
    v_cvt_pk_bf16_f32 v171, v168, v169
    v_mfma_f32_16x16x32_bf16 v[100:103], v[72:75], a[248:251], v[100:103]
    ds_write_b64 v12, v[170:171] offset:18432
    s_waitcnt vmcnt(12)
    v_mfma_f32_16x16x32_bf16 v[104:107], v[76:79], a[24:27], v[104:107]
    v_mul_f32 v152, v128, v128
    v_mul_f32 v153, v129, v129
    ds_read_b128 a[24:27], v10 offset:6144
    v_mfma_f32_16x16x32_bf16 v[104:107], v[80:83], a[28:31], v[104:107]
    buffer_load_dwordx4 v[64:67], v187, s[48:51], s23 offen offset:3072 sc1
    v_mfma_f32_16x16x32_bf16 v[104:107], v[84:87], a[32:35], v[104:107]
    v_mul_f32 v154, v130, v130
    v_mul_f32 v155, v131, v131
    v_mfma_f32_16x16x32_bf16 v[108:111], v[76:79], a[96:99], v[108:111]
    v_fma_f32 v152, v152, v13, v6
    v_fma_f32 v153, v153, v13, v6
    ds_read_b128 a[96:99], v10 offset:24576
    v_mfma_f32_16x16x32_bf16 v[108:111], v[80:83], a[100:103], v[108:111]
    v_fma_f32 v154, v154, v13, v6
    v_fma_f32 v155, v155, v13, v6
    v_mfma_f32_16x16x32_bf16 v[108:111], v[84:87], a[104:107], v[108:111]
    buffer_load_dwordx4 v[68:71], v188, s[48:51], s23 offen offset:0 sc1
    v_mfma_f32_16x16x32_bf16 v[112:115], v[76:79], a[168:171], v[112:115]
    v_mul_f32 v152, v128, v152
    v_mul_f32 v153, v129, v153
    ds_read_b128 a[168:171], v11 offset:6144
    v_mfma_f32_16x16x32_bf16 v[112:115], v[80:83], a[172:175], v[112:115]
    v_mul_f32 v154, v130, v154
    v_mul_f32 v155, v131, v155
    v_mfma_f32_16x16x32_bf16 v[112:115], v[84:87], a[176:179], v[112:115]
    v_exp_f32 v152, v152
    v_mfma_f32_16x16x32_bf16 v[116:119], v[76:79], a[240:243], v[116:119]
    buffer_load_dwordx4 v[72:75], v188, s[48:51], s23 offen offset:1024 sc1
    v_mfma_f32_16x16x32_bf16 v[116:119], v[80:83], a[244:247], v[116:119]
    v_exp_f32 v153, v153
    ds_read_b128 a[240:243], v11 offset:24576
    v_mfma_f32_16x16x32_bf16 v[116:119], v[84:87], a[248:251], v[116:119]
    v_exp_f32 v154, v154
    ds_read_b128 a[28:31], v10 offset:7168
    s_waitcnt vmcnt(12)
    v_mfma_f32_16x16x32_bf16 v[88:91], v[16:19], a[36:39], v[88:91]
    v_exp_f32 v155, v155
    ds_read_b128 a[100:103], v10 offset:25600
    v_mfma_f32_16x16x32_bf16 v[88:91], v[20:23], a[40:43], v[88:91]
    buffer_load_dwordx4 v[76:79], v188, s[48:51], s23 offen offset:2048 sc1
    v_mfma_f32_16x16x32_bf16 v[88:91], v[24:27], a[44:47], v[88:91]
    v_mul_f32 v156, v128, v144
    v_mul_f32 v157, v129, v145
    ds_read_b128 a[172:175], v11 offset:7168
    v_mfma_f32_16x16x32_bf16 v[92:95], v[16:19], a[108:111], v[92:95]
    v_mul_f32 v158, v130, v146
    v_mul_f32 v159, v131, v147
    ds_read_b128 a[244:247], v11 offset:25600
    v_mfma_f32_16x16x32_bf16 v[92:95], v[20:23], a[112:115], v[92:95]
    v_fma_f32 v152, v152, v195, v195
    v_fma_f32 v153, v153, v195, v195
    ds_read_b128 a[32:35], v10 offset:8192
    v_mfma_f32_16x16x32_bf16 v[92:95], v[24:27], a[116:119], v[92:95]
    buffer_load_dwordx4 v[80:83], v188, s[48:51], s23 offen offset:3072 sc1
    v_mfma_f32_16x16x32_bf16 v[96:99], v[16:19], a[180:183], v[96:99]
    v_fma_f32 v154, v154, v195, v195
    v_fma_f32 v155, v155, v195, v195
    ds_read_b128 a[104:107], v10 offset:26624
    v_mfma_f32_16x16x32_bf16 v[96:99], v[20:23], a[184:187], v[96:99]
    v_rcp_f32 v152, v152
    ds_read_b128 a[176:179], v11 offset:8192
    v_mfma_f32_16x16x32_bf16 v[96:99], v[24:27], a[188:191], v[96:99]
    v_rcp_f32 v153, v153
    ds_read_b128 a[248:251], v11 offset:26624
    v_mfma_f32_16x16x32_bf16 v[100:103], v[16:19], a[252:255], v[100:103]
    buffer_load_dwordx4 v[84:87], v189, s[48:51], s23 offen offset:0 sc1
    v_mfma_f32_16x16x32_bf16 v[100:103], v[20:23], v[220:223], v[100:103]
    v_rcp_f32 v154, v154
    v_mfma_f32_16x16x32_bf16 v[100:103], v[24:27], v[224:227], v[100:103]
    v_rcp_f32 v155, v155
    s_waitcnt vmcnt(12)
    v_mfma_f32_16x16x32_bf16 v[104:107], v[28:31], a[36:39], v[104:107]
    v_mul_f32 v156, v156, v152
    v_mul_f32 v157, v157, v153
    ds_read_b128 a[36:39], v10 offset:9216
    v_mfma_f32_16x16x32_bf16 v[104:107], v[32:35], a[40:43], v[104:107]
    buffer_load_dwordx4 v[16:19], v189, s[48:51], s23 offen offset:1024 sc1
    v_mfma_f32_16x16x32_bf16 v[104:107], v[36:39], a[44:47], v[104:107]
    v_mul_f32 v158, v158, v154
    v_mul_f32 v159, v159, v155
    v_mfma_f32_16x16x32_bf16 v[108:111], v[28:31], a[108:111], v[108:111]
    v_cvt_pk_bf16_f32 v160, v156, v157
    v_cvt_pk_bf16_f32 v161, v158, v159
    ds_read_b128 a[108:111], v10 offset:27648
    v_mfma_f32_16x16x32_bf16 v[108:111], v[32:35], a[112:115], v[108:111]
    ds_write_b64 v12, v[160:161] offset:36864
    v_mfma_f32_16x16x32_bf16 v[108:111], v[36:39], a[116:119], v[108:111]
    buffer_load_dwordx4 v[20:23], v189, s[48:51], s23 offen offset:2048 sc1
    v_mfma_f32_16x16x32_bf16 v[112:115], v[28:31], a[180:183], v[112:115]
    v_mul_f32 v162, v132, v132
    v_mul_f32 v163, v133, v133
    ds_read_b128 a[180:183], v11 offset:9216
    v_mfma_f32_16x16x32_bf16 v[112:115], v[32:35], a[184:187], v[112:115]
    v_mul_f32 v164, v134, v134
    v_mul_f32 v165, v135, v135
    v_mfma_f32_16x16x32_bf16 v[112:115], v[36:39], a[188:191], v[112:115]
    v_fma_f32 v162, v162, v14, v7
    v_fma_f32 v163, v163, v14, v7
    v_mfma_f32_16x16x32_bf16 v[116:119], v[28:31], a[252:255], v[116:119]
    buffer_load_dwordx4 v[24:27], v189, s[48:51], s23 offen offset:3072 sc1
    v_mfma_f32_16x16x32_bf16 v[116:119], v[32:35], v[220:223], v[116:119]
    v_fma_f32 v164, v164, v14, v7
    v_fma_f32 v165, v165, v14, v7
    ds_read_b128 a[252:255], v11 offset:27648
    v_mfma_f32_16x16x32_bf16 v[116:119], v[36:39], v[224:227], v[116:119]
    v_mul_f32 v162, v132, v162
    v_mul_f32 v163, v133, v163
    ds_read_b128 a[40:43], v10 offset:10240
    s_waitcnt vmcnt(12)
    v_mfma_f32_16x16x32_bf16 v[88:91], v[40:43], a[48:51], v[88:91]
    v_mul_f32 v164, v134, v164
    v_mul_f32 v165, v135, v165
    ds_read_b128 a[112:115], v10 offset:28672
    v_mfma_f32_16x16x32_bf16 v[88:91], v[44:47], a[52:55], v[88:91]
    buffer_load_dwordx4 v[28:31], v190, s[48:51], s23 offen offset:0 sc1
    v_mfma_f32_16x16x32_bf16 v[88:91], v[48:51], a[56:59], v[88:91]
    v_exp_f32 v162, v162
    ds_read_b128 a[184:187], v11 offset:10240
    v_mfma_f32_16x16x32_bf16 v[92:95], v[40:43], a[120:123], v[92:95]
    v_exp_f32 v163, v163
    ds_read_b128 v[220:223], v11 offset:28672
    v_mfma_f32_16x16x32_bf16 v[92:95], v[44:47], a[124:127], v[92:95]
    v_exp_f32 v164, v164
    ds_read_b128 a[44:47], v10 offset:11264
    v_mfma_f32_16x16x32_bf16 v[92:95], v[48:51], a[128:131], v[92:95]
    buffer_load_dwordx4 v[32:35], v190, s[48:51], s23 offen offset:1024 sc1
    v_mfma_f32_16x16x32_bf16 v[96:99], v[40:43], a[192:195], v[96:99]
    v_exp_f32 v165, v165
    ds_read_b128 a[116:119], v10 offset:29696
    v_mfma_f32_16x16x32_bf16 v[96:99], v[44:47], a[196:199], v[96:99]
    v_mul_f32 v166, v132, v148
    v_mul_f32 v167, v133, v149
    ds_read_b128 a[188:191], v11 offset:11264
    v_mfma_f32_16x16x32_bf16 v[96:99], v[48:51], a[200:203], v[96:99]
    v_mul_f32 v168, v134, v150
    v_mul_f32 v169, v135, v151
    ds_read_b128 v[224:227], v11 offset:29696
    v_mfma_f32_16x16x32_bf16 v[100:103], v[40:43], v[228:231], v[100:103]
    buffer_load_dwordx4 v[36:39], v190, s[48:51], s23 offen offset:2048 sc1
    v_mfma_f32_16x16x32_bf16 v[100:103], v[44:47], v[232:235], v[100:103]
    v_fma_f32 v162, v162, v252, v252
    v_fma_f32 v163, v163, v252, v252
    v_mfma_f32_16x16x32_bf16 v[100:103], v[48:51], v[236:239], v[100:103]
    v_fma_f32 v164, v164, v252, v252
    v_fma_f32 v165, v165, v252, v252
    s_waitcnt vmcnt(12)
    v_mfma_f32_16x16x32_bf16 v[104:107], v[52:55], a[48:51], v[104:107]
    v_rcp_f32 v162, v162
    ds_read_b128 a[48:51], v10 offset:12288
    v_mfma_f32_16x16x32_bf16 v[104:107], v[56:59], a[52:55], v[104:107]
    buffer_load_dwordx4 v[40:43], v190, s[48:51], s23 offen offset:3072 sc1
    v_mfma_f32_16x16x32_bf16 v[104:107], v[60:63], a[56:59], v[104:107]
    v_rcp_f32 v163, v163
    v_mfma_f32_16x16x32_bf16 v[108:111], v[52:55], a[120:123], v[108:111]
    v_rcp_f32 v164, v164
    ds_read_b128 a[120:123], v10 offset:30720
    v_mfma_f32_16x16x32_bf16 v[108:111], v[56:59], a[124:127], v[108:111]
    v_rcp_f32 v165, v165
    v_mfma_f32_16x16x32_bf16 v[108:111], v[60:63], a[128:131], v[108:111]
    buffer_load_dwordx4 v[44:47], v191, s[48:51], s23 offen offset:0 sc1
    v_mfma_f32_16x16x32_bf16 v[112:115], v[52:55], a[192:195], v[112:115]
    v_mul_f32 v166, v166, v162
    v_mul_f32 v167, v167, v163
    ds_read_b128 a[192:195], v11 offset:12288
    v_mfma_f32_16x16x32_bf16 v[112:115], v[56:59], a[196:199], v[112:115]
    v_mul_f32 v168, v168, v164
    v_mul_f32 v169, v169, v165
    v_mfma_f32_16x16x32_bf16 v[112:115], v[60:63], a[200:203], v[112:115]
    v_cvt_pk_bf16_f32 v170, v166, v167
    v_cvt_pk_bf16_f32 v171, v168, v169
    v_mfma_f32_16x16x32_bf16 v[116:119], v[52:55], v[228:231], v[116:119]
    buffer_load_dwordx4 v[48:51], v191, s[48:51], s23 offen offset:1024 sc1
    v_mfma_f32_16x16x32_bf16 v[116:119], v[56:59], v[232:235], v[116:119]
    ds_write_b64 v12, v[170:171] offset:55296
    v_mfma_f32_16x16x32_bf16 v[116:119], v[60:63], v[236:239], v[116:119]
    ds_read_b128 v[228:231], v11 offset:30720
    s_waitcnt vmcnt(12)
    v_mfma_f32_16x16x32_bf16 v[88:91], v[64:67], a[60:63], v[88:91]
    ds_read_b128 a[52:55], v10 offset:13312
    v_mfma_f32_16x16x32_bf16 v[88:91], v[68:71], a[64:67], v[88:91]
    buffer_load_dwordx4 v[52:55], v191, s[48:51], s23 offen offset:2048 sc1
    v_mfma_f32_16x16x32_bf16 v[120:123], v[72:75], a[68:71], v[88:91]
    ds_read_b128 a[124:127], v10 offset:31744
    v_mfma_f32_16x16x32_bf16 v[92:95], v[64:67], a[132:135], v[92:95]
    ds_read_b128 a[196:199], v11 offset:13312
    v_mfma_f32_16x16x32_bf16 v[92:95], v[68:71], a[136:139], v[92:95]
    ds_read_b128 v[232:235], v11 offset:31744
    v_mfma_f32_16x16x32_bf16 v[124:127], v[72:75], a[140:143], v[92:95]
    buffer_load_dwordx4 v[56:59], v191, s[48:51], s23 offen offset:3072 sc1
    v_mfma_f32_16x16x32_bf16 v[96:99], v[64:67], a[204:207], v[96:99]
    v_mfma_f32_16x16x32_bf16 v[96:99], v[68:71], a[208:211], v[96:99]
    v_mfma_f32_16x16x32_bf16 v[128:131], v[72:75], a[212:215], v[96:99]
    v_mfma_f32_16x16x32_bf16 v[100:103], v[64:67], v[240:243], v[100:103]
    buffer_load_dwordx4 v[60:63], v192, s[48:51], s23 offen offset:0 sc1
    v_mfma_f32_16x16x32_bf16 v[100:103], v[68:71], v[244:247], v[100:103]
    v_mfma_f32_16x16x32_bf16 v[132:135], v[72:75], v[248:251], v[100:103]
    s_waitcnt vmcnt(12)
    v_mfma_f32_16x16x32_bf16 v[104:107], v[76:79], a[60:63], v[104:107]
    v_mfma_f32_16x16x32_bf16 v[104:107], v[80:83], a[64:67], v[104:107]
    buffer_load_dwordx4 v[64:67], v192, s[48:51], s23 offen offset:1024 sc1
    v_mfma_f32_16x16x32_bf16 v[136:139], v[84:87], a[68:71], v[104:107]
    v_mfma_f32_16x16x32_bf16 v[108:111], v[76:79], a[132:135], v[108:111]
    v_mfma_f32_16x16x32_bf16 v[108:111], v[80:83], a[136:139], v[108:111]
    v_mfma_f32_16x16x32_bf16 v[140:143], v[84:87], a[140:143], v[108:111]
    buffer_load_dwordx4 v[68:71], v192, s[48:51], s23 offen offset:2048 sc1
    v_mfma_f32_16x16x32_bf16 v[112:115], v[76:79], a[204:207], v[112:115]
    v_mfma_f32_16x16x32_bf16 v[112:115], v[80:83], a[208:211], v[112:115]
    s_lshl_b32 s7, s25, 11
    v_mfma_f32_16x16x32_bf16 v[144:147], v[84:87], a[212:215], v[112:115]
    s_add_u32 s7, s7, s28
    v_mfma_f32_16x16x32_bf16 v[116:119], v[76:79], v[240:243], v[116:119]
    buffer_load_dwordx4 v[72:75], v192, s[48:51], s23 offen offset:3072 sc1
    v_mfma_f32_16x16x32_bf16 v[116:119], v[80:83], v[244:247], v[116:119]
    s_add_u32 s23, s23, 36864
    v_mfma_f32_16x16x32_bf16 v[148:151], v[84:87], v[248:251], v[116:119]
    v_add_u32 v12, s7, v184
    s_add_u32 s25, s25, 1
    s_waitcnt lgkmcnt(0)
    s_barrier
    v_pk_mul_f32 v[152:153], v[120:121], v[120:121]
    ds_read_b128 a[56:59], v10 offset:14336
    v_pk_mul_f32 v[154:155], v[122:123], v[122:123]
    ds_read_b128 a[128:131], v10 offset:32768
    v_pk_fma_f32 v[152:153], v[152:153], v[8:9], v[4:5] op_sel:[0,0,0] op_sel_hi:[1,0,0]
    ds_read_b128 a[200:203], v11 offset:14336
    v_pk_fma_f32 v[154:155], v[154:155], v[8:9], v[4:5] op_sel:[0,0,0] op_sel_hi:[1,0,0]
    v_pk_mul_f32 v[152:153], v[120:121], v[152:153]
    ds_read_b128 v[236:239], v11 offset:32768
    v_pk_mul_f32 v[154:155], v[122:123], v[154:155]
    ds_read_b128 a[60:63], v10 offset:15360
    buffer_load_dwordx4 v[76:79], v184, s[48:51], s23 offen offset:0 sc1
    v_exp_f32 v152, v152
    ds_read_b128 a[132:135], v10 offset:33792
    v_exp_f32 v153, v153
    v_exp_f32 v154, v154
    ds_read_b128 a[204:207], v11 offset:15360
    v_exp_f32 v155, v155
    ds_read_b128 v[240:243], v11 offset:33792
    v_pk_mul_f32 v[156:157], v[120:121], v[136:137]
    v_pk_mul_f32 v[158:159], v[122:123], v[138:139]
    buffer_load_dwordx4 v[80:83], v184, s[48:51], s23 offen offset:1024 sc1
    v_pk_fma_f32 v[152:153], v[152:153], v[192:193], v[192:193] op_sel:[0,1,1] op_sel_hi:[1,1,1]
    v_pk_fma_f32 v[154:155], v[154:155], v[192:193], v[192:193] op_sel:[0,1,1] op_sel_hi:[1,1,1]
    v_rcp_f32 v152, v152
    v_rcp_f32 v153, v153
    v_rcp_f32 v154, v154
    v_rcp_f32 v155, v155
    buffer_load_dwordx4 v[84:87], v184, s[48:51], s23 offen offset:2048 sc1
    s_nop 0
    v_pk_mul_f32 v[156:157], v[156:157], v[152:153]
    v_pk_mul_f32 v[158:159], v[158:159], v[154:155]
    v_cvt_pk_bf16_f32 v160, v156, v157
    v_cvt_pk_bf16_f32 v161, v158, v159
    ds_write_b64 v12, v[160:161] offset:0
    buffer_load_dwordx4 v[104:107], v184, s[48:51], s23 offen offset:3072 sc1
    v_pk_mul_f32 v[162:163], v[124:125], v[124:125]
    v_pk_mul_f32 v[164:165], v[126:127], v[126:127]
    v_pk_fma_f32 v[162:163], v[162:163], v[8:9], v[4:5] op_sel:[0,1,1] op_sel_hi:[1,1,1]
    v_pk_fma_f32 v[164:165], v[164:165], v[8:9], v[4:5] op_sel:[0,1,1] op_sel_hi:[1,1,1]
    v_pk_mul_f32 v[162:163], v[124:125], v[162:163]
    v_pk_mul_f32 v[164:165], v[126:127], v[164:165]
    buffer_load_dwordx4 v[108:111], v185, s[48:51], s23 offen offset:0 sc1
    v_exp_f32 v162, v162
    v_exp_f32 v163, v163
    v_exp_f32 v164, v164
    v_exp_f32 v165, v165
    v_pk_mul_f32 v[166:167], v[124:125], v[140:141]
    v_pk_mul_f32 v[168:169], v[126:127], v[142:143]
    buffer_load_dwordx4 v[112:115], v185, s[48:51], s23 offen offset:1024 sc1
    v_pk_fma_f32 v[162:163], v[162:163], v[194:195], v[194:195] op_sel:[0,0,0] op_sel_hi:[1,0,0]
    v_pk_fma_f32 v[164:165], v[164:165], v[194:195], v[194:195] op_sel:[0,0,0] op_sel_hi:[1,0,0]
    v_rcp_f32 v162, v162
    v_rcp_f32 v163, v163
    v_rcp_f32 v164, v164
    v_rcp_f32 v165, v165
    buffer_load_dwordx4 v[116:119], v185, s[48:51], s23 offen offset:2048 sc1
    s_nop 0
    v_pk_mul_f32 v[166:167], v[166:167], v[162:163]
    v_pk_mul_f32 v[168:169], v[168:169], v[164:165]
    v_cvt_pk_bf16_f32 v170, v166, v167
    v_cvt_pk_bf16_f32 v171, v168, v169
    ds_write_b64 v12, v[170:171] offset:18432
    buffer_load_dwordx4 v[180:183], v185, s[48:51], s23 offen offset:3072 sc1
    v_pk_mul_f32 v[152:153], v[128:129], v[128:129]
    v_pk_mul_f32 v[154:155], v[130:131], v[130:131]
    v_pk_fma_f32 v[152:153], v[152:153], v[12:13], v[6:7] op_sel:[0,1,0] op_sel_hi:[1,1,0]
    v_pk_fma_f32 v[154:155], v[154:155], v[12:13], v[6:7] op_sel:[0,1,0] op_sel_hi:[1,1,0]
    v_pk_mul_f32 v[152:153], v[128:129], v[152:153]
    v_pk_mul_f32 v[154:155], v[130:131], v[154:155]
    buffer_load_dwordx4 v[196:199], v186, s[48:51], s23 offen offset:0 sc1
    v_exp_f32 v152, v152
    v_exp_f32 v153, v153
    v_exp_f32 v154, v154
    v_exp_f32 v155, v155
    v_pk_mul_f32 v[156:157], v[128:129], v[144:145]
    v_pk_mul_f32 v[158:159], v[130:131], v[146:147]
    buffer_load_dwordx4 v[200:203], v186, s[48:51], s23 offen offset:1024 sc1
    v_pk_fma_f32 v[152:153], v[152:153], v[194:195], v[194:195] op_sel:[0,1,1] op_sel_hi:[1,1,1]
    v_pk_fma_f32 v[154:155], v[154:155], v[194:195], v[194:195] op_sel:[0,1,1] op_sel_hi:[1,1,1]
    v_rcp_f32 v152, v152
    v_rcp_f32 v153, v153
    v_rcp_f32 v154, v154
    v_rcp_f32 v155, v155
    buffer_load_dwordx4 v[204:207], v186, s[48:51], s23 offen offset:2048 sc1
    s_nop 0
    v_pk_mul_f32 v[156:157], v[156:157], v[152:153]
    v_pk_mul_f32 v[158:159], v[158:159], v[154:155]
    v_cvt_pk_bf16_f32 v160, v156, v157
    v_cvt_pk_bf16_f32 v161, v158, v159
    ds_write_b64 v12, v[160:161] offset:36864
    buffer_load_dwordx4 v[208:211], v186, s[48:51], s23 offen offset:3072 sc1
    v_pk_mul_f32 v[162:163], v[132:133], v[132:133]
    v_pk_mul_f32 v[164:165], v[134:135], v[134:135]
    v_pk_fma_f32 v[162:163], v[162:163], v[14:15], v[6:7] op_sel:[0,0,1] op_sel_hi:[1,0,1]
    v_pk_fma_f32 v[164:165], v[164:165], v[14:15], v[6:7] op_sel:[0,0,1] op_sel_hi:[1,0,1]
    v_pk_mul_f32 v[162:163], v[132:133], v[162:163]
    v_pk_mul_f32 v[164:165], v[134:135], v[164:165]
    buffer_load_dwordx4 v[212:215], v187, s[48:51], s23 offen offset:0 sc1
    v_exp_f32 v162, v162
    v_exp_f32 v163, v163
    v_exp_f32 v164, v164
    v_exp_f32 v165, v165
    v_pk_mul_f32 v[166:167], v[132:133], v[148:149]
    v_pk_mul_f32 v[168:169], v[134:135], v[150:151]
    v_pk_fma_f32 v[162:163], v[162:163], v[252:253], v[252:253] op_sel:[0,0,0] op_sel_hi:[1,0,0]
    v_pk_fma_f32 v[164:165], v[164:165], v[252:253], v[252:253] op_sel:[0,0,0] op_sel_hi:[1,0,0]
    v_rcp_f32 v162, v162
    v_rcp_f32 v163, v163
    v_rcp_f32 v164, v164
    v_rcp_f32 v165, v165
    s_nop 0
    v_pk_mul_f32 v[166:167], v[166:167], v[162:163]
    v_pk_mul_f32 v[168:169], v[168:169], v[164:165]
    v_cvt_pk_bf16_f32 v170, v166, v167
    v_cvt_pk_bf16_f32 v171, v168, v169
    ds_write_b64 v12, v[170:171] offset:55296
    buffer_load_dwordx4 v[136:139], v187, s[48:51], s23 offen offset:1024 sc1
    buffer_load_dwordx4 v[140:143], v187, s[48:51], s23 offen offset:2048 sc1
    buffer_load_dwordx4 v[144:147], v187, s[48:51], s23 offen offset:3072 sc1
    buffer_load_dwordx4 v[160:163], v188, s[48:51], s23 offen offset:0 sc1
    buffer_load_dwordx4 v[164:167], v188, s[48:51], s23 offen offset:1024 sc1
    s_add_u32 s23, s23, 18432
    s_waitcnt lgkmcnt(0)
    s_barrier
    ds_read_b128 a[64:67], v10 offset:16384
    ds_read_b128 a[136:139], v10 offset:34816
    ds_read_b128 a[208:211], v11 offset:16384
    ds_read_b128 v[244:247], v11 offset:34816
    ds_read_b128 a[68:71], v10 offset:17408
    ds_read_b128 a[140:143], v10 offset:35840
    ds_read_b128 a[212:215], v11 offset:17408
    ds_read_b128 v[248:251], v11 offset:35840
    s_mov_b32 s25, 0
    s_waitcnt lgkmcnt(0)
    s_branch L_ffn_dn_mid_36
L_ffn_dn_35:
    s_waitcnt vmcnt(32)
    v_mfma_f32_16x16x32_bf16 v[88:91], v[104:107], a[0:3], 0
    v_mfma_f32_16x16x32_bf16 v[88:91], v[108:111], a[4:7], v[88:91]
    buffer_load_dwordx4 v[76:79], v184, s[48:51], s23 offen offset:0 sc1
    v_mfma_f32_16x16x32_bf16 v[88:91], v[112:115], a[8:11], v[88:91]
    v_mfma_f32_16x16x32_bf16 v[92:95], v[104:107], a[72:75], 0
    v_mfma_f32_16x16x32_bf16 v[92:95], v[108:111], a[76:79], v[92:95]
    v_mfma_f32_16x16x32_bf16 v[92:95], v[112:115], a[80:83], v[92:95]
    buffer_load_dwordx4 v[80:83], v184, s[48:51], s23 offen offset:1024 sc1
    v_mfma_f32_16x16x32_bf16 v[96:99], v[104:107], a[144:147], 0
    v_cvt_pk_bf16_f32 v152, v120, v121
    v_cvt_pk_bf16_f32 v153, v122, v123
    v_mfma_f32_16x16x32_bf16 v[96:99], v[108:111], a[148:151], v[96:99]
    v_cvt_pk_bf16_f32 v154, v124, v125
    v_cvt_pk_bf16_f32 v155, v126, v127
    v_mfma_f32_16x16x32_bf16 v[96:99], v[112:115], a[152:155], v[96:99]
    s_nop 0
    v_permlane16_swap_b32 v152, v154
    v_mfma_f32_16x16x32_bf16 v[100:103], v[104:107], a[216:219], 0
    buffer_load_dwordx4 v[84:87], v184, s[48:51], s23 offen offset:2048 sc1
    v_mfma_f32_16x16x32_bf16 v[100:103], v[108:111], a[220:223], v[100:103]
    v_permlane16_swap_b32 v153, v155
    v_mfma_f32_16x16x32_bf16 v[100:103], v[112:115], a[224:227], v[100:103]
    buffer_store_dwordx4 v[152:155], v178, s[72:75], s27 offen sc1
    s_waitcnt vmcnt(33)
    v_mfma_f32_16x16x32_bf16 v[88:91], v[116:119], a[12:15], v[88:91]
    ds_write_b128 v216, v[152:155]
    v_mfma_f32_16x16x32_bf16 v[88:91], v[180:183], a[16:19], v[88:91]
    buffer_load_dwordx4 v[104:107], v184, s[48:51], s23 offen offset:3072 sc1
    v_mfma_f32_16x16x32_bf16 v[88:91], v[196:199], a[20:23], v[88:91]
    v_add_u32 v216, v216, v218
    v_mfma_f32_16x16x32_bf16 v[92:95], v[116:119], a[84:87], v[92:95]
    v_mfma_f32_16x16x32_bf16 v[92:95], v[180:183], a[88:91], v[92:95]
    v_mfma_f32_16x16x32_bf16 v[92:95], v[196:199], a[92:95], v[92:95]
    buffer_load_dwordx4 v[108:111], v185, s[48:51], s23 offen offset:0 sc1
    v_mfma_f32_16x16x32_bf16 v[96:99], v[116:119], a[156:159], v[96:99]
    v_mfma_f32_16x16x32_bf16 v[96:99], v[180:183], a[160:163], v[96:99]
    v_mfma_f32_16x16x32_bf16 v[96:99], v[196:199], a[164:167], v[96:99]
    v_mfma_f32_16x16x32_bf16 v[100:103], v[116:119], a[228:231], v[100:103]
    buffer_load_dwordx4 v[112:115], v185, s[48:51], s23 offen offset:1024 sc1
    v_mfma_f32_16x16x32_bf16 v[100:103], v[180:183], a[232:235], v[100:103]
    v_mfma_f32_16x16x32_bf16 v[100:103], v[196:199], a[236:239], v[100:103]
    s_waitcnt vmcnt(33)
    v_mfma_f32_16x16x32_bf16 v[88:91], v[200:203], a[24:27], v[88:91]
    v_mfma_f32_16x16x32_bf16 v[88:91], v[204:207], a[28:31], v[88:91]
    buffer_load_dwordx4 v[116:119], v185, s[48:51], s23 offen offset:2048 sc1
    v_mfma_f32_16x16x32_bf16 v[88:91], v[208:211], a[32:35], v[88:91]
    v_mfma_f32_16x16x32_bf16 v[92:95], v[200:203], a[96:99], v[92:95]
    v_mfma_f32_16x16x32_bf16 v[92:95], v[204:207], a[100:103], v[92:95]
    v_mfma_f32_16x16x32_bf16 v[92:95], v[208:211], a[104:107], v[92:95]
    buffer_load_dwordx4 v[180:183], v185, s[48:51], s23 offen offset:3072 sc1
    v_mfma_f32_16x16x32_bf16 v[96:99], v[200:203], a[168:171], v[96:99]
    v_mfma_f32_16x16x32_bf16 v[96:99], v[204:207], a[172:175], v[96:99]
    v_mfma_f32_16x16x32_bf16 v[96:99], v[208:211], a[176:179], v[96:99]
    v_mfma_f32_16x16x32_bf16 v[100:103], v[200:203], a[240:243], v[100:103]
    buffer_load_dwordx4 v[196:199], v186, s[48:51], s23 offen offset:0 sc1
    v_mfma_f32_16x16x32_bf16 v[100:103], v[204:207], a[244:247], v[100:103]
    v_mfma_f32_16x16x32_bf16 v[100:103], v[208:211], a[248:251], v[100:103]
    s_waitcnt vmcnt(33)
    v_mfma_f32_16x16x32_bf16 v[88:91], v[212:215], a[36:39], v[88:91]
    v_mfma_f32_16x16x32_bf16 v[88:91], v[136:139], a[40:43], v[88:91]
    buffer_load_dwordx4 v[200:203], v186, s[48:51], s23 offen offset:1024 sc1
    v_mfma_f32_16x16x32_bf16 v[88:91], v[140:143], a[44:47], v[88:91]
    v_mfma_f32_16x16x32_bf16 v[92:95], v[212:215], a[108:111], v[92:95]
    v_mfma_f32_16x16x32_bf16 v[92:95], v[136:139], a[112:115], v[92:95]
    v_cvt_pk_bf16_f32 v156, v128, v129
    v_cvt_pk_bf16_f32 v157, v130, v131
    v_mfma_f32_16x16x32_bf16 v[92:95], v[140:143], a[116:119], v[92:95]
    buffer_load_dwordx4 v[204:207], v186, s[48:51], s23 offen offset:2048 sc1
    v_mfma_f32_16x16x32_bf16 v[96:99], v[212:215], a[180:183], v[96:99]
    v_cvt_pk_bf16_f32 v158, v132, v133
    v_cvt_pk_bf16_f32 v159, v134, v135
    v_mfma_f32_16x16x32_bf16 v[96:99], v[136:139], a[184:187], v[96:99]
    s_nop 0
    v_permlane16_swap_b32 v156, v158
    v_mfma_f32_16x16x32_bf16 v[96:99], v[140:143], a[188:191], v[96:99]
    v_permlane16_swap_b32 v157, v159
    v_mfma_f32_16x16x32_bf16 v[100:103], v[212:215], a[252:255], v[100:103]
    buffer_load_dwordx4 v[208:211], v186, s[48:51], s23 offen offset:3072 sc1
    v_mfma_f32_16x16x32_bf16 v[100:103], v[136:139], v[220:223], v[100:103]
    buffer_store_dwordx4 v[156:159], v179, s[72:75], s27 offen sc1
    v_mfma_f32_16x16x32_bf16 v[100:103], v[140:143], v[224:227], v[100:103]
    ds_write_b128 v217, v[156:159]
    s_waitcnt vmcnt(34)
    v_mfma_f32_16x16x32_bf16 v[88:91], v[144:147], a[48:51], v[88:91]
    v_add_u32 v217, v217, v219
    v_mfma_f32_16x16x32_bf16 v[88:91], v[160:163], a[52:55], v[88:91]
    buffer_load_dwordx4 v[212:215], v187, s[48:51], s23 offen offset:0 sc1
    v_mfma_f32_16x16x32_bf16 v[88:91], v[164:167], a[56:59], v[88:91]
    v_mfma_f32_16x16x32_bf16 v[92:95], v[144:147], a[120:123], v[92:95]
    v_mfma_f32_16x16x32_bf16 v[92:95], v[160:163], a[124:127], v[92:95]
    v_mfma_f32_16x16x32_bf16 v[92:95], v[164:167], a[128:131], v[92:95]
    buffer_load_dwordx4 v[136:139], v187, s[48:51], s23 offen offset:1024 sc1
    v_mfma_f32_16x16x32_bf16 v[96:99], v[144:147], a[192:195], v[96:99]
    v_mfma_f32_16x16x32_bf16 v[96:99], v[160:163], a[196:199], v[96:99]
    v_mfma_f32_16x16x32_bf16 v[96:99], v[164:167], a[200:203], v[96:99]
    v_mfma_f32_16x16x32_bf16 v[100:103], v[144:147], v[228:231], v[100:103]
    buffer_load_dwordx4 v[140:143], v187, s[48:51], s23 offen offset:2048 sc1
    v_mfma_f32_16x16x32_bf16 v[100:103], v[160:163], v[232:235], v[100:103]
    v_mfma_f32_16x16x32_bf16 v[100:103], v[164:167], v[236:239], v[100:103]
    s_waitcnt vmcnt(34)
    v_mfma_f32_16x16x32_bf16 v[88:91], v[168:171], a[60:63], v[88:91]
    v_mfma_f32_16x16x32_bf16 v[88:91], v[148:151], a[64:67], v[88:91]
    buffer_load_dwordx4 v[144:147], v187, s[48:51], s23 offen offset:3072 sc1
    v_mfma_f32_16x16x32_bf16 v[120:123], v[4:7], a[68:71], v[88:91]
    v_mfma_f32_16x16x32_bf16 v[92:95], v[168:171], a[132:135], v[92:95]
    v_mfma_f32_16x16x32_bf16 v[92:95], v[148:151], a[136:139], v[92:95]
    v_mfma_f32_16x16x32_bf16 v[124:127], v[4:7], a[140:143], v[92:95]
    buffer_load_dwordx4 v[160:163], v188, s[48:51], s23 offen offset:0 sc1
    v_mfma_f32_16x16x32_bf16 v[96:99], v[168:171], a[204:207], v[96:99]
    s_mov_b32 s74, 268435456
    v_mfma_f32_16x16x32_bf16 v[96:99], v[148:151], a[208:211], v[96:99]
    s_add_u32 s27, s27, 1024
    v_mfma_f32_16x16x32_bf16 v[128:131], v[4:7], a[212:215], v[96:99]
    s_add_u32 s25, s25, 1
    v_mfma_f32_16x16x32_bf16 v[100:103], v[168:171], v[240:243], v[100:103]
    buffer_load_dwordx4 v[164:167], v188, s[48:51], s23 offen offset:1024 sc1
    v_mfma_f32_16x16x32_bf16 v[100:103], v[148:151], v[244:247], v[100:103]
    s_add_u32 s23, s23, 18432
    v_mfma_f32_16x16x32_bf16 v[132:135], v[4:7], v[248:251], v[100:103]
L_ffn_dn_mid_36:
    s_waitcnt vmcnt(30)
    v_mfma_f32_16x16x32_bf16 v[88:91], v[16:19], a[0:3], 0
    v_mfma_f32_16x16x32_bf16 v[88:91], v[20:23], a[4:7], v[88:91]
    buffer_load_dwordx4 v[168:171], v184, s[48:51], s23 offen offset:0 sc1
    v_mfma_f32_16x16x32_bf16 v[88:91], v[24:27], a[8:11], v[88:91]
    v_mfma_f32_16x16x32_bf16 v[92:95], v[16:19], a[72:75], 0
    v_mfma_f32_16x16x32_bf16 v[92:95], v[20:23], a[76:79], v[92:95]
    v_mfma_f32_16x16x32_bf16 v[92:95], v[24:27], a[80:83], v[92:95]
    buffer_load_dwordx4 v[148:151], v184, s[48:51], s23 offen offset:1024 sc1
    v_mfma_f32_16x16x32_bf16 v[96:99], v[16:19], a[144:147], 0
    v_cvt_pk_bf16_f32 v152, v120, v121
    v_cvt_pk_bf16_f32 v153, v122, v123
    v_mfma_f32_16x16x32_bf16 v[96:99], v[20:23], a[148:151], v[96:99]
    v_cvt_pk_bf16_f32 v154, v124, v125
    v_cvt_pk_bf16_f32 v155, v126, v127
    v_mfma_f32_16x16x32_bf16 v[96:99], v[24:27], a[152:155], v[96:99]
    s_nop 0
    v_permlane16_swap_b32 v152, v154
    v_mfma_f32_16x16x32_bf16 v[100:103], v[16:19], a[216:219], 0
    buffer_load_dwordx4 v[4:7], v184, s[48:51], s23 offen offset:2048 sc1
    v_mfma_f32_16x16x32_bf16 v[100:103], v[20:23], a[220:223], v[100:103]
    v_permlane16_swap_b32 v153, v155
    v_mfma_f32_16x16x32_bf16 v[100:103], v[24:27], a[224:227], v[100:103]
    buffer_store_dwordx4 v[152:155], v178, s[72:75], s27 offen sc1
    s_waitcnt vmcnt(31)
    v_mfma_f32_16x16x32_bf16 v[88:91], v[28:31], a[12:15], v[88:91]
    ds_write_b128 v216, v[152:155]
    v_mfma_f32_16x16x32_bf16 v[88:91], v[32:35], a[16:19], v[88:91]
    buffer_load_dwordx4 v[16:19], v184, s[48:51], s23 offen offset:3072 sc1
    v_mfma_f32_16x16x32_bf16 v[88:91], v[36:39], a[20:23], v[88:91]
    v_add_u32 v216, v216, v218
    v_mfma_f32_16x16x32_bf16 v[92:95], v[28:31], a[84:87], v[92:95]
    v_mfma_f32_16x16x32_bf16 v[92:95], v[32:35], a[88:91], v[92:95]
    v_mfma_f32_16x16x32_bf16 v[92:95], v[36:39], a[92:95], v[92:95]
    buffer_load_dwordx4 v[20:23], v185, s[48:51], s23 offen offset:0 sc1
    v_mfma_f32_16x16x32_bf16 v[96:99], v[28:31], a[156:159], v[96:99]
    v_mfma_f32_16x16x32_bf16 v[96:99], v[32:35], a[160:163], v[96:99]
    v_mfma_f32_16x16x32_bf16 v[96:99], v[36:39], a[164:167], v[96:99]
    v_mfma_f32_16x16x32_bf16 v[100:103], v[28:31], a[228:231], v[100:103]
    buffer_load_dwordx4 v[24:27], v185, s[48:51], s23 offen offset:1024 sc1
    v_mfma_f32_16x16x32_bf16 v[100:103], v[32:35], a[232:235], v[100:103]
    v_mfma_f32_16x16x32_bf16 v[100:103], v[36:39], a[236:239], v[100:103]
    s_waitcnt vmcnt(31)
    v_mfma_f32_16x16x32_bf16 v[88:91], v[40:43], a[24:27], v[88:91]
    v_mfma_f32_16x16x32_bf16 v[88:91], v[44:47], a[28:31], v[88:91]
    buffer_load_dwordx4 v[28:31], v185, s[48:51], s23 offen offset:2048 sc1
    v_mfma_f32_16x16x32_bf16 v[88:91], v[48:51], a[32:35], v[88:91]
    v_mfma_f32_16x16x32_bf16 v[92:95], v[40:43], a[96:99], v[92:95]
    v_mfma_f32_16x16x32_bf16 v[92:95], v[44:47], a[100:103], v[92:95]
    v_mfma_f32_16x16x32_bf16 v[92:95], v[48:51], a[104:107], v[92:95]
    buffer_load_dwordx4 v[32:35], v185, s[48:51], s23 offen offset:3072 sc1
    v_mfma_f32_16x16x32_bf16 v[96:99], v[40:43], a[168:171], v[96:99]
    v_mfma_f32_16x16x32_bf16 v[96:99], v[44:47], a[172:175], v[96:99]
    v_mfma_f32_16x16x32_bf16 v[96:99], v[48:51], a[176:179], v[96:99]
    v_mfma_f32_16x16x32_bf16 v[100:103], v[40:43], a[240:243], v[100:103]
    buffer_load_dwordx4 v[36:39], v186, s[48:51], s23 offen offset:0 sc1
    v_mfma_f32_16x16x32_bf16 v[100:103], v[44:47], a[244:247], v[100:103]
    v_mfma_f32_16x16x32_bf16 v[100:103], v[48:51], a[248:251], v[100:103]
    s_waitcnt vmcnt(31)
    s_cmp_lg_u32 s25, 6
    s_cbranch_scc1 L_early_37
    s_waitcnt vmcnt(16)
    s_barrier
    s_cmp_lg_u32 s3, 0
    s_cbranch_scc1 L_early_37
    v_lshlrev_b32 v15, 7, v0
    v_mov_b32 v1, s76
    s_mov_b64 exec, 0xff
    buffer_store_dword v1, v15, s[8:11], s29 offen sc1
    s_mov_b64 exec, -1
L_early_37:
    v_mfma_f32_16x16x32_bf16 v[88:91], v[52:55], a[36:39], v[88:91]
    v_mfma_f32_16x16x32_bf16 v[88:91], v[56:59], a[40:43], v[88:91]
    buffer_load_dwordx4 v[40:43], v186, s[48:51], s23 offen offset:1024 sc1
    v_mfma_f32_16x16x32_bf16 v[88:91], v[60:63], a[44:47], v[88:91]
    v_mfma_f32_16x16x32_bf16 v[92:95], v[52:55], a[108:111], v[92:95]
    v_mfma_f32_16x16x32_bf16 v[92:95], v[56:59], a[112:115], v[92:95]
    v_cvt_pk_bf16_f32 v156, v128, v129
    v_cvt_pk_bf16_f32 v157, v130, v131
    v_mfma_f32_16x16x32_bf16 v[92:95], v[60:63], a[116:119], v[92:95]
    buffer_load_dwordx4 v[44:47], v186, s[48:51], s23 offen offset:2048 sc1
    v_mfma_f32_16x16x32_bf16 v[96:99], v[52:55], a[180:183], v[96:99]
    v_cvt_pk_bf16_f32 v158, v132, v133
    v_cvt_pk_bf16_f32 v159, v134, v135
    v_mfma_f32_16x16x32_bf16 v[96:99], v[56:59], a[184:187], v[96:99]
    s_nop 0
    v_permlane16_swap_b32 v156, v158
    v_mfma_f32_16x16x32_bf16 v[96:99], v[60:63], a[188:191], v[96:99]
    v_permlane16_swap_b32 v157, v159
    v_mfma_f32_16x16x32_bf16 v[100:103], v[52:55], a[252:255], v[100:103]
    buffer_load_dwordx4 v[48:51], v186, s[48:51], s23 offen offset:3072 sc1
    v_mfma_f32_16x16x32_bf16 v[100:103], v[56:59], v[220:223], v[100:103]
    buffer_store_dwordx4 v[156:159], v179, s[72:75], s27 offen sc1
    v_mfma_f32_16x16x32_bf16 v[100:103], v[60:63], v[224:227], v[100:103]
    ds_write_b128 v217, v[156:159]
    s_waitcnt vmcnt(32)
    v_mfma_f32_16x16x32_bf16 v[88:91], v[64:67], a[48:51], v[88:91]
    v_add_u32 v217, v217, v219
    v_mfma_f32_16x16x32_bf16 v[88:91], v[68:71], a[52:55], v[88:91]
    buffer_load_dwordx4 v[52:55], v187, s[48:51], s23 offen offset:0 sc1
    v_mfma_f32_16x16x32_bf16 v[88:91], v[72:75], a[56:59], v[88:91]
    v_mfma_f32_16x16x32_bf16 v[92:95], v[64:67], a[120:123], v[92:95]
    v_mfma_f32_16x16x32_bf16 v[92:95], v[68:71], a[124:127], v[92:95]
    v_mfma_f32_16x16x32_bf16 v[92:95], v[72:75], a[128:131], v[92:95]
    buffer_load_dwordx4 v[56:59], v187, s[48:51], s23 offen offset:1024 sc1
    v_mfma_f32_16x16x32_bf16 v[96:99], v[64:67], a[192:195], v[96:99]
    v_mfma_f32_16x16x32_bf16 v[96:99], v[68:71], a[196:199], v[96:99]
    v_mfma_f32_16x16x32_bf16 v[96:99], v[72:75], a[200:203], v[96:99]
    v_mfma_f32_16x16x32_bf16 v[100:103], v[64:67], v[228:231], v[100:103]
    buffer_load_dwordx4 v[60:63], v187, s[48:51], s23 offen offset:2048 sc1
    v_mfma_f32_16x16x32_bf16 v[100:103], v[68:71], v[232:235], v[100:103]
    v_mfma_f32_16x16x32_bf16 v[100:103], v[72:75], v[236:239], v[100:103]
    s_waitcnt vmcnt(32)
    v_mfma_f32_16x16x32_bf16 v[88:91], v[76:79], a[60:63], v[88:91]
    v_mfma_f32_16x16x32_bf16 v[88:91], v[80:83], a[64:67], v[88:91]
    buffer_load_dwordx4 v[64:67], v187, s[48:51], s23 offen offset:3072 sc1
    v_mfma_f32_16x16x32_bf16 v[120:123], v[84:87], a[68:71], v[88:91]
    v_mfma_f32_16x16x32_bf16 v[92:95], v[76:79], a[132:135], v[92:95]
    v_mfma_f32_16x16x32_bf16 v[92:95], v[80:83], a[136:139], v[92:95]
    v_mfma_f32_16x16x32_bf16 v[124:127], v[84:87], a[140:143], v[92:95]
    buffer_load_dwordx4 v[68:71], v188, s[48:51], s23 offen offset:0 sc1
    v_mfma_f32_16x16x32_bf16 v[96:99], v[76:79], a[204:207], v[96:99]
    s_mov_b32 s74, 268435456
    v_mfma_f32_16x16x32_bf16 v[96:99], v[80:83], a[208:211], v[96:99]
    s_add_u32 s27, s27, 1024
    v_mfma_f32_16x16x32_bf16 v[128:131], v[84:87], a[212:215], v[96:99]
    s_add_u32 s25, s25, 1
    v_mfma_f32_16x16x32_bf16 v[100:103], v[76:79], v[240:243], v[100:103]
    buffer_load_dwordx4 v[72:75], v188, s[48:51], s23 offen offset:1024 sc1
    v_mfma_f32_16x16x32_bf16 v[100:103], v[80:83], v[244:247], v[100:103]
    s_add_u32 s23, s23, 18432
    v_mfma_f32_16x16x32_bf16 v[132:135], v[84:87], v[248:251], v[100:103]
    s_cmp_lt_u32 s25, 7
    s_cbranch_scc1 L_ffn_dn_35
    s_waitcnt vmcnt(33)
    v_mfma_f32_16x16x32_bf16 v[88:91], v[104:107], a[0:3], 0
    v_mfma_f32_16x16x32_bf16 v[88:91], v[108:111], a[4:7], v[88:91]
    buffer_load_dwordx4 v[76:79], v184, s[48:51], s23 offen offset:0 sc1
    v_mfma_f32_16x16x32_bf16 v[88:91], v[112:115], a[8:11], v[88:91]
    v_mfma_f32_16x16x32_bf16 v[92:95], v[104:107], a[72:75], 0
    v_mfma_f32_16x16x32_bf16 v[92:95], v[108:111], a[76:79], v[92:95]
    v_mfma_f32_16x16x32_bf16 v[92:95], v[112:115], a[80:83], v[92:95]
    buffer_load_dwordx4 v[80:83], v184, s[48:51], s23 offen offset:1024 sc1
    v_mfma_f32_16x16x32_bf16 v[96:99], v[104:107], a[144:147], 0
    v_cvt_pk_bf16_f32 v152, v120, v121
    v_cvt_pk_bf16_f32 v153, v122, v123
    v_mfma_f32_16x16x32_bf16 v[96:99], v[108:111], a[148:151], v[96:99]
    v_cvt_pk_bf16_f32 v154, v124, v125
    v_cvt_pk_bf16_f32 v155, v126, v127
    v_mfma_f32_16x16x32_bf16 v[96:99], v[112:115], a[152:155], v[96:99]
    s_nop 0
    v_permlane16_swap_b32 v152, v154
    v_mfma_f32_16x16x32_bf16 v[100:103], v[104:107], a[216:219], 0
    buffer_load_dwordx4 v[84:87], v184, s[48:51], s23 offen offset:2048 sc1
    v_mfma_f32_16x16x32_bf16 v[100:103], v[108:111], a[220:223], v[100:103]
    v_permlane16_swap_b32 v153, v155
    v_mfma_f32_16x16x32_bf16 v[100:103], v[112:115], a[224:227], v[100:103]
    buffer_store_dwordx4 v[152:155], v178, s[72:75], s27 offen sc1
    s_waitcnt vmcnt(34)
    v_mfma_f32_16x16x32_bf16 v[88:91], v[116:119], a[12:15], v[88:91]
    ds_write_b128 v216, v[152:155]
    v_mfma_f32_16x16x32_bf16 v[88:91], v[180:183], a[16:19], v[88:91]
    v_add_u32 v216, v216, v218
    v_cvt_pk_bf16_f32 v156, v128, v129
    v_mfma_f32_16x16x32_bf16 v[88:91], v[196:199], a[20:23], v[88:91]
    v_cvt_pk_bf16_f32 v157, v130, v131
    v_cvt_pk_bf16_f32 v158, v132, v133
    s_load_dwordx8 s[56:63], s[38:39], 0 glc
    v_mfma_f32_16x16x32_bf16 v[92:95], v[116:119], a[84:87], v[92:95]
    v_cvt_pk_bf16_f32 v159, v134, v135
    s_mov_b32 s6, 0
    v_mfma_f32_16x16x32_bf16 v[92:95], v[180:183], a[88:91], v[92:95]
    s_nop 0
    v_permlane16_swap_b32 v156, v158
    v_mfma_f32_16x16x32_bf16 v[92:95], v[196:199], a[92:95], v[92:95]
    v_permlane16_swap_b32 v157, v159
    v_mfma_f32_16x16x32_bf16 v[96:99], v[116:119], a[156:159], v[96:99]
    buffer_store_dwordx4 v[156:159], v179, s[72:75], s27 offen sc1
    v_mfma_f32_16x16x32_bf16 v[96:99], v[180:183], a[160:163], v[96:99]
    ds_write_b128 v217, v[156:159]
    v_mfma_f32_16x16x32_bf16 v[96:99], v[196:199], a[164:167], v[96:99]
    v_add_u32 v217, v217, v219
    v_mfma_f32_16x16x32_bf16 v[100:103], v[116:119], a[228:231], v[100:103]
    v_mfma_f32_16x16x32_bf16 v[100:103], v[180:183], a[232:235], v[100:103]
    v_mfma_f32_16x16x32_bf16 v[100:103], v[196:199], a[236:239], v[100:103]
    s_waitcnt vmcnt(32)
L_epoll_38:
    s_waitcnt lgkmcnt(0)
    s_xor_b64 s[56:57], s[56:57], s[76:77]
    s_xor_b64 s[58:59], s[58:59], s[76:77]
    s_xor_b64 s[60:61], s[60:61], s[76:77]
    s_xor_b64 s[62:63], s[62:63], s[76:77]
    s_or_b64 s[56:57], s[56:57], s[58:59]
    s_or_b64 s[60:61], s[60:61], s[62:63]
    s_or_b64 s[56:57], s[56:57], s[60:61]
    s_cbranch_scc0 L_epolled_39
    s_load_dwordx8 s[56:63], s[38:39], 0 glc
    s_add_u32 s6, s6, 1
    s_cmp_lt_u32 s6, 1048576
    s_cbranch_scc1 L_epoll_38
    s_branch L_main_end
L_epolled_39:
    v_mfma_f32_16x16x32_bf16 v[88:91], v[200:203], a[24:27], v[88:91]
    v_mfma_f32_16x16x32_bf16 v[88:91], v[204:207], a[28:31], v[88:91]
    s_add_u32 s7, s40, 1
    s_and_b32 s7, s7, 7
    s_mul_i32 s7, s7, 9216
    s_add_u32 s19, s7, s20
    buffer_load_dwordx4 v[104:107], v172, s[8:11], s19 offen sc1
    v_mfma_f32_16x16x32_bf16 v[88:91], v[208:211], a[32:35], v[88:91]
    v_mfma_f32_16x16x32_bf16 v[92:95], v[200:203], a[96:99], v[92:95]
    v_mfma_f32_16x16x32_bf16 v[92:95], v[204:207], a[100:103], v[92:95]
    v_mfma_f32_16x16x32_bf16 v[92:95], v[208:211], a[104:107], v[92:95]
    buffer_load_dwordx4 v[108:111], v173, s[8:11], s19 offen sc1
    v_mfma_f32_16x16x32_bf16 v[96:99], v[200:203], a[168:171], v[96:99]
    v_mfma_f32_16x16x32_bf16 v[96:99], v[204:207], a[172:175], v[96:99]
    v_mfma_f32_16x16x32_bf16 v[96:99], v[208:211], a[176:179], v[96:99]
    v_mfma_f32_16x16x32_bf16 v[100:103], v[200:203], a[240:243], v[100:103]
    s_add_u32 s7, s40, 2
    s_and_b32 s7, s7, 7
    s_mul_i32 s7, s7, 9216
    s_add_u32 s19, s7, s20
    buffer_load_dwordx4 v[112:115], v172, s[8:11], s19 offen sc1
    v_mfma_f32_16x16x32_bf16 v[100:103], v[204:207], a[244:247], v[100:103]
    v_mfma_f32_16x16x32_bf16 v[100:103], v[208:211], a[248:251], v[100:103]
    s_waitcnt vmcnt(31)
    v_mfma_f32_16x16x32_bf16 v[88:91], v[212:215], a[36:39], v[88:91]
    v_mfma_f32_16x16x32_bf16 v[88:91], v[136:139], a[40:43], v[88:91]
    buffer_load_dwordx4 v[116:119], v173, s[8:11], s19 offen sc1
    v_mfma_f32_16x16x32_bf16 v[88:91], v[140:143], a[44:47], v[88:91]
    v_mfma_f32_16x16x32_bf16 v[92:95], v[212:215], a[108:111], v[92:95]
    v_mfma_f32_16x16x32_bf16 v[92:95], v[136:139], a[112:115], v[92:95]
    v_mfma_f32_16x16x32_bf16 v[92:95], v[140:143], a[116:119], v[92:95]
    s_add_u32 s7, s40, 3
    s_and_b32 s7, s7, 7
    s_mul_i32 s7, s7, 9216
    s_add_u32 s19, s7, s20
    buffer_load_dwordx4 v[180:183], v172, s[8:11], s19 offen sc1
    v_mfma_f32_16x16x32_bf16 v[96:99], v[212:215], a[180:183], v[96:99]
    v_mfma_f32_16x16x32_bf16 v[96:99], v[136:139], a[184:187], v[96:99]
    v_mfma_f32_16x16x32_bf16 v[96:99], v[140:143], a[188:191], v[96:99]
    v_mfma_f32_16x16x32_bf16 v[100:103], v[212:215], a[252:255], v[100:103]
    buffer_load_dwordx4 v[196:199], v173, s[8:11], s19 offen sc1
    v_mfma_f32_16x16x32_bf16 v[100:103], v[136:139], v[220:223], v[100:103]
    v_mfma_f32_16x16x32_bf16 v[100:103], v[140:143], v[224:227], v[100:103]
    s_waitcnt vmcnt(31)
    v_mfma_f32_16x16x32_bf16 v[88:91], v[144:147], a[48:51], v[88:91]
    v_mfma_f32_16x16x32_bf16 v[88:91], v[160:163], a[52:55], v[88:91]
    s_add_u32 s7, s40, 4
    s_and_b32 s7, s7, 7
    s_mul_i32 s7, s7, 9216
    s_add_u32 s19, s7, s20
    buffer_load_dwordx4 v[200:203], v172, s[8:11], s19 offen sc1
    v_mfma_f32_16x16x32_bf16 v[88:91], v[164:167], a[56:59], v[88:91]
    v_mfma_f32_16x16x32_bf16 v[92:95], v[144:147], a[120:123], v[92:95]
    v_mfma_f32_16x16x32_bf16 v[92:95], v[160:163], a[124:127], v[92:95]
    v_mfma_f32_16x16x32_bf16 v[92:95], v[164:167], a[128:131], v[92:95]
    buffer_load_dwordx4 v[204:207], v173, s[8:11], s19 offen sc1
    v_mfma_f32_16x16x32_bf16 v[96:99], v[144:147], a[192:195], v[96:99]
    v_mfma_f32_16x16x32_bf16 v[96:99], v[160:163], a[196:199], v[96:99]
    v_mfma_f32_16x16x32_bf16 v[96:99], v[164:167], a[200:203], v[96:99]
    v_mfma_f32_16x16x32_bf16 v[100:103], v[144:147], v[228:231], v[100:103]
    s_add_u32 s7, s40, 5
    s_and_b32 s7, s7, 7
    s_mul_i32 s7, s7, 9216
    s_add_u32 s19, s7, s20
    buffer_load_dwordx4 v[208:211], v172, s[8:11], s19 offen sc1
    v_mfma_f32_16x16x32_bf16 v[100:103], v[160:163], v[232:235], v[100:103]
    v_mfma_f32_16x16x32_bf16 v[100:103], v[164:167], v[236:239], v[100:103]
    s_waitcnt vmcnt(31)
    v_mfma_f32_16x16x32_bf16 v[88:91], v[168:171], a[60:63], v[88:91]
    v_mfma_f32_16x16x32_bf16 v[88:91], v[148:151], a[64:67], v[88:91]
    buffer_load_dwordx4 v[212:215], v173, s[8:11], s19 offen sc1
    v_mfma_f32_16x16x32_bf16 v[120:123], v[4:7], a[68:71], v[88:91]
    v_mfma_f32_16x16x32_bf16 v[92:95], v[168:171], a[132:135], v[92:95]
    v_mfma_f32_16x16x32_bf16 v[92:95], v[148:151], a[136:139], v[92:95]
    v_mfma_f32_16x16x32_bf16 v[124:127], v[4:7], a[140:143], v[92:95]
    s_add_u32 s7, s40, 6
    s_and_b32 s7, s7, 7
    s_mul_i32 s7, s7, 9216
    s_add_u32 s19, s7, s20
    buffer_load_dwordx4 v[136:139], v172, s[8:11], s19 offen sc1
    v_mfma_f32_16x16x32_bf16 v[96:99], v[168:171], a[204:207], v[96:99]
    s_mov_b32 s74, 268435456
    v_mfma_f32_16x16x32_bf16 v[96:99], v[148:151], a[208:211], v[96:99]
    s_add_u32 s27, s27, 1024
    v_mfma_f32_16x16x32_bf16 v[128:131], v[4:7], a[212:215], v[96:99]
    s_add_u32 s25, s25, 1
    v_mfma_f32_16x16x32_bf16 v[100:103], v[168:171], v[240:243], v[100:103]
    buffer_load_dwordx4 v[140:143], v173, s[8:11], s19 offen sc1
    v_mfma_f32_16x16x32_bf16 v[100:103], v[148:151], v[244:247], v[100:103]
    s_add_u32 s23, s23, 18432
    v_mfma_f32_16x16x32_bf16 v[132:135], v[4:7], v[248:251], v[100:103]
    s_waitcnt vmcnt(30)
    v_mfma_f32_16x16x32_bf16 v[88:91], v[16:19], a[0:3], 0
    v_mfma_f32_16x16x32_bf16 v[88:91], v[20:23], a[4:7], v[88:91]
    s_add_u32 s7, s40, 7
    s_and_b32 s7, s7, 7
    s_mul_i32 s7, s7, 9216
    s_add_u32 s19, s7, s20
    buffer_load_dwordx4 v[144:147], v172, s[8:11], s19 offen sc1
    v_mfma_f32_16x16x32_bf16 v[88:91], v[24:27], a[8:11], v[88:91]
    v_mfma_f32_16x16x32_bf16 v[92:95], v[16:19], a[72:75], 0
    v_mfma_f32_16x16x32_bf16 v[92:95], v[20:23], a[76:79], v[92:95]
    v_mfma_f32_16x16x32_bf16 v[92:95], v[24:27], a[80:83], v[92:95]
    buffer_load_dwordx4 v[160:163], v173, s[8:11], s19 offen sc1
    v_mfma_f32_16x16x32_bf16 v[96:99], v[16:19], a[144:147], 0
    v_cvt_pk_bf16_f32 v152, v120, v121
    v_cvt_pk_bf16_f32 v153, v122, v123
    v_mfma_f32_16x16x32_bf16 v[96:99], v[20:23], a[148:151], v[96:99]
    v_cvt_pk_bf16_f32 v154, v124, v125
    v_cvt_pk_bf16_f32 v155, v126, v127
    v_mfma_f32_16x16x32_bf16 v[96:99], v[24:27], a[152:155], v[96:99]
    s_nop 0
    v_permlane16_swap_b32 v152, v154
    v_mfma_f32_16x16x32_bf16 v[100:103], v[16:19], a[216:219], 0
    v_permlane16_swap_b32 v153, v155
    v_mfma_f32_16x16x32_bf16 v[100:103], v[20:23], a[220:223], v[100:103]
    buffer_store_dwordx4 v[152:155], v178, s[72:75], s27 offen sc1
    v_mfma_f32_16x16x32_bf16 v[100:103], v[24:27], a[224:227], v[100:103]
    ds_write_b128 v216, v[152:155]
    s_waitcnt vmcnt(30)
    v_mfma_f32_16x16x32_bf16 v[88:91], v[28:31], a[12:15], v[88:91]
    v_add_u32 v216, v216, v218
    v_cvt_pk_bf16_f32 v156, v128, v129
    v_mfma_f32_16x16x32_bf16 v[88:91], v[32:35], a[16:19], v[88:91]
    v_cvt_pk_bf16_f32 v157, v130, v131
    v_cvt_pk_bf16_f32 v158, v132, v133
    v_mfma_f32_16x16x32_bf16 v[88:91], v[36:39], a[20:23], v[88:91]
    v_cvt_pk_bf16_f32 v159, v134, v135
    v_mfma_f32_16x16x32_bf16 v[92:95], v[28:31], a[84:87], v[92:95]
    s_nop 0
    v_permlane16_swap_b32 v156, v158
    v_mfma_f32_16x16x32_bf16 v[92:95], v[32:35], a[88:91], v[92:95]
    v_permlane16_swap_b32 v157, v159
    v_mfma_f32_16x16x32_bf16 v[92:95], v[36:39], a[92:95], v[92:95]
    buffer_store_dwordx4 v[156:159], v179, s[72:75], s27 offen sc1
    v_mfma_f32_16x16x32_bf16 v[96:99], v[28:31], a[156:159], v[96:99]
    ds_write_b128 v217, v[156:159]
    v_mfma_f32_16x16x32_bf16 v[96:99], v[32:35], a[160:163], v[96:99]
    v_add_u32 v217, v217, v219
    v_mfma_f32_16x16x32_bf16 v[96:99], v[36:39], a[164:167], v[96:99]
    v_mfma_f32_16x16x32_bf16 v[100:103], v[28:31], a[228:231], v[100:103]
    v_mfma_f32_16x16x32_bf16 v[100:103], v[32:35], a[232:235], v[100:103]
    v_mfma_f32_16x16x32_bf16 v[100:103], v[36:39], a[236:239], v[100:103]
    s_waitcnt vmcnt(28)
    v_mfma_f32_16x16x32_bf16 v[88:91], v[40:43], a[24:27], v[88:91]
    v_mfma_f32_16x16x32_bf16 v[88:91], v[44:47], a[28:31], v[88:91]
    v_mfma_f32_16x16x32_bf16 v[88:91], v[48:51], a[32:35], v[88:91]
    v_mfma_f32_16x16x32_bf16 v[92:95], v[40:43], a[96:99], v[92:95]
    v_mfma_f32_16x16x32_bf16 v[92:95], v[44:47], a[100:103], v[92:95]
    v_mfma_f32_16x16x32_bf16 v[92:95], v[48:51], a[104:107], v[92:95]
    v_mfma_f32_16x16x32_bf16 v[96:99], v[40:43], a[168:171], v[96:99]
    v_mfma_f32_16x16x32_bf16 v[96:99], v[44:47], a[172:175], v[96:99]
    v_mfma_f32_16x16x32_bf16 v[96:99], v[48:51], a[176:179], v[96:99]
    v_mfma_f32_16x16x32_bf16 v[100:103], v[40:43], a[240:243], v[100:103]
    v_mfma_f32_16x16x32_bf16 v[100:103], v[44:47], a[244:247], v[100:103]
    v_mfma_f32_16x16x32_bf16 v[100:103], v[48:51], a[248:251], v[100:103]
    s_waitcnt vmcnt(24)
    v_mfma_f32_16x16x32_bf16 v[88:91], v[52:55], a[36:39], v[88:91]
    v_mfma_f32_16x16x32_bf16 v[88:91], v[56:59], a[40:43], v[88:91]
    v_mfma_f32_16x16x32_bf16 v[88:91], v[60:63], a[44:47], v[88:91]
    v_mfma_f32_16x16x32_bf16 v[92:95], v[52:55], a[108:111], v[92:95]
    v_mfma_f32_16x16x32_bf16 v[92:95], v[56:59], a[112:115], v[92:95]
    v_mfma_f32_16x16x32_bf16 v[92:95], v[60:63], a[116:119], v[92:95]
    v_mfma_f32_16x16x32_bf16 v[96:99], v[52:55], a[180:183], v[96:99]
    v_mfma_f32_16x16x32_bf16 v[96:99], v[56:59], a[184:187], v[96:99]
    v_mfma_f32_16x16x32_bf16 v[96:99], v[60:63], a[188:191], v[96:99]
    v_mfma_f32_16x16x32_bf16 v[100:103], v[52:55], a[252:255], v[100:103]
    v_mfma_f32_16x16x32_bf16 v[100:103], v[56:59], v[220:223], v[100:103]
    v_mfma_f32_16x16x32_bf16 v[100:103], v[60:63], v[224:227], v[100:103]
    s_waitcnt vmcnt(21)
    v_mfma_f32_16x16x32_bf16 v[88:91], v[64:67], a[48:51], v[88:91]
    v_mfma_f32_16x16x32_bf16 v[88:91], v[68:71], a[52:55], v[88:91]
    v_mfma_f32_16x16x32_bf16 v[88:91], v[72:75], a[56:59], v[88:91]
    v_mfma_f32_16x16x32_bf16 v[92:95], v[64:67], a[120:123], v[92:95]
    v_mfma_f32_16x16x32_bf16 v[92:95], v[68:71], a[124:127], v[92:95]
    v_mfma_f32_16x16x32_bf16 v[92:95], v[72:75], a[128:131], v[92:95]
    v_mfma_f32_16x16x32_bf16 v[96:99], v[64:67], a[192:195], v[96:99]
    v_mfma_f32_16x16x32_bf16 v[96:99], v[68:71], a[196:199], v[96:99]
    v_mfma_f32_16x16x32_bf16 v[96:99], v[72:75], a[200:203], v[96:99]
    v_mfma_f32_16x16x32_bf16 v[100:103], v[64:67], v[228:231], v[100:103]
    v_mfma_f32_16x16x32_bf16 v[100:103], v[68:71], v[232:235], v[100:103]
    v_mfma_f32_16x16x32_bf16 v[100:103], v[72:75], v[236:239], v[100:103]
    s_waitcnt vmcnt(18)
    v_mfma_f32_16x16x32_bf16 v[88:91], v[76:79], a[60:63], v[88:91]
    v_mfma_f32_16x16x32_bf16 v[88:91], v[80:83], a[64:67], v[88:91]
    v_mfma_f32_16x16x32_bf16 v[120:123], v[84:87], a[68:71], v[88:91]
    v_mfma_f32_16x16x32_bf16 v[92:95], v[76:79], a[132:135], v[92:95]
    v_mfma_f32_16x16x32_bf16 v[92:95], v[80:83], a[136:139], v[92:95]
    v_mfma_f32_16x16x32_bf16 v[124:127], v[84:87], a[140:143], v[92:95]
    v_mfma_f32_16x16x32_bf16 v[96:99], v[76:79], a[204:207], v[96:99]
    s_mov_b32 s74, 268435456
    v_mfma_f32_16x16x32_bf16 v[96:99], v[80:83], a[208:211], v[96:99]
    s_add_u32 s27, s27, 1024
    v_mfma_f32_16x16x32_bf16 v[128:131], v[84:87], a[212:215], v[96:99]
    s_add_u32 s25, s25, 1
    v_mfma_f32_16x16x32_bf16 v[100:103], v[76:79], v[240:243], v[100:103]
    v_mfma_f32_16x16x32_bf16 v[100:103], v[80:83], v[244:247], v[100:103]
    s_add_u32 s23, s23, 18432
    v_mfma_f32_16x16x32_bf16 v[132:135], v[84:87], v[248:251], v[100:103]
    s_nop 7
    v_cvt_pk_bf16_f32 v152, v120, v121
    v_cvt_pk_bf16_f32 v153, v122, v123
    v_cvt_pk_bf16_f32 v154, v124, v125
    v_cvt_pk_bf16_f32 v155, v126, v127
    v_cvt_pk_bf16_f32 v156, v128, v129
    v_cvt_pk_bf16_f32 v157, v130, v131
    v_cvt_pk_bf16_f32 v158, v132, v133
    v_cvt_pk_bf16_f32 v159, v134, v135
    s_nop 0
    v_permlane16_swap_b32 v152, v154
    v_permlane16_swap_b32 v153, v155
    buffer_store_dwordx4 v[152:155], v178, s[72:75], s27 offen sc1
    s_nop 0
    v_permlane16_swap_b32 v156, v158
    v_permlane16_swap_b32 v157, v159
    buffer_store_dwordx4 v[156:159], v179, s[72:75], s27 offen sc1
    ds_write_b128 v216, v[152:155]
    ds_write_b128 v217, v[156:159]
    s_waitcnt lgkmcnt(0)
    v_lshlrev_b32 v15, 7, v0
    s_lshl_b32 s6, s40, 2
    s_add_u32 s6, s6, s44
    s_add_u32 s6, s6, 65536
    v_mov_b32 v1, s76
    s_mov_b64 vcc, 0xff
    s_waitcnt vmcnt(0)
    s_barrier
    s_cmp_lg_u32 s3, 0
    s_cbranch_scc1 L_pub_40
    s_mov_b64 exec, vcc
    buffer_store_dword v1, v15, s[8:11], s6 offen sc1
L_pub_40:
    s_mov_b64 exec, -1
    s_add_u32 s19, s18, s43
    s_add_u32 s22, s19, 45875200
    s_lshl_b32 s23, s21, 5
    s_add_u32 s23, s23, s43
    s_add_u32 s23, s23, 48431104
    v_and_b32 v12, 7, v0
    v_lshlrev_b32 v12, 2, v12
    buffer_load_dword v10, v12, s[8:11], s23 offen sc1
    buffer_load_dwordx4 v[92:95], v172, s[8:11], s22 offen sc1
    buffer_load_dwordx4 v[96:99], v173, s[8:11], s22 offen sc1
    buffer_load_dwordx4 v[100:103], v174, s[8:11], s22 offen sc1
    v_min_u32 v13, 9216, v173
    ds_read_b128 v[148:151], v172 offset:4096
    ds_read_b128 v[152:155], v13 offset:4096
    ds_read_b128 v[156:159], v174 offset:4096
    s_lshl_b32 s28, s40, 2
    s_add_u32 s28, s28, s3
    s_mul_i32 s28, s28, 73728
    v_and_b32 v229, 8, v0
    v_lshl_add_u32 v229, v229, 27, v253
    s_mul_i32 s7, s42, 1073741824
    v_add_u32 v3, s7, v253
    v_or_b32 v229, s7, v229
    v_lshlrev_b32 v16, 16, v104
    v_and_b32 v17, s16, v104
    v_lshlrev_b32 v18, 16, v105
    v_and_b32 v19, s16, v105
    v_lshlrev_b32 v20, 16, v106
    v_and_b32 v21, s16, v106
    v_lshlrev_b32 v22, 16, v107
    v_and_b32 v23, s16, v107
    v_lshlrev_b32 v24, 16, v108
    v_and_b32 v25, s16, v108
    v_lshlrev_b32 v26, 16, v109
    v_and_b32 v27, s16, v109
    v_lshlrev_b32 v28, 16, v110
    v_and_b32 v29, s16, v110
    v_lshlrev_b32 v30, 16, v111
    v_and_b32 v31, s16, v111
    s_cmp_lg_u32 s42, 0
    s_cbranch_scc1 L_nopf_41
    buffer_load_dwordx4 a[0:3], v3, s[8:11], s28 offen offset:0 sc1
    buffer_load_dwordx4 a[4:7], v3, s[8:11], s28 offen offset:1024 sc1
    buffer_load_dwordx4 a[8:11], v3, s[8:11], s28 offen offset:2048 sc1
    buffer_load_dwordx4 a[12:15], v229, s[8:11], s28 offen offset:3072 sc1
    s_add_u32 s28, s28, 4096
    buffer_load_dwordx4 a[16:19], v3, s[8:11], s28 offen offset:0 sc1
    buffer_load_dwordx4 a[20:23], v3, s[8:11], s28 offen offset:1024 sc1
    buffer_load_dwordx4 a[24:27], v3, s[8:11], s28 offen offset:2048 sc1
    buffer_load_dwordx4 a[28:31], v229, s[8:11], s28 offen offset:3072 sc1
L_nopf_41:
    v_lshlrev_b32 v40, 16, v112
    v_and_b32 v41, s16, v112
    v_lshlrev_b32 v42, 16, v113
    v_and_b32 v43, s16, v113
    v_lshlrev_b32 v44, 16, v114
    v_and_b32 v45, s16, v114
    v_lshlrev_b32 v46, 16, v115
    v_and_b32 v47, s16, v115
    v_pk_add_f32 v[16:17], v[16:17], v[40:41]
    v_pk_add_f32 v[18:19], v[18:19], v[42:43]
    v_pk_add_f32 v[20:21], v[20:21], v[44:45]
    v_pk_add_f32 v[22:23], v[22:23], v[46:47]
    v_lshlrev_b32 v40, 16, v116
    v_and_b32 v41, s16, v116
    v_lshlrev_b32 v42, 16, v117
    v_and_b32 v43, s16, v117
    v_lshlrev_b32 v44, 16, v118
    v_and_b32 v45, s16, v118
    v_lshlrev_b32 v46, 16, v119
    v_and_b32 v47, s16, v119
    v_pk_add_f32 v[24:25], v[24:25], v[40:41]
    v_pk_add_f32 v[26:27], v[26:27], v[42:43]
    v_pk_add_f32 v[28:29], v[28:29], v[44:45]
    v_pk_add_f32 v[30:31], v[30:31], v[46:47]
    s_cmp_lg_u32 s42, 0
    s_cbranch_scc1 L_nopf_42
    s_add_u32 s28, s28, 4096
    buffer_load_dwordx4 a[32:35], v3, s[8:11], s28 offen offset:0 sc1
    buffer_load_dwordx4 a[36:39], v3, s[8:11], s28 offen offset:1024 sc1
    buffer_load_dwordx4 a[40:43], v3, s[8:11], s28 offen offset:2048 sc1
    buffer_load_dwordx4 a[44:47], v229, s[8:11], s28 offen offset:3072 sc1
    s_add_u32 s28, s28, 4096
    buffer_load_dwordx4 a[48:51], v3, s[8:11], s28 offen offset:0 sc1
    buffer_load_dwordx4 a[52:55], v3, s[8:11], s28 offen offset:1024 sc1
    buffer_load_dwordx4 a[56:59], v3, s[8:11], s28 offen offset:2048 sc1
    buffer_load_dwordx4 a[60:63], v229, s[8:11], s28 offen offset:3072 sc1
L_nopf_42:
    v_lshlrev_b32 v40, 16, v180
    v_and_b32 v41, s16, v180
    v_lshlrev_b32 v42, 16, v181
    v_and_b32 v43, s16, v181
    v_lshlrev_b32 v44, 16, v182
    v_and_b32 v45, s16, v182
    v_lshlrev_b32 v46, 16, v183
    v_and_b32 v47, s16, v183
    v_pk_add_f32 v[16:17], v[16:17], v[40:41]
    v_pk_add_f32 v[18:19], v[18:19], v[42:43]
    v_pk_add_f32 v[20:21], v[20:21], v[44:45]
    v_pk_add_f32 v[22:23], v[22:23], v[46:47]
    v_lshlrev_b32 v40, 16, v196
    v_and_b32 v41, s16, v196
    v_lshlrev_b32 v42, 16, v197
    v_and_b32 v43, s16, v197
    v_lshlrev_b32 v44, 16, v198
    v_and_b32 v45, s16, v198
    v_lshlrev_b32 v46, 16, v199
    v_and_b32 v47, s16, v199
    v_pk_add_f32 v[24:25], v[24:25], v[40:41]
    v_pk_add_f32 v[26:27], v[26:27], v[42:43]
    v_pk_add_f32 v[28:29], v[28:29], v[44:45]
    v_pk_add_f32 v[30:31], v[30:31], v[46:47]
    v_lshlrev_b32 v40, 16, v200
    v_and_b32 v41, s16, v200
    v_lshlrev_b32 v42, 16, v201
    v_and_b32 v43, s16, v201
    v_lshlrev_b32 v44, 16, v202
    v_and_b32 v45, s16, v202
    v_lshlrev_b32 v46, 16, v203
    v_and_b32 v47, s16, v203
    v_pk_add_f32 v[16:17], v[16:17], v[40:41]
    v_pk_add_f32 v[18:19], v[18:19], v[42:43]
    v_pk_add_f32 v[20:21], v[20:21], v[44:45]
    v_pk_add_f32 v[22:23], v[22:23], v[46:47]
    v_lshlrev_b32 v40, 16, v204
    v_and_b32 v41, s16, v204
    v_lshlrev_b32 v42, 16, v205
    v_and_b32 v43, s16, v205
    v_lshlrev_b32 v44, 16, v206
    v_and_b32 v45, s16, v206
    v_lshlrev_b32 v46, 16, v207
    v_and_b32 v47, s16, v207
    v_pk_add_f32 v[24:25], v[24:25], v[40:41]
    v_pk_add_f32 v[26:27], v[26:27], v[42:43]
    v_pk_add_f32 v[28:29], v[28:29], v[44:45]
    v_pk_add_f32 v[30:31], v[30:31], v[46:47]
    s_cmp_lg_u32 s3, 3
    s_cbranch_scc1 L_pollout_45
    s_lshl_b32 s7, s40, 7
    s_add_u32 s7, s7, s44
    s_add_u32 s7, s7, 65536
    s_add_u32 s52, s4, s7
    s_addc_u32 s53, s5, 0
    s_mov_b32 s6, 0
L_poll_43:
    s_load_dwordx8 s[56:63], s[52:53], 0 glc
    s_add_u32 s6, s6, 1
    s_waitcnt lgkmcnt(0)
    s_xor_b64 s[56:57], s[56:57], s[76:77]
    s_xor_b64 s[58:59], s[58:59], s[76:77]
    s_xor_b64 s[60:61], s[60:61], s[76:77]
    s_xor_b64 s[62:63], s[62:63], s[76:77]
    s_or_b64 s[56:57], s[56:57], s[58:59]
    s_or_b64 s[60:61], s[60:61], s[62:63]
    s_or_b64 s[56:57], s[56:57], s[60:61]
    s_cbranch_scc0 L_polled_44
    s_cmp_lt_u32 s6, 1048576
    s_cbranch_scc1 L_poll_43
    s_branch L_main_end
L_polled_44:
L_pollout_45:
    s_barrier
    s_add_u32 s7, s40, 1
    s_and_b32 s7, s7, 7
    s_mul_i32 s7, s7, 9216
    s_add_u32 s19, s7, s20
    buffer_load_dwordx4 v[60:63], v174, s[8:11], s19 offen sc1
    s_add_u32 s7, s40, 2
    s_and_b32 s7, s7, 7
    s_mul_i32 s7, s7, 9216
    s_add_u32 s19, s7, s20
    buffer_load_dwordx4 v[64:67], v174, s[8:11], s19 offen sc1
    s_add_u32 s7, s40, 3
    s_and_b32 s7, s7, 7
    s_mul_i32 s7, s7, 9216
    s_add_u32 s19, s7, s20
    buffer_load_dwordx4 v[68:71], v174, s[8:11], s19 offen sc1
    s_add_u32 s7, s40, 4
    s_and_b32 s7, s7, 7
    s_mul_i32 s7, s7, 9216
    s_add_u32 s19, s7, s20
    buffer_load_dwordx4 v[72:75], v174, s[8:11], s19 offen sc1
    s_add_u32 s7, s40, 5
    s_and_b32 s7, s7, 7
    s_mul_i32 s7, s7, 9216
    s_add_u32 s19, s7, s20
    buffer_load_dwordx4 v[76:79], v174, s[8:11], s19 offen sc1
    s_add_u32 s7, s40, 6
    s_and_b32 s7, s7, 7
    s_mul_i32 s7, s7, 9216
    s_add_u32 s19, s7, s20
    buffer_load_dwordx4 v[80:83], v174, s[8:11], s19 offen sc1
    s_add_u32 s7, s40, 7
    s_and_b32 s7, s7, 7
    s_mul_i32 s7, s7, 9216
    s_add_u32 s19, s7, s20
    buffer_load_dwordx4 v[84:87], v174, s[8:11], s19 offen sc1
    v_lshlrev_b32 v40, 16, v208
    v_and_b32 v41, s16, v208
    v_lshlrev_b32 v42, 16, v209
    v_and_b32 v43, s16, v209
    v_lshlrev_b32 v44, 16, v210
    v_and_b32 v45, s16, v210
    v_lshlrev_b32 v46, 16, v211
    v_and_b32 v47, s16, v211
    v_pk_add_f32 v[16:17], v[16:17], v[40:41]
    v_pk_add_f32 v[18:19], v[18:19], v[42:43]
    v_pk_add_f32 v[20:21], v[20:21], v[44:45]
    v_pk_add_f32 v[22:23], v[22:23], v[46:47]
    v_lshlrev_b32 v40, 16, v212
    v_and_b32 v41, s16, v212
    v_lshlrev_b32 v42, 16, v213
    v_and_b32 v43, s16, v213
    v_lshlrev_b32 v44, 16, v214
    v_and_b32 v45, s16, v214
    v_lshlrev_b32 v46, 16, v215
    v_and_b32 v47, s16, v215
    v_pk_add_f32 v[24:25], v[24:25], v[40:41]
    v_pk_add_f32 v[26:27], v[26:27], v[42:43]
    v_pk_add_f32 v[28:29], v[28:29], v[44:45]
    v_pk_add_f32 v[30:31], v[30:31], v[46:47]
    v_lshlrev_b32 v40, 16, v136
    v_and_b32 v41, s16, v136
    v_lshlrev_b32 v42, 16, v137
    v_and_b32 v43, s16, v137
    v_lshlrev_b32 v44, 16, v138
    v_and_b32 v45, s16, v138
    v_lshlrev_b32 v46, 16, v139
    v_and_b32 v47, s16, v139
    v_pk_add_f32 v[16:17], v[16:17], v[40:41]
    v_pk_add_f32 v[18:19], v[18:19], v[42:43]
    v_pk_add_f32 v[20:21], v[20:21], v[44:45]
    v_pk_add_f32 v[22:23], v[22:23], v[46:47]
    v_lshlrev_b32 v40, 16, v140
    v_and_b32 v41, s16, v140
    v_lshlrev_b32 v42, 16, v141
    v_and_b32 v43, s16, v141
    v_lshlrev_b32 v44, 16, v142
    v_and_b32 v45, s16, v142
    v_lshlrev_b32 v46, 16, v143
    v_and_b32 v47, s16, v143
    v_pk_add_f32 v[24:25], v[24:25], v[40:41]
    v_pk_add_f32 v[26:27], v[26:27], v[42:43]
    v_pk_add_f32 v[28:29], v[28:29], v[44:45]
    v_pk_add_f32 v[30:31], v[30:31], v[46:47]
    v_lshlrev_b32 v40, 16, v144
    v_and_b32 v41, s16, v144
    v_lshlrev_b32 v42, 16, v145
    v_and_b32 v43, s16, v145
    v_lshlrev_b32 v44, 16, v146
    v_and_b32 v45, s16, v146
    v_lshlrev_b32 v46, 16, v147
    v_and_b32 v47, s16, v147
    v_pk_add_f32 v[16:17], v[16:17], v[40:41]
    v_pk_add_f32 v[18:19], v[18:19], v[42:43]
    v_pk_add_f32 v[20:21], v[20:21], v[44:45]
    v_pk_add_f32 v[22:23], v[22:23], v[46:47]
    v_lshlrev_b32 v40, 16, v160
    v_and_b32 v41, s16, v160
    v_lshlrev_b32 v42, 16, v161
    v_and_b32 v43, s16, v161
    v_lshlrev_b32 v44, 16, v162
    v_and_b32 v45, s16, v162
    v_lshlrev_b32 v46, 16, v163
    v_and_b32 v47, s16, v163
    v_pk_add_f32 v[24:25], v[24:25], v[40:41]
    v_pk_add_f32 v[26:27], v[26:27], v[42:43]
    v_pk_add_f32 v[28:29], v[28:29], v[44:45]
    v_pk_add_f32 v[30:31], v[30:31], v[46:47]
    s_cmp_eq_u32 s3, 0
    s_cselect_b32 s7, 1.0, 0
    s_cselect_b32 s6, -1, 0
    s_waitcnt vmcnt(7) lgkmcnt(0)
    v_and_b32 v152, s6, v152
    v_and_b32 v153, s6, v153
    v_and_b32 v154, s6, v154
    v_and_b32 v155, s6, v155
    v_mul_f32 v11, s7, v10
    v_lshlrev_b32 v40, 16, v92
    v_and_b32 v41, s16, v92
    v_lshlrev_b32 v42, 16, v93
    v_and_b32 v43, s16, v93
    v_lshlrev_b32 v44, 16, v94
    v_and_b32 v45, s16, v94
    v_lshlrev_b32 v46, 16, v95
    v_and_b32 v47, s16, v95
    v_pk_add_f32 v[16:17], v[16:17], v[40:41]
    v_pk_add_f32 v[18:19], v[18:19], v[42:43]
    v_pk_add_f32 v[20:21], v[20:21], v[44:45]
    v_pk_add_f32 v[22:23], v[22:23], v[46:47]
    v_lshlrev_b32 v40, 16, v96
    v_and_b32 v41, s16, v96
    v_lshlrev_b32 v42, 16, v97
    v_and_b32 v43, s16, v97
    v_lshlrev_b32 v44, 16, v98
    v_and_b32 v45, s16, v98
    v_lshlrev_b32 v46, 16, v99
    v_and_b32 v47, s16, v99
    v_pk_add_f32 v[24:25], v[24:25], v[40:41]
    v_pk_add_f32 v[26:27], v[26:27], v[42:43]
    v_pk_add_f32 v[28:29], v[28:29], v[44:45]
    v_pk_add_f32 v[30:31], v[30:31], v[46:47]
    v_lshlrev_b32 v32, 16, v100
    v_and_b32 v33, s16, v100
    v_lshlrev_b32 v34, 16, v101
    v_and_b32 v35, s16, v101
    v_lshlrev_b32 v36, 16, v102
    v_and_b32 v37, s16, v102
    v_lshlrev_b32 v38, 16, v103
    v_and_b32 v39, s16, v103
    v_lshlrev_b32 v40, 16, v148
    v_and_b32 v41, s16, v148
    v_lshlrev_b32 v42, 16, v149
    v_and_b32 v43, s16, v149
    v_lshlrev_b32 v44, 16, v150
    v_and_b32 v45, s16, v150
    v_lshlrev_b32 v46, 16, v151
    v_and_b32 v47, s16, v151
    v_pk_add_f32 v[16:17], v[16:17], v[40:41]
    v_pk_add_f32 v[18:19], v[18:19], v[42:43]
    v_pk_add_f32 v[20:21], v[20:21], v[44:45]
    v_pk_add_f32 v[22:23], v[22:23], v[46:47]
    v_lshlrev_b32 v40, 16, v152
    v_and_b32 v41, s16, v152
    v_lshlrev_b32 v42, 16, v153
    v_and_b32 v43, s16, v153
    v_lshlrev_b32 v44, 16, v154
    v_and_b32 v45, s16, v154
    v_lshlrev_b32 v46, 16, v155
    v_and_b32 v47, s16, v155
    v_pk_add_f32 v[24:25], v[24:25], v[40:41]
    v_pk_add_f32 v[26:27], v[26:27], v[42:43]
    v_pk_add_f32 v[28:29], v[28:29], v[44:45]
    v_pk_add_f32 v[30:31], v[30:31], v[46:47]
    v_lshlrev_b32 v40, 16, v156
    v_and_b32 v41, s16, v156
    v_lshlrev_b32 v42, 16, v157
    v_and_b32 v43, s16, v157
    v_lshlrev_b32 v44, 16, v158
    v_and_b32 v45, s16, v158
    v_lshlrev_b32 v46, 16, v159
    v_and_b32 v47, s16, v159
    v_pk_add_f32 v[32:33], v[32:33], v[40:41]
    v_pk_add_f32 v[34:35], v[34:35], v[42:43]
    v_pk_add_f32 v[36:37], v[36:37], v[44:45]
    v_pk_add_f32 v[38:39], v[38:39], v[46:47]
    v_pk_add_f32 v[16:17], v[16:17], v[10:11] op_sel_hi:[1,0]
    v_pk_add_f32 v[18:19], v[18:19], v[10:11] op_sel_hi:[1,0]
    v_pk_add_f32 v[20:21], v[20:21], v[10:11] op_sel_hi:[1,0]
    v_pk_add_f32 v[22:23], v[22:23], v[10:11] op_sel_hi:[1,0]
    v_pk_add_f32 v[24:25], v[24:25], v[10:11] op_sel:[0,1] op_sel_hi:[1,1]
    v_pk_add_f32 v[26:27], v[26:27], v[10:11] op_sel:[0,1] op_sel_hi:[1,1]
    v_pk_add_f32 v[28:29], v[28:29], v[10:11] op_sel:[0,1] op_sel_hi:[1,1]
    v_pk_add_f32 v[30:31], v[30:31], v[10:11] op_sel:[0,1] op_sel_hi:[1,1]
    v_pk_add_f32 v[32:33], v[32:33], v[10:11] op_sel_hi:[1,0]
    v_pk_add_f32 v[34:35], v[34:35], v[10:11] op_sel_hi:[1,0]
    v_pk_add_f32 v[36:37], v[36:37], v[10:11] op_sel_hi:[1,0]
    v_pk_add_f32 v[38:39], v[38:39], v[10:11] op_sel_hi:[1,0]
    s_waitcnt vmcnt(6)
    s_add_u32 s28, s28, 4096
    buffer_load_dwordx4 a[64:67], v3, s[8:11], s28 offen offset:0 sc1
    v_lshlrev_b32 v40, 16, v60
    v_and_b32 v41, s16, v60
    v_lshlrev_b32 v42, 16, v61
    v_and_b32 v43, s16, v61
    v_lshlrev_b32 v44, 16, v62
    v_and_b32 v45, s16, v62
    v_lshlrev_b32 v46, 16, v63
    v_and_b32 v47, s16, v63
    v_pk_add_f32 v[32:33], v[32:33], v[40:41]
    v_pk_add_f32 v[34:35], v[34:35], v[42:43]
    v_pk_add_f32 v[36:37], v[36:37], v[44:45]
    v_pk_add_f32 v[38:39], v[38:39], v[46:47]
    s_waitcnt vmcnt(6)
    buffer_load_dwordx4 a[68:71], v3, s[8:11], s28 offen offset:1024 sc1
    v_lshlrev_b32 v40, 16, v64
    v_and_b32 v41, s16, v64
    v_lshlrev_b32 v42, 16, v65
    v_and_b32 v43, s16, v65
    v_lshlrev_b32 v44, 16, v66
    v_and_b32 v45, s16, v66
    v_lshlrev_b32 v46, 16, v67
    v_and_b32 v47, s16, v67
    v_pk_add_f32 v[32:33], v[32:33], v[40:41]
    v_pk_add_f32 v[34:35], v[34:35], v[42:43]
    v_pk_add_f32 v[36:37], v[36:37], v[44:45]
    v_pk_add_f32 v[38:39], v[38:39], v[46:47]
    s_waitcnt vmcnt(6)
    buffer_load_dwordx4 a[72:75], v3, s[8:11], s28 offen offset:2048 sc1
    v_lshlrev_b32 v40, 16, v68
    v_and_b32 v41, s16, v68
    v_lshlrev_b32 v42, 16, v69
    v_and_b32 v43, s16, v69
    v_lshlrev_b32 v44, 16, v70
    v_and_b32 v45, s16, v70
    v_lshlrev_b32 v46, 16, v71
    v_and_b32 v47, s16, v71
    v_pk_add_f32 v[32:33], v[32:33], v[40:41]
    v_pk_add_f32 v[34:35], v[34:35], v[42:43]
    v_pk_add_f32 v[36:37], v[36:37], v[44:45]
    v_pk_add_f32 v[38:39], v[38:39], v[46:47]
    s_waitcnt vmcnt(6)
    buffer_load_dwordx4 a[76:79], v229, s[8:11], s28 offen offset:3072 sc1
    v_lshlrev_b32 v40, 16, v72
    v_and_b32 v41, s16, v72
    v_lshlrev_b32 v42, 16, v73
    v_and_b32 v43, s16, v73
    v_lshlrev_b32 v44, 16, v74
    v_and_b32 v45, s16, v74
    v_lshlrev_b32 v46, 16, v75
    v_and_b32 v47, s16, v75
    v_pk_add_f32 v[32:33], v[32:33], v[40:41]
    v_pk_add_f32 v[34:35], v[34:35], v[42:43]
    v_pk_add_f32 v[36:37], v[36:37], v[44:45]
    v_pk_add_f32 v[38:39], v[38:39], v[46:47]
    s_waitcnt vmcnt(6)
    s_add_u32 s28, s28, 4096
    buffer_load_dwordx4 a[80:83], v3, s[8:11], s28 offen offset:0 sc1
    v_lshlrev_b32 v40, 16, v76
    v_and_b32 v41, s16, v76
    v_lshlrev_b32 v42, 16, v77
    v_and_b32 v43, s16, v77
    v_lshlrev_b32 v44, 16, v78
    v_and_b32 v45, s16, v78
    v_lshlrev_b32 v46, 16, v79
    v_and_b32 v47, s16, v79
    v_pk_add_f32 v[32:33], v[32:33], v[40:41]
    v_pk_add_f32 v[34:35], v[34:35], v[42:43]
    v_pk_add_f32 v[36:37], v[36:37], v[44:45]
    v_pk_add_f32 v[38:39], v[38:39], v[46:47]
    s_waitcnt vmcnt(6)
    buffer_load_dwordx4 a[84:87], v3, s[8:11], s28 offen offset:1024 sc1
    v_lshlrev_b32 v40, 16, v80
    v_and_b32 v41, s16, v80
    v_lshlrev_b32 v42, 16, v81
    v_and_b32 v43, s16, v81
    v_lshlrev_b32 v44, 16, v82
    v_and_b32 v45, s16, v82
    v_lshlrev_b32 v46, 16, v83
    v_and_b32 v47, s16, v83
    v_pk_add_f32 v[32:33], v[32:33], v[40:41]
    v_pk_add_f32 v[34:35], v[34:35], v[42:43]
    v_pk_add_f32 v[36:37], v[36:37], v[44:45]
    v_pk_add_f32 v[38:39], v[38:39], v[46:47]
    s_waitcnt vmcnt(6)
    buffer_load_dwordx4 a[88:91], v3, s[8:11], s28 offen offset:2048 sc1
    v_lshlrev_b32 v40, 16, v84
    v_and_b32 v41, s16, v84
    v_lshlrev_b32 v42, 16, v85
    v_and_b32 v43, s16, v85
    v_lshlrev_b32 v44, 16, v86
    v_and_b32 v45, s16, v86
    v_lshlrev_b32 v46, 16, v87
    v_and_b32 v47, s16, v87
    v_pk_add_f32 v[32:33], v[32:33], v[40:41]
    v_pk_add_f32 v[34:35], v[34:35], v[42:43]
    v_pk_add_f32 v[36:37], v[36:37], v[44:45]
    v_pk_add_f32 v[38:39], v[38:39], v[46:47]
    buffer_load_dwordx4 a[92:95], v229, s[8:11], s28 offen offset:3072 sc1
    v_cvt_pk_bf16_f32 v120, v16, v17
    v_cvt_pk_bf16_f32 v121, v18, v19
    v_cvt_pk_bf16_f32 v122, v20, v21
    v_cvt_pk_bf16_f32 v123, v22, v23
    v_cvt_pk_bf16_f32 v124, v24, v25
    v_cvt_pk_bf16_f32 v125, v26, v27
    v_cvt_pk_bf16_f32 v126, v28, v29
    v_cvt_pk_bf16_f32 v127, v30, v31
    v_cvt_pk_bf16_f32 v128, v32, v33
    v_cvt_pk_bf16_f32 v129, v34, v35
    v_cvt_pk_bf16_f32 v130, v36, v37
    v_cvt_pk_bf16_f32 v131, v38, v39
    s_cmp_lg_u32 s42, 0
    s_cbranch_scc1 L_main_last
    s_add_u32 s19, s18, 43515904
    s_add_u32 s20, s18, 38797312
    s_lshl_b32 s22, s21, 7
    s_add_u32 s22, s22, 48234496
    buffer_store_dwordx4 v[120:123], v172, s[8:11], s19 offen sc1
    buffer_store_dwordx4 v[124:127], v173, s[8:11], s19 offen sc1
    buffer_store_dwordx4 v[128:131], v174, s[8:11], s19 offen sc1
    s_mov_b32 s17, 0x3f803f80
    v_mov_b32 v8, 0
    v_mov_b32 v9, 0
    v_mov_b32 v10, 0
    v_mov_b32 v11, 0
    v_dot2c_f32_bf16 v8, s17, v120
    v_dot2c_f32_bf16 v9, v120, v120
    v_dot2c_f32_bf16 v10, s17, v121
    v_dot2c_f32_bf16 v11, v121, v121
    v_dot2c_f32_bf16 v8, s17, v122
    v_dot2c_f32_bf16 v9, v122, v122
    v_dot2c_f32_bf16 v10, s17, v123
    v_dot2c_f32_bf16 v11, v123, v123
    v_dot2c_f32_bf16 v8, s17, v124
    v_dot2c_f32_bf16 v9, v124, v124
    v_dot2c_f32_bf16 v10, s17, v125
    v_dot2c_f32_bf16 v11, v125, v125
    v_dot2c_f32_bf16 v8, s17, v126
    v_dot2c_f32_bf16 v9, v126, v126
    v_dot2c_f32_bf16 v10, s17, v127
    v_dot2c_f32_bf16 v11, v127, v127
    v_dot2c_f32_bf16 v8, s17, v128
    v_dot2c_f32_bf16 v9, v128, v128
    v_dot2c_f32_bf16 v10, s17, v129
    v_dot2c_f32_bf16 v11, v129, v129
    v_dot2c_f32_bf16 v8, s17, v130
    v_dot2c_f32_bf16 v9, v130, v130
    v_dot2c_f32_bf16 v10, s17, v131
    v_dot2c_f32_bf16 v11, v131, v131
    v_and_b32 v12, 7, v0
    v_lshlrev_b32 v12, 3, v12
    s_lshl_b32 s7, s3, 6
    v_add_u32 v13, s7, v12
    v_pk_add_f32 v[8:9], v[8:9], v[10:11]
    s_nop 1
    v_add_f32_dpp v8, v8, v8 row_ror:8 row_mask:0xf bank_mask:0xf
    v_add_f32_dpp v9, v9, v9 row_ror:8 row_mask:0xf bank_mask:0xf
    v_mov_b32 v10, v8
    v_mov_b32 v11, v9
    s_nop 1
    v_permlane32_swap_b32 v10, v8
    v_permlane32_swap_b32 v11, v9
    v_add_f32 v8, v8, v10
    v_add_f32 v9, v9, v11
    v_mov_b32 v10, v8
    v_mov_b32 v11, v9
    s_nop 1
    v_permlane16_swap_b32 v10, v8
    v_permlane16_swap_b32 v11, v9
    v_add_f32 v8, v8, v10
    v_add_f32 v9, v9, v11
    ds_write_b64 v13, v[8:9]
    s_waitcnt lgkmcnt(0)
    s_barrier
    ds_read_b64 v[40:41], v12 offset:0
    ds_read_b64 v[42:43], v12 offset:64
    ds_read_b64 v[44:45], v12 offset:128
    ds_read_b64 v[46:47], v12 offset:192
    s_waitcnt lgkmcnt(0)
    v_pk_add_f32 v[40:41], v[40:41], v[42:43]
    v_pk_add_f32 v[44:45], v[44:45], v[46:47]
    v_pk_add_f32 v[8:9], v[40:41], v[44:45]
    v_mul_f32 v8, 0x3ae38e39, v8
    v_mul_f32 v9, 0x3ae38e39, v9
    v_fma_f32 v9, -v8, v8, v9
    v_max_f32 v9, 0, v9
    v_add_f32 v9, 0x3727c5ac, v9
    v_rsq_f32 v10, v9
    s_nop 0
    v_mul_f32 v12, v8, v10
    v_mov_b32 v11, v10
    v_sub_f32 v12, 0, v12
    v_mov_b32 v13, v12
    s_cmp_eq_u32 s3, 0
    s_cselect_b32 s7, 32, 0
    v_lshlrev_b32 v14, 2, v0
    v_cmp_gt_u32 vcc, s7, v0
    v_mov_b32 v9, 1073741824
    s_nop 0
    v_cndmask_b32 v14, v9, v14, vcc
    buffer_store_dword v8, v14, s[8:11], s22 offen sc1
    v_lshlrev_b32 v40, 16, v120
    v_and_b32 v41, s16, v120
    v_lshlrev_b32 v42, 16, v121
    v_and_b32 v43, s16, v121
    v_lshlrev_b32 v44, 16, v122
    v_and_b32 v45, s16, v122
    v_lshlrev_b32 v46, 16, v123
    v_and_b32 v47, s16, v123
    v_pk_fma_f32 v[40:41], v[40:41], v[10:11], v[12:13]
    v_pk_fma_f32 v[42:43], v[42:43], v[10:11], v[12:13]
    v_pk_fma_f32 v[44:45], v[44:45], v[10:11], v[12:13]
    v_pk_fma_f32 v[46:47], v[46:47], v[10:11], v[12:13]
    v_cvt_pk_bf16_f32 v48, v40, v41
    v_cvt_pk_bf16_f32 v49, v42, v43
    v_cvt_pk_bf16_f32 v50, v44, v45
    v_cvt_pk_bf16_f32 v51, v46, v47
    v_lshlrev_b32 v40, 16, v124
    v_and_b32 v41, s16, v124
    v_lshlrev_b32 v42, 16, v125
    v_and_b32 v43, s16, v125
    v_lshlrev_b32 v44, 16, v126
    v_and_b32 v45, s16, v126
    v_lshlrev_b32 v46, 16, v127
    v_and_b32 v47, s16, v127
    v_pk_fma_f32 v[40:41], v[40:41], v[10:11], v[12:13]
    v_pk_fma_f32 v[42:43], v[42:43], v[10:11], v[12:13]
    v_pk_fma_f32 v[44:45], v[44:45], v[10:11], v[12:13]
    v_pk_fma_f32 v[46:47], v[46:47], v[10:11], v[12:13]
    v_cvt_pk_bf16_f32 v52, v40, v41
    v_cvt_pk_bf16_f32 v53, v42, v43
    v_cvt_pk_bf16_f32 v54, v44, v45
    v_cvt_pk_bf16_f32 v55, v46, v47
    v_lshlrev_b32 v40, 16, v128
    v_and_b32 v41, s16, v128
    v_lshlrev_b32 v42, 16, v129
    v_and_b32 v43, s16, v129
    v_lshlrev_b32 v44, 16, v130
    v_and_b32 v45, s16, v130
    v_lshlrev_b32 v46, 16, v131
    v_and_b32 v47, s16, v131
    v_pk_fma_f32 v[40:41], v[40:41], v[10:11], v[12:13]
    v_pk_fma_f32 v[42:43], v[42:43], v[10:11], v[12:13]
    v_pk_fma_f32 v[44:45], v[44:45], v[10:11], v[12:13]
    v_pk_fma_f32 v[46:47], v[46:47], v[10:11], v[12:13]
    v_cvt_pk_bf16_f32 v56, v40, v41
    v_cvt_pk_bf16_f32 v57, v42, v43
    v_cvt_pk_bf16_f32 v58, v44, v45
    v_cvt_pk_bf16_f32 v59, v46, v47
    buffer_store_dwordx4 v[48:51], v172, s[8:11], s20 offen sc1
    buffer_store_dwordx4 v[52:55], v173, s[8:11], s20 offen sc1
    buffer_store_dwordx4 v[56:59], v174, s[8:11], s20 offen sc1
    v_lshlrev_b32 v15, 7, v0
    s_lshl_b32 s6, s40, 2
    s_add_u32 s6, s6, s44
    s_add_u32 s6, s6, 98304
    v_mov_b32 v1, s76
    s_mov_b64 vcc, 0xff
    v_lshrrev_b32 v14, 3, v0
    v_lshl_add_u32 v15, v14, 3, v15
    s_cmp_ge_u32 s40, 6
    s_cselect_b32 s7, s41, 31
    s_cmp_lt_u32 s7, 31
    s_cmov_b64 vcc, 0xffff
    s_waitcnt vmcnt(0)
    s_barrier
    s_cmp_lg_u32 s3, 0
    s_cbranch_scc1 L_pub_46
    s_mov_b64 exec, vcc
    buffer_store_dword v1, v15, s[8:11], s6 offen sc1
L_pub_46:
    s_mov_b64 exec, -1
    s_add_u32 s28, s28, 4096
    buffer_load_dwordx4 a[96:99], v3, s[8:11], s28 offen offset:0 sc1
    buffer_load_dwordx4 a[100:103], v3, s[8:11], s28 offen offset:1024 sc1
    buffer_load_dwordx4 a[104:107], v3, s[8:11], s28 offen offset:2048 sc1
    buffer_load_dwordx4 a[108:111], v229, s[8:11], s28 offen offset:3072 sc1
    s_add_u32 s28, s28, 4096
    buffer_load_dwordx4 a[112:115], v3, s[8:11], s28 offen offset:0 sc1
    buffer_load_dwordx4 a[116:119], v3, s[8:11], s28 offen offset:1024 sc1
    buffer_load_dwordx4 a[120:123], v3, s[8:11], s28 offen offset:2048 sc1
    buffer_load_dwordx4 a[124:127], v229, s[8:11], s28 offen offset:3072 sc1
    s_add_u32 s28, s28, 4096
    buffer_load_dwordx4 a[128:131], v3, s[8:11], s28 offen offset:0 sc1
    buffer_load_dwordx4 a[132:135], v3, s[8:11], s28 offen offset:1024 sc1
    buffer_load_dwordx4 a[136:139], v3, s[8:11], s28 offen offset:2048 sc1
    buffer_load_dwordx4 a[140:143], v229, s[8:11], s28 offen offset:3072 sc1
    s_add_u32 s28, s28, 4096
    s_mov_b32 s42, 1
    s_mov_b32 s43, 0
    s_add_u32 s44, s44, 131072
    s_mov_b32 s74, 0
    s_branch L_main_layer
L_main_last:
    buffer_store_dwordx4 v[120:123], v175, s[12:15], s18 offen sc0 sc1
    buffer_store_dwordx4 v[124:127], v176, s[12:15], s18 offen sc0 sc1
    buffer_store_dwordx4 v[128:131], v177, s[12:15], s18 offen sc0 sc1
    s_or_b32 s7, s40, s41
    s_or_b32 s7, s7, s3
    s_cbranch_scc1 L_done_47
    v_mov_b32 v1, s76
    s_mov_b32 s7, 19660800
    s_mov_b64 exec, 1
    buffer_store_dword v1, off, s[8:11], s7 sc1
    s_mov_b64 exec, -1
L_done_47:
L_main_end:
    s_endpgm
L_main_code_end:
.section .rodata,"a"
.p2align 6
.amdhsa_kernel interleave_layers__sliding_local_dilated__glu_gated_geglu__prompt_kernel
.amdhsa_next_free_vgpr 512
.amdhsa_next_free_sgpr 102
.amdhsa_accum_offset 256
.amdhsa_group_segment_fixed_size 0
.amdhsa_kernarg_size 80
.amdhsa_user_sgpr_count 2
.amdhsa_user_sgpr_kernarg_segment_ptr 1
.amdhsa_system_sgpr_workgroup_id_x 1
.amdhsa_float_denorm_mode_32 3
.amdhsa_float_denorm_mode_16_64 3
.end_amdhsa_kernel
```

```asm
; @launch grid=(256,1,1) block=(256,1,1) lds=163840
.amdgcn_target "amdgcn-amd-amdhsa--gfx950"
.text
.globl interleave_layers__sliding_local_dilated__glu_gated_geglu__prompt_kernel
.p2align 8
.type interleave_layers__sliding_local_dilated__glu_gated_geglu__prompt_kernel,@function
interleave_layers__sliding_local_dilated__glu_gated_geglu__prompt_kernel:
    s_cmp_ge_u32 s2, 256
    s_cbranch_scc1 L_main_end
    s_load_dwordx2 s[4:5], s[0:1], 72
    s_load_dwordx4 s[16:19], s[0:1], 0
    s_load_dwordx2 s[22:23], s[0:1], 16
    s_load_dwordx8 s[24:31], s[0:1], 32
    s_getpc_b64 s[96:97]
L_main_pc:
    s_sub_u32 s96, s96, L_main_pc-interleave_layers__sliding_local_dilated__glu_gated_geglu__prompt_kernel
    s_subb_u32 s97, s97, 0
    s_and_b32 s97, s97, 0xffff
    s_mov_b32 s98, L_main_code_end-interleave_layers__sliding_local_dilated__glu_gated_geglu__prompt_kernel
    s_mov_b32 s99, 0x20000
    s_lshr_b32 s7, s2, 3
    s_lshl_b32 s7, s7, 11
    v_lshl_add_u32 v253, v0, 3, s7
    buffer_load_dwordx2 v[2:3], v253, s[96:99], 0 offen
    v_lshrrev_b32 v1, 6, v0
    v_and_b32 v0, 63, v0
    v_readfirstlane_b32 s3, v1
    s_waitcnt lgkmcnt(0)
    s_mov_b32 s8, s4
    s_and_b32 s9, s5, 0xffff
    s_mov_b32 s10, 268435456
    s_mov_b32 s11, 0x20000
    s_mov_b32 s7, 19660800
    s_load_dword s76, s[4:5], s7
    s_mov_b64 s[20:21], s[18:19]
    s_mov_b64 s[18:19], s[16:17]
    s_mov_b32 s48, s4
    s_and_b32 s49, s5, 0xffff
    s_mov_b32 s50, 268435456
    s_mov_b32 s51, 0x20000
    s_and_b32 s40, s2, 3
    s_lshl_b32 s40, s40, 1
    s_bfe_u32 s7, s2, 65539
    s_add_u32 s40, s40, s7
    s_bfe_u32 s41, s2, 65538
    s_lshl_b32 s41, s41, 4
    s_lshr_b32 s7, s2, 4
    s_add_u32 s41, s41, s7
    s_mov_b32 s42, 0
    s_mov_b32 s43, 0
    s_lshl_b32 s44, s41, 10
    s_add_u32 s44, s44, 19169280
    v_lshlrev_b32 v253, 4, v0
    s_mov_b32 s12, s18
    s_and_b32 s13, s19, 0xffff
    s_mov_b32 s14, 2359296
    s_mov_b32 s15, 0x20000
    s_mov_b32 s64, s20
    s_and_b32 s65, s21, 0xffff
    s_mov_b32 s66, 1990656
    s_mov_b32 s67, 0x20000
    s_mov_b32 s68, s22
    s_and_b32 s69, s23, 0xffff
    s_mov_b32 s70, 663552
    s_mov_b32 s71, 0x20000
    s_mov_b32 s16, 0xffff0000
    s_lshl_b32 s7, s3, 10
    v_add_u32 v172, s7, v253
    v_add_u32 v174, 5120, v172
    v_and_b32 v178, 7, v0
    v_mul_u32_u24 v178, 1152, v178
    v_lshrrev_b32 v179, 3, v0
    v_lshl_add_u32 v178, v179, 4, v178
    s_lshl_b32 s7, s3, 7
    v_add_u32 v175, s7, v178
    v_add_u32 v177, 640, v175
    s_cmp_eq_u32 s3, 0
    s_mov_b32 s17, 1073741824
    s_cmov_b32 s17, 4096
    v_add_u32 v173, s17, v172
    s_mov_b32 s17, 1073741824
    s_cmov_b32 s17, 512
    v_add_u32 v176, s17, v175
    s_lshl_b32 s21, s41, 3
    s_add_u32 s21, s21, s40
    s_mul_i32 s18, s21, 9216
    buffer_load_dwordx4 v[16:19], v175, s[12:15], s18 offen nt
    buffer_load_dwordx4 v[20:23], v176, s[12:15], s18 offen nt
    buffer_load_dwordx4 v[24:27], v177, s[12:15], s18 offen nt
    s_mov_b32 s12, s30
    s_and_b32 s13, s31, 0xffff
    s_mov_b32 s14, 2359296
    s_mov_b32 s15, 0x20000
    s_lshl_b32 s79, s3, 14
    s_add_u32 s79, s79, 98304
    s_and_b32 s32, s41, 15
    s_lshl_b32 s32, s32, 1
    s_lshr_b32 s7, s41, 4
    s_add_u32 s32, s32, s7
    s_lshl_b32 s36, s32, 3
    s_add_u32 s36, s36, s40
    s_sub_u32 s36, s36, 144
    s_cmp_ge_u32 s32, 18
    s_cbranch_scc1 L_prep_o_1
    s_mul_i32 s35, s32, 110592
    s_mul_i32 s7, s40, 144
    s_and_b32 s46, s7, 127
    s_sub_u32 s7, s7, s46
    s_add_u32 s35, s35, s7
    s_mul_i32 s7, s3, 13824
    s_add_u32 s35, s35, s7
    v_lshrrev_b32 v8, 4, v0
    v_mul_u32_u24 v8, 3456, v8
    v_and_b32 v9, 15, v0
    v_lshl_add_u32 v8, v9, 4, v8
    s_lshl_b32 s34, s3, 10
    s_add_u32 m0, s34, 8192
    s_add_u32 s7, s35, 0
    buffer_load_dwordx4 v8, s[64:67], s7 offen nt lds
    s_add_u32 m0, s34, 12288
    s_add_u32 s7, s35, 55296
    buffer_load_dwordx4 v8, s[64:67], s7 offen nt lds
    s_add_u32 m0, s34, 16384
    s_add_u32 s7, s35, 1152
    buffer_load_dwordx4 v8, s[64:67], s7 offen nt lds
    s_add_u32 m0, s34, 20480
    s_add_u32 s7, s35, 56448
    buffer_load_dwordx4 v8, s[64:67], s7 offen nt lds
    s_add_u32 m0, s34, 24576
    s_add_u32 s7, s35, 2304
    buffer_load_dwordx4 v8, s[64:67], s7 offen nt lds
    s_add_u32 m0, s34, 28672
    s_add_u32 s7, s35, 57600
    buffer_load_dwordx4 v8, s[64:67], s7 offen nt lds
    s_branch L_prep_go_3
L_prep_o_1:
    s_cmp_ge_u32 s36, 54
    s_cbranch_scc1 L_prep_m_2
    s_mul_i32 s33, s36, 349526
    s_lshr_b32 s33, s33, 20
    s_mul_i32 s34, s33, 3
    s_sub_u32 s34, s36, s34
    s_lshl_b32 s7, s33, 2
    s_add_u32 s7, s7, s3
    v_mov_b32 v8, s7
    v_lshrrev_b32 v9, 3, v0
    v_mul_u32_u24 v11, 7282, v8
    v_lshrrev_b32 v11, 16, v11
    v_mul_u32_u24 v12, 9, v11
    v_sub_u32 v12, v8, v12
    v_mul_u32_u24 v11, 72, v11
    v_cmp_eq_u32 vcc, 8, v12
    v_lshrrev_b32 v10, 1, v12
    v_mad_u32_u24 v10, v10, 18, v11
    v_and_b32 v12, 1, v12
    v_lshl_add_u32 v10, v12, 3, v10
    v_add_u32 v10, v10, v9
    v_lshrrev_b32 v12, 1, v9
    v_mad_u32_u24 v11, v12, 18, v11
    v_and_b32 v12, 1, v9
    v_add3_u32 v11, v11, v12, 16
    v_cndmask_b32 v10, v10, v11, vcc
    v_mul_u32_u24 v10, 1152, v10
    v_and_b32 v9, 7, v0
    v_lshl_add_u32 v10, v9, 4, v10
    s_mul_i32 s35, s34, 384
    s_lshl_b32 s6, s3, 10
    s_add_u32 m0, s6, 8192
    s_add_u32 s7, s35, 0
    buffer_load_dwordx4 v10, s[68:71], s7 offen nt lds
    s_add_u32 m0, s6, 12288
    s_add_u32 s7, s35, 128
    buffer_load_dwordx4 v10, s[68:71], s7 offen nt lds
    s_add_u32 m0, s6, 16384
    s_add_u32 s7, s35, 256
    buffer_load_dwordx4 v10, s[68:71], s7 offen nt lds
    s_branch L_prep_go_3
L_prep_m_2:
    s_sub_u32 s37, s36, 54
    s_lshl_b32 s7, s3, 6
    s_add_u32 s37, s37, s7
    s_cmp_ge_u32 s37, 36
    s_cbranch_scc1 L_prep_go_3
    s_lshl_b32 s7, s37, 1
    v_bfe_u32 v8, v0, 3, 1
    v_add_u32 v8, s7, v8
    v_and_b32 v9, 7, v0
    v_mul_u32_u24 v11, 7282, v8
    v_lshrrev_b32 v11, 16, v11
    v_mul_u32_u24 v12, 9, v11
    v_sub_u32 v12, v8, v12
    v_mul_u32_u24 v11, 72, v11
    v_cmp_eq_u32 vcc, 8, v12
    v_lshrrev_b32 v10, 1, v12
    v_mad_u32_u24 v10, v10, 18, v11
    v_and_b32 v12, 1, v12
    v_lshl_add_u32 v10, v12, 3, v10
    v_add_u32 v10, v10, v9
    v_lshrrev_b32 v12, 1, v9
    v_mad_u32_u24 v11, v12, 18, v11
    v_and_b32 v12, 1, v9
    v_add3_u32 v11, v11, v12, 16
    v_cndmask_b32 v10, v10, v11, vcc
    v_mul_u32_u24 v10, 1152, v10
    v_lshrrev_b32 v9, 4, v0
    v_lshl_add_u32 v10, v9, 4, v10
    buffer_load_dwordx4 v[64:67], v10, s[68:71], 0 offen offset:0
    buffer_load_dwordx4 v[68:71], v10, s[68:71], 0 offen offset:64
    buffer_load_dwordx4 v[72:75], v10, s[68:71], 0 offen offset:128
    buffer_load_dwordx4 v[76:79], v10, s[68:71], 0 offen offset:192
    buffer_load_dwordx4 v[80:83], v10, s[68:71], 0 offen offset:256
    buffer_load_dwordx4 v[84:87], v10, s[68:71], 0 offen offset:320
    buffer_load_dwordx4 v[88:91], v10, s[68:71], 0 offen offset:384
    buffer_load_dwordx4 v[92:95], v10, s[68:71], 0 offen offset:448
    buffer_load_dwordx4 v[96:99], v10, s[68:71], 0 offen offset:512
    buffer_load_dwordx4 v[100:103], v10, s[68:71], 0 offen offset:576
    buffer_load_dwordx4 v[104:107], v10, s[68:71], 0 offen offset:640
    buffer_load_dwordx4 v[108:111], v10, s[68:71], 0 offen offset:704
    buffer_load_dwordx4 v[112:115], v10, s[68:71], 0 offen offset:768
    buffer_load_dwordx4 v[116:119], v10, s[68:71], 0 offen offset:832
    buffer_load_dwordx4 v[120:123], v10, s[68:71], 0 offen offset:896
    buffer_load_dwordx4 v[124:127], v10, s[68:71], 0 offen offset:960
    buffer_load_dwordx4 v[128:131], v10, s[68:71], 0 offen offset:1024
    buffer_load_dwordx4 v[132:135], v10, s[68:71], 0 offen offset:1088
L_prep_go_3:
    s_lshl_b32 s7, s41, 2
    s_add_u32 s7, s7, s3
    s_mul_i32 s93, s7, 25576
    s_lshr_b32 s93, s93, 20
    s_min_u32 s93, s93, 2
    s_mul_i32 s6, s93, 41
    s_sub_u32 s7, s7, s6
    s_lshl_b32 s17, s7, 2
    s_cmp_eq_u32 s93, 1
    s_cselect_b32 s72, s26, s24
    s_cselect_b32 s73, s27, s25
    s_cmp_eq_u32 s93, 2
    s_cselect_b32 s72, s28, s72
    s_cselect_b32 s73, s29, s73
    s_mov_b32 s92, 73728
    s_cmov_b32 s92, 9216
    s_mov_b32 s47, 1152
    s_cmov_b32 s47, 663552
    s_and_b32 s73, s73, 0xffff
    s_mov_b32 s74, 5308416
    s_mov_b32 s75, 0x20000
    s_mul_i32 s47, s47, s40
    s_add_u32 s7, s17, 0
    s_min_u32 s7, s7, 161
    s_mul_i32 s84, s7, 116509
    s_lshr_b32 s84, s84, 20
    s_mul_i32 s88, s84, 9
    s_sub_u32 s88, s7, s88
    s_mul_i32 s7, s84, s92
    s_lshl_b32 s7, s7, 2
    s_add_u32 s7, s7, s47
    s_lshl_b32 s6, s88, 7
    s_add_u32 s80, s7, s6
    s_add_u32 s7, s17, 1
    s_min_u32 s7, s7, 161
    s_mul_i32 s85, s7, 116509
    s_lshr_b32 s85, s85, 20
    s_mul_i32 s89, s85, 9
    s_sub_u32 s89, s7, s89
    s_mul_i32 s7, s85, s92
    s_lshl_b32 s7, s7, 2
    s_add_u32 s7, s7, s47
    s_lshl_b32 s6, s89, 7
    s_add_u32 s81, s7, s6
    s_add_u32 s7, s17, 2
    s_min_u32 s7, s7, 161
    s_mul_i32 s86, s7, 116509
    s_lshr_b32 s86, s86, 20
    s_mul_i32 s90, s86, 9
    s_sub_u32 s90, s7, s90
    s_mul_i32 s7, s86, s92
    s_lshl_b32 s7, s7, 2
    s_add_u32 s7, s7, s47
    s_lshl_b32 s6, s90, 7
    s_add_u32 s82, s7, s6
    s_add_u32 s7, s17, 3
    s_min_u32 s7, s7, 161
    s_mul_i32 s87, s7, 116509
    s_lshr_b32 s87, s87, 20
    s_mul_i32 s91, s87, 9
    s_sub_u32 s91, s7, s91
    s_mul_i32 s7, s87, s92
    s_lshl_b32 s7, s7, 2
    s_add_u32 s7, s7, s47
    s_lshl_b32 s6, s91, 7
    s_add_u32 s83, s7, s6
    s_lshr_b32 s7, s92, 3
    v_lshrrev_b32 v224, 3, v0
    v_mul_lo_u32 v224, v224, s7
    v_and_b32 v8, 7, v0
    v_lshl_add_u32 v224, v8, 4, v224
    s_waitcnt lgkmcnt(0)
    s_mul_i32 s76, s76, 0x9e3779b1
    s_add_u32 s76, s76, 0x7f4a7c15
    s_mov_b32 s77, s76
    s_add_u32 m0, s79, 0
    s_mov_b32 s71, s80
    buffer_load_dwordx4 v224, s[72:75], s71 offen nt lds
    s_add_u32 m0, s79, 1024
    s_add_u32 s71, s71, s92
    buffer_load_dwordx4 v224, s[72:75], s71 offen nt lds
    s_add_u32 m0, s79, 2048
    s_add_u32 s71, s71, s92
    buffer_load_dwordx4 v224, s[72:75], s71 offen nt lds
    s_add_u32 m0, s79, 3072
    s_add_u32 s71, s71, s92
    buffer_load_dwordx4 v224, s[72:75], s71 offen nt lds
    s_waitcnt vmcnt(4)
    s_barrier
    s_cmp_ge_u32 s32, 18
    s_cbranch_scc1 L_prep_o_4
    s_mul_i32 s7, s3, 36
    s_add_u32 s7, s7, s46
    v_lshrrev_b32 v8, 4, v0
    v_lshlrev_b32 v8, 11, v8
    v_add_u32 v8, s7, v8
    v_and_b32 v9, 15, v0
    v_cmp_gt_u32 s[22:23], 6, v9
    v_lshrrev_b32 v10, 1, v9
    v_min_u32 v10, 2, v10
    v_lshl_add_u32 v10, v10, 13, v8
    v_and_b32 v11, 1, v0
    v_lshl_add_u32 v10, v11, 1, v10
    v_lshl_add_u32 v8, v9, 1, v8
    ds_read_u16 v136, v8 offset:8192
    ds_read_u16 v137, v8 offset:8448
    ds_read_u16 v138, v8 offset:8704
    ds_read_u16 v139, v8 offset:8960
    ds_read_u16 v140, v8 offset:9216
    ds_read_u16 v141, v8 offset:9472
    ds_read_u16 v142, v8 offset:9728
    ds_read_u16 v143, v8 offset:9984
    s_lshl_b32 s33, s40, 2
    s_add_u32 s33, s33, s3
    s_mul_i32 s33, s33, 18
    s_add_u32 s33, s33, s32
    s_lshl_b32 s33, s33, 12
    ds_read_u16 v144, v8 offset:16384
    ds_read_u16 v145, v8 offset:16640
    ds_read_u16 v146, v8 offset:16896
    ds_read_u16 v147, v8 offset:17152
    ds_read_u16 v148, v8 offset:17408
    ds_read_u16 v149, v8 offset:17664
    ds_read_u16 v150, v8 offset:17920
    ds_read_u16 v151, v8 offset:18176
    s_waitcnt lgkmcnt(8)
    v_lshl_or_b32 v32, v137, 16, v136
    v_lshl_or_b32 v33, v139, 16, v138
    v_lshl_or_b32 v34, v141, 16, v140
    v_lshl_or_b32 v35, v143, 16, v142
    buffer_store_dwordx4 v[32:35], v253, s[8:11], s33 offen offset:0 sc1
    ds_read_u16 v152, v8 offset:24576
    ds_read_u16 v153, v8 offset:24832
    ds_read_u16 v154, v8 offset:25088
    ds_read_u16 v155, v8 offset:25344
    ds_read_u16 v156, v8 offset:25600
    ds_read_u16 v157, v8 offset:25856
    ds_read_u16 v158, v8 offset:26112
    ds_read_u16 v159, v8 offset:26368
    s_waitcnt lgkmcnt(8)
    v_lshl_or_b32 v36, v145, 16, v144
    v_lshl_or_b32 v37, v147, 16, v146
    v_lshl_or_b32 v38, v149, 16, v148
    v_lshl_or_b32 v39, v151, 16, v150
    buffer_store_dwordx4 v[36:39], v253, s[8:11], s33 offen offset:1024 sc1
    ds_read_u16 v160, v10 offset:8224
    ds_read_u16 v161, v10 offset:8480
    ds_read_u16 v162, v10 offset:8736
    ds_read_u16 v163, v10 offset:8992
    ds_read_u16 v164, v10 offset:9248
    ds_read_u16 v165, v10 offset:9504
    ds_read_u16 v166, v10 offset:9760
    ds_read_u16 v167, v10 offset:10016
    s_waitcnt lgkmcnt(8)
    v_lshl_or_b32 v40, v153, 16, v152
    v_lshl_or_b32 v41, v155, 16, v154
    v_lshl_or_b32 v42, v157, 16, v156
    v_lshl_or_b32 v43, v159, 16, v158
    buffer_store_dwordx4 v[40:43], v253, s[8:11], s33 offen offset:2048 sc1
    s_waitcnt lgkmcnt(0)
    v_lshl_or_b32 v44, v161, 16, v160
    v_cndmask_b32 v44, 0, v44, s[22:23]
    v_lshl_or_b32 v45, v163, 16, v162
    v_cndmask_b32 v45, 0, v45, s[22:23]
    v_lshl_or_b32 v46, v165, 16, v164
    v_cndmask_b32 v46, 0, v46, s[22:23]
    v_lshl_or_b32 v47, v167, 16, v166
    v_cndmask_b32 v47, 0, v47, s[22:23]
    buffer_store_dwordx4 v[44:47], v253, s[8:11], s33 offen offset:3072 sc1
    s_branch L_prep_done_6
L_prep_o_4:
    s_cmp_ge_u32 s36, 54
    s_cbranch_scc1 L_prep_m_5
    v_lshrrev_b32 v8, 4, v0
    v_lshlrev_b32 v8, 3, v8
    v_bfe_u32 v9, v0, 2, 2
    v_add_u32 v8, v8, v9
    v_mul_u32_u24 v8, 128, v8
    v_and_b32 v9, 3, v0
    v_lshl_add_u32 v8, v9, 3, v8
    s_lshl_b32 s7, s3, 5
    v_add_u32 v8, s7, v8
    ds_read_b64_tr_b16 v[32:33], v8 offset:8192
    ds_read_b64_tr_b16 v[34:35], v8 offset:8704
    ds_read_b64_tr_b16 v[36:37], v8 offset:12288
    ds_read_b64_tr_b16 v[38:39], v8 offset:12800
    ds_read_b64_tr_b16 v[40:41], v8 offset:16384
    ds_read_b64_tr_b16 v[42:43], v8 offset:16896
    s_mul_i32 s34, s34, 12
    s_add_u32 s34, s34, s3
    s_mul_i32 s34, s34, 18
    s_add_u32 s34, s34, s33
    s_lshl_b32 s34, s34, 10
    s_add_u32 s7, s34, 2359296
    s_waitcnt lgkmcnt(4)
    buffer_store_dwordx4 v[32:35], v253, s[8:11], s7 offen sc1
    s_add_u32 s7, s34, 2433024
    s_waitcnt lgkmcnt(2)
    buffer_store_dwordx4 v[36:39], v253, s[8:11], s7 offen sc1
    s_add_u32 s7, s34, 2506752
    s_waitcnt lgkmcnt(0)
    buffer_store_dwordx4 v[40:43], v253, s[8:11], s7 offen sc1
    s_branch L_prep_done_6
L_prep_m_5:
    s_cmp_ge_u32 s37, 36
    s_cbranch_scc1 L_prep_done_6
    v_mov_b32 v28, 0x3f803f80
    v_mov_b32 v29, 0x3f803f80
    v_mov_b32 v30, 0x3f803f80
    v_mov_b32 v31, 0x3f803f80
    v_and_b32 v9, 15, v0
    v_cmp_eq_u32 vcc, 0, v9
    v_cmp_eq_u32 s[22:23], 1, v9
    v_mfma_f32_16x16x32_bf16 v[32:35], v[64:67], v[28:31], 0
    v_mfma_f32_16x16x32_bf16 v[32:35], v[68:71], v[28:31], v[32:35]
    v_mfma_f32_16x16x32_bf16 v[32:35], v[72:75], v[28:31], v[32:35]
    v_mfma_f32_16x16x32_bf16 v[32:35], v[76:79], v[28:31], v[32:35]
    v_mfma_f32_16x16x32_bf16 v[32:35], v[80:83], v[28:31], v[32:35]
    v_mfma_f32_16x16x32_bf16 v[32:35], v[84:87], v[28:31], v[32:35]
    v_mfma_f32_16x16x32_bf16 v[32:35], v[88:91], v[28:31], v[32:35]
    v_mfma_f32_16x16x32_bf16 v[32:35], v[92:95], v[28:31], v[32:35]
    v_mfma_f32_16x16x32_bf16 v[32:35], v[96:99], v[28:31], v[32:35]
    v_mfma_f32_16x16x32_bf16 v[32:35], v[100:103], v[28:31], v[32:35]
    v_mfma_f32_16x16x32_bf16 v[32:35], v[104:107], v[28:31], v[32:35]
    v_mfma_f32_16x16x32_bf16 v[32:35], v[108:111], v[28:31], v[32:35]
    v_mfma_f32_16x16x32_bf16 v[32:35], v[112:115], v[28:31], v[32:35]
    v_mfma_f32_16x16x32_bf16 v[32:35], v[116:119], v[28:31], v[32:35]
    v_mfma_f32_16x16x32_bf16 v[32:35], v[120:123], v[28:31], v[32:35]
    v_mfma_f32_16x16x32_bf16 v[32:35], v[124:127], v[28:31], v[32:35]
    v_mfma_f32_16x16x32_bf16 v[32:35], v[128:131], v[28:31], v[32:35]
    v_mfma_f32_16x16x32_bf16 v[32:35], v[132:135], v[28:31], v[32:35]
    v_lshrrev_b32 v10, 5, v0
    v_lshlrev_b32 v10, 8, v10
    v_lshl_add_u32 v10, v9, 4, v10
    v_bfe_u32 v9, v0, 4, 1
    v_lshl_add_u32 v10, v9, 3, v10
    s_lshl_b32 s7, s37, 9
    s_add_u32 s7, s7, 3022848
    s_nop 0
    v_mul_f32 v32, 0x3ae38e39, v32
    v_mul_f32 v33, 0x3ae38e39, v33
    v_mul_f32 v34, 0x3ae38e39, v34
    v_mul_f32 v35, 0x3ae38e39, v35
    v_cvt_pk_bf16_f32 v36, v32, v33
    v_cvt_pk_bf16_f32 v37, v34, v35
    v_lshlrev_b32 v38, 16, v36
    v_and_b32 v39, s16, v36
    v_sub_f32 v38, v32, v38
    v_sub_f32 v39, v33, v39
    v_cvt_pk_bf16_f32 v28, v38, v39
    v_cndmask_b32 v28, 0, v28, s[22:23]
    v_cndmask_b32 v28, v28, v36, vcc
    v_lshlrev_b32 v38, 16, v37
    v_and_b32 v39, s16, v37
    v_sub_f32 v38, v34, v38
    v_sub_f32 v39, v35, v39
    v_cvt_pk_bf16_f32 v29, v38, v39
    v_cndmask_b32 v29, 0, v29, s[22:23]
    v_cndmask_b32 v29, v29, v37, vcc
    buffer_store_dwordx2 v[28:29], v10, s[8:11], s7 offen sc1
L_prep_done_6:
    s_add_u32 s19, s18, 43515904
    s_add_u32 s20, s18, 38797312
    s_lshl_b32 s22, s21, 7
    s_add_u32 s22, s22, 48234496
    buffer_store_dwordx4 v[16:19], v172, s[8:11], s19 offen sc1
    buffer_store_dwordx4 v[20:23], v173, s[8:11], s19 offen sc1
    buffer_store_dwordx4 v[24:27], v174, s[8:11], s19 offen sc1
    s_mov_b32 s17, 0x3f803f80
    v_mov_b32 v8, 0
    v_mov_b32 v9, 0
    v_mov_b32 v10, 0
    v_mov_b32 v11, 0
    v_dot2c_f32_bf16 v8, s17, v16
    v_dot2c_f32_bf16 v9, v16, v16
    v_dot2c_f32_bf16 v10, s17, v17
    v_dot2c_f32_bf16 v11, v17, v17
    v_dot2c_f32_bf16 v8, s17, v18
    v_dot2c_f32_bf16 v9, v18, v18
    v_dot2c_f32_bf16 v10, s17, v19
    v_dot2c_f32_bf16 v11, v19, v19
    v_dot2c_f32_bf16 v8, s17, v20
    v_dot2c_f32_bf16 v9, v20, v20
    v_dot2c_f32_bf16 v10, s17, v21
    v_dot2c_f32_bf16 v11, v21, v21
    v_dot2c_f32_bf16 v8, s17, v22
    v_dot2c_f32_bf16 v9, v22, v22
    v_dot2c_f32_bf16 v10, s17, v23
    v_dot2c_f32_bf16 v11, v23, v23
    v_dot2c_f32_bf16 v8, s17, v24
    v_dot2c_f32_bf16 v9, v24, v24
    v_dot2c_f32_bf16 v10, s17, v25
    v_dot2c_f32_bf16 v11, v25, v25
    v_dot2c_f32_bf16 v8, s17, v26
    v_dot2c_f32_bf16 v9, v26, v26
    v_dot2c_f32_bf16 v10, s17, v27
    v_dot2c_f32_bf16 v11, v27, v27
    v_and_b32 v12, 7, v0
    v_lshlrev_b32 v12, 3, v12
    s_lshl_b32 s7, s3, 6
    v_add_u32 v13, s7, v12
    v_pk_add_f32 v[8:9], v[8:9], v[10:11]
    s_nop 1
    v_add_f32_dpp v8, v8, v8 row_ror:8 row_mask:0xf bank_mask:0xf
    v_add_f32_dpp v9, v9, v9 row_ror:8 row_mask:0xf bank_mask:0xf
    v_mov_b32 v10, v8
    v_mov_b32 v11, v9
    s_nop 1
    v_permlane32_swap_b32 v10, v8
    v_permlane32_swap_b32 v11, v9
    v_add_f32 v8, v8, v10
    v_add_f32 v9, v9, v11
    v_mov_b32 v10, v8
    v_mov_b32 v11, v9
    s_nop 1
    v_permlane16_swap_b32 v10, v8
    v_permlane16_swap_b32 v11, v9
    v_add_f32 v8, v8, v10
    v_add_f32 v9, v9, v11
    ds_write_b64 v13, v[8:9]
    s_waitcnt lgkmcnt(0)
    s_barrier
    ds_read_b64 v[40:41], v12 offset:0
    ds_read_b64 v[42:43], v12 offset:64
    ds_read_b64 v[44:45], v12 offset:128
    ds_read_b64 v[46:47], v12 offset:192
    s_waitcnt lgkmcnt(0)
    v_pk_add_f32 v[40:41], v[40:41], v[42:43]
    v_pk_add_f32 v[44:45], v[44:45], v[46:47]
    v_pk_add_f32 v[8:9], v[40:41], v[44:45]
    v_mul_f32 v8, 0x3ae38e39, v8
    v_mul_f32 v9, 0x3ae38e39, v9
    v_fma_f32 v9, -v8, v8, v9
    v_max_f32 v9, 0, v9
    v_add_f32 v9, 0x3727c5ac, v9
    v_rsq_f32 v10, v9
    s_nop 0
    v_mul_f32 v12, v8, v10
    v_mov_b32 v11, v10
    v_sub_f32 v12, 0, v12
    v_mov_b32 v13, v12
    s_cmp_eq_u32 s3, 0
    s_cselect_b32 s7, 32, 0
    v_lshlrev_b32 v14, 2, v0
    v_cmp_gt_u32 vcc, s7, v0
    v_mov_b32 v9, 1073741824
    s_nop 0
    v_cndmask_b32 v14, v9, v14, vcc
    buffer_store_dword v8, v14, s[8:11], s22 offen sc1
    v_lshlrev_b32 v40, 16, v16
    v_and_b32 v41, s16, v16
    v_lshlrev_b32 v42, 16, v17
    v_and_b32 v43, s16, v17
    v_lshlrev_b32 v44, 16, v18
    v_and_b32 v45, s16, v18
    v_lshlrev_b32 v46, 16, v19
    v_and_b32 v47, s16, v19
    v_pk_fma_f32 v[40:41], v[40:41], v[10:11], v[12:13]
    v_pk_fma_f32 v[42:43], v[42:43], v[10:11], v[12:13]
    v_pk_fma_f32 v[44:45], v[44:45], v[10:11], v[12:13]
    v_pk_fma_f32 v[46:47], v[46:47], v[10:11], v[12:13]
    v_cvt_pk_bf16_f32 v48, v40, v41
    v_cvt_pk_bf16_f32 v49, v42, v43
    v_cvt_pk_bf16_f32 v50, v44, v45
    v_cvt_pk_bf16_f32 v51, v46, v47
    v_lshlrev_b32 v40, 16, v20
    v_and_b32 v41, s16, v20
    v_lshlrev_b32 v42, 16, v21
    v_and_b32 v43, s16, v21
    v_lshlrev_b32 v44, 16, v22
    v_and_b32 v45, s16, v22
    v_lshlrev_b32 v46, 16, v23
    v_and_b32 v47, s16, v23
    v_pk_fma_f32 v[40:41], v[40:41], v[10:11], v[12:13]
    v_pk_fma_f32 v[42:43], v[42:43], v[10:11], v[12:13]
    v_pk_fma_f32 v[44:45], v[44:45], v[10:11], v[12:13]
    v_pk_fma_f32 v[46:47], v[46:47], v[10:11], v[12:13]
    v_cvt_pk_bf16_f32 v52, v40, v41
    v_cvt_pk_bf16_f32 v53, v42, v43
    v_cvt_pk_bf16_f32 v54, v44, v45
    v_cvt_pk_bf16_f32 v55, v46, v47
    v_lshlrev_b32 v40, 16, v24
    v_and_b32 v41, s16, v24
    v_lshlrev_b32 v42, 16, v25
    v_and_b32 v43, s16, v25
    v_lshlrev_b32 v44, 16, v26
    v_and_b32 v45, s16, v26
    v_lshlrev_b32 v46, 16, v27
    v_and_b32 v47, s16, v27
    v_pk_fma_f32 v[40:41], v[40:41], v[10:11], v[12:13]
    v_pk_fma_f32 v[42:43], v[42:43], v[10:11], v[12:13]
    v_pk_fma_f32 v[44:45], v[44:45], v[10:11], v[12:13]
    v_pk_fma_f32 v[46:47], v[46:47], v[10:11], v[12:13]
    v_cvt_pk_bf16_f32 v56, v40, v41
    v_cvt_pk_bf16_f32 v57, v42, v43
    v_cvt_pk_bf16_f32 v58, v44, v45
    v_cvt_pk_bf16_f32 v59, v46, v47
    buffer_store_dwordx4 v[48:51], v172, s[8:11], s20 offen sc1
    buffer_store_dwordx4 v[52:55], v173, s[8:11], s20 offen sc1
    buffer_store_dwordx4 v[56:59], v174, s[8:11], s20 offen sc1
    v_lshlrev_b32 v15, 7, v0
    s_lshl_b32 s6, s40, 2
    s_add_u32 s6, s6, s44
    s_sub_u32 s6, s6, 32768
    v_mov_b32 v1, s76
    s_mov_b64 vcc, 0xff
    v_lshrrev_b32 v14, 3, v0
    v_lshl_add_u32 v15, v14, 3, v15
    s_cmp_ge_u32 s40, 6
    s_cselect_b32 s7, s41, 31
    s_cmp_lt_u32 s7, 31
    s_cmov_b64 vcc, 0xffff
    s_waitcnt vmcnt(0)
    s_barrier
    s_cmp_lg_u32 s3, 0
    s_cbranch_scc1 L_pub_7
    s_mov_b64 exec, vcc
    buffer_store_dword v1, v15, s[8:11], s6 offen sc1
    s_lshl_b32 s6, s40, 7
    s_lshl_b32 s7, s32, 2
    s_add_u32 s6, s6, s7
    s_add_u32 s6, s6, 19431424
    s_mov_b64 exec, 0xffffffff
    v_lshlrev_b32 v15, 10, v0
    v_mov_b32 v1, s76
    buffer_store_dword v1, v15, s[8:11], s6 offen sc1
    s_cmp_lt_u32 s32, 18
    s_cbranch_scc1 L_pub_7
    s_lshl_b32 s6, s36, 2
    s_add_u32 s6, s6, 19496960
    s_mov_b64 exec, 1
    buffer_store_dword v1, off, s[8:11], s6 sc1
L_pub_7:
    s_mov_b64 exec, -1
    s_add_u32 m0, s79, 4096
    s_mov_b32 s71, s81
    buffer_load_dwordx4 v224, s[72:75], s71 offen nt lds
    s_add_u32 m0, s79, 5120
    s_add_u32 s71, s71, s92
    buffer_load_dwordx4 v224, s[72:75], s71 offen nt lds
    s_add_u32 m0, s79, 6144
    s_add_u32 s71, s71, s92
    buffer_load_dwordx4 v224, s[72:75], s71 offen nt lds
    s_add_u32 m0, s79, 7168
    s_add_u32 s71, s71, s92
    buffer_load_dwordx4 v224, s[72:75], s71 offen nt lds
    s_add_u32 m0, s79, 8192
    s_mov_b32 s71, s82
    buffer_load_dwordx4 v224, s[72:75], s71 offen nt lds
    s_add_u32 m0, s79, 9216
    s_add_u32 s71, s71, s92
    buffer_load_dwordx4 v224, s[72:75], s71 offen nt lds
    s_add_u32 m0, s79, 10240
    s_add_u32 s71, s71, s92
    buffer_load_dwordx4 v224, s[72:75], s71 offen nt lds
    s_add_u32 m0, s79, 11264
    s_add_u32 s71, s71, s92
    buffer_load_dwordx4 v224, s[72:75], s71 offen nt lds
    s_add_u32 m0, s79, 12288
    s_mov_b32 s71, s83
    buffer_load_dwordx4 v224, s[72:75], s71 offen nt lds
    s_add_u32 m0, s79, 13312
    s_add_u32 s71, s71, s92
    buffer_load_dwordx4 v224, s[72:75], s71 offen nt lds
    s_add_u32 m0, s79, 14336
    s_add_u32 s71, s71, s92
    buffer_load_dwordx4 v224, s[72:75], s71 offen nt lds
    s_add_u32 m0, s79, 15360
    s_add_u32 s71, s71, s92
    buffer_load_dwordx4 v224, s[72:75], s71 offen nt lds
    s_cmp_lg_u32 s3, 0
    s_cbranch_scc1 L_wq_ready_8
    s_lshl_b32 s7, s41, 3
    s_add_u32 s7, s7, s40
    s_lshl_b32 s7, s7, 7
    s_add_u32 s7, s7, 19431424
    s_add_u32 s68, s4, s7
    s_addc_u32 s69, s5, 0
    s_mov_b32 s6, 0
    s_mov_b32 s7, 0
L_cpoll_9:
    s_load_dwordx16 s[52:67], s[68:69], s7 glc
    s_add_u32 s6, s6, 1
    s_waitcnt lgkmcnt(0)
    s_xor_b64 s[52:53], s[52:53], s[76:77]
    s_xor_b64 s[54:55], s[54:55], s[76:77]
    s_xor_b64 s[56:57], s[56:57], s[76:77]
    s_xor_b64 s[58:59], s[58:59], s[76:77]
    s_xor_b64 s[60:61], s[60:61], s[76:77]
    s_xor_b64 s[62:63], s[62:63], s[76:77]
    s_xor_b64 s[64:65], s[64:65], s[76:77]
    s_xor_b64 s[66:67], s[66:67], s[76:77]
    s_or_b64 s[52:53], s[52:53], s[60:61]
    s_or_b64 s[54:55], s[54:55], s[62:63]
    s_or_b64 s[56:57], s[56:57], s[64:65]
    s_or_b64 s[58:59], s[58:59], s[66:67]
    s_or_b64 s[52:53], s[52:53], s[56:57]
    s_or_b64 s[54:55], s[54:55], s[58:59]
    s_or_b64 s[52:53], s[52:53], s[54:55]
    s_cbranch_scc1 L_cpoll_10
    s_add_u32 s7, s7, 8
    s_cmp_eq_u32 s7, 16
    s_cbranch_scc1 L_cpolled_11
L_cpoll_10:
    s_cmp_lt_u32 s6, 1048576
    s_cbranch_scc1 L_cpoll_9
    s_branch L_main_end
L_cpolled_11:
L_wq_ready_8:
    s_barrier
    s_lshl_b32 s28, s40, 2
    s_add_u32 s28, s28, s3
    s_mul_i32 s28, s28, 73728
    v_and_b32 v229, 8, v0
    v_lshl_add_u32 v229, v229, 27, v253
    buffer_load_dwordx4 a[0:3], v253, s[8:11], s28 offen offset:0 sc1
    buffer_load_dwordx4 a[4:7], v253, s[8:11], s28 offen offset:1024 sc1
    buffer_load_dwordx4 a[8:11], v253, s[8:11], s28 offen offset:2048 sc1
    buffer_load_dwordx4 a[12:15], v229, s[8:11], s28 offen offset:3072 sc1
    s_add_u32 s28, s28, 4096
    buffer_load_dwordx4 a[16:19], v253, s[8:11], s28 offen offset:0 sc1
    buffer_load_dwordx4 a[20:23], v253, s[8:11], s28 offen offset:1024 sc1
    buffer_load_dwordx4 a[24:27], v253, s[8:11], s28 offen offset:2048 sc1
    buffer_load_dwordx4 a[28:31], v229, s[8:11], s28 offen offset:3072 sc1
    s_add_u32 s28, s28, 4096
    buffer_load_dwordx4 a[32:35], v253, s[8:11], s28 offen offset:0 sc1
    buffer_load_dwordx4 a[36:39], v253, s[8:11], s28 offen offset:1024 sc1
    buffer_load_dwordx4 a[40:43], v253, s[8:11], s28 offen offset:2048 sc1
    buffer_load_dwordx4 a[44:47], v229, s[8:11], s28 offen offset:3072 sc1
    s_add_u32 s28, s28, 4096
    buffer_load_dwordx4 a[48:51], v253, s[8:11], s28 offen offset:0 sc1
    buffer_load_dwordx4 a[52:55], v253, s[8:11], s28 offen offset:1024 sc1
    buffer_load_dwordx4 a[56:59], v253, s[8:11], s28 offen offset:2048 sc1
    buffer_load_dwordx4 a[60:63], v229, s[8:11], s28 offen offset:3072 sc1
    s_add_u32 s28, s28, 4096
    buffer_load_dwordx4 a[64:67], v253, s[8:11], s28 offen offset:0 sc1
    buffer_load_dwordx4 a[68:71], v253, s[8:11], s28 offen offset:1024 sc1
    buffer_load_dwordx4 a[72:75], v253, s[8:11], s28 offen offset:2048 sc1
    buffer_load_dwordx4 a[76:79], v229, s[8:11], s28 offen offset:3072 sc1
    s_add_u32 s28, s28, 4096
    buffer_load_dwordx4 a[80:83], v253, s[8:11], s28 offen offset:0 sc1
    buffer_load_dwordx4 a[84:87], v253, s[8:11], s28 offen offset:1024 sc1
    buffer_load_dwordx4 a[88:91], v253, s[8:11], s28 offen offset:2048 sc1
    buffer_load_dwordx4 a[92:95], v229, s[8:11], s28 offen offset:3072 sc1
    s_add_u32 s28, s28, 4096
    buffer_load_dwordx4 a[96:99], v253, s[8:11], s28 offen offset:0 sc1
    buffer_load_dwordx4 a[100:103], v253, s[8:11], s28 offen offset:1024 sc1
    buffer_load_dwordx4 a[104:107], v253, s[8:11], s28 offen offset:2048 sc1
    buffer_load_dwordx4 a[108:111], v229, s[8:11], s28 offen offset:3072 sc1
    s_add_u32 s28, s28, 4096
    buffer_load_dwordx4 a[112:115], v253, s[8:11], s28 offen offset:0 sc1
    buffer_load_dwordx4 a[116:119], v253, s[8:11], s28 offen offset:1024 sc1
    buffer_load_dwordx4 a[120:123], v253, s[8:11], s28 offen offset:2048 sc1
    buffer_load_dwordx4 a[124:127], v229, s[8:11], s28 offen offset:3072 sc1
    s_add_u32 s28, s28, 4096
    buffer_load_dwordx4 a[128:131], v253, s[8:11], s28 offen offset:0 sc1
    buffer_load_dwordx4 a[132:135], v253, s[8:11], s28 offen offset:1024 sc1
    buffer_load_dwordx4 a[136:139], v253, s[8:11], s28 offen offset:2048 sc1
    buffer_load_dwordx4 a[140:143], v229, s[8:11], s28 offen offset:3072 sc1
    s_add_u32 s28, s28, 4096
L_main_layer:
    v_bfe_u32 v3, v0, 3, 1
    v_mul_u32_u24 v2, 9216, v3
    v_lshrrev_b32 v3, 4, v0
    v_lshl_add_u32 v2, v3, 7, v2
    v_and_b32 v3, 7, v0
    v_lshl_add_u32 v2, v3, 4, v2
    v_bfe_u32 v3, v0, 3, 2
    s_mov_b32 s7, 9216
    v_mul_lo_u32 v9, v3, s7
    v_lshrrev_b32 v3, 5, v0
    v_lshl_add_u32 v9, v3, 7, v9
    v_and_b32 v3, 7, v0
    v_lshl_add_u32 v9, v3, 4, v9
    s_mul_i32 s22, s41, 73728
    s_add_u32 s22, s22, s43
    s_add_u32 s23, s22, 38797312
    s_mul_i32 s7, s3, 18432
    s_add_u32 s24, s23, s7
    s_cmp_eq_u32 s41, 0
    s_cselect_b32 s7, 0, 18432
    s_sub_u32 s23, s23, s7
    s_lshl_b32 s25, s3, 10
    s_add_u32 s25, s25, 1024
    s_mul_i32 s26, s3, 5120
    s_lshl_b32 s7, s3, 9
    s_add_u32 s27, s23, s7
    s_and_b32 s7, s3, 1
    s_add_u32 s7, s7, 4
    s_mul_i32 s29, s7, 5120
    s_lshl_b32 s7, s7, 9
    s_add_u32 s23, s23, s7
    s_cmp_lg_u32 s3, 3
    s_cbranch_scc1 L_pollout_14
    s_lshl_b32 s7, s40, 7
    s_add_u32 s7, s7, s44
    s_sub_u32 s7, s7, 32768
    s_add_u32 s52, s4, s7
    s_addc_u32 s53, s5, 0
    s_cmp_eq_u32 s41, 0
    s_cselect_b32 s7, 0, 32
    s_mov_b32 s6, 0
L_poll_12:
    s_load_dwordx8 s[56:63], s[52:53], 0 glc
    s_load_dwordx2 s[54:55], s[52:53], s7 glc
    s_add_u32 s6, s6, 1
    s_waitcnt lgkmcnt(0)
    s_xor_b64 s[54:55], s[54:55], s[76:77]
    s_xor_b64 s[56:57], s[56:57], s[76:77]
    s_xor_b64 s[58:59], s[58:59], s[76:77]
    s_xor_b64 s[60:61], s[60:61], s[76:77]
    s_xor_b64 s[62:63], s[62:63], s[76:77]
    s_or_b64 s[56:57], s[56:57], s[58:59]
    s_or_b64 s[60:61], s[60:61], s[62:63]
    s_or_b64 s[56:57], s[56:57], s[54:55]
    s_or_b64 s[56:57], s[56:57], s[60:61]
    s_cbranch_scc0 L_polled_13
    s_cmp_lt_u32 s6, 1048576
    s_cbranch_scc1 L_poll_12
    s_branch L_main_end
L_polled_13:
L_pollout_14:
    s_barrier
    s_add_u32 m0, s25, 0
    s_nop 0
    buffer_load_dwordx4 v2, s[8:11], s24 offen offset:0 sc1 lds
    s_add_u32 m0, s25, 4608
    s_nop 0
    buffer_load_dwordx4 v2, s[8:11], s24 offen offset:512 sc1 lds
    s_add_u32 m0, s25, 9216
    s_nop 0
    buffer_load_dwordx4 v2, s[8:11], s24 offen offset:1024 sc1 lds
    s_add_u32 m0, s25, 13824
    s_nop 0
    buffer_load_dwordx4 v2, s[8:11], s24 offen offset:1536 sc1 lds
    s_add_u32 m0, s25, 18432
    s_nop 0
    buffer_load_dwordx4 v2, s[8:11], s24 offen offset:2048 sc1 lds
    s_add_u32 m0, s25, 23040
    s_nop 0
    buffer_load_dwordx4 v2, s[8:11], s24 offen offset:2560 sc1 lds
    s_add_u32 m0, s26, 0
    s_add_u32 s7, s27, 0
    buffer_load_dwordx4 v2, s[8:11], s7 offen sc1 lds
    s_add_u32 m0, s29, 0
    s_add_u32 s7, s23, 0
    buffer_load_dwordx4 v2, s[8:11], s7 offen sc1 lds
    v_add_u32 v6, 46080, v253
    s_waitcnt vmcnt(0)
    s_barrier
    ds_read_b128 v[16:19], v253 offset:0
    ds_read_b128 v[20:23], v253 offset:1024
    ds_read_b128 v[24:27], v253 offset:2048
    ds_read_b128 v[28:31], v253 offset:3072
    ds_read_b128 v[32:35], v253 offset:4096
    s_waitcnt lgkmcnt(0)
    v_mfma_f32_16x16x32_bf16 v[56:59], a[0:3], v[20:23], 0
    ds_read_b128 v[36:39], v253 offset:5120
    v_mfma_f32_16x16x32_bf16 v[60:63], a[0:3], v[24:27], 0
    ds_read_b128 v[40:43], v253 offset:6144
    v_mfma_f32_16x16x32_bf16 v[64:67], a[0:3], v[28:31], 0
    ds_read_b128 v[44:47], v253 offset:7168
    v_mfma_f32_16x16x32_bf16 v[68:71], a[0:3], v[32:35], 0
    ds_read_b128 v[48:51], v253 offset:8192
    v_mfma_f32_16x16x32_bf16 v[72:75], a[4:7], v[16:19], 0
    ds_read_b128 v[52:55], v253 offset:9216
    v_mfma_f32_16x16x32_bf16 v[76:79], a[4:7], v[20:23], 0
    s_add_u32 m0, s25, 27648
    s_nop 0
    buffer_load_dwordx4 v2, s[8:11], s24 offen offset:3072 sc1 lds
    v_mfma_f32_16x16x32_bf16 v[80:83], a[4:7], v[24:27], 0
    v_mov_b32 v132, 0
    v_mov_b32 v133, 0
    v_mfma_f32_16x16x32_bf16 v[84:87], a[4:7], v[28:31], 0
    s_add_u32 m0, s25, 32256
    s_nop 0
    buffer_load_dwordx4 v2, s[8:11], s24 offen offset:3584 sc1 lds
    v_mfma_f32_16x16x32_bf16 v[88:91], a[4:7], v[32:35], 0
    v_mov_b32 v192, 0
    v_mov_b32 v193, 0
    v_mfma_f32_16x16x32_bf16 v[92:95], v[16:19], a[8:11], 0
    buffer_load_dwordx4 a[144:147], v253, s[8:11], s28 offen offset:0 sc1
    v_mfma_f32_16x16x32_bf16 v[96:99], v[20:23], a[8:11], 0
    v_mov_b32 v195, 0
    v_mov_b32 v135, 0
    v_mfma_f32_16x16x32_bf16 v[100:103], v[24:27], a[8:11], 0
    buffer_load_dwordx4 a[148:151], v253, s[8:11], s28 offen offset:1024 sc1
    v_mfma_f32_16x16x32_bf16 v[104:107], v[28:31], a[8:11], 0
    v_mov_b32 v139, 0
    v_mov_b32 v143, 0
    v_mfma_f32_16x16x32_bf16 v[108:111], v[32:35], a[8:11], 0
    buffer_load_dwordx4 a[152:155], v253, s[8:11], s28 offen offset:2048 sc1
    v_mfma_f32_16x16x32_bf16 v[112:115], a[12:15], v[16:19], 0
    v_mov_b32 v147, 0
    v_mov_b32 v151, 0
    v_mfma_f32_16x16x32_bf16 v[116:119], a[12:15], v[20:23], 0
    v_mov_b32 v155, 0
    v_mov_b32 v159, 0
    v_mfma_f32_16x16x32_bf16 v[120:123], a[12:15], v[24:27], 0
    v_mov_b32 v163, 0
    v_mov_b32 v167, 0
    v_mfma_f32_16x16x32_bf16 v[124:127], a[12:15], v[28:31], 0
    v_mov_b32 v171, 0
    v_cmp_eq_u32 vcc, 16, v0
    v_mov_b32 v10, 0x3f80
    v_mfma_f32_16x16x32_bf16 v[128:131], a[12:15], v[32:35], 0
    v_cmp_eq_u32 s[20:21], 17, v0
    v_cndmask_b32 v194, 0, v10, vcc
    v_and_b32 v11, 3, v0
    s_waitcnt lgkmcnt(0)
    v_mfma_f32_16x16x32_bf16 v[56:59], a[16:19], v[40:43], v[56:59]
    ds_read_b128 v[16:19], v253 offset:10240
    v_mfma_f32_16x16x32_bf16 v[60:63], a[16:19], v[44:47], v[60:63]
    ds_read_b128 v[20:23], v253 offset:11264
    v_mfma_f32_16x16x32_bf16 v[64:67], a[16:19], v[48:51], v[64:67]
    ds_read_b128 v[24:27], v253 offset:12288
    v_mfma_f32_16x16x32_bf16 v[68:71], a[16:19], v[52:55], v[68:71]
    ds_read_b128 v[28:31], v253 offset:13312
    v_mfma_f32_16x16x32_bf16 v[72:75], a[20:23], v[36:39], v[72:75]
    ds_read_b128 v[32:35], v253 offset:14336
    v_mfma_f32_16x16x32_bf16 v[76:79], a[20:23], v[40:43], v[76:79]
    s_add_u32 m0, s25, 40960
    s_add_u32 s24, s24, 4096
    buffer_load_dwordx4 v2, s[8:11], s24 offen offset:0 sc1 lds
    v_mfma_f32_16x16x32_bf16 v[80:83], a[20:23], v[44:47], v[80:83]
    v_cndmask_b32 v194, v194, 1.0, s[20:21]
    v_cmp_eq_u32 vcc, 2, v11
    v_and_b32 v10, 15, v0
    v_mfma_f32_16x16x32_bf16 v[84:87], a[20:23], v[48:51], v[84:87]
    s_add_u32 m0, s25, 45568
    s_nop 0
    buffer_load_dwordx4 v2, s[8:11], s24 offen offset:512 sc1 lds
    v_mfma_f32_16x16x32_bf16 v[88:91], a[20:23], v[52:55], v[88:91]
    v_lshrrev_b32 v11, 4, v0
    v_cndmask_b32 v196, 0, 1.0, vcc
    v_mfma_f32_16x16x32_bf16 v[92:95], v[36:39], a[24:27], v[92:95]
    buffer_load_dwordx4 a[156:159], v229, s[8:11], s28 offen offset:3072 sc1
    s_add_u32 s28, s28, 4096
    v_mfma_f32_16x16x32_bf16 v[96:99], v[40:43], a[24:27], v[96:99]
    v_cndmask_b32 v197, 0, 1.0, vcc
    v_cndmask_b32 v198, 0, 1.0, vcc
    v_mfma_f32_16x16x32_bf16 v[100:103], v[44:47], a[24:27], v[100:103]
    buffer_load_dwordx4 a[0:3], v253, s[8:11], s28 offen offset:0 sc1
    v_mfma_f32_16x16x32_bf16 v[104:107], v[48:51], a[24:27], v[104:107]
    v_cndmask_b32 v199, 0, 1.0, vcc
    v_lshlrev_b32 v11, 2, v11
    v_mfma_f32_16x16x32_bf16 v[108:111], v[52:55], a[24:27], v[108:111]
    buffer_load_dwordx4 a[4:7], v253, s[8:11], s28 offen offset:1024 sc1
    v_mfma_f32_16x16x32_bf16 v[112:115], a[28:31], v[36:39], v[112:115]
    v_sub_u32 v10, v11, v10
    v_mov_b32 v12, 0xf149f2ca
    v_mfma_f32_16x16x32_bf16 v[116:119], a[28:31], v[40:43], v[116:119]
    s_cmp_eq_u32 s41, 0
    s_cselect_b64 s[38:39], 0, -1
    v_add_u32 v11, 0, v10
    v_and_b32 v13, 1, v11
    v_mfma_f32_16x16x32_bf16 v[120:123], a[28:31], v[44:47], v[120:123]
    v_cmp_eq_u32 s[20:21], 0, v13
    v_cmp_lt_i32 vcc, 1, v11
    v_cmp_gt_i32 s[18:19], 1, v11
    s_and_b64 vcc, vcc, s[20:21]
    s_and_b64 s[18:19], s[18:19], s[20:21]
    s_and_b64 s[20:21], vcc, s[38:39]
    v_cndmask_b32 v200, v12, 0, vcc
    v_cndmask_b32 v204, v12, 0, s[18:19]
    v_mfma_f32_16x16x32_bf16 v[124:127], a[28:31], v[48:51], v[124:127]
    v_cndmask_b32 v208, v12, 0, s[20:21]
    v_add_u32 v11, 1, v10
    v_mfma_f32_16x16x32_bf16 v[128:131], a[28:31], v[52:55], v[128:131]
    v_and_b32 v13, 1, v11
    v_cmp_eq_u32 s[20:21], 0, v13
    v_cmp_lt_i32 vcc, 1, v11
    v_cmp_gt_i32 s[18:19], 1, v11
    s_and_b64 vcc, vcc, s[20:21]
    s_and_b64 s[18:19], s[18:19], s[20:21]
    s_and_b64 s[20:21], vcc, s[38:39]
    v_cndmask_b32 v201, v12, 0, vcc
    s_waitcnt lgkmcnt(0)
    v_mfma_f32_16x16x32_bf16 v[56:59], a[32:35], v[20:23], v[56:59]
    ds_read_b128 v[36:39], v253 offset:15360
    v_mfma_f32_16x16x32_bf16 v[60:63], a[32:35], v[24:27], v[60:63]
    ds_read_b128 v[40:43], v253 offset:16384
    v_mfma_f32_16x16x32_bf16 v[64:67], a[32:35], v[28:31], v[64:67]
    ds_read_b128 v[44:47], v253 offset:17408
    v_mfma_f32_16x16x32_bf16 v[68:71], a[32:35], v[32:35], v[68:71]
    ds_read_b128 v[48:51], v253 offset:18432
    v_mfma_f32_16x16x32_bf16 v[72:75], a[36:39], v[16:19], v[72:75]
    ds_read_b128 v[52:55], v253 offset:19456
    v_mfma_f32_16x16x32_bf16 v[76:79], a[36:39], v[20:23], v[76:79]
    s_add_u32 m0, s25, 50176
    s_nop 0
    buffer_load_dwordx4 v2, s[8:11], s24 offen offset:1024 sc1 lds
    v_mfma_f32_16x16x32_bf16 v[80:83], a[36:39], v[24:27], v[80:83]
    v_cndmask_b32 v205, v12, 0, s[18:19]
    v_cndmask_b32 v209, v12, 0, s[20:21]
    v_mfma_f32_16x16x32_bf16 v[84:87], a[36:39], v[28:31], v[84:87]
    s_add_u32 m0, s25, 54784
    s_nop 0
    buffer_load_dwordx4 v2, s[8:11], s24 offen offset:1536 sc1 lds
    v_mfma_f32_16x16x32_bf16 v[88:91], a[36:39], v[32:35], v[88:91]
    v_add_u32 v11, 2, v10
    v_and_b32 v13, 1, v11
    v_mfma_f32_16x16x32_bf16 v[92:95], v[16:19], a[40:43], v[92:95]
    buffer_load_dwordx4 a[8:11], v253, s[8:11], s28 offen offset:2048 sc1
    v_mfma_f32_16x16x32_bf16 v[96:99], v[20:23], a[40:43], v[96:99]
    v_cmp_eq_u32 s[20:21], 0, v13
    v_cmp_lt_i32 vcc, 1, v11
    v_cmp_gt_i32 s[18:19], 1, v11
    s_and_b64 vcc, vcc, s[20:21]
    s_and_b64 s[18:19], s[18:19], s[20:21]
    s_and_b64 s[20:21], vcc, s[38:39]
    v_cndmask_b32 v202, v12, 0, vcc
    v_cndmask_b32 v206, v12, 0, s[18:19]
    v_mfma_f32_16x16x32_bf16 v[100:103], v[24:27], a[40:43], v[100:103]
    buffer_load_dwordx4 a[12:15], v229, s[8:11], s28 offen offset:3072 sc1
    s_add_u32 s28, s28, 4096
    v_mfma_f32_16x16x32_bf16 v[104:107], v[28:31], a[40:43], v[104:107]
    v_cndmask_b32 v210, v12, 0, s[20:21]
    v_add_u32 v11, 3, v10
    v_mfma_f32_16x16x32_bf16 v[108:111], v[32:35], a[40:43], v[108:111]
    buffer_load_dwordx4 a[16:19], v253, s[8:11], s28 offen offset:0 sc1
    v_mfma_f32_16x16x32_bf16 v[112:115], a[44:47], v[16:19], v[112:115]
    v_and_b32 v13, 1, v11
    v_cmp_eq_u32 s[20:21], 0, v13
    v_cmp_lt_i32 vcc, 1, v11
    v_cmp_gt_i32 s[18:19], 1, v11
    s_and_b64 vcc, vcc, s[20:21]
    s_and_b64 s[18:19], s[18:19], s[20:21]
    s_and_b64 s[20:21], vcc, s[38:39]
    v_cndmask_b32 v203, v12, 0, vcc
    v_mfma_f32_16x16x32_bf16 v[116:119], a[44:47], v[20:23], v[116:119]
    v_cndmask_b32 v207, v12, 0, s[18:19]
    v_cndmask_b32 v211, v12, 0, s[20:21]
    v_mfma_f32_16x16x32_bf16 v[120:123], a[44:47], v[24:27], v[120:123]
    s_lshl_b32 s45, s41, 1
    s_lshr_b32 s7, s40, 2
    s_add_u32 s45, s45, s7
    s_mul_i32 s30, s45, 36864
    s_add_u32 s30, s30, s43
    s_and_b32 s31, s40, 3
    s_mul_i32 s31, s31, 9
    s_add_u32 s31, s31, s3
    s_mul_i32 s32, s31, 18432
    s_add_u32 s32, s32, 2359296
    s_add_u32 s33, s32, 73728
    s_add_u32 s34, s32, 147456
    s_mov_b32 s39, 19496960
    v_min_u32 v228, 44, v0
    v_lshlrev_b32 v228, 3, v228
    v_mfma_f32_16x16x32_bf16 v[124:127], a[44:47], v[28:31], v[124:127]
    s_cmp_eq_u32 s3, 1
    s_cmov_b32 s34, 3022848
    s_cmp_lt_u32 s3, 2
    s_cselect_b32 s35, 0, 1073741824
    v_add_u32 v5, s35, v253
    s_cmp_eq_u32 s3, 1
    s_cselect_b32 s7, 8, 0
    v_and_b32 v10, s7, v0
    v_mfma_f32_16x16x32_bf16 v[128:131], a[44:47], v[32:35], v[128:131]
    v_lshl_add_u32 v5, v10, 27, v5
    s_cmp_eq_u32 s3, 0
    s_cselect_b32 s35, 0, 1073741824
    v_add_u32 v7, s35, v9
    s_waitcnt lgkmcnt(0)
    v_mfma_f32_16x16x32_bf16 v[56:59], a[48:51], v[40:43], v[56:59]
    ds_read_b128 v[16:19], v253 offset:20480
    v_mfma_f32_16x16x32_bf16 v[60:63], a[48:51], v[44:47], v[60:63]
    ds_read_b128 v[20:23], v253 offset:21504
    v_mfma_f32_16x16x32_bf16 v[64:67], a[48:51], v[48:51], v[64:67]
    ds_read_b128 v[24:27], v253 offset:22528
    v_mfma_f32_16x16x32_bf16 v[68:71], a[48:51], v[52:55], v[68:71]
    ds_read_b128 v[28:31], v253 offset:23552
    v_mfma_f32_16x16x32_bf16 v[72:75], a[52:55], v[36:39], v[72:75]
    ds_read_b128 v[32:35], v253 offset:24576
    v_mfma_f32_16x16x32_bf16 v[76:79], a[52:55], v[40:43], v[76:79]
    s_add_u32 m0, s26, 30720
    s_add_u32 s7, s27, 3072
    buffer_load_dwordx4 v2, s[8:11], s7 offen sc1 lds
    v_mfma_f32_16x16x32_bf16 v[80:83], a[52:55], v[44:47], v[80:83]
    s_lshl_b32 s7, s31, 8
    s_add_u32 s36, s30, s7
    s_add_u32 s37, s36, 43515904
    s_add_u32 s46, s36, 45875200
    s_lshl_b32 s36, s45, 7
    s_add_u32 s36, s36, s43
    s_add_u32 s36, s36, 48431104
    s_lshl_b32 s47, s45, 9
    s_add_u32 s47, s47, s43
    s_add_u32 s47, s47, 48234496
    v_bfe_u32 v10, v0, 3, 2
    v_and_b32 v8, 7, v0
    v_mfma_f32_16x16x32_bf16 v[84:87], a[52:55], v[48:51], v[84:87]
    s_add_u32 m0, s29, 30720
    s_add_u32 s7, s23, 3072
    buffer_load_dwordx4 v2, s[8:11], s7 offen sc1 lds
    v_mfma_f32_16x16x32_bf16 v[88:91], a[52:55], v[52:55], v[88:91]
    v_lshlrev_b32 v8, 2, v8
    v_lshl_add_u32 v8, v10, 7, v8
    v_mfma_f32_16x16x32_bf16 v[92:95], v[36:39], a[56:59], v[92:95]
    buffer_load_dwordx4 a[20:23], v253, s[8:11], s28 offen offset:1024 sc1
    v_mfma_f32_16x16x32_bf16 v[96:99], v[40:43], a[56:59], v[96:99]
    v_mfma_f32_16x16x32_bf16 v[100:103], v[44:47], a[56:59], v[100:103]
    buffer_load_dwordx4 a[24:27], v253, s[8:11], s28 offen offset:2048 sc1
    v_mfma_f32_16x16x32_bf16 v[104:107], v[48:51], a[56:59], v[104:107]
    v_mfma_f32_16x16x32_bf16 v[108:111], v[52:55], a[56:59], v[108:111]
    buffer_load_dwordx4 a[28:31], v229, s[8:11], s28 offen offset:3072 sc1
    s_add_u32 s28, s28, 4096
    v_mfma_f32_16x16x32_bf16 v[112:115], a[60:63], v[36:39], v[112:115]
    v_mfma_f32_16x16x32_bf16 v[116:119], a[60:63], v[40:43], v[116:119]
    v_mfma_f32_16x16x32_bf16 v[120:123], a[60:63], v[44:47], v[120:123]
    v_mfma_f32_16x16x32_bf16 v[124:127], a[60:63], v[48:51], v[124:127]
    v_mfma_f32_16x16x32_bf16 v[128:131], a[60:63], v[52:55], v[128:131]
    s_waitcnt lgkmcnt(0)
    v_mfma_f32_16x16x32_bf16 v[56:59], a[64:67], v[20:23], v[56:59]
    ds_read_b128 v[36:39], v253 offset:25600
    v_mfma_f32_16x16x32_bf16 v[60:63], a[64:67], v[24:27], v[60:63]
    ds_read_b128 v[40:43], v253 offset:26624
    v_mfma_f32_16x16x32_bf16 v[64:67], a[64:67], v[28:31], v[64:67]
    ds_read_b128 v[44:47], v253 offset:27648
    v_mfma_f32_16x16x32_bf16 v[68:71], a[64:67], v[32:35], v[68:71]
    ds_read_b128 v[48:51], v253 offset:28672
    v_mfma_f32_16x16x32_bf16 v[72:75], a[68:71], v[16:19], v[72:75]
    ds_read_b128 v[52:55], v253 offset:29696
    v_mfma_f32_16x16x32_bf16 v[76:79], a[68:71], v[20:23], v[76:79]
    buffer_load_dwordx4 a[32:35], v253, s[8:11], s28 offen offset:0 sc1
    v_mfma_f32_16x16x32_bf16 v[80:83], a[68:71], v[24:27], v[80:83]
    v_mfma_f32_16x16x32_bf16 v[84:87], a[68:71], v[28:31], v[84:87]
    buffer_load_dwordx4 a[36:39], v253, s[8:11], s28 offen offset:1024 sc1
    v_mfma_f32_16x16x32_bf16 v[88:91], a[68:71], v[32:35], v[88:91]
    v_mfma_f32_16x16x32_bf16 v[92:95], v[16:19], a[72:75], v[92:95]
    buffer_load_dwordx4 a[40:43], v253, s[8:11], s28 offen offset:2048 sc1
    v_mfma_f32_16x16x32_bf16 v[96:99], v[20:23], a[72:75], v[96:99]
    v_mfma_f32_16x16x32_bf16 v[100:103], v[24:27], a[72:75], v[100:103]
    v_mfma_f32_16x16x32_bf16 v[104:107], v[28:31], a[72:75], v[104:107]
    v_mfma_f32_16x16x32_bf16 v[108:111], v[32:35], a[72:75], v[108:111]
    v_mfma_f32_16x16x32_bf16 v[112:115], a[76:79], v[16:19], v[112:115]
    v_mfma_f32_16x16x32_bf16 v[116:119], a[76:79], v[20:23], v[116:119]
    v_mfma_f32_16x16x32_bf16 v[120:123], a[76:79], v[24:27], v[120:123]
    v_mfma_f32_16x16x32_bf16 v[124:127], a[76:79], v[28:31], v[124:127]
    v_mfma_f32_16x16x32_bf16 v[128:131], a[76:79], v[32:35], v[128:131]
    s_waitcnt vmcnt(6) lgkmcnt(0)
    s_barrier
    v_mfma_f32_16x16x32_bf16 v[56:59], a[80:83], v[40:43], v[56:59]
    ds_read_b128 v[16:19], v253 offset:30720
    v_mfma_f32_16x16x32_bf16 v[60:63], a[80:83], v[44:47], v[60:63]
    ds_read_b128 v[20:23], v253 offset:31744
    v_mfma_f32_16x16x32_bf16 v[64:67], a[80:83], v[48:51], v[64:67]
    ds_read_b128 v[24:27], v253 offset:32768
    v_mfma_f32_16x16x32_bf16 v[68:71], a[80:83], v[52:55], v[68:71]
    ds_read_b128 v[28:31], v253 offset:33792
    v_mfma_f32_16x16x32_bf16 v[72:75], a[84:87], v[36:39], v[72:75]
    ds_read_b128 v[32:35], v253 offset:34816
    v_mfma_f32_16x16x32_bf16 v[76:79], a[84:87], v[40:43], v[76:79]
    s_add_u32 m0, s25, 59392
    s_nop 0
    buffer_load_dwordx4 v2, s[8:11], s24 offen offset:2048 sc1 lds
    v_mfma_f32_16x16x32_bf16 v[80:83], a[84:87], v[44:47], v[80:83]
    v_mfma_f32_16x16x32_bf16 v[84:87], a[84:87], v[48:51], v[84:87]
    s_add_u32 m0, s25, 64000
    s_nop 0
    buffer_load_dwordx4 v2, s[8:11], s24 offen offset:2560 sc1 lds
    v_mfma_f32_16x16x32_bf16 v[88:91], a[84:87], v[52:55], v[88:91]
    v_mfma_f32_16x16x32_bf16 v[92:95], v[36:39], a[88:91], v[92:95]
    buffer_load_dwordx4 a[44:47], v229, s[8:11], s28 offen offset:3072 sc1
    s_add_u32 s28, s28, 4096
    v_mfma_f32_16x16x32_bf16 v[96:99], v[40:43], a[88:91], v[96:99]
    v_mfma_f32_16x16x32_bf16 v[100:103], v[44:47], a[88:91], v[100:103]
    buffer_load_dwordx4 a[48:51], v253, s[8:11], s28 offen offset:0 sc1
    v_mfma_f32_16x16x32_bf16 v[104:107], v[48:51], a[88:91], v[104:107]
    v_mfma_f32_16x16x32_bf16 v[108:111], v[52:55], a[88:91], v[108:111]
    buffer_load_dwordx4 a[52:55], v253, s[8:11], s28 offen offset:1024 sc1
    v_mfma_f32_16x16x32_bf16 v[112:115], a[92:95], v[36:39], v[112:115]
    v_mfma_f32_16x16x32_bf16 v[116:119], a[92:95], v[40:43], v[116:119]
    v_mfma_f32_16x16x32_bf16 v[120:123], a[92:95], v[44:47], v[120:123]
    v_mfma_f32_16x16x32_bf16 v[124:127], a[92:95], v[48:51], v[124:127]
    v_mfma_f32_16x16x32_bf16 v[128:131], a[92:95], v[52:55], v[128:131]
    s_waitcnt lgkmcnt(0)
    v_mfma_f32_16x16x32_bf16 v[56:59], a[96:99], v[20:23], v[56:59]
    ds_read_b128 v[36:39], v253 offset:35840
    v_mfma_f32_16x16x32_bf16 v[60:63], a[96:99], v[24:27], v[60:63]
    ds_read_b128 v[40:43], v253 offset:36864
    v_mfma_f32_16x16x32_bf16 v[64:67], a[96:99], v[28:31], v[64:67]
    ds_read_b128 v[44:47], v253 offset:37888
    v_mfma_f32_16x16x32_bf16 v[68:71], a[96:99], v[32:35], v[68:71]
    ds_read_b128 v[48:51], v253 offset:38912
    v_mfma_f32_16x16x32_bf16 v[72:75], a[100:103], v[16:19], v[72:75]
    ds_read_b128 v[52:55], v253 offset:39936
    v_mfma_f32_16x16x32_bf16 v[76:79], a[100:103], v[20:23], v[76:79]
    s_add_u32 m0, s25, 68608
    s_nop 0
    buffer_load_dwordx4 v2, s[8:11], s24 offen offset:3072 sc1 lds
    v_mfma_f32_16x16x32_bf16 v[80:83], a[100:103], v[24:27], v[80:83]
    v_mfma_f32_16x16x32_bf16 v[84:87], a[100:103], v[28:31], v[84:87]
    s_add_u32 m0, s25, 73216
    s_nop 0
    buffer_load_dwordx4 v2, s[8:11], s24 offen offset:3584 sc1 lds
    v_mfma_f32_16x16x32_bf16 v[88:91], a[100:103], v[32:35], v[88:91]
    v_mfma_f32_16x16x32_bf16 v[92:95], v[16:19], a[104:107], v[92:95]
    buffer_load_dwordx4 a[56:59], v253, s[8:11], s28 offen offset:2048 sc1
    v_mfma_f32_16x16x32_bf16 v[96:99], v[20:23], a[104:107], v[96:99]
    v_mfma_f32_16x16x32_bf16 v[100:103], v[24:27], a[104:107], v[100:103]
    buffer_load_dwordx4 a[60:63], v229, s[8:11], s28 offen offset:3072 sc1
    s_add_u32 s28, s28, 4096
    v_mfma_f32_16x16x32_bf16 v[104:107], v[28:31], a[104:107], v[104:107]
    v_mfma_f32_16x16x32_bf16 v[108:111], v[32:35], a[104:107], v[108:111]
    buffer_load_dwordx4 a[64:67], v253, s[8:11], s28 offen offset:0 sc1
    v_mfma_f32_16x16x32_bf16 v[112:115], a[108:111], v[16:19], v[112:115]
    v_mfma_f32_16x16x32_bf16 v[116:119], a[108:111], v[20:23], v[116:119]
    buffer_load_dwordx2 v[226:227], v228, s[8:11], s39 offen sc1
    v_mfma_f32_16x16x32_bf16 v[120:123], a[108:111], v[24:27], v[120:123]
    v_mfma_f32_16x16x32_bf16 v[124:127], a[108:111], v[28:31], v[124:127]
    v_mfma_f32_16x16x32_bf16 v[128:131], a[108:111], v[32:35], v[128:131]
    s_waitcnt lgkmcnt(0)
    v_mfma_f32_16x16x32_bf16 v[56:59], a[112:115], v[40:43], v[56:59]
    ds_read_b128 v[16:19], v253 offset:40960
    v_mfma_f32_16x16x32_bf16 v[60:63], a[112:115], v[44:47], v[60:63]
    ds_read_b128 v[20:23], v253 offset:41984
    v_mfma_f32_16x16x32_bf16 v[64:67], a[112:115], v[48:51], v[64:67]
    ds_read_b128 v[24:27], v253 offset:43008
    v_mfma_f32_16x16x32_bf16 v[68:71], a[112:115], v[52:55], v[68:71]
    ds_read_b128 v[28:31], v253 offset:44032
    v_mfma_f32_16x16x32_bf16 v[72:75], a[116:119], v[36:39], v[72:75]
    ds_read_b128 v[32:35], v253 offset:45056
    v_mfma_f32_16x16x32_bf16 v[76:79], a[116:119], v[40:43], v[76:79]
    s_add_u32 m0, s25, 81920
    s_add_u32 s24, s24, 4096
    buffer_load_dwordx4 v2, s[8:11], s24 offen offset:0 sc1 lds
    v_mfma_f32_16x16x32_bf16 v[80:83], a[116:119], v[44:47], v[80:83]
    v_mfma_f32_16x16x32_bf16 v[84:87], a[116:119], v[48:51], v[84:87]
    s_add_u32 m0, s25, 86528
    s_nop 0
    buffer_load_dwordx4 v2, s[8:11], s24 offen offset:512 sc1 lds
    v_mfma_f32_16x16x32_bf16 v[88:91], a[116:119], v[52:55], v[88:91]
    v_mfma_f32_16x16x32_bf16 v[92:95], v[36:39], a[120:123], v[92:95]
    buffer_load_dwordx4 a[68:71], v253, s[8:11], s28 offen offset:1024 sc1
    v_mfma_f32_16x16x32_bf16 v[96:99], v[40:43], a[120:123], v[96:99]
    v_mfma_f32_16x16x32_bf16 v[100:103], v[44:47], a[120:123], v[100:103]
    buffer_load_dwordx4 a[72:75], v253, s[8:11], s28 offen offset:2048 sc1
    v_mfma_f32_16x16x32_bf16 v[104:107], v[48:51], a[120:123], v[104:107]
    v_mfma_f32_16x16x32_bf16 v[108:111], v[52:55], a[120:123], v[108:111]
    buffer_load_dwordx4 a[76:79], v229, s[8:11], s28 offen offset:3072 sc1
    s_add_u32 s28, s28, 4096
    v_mfma_f32_16x16x32_bf16 v[112:115], a[124:127], v[36:39], v[112:115]
    v_mfma_f32_16x16x32_bf16 v[116:119], a[124:127], v[40:43], v[116:119]
    v_mfma_f32_16x16x32_bf16 v[120:123], a[124:127], v[44:47], v[120:123]
    v_mfma_f32_16x16x32_bf16 v[124:127], a[124:127], v[48:51], v[124:127]
    v_mfma_f32_16x16x32_bf16 v[128:131], a[124:127], v[52:55], v[128:131]
    s_waitcnt lgkmcnt(0)
    v_mfma_f32_16x16x32_bf16 v[56:59], a[128:131], v[20:23], v[56:59]
    ds_read_b128 v[36:39], v6 offset:0
    v_mfma_f32_16x16x32_bf16 v[60:63], a[128:131], v[24:27], v[60:63]
    ds_read_b128 v[40:43], v6 offset:1024
    v_mfma_f32_16x16x32_bf16 v[64:67], a[128:131], v[28:31], v[64:67]
    ds_read_b128 v[44:47], v6 offset:2048
    v_mfma_f32_16x16x32_bf16 v[68:71], a[128:131], v[32:35], v[68:71]
    ds_read_b128 v[48:51], v6 offset:3072
    v_mfma_f32_16x16x32_bf16 v[72:75], a[132:135], v[16:19], v[72:75]
    ds_read_b128 v[52:55], v6 offset:4096
    v_mfma_f32_16x16x32_bf16 v[76:79], a[132:135], v[20:23], v[76:79]
    s_add_u32 m0, s26, 61440
    s_add_u32 s7, s27, 6144
    buffer_load_dwordx4 v2, s[8:11], s7 offen sc1 lds
    v_mfma_f32_16x16x32_bf16 v[80:83], a[132:135], v[24:27], v[80:83]
    v_mfma_f32_16x16x32_bf16 v[84:87], a[132:135], v[28:31], v[84:87]
    s_add_u32 m0, s29, 61440
    s_add_u32 s7, s23, 6144
    buffer_load_dwordx4 v2, s[8:11], s7 offen sc1 lds
    v_mfma_f32_16x16x32_bf16 v[88:91], a[132:135], v[32:35], v[88:91]
    v_mfma_f32_16x16x32_bf16 v[92:95], v[16:19], a[136:139], v[92:95]
    buffer_load_dwordx4 a[80:83], v253, s[8:11], s28 offen offset:0 sc1
    v_mfma_f32_16x16x32_bf16 v[96:99], v[20:23], a[136:139], v[96:99]
    v_mfma_f32_16x16x32_bf16 v[100:103], v[24:27], a[136:139], v[100:103]
    buffer_load_dwordx4 a[84:87], v253, s[8:11], s28 offen offset:1024 sc1
    v_mfma_f32_16x16x32_bf16 v[104:107], v[28:31], a[136:139], v[104:107]
    v_mfma_f32_16x16x32_bf16 v[108:111], v[32:35], a[136:139], v[108:111]
    buffer_load_dwordx4 a[88:91], v253, s[8:11], s28 offen offset:2048 sc1
    v_mfma_f32_16x16x32_bf16 v[112:115], a[140:143], v[16:19], v[112:115]
    v_mfma_f32_16x16x32_bf16 v[116:119], a[140:143], v[20:23], v[116:119]
    v_mfma_f32_16x16x32_bf16 v[120:123], a[140:143], v[24:27], v[120:123]
    v_mfma_f32_16x16x32_bf16 v[124:127], a[140:143], v[28:31], v[124:127]
    v_mfma_f32_16x16x32_bf16 v[128:131], a[140:143], v[32:35], v[128:131]
    s_waitcnt vmcnt(10) lgkmcnt(0)
    s_mov_b32 s6, 0
L_wo_poll_15:
    v_cmp_eq_u32 vcc, s76, v226
    v_cmp_eq_u32 s[20:21], s76, v227
    s_and_b64 vcc, vcc, s[20:21]
    s_cmp_eq_u64 vcc, exec
    s_cbranch_scc1 L_wo_ready_16
    buffer_load_dwordx2 v[226:227], v228, s[8:11], s39 offen sc1
    s_add_u32 s6, s6, 1
    s_cmp_lt_u32 s6, 1048576
    s_waitcnt vmcnt(0)
    s_cbranch_scc1 L_wo_poll_15
    s_branch L_main_end
L_wo_ready_16:
    v_mfma_f32_16x16x32_bf16 v[56:59], a[144:147], v[40:43], v[56:59]
    ds_read_b128 v[16:19], v6 offset:5120
    v_mfma_f32_16x16x32_bf16 v[60:63], a[144:147], v[44:47], v[60:63]
    ds_read_b128 v[20:23], v6 offset:6144
    v_mfma_f32_16x16x32_bf16 v[64:67], a[144:147], v[48:51], v[64:67]
    ds_read_b128 v[24:27], v6 offset:7168
    v_mfma_f32_16x16x32_bf16 v[68:71], a[144:147], v[52:55], v[68:71]
    ds_read_b128 v[28:31], v6 offset:8192
    v_mfma_f32_16x16x32_bf16 v[72:75], a[148:151], v[36:39], v[72:75]
    ds_read_b128 v[32:35], v6 offset:9216
    v_mfma_f32_16x16x32_bf16 v[76:79], a[148:151], v[40:43], v[76:79]
    buffer_load_dwordx4 a[92:95], v229, s[8:11], s28 offen offset:3072 sc1
    s_add_u32 s28, s28, 4096
    v_mfma_f32_16x16x32_bf16 v[80:83], a[148:151], v[44:47], v[80:83]
    v_mfma_f32_16x16x32_bf16 v[84:87], a[148:151], v[48:51], v[84:87]
    buffer_load_dwordx4 a[96:99], v253, s[8:11], s28 offen offset:0 sc1
    v_mfma_f32_16x16x32_bf16 v[88:91], a[148:151], v[52:55], v[88:91]
    v_mfma_f32_16x16x32_bf16 v[92:95], v[36:39], a[152:155], v[92:95]
    buffer_load_dwordx4 a[100:103], v253, s[8:11], s28 offen offset:1024 sc1
    v_mfma_f32_16x16x32_bf16 v[96:99], v[40:43], a[152:155], v[96:99]
    v_mfma_f32_16x16x32_bf16 v[100:103], v[44:47], a[152:155], v[100:103]
    buffer_load_dwordx4 a[160:163], v253, s[8:11], s32 offen offset:0 sc1
    v_mfma_f32_16x16x32_bf16 v[104:107], v[48:51], a[152:155], v[104:107]
    v_mfma_f32_16x16x32_bf16 v[108:111], v[52:55], a[152:155], v[108:111]
    v_mfma_f32_16x16x32_bf16 v[112:115], a[156:159], v[36:39], v[112:115]
    v_mfma_f32_16x16x32_bf16 v[116:119], a[156:159], v[40:43], v[116:119]
    v_mfma_f32_16x16x32_bf16 v[120:123], a[156:159], v[44:47], v[120:123]
    v_mfma_f32_16x16x32_bf16 v[124:127], a[156:159], v[48:51], v[124:127]
    v_mfma_f32_16x16x32_bf16 v[128:131], a[156:159], v[52:55], v[128:131]
    s_waitcnt vmcnt(34) lgkmcnt(0)
    v_mfma_f32_16x16x32_bf16 v[56:59], a[0:3], v[20:23], v[56:59]
    ds_read_b128 v[36:39], v6 offset:10240
    v_mfma_f32_16x16x32_bf16 v[60:63], a[0:3], v[24:27], v[60:63]
    ds_read_b128 v[40:43], v6 offset:11264
    v_mfma_f32_16x16x32_bf16 v[64:67], a[0:3], v[28:31], v[64:67]
    ds_read_b128 v[44:47], v6 offset:12288
    v_mfma_f32_16x16x32_bf16 v[68:71], a[0:3], v[32:35], v[68:71]
    ds_read_b128 v[48:51], v6 offset:13312
    v_mfma_f32_16x16x32_bf16 v[72:75], a[4:7], v[16:19], v[72:75]
    ds_read_b128 v[52:55], v6 offset:14336
    v_mfma_f32_16x16x32_bf16 v[76:79], a[4:7], v[20:23], v[76:79]
    buffer_load_dwordx4 a[104:107], v253, s[8:11], s28 offen offset:2048 sc1
    v_mfma_f32_16x16x32_bf16 v[80:83], a[4:7], v[24:27], v[80:83]
    v_mfma_f32_16x16x32_bf16 v[84:87], a[4:7], v[28:31], v[84:87]
    buffer_load_dwordx4 a[108:111], v229, s[8:11], s28 offen offset:3072 sc1
    s_add_u32 s28, s28, 4096
    v_mfma_f32_16x16x32_bf16 v[88:91], a[4:7], v[32:35], v[88:91]
    v_mfma_f32_16x16x32_bf16 v[92:95], v[16:19], a[8:11], v[92:95]
    buffer_load_dwordx4 a[112:115], v253, s[8:11], s28 offen offset:0 sc1
    v_mfma_f32_16x16x32_bf16 v[96:99], v[20:23], a[8:11], v[96:99]
    v_mfma_f32_16x16x32_bf16 v[100:103], v[24:27], a[8:11], v[100:103]
    buffer_load_dwordx4 a[164:167], v253, s[8:11], s33 offen offset:0 sc1
    v_mfma_f32_16x16x32_bf16 v[104:107], v[28:31], a[8:11], v[104:107]
    v_mfma_f32_16x16x32_bf16 v[108:111], v[32:35], a[8:11], v[108:111]
    v_mfma_f32_16x16x32_bf16 v[112:115], a[12:15], v[16:19], v[112:115]
    v_mfma_f32_16x16x32_bf16 v[116:119], a[12:15], v[20:23], v[116:119]
    v_mfma_f32_16x16x32_bf16 v[120:123], a[12:15], v[24:27], v[120:123]
    v_mfma_f32_16x16x32_bf16 v[124:127], a[12:15], v[28:31], v[124:127]
    v_mfma_f32_16x16x32_bf16 v[128:131], a[12:15], v[32:35], v[128:131]
    s_waitcnt vmcnt(11) lgkmcnt(0)
    s_barrier
    v_mfma_f32_16x16x32_bf16 v[56:59], a[16:19], v[40:43], v[56:59]
    ds_read_b128 v[16:19], v6 offset:15360
    v_mfma_f32_16x16x32_bf16 v[60:63], a[16:19], v[44:47], v[60:63]
    ds_read_b128 v[20:23], v6 offset:16384
    v_mfma_f32_16x16x32_bf16 v[64:67], a[16:19], v[48:51], v[64:67]
    ds_read_b128 v[24:27], v6 offset:17408
    v_mfma_f32_16x16x32_bf16 v[68:71], a[16:19], v[52:55], v[68:71]
    ds_read_b128 v[28:31], v6 offset:18432
    v_mfma_f32_16x16x32_bf16 v[72:75], a[20:23], v[36:39], v[72:75]
    ds_read_b128 v[32:35], v6 offset:19456
    v_mfma_f32_16x16x32_bf16 v[76:79], a[20:23], v[40:43], v[76:79]
    buffer_load_dwordx4 a[116:119], v253, s[8:11], s28 offen offset:1024 sc1
    v_mfma_f32_16x16x32_bf16 v[80:83], a[20:23], v[44:47], v[80:83]
    v_mfma_f32_16x16x32_bf16 v[84:87], a[20:23], v[48:51], v[84:87]
    buffer_load_dwordx4 a[120:123], v253, s[8:11], s28 offen offset:2048 sc1
    v_mfma_f32_16x16x32_bf16 v[88:91], a[20:23], v[52:55], v[88:91]
    v_mfma_f32_16x16x32_bf16 v[92:95], v[36:39], a[24:27], v[92:95]
    buffer_load_dwordx4 a[124:127], v229, s[8:11], s28 offen offset:3072 sc1
    s_add_u32 s28, s28, 4096
    v_mfma_f32_16x16x32_bf16 v[96:99], v[40:43], a[24:27], v[96:99]
    v_mfma_f32_16x16x32_bf16 v[100:103], v[44:47], a[24:27], v[100:103]
    buffer_load_dwordx4 a[168:171], v5, s[8:11], s34 offen offset:0 sc1
    v_mfma_f32_16x16x32_bf16 v[104:107], v[48:51], a[24:27], v[104:107]
    v_mfma_f32_16x16x32_bf16 v[108:111], v[52:55], a[24:27], v[108:111]
    v_mfma_f32_16x16x32_bf16 v[112:115], a[28:31], v[36:39], v[112:115]
    v_mfma_f32_16x16x32_bf16 v[116:119], a[28:31], v[40:43], v[116:119]
    v_mfma_f32_16x16x32_bf16 v[120:123], a[28:31], v[44:47], v[120:123]
    v_mfma_f32_16x16x32_bf16 v[124:127], a[28:31], v[48:51], v[124:127]
    v_mfma_f32_16x16x32_bf16 v[128:131], a[28:31], v[52:55], v[128:131]
    s_waitcnt vmcnt(30) lgkmcnt(0)
    v_mfma_f32_16x16x32_bf16 v[56:59], a[32:35], v[20:23], v[56:59]
    ds_read_b128 v[36:39], v6 offset:20480
    v_mfma_f32_16x16x32_bf16 v[60:63], a[32:35], v[24:27], v[60:63]
    ds_read_b128 v[40:43], v6 offset:21504
    v_mfma_f32_16x16x32_bf16 v[64:67], a[32:35], v[28:31], v[64:67]
    ds_read_b128 v[44:47], v6 offset:22528
    v_mfma_f32_16x16x32_bf16 v[68:71], a[32:35], v[32:35], v[68:71]
    ds_read_b128 v[48:51], v6 offset:23552
    v_mfma_f32_16x16x32_bf16 v[72:75], a[36:39], v[16:19], v[72:75]
    ds_read_b128 v[52:55], v6 offset:24576
    v_mfma_f32_16x16x32_bf16 v[76:79], a[36:39], v[20:23], v[76:79]
    buffer_load_dwordx4 a[172:175], v253, s[8:11], s32 offen offset:1024 sc1
    v_mfma_f32_16x16x32_bf16 v[80:83], a[36:39], v[24:27], v[80:83]
    v_mfma_f32_16x16x32_bf16 v[84:87], a[36:39], v[28:31], v[84:87]
    buffer_load_dwordx4 a[176:179], v253, s[8:11], s33 offen offset:1024 sc1
    v_mfma_f32_16x16x32_bf16 v[88:91], a[36:39], v[32:35], v[88:91]
    v_mfma_f32_16x16x32_bf16 v[92:95], v[16:19], a[40:43], v[92:95]
    buffer_load_dwordx4 a[180:183], v5, s[8:11], s34 offen offset:1024 sc1
    v_mfma_f32_16x16x32_bf16 v[96:99], v[20:23], a[40:43], v[96:99]
    v_mfma_f32_16x16x32_bf16 v[100:103], v[24:27], a[40:43], v[100:103]
    buffer_load_dwordx4 a[184:187], v253, s[8:11], s32 offen offset:2048 sc1
    v_mfma_f32_16x16x32_bf16 v[104:107], v[28:31], a[40:43], v[104:107]
    v_mfma_f32_16x16x32_bf16 v[108:111], v[32:35], a[40:43], v[108:111]
    v_mfma_f32_16x16x32_bf16 v[112:115], a[44:47], v[16:19], v[112:115]
    v_mfma_f32_16x16x32_bf16 v[116:119], a[44:47], v[20:23], v[116:119]
    v_mfma_f32_16x16x32_bf16 v[120:123], a[44:47], v[24:27], v[120:123]
    v_mfma_f32_16x16x32_bf16 v[124:127], a[44:47], v[28:31], v[124:127]
    v_mfma_f32_16x16x32_bf16 v[128:131], a[44:47], v[32:35], v[128:131]
    s_waitcnt vmcnt(28) lgkmcnt(0)
    v_mfma_f32_16x16x32_bf16 v[56:59], a[48:51], v[40:43], v[56:59]
    ds_read_b128 v[16:19], v6 offset:25600
    v_mfma_f32_16x16x32_bf16 v[60:63], a[48:51], v[44:47], v[60:63]
    ds_read_b128 v[20:23], v6 offset:26624
    v_mfma_f32_16x16x32_bf16 v[64:67], a[48:51], v[48:51], v[64:67]
    ds_read_b128 v[24:27], v6 offset:27648
    v_mfma_f32_16x16x32_bf16 v[68:71], a[48:51], v[52:55], v[68:71]
    ds_read_b128 v[28:31], v6 offset:28672
    v_mfma_f32_16x16x32_bf16 v[72:75], a[52:55], v[36:39], v[72:75]
    ds_read_b128 v[32:35], v6 offset:29696
    v_mfma_f32_16x16x32_bf16 v[76:79], a[52:55], v[40:43], v[76:79]
    buffer_load_dwordx4 a[188:191], v253, s[8:11], s33 offen offset:2048 sc1
    v_mfma_f32_16x16x32_bf16 v[80:83], a[52:55], v[44:47], v[80:83]
    v_mfma_f32_16x16x32_bf16 v[84:87], a[52:55], v[48:51], v[84:87]
    buffer_load_dwordx4 a[192:195], v5, s[8:11], s34 offen offset:2048 sc1
    v_mfma_f32_16x16x32_bf16 v[88:91], a[52:55], v[52:55], v[88:91]
    v_mfma_f32_16x16x32_bf16 v[92:95], v[36:39], a[56:59], v[92:95]
    buffer_load_dwordx4 a[196:199], v253, s[8:11], s32 offen offset:3072 sc1
    s_add_u32 s32, s32, 4096
    v_mfma_f32_16x16x32_bf16 v[96:99], v[40:43], a[56:59], v[96:99]
    v_mfma_f32_16x16x32_bf16 v[100:103], v[44:47], a[56:59], v[100:103]
    buffer_load_dwordx4 a[200:203], v253, s[8:11], s33 offen offset:3072 sc1
    s_add_u32 s33, s33, 4096
    v_mfma_f32_16x16x32_bf16 v[104:107], v[48:51], a[56:59], v[104:107]
    v_mfma_f32_16x16x32_bf16 v[108:111], v[52:55], a[56:59], v[108:111]
    v_mfma_f32_16x16x32_bf16 v[112:115], a[60:63], v[36:39], v[112:115]
    v_mfma_f32_16x16x32_bf16 v[116:119], a[60:63], v[40:43], v[116:119]
    v_mfma_f32_16x16x32_bf16 v[120:123], a[60:63], v[44:47], v[120:123]
    v_mfma_f32_16x16x32_bf16 v[124:127], a[60:63], v[48:51], v[124:127]
    v_mfma_f32_16x16x32_bf16 v[128:131], a[60:63], v[52:55], v[128:131]
    s_waitcnt vmcnt(25) lgkmcnt(0)
    v_mfma_f32_16x16x32_bf16 v[56:59], a[64:67], v[20:23], v[56:59]
    ds_read_b128 v[36:39], v6 offset:30720
    v_mfma_f32_16x16x32_bf16 v[60:63], a[64:67], v[24:27], v[60:63]
    ds_read_b128 v[40:43], v6 offset:31744
    v_mfma_f32_16x16x32_bf16 v[64:67], a[64:67], v[28:31], v[64:67]
    ds_read_b128 v[44:47], v6 offset:32768
    v_mfma_f32_16x16x32_bf16 v[68:71], a[64:67], v[32:35], v[68:71]
    ds_read_b128 v[48:51], v6 offset:33792
    v_mfma_f32_16x16x32_bf16 v[72:75], a[68:71], v[16:19], v[72:75]
    ds_read_b128 v[52:55], v6 offset:34816
    v_mfma_f32_16x16x32_bf16 v[76:79], a[68:71], v[20:23], v[76:79]
    buffer_load_dwordx4 a[204:207], v5, s[8:11], s34 offen offset:3072 sc1
    s_add_u32 s34, s34, 4096
    v_mfma_f32_16x16x32_bf16 v[80:83], a[68:71], v[24:27], v[80:83]
    v_mfma_f32_16x16x32_bf16 v[84:87], a[68:71], v[28:31], v[84:87]
    buffer_load_dwordx4 a[208:211], v253, s[8:11], s32 offen offset:0 sc1
    v_mfma_f32_16x16x32_bf16 v[88:91], a[68:71], v[32:35], v[88:91]
    v_mfma_f32_16x16x32_bf16 v[92:95], v[16:19], a[72:75], v[92:95]
    buffer_load_dwordx4 a[212:215], v253, s[8:11], s33 offen offset:0 sc1
    v_mfma_f32_16x16x32_bf16 v[96:99], v[20:23], a[72:75], v[96:99]
    v_mfma_f32_16x16x32_bf16 v[100:103], v[24:27], a[72:75], v[100:103]
    buffer_load_dwordx4 a[216:219], v5, s[8:11], s34 offen offset:0 sc1
    v_mfma_f32_16x16x32_bf16 v[104:107], v[28:31], a[72:75], v[104:107]
    v_mfma_f32_16x16x32_bf16 v[108:111], v[32:35], a[72:75], v[108:111]
    v_mfma_f32_16x16x32_bf16 v[112:115], a[76:79], v[16:19], v[112:115]
    v_mfma_f32_16x16x32_bf16 v[116:119], a[76:79], v[20:23], v[116:119]
    v_mfma_f32_16x16x32_bf16 v[120:123], a[76:79], v[24:27], v[120:123]
    v_mfma_f32_16x16x32_bf16 v[124:127], a[76:79], v[28:31], v[124:127]
    v_mfma_f32_16x16x32_bf16 v[128:131], a[76:79], v[32:35], v[128:131]
    s_waitcnt vmcnt(23) lgkmcnt(0)
    v_mfma_f32_16x16x32_bf16 v[56:59], a[80:83], v[40:43], v[56:59]
    ds_read_b128 v[16:19], v6 offset:35840
    v_mfma_f32_16x16x32_bf16 v[60:63], a[80:83], v[44:47], v[60:63]
    ds_read_b128 v[20:23], v6 offset:36864
    v_mfma_f32_16x16x32_bf16 v[64:67], a[80:83], v[48:51], v[64:67]
    ds_read_b128 v[24:27], v6 offset:37888
    v_mfma_f32_16x16x32_bf16 v[68:71], a[80:83], v[52:55], v[68:71]
    ds_read_b128 v[28:31], v6 offset:38912
    v_mfma_f32_16x16x32_bf16 v[72:75], a[84:87], v[36:39], v[72:75]
    ds_read_b128 v[32:35], v6 offset:39936
    v_mfma_f32_16x16x32_bf16 v[76:79], a[84:87], v[40:43], v[76:79]
    buffer_load_dwordx4 a[220:223], v253, s[8:11], s32 offen offset:1024 sc1
    v_mfma_f32_16x16x32_bf16 v[80:83], a[84:87], v[44:47], v[80:83]
    v_mfma_f32_16x16x32_bf16 v[84:87], a[84:87], v[48:51], v[84:87]
    buffer_load_dwordx4 a[224:227], v253, s[8:11], s33 offen offset:1024 sc1
    v_mfma_f32_16x16x32_bf16 v[88:91], a[84:87], v[52:55], v[88:91]
    v_mfma_f32_16x16x32_bf16 v[92:95], v[36:39], a[88:91], v[92:95]
    buffer_load_dwordx4 a[228:231], v5, s[8:11], s34 offen offset:1024 sc1
    v_mfma_f32_16x16x32_bf16 v[96:99], v[40:43], a[88:91], v[96:99]
    v_mfma_f32_16x16x32_bf16 v[100:103], v[44:47], a[88:91], v[100:103]
    buffer_load_dwordx4 a[232:235], v253, s[8:11], s32 offen offset:2048 sc1
    v_mfma_f32_16x16x32_bf16 v[104:107], v[48:51], a[88:91], v[104:107]
    v_mfma_f32_16x16x32_bf16 v[108:111], v[52:55], a[88:91], v[108:111]
    v_mfma_f32_16x16x32_bf16 v[112:115], a[92:95], v[36:39], v[112:115]
    v_mfma_f32_16x16x32_bf16 v[116:119], a[92:95], v[40:43], v[116:119]
    v_mfma_f32_16x16x32_bf16 v[120:123], a[92:95], v[44:47], v[120:123]
    v_mfma_f32_16x16x32_bf16 v[124:127], a[92:95], v[48:51], v[124:127]
    v_mfma_f32_16x16x32_bf16 v[128:131], a[92:95], v[52:55], v[128:131]
    s_waitcnt vmcnt(22) lgkmcnt(0)
    v_mfma_f32_16x16x32_bf16 v[56:59], a[96:99], v[20:23], v[56:59]
    ds_read_b128 v[36:39], v6 offset:40960
    v_mfma_f32_16x16x32_bf16 v[60:63], a[96:99], v[24:27], v[60:63]
    ds_read_b128 v[40:43], v6 offset:41984
    v_mfma_f32_16x16x32_bf16 v[64:67], a[96:99], v[28:31], v[64:67]
    ds_read_b128 v[44:47], v6 offset:43008
    v_mfma_f32_16x16x32_bf16 v[68:71], a[96:99], v[32:35], v[68:71]
    ds_read_b128 v[48:51], v6 offset:44032
    v_mfma_f32_16x16x32_bf16 v[72:75], a[100:103], v[16:19], v[72:75]
    ds_read_b128 v[52:55], v6 offset:45056
    v_mfma_f32_16x16x32_bf16 v[76:79], a[100:103], v[20:23], v[76:79]
    buffer_load_dwordx4 a[236:239], v253, s[8:11], s33 offen offset:2048 sc1
    v_mfma_f32_16x16x32_bf16 v[80:83], a[100:103], v[24:27], v[80:83]
    v_mfma_f32_16x16x32_bf16 v[84:87], a[100:103], v[28:31], v[84:87]
    buffer_load_dwordx4 a[240:243], v5, s[8:11], s34 offen offset:2048 sc1
    v_mfma_f32_16x16x32_bf16 v[88:91], a[100:103], v[32:35], v[88:91]
    v_mfma_f32_16x16x32_bf16 v[92:95], v[16:19], a[104:107], v[92:95]
    buffer_load_dwordx4 a[244:247], v253, s[8:11], s32 offen offset:3072 sc1
    s_add_u32 s32, s32, 4096
    v_mfma_f32_16x16x32_bf16 v[96:99], v[20:23], a[104:107], v[96:99]
    v_mfma_f32_16x16x32_bf16 v[100:103], v[24:27], a[104:107], v[100:103]
    buffer_load_dwordx4 a[248:251], v253, s[8:11], s33 offen offset:3072 sc1
    s_add_u32 s33, s33, 4096
    v_mfma_f32_16x16x32_bf16 v[104:107], v[28:31], a[104:107], v[104:107]
    v_mfma_f32_16x16x32_bf16 v[108:111], v[32:35], a[104:107], v[108:111]
    v_mfma_f32_16x16x32_bf16 v[112:115], a[108:111], v[16:19], v[112:115]
    v_mfma_f32_16x16x32_bf16 v[116:119], a[108:111], v[20:23], v[116:119]
    v_mfma_f32_16x16x32_bf16 v[120:123], a[108:111], v[24:27], v[120:123]
    v_mfma_f32_16x16x32_bf16 v[124:127], a[108:111], v[28:31], v[124:127]
    v_mfma_f32_16x16x32_bf16 v[128:131], a[108:111], v[32:35], v[128:131]
    s_waitcnt vmcnt(21) lgkmcnt(0)
    v_mfma_f32_16x16x32_bf16 v[56:59], a[112:115], v[40:43], v[56:59]
    v_mfma_f32_16x16x32_bf16 v[60:63], a[112:115], v[44:47], v[60:63]
    v_mfma_f32_16x16x32_bf16 v[64:67], a[112:115], v[48:51], v[64:67]
    v_mfma_f32_16x16x32_bf16 v[68:71], a[112:115], v[52:55], v[68:71]
    v_mfma_f32_16x16x32_bf16 v[72:75], a[116:119], v[36:39], v[72:75]
    v_mfma_f32_16x16x32_bf16 v[76:79], a[116:119], v[40:43], v[76:79]
    buffer_load_dwordx4 a[252:255], v5, s[8:11], s34 offen offset:3072 sc1
    s_add_u32 s34, s34, 4096
    v_mfma_f32_16x16x32_bf16 v[80:83], a[116:119], v[44:47], v[80:83]
    v_mfma_f32_16x16x32_bf16 v[84:87], a[116:119], v[48:51], v[84:87]
    buffer_load_dwordx4 a[128:131], v253, s[8:11], s32 offen offset:0 sc1
    v_mfma_f32_16x16x32_bf16 v[88:91], a[116:119], v[52:55], v[88:91]
    v_mfma_f32_16x16x32_bf16 v[92:95], v[36:39], a[120:123], v[92:95]
    buffer_load_dwordx4 a[132:135], v253, s[8:11], s33 offen offset:0 sc1
    v_mfma_f32_16x16x32_bf16 v[96:99], v[40:43], a[120:123], v[96:99]
    v_mfma_f32_16x16x32_bf16 v[100:103], v[44:47], a[120:123], v[100:103]
    buffer_load_dwordx4 a[136:139], v5, s[8:11], s34 offen offset:0 sc1
    v_mfma_f32_16x16x32_bf16 v[104:107], v[48:51], a[120:123], v[104:107]
    v_mfma_f32_16x16x32_bf16 v[108:111], v[52:55], a[120:123], v[108:111]
    v_mfma_f32_16x16x32_bf16 v[112:115], a[124:127], v[36:39], v[112:115]
    v_mfma_f32_16x16x32_bf16 v[116:119], a[124:127], v[40:43], v[116:119]
    v_mfma_f32_16x16x32_bf16 v[120:123], a[124:127], v[44:47], v[120:123]
    v_mfma_f32_16x16x32_bf16 v[124:127], a[124:127], v[48:51], v[124:127]
    v_mfma_f32_16x16x32_bf16 v[128:131], a[124:127], v[52:55], v[128:131]
    v_cvt_pk_bf16_f32 v136, v56, v57
    v_cvt_pk_bf16_f32 v137, v58, v59
    v_cvt_pk_bf16_f32 v140, v60, v61
    v_cvt_pk_bf16_f32 v141, v62, v63
    v_cvt_pk_bf16_f32 v144, v64, v65
    v_cvt_pk_bf16_f32 v145, v66, v67
    v_cvt_pk_bf16_f32 v148, v68, v69
    v_cvt_pk_bf16_f32 v149, v70, v71
    v_cvt_pk_bf16_f32 v152, v72, v73
    buffer_load_dwordx4 a[140:143], v253, s[8:11], s32 offen offset:1024 sc1
    v_cvt_pk_bf16_f32 v153, v74, v75
    v_cvt_pk_bf16_f32 v156, v76, v77
    v_cvt_pk_bf16_f32 v157, v78, v79
    v_cvt_pk_bf16_f32 v160, v80, v81
    v_cvt_pk_bf16_f32 v161, v82, v83
    v_cvt_pk_bf16_f32 v164, v84, v85
    v_cvt_pk_bf16_f32 v165, v86, v87
    v_cvt_pk_bf16_f32 v168, v88, v89
    v_cvt_pk_bf16_f32 v169, v90, v91
    buffer_load_dwordx4 a[144:147], v253, s[8:11], s33 offen offset:1024 sc1
    v_cvt_pk_bf16_f32 v134, v112, v113
    v_cvt_pk_bf16_f32 v154, v114, v115
    v_cvt_pk_bf16_f32 v138, v116, v117
    v_cvt_pk_bf16_f32 v158, v118, v119
    v_cvt_pk_bf16_f32 v142, v120, v121
    v_cvt_pk_bf16_f32 v162, v122, v123
    v_cvt_pk_bf16_f32 v146, v124, v125
    v_cvt_pk_bf16_f32 v166, v126, v127
    v_cvt_pk_bf16_f32 v150, v128, v129
    buffer_load_dwordx4 a[148:151], v5, s[8:11], s34 offen offset:1024 sc1
    v_cvt_pk_bf16_f32 v170, v130, v131
    v_cvt_pk_bf16_f32 v172, v92, v93
    v_cvt_pk_bf16_f32 v173, v94, v95
    v_cvt_pk_bf16_f32 v174, v96, v97
    v_cvt_pk_bf16_f32 v175, v98, v99
    v_cvt_pk_bf16_f32 v176, v100, v101
    v_cvt_pk_bf16_f32 v177, v102, v103
    v_cvt_pk_bf16_f32 v178, v104, v105
    v_cvt_pk_bf16_f32 v179, v106, v107
    buffer_load_dwordx4 a[152:155], v253, s[8:11], s32 offen offset:2048 sc1
    v_cvt_pk_bf16_f32 v180, v108, v109
    v_cvt_pk_bf16_f32 v181, v110, v111
    v_mfma_f32_16x16x32_bf16 v[16:19], v[152:155], v[136:139], v[208:211]
    v_mfma_f32_16x16x32_bf16 v[20:23], v[156:159], v[136:139], v[204:207]
    v_mfma_f32_16x16x32_bf16 v[24:27], v[156:159], v[140:143], v[200:203]
    v_mfma_f32_16x16x32_bf16 v[28:31], v[160:163], v[140:143], v[204:207]
    v_mfma_f32_16x16x32_bf16 v[32:35], v[160:163], v[144:147], v[200:203]
    v_mfma_f32_16x16x32_bf16 v[36:39], v[164:167], v[144:147], v[204:207]
    v_mfma_f32_16x16x32_bf16 v[40:43], v[164:167], v[148:151], v[200:203]
    buffer_load_dwordx4 a[156:159], v253, s[8:11], s33 offen offset:2048 sc1
    v_mfma_f32_16x16x32_bf16 v[44:47], v[168:171], v[148:151], v[204:207]
    v_mfma_f32_16x16x32_bf16 v[56:59], v[132:135], v[192:195], v[196:199]
    v_mfma_f32_16x16x32_bf16 v[60:63], v[136:139], v[192:195], v[196:199]
    v_mfma_f32_16x16x32_bf16 v[64:67], v[140:143], v[192:195], v[196:199]
    v_mfma_f32_16x16x32_bf16 v[68:71], v[144:147], v[192:195], v[196:199]
    v_mfma_f32_16x16x32_bf16 v[72:75], v[148:151], v[192:195], v[196:199]
    v_max3_f32 v92, v16, v17, v18
    v_max3_f32 v96, v19, v20, v21
    v_max3_f32 v93, v24, v25, v26
    buffer_load_dwordx4 a[0:3], v5, s[8:11], s34 offen offset:2048 sc1
    v_max3_f32 v97, v27, v28, v29
    v_max3_f32 v94, v32, v33, v34
    v_max3_f32 v98, v35, v36, v37
    v_max3_f32 v95, v40, v41, v42
    v_max3_f32 v99, v43, v44, v45
    v_max3_f32 v92, v92, v22, v23
    v_max3_f32 v93, v93, v30, v31
    v_max3_f32 v94, v94, v38, v39
    v_max3_f32 v95, v95, v46, v47
    buffer_load_dwordx4 a[4:7], v253, s[8:11], s32 offen offset:3072 sc1
    s_add_u32 s32, s32, 4096
    v_max_f32 v92, v92, v96
    v_max_f32 v93, v93, v97
    v_max_f32 v94, v94, v98
    v_max_f32 v95, v95, v99
    s_mov_b32 s18, 0x3eae1a93
    v_cvt_pk_bf16_f32 v182, v56, v57
    v_permlane32_swap_b32 v92, v93
    v_permlane32_swap_b32 v94, v95
    v_max_f32 v92, v92, v93
    buffer_load_dwordx4 a[8:11], v253, s[8:11], s33 offen offset:3072 sc1
    s_add_u32 s33, s33, 4096
    v_max_f32 v94, v94, v95
    v_cvt_pk_bf16_f32 v183, v58, v59
    v_cvt_pk_bf16_f32 v184, v60, v61
    v_permlane16_swap_b32 v92, v94
    v_max_f32 v92, v92, v94
    v_mul_f32 v92, 0xbeae1a93, v92
    v_mov_b32 v94, v92
    v_cvt_pk_bf16_f32 v185, v62, v63
    v_cvt_pk_bf16_f32 v186, v64, v65
    buffer_load_dwordx4 a[12:15], v5, s[8:11], s34 offen offset:3072 sc1
    s_add_u32 s34, s34, 4096
    v_permlane16_swap_b32 v92, v94
    v_mov_b32 v93, v92
    v_mov_b32 v95, v94
    v_cvt_pk_bf16_f32 v187, v66, v67
    v_cvt_pk_bf16_f32 v188, v68, v69
    v_permlane32_swap_b32 v92, v93
    v_permlane32_swap_b32 v94, v95
    v_cvt_pk_bf16_f32 v189, v70, v71
    v_cvt_pk_bf16_f32 v190, v72, v73
    buffer_load_dwordx4 a[16:19], v253, s[8:11], s32 offen offset:0 sc1
    v_cvt_pk_bf16_f32 v191, v74, v75
    v_fma_f32 v16, v16, s18, v92
    v_fma_f32 v17, v17, s18, v92
    v_fma_f32 v18, v18, s18, v92
    v_fma_f32 v19, v19, s18, v92
    v_fma_f32 v20, v20, s18, v92
    v_fma_f32 v21, v21, s18, v92
    v_fma_f32 v22, v22, s18, v92
    v_fma_f32 v23, v23, s18, v92
    buffer_load_dwordx4 a[20:23], v253, s[8:11], s33 offen offset:0 sc1
    v_exp_f32 v16, v16
    v_exp_f32 v17, v17
    v_exp_f32 v18, v18
    v_exp_f32 v19, v19
    v_exp_f32 v20, v20
    v_exp_f32 v21, v21
    v_exp_f32 v22, v22
    v_exp_f32 v23, v23
    s_nop 0
    buffer_load_dwordx4 a[24:27], v5, s[8:11], s34 offen offset:0 sc1
    v_cvt_pk_bf16_f32 v76, v16, v17
    v_cvt_pk_bf16_f32 v77, v18, v19
    v_cvt_pk_bf16_f32 v78, v20, v21
    v_cvt_pk_bf16_f32 v79, v22, v23
    v_fma_f32 v24, v24, s18, v93
    v_fma_f32 v25, v25, s18, v93
    v_fma_f32 v26, v26, s18, v93
    v_fma_f32 v27, v27, s18, v93
    v_fma_f32 v28, v28, s18, v93
    buffer_load_dwordx4 a[28:31], v253, s[8:11], s32 offen offset:1024 sc1
    v_fma_f32 v29, v29, s18, v93
    v_fma_f32 v30, v30, s18, v93
    v_fma_f32 v31, v31, s18, v93
    v_exp_f32 v24, v24
    v_exp_f32 v25, v25
    v_exp_f32 v26, v26
    v_exp_f32 v27, v27
    v_exp_f32 v28, v28
    v_exp_f32 v29, v29
    buffer_load_dwordx4 a[32:35], v253, s[8:11], s33 offen offset:1024 sc1
    v_exp_f32 v30, v30
    v_exp_f32 v31, v31
    v_mfma_f32_16x16x32_bf16 v[100:103], v[172:175], v[76:79], 0
    v_mfma_f32_16x16x32_bf16 v[116:119], v[182:185], v[76:79], 0
    v_cvt_pk_bf16_f32 v80, v24, v25
    v_cvt_pk_bf16_f32 v81, v26, v27
    v_cvt_pk_bf16_f32 v82, v28, v29
    v_cvt_pk_bf16_f32 v83, v30, v31
    v_fma_f32 v32, v32, s18, v94
    buffer_load_dwordx4 a[36:39], v5, s[8:11], s34 offen offset:1024 sc1
    v_fma_f32 v33, v33, s18, v94
    v_fma_f32 v34, v34, s18, v94
    v_fma_f32 v35, v35, s18, v94
    v_fma_f32 v36, v36, s18, v94
    v_fma_f32 v37, v37, s18, v94
    v_fma_f32 v38, v38, s18, v94
    v_fma_f32 v39, v39, s18, v94
    v_exp_f32 v32, v32
    v_exp_f32 v33, v33
    buffer_load_dwordx4 a[40:43], v253, s[8:11], s32 offen offset:2048 sc1
    v_exp_f32 v34, v34
    v_exp_f32 v35, v35
    v_exp_f32 v36, v36
    v_exp_f32 v37, v37
    v_exp_f32 v38, v38
    v_exp_f32 v39, v39
    v_mfma_f32_16x16x32_bf16 v[104:107], v[174:177], v[80:83], 0
    v_mfma_f32_16x16x32_bf16 v[120:123], v[184:187], v[80:83], 0
    v_cvt_pk_bf16_f32 v84, v32, v33
    buffer_load_dwordx4 a[44:47], v253, s[8:11], s33 offen offset:2048 sc1
    v_cvt_pk_bf16_f32 v85, v34, v35
    v_cvt_pk_bf16_f32 v86, v36, v37
    v_cvt_pk_bf16_f32 v87, v38, v39
    v_fma_f32 v40, v40, s18, v95
    v_fma_f32 v41, v41, s18, v95
    v_fma_f32 v42, v42, s18, v95
    v_fma_f32 v43, v43, s18, v95
    v_fma_f32 v44, v44, s18, v95
    v_fma_f32 v45, v45, s18, v95
    buffer_load_dwordx4 a[48:51], v5, s[8:11], s34 offen offset:2048 sc1
    v_fma_f32 v46, v46, s18, v95
    v_fma_f32 v47, v47, s18, v95
    v_exp_f32 v40, v40
    v_exp_f32 v41, v41
    v_exp_f32 v42, v42
    v_exp_f32 v43, v43
    v_exp_f32 v44, v44
    v_exp_f32 v45, v45
    v_exp_f32 v46, v46
    buffer_load_dwordx4 a[52:55], v253, s[8:11], s32 offen offset:3072 sc1
    s_add_u32 s32, s32, 4096
    v_exp_f32 v47, v47
    v_mfma_f32_16x16x32_bf16 v[108:111], v[176:179], v[84:87], 0
    v_mfma_f32_16x16x32_bf16 v[124:127], v[186:189], v[84:87], 0
    v_cvt_pk_bf16_f32 v88, v40, v41
    v_cvt_pk_bf16_f32 v89, v42, v43
    v_cvt_pk_bf16_f32 v90, v44, v45
    v_cvt_pk_bf16_f32 v91, v46, v47
    v_rcp_f32 v96, v118
    v_rcp_f32 v97, v122
    buffer_load_dwordx4 v[240:243], v9, s[8:11], s37 offen offset:0 sc1
    v_mfma_f32_16x16x32_bf16 v[112:115], v[178:181], v[88:91], 0
    v_mfma_f32_16x16x32_bf16 v[128:131], v[188:191], v[88:91], 0
    v_pk_mul_f32 v[100:101], v[96:97], v[100:101] op_sel:[0,0] op_sel_hi:[0,1]
    v_pk_mul_f32 v[102:103], v[96:97], v[102:103] op_sel:[0,0] op_sel_hi:[0,1]
    v_pk_mul_f32 v[116:117], v[96:97], v[116:117] op_sel:[0,0] op_sel_hi:[0,1]
    v_cvt_pk_bf16_f32 v212, v100, v101
    v_cvt_pk_bf16_f32 v213, v102, v103
    v_cvt_pk_bf16_f32 v220, v116, v117
    v_rcp_f32 v98, v126
    buffer_load_dwordx4 v[244:247], v9, s[8:11], s37 offen offset:1024 sc1
    v_pk_mul_f32 v[104:105], v[96:97], v[104:105] op_sel:[1,0] op_sel_hi:[1,1]
    v_pk_mul_f32 v[106:107], v[96:97], v[106:107] op_sel:[1,0] op_sel_hi:[1,1]
    v_pk_mul_f32 v[120:121], v[96:97], v[120:121] op_sel:[1,0] op_sel_hi:[1,1]
    v_cvt_pk_bf16_f32 v214, v104, v105
    v_cvt_pk_bf16_f32 v215, v106, v107
    v_cvt_pk_bf16_f32 v221, v120, v121
    v_rcp_f32 v99, v130
    v_permlane16_swap_b32 v212, v214
    v_permlane16_swap_b32 v213, v215
    buffer_load_dwordx4 v[248:251], v7, s[8:11], s37 offen offset:2048 sc1
    v_pk_mul_f32 v[108:109], v[98:99], v[108:109] op_sel:[0,0] op_sel_hi:[0,1]
    v_pk_mul_f32 v[110:111], v[98:99], v[110:111] op_sel:[0,0] op_sel_hi:[0,1]
    v_pk_mul_f32 v[124:125], v[98:99], v[124:125] op_sel:[0,0] op_sel_hi:[0,1]
    v_cvt_pk_bf16_f32 v216, v108, v109
    v_cvt_pk_bf16_f32 v217, v110, v111
    v_cvt_pk_bf16_f32 v222, v124, v125
    v_pk_mul_f32 v[112:113], v[98:99], v[112:113] op_sel:[1,0] op_sel_hi:[1,1]
    v_pk_mul_f32 v[114:115], v[98:99], v[114:115] op_sel:[1,0] op_sel_hi:[1,1]
    v_pk_mul_f32 v[128:129], v[98:99], v[128:129] op_sel:[1,0] op_sel_hi:[1,1]
    buffer_load_dword v252, v8, s[8:11], s47 offen sc1
    v_cvt_pk_bf16_f32 v218, v112, v113
    v_cvt_pk_bf16_f32 v219, v114, v115
    v_cvt_pk_bf16_f32 v223, v128, v129
    s_lshl_b32 s7, s3, 2
    s_add_u32 s7, s7, 94208
    v_permlane16_swap_b32 v220, v221
    v_permlane16_swap_b32 v222, v223
    v_add_u32 v11, s7, v253
    v_lshrrev_b32 v10, 3, v0
    v_permlane32_swap_b32 v220, v222
    v_mul_u32_u24 v10, 9216, v10
    ds_write_b32 v11, v220
    v_permlane16_swap_b32 v216, v218
    v_permlane16_swap_b32 v217, v219
    s_mul_i32 s7, s40, 1152
    s_add_u32 s22, s22, s7
    s_add_u32 s22, s22, 41156608
    s_lshl_b32 s7, s3, 8
    s_add_u32 s23, s22, s7
    s_add_u32 s24, s23, 36864
    buffer_store_dwordx4 v[212:215], v9, s[8:11], s23 offen sc1
    buffer_store_dwordx4 v[216:219], v9, s[8:11], s24 offen sc1
    v_and_b32 v11, 7, v0
    v_lshl_add_u32 v10, v11, 4, v10
    s_cmp_eq_u32 s3, 3
    s_cselect_b32 s7, 0, 1073741824
    v_add_u32 v10, s7, v10
    v_add_u32 v11, 94208, v253
    s_waitcnt lgkmcnt(0)
    s_barrier
    ds_read_b128 v[220:223], v11
    s_waitcnt lgkmcnt(0)
    buffer_store_dwordx4 v[220:223], v10, s[8:11], s22 offen offset:1024 sc1
    v_lshlrev_b32 v15, 7, v0
    s_lshl_b32 s6, s40, 2
    s_add_u32 s6, s6, s44
    v_mov_b32 v1, s76
    s_mov_b64 vcc, 0xff
    s_waitcnt vmcnt(0)
    s_barrier
    s_cmp_lg_u32 s3, 0
    s_cbranch_scc1 L_pub_17
    s_mov_b64 exec, vcc
    buffer_store_dword v1, v15, s[8:11], s6 offen sc1
L_pub_17:
    s_mov_b64 exec, -1
    buffer_load_dwordx4 a[56:59], v253, s[8:11], s33 offen offset:3072 sc1
    s_add_u32 s33, s33, 4096
    buffer_load_dwordx4 a[60:63], v5, s[8:11], s34 offen offset:3072 sc1
    s_add_u32 s34, s34, 4096
    buffer_load_dwordx4 a[64:67], v253, s[8:11], s32 offen offset:0 sc1
    buffer_load_dwordx4 a[68:71], v253, s[8:11], s33 offen offset:0 sc1
    buffer_load_dwordx4 a[72:75], v5, s[8:11], s34 offen offset:0 sc1
    buffer_load_dwordx4 a[76:79], v253, s[8:11], s32 offen offset:1024 sc1
    buffer_load_dwordx4 a[80:83], v253, s[8:11], s33 offen offset:1024 sc1
    buffer_load_dwordx4 a[84:87], v5, s[8:11], s34 offen offset:1024 sc1
    s_cmp_lg_u32 s42, 0
    s_cbranch_scc1 L_swz_18
    s_cmp_eq_u32 s93, 2
    s_cselect_b32 s6, 2, 3
    s_mov_b32 s7, 512
    s_cmov_b32 s7, 2048
    v_lshrrev_b32 v14, 4, v0
    v_lshlrev_b32 v14, s6, v14
    v_bfe_u32 v15, v0, 2, 2
    v_add_u32 v14, v14, v15
    v_mul_u32_u24 v14, 128, v14
    v_and_b32 v15, 3, v0
    v_lshl_add_u32 v14, v15, 3, v14
    v_add_u32 v14, s79, v14
    v_add_u32 v15, s7, v14
    ds_read_b64_tr_b16 v[76:77], v14 offset:0
    ds_read_b64_tr_b16 v[78:79], v15 offset:0
    ds_read_b64_tr_b16 v[80:81], v14 offset:32
    ds_read_b64_tr_b16 v[82:83], v15 offset:32
    ds_read_b64_tr_b16 v[84:85], v14 offset:64
    ds_read_b64_tr_b16 v[86:87], v15 offset:64
    ds_read_b64_tr_b16 v[88:89], v14 offset:96
    ds_read_b64_tr_b16 v[90:91], v15 offset:96
    ds_read_b64_tr_b16 v[92:93], v14 offset:4096
    ds_read_b64_tr_b16 v[94:95], v15 offset:4096
    ds_read_b64_tr_b16 v[96:97], v14 offset:4128
    ds_read_b64_tr_b16 v[98:99], v15 offset:4128
    ds_read_b64_tr_b16 v[176:177], v14 offset:4160
    ds_read_b64_tr_b16 v[178:179], v15 offset:4160
    ds_read_b64_tr_b16 v[180:181], v14 offset:4192
    ds_read_b64_tr_b16 v[182:183], v15 offset:4192
    ds_read_b64_tr_b16 v[196:197], v14 offset:8192
    ds_read_b64_tr_b16 v[198:199], v15 offset:8192
    ds_read_b64_tr_b16 v[200:201], v14 offset:8224
    ds_read_b64_tr_b16 v[202:203], v15 offset:8224
    ds_read_b64_tr_b16 v[204:205], v14 offset:8256
    ds_read_b64_tr_b16 v[206:207], v15 offset:8256
    ds_read_b64_tr_b16 v[208:209], v14 offset:8288
    ds_read_b64_tr_b16 v[210:211], v15 offset:8288
    ds_read_b64_tr_b16 v[212:213], v14 offset:12288
    ds_read_b64_tr_b16 v[214:215], v15 offset:12288
    ds_read_b64_tr_b16 v[216:217], v14 offset:12320
    ds_read_b64_tr_b16 v[218:219], v15 offset:12320
    ds_read_b64_tr_b16 v[220:221], v14 offset:12352
    ds_read_b64_tr_b16 v[222:223], v15 offset:12352
    ds_read_b64_tr_b16 v[228:229], v14 offset:12384
    ds_read_b64_tr_b16 v[230:231], v15 offset:12384
    s_mul_i32 s68, s40, 1990656
    s_add_u32 s68, s68, 3145728
    s_cmp_eq_u32 s93, 2
    s_cbranch_scc1 L_swz_down_19
    s_mul_i32 s6, s84, 349526
    s_lshr_b32 s6, s6, 20
    s_mul_i32 s7, s6, 3
    s_sub_u32 s7, s84, s7
    s_mul_i32 s6, s6, 6
    s_add_u32 s7, s7, s6
    s_mul_i32 s6, s88, 36
    s_add_u32 s7, s7, s6
    s_mul_i32 s6, s93, 3
    s_add_u32 s7, s7, s6
    s_lshl_b32 s7, s7, 10
    s_add_u32 s7, s7, s68
    s_add_u32 s80, s7, 0
    s_add_u32 s81, s7, 497664
    s_add_u32 s82, s7, 995328
    s_add_u32 s83, s7, 1492992
    s_mul_i32 s6, s85, 349526
    s_lshr_b32 s6, s6, 20
    s_mul_i32 s7, s6, 3
    s_sub_u32 s7, s85, s7
    s_mul_i32 s6, s6, 6
    s_add_u32 s7, s7, s6
    s_mul_i32 s6, s89, 36
    s_add_u32 s7, s7, s6
    s_mul_i32 s6, s93, 3
    s_add_u32 s7, s7, s6
    s_lshl_b32 s7, s7, 10
    s_add_u32 s7, s7, s68
    s_add_u32 s64, s7, 0
    s_add_u32 s65, s7, 497664
    s_add_u32 s18, s7, 995328
    s_add_u32 s19, s7, 1492992
    s_mul_i32 s6, s86, 349526
    s_lshr_b32 s6, s6, 20
    s_mul_i32 s7, s6, 3
    s_sub_u32 s7, s86, s7
    s_mul_i32 s6, s6, 6
    s_add_u32 s7, s7, s6
    s_mul_i32 s6, s90, 36
    s_add_u32 s7, s7, s6
    s_mul_i32 s6, s93, 3
    s_add_u32 s7, s7, s6
    s_lshl_b32 s7, s7, 10
    s_add_u32 s7, s7, s68
    s_add_u32 s20, s7, 0
    s_add_u32 s21, s7, 497664
    s_add_u32 s22, s7, 995328
    s_add_u32 s25, s7, 1492992
    s_mul_i32 s6, s87, 349526
    s_lshr_b32 s6, s6, 20
    s_mul_i32 s7, s6, 3
    s_sub_u32 s7, s87, s7
    s_mul_i32 s6, s6, 6
    s_add_u32 s7, s7, s6
    s_mul_i32 s6, s91, 36
    s_add_u32 s7, s7, s6
    s_mul_i32 s6, s93, 3
    s_add_u32 s7, s7, s6
    s_lshl_b32 s7, s7, 10
    s_add_u32 s7, s7, s68
    s_add_u32 s26, s7, 0
    s_add_u32 s27, s7, 497664
    s_add_u32 s28, s7, 995328
    s_add_u32 s29, s7, 1492992
    s_branch L_swz_dest_20
L_swz_down_19:
    s_mul_i32 s7, s88, 18
    s_add_u32 s7, s7, s84
    s_add_u32 s7, s7, 324
    s_lshl_b32 s7, s7, 10
    s_add_u32 s7, s7, s68
    s_add_u32 s80, s7, 0
    s_add_u32 s81, s7, 497664
    s_add_u32 s82, s7, 995328
    s_add_u32 s83, s7, 1492992
    s_mul_i32 s7, s89, 18
    s_add_u32 s7, s7, s85
    s_add_u32 s7, s7, 324
    s_lshl_b32 s7, s7, 10
    s_add_u32 s7, s7, s68
    s_add_u32 s64, s7, 0
    s_add_u32 s65, s7, 497664
    s_add_u32 s18, s7, 995328
    s_add_u32 s19, s7, 1492992
    s_mul_i32 s7, s90, 18
    s_add_u32 s7, s7, s86
    s_add_u32 s7, s7, 324
    s_lshl_b32 s7, s7, 10
    s_add_u32 s7, s7, s68
    s_add_u32 s20, s7, 0
    s_add_u32 s21, s7, 497664
    s_add_u32 s22, s7, 995328
    s_add_u32 s25, s7, 1492992
    s_mul_i32 s7, s91, 18
    s_add_u32 s7, s7, s87
    s_add_u32 s7, s7, 324
    s_lshl_b32 s7, s7, 10
    s_add_u32 s7, s7, s68
    s_add_u32 s26, s7, 0
    s_add_u32 s27, s7, 497664
    s_add_u32 s28, s7, 995328
    s_add_u32 s29, s7, 1492992
L_swz_dest_20:
    s_mov_b32 s72, s8
    s_mov_b32 s73, s9
    s_mov_b32 s74, 268435456
    s_waitcnt lgkmcnt(0)
    buffer_store_dwordx4 v[76:79], v253, s[72:75], s80 offen sc1
    buffer_store_dwordx4 v[80:83], v253, s[72:75], s81 offen sc1
    buffer_store_dwordx4 v[84:87], v253, s[72:75], s82 offen sc1
    buffer_store_dwordx4 v[88:91], v253, s[72:75], s83 offen sc1
    buffer_store_dwordx4 v[92:95], v253, s[72:75], s64 offen sc1
    buffer_store_dwordx4 v[96:99], v253, s[72:75], s65 offen sc1
    buffer_store_dwordx4 v[176:179], v253, s[72:75], s18 offen sc1
    buffer_store_dwordx4 v[180:183], v253, s[72:75], s19 offen sc1
    buffer_store_dwordx4 v[196:199], v253, s[72:75], s20 offen sc1
    buffer_store_dwordx4 v[200:203], v253, s[72:75], s21 offen sc1
    buffer_store_dwordx4 v[204:207], v253, s[72:75], s22 offen sc1
    buffer_store_dwordx4 v[208:211], v253, s[72:75], s25 offen sc1
    buffer_store_dwordx4 v[212:215], v253, s[72:75], s26 offen sc1
    buffer_store_dwordx4 v[216:219], v253, s[72:75], s27 offen sc1
    buffer_store_dwordx4 v[220:223], v253, s[72:75], s28 offen sc1
    buffer_store_dwordx4 v[228:231], v253, s[72:75], s29 offen sc1
    s_lshr_b32 s7, s2, 3
    s_lshl_b32 s7, s7, 2
    s_add_u32 s7, s7, s3
    s_lshl_b32 s7, s7, 9
    v_lshrrev_b32 v1, 1, v253
    v_add_u32 v1, s7, v1
    buffer_load_dwordx2 v[14:15], v1, s[96:99], 0 offen
L_swz_18:
    s_and_b32 s7, s3, 1
    s_mul_i32 s7, s7, 18432
    s_add_u32 s24, s30, s7
    s_lshr_b32 s7, s3, 1
    s_lshl_b32 s7, s7, 9
    s_add_u32 s24, s24, s7
    s_add_u32 s24, s24, 41156608
    s_mov_b32 s16, 0xffff0000
    v_lshlrev_b32 v124, 16, v240
    v_and_b32 v125, s16, v240
    v_lshlrev_b32 v126, 16, v241
    v_and_b32 v127, s16, v241
    v_lshlrev_b32 v128, 16, v242
    v_and_b32 v129, s16, v242
    v_lshlrev_b32 v130, 16, v243
    v_and_b32 v131, s16, v243
    v_lshlrev_b32 v132, 16, v244
    v_and_b32 v133, s16, v244
    v_lshlrev_b32 v134, 16, v245
    v_and_b32 v135, s16, v245
    v_lshlrev_b32 v136, 16, v246
    v_and_b32 v137, s16, v246
    v_lshlrev_b32 v138, 16, v247
    v_and_b32 v139, s16, v247
    v_lshlrev_b32 v140, 16, v248
    v_and_b32 v141, s16, v248
    v_lshlrev_b32 v142, 16, v249
    v_and_b32 v143, s16, v249
    v_lshlrev_b32 v144, 16, v250
    v_and_b32 v145, s16, v250
    v_lshlrev_b32 v146, 16, v251
    v_and_b32 v147, s16, v251
    s_cmp_eq_u32 s3, 1
    s_cselect_b32 s7, 16, 0
    v_lshlrev_b32 v12, 2, v0
    v_cmp_gt_u32 vcc, s7, v0
    v_add_u32 v10, 40960, v12
    v_add_u32 v11, 41472, v12
    v_cndmask_b32 v10, v11, v10, vcc
    v_and_b32 v11, 0x7c, v12
    v_cmp_gt_u32 vcc, 32, v0
    v_mov_b32 v13, 1073741824
    s_and_b32 s7, s40, 3
    s_lshl_b32 s45, s45, 2
    v_cndmask_b32 v8, v13, v12, vcc
    s_add_u32 s6, s7, s3
    s_cmp_eq_u32 s6, 0
    s_cselect_b32 s6, 0, 1073741824
    v_add_u32 v6, s6, v8
    s_add_u32 s45, s45, s7
    s_lshl_b32 s45, s45, 2
    s_add_u32 s45, s45, s3
    s_lshl_b32 s45, s45, 7
    s_add_u32 s45, s45, s43
    s_add_u32 s45, s45, 48300032
    s_cmp_eq_u32 s3, 0
    s_cselect_b32 s35, 1.0, 0
    s_lshl_b32 s7, s40, 2
    s_add_u32 s7, s7, s3
    s_mul_i32 s23, s7, 497664
    s_add_u32 s23, s23, 3145728
    s_add_u32 s50, s23, 497664
    s_mul_i32 s50, s50, s42
    v_mov_b32 v184, v253
    v_add_u32 v185, 4096, v253
    v_add_u32 v186, 8192, v253
    v_add_u32 v187, 12288, v253
    v_add_u32 v188, 16384, v253
    v_add_u32 v189, 20480, v253
    v_add_u32 v190, 24576, v253
    v_add_u32 v191, 28672, v253
    v_add_u32 v192, 32768, v253
    s_cmp_lg_u32 s3, 3
    s_cbranch_scc1 L_pollout_23
    s_lshl_b32 s7, s40, 7
    s_add_u32 s7, s7, s44
    s_add_u32 s52, s4, s7
    s_addc_u32 s53, s5, 0
    s_mov_b32 s6, 0
L_poll_21:
    s_load_dwordx8 s[56:63], s[52:53], 0 glc
    s_add_u32 s6, s6, 1
    s_waitcnt lgkmcnt(0)
    s_xor_b64 s[56:57], s[56:57], s[76:77]
    s_xor_b64 s[58:59], s[58:59], s[76:77]
    s_xor_b64 s[60:61], s[60:61], s[76:77]
    s_xor_b64 s[62:63], s[62:63], s[76:77]
    s_or_b64 s[56:57], s[56:57], s[58:59]
    s_or_b64 s[60:61], s[60:61], s[62:63]
    s_or_b64 s[56:57], s[56:57], s[60:61]
    s_cbranch_scc0 L_polled_22
    s_cmp_lt_u32 s6, 1048576
    s_cbranch_scc1 L_poll_21
    s_branch L_main_end
L_polled_22:
L_pollout_23:
    s_barrier
    s_lshl_b32 m0, s3, 10
    s_nop 0
    buffer_load_dwordx4 v2, s[8:11], s24 offen sc1 lds
    s_add_u32 m0, m0, 4096
    s_add_u32 s24, s24, 1024
    buffer_load_dwordx4 v2, s[8:11], s24 offen sc1 lds
    s_add_u32 m0, m0, 4096
    s_add_u32 s24, s24, 1024
    buffer_load_dwordx4 v2, s[8:11], s24 offen sc1 lds
    s_add_u32 m0, m0, 4096
    s_add_u32 s24, s24, 1024
    buffer_load_dwordx4 v2, s[8:11], s24 offen sc1 lds
    s_add_u32 m0, m0, 4096
    s_add_u32 s24, s24, 1024
    buffer_load_dwordx4 v2, s[8:11], s24 offen sc1 lds
    s_add_u32 m0, m0, 4096
    s_add_u32 s24, s24, 1024
    buffer_load_dwordx4 v2, s[8:11], s24 offen sc1 lds
    s_add_u32 m0, m0, 4096
    s_add_u32 s24, s24, 1024
    buffer_load_dwordx4 v2, s[8:11], s24 offen sc1 lds
    s_add_u32 m0, m0, 4096
    s_add_u32 s24, s24, 1024
    buffer_load_dwordx4 v2, s[8:11], s24 offen sc1 lds
    s_add_u32 m0, m0, 4096
    s_add_u32 s24, s24, 1024
    buffer_load_dwordx4 v2, s[8:11], s24 offen sc1 lds
    s_waitcnt vmcnt(4)
    s_barrier
    ds_read_b128 v[160:163], v253 offset:0
    ds_read_b128 v[164:167], v253 offset:1024
    s_waitcnt lgkmcnt(0)
    v_mfma_f32_16x16x32_bf16 v[100:103], a[160:163], v[160:163], 0
    ds_read_b128 v[168:171], v253 offset:2048
    v_mfma_f32_16x16x32_bf16 v[104:107], a[160:163], v[164:167], 0
    ds_read_b128 v[172:175], v253 offset:3072
    v_mfma_f32_16x16x32_bf16 v[108:111], a[164:167], v[160:163], 0
    v_mfma_f32_16x16x32_bf16 v[112:115], a[164:167], v[164:167], 0
    buffer_load_dwordx4 v[16:19], v184, s[48:51], s23 offen offset:0 sc1
    v_mfma_f32_16x16x32_bf16 v[116:119], a[168:171], v[160:163], 0
    v_mfma_f32_16x16x32_bf16 v[120:123], a[168:171], v[164:167], 0
    s_waitcnt lgkmcnt(0)
    v_mfma_f32_16x16x32_bf16 v[100:103], a[172:175], v[168:171], v[100:103]
    ds_read_b128 v[160:163], v253 offset:4096
    v_mfma_f32_16x16x32_bf16 v[104:107], a[172:175], v[172:175], v[104:107]
    ds_read_b128 v[164:167], v253 offset:5120
    v_mfma_f32_16x16x32_bf16 v[108:111], a[176:179], v[168:171], v[108:111]
    v_mfma_f32_16x16x32_bf16 v[112:115], a[176:179], v[172:175], v[112:115]
    buffer_load_dwordx4 v[20:23], v184, s[48:51], s23 offen offset:1024 sc1
    v_mfma_f32_16x16x32_bf16 v[116:119], a[180:183], v[168:171], v[116:119]
    v_mfma_f32_16x16x32_bf16 v[120:123], a[180:183], v[172:175], v[120:123]
    s_waitcnt lgkmcnt(0)
    v_mfma_f32_16x16x32_bf16 v[100:103], a[184:187], v[160:163], v[100:103]
    ds_read_b128 v[168:171], v253 offset:6144
    v_mfma_f32_16x16x32_bf16 v[104:107], a[184:187], v[164:167], v[104:107]
    ds_read_b128 v[172:175], v253 offset:7168
    v_mfma_f32_16x16x32_bf16 v[108:111], a[188:191], v[160:163], v[108:111]
    v_mfma_f32_16x16x32_bf16 v[112:115], a[188:191], v[164:167], v[112:115]
    buffer_load_dwordx4 v[24:27], v184, s[48:51], s23 offen offset:2048 sc1
    v_mfma_f32_16x16x32_bf16 v[116:119], a[192:195], v[160:163], v[116:119]
    v_mfma_f32_16x16x32_bf16 v[120:123], a[192:195], v[164:167], v[120:123]
    s_waitcnt lgkmcnt(0)
    v_mfma_f32_16x16x32_bf16 v[100:103], a[196:199], v[168:171], v[100:103]
    ds_read_b128 v[160:163], v253 offset:8192
    v_mfma_f32_16x16x32_bf16 v[104:107], a[196:199], v[172:175], v[104:107]
    ds_read_b128 v[164:167], v253 offset:9216
    v_mfma_f32_16x16x32_bf16 v[108:111], a[200:203], v[168:171], v[108:111]
    v_mfma_f32_16x16x32_bf16 v[112:115], a[200:203], v[172:175], v[112:115]
    buffer_load_dwordx4 v[28:31], v184, s[48:51], s23 offen offset:3072 sc1
    v_mfma_f32_16x16x32_bf16 v[116:119], a[204:207], v[168:171], v[116:119]
    v_mfma_f32_16x16x32_bf16 v[120:123], a[204:207], v[172:175], v[120:123]
    s_waitcnt lgkmcnt(0)
    v_mfma_f32_16x16x32_bf16 v[100:103], a[208:211], v[160:163], v[100:103]
    ds_read_b128 v[168:171], v253 offset:10240
    v_mfma_f32_16x16x32_bf16 v[104:107], a[208:211], v[164:167], v[104:107]
    ds_read_b128 v[172:175], v253 offset:11264
    v_mfma_f32_16x16x32_bf16 v[108:111], a[212:215], v[160:163], v[108:111]
    v_mfma_f32_16x16x32_bf16 v[112:115], a[212:215], v[164:167], v[112:115]
    buffer_load_dwordx4 v[32:35], v185, s[48:51], s23 offen offset:0 sc1
    v_mfma_f32_16x16x32_bf16 v[116:119], a[216:219], v[160:163], v[116:119]
    v_mfma_f32_16x16x32_bf16 v[120:123], a[216:219], v[164:167], v[120:123]
    s_waitcnt lgkmcnt(0)
    v_mfma_f32_16x16x32_bf16 v[100:103], a[220:223], v[168:171], v[100:103]
    ds_read_b128 v[160:163], v253 offset:12288
    v_mfma_f32_16x16x32_bf16 v[104:107], a[220:223], v[172:175], v[104:107]
    ds_read_b128 v[164:167], v253 offset:13312
    v_mfma_f32_16x16x32_bf16 v[108:111], a[224:227], v[168:171], v[108:111]
    v_mfma_f32_16x16x32_bf16 v[112:115], a[224:227], v[172:175], v[112:115]
    buffer_load_dwordx4 v[36:39], v185, s[48:51], s23 offen offset:1024 sc1
    v_mfma_f32_16x16x32_bf16 v[116:119], a[228:231], v[168:171], v[116:119]
    v_mfma_f32_16x16x32_bf16 v[120:123], a[228:231], v[172:175], v[120:123]
    s_waitcnt lgkmcnt(0)
    v_mfma_f32_16x16x32_bf16 v[100:103], a[232:235], v[160:163], v[100:103]
    ds_read_b128 v[168:171], v253 offset:14336
    v_mfma_f32_16x16x32_bf16 v[104:107], a[232:235], v[164:167], v[104:107]
    ds_read_b128 v[172:175], v253 offset:15360
    v_mfma_f32_16x16x32_bf16 v[108:111], a[236:239], v[160:163], v[108:111]
    v_mfma_f32_16x16x32_bf16 v[112:115], a[236:239], v[164:167], v[112:115]
    buffer_load_dwordx4 v[40:43], v185, s[48:51], s23 offen offset:2048 sc1
    v_mfma_f32_16x16x32_bf16 v[116:119], a[240:243], v[160:163], v[116:119]
    v_mfma_f32_16x16x32_bf16 v[120:123], a[240:243], v[164:167], v[120:123]
    s_waitcnt lgkmcnt(0)
    v_mfma_f32_16x16x32_bf16 v[100:103], a[244:247], v[168:171], v[100:103]
    ds_read_b128 v[160:163], v253 offset:16384
    v_mfma_f32_16x16x32_bf16 v[104:107], a[244:247], v[172:175], v[104:107]
    ds_read_b128 v[164:167], v253 offset:17408
    v_mfma_f32_16x16x32_bf16 v[108:111], a[248:251], v[168:171], v[108:111]
    v_mfma_f32_16x16x32_bf16 v[112:115], a[248:251], v[172:175], v[112:115]
    buffer_load_dwordx4 v[44:47], v185, s[48:51], s23 offen offset:3072 sc1
    v_mfma_f32_16x16x32_bf16 v[116:119], a[252:255], v[168:171], v[116:119]
    v_mfma_f32_16x16x32_bf16 v[120:123], a[252:255], v[172:175], v[120:123]
    s_waitcnt lgkmcnt(0)
    v_mfma_f32_16x16x32_bf16 v[100:103], a[128:131], v[160:163], v[100:103]
    ds_read_b128 v[168:171], v253 offset:18432
    v_mfma_f32_16x16x32_bf16 v[104:107], a[128:131], v[164:167], v[104:107]
    ds_read_b128 v[172:175], v253 offset:19456
    v_mfma_f32_16x16x32_bf16 v[108:111], a[132:135], v[160:163], v[108:111]
    v_mfma_f32_16x16x32_bf16 v[112:115], a[132:135], v[164:167], v[112:115]
    buffer_load_dwordx4 v[48:51], v186, s[48:51], s23 offen offset:0 sc1
    v_mfma_f32_16x16x32_bf16 v[116:119], a[136:139], v[160:163], v[116:119]
    v_mfma_f32_16x16x32_bf16 v[120:123], a[136:139], v[164:167], v[120:123]
    s_waitcnt vmcnt(9) lgkmcnt(0)
    s_barrier
    s_xor_b32 s7, s3, 0
    s_or_b32 s7, s7, s42
    s_cbranch_scc1 L_swz_24
    s_lshl_b32 s6, s40, 7
    s_lshl_b32 s7, s41, 2
    s_add_u32 s6, s6, s7
    s_add_u32 s6, s6, 19464192
    s_mov_b64 exec, 0xffffffff
    v_lshlrev_b32 v15, 10, v0
    v_mov_b32 v1, s76
    buffer_store_dword v1, v15, s[8:11], s6 offen sc1
    s_mov_b64 exec, -1
L_swz_24:
    v_mfma_f32_16x16x32_bf16 v[100:103], a[140:143], v[168:171], v[100:103]
    ds_read_b128 v[160:163], v253 offset:20480
    v_mfma_f32_16x16x32_bf16 v[104:107], a[140:143], v[172:175], v[104:107]
    ds_read_b128 v[164:167], v253 offset:21504
    v_mfma_f32_16x16x32_bf16 v[108:111], a[144:147], v[168:171], v[108:111]
    v_mfma_f32_16x16x32_bf16 v[112:115], a[144:147], v[172:175], v[112:115]
    buffer_load_dwordx4 v[52:55], v186, s[48:51], s23 offen offset:1024 sc1
    v_mfma_f32_16x16x32_bf16 v[116:119], a[148:151], v[168:171], v[116:119]
    v_mfma_f32_16x16x32_bf16 v[120:123], a[148:151], v[172:175], v[120:123]
    s_waitcnt lgkmcnt(0)
    v_mfma_f32_16x16x32_bf16 v[100:103], a[152:155], v[160:163], v[100:103]
    ds_read_b128 v[168:171], v253 offset:22528
    v_mfma_f32_16x16x32_bf16 v[104:107], a[152:155], v[164:167], v[104:107]
    ds_read_b128 v[172:175], v253 offset:23552
    v_mfma_f32_16x16x32_bf16 v[108:111], a[156:159], v[160:163], v[108:111]
    v_mfma_f32_16x16x32_bf16 v[112:115], a[156:159], v[164:167], v[112:115]
    buffer_load_dwordx4 v[56:59], v186, s[48:51], s23 offen offset:2048 sc1
    v_mfma_f32_16x16x32_bf16 v[116:119], a[0:3], v[160:163], v[116:119]
    v_mfma_f32_16x16x32_bf16 v[120:123], a[0:3], v[164:167], v[120:123]
    s_waitcnt lgkmcnt(0)
    v_mfma_f32_16x16x32_bf16 v[100:103], a[4:7], v[168:171], v[100:103]
    ds_read_b128 v[160:163], v253 offset:24576
    v_mfma_f32_16x16x32_bf16 v[104:107], a[4:7], v[172:175], v[104:107]
    ds_read_b128 v[164:167], v253 offset:25600
    v_mfma_f32_16x16x32_bf16 v[108:111], a[8:11], v[168:171], v[108:111]
    v_mfma_f32_16x16x32_bf16 v[112:115], a[8:11], v[172:175], v[112:115]
    buffer_load_dwordx4 v[60:63], v186, s[48:51], s23 offen offset:3072 sc1
    v_mfma_f32_16x16x32_bf16 v[116:119], a[12:15], v[168:171], v[116:119]
    v_mfma_f32_16x16x32_bf16 v[120:123], a[12:15], v[172:175], v[120:123]
    s_waitcnt lgkmcnt(0)
    v_mfma_f32_16x16x32_bf16 v[100:103], a[16:19], v[160:163], v[100:103]
    ds_read_b128 v[168:171], v253 offset:26624
    v_mfma_f32_16x16x32_bf16 v[104:107], a[16:19], v[164:167], v[104:107]
    ds_read_b128 v[172:175], v253 offset:27648
    v_mfma_f32_16x16x32_bf16 v[108:111], a[20:23], v[160:163], v[108:111]
    v_mfma_f32_16x16x32_bf16 v[112:115], a[20:23], v[164:167], v[112:115]
    buffer_load_dwordx4 v[64:67], v187, s[48:51], s23 offen offset:0 sc1
    v_mfma_f32_16x16x32_bf16 v[116:119], a[24:27], v[160:163], v[116:119]
    v_mfma_f32_16x16x32_bf16 v[120:123], a[24:27], v[164:167], v[120:123]
    s_waitcnt lgkmcnt(0)
    v_mfma_f32_16x16x32_bf16 v[100:103], a[28:31], v[168:171], v[100:103]
    ds_read_b128 v[160:163], v253 offset:28672
    v_mfma_f32_16x16x32_bf16 v[104:107], a[28:31], v[172:175], v[104:107]
    ds_read_b128 v[164:167], v253 offset:29696
    v_mfma_f32_16x16x32_bf16 v[108:111], a[32:35], v[168:171], v[108:111]
    v_mfma_f32_16x16x32_bf16 v[112:115], a[32:35], v[172:175], v[112:115]
    buffer_load_dwordx4 v[68:71], v187, s[48:51], s23 offen offset:1024 sc1
    v_mfma_f32_16x16x32_bf16 v[116:119], a[36:39], v[168:171], v[116:119]
    v_mfma_f32_16x16x32_bf16 v[120:123], a[36:39], v[172:175], v[120:123]
    s_waitcnt lgkmcnt(0)
    v_mfma_f32_16x16x32_bf16 v[100:103], a[40:43], v[160:163], v[100:103]
    ds_read_b128 v[168:171], v253 offset:30720
    v_mfma_f32_16x16x32_bf16 v[104:107], a[40:43], v[164:167], v[104:107]
    ds_read_b128 v[172:175], v253 offset:31744
    v_mfma_f32_16x16x32_bf16 v[108:111], a[44:47], v[160:163], v[108:111]
    v_mfma_f32_16x16x32_bf16 v[112:115], a[44:47], v[164:167], v[112:115]
    buffer_load_dwordx4 v[72:75], v187, s[48:51], s23 offen offset:2048 sc1
    v_mfma_f32_16x16x32_bf16 v[116:119], a[48:51], v[160:163], v[116:119]
    v_mfma_f32_16x16x32_bf16 v[120:123], a[48:51], v[164:167], v[120:123]
    s_waitcnt lgkmcnt(0)
    v_mfma_f32_16x16x32_bf16 v[100:103], a[52:55], v[168:171], v[100:103]
    ds_read_b128 v[160:163], v253 offset:32768
    v_mfma_f32_16x16x32_bf16 v[104:107], a[52:55], v[172:175], v[104:107]
    ds_read_b128 v[164:167], v253 offset:33792
    v_mfma_f32_16x16x32_bf16 v[108:111], a[56:59], v[168:171], v[108:111]
    v_mfma_f32_16x16x32_bf16 v[112:115], a[56:59], v[172:175], v[112:115]
    v_mfma_f32_16x16x32_bf16 v[116:119], a[60:63], v[168:171], v[116:119]
    v_mfma_f32_16x16x32_bf16 v[120:123], a[60:63], v[172:175], v[120:123]
    s_waitcnt lgkmcnt(0)
    v_mfma_f32_16x16x32_bf16 v[100:103], a[64:67], v[160:163], v[100:103]
    ds_read_b128 v[168:171], v253 offset:34816
    v_mfma_f32_16x16x32_bf16 v[104:107], a[64:67], v[164:167], v[104:107]
    ds_read_b128 v[172:175], v253 offset:35840
    v_mfma_f32_16x16x32_bf16 v[108:111], a[68:71], v[160:163], v[108:111]
    v_mfma_f32_16x16x32_bf16 v[112:115], a[68:71], v[164:167], v[112:115]
    v_mfma_f32_16x16x32_bf16 v[116:119], a[72:75], v[160:163], v[116:119]
    v_mfma_f32_16x16x32_bf16 v[120:123], a[72:75], v[164:167], v[120:123]
    s_waitcnt lgkmcnt(0)
    v_mfma_f32_16x16x32_bf16 v[100:103], a[76:79], v[168:171], v[100:103]
    v_mfma_f32_16x16x32_bf16 v[104:107], a[76:79], v[172:175], v[104:107]
    v_mfma_f32_16x16x32_bf16 v[108:111], a[80:83], v[168:171], v[108:111]
    v_mfma_f32_16x16x32_bf16 v[112:115], a[80:83], v[172:175], v[112:115]
    v_mfma_f32_16x16x32_bf16 v[116:119], a[84:87], v[168:171], v[116:119]
    v_mfma_f32_16x16x32_bf16 v[120:123], a[84:87], v[172:175], v[120:123]
    s_nop 3
    v_permlane16_swap_b32 v100, v104
    v_permlane16_swap_b32 v101, v105
    v_permlane16_swap_b32 v102, v106
    v_permlane16_swap_b32 v103, v107
    v_add_f32 v12, v116, v117
    v_add_f32 v13, v120, v121
    ds_write_b32 v10, v12
    ds_write_b32 v10, v13 offset:64
    v_permlane16_swap_b32 v108, v112
    v_permlane16_swap_b32 v109, v113
    v_permlane16_swap_b32 v110, v114
    v_permlane16_swap_b32 v111, v115
    v_permlane16_swap_b32 v116, v120
    v_permlane16_swap_b32 v117, v121
    v_permlane16_swap_b32 v118, v122
    v_permlane16_swap_b32 v119, v123
    s_waitcnt lgkmcnt(0)
    s_barrier
    ds_read_b32 v12, v11 offset:40960
    v_pk_add_f32 v[124:125], v[124:125], v[100:101]
    v_pk_add_f32 v[126:127], v[126:127], v[102:103]
    v_pk_add_f32 v[128:129], v[128:129], v[104:105]
    v_pk_add_f32 v[130:131], v[130:131], v[106:107]
    v_pk_add_f32 v[132:133], v[132:133], v[108:109]
    v_pk_add_f32 v[134:135], v[134:135], v[110:111]
    v_pk_add_f32 v[136:137], v[136:137], v[112:113]
    v_pk_add_f32 v[138:139], v[138:139], v[114:115]
    v_pk_add_f32 v[140:141], v[140:141], v[116:117]
    v_pk_add_f32 v[142:143], v[142:143], v[118:119]
    v_pk_add_f32 v[144:145], v[144:145], v[120:121]
    v_pk_add_f32 v[146:147], v[146:147], v[122:123]
    v_mov_b32 v14, 0
    v_mov_b32 v15, 0
    s_waitcnt lgkmcnt(0)
    v_add_f32 v12, v12, v252
    v_pk_add_f32 v[100:101], v[124:125], v[12:13] op_sel_hi:[1,0] neg_lo:[0,1] neg_hi:[0,1]
    v_pk_add_f32 v[102:103], v[126:127], v[12:13] op_sel_hi:[1,0] neg_lo:[0,1] neg_hi:[0,1]
    v_pk_add_f32 v[104:105], v[128:129], v[12:13] op_sel_hi:[1,0] neg_lo:[0,1] neg_hi:[0,1]
    v_pk_add_f32 v[106:107], v[130:131], v[12:13] op_sel_hi:[1,0] neg_lo:[0,1] neg_hi:[0,1]
    v_cvt_pk_bf16_f32 v148, v100, v101
    v_cvt_pk_bf16_f32 v149, v102, v103
    v_cvt_pk_bf16_f32 v150, v104, v105
    v_cvt_pk_bf16_f32 v151, v106, v107
    buffer_store_dwordx4 v[148:151], v9, s[8:11], s46 offen offset:0 sc1
    v_pk_add_f32 v[108:109], v[132:133], v[12:13] op_sel_hi:[1,0] neg_lo:[0,1] neg_hi:[0,1]
    v_pk_add_f32 v[110:111], v[134:135], v[12:13] op_sel_hi:[1,0] neg_lo:[0,1] neg_hi:[0,1]
    v_pk_add_f32 v[112:113], v[136:137], v[12:13] op_sel_hi:[1,0] neg_lo:[0,1] neg_hi:[0,1]
    v_pk_add_f32 v[114:115], v[138:139], v[12:13] op_sel_hi:[1,0] neg_lo:[0,1] neg_hi:[0,1]
    v_cvt_pk_bf16_f32 v152, v108, v109
    v_cvt_pk_bf16_f32 v153, v110, v111
    v_cvt_pk_bf16_f32 v154, v112, v113
    v_cvt_pk_bf16_f32 v155, v114, v115
    buffer_store_dwordx4 v[152:155], v9, s[8:11], s46 offen offset:1024 sc1
    v_pk_add_f32 v[116:117], v[140:141], v[12:13] op_sel_hi:[1,0] neg_lo:[0,1] neg_hi:[0,1]
    v_pk_add_f32 v[118:119], v[142:143], v[12:13] op_sel_hi:[1,0] neg_lo:[0,1] neg_hi:[0,1]
    v_pk_add_f32 v[120:121], v[144:145], v[12:13] op_sel_hi:[1,0] neg_lo:[0,1] neg_hi:[0,1]
    v_pk_add_f32 v[122:123], v[146:147], v[12:13] op_sel_hi:[1,0] neg_lo:[0,1] neg_hi:[0,1]
    v_cvt_pk_bf16_f32 v156, v116, v117
    v_cvt_pk_bf16_f32 v157, v118, v119
    v_cvt_pk_bf16_f32 v158, v120, v121
    v_cvt_pk_bf16_f32 v159, v122, v123
    buffer_store_dwordx4 v[156:159], v7, s[8:11], s46 offen offset:2048 sc1
    v_dot2c_f32_bf16 v14, v148, v148
    v_dot2c_f32_bf16 v14, v149, v149
    v_dot2c_f32_bf16 v14, v150, v150
    v_dot2c_f32_bf16 v14, v151, v151
    v_dot2c_f32_bf16 v14, v152, v152
    v_dot2c_f32_bf16 v14, v153, v153
    v_dot2c_f32_bf16 v14, v154, v154
    v_dot2c_f32_bf16 v14, v155, v155
    v_dot2c_f32_bf16 v15, v156, v156
    v_dot2c_f32_bf16 v15, v157, v157
    v_dot2c_f32_bf16 v15, v158, v158
    v_dot2c_f32_bf16 v15, v159, v159
    buffer_store_dword v12, v6, s[8:11], s36 offen sc1
    s_nop 1
    v_fma_f32 v14, v15, s35, v14
    v_mov_b32 v15, v14
    s_nop 1
    v_permlane32_swap_b32 v14, v15
    v_add_f32 v14, v14, v15
    buffer_store_dword v14, v8, s[8:11], s45 offen sc1
    v_lshlrev_b32 v15, 7, v0
    s_lshl_b32 s6, s40, 2
    s_add_u32 s6, s6, s44
    s_add_u32 s6, s6, 32768
    v_mov_b32 v1, s76
    s_mov_b64 vcc, 0xff
    s_waitcnt vmcnt(0)
    s_barrier
    s_cmp_lg_u32 s3, 0
    s_cbranch_scc1 L_pub_25
    s_mov_b64 exec, vcc
    buffer_store_dword v1, v15, s[8:11], s6 offen sc1
L_pub_25:
    s_mov_b64 exec, -1
    s_lshl_b32 s7, s41, 2
    s_add_u32 s7, s7, s3
    s_mul_i32 s22, s7, 18432
    s_add_u32 s22, s22, s43
    s_add_u32 s22, s22, 45875200
    s_mul_i32 s24, s3, 18432
    s_lshl_b32 s25, s41, 12
    s_add_u32 s25, s25, s43
    s_add_u32 s25, s25, 48300032
    v_lshrrev_b32 v3, 5, v0
    v_and_b32 v10, 31, v0
    v_lshlrev_b32 v10, 2, v10
    v_lshl_add_u32 v3, v3, 11, v10
    v_add_u32 v11, 36864, v184
    s_mov_b32 s16, 0xffff0000
    s_lshl_b32 s7, s3, 10
    v_add_u32 v172, s7, v253
    v_add_u32 v174, 5120, v172
    v_and_b32 v178, 7, v0
    v_mul_u32_u24 v178, 1152, v178
    v_lshrrev_b32 v179, 3, v0
    v_lshl_add_u32 v178, v179, 4, v178
    s_lshl_b32 s7, s3, 7
    v_add_u32 v175, s7, v178
    v_add_u32 v177, 640, v175
    s_cmp_eq_u32 s3, 0
    s_mov_b32 s17, 1073741824
    s_cmov_b32 s17, 4096
    v_add_u32 v173, s17, v172
    s_mov_b32 s17, 1073741824
    s_cmov_b32 s17, 512
    v_add_u32 v176, s17, v175
    s_lshl_b32 s21, s41, 3
    s_add_u32 s21, s21, s40
    s_mul_i32 s18, s21, 9216
    s_mul_i32 s20, s21, 73728
    s_add_u32 s20, s20, 19922944
    v_bfe_u32 v1, v0, 3, 2
    s_mov_b32 s7, 73728
    v_mul_lo_u32 v178, v1, s7
    v_lshrrev_b32 v1, 5, v0
    v_lshl_add_u32 v178, v1, 7, v178
    v_and_b32 v1, 7, v0
    v_lshl_add_u32 v178, v1, 4, v178
    v_add_u32 v179, 294912, v178
    v_lshrrev_b32 v1, 5, v0
    v_and_b32 v15, 7, v0
    v_lshlrev_b32 v15, 4, v15
    v_lshl_add_u32 v15, v1, 7, v15
    s_lshl_b32 s7, s3, 8
    s_add_u32 s7, s7, 3072
    v_add_u32 v15, s7, v15
    v_bfe_u32 v1, v0, 3, 2
    v_mov_b32 v182, 1073741824
    v_add_u32 v183, 14336, v253
    s_sub_u32 s7, s40, 0
    v_cmp_eq_u32 vcc, s7, v1
    s_nop 1
    v_cndmask_b32 v178, v178, v182, vcc
    v_cndmask_b32 v216, v183, v15, vcc
    v_cndmask_b32 v218, 0, 1, vcc
    v_lshlrev_b32 v218, 10, v218
    s_sub_u32 s7, s40, 4
    v_cmp_eq_u32 vcc, s7, v1
    s_nop 1
    v_cndmask_b32 v179, v179, v182, vcc
    v_cndmask_b32 v217, v183, v15, vcc
    v_cndmask_b32 v219, 0, 1, vcc
    v_lshlrev_b32 v219, 10, v219
    s_mul_i32 s26, s41, 589824
    s_mul_i32 s7, s40, 9216
    s_add_u32 s26, s26, s7
    s_lshl_b32 s7, s3, 8
    s_add_u32 s27, s26, s7
    s_add_u32 s27, s27, 19921920
    s_mov_b32 s74, 0
    s_mul_i32 s7, s42, 98304
    s_sub_u32 s29, s44, s7
    s_add_u32 s29, s29, 360448
    s_lshl_b32 s7, s40, 7
    s_add_u32 s7, s7, s29
    s_add_u32 s38, s4, s7
    s_addc_u32 s39, s5, 0
    s_lshl_b32 s7, s40, 2
    s_add_u32 s29, s29, s7
    s_add_u32 s50, s23, 497664
    s_cmp_lg_u32 s42, 0
    s_cbranch_scc1 L_ring_26
    s_cmp_lg_u32 s3, 0
    s_cbranch_scc1 L_ring_27
    s_lshl_b32 s7, s41, 3
    s_add_u32 s7, s7, s40
    s_lshl_b32 s7, s7, 7
    s_add_u32 s7, s7, 19464192
    s_add_u32 s68, s4, s7
    s_addc_u32 s69, s5, 0
    s_mov_b32 s6, 0
    s_mov_b32 s7, 0
L_cpoll_28:
    s_load_dwordx16 s[52:67], s[68:69], s7 glc
    s_add_u32 s6, s6, 1
    s_waitcnt lgkmcnt(0)
    s_xor_b64 s[52:53], s[52:53], s[76:77]
    s_xor_b64 s[54:55], s[54:55], s[76:77]
    s_xor_b64 s[56:57], s[56:57], s[76:77]
    s_xor_b64 s[58:59], s[58:59], s[76:77]
    s_xor_b64 s[60:61], s[60:61], s[76:77]
    s_xor_b64 s[62:63], s[62:63], s[76:77]
    s_xor_b64 s[64:65], s[64:65], s[76:77]
    s_xor_b64 s[66:67], s[66:67], s[76:77]
    s_or_b64 s[52:53], s[52:53], s[60:61]
    s_or_b64 s[54:55], s[54:55], s[62:63]
    s_or_b64 s[56:57], s[56:57], s[64:65]
    s_or_b64 s[58:59], s[58:59], s[66:67]
    s_or_b64 s[52:53], s[52:53], s[56:57]
    s_or_b64 s[54:55], s[54:55], s[58:59]
    s_or_b64 s[52:53], s[52:53], s[54:55]
    s_cbranch_scc1 L_cpoll_29
    s_add_u32 s7, s7, 64
    s_cmp_eq_u32 s7, 128
    s_cbranch_scc1 L_cpolled_30
L_cpoll_29:
    s_cmp_lt_u32 s6, 1048576
    s_cbranch_scc1 L_cpoll_28
    s_branch L_main_end
L_cpolled_30:
L_ring_27:
    s_barrier
    buffer_load_dwordx4 v[16:19], v184, s[48:51], s23 offen offset:0 sc1
    buffer_load_dwordx4 v[20:23], v184, s[48:51], s23 offen offset:1024 sc1
    buffer_load_dwordx4 v[24:27], v184, s[48:51], s23 offen offset:2048 sc1
    buffer_load_dwordx4 v[28:31], v184, s[48:51], s23 offen offset:3072 sc1
    buffer_load_dwordx4 v[32:35], v185, s[48:51], s23 offen offset:0 sc1
    buffer_load_dwordx4 v[36:39], v185, s[48:51], s23 offen offset:1024 sc1
    buffer_load_dwordx4 v[40:43], v185, s[48:51], s23 offen offset:2048 sc1
    buffer_load_dwordx4 v[44:47], v185, s[48:51], s23 offen offset:3072 sc1
    buffer_load_dwordx4 v[48:51], v186, s[48:51], s23 offen offset:0 sc1
    buffer_load_dwordx4 v[52:55], v186, s[48:51], s23 offen offset:1024 sc1
    buffer_load_dwordx4 v[56:59], v186, s[48:51], s23 offen offset:2048 sc1
    buffer_load_dwordx4 v[60:63], v186, s[48:51], s23 offen offset:3072 sc1
    buffer_load_dwordx4 v[64:67], v187, s[48:51], s23 offen offset:0 sc1
    buffer_load_dwordx4 v[68:71], v187, s[48:51], s23 offen offset:1024 sc1
    buffer_load_dwordx4 v[72:75], v187, s[48:51], s23 offen offset:2048 sc1
L_ring_26:
    s_cmp_lg_u32 s3, 3
    s_cbranch_scc1 L_pollout_33
    s_lshl_b32 s7, s40, 7
    s_add_u32 s7, s7, s44
    s_add_u32 s7, s7, 32768
    s_add_u32 s52, s4, s7
    s_addc_u32 s53, s5, 0
    s_mov_b32 s6, 0
L_poll_31:
    s_load_dwordx8 s[56:63], s[52:53], 0 glc
    s_add_u32 s6, s6, 1
    s_waitcnt lgkmcnt(0)
    s_xor_b64 s[56:57], s[56:57], s[76:77]
    s_xor_b64 s[58:59], s[58:59], s[76:77]
    s_xor_b64 s[60:61], s[60:61], s[76:77]
    s_xor_b64 s[62:63], s[62:63], s[76:77]
    s_or_b64 s[56:57], s[56:57], s[58:59]
    s_or_b64 s[60:61], s[60:61], s[62:63]
    s_or_b64 s[56:57], s[56:57], s[60:61]
    s_cbranch_scc0 L_polled_32
    s_cmp_lt_u32 s6, 1048576
    s_cbranch_scc1 L_poll_31
    s_branch L_main_end
L_polled_32:
L_pollout_33:
    s_barrier
    s_add_u32 m0, s24, 0
    s_nop 0
    buffer_load_dwordx4 v2, s[8:11], s22 offen offset:0 sc1 lds
    s_add_u32 m0, s24, 512
    s_nop 0
    buffer_load_dwordx4 v2, s[8:11], s22 offen offset:512 sc1 lds
    s_add_u32 m0, s24, 1024
    s_nop 0
    buffer_load_dwordx4 v2, s[8:11], s22 offen offset:1024 sc1 lds
    s_add_u32 m0, s24, 1536
    s_nop 0
    buffer_load_dwordx4 v2, s[8:11], s22 offen offset:1536 sc1 lds
    s_add_u32 m0, s24, 2048
    s_nop 0
    buffer_load_dwordx4 v2, s[8:11], s22 offen offset:2048 sc1 lds
    s_add_u32 m0, s24, 2560
    s_nop 0
    buffer_load_dwordx4 v2, s[8:11], s22 offen offset:2560 sc1 lds
    s_add_u32 m0, s24, 3072
    s_nop 0
    buffer_load_dwordx4 v2, s[8:11], s22 offen offset:3072 sc1 lds
    s_add_u32 m0, s24, 3584
    s_nop 0
    buffer_load_dwordx4 v2, s[8:11], s22 offen offset:3584 sc1 lds
    s_add_u32 m0, s24, 8192
    s_add_u32 s22, s22, 4096
    buffer_load_dwordx4 v2, s[8:11], s22 offen offset:0 sc1 lds
    s_add_u32 m0, s24, 8704
    s_nop 0
    buffer_load_dwordx4 v2, s[8:11], s22 offen offset:512 sc1 lds
    s_add_u32 m0, s24, 9216
    s_nop 0
    buffer_load_dwordx4 v2, s[8:11], s22 offen offset:1024 sc1 lds
    s_add_u32 m0, s24, 9728
    s_nop 0
    buffer_load_dwordx4 v2, s[8:11], s22 offen offset:1536 sc1 lds
    s_add_u32 s23, s23, 15360
    s_lshr_b32 s7, s3, 1
    s_lshl_b32 s7, s7, 10
    s_and_b32 s6, s3, 1
    s_lshl_b32 s6, s6, 3
    s_add_u32 s28, s7, s6
    s_add_u32 s28, s28, 73728
    s_waitcnt vmcnt(6)
    s_barrier
    ds_read_b128 a[0:3], v184 offset:0
    ds_read_b128 a[72:75], v184 offset:18432
    ds_read_b128 a[144:147], v11 offset:0
    ds_read_b128 a[216:219], v11 offset:18432
    ds_read_b128 a[4:7], v184 offset:1024
    ds_read_b128 a[76:79], v184 offset:19456
    ds_read_b128 a[148:151], v11 offset:1024
    ds_read_b128 a[220:223], v11 offset:19456
    ds_read_b128 a[8:11], v184 offset:2048
    ds_read_b128 a[80:83], v184 offset:20480
    ds_read_b128 a[152:155], v11 offset:2048
    ds_read_b128 a[224:227], v11 offset:20480
    s_waitcnt vmcnt(24) lgkmcnt(0)
    v_mfma_f32_16x16x32_bf16 v[88:91], v[16:19], a[0:3], 0
    ds_read_b128 a[12:15], v184 offset:3072
    v_mfma_f32_16x16x32_bf16 v[88:91], v[20:23], a[4:7], v[88:91]
    buffer_load_dwordx4 v[76:79], v184, s[48:51], s23 offen offset:0 sc1
    v_mfma_f32_16x16x32_bf16 v[88:91], v[24:27], a[8:11], v[88:91]
    ds_read_b128 a[84:87], v184 offset:21504
    v_mfma_f32_16x16x32_bf16 v[92:95], v[16:19], a[72:75], 0
    s_add_u32 m0, s24, 10240
    s_nop 0
    buffer_load_dwordx4 v2, s[8:11], s22 offen offset:2048 sc1 lds
    v_mfma_f32_16x16x32_bf16 v[92:95], v[20:23], a[76:79], v[92:95]
    ds_read_b128 a[156:159], v11 offset:3072
    ds_read_b128 a[228:231], v11 offset:21504
    v_mfma_f32_16x16x32_bf16 v[92:95], v[24:27], a[80:83], v[92:95]
    buffer_load_dwordx4 v[80:83], v184, s[48:51], s23 offen offset:1024 sc1
    v_mfma_f32_16x16x32_bf16 v[96:99], v[16:19], a[144:147], 0
    ds_read_b128 a[16:19], v184 offset:4096
    v_mfma_f32_16x16x32_bf16 v[96:99], v[20:23], a[148:151], v[96:99]
    s_add_u32 m0, s24, 10752
    s_nop 0
    buffer_load_dwordx4 v2, s[8:11], s22 offen offset:2560 sc1 lds
    v_mfma_f32_16x16x32_bf16 v[96:99], v[24:27], a[152:155], v[96:99]
    ds_read_b128 a[88:91], v184 offset:22528
    v_mfma_f32_16x16x32_bf16 v[100:103], v[16:19], a[216:219], 0
    buffer_load_dwordx4 v[84:87], v184, s[48:51], s23 offen offset:2048 sc1
    v_mfma_f32_16x16x32_bf16 v[100:103], v[20:23], a[220:223], v[100:103]
    ds_read_b128 a[160:163], v11 offset:4096
    ds_read_b128 a[232:235], v11 offset:22528
    v_mfma_f32_16x16x32_bf16 v[100:103], v[24:27], a[224:227], v[100:103]
    s_add_u32 m0, s24, 11264
    s_nop 0
    buffer_load_dwordx4 v2, s[8:11], s22 offen offset:3072 sc1 lds
    s_waitcnt vmcnt(27) lgkmcnt(8)
    v_mfma_f32_16x16x32_bf16 v[104:107], v[28:31], a[0:3], 0
    ds_read_b128 a[20:23], v184 offset:5120
    v_mfma_f32_16x16x32_bf16 v[104:107], v[32:35], a[4:7], v[104:107]
    buffer_load_dwordx4 v[16:19], v184, s[48:51], s23 offen offset:3072 sc1
    v_mfma_f32_16x16x32_bf16 v[104:107], v[36:39], a[8:11], v[104:107]
    ds_read_b128 a[92:95], v184 offset:23552
    v_mfma_f32_16x16x32_bf16 v[108:111], v[28:31], a[72:75], 0
    s_add_u32 m0, s24, 11776
    s_nop 0
    buffer_load_dwordx4 v2, s[8:11], s22 offen offset:3584 sc1 lds
    v_mfma_f32_16x16x32_bf16 v[108:111], v[32:35], a[76:79], v[108:111]
    ds_read_b128 a[164:167], v11 offset:5120
    ds_read_b128 a[236:239], v11 offset:23552
    v_mfma_f32_16x16x32_bf16 v[108:111], v[36:39], a[80:83], v[108:111]
    buffer_load_dwordx4 v[20:23], v185, s[48:51], s23 offen offset:0 sc1
    v_mfma_f32_16x16x32_bf16 v[112:115], v[28:31], a[144:147], 0
    v_mfma_f32_16x16x32_bf16 v[112:115], v[32:35], a[148:151], v[112:115]
    s_add_u32 m0, s24, 16384
    s_add_u32 s22, s22, 4096
    buffer_load_dwordx4 v2, s[8:11], s22 offen offset:0 sc1 lds
    v_mfma_f32_16x16x32_bf16 v[112:115], v[36:39], a[152:155], v[112:115]
    v_mfma_f32_16x16x32_bf16 v[116:119], v[28:31], a[216:219], 0
    buffer_load_dwordx4 v[24:27], v185, s[48:51], s23 offen offset:1024 sc1
    v_mfma_f32_16x16x32_bf16 v[116:119], v[32:35], a[220:223], v[116:119]
    v_mfma_f32_16x16x32_bf16 v[116:119], v[36:39], a[224:227], v[116:119]
    s_add_u32 m0, s24, 16896
    s_nop 0
    buffer_load_dwordx4 v2, s[8:11], s22 offen offset:512 sc1 lds
    s_waitcnt vmcnt(12) lgkmcnt(0)
    s_barrier
    v_mfma_f32_16x16x32_bf16 v[88:91], v[40:43], a[12:15], v[88:91]
    ds_read_b128 a[24:27], v184 offset:6144
    v_mfma_f32_16x16x32_bf16 v[88:91], v[44:47], a[16:19], v[88:91]
    buffer_load_dwordx4 v[28:31], v185, s[48:51], s23 offen offset:2048 sc1
    v_mfma_f32_16x16x32_bf16 v[88:91], v[48:51], a[20:23], v[88:91]
    ds_read_b128 a[96:99], v184 offset:24576
    v_mfma_f32_16x16x32_bf16 v[92:95], v[40:43], a[84:87], v[92:95]
    buffer_load_dword v136, v3, s[8:11], s25 offen offset:0 sc1
    v_mfma_f32_16x16x32_bf16 v[92:95], v[44:47], a[88:91], v[92:95]
    ds_read_b128 a[168:171], v11 offset:6144
    ds_read_b128 a[240:243], v11 offset:24576
    v_mfma_f32_16x16x32_bf16 v[92:95], v[48:51], a[92:95], v[92:95]
    buffer_load_dwordx4 v[32:35], v185, s[48:51], s23 offen offset:3072 sc1
    v_mfma_f32_16x16x32_bf16 v[96:99], v[40:43], a[156:159], v[96:99]
    buffer_load_dword v137, v3, s[8:11], s25 offen offset:128 sc1
    v_mfma_f32_16x16x32_bf16 v[96:99], v[44:47], a[160:163], v[96:99]
    buffer_load_dword v138, v3, s[8:11], s25 offen offset:256 sc1
    v_mfma_f32_16x16x32_bf16 v[96:99], v[48:51], a[164:167], v[96:99]
    ds_read_b128 a[28:31], v184 offset:7168
    ds_read_b128 a[100:103], v184 offset:25600
    v_mfma_f32_16x16x32_bf16 v[100:103], v[40:43], a[228:231], v[100:103]
    buffer_load_dwordx4 v[36:39], v186, s[48:51], s23 offen offset:0 sc1
    v_mfma_f32_16x16x32_bf16 v[100:103], v[44:47], a[232:235], v[100:103]
    buffer_load_dword v139, v3, s[8:11], s25 offen offset:384 sc1
    v_mfma_f32_16x16x32_bf16 v[100:103], v[48:51], a[236:239], v[100:103]
    buffer_load_dword v140, v3, s[8:11], s25 offen offset:512 sc1
    s_waitcnt vmcnt(35) lgkmcnt(6)
    v_mfma_f32_16x16x32_bf16 v[104:107], v[52:55], a[12:15], v[104:107]
    ds_read_b128 a[172:175], v11 offset:7168
    ds_read_b128 a[244:247], v11 offset:25600
    v_mfma_f32_16x16x32_bf16 v[104:107], v[56:59], a[16:19], v[104:107]
    buffer_load_dwordx4 v[40:43], v186, s[48:51], s23 offen offset:1024 sc1
    v_mfma_f32_16x16x32_bf16 v[104:107], v[60:63], a[20:23], v[104:107]
    ds_read_b128 a[32:35], v184 offset:8192
    ds_read_b128 a[104:107], v184 offset:26624
    v_mfma_f32_16x16x32_bf16 v[108:111], v[52:55], a[84:87], v[108:111]
    buffer_load_dword v141, v3, s[8:11], s25 offen offset:640 sc1
    v_mfma_f32_16x16x32_bf16 v[108:111], v[56:59], a[88:91], v[108:111]
    ds_read_b128 a[176:179], v11 offset:8192
    ds_read_b128 a[248:251], v11 offset:26624
    v_mfma_f32_16x16x32_bf16 v[108:111], v[60:63], a[92:95], v[108:111]
    buffer_load_dwordx4 v[44:47], v186, s[48:51], s23 offen offset:2048 sc1
    v_mfma_f32_16x16x32_bf16 v[112:115], v[52:55], a[156:159], v[112:115]
    buffer_load_dword v142, v3, s[8:11], s25 offen offset:768 sc1
    v_mfma_f32_16x16x32_bf16 v[112:115], v[56:59], a[160:163], v[112:115]
    buffer_load_dword v143, v3, s[8:11], s25 offen offset:896 sc1
    v_mfma_f32_16x16x32_bf16 v[112:115], v[60:63], a[164:167], v[112:115]
    v_mfma_f32_16x16x32_bf16 v[116:119], v[52:55], a[228:231], v[116:119]
    buffer_load_dwordx4 v[48:51], v186, s[48:51], s23 offen offset:3072 sc1
    v_mfma_f32_16x16x32_bf16 v[116:119], v[56:59], a[232:235], v[116:119]
    buffer_load_dword v144, v3, s[8:11], s25 offen offset:1024 sc1
    v_mfma_f32_16x16x32_bf16 v[116:119], v[60:63], a[236:239], v[116:119]
    buffer_load_dword v145, v3, s[8:11], s25 offen offset:1152 sc1
    s_waitcnt vmcnt(40) lgkmcnt(0)
    v_mfma_f32_16x16x32_bf16 v[88:91], v[64:67], a[24:27], v[88:91]
    ds_read_b128 a[36:39], v184 offset:9216
    v_mfma_f32_16x16x32_bf16 v[88:91], v[68:71], a[28:31], v[88:91]
    buffer_load_dwordx4 v[52:55], v187, s[48:51], s23 offen offset:0 sc1
    v_mfma_f32_16x16x32_bf16 v[88:91], v[72:75], a[32:35], v[88:91]
    ds_read_b128 a[108:111], v184 offset:27648
    v_mfma_f32_16x16x32_bf16 v[92:95], v[64:67], a[96:99], v[92:95]
    buffer_load_dword v146, v3, s[8:11], s25 offen offset:1280 sc1
    v_mfma_f32_16x16x32_bf16 v[92:95], v[68:71], a[100:103], v[92:95]
    ds_read_b128 a[180:183], v11 offset:9216
    ds_read_b128 a[252:255], v11 offset:27648
    v_mfma_f32_16x16x32_bf16 v[92:95], v[72:75], a[104:107], v[92:95]
    buffer_load_dwordx4 v[56:59], v187, s[48:51], s23 offen offset:1024 sc1
    v_mfma_f32_16x16x32_bf16 v[96:99], v[64:67], a[168:171], v[96:99]
    buffer_load_dword v147, v3, s[8:11], s25 offen offset:1408 sc1
    v_mfma_f32_16x16x32_bf16 v[96:99], v[68:71], a[172:175], v[96:99]
    buffer_load_dword v148, v3, s[8:11], s25 offen offset:1536 sc1
    v_mfma_f32_16x16x32_bf16 v[96:99], v[72:75], a[176:179], v[96:99]
    ds_read_b128 a[40:43], v184 offset:10240
    ds_read_b128 a[112:115], v184 offset:28672
    v_mfma_f32_16x16x32_bf16 v[100:103], v[64:67], a[240:243], v[100:103]
    buffer_load_dwordx4 v[60:63], v187, s[48:51], s23 offen offset:2048 sc1
    v_mfma_f32_16x16x32_bf16 v[100:103], v[68:71], a[244:247], v[100:103]
    buffer_load_dword v149, v3, s[8:11], s25 offen offset:1664 sc1
    v_mfma_f32_16x16x32_bf16 v[100:103], v[72:75], a[248:251], v[100:103]
    buffer_load_dword v150, v3, s[8:11], s25 offen offset:1792 sc1
    s_waitcnt vmcnt(31) lgkmcnt(6)
    v_mfma_f32_16x16x32_bf16 v[104:107], v[76:79], a[24:27], v[104:107]
    ds_read_b128 a[184:187], v11 offset:10240
    ds_read_b128 v[220:223], v11 offset:28672
    v_mfma_f32_16x16x32_bf16 v[104:107], v[80:83], a[28:31], v[104:107]
    buffer_load_dwordx4 v[64:67], v187, s[48:51], s23 offen offset:3072 sc1
    v_mfma_f32_16x16x32_bf16 v[104:107], v[84:87], a[32:35], v[104:107]
    ds_read_b128 a[44:47], v184 offset:11264
    ds_read_b128 a[116:119], v184 offset:29696
    v_mfma_f32_16x16x32_bf16 v[108:111], v[76:79], a[96:99], v[108:111]
    buffer_load_dword v151, v3, s[8:11], s25 offen offset:1920 sc1
    v_mfma_f32_16x16x32_bf16 v[108:111], v[80:83], a[100:103], v[108:111]
    ds_read_b128 a[188:191], v11 offset:11264
    ds_read_b128 v[224:227], v11 offset:29696
    v_mfma_f32_16x16x32_bf16 v[108:111], v[84:87], a[104:107], v[108:111]
    buffer_load_dwordx4 v[68:71], v188, s[48:51], s23 offen offset:0 sc1
    v_mfma_f32_16x16x32_bf16 v[112:115], v[76:79], a[168:171], v[112:115]
    v_mfma_f32_16x16x32_bf16 v[112:115], v[80:83], a[172:175], v[112:115]
    v_mfma_f32_16x16x32_bf16 v[112:115], v[84:87], a[176:179], v[112:115]
    v_mfma_f32_16x16x32_bf16 v[116:119], v[76:79], a[240:243], v[116:119]
    buffer_load_dwordx4 v[72:75], v188, s[48:51], s23 offen offset:1024 sc1
    v_mfma_f32_16x16x32_bf16 v[116:119], v[80:83], a[244:247], v[116:119]
    v_mfma_f32_16x16x32_bf16 v[116:119], v[84:87], a[248:251], v[116:119]
    s_waitcnt vmcnt(28) lgkmcnt(0)
    s_barrier
    v_mfma_f32_16x16x32_bf16 v[88:91], v[16:19], a[36:39], v[88:91]
    ds_read_b128 a[48:51], v184 offset:12288
    v_mfma_f32_16x16x32_bf16 v[88:91], v[20:23], a[40:43], v[88:91]
    buffer_load_dwordx4 v[76:79], v188, s[48:51], s23 offen offset:2048 sc1
    v_mfma_f32_16x16x32_bf16 v[88:91], v[24:27], a[44:47], v[88:91]
    ds_read_b128 a[120:123], v184 offset:30720
    v_mfma_f32_16x16x32_bf16 v[92:95], v[16:19], a[108:111], v[92:95]
    ds_read_b128 a[192:195], v11 offset:12288
    v_mfma_f32_16x16x32_bf16 v[92:95], v[20:23], a[112:115], v[92:95]
    ds_read_b128 v[228:231], v11 offset:30720
    v_mfma_f32_16x16x32_bf16 v[92:95], v[24:27], a[116:119], v[92:95]
    buffer_load_dwordx4 v[80:83], v188, s[48:51], s23 offen offset:3072 sc1
    v_mfma_f32_16x16x32_bf16 v[96:99], v[16:19], a[180:183], v[96:99]
    ds_read_b128 a[52:55], v184 offset:13312
    v_mfma_f32_16x16x32_bf16 v[96:99], v[20:23], a[184:187], v[96:99]
    ds_read_b128 a[124:127], v184 offset:31744
    v_mfma_f32_16x16x32_bf16 v[96:99], v[24:27], a[188:191], v[96:99]
    v_mfma_f32_16x16x32_bf16 v[100:103], v[16:19], a[252:255], v[100:103]
    buffer_load_dwordx4 v[84:87], v189, s[48:51], s23 offen offset:0 sc1
    v_mfma_f32_16x16x32_bf16 v[100:103], v[20:23], v[220:223], v[100:103]
    ds_read_b128 a[196:199], v11 offset:13312
    ds_read_b128 v[232:235], v11 offset:31744
    v_mfma_f32_16x16x32_bf16 v[100:103], v[24:27], v[224:227], v[100:103]
    s_waitcnt vmcnt(25) lgkmcnt(8)
    v_mfma_f32_16x16x32_bf16 v[104:107], v[28:31], a[36:39], v[104:107]
    ds_read_b128 a[56:59], v184 offset:14336
    v_mfma_f32_16x16x32_bf16 v[104:107], v[32:35], a[40:43], v[104:107]
    buffer_load_dwordx4 v[16:19], v189, s[48:51], s23 offen offset:1024 sc1
    v_mfma_f32_16x16x32_bf16 v[104:107], v[36:39], a[44:47], v[104:107]
    ds_read_b128 a[128:131], v184 offset:32768
    v_mfma_f32_16x16x32_bf16 v[108:111], v[28:31], a[108:111], v[108:111]
    ds_read_b128 a[200:203], v11 offset:14336
    v_mfma_f32_16x16x32_bf16 v[108:111], v[32:35], a[112:115], v[108:111]
    ds_read_b128 v[236:239], v11 offset:32768
    v_mfma_f32_16x16x32_bf16 v[108:111], v[36:39], a[116:119], v[108:111]
    buffer_load_dwordx4 v[20:23], v189, s[48:51], s23 offen offset:2048 sc1
    v_mfma_f32_16x16x32_bf16 v[112:115], v[28:31], a[180:183], v[112:115]
    v_mfma_f32_16x16x32_bf16 v[112:115], v[32:35], a[184:187], v[112:115]
    v_mfma_f32_16x16x32_bf16 v[112:115], v[36:39], a[188:191], v[112:115]
    v_mfma_f32_16x16x32_bf16 v[116:119], v[28:31], a[252:255], v[116:119]
    buffer_load_dwordx4 v[24:27], v189, s[48:51], s23 offen offset:3072 sc1
    v_mfma_f32_16x16x32_bf16 v[116:119], v[32:35], v[220:223], v[116:119]
    v_mfma_f32_16x16x32_bf16 v[116:119], v[36:39], v[224:227], v[116:119]
    s_waitcnt vmcnt(8) lgkmcnt(0)
    v_mfma_f32_16x16x32_bf16 v[88:91], v[40:43], a[48:51], v[88:91]
    ds_read_b128 a[60:63], v184 offset:15360
    v_add_f32 v136, v136, v144
    v_mfma_f32_16x16x32_bf16 v[88:91], v[44:47], a[52:55], v[88:91]
    buffer_load_dwordx4 v[28:31], v190, s[48:51], s23 offen offset:0 sc1
    v_mfma_f32_16x16x32_bf16 v[88:91], v[48:51], a[56:59], v[88:91]
    ds_read_b128 a[132:135], v184 offset:33792
    v_add_f32 v137, v137, v145
    v_mfma_f32_16x16x32_bf16 v[92:95], v[40:43], a[120:123], v[92:95]
    ds_read_b128 a[204:207], v11 offset:15360
    v_add_f32 v138, v138, v146
    v_mfma_f32_16x16x32_bf16 v[92:95], v[44:47], a[124:127], v[92:95]
    ds_read_b128 v[240:243], v11 offset:33792
    v_add_f32 v139, v139, v147
    v_mfma_f32_16x16x32_bf16 v[92:95], v[48:51], a[128:131], v[92:95]
    buffer_load_dwordx4 v[32:35], v190, s[48:51], s23 offen offset:1024 sc1
    v_mfma_f32_16x16x32_bf16 v[96:99], v[40:43], a[192:195], v[96:99]
    ds_read_b128 a[64:67], v184 offset:16384
    v_add_f32 v140, v140, v148
    v_mfma_f32_16x16x32_bf16 v[96:99], v[44:47], a[196:199], v[96:99]
    ds_read_b128 a[136:139], v184 offset:34816
    v_add_f32 v141, v141, v149
    v_mfma_f32_16x16x32_bf16 v[96:99], v[48:51], a[200:203], v[96:99]
    v_add_f32 v142, v142, v150
    v_add_f32 v143, v143, v151
    v_mfma_f32_16x16x32_bf16 v[100:103], v[40:43], v[228:231], v[100:103]
    buffer_load_dwordx4 v[36:39], v190, s[48:51], s23 offen offset:2048 sc1
    v_mfma_f32_16x16x32_bf16 v[100:103], v[44:47], v[232:235], v[100:103]
    ds_read_b128 a[208:211], v11 offset:16384
    ds_read_b128 v[244:247], v11 offset:34816
    v_mfma_f32_16x16x32_bf16 v[100:103], v[48:51], v[236:239], v[100:103]
    v_add_f32 v136, v136, v140
    v_add_f32 v137, v137, v141
    s_waitcnt vmcnt(15) lgkmcnt(8)
    v_mfma_f32_16x16x32_bf16 v[104:107], v[52:55], a[48:51], v[104:107]
    ds_read_b128 a[68:71], v184 offset:17408
    v_add_f32 v138, v138, v142
    v_mfma_f32_16x16x32_bf16 v[104:107], v[56:59], a[52:55], v[104:107]
    buffer_load_dwordx4 v[40:43], v190, s[48:51], s23 offen offset:3072 sc1
    v_mfma_f32_16x16x32_bf16 v[104:107], v[60:63], a[56:59], v[104:107]
    ds_read_b128 a[140:143], v184 offset:35840
    v_add_f32 v139, v139, v143
    v_mfma_f32_16x16x32_bf16 v[108:111], v[52:55], a[120:123], v[108:111]
    ds_read_b128 a[212:215], v11 offset:17408
    v_add_f32 v136, v136, v138
    v_mfma_f32_16x16x32_bf16 v[108:111], v[56:59], a[124:127], v[108:111]
    ds_read_b128 v[248:251], v11 offset:35840
    v_add_f32 v137, v137, v139
    v_mfma_f32_16x16x32_bf16 v[108:111], v[60:63], a[128:131], v[108:111]
    buffer_load_dwordx4 v[44:47], v191, s[48:51], s23 offen offset:0 sc1
    v_mfma_f32_16x16x32_bf16 v[112:115], v[52:55], a[192:195], v[112:115]
    v_add_f32 v136, v136, v137
    v_mov_b32 v137, 0x3727c5ac
    v_mfma_f32_16x16x32_bf16 v[112:115], v[56:59], a[196:199], v[112:115]
    v_fmac_f32 v137, 0x3ae38e39, v136
    v_mov_b32 v193, v137
    v_mfma_f32_16x16x32_bf16 v[112:115], v[60:63], a[200:203], v[112:115]
    s_nop 0
    v_permlane16_swap_b32 v193, v137
    v_mfma_f32_16x16x32_bf16 v[116:119], v[52:55], v[228:231], v[116:119]
    buffer_load_dwordx4 v[48:51], v191, s[48:51], s23 offen offset:1024 sc1
    v_mfma_f32_16x16x32_bf16 v[116:119], v[56:59], v[232:235], v[116:119]
    v_mov_b32 v195, v193
    v_mov_b32 v194, v137
    v_mfma_f32_16x16x32_bf16 v[116:119], v[60:63], v[236:239], v[116:119]
    v_mov_b32 v252, v137
    s_waitcnt vmcnt(12) lgkmcnt(0)
    v_mfma_f32_16x16x32_bf16 v[88:91], v[64:67], a[60:63], v[88:91]
    s_nop 0
    v_permlane32_swap_b32 v193, v195
    v_mfma_f32_16x16x32_bf16 v[88:91], v[68:71], a[64:67], v[88:91]
    buffer_load_dwordx4 v[52:55], v191, s[48:51], s23 offen offset:2048 sc1
    v_mfma_f32_16x16x32_bf16 v[120:123], v[72:75], a[68:71], v[88:91]
    v_permlane32_swap_b32 v194, v252
    v_mfma_f32_16x16x32_bf16 v[92:95], v[64:67], a[132:135], v[92:95]
    v_rsq_f32 v4, v193
    v_mfma_f32_16x16x32_bf16 v[92:95], v[68:71], a[136:139], v[92:95]
    v_rsq_f32 v5, v194
    v_mfma_f32_16x16x32_bf16 v[124:127], v[72:75], a[140:143], v[92:95]
    buffer_load_dwordx4 v[56:59], v191, s[48:51], s23 offen offset:3072 sc1
    v_mfma_f32_16x16x32_bf16 v[96:99], v[64:67], a[204:207], v[96:99]
    v_rsq_f32 v6, v195
    v_mfma_f32_16x16x32_bf16 v[96:99], v[68:71], a[208:211], v[96:99]
    v_rsq_f32 v7, v252
    v_mfma_f32_16x16x32_bf16 v[128:131], v[72:75], a[212:215], v[96:99]
    v_mul_f32 v8, v4, v4
    v_mul_f32 v9, v5, v5
    v_mfma_f32_16x16x32_bf16 v[100:103], v[64:67], v[240:243], v[100:103]
    buffer_load_dwordx4 v[60:63], v192, s[48:51], s23 offen offset:0 sc1
    v_mfma_f32_16x16x32_bf16 v[100:103], v[68:71], v[244:247], v[100:103]
    v_mul_f32 v13, v6, v6
    v_mul_f32 v14, v7, v7
    v_mfma_f32_16x16x32_bf16 v[132:135], v[72:75], v[248:251], v[100:103]
    v_mul_f32 v4, 0xc0135761, v4
    v_mul_f32 v5, 0xc0135761, v5
    s_waitcnt vmcnt(12) lgkmcnt(0)
    v_mfma_f32_16x16x32_bf16 v[104:107], v[76:79], a[60:63], v[104:107]
    v_mul_f32 v6, 0xc0135761, v6
    v_mul_f32 v7, 0xc0135761, v7
    v_mfma_f32_16x16x32_bf16 v[104:107], v[80:83], a[64:67], v[104:107]
    buffer_load_dwordx4 v[64:67], v192, s[48:51], s23 offen offset:1024 sc1
    v_mfma_f32_16x16x32_bf16 v[136:139], v[84:87], a[68:71], v[104:107]
    v_mul_f32 v8, 0x3d372713, v8
    v_mul_f32 v9, 0x3d372713, v9
    v_mfma_f32_16x16x32_bf16 v[108:111], v[76:79], a[132:135], v[108:111]
    v_mul_f32 v13, 0x3d372713, v13
    v_mul_f32 v14, 0x3d372713, v14
    v_mfma_f32_16x16x32_bf16 v[108:111], v[80:83], a[136:139], v[108:111]
    v_mul_f32 v8, v8, v4
    v_mul_f32 v9, v9, v5
    v_mfma_f32_16x16x32_bf16 v[140:143], v[84:87], a[140:143], v[108:111]
    buffer_load_dwordx4 v[68:71], v192, s[48:51], s23 offen offset:2048 sc1
    v_mfma_f32_16x16x32_bf16 v[112:115], v[76:79], a[204:207], v[112:115]
    v_mul_f32 v13, v13, v6
    v_mul_f32 v14, v14, v7
    v_mfma_f32_16x16x32_bf16 v[112:115], v[80:83], a[208:211], v[112:115]
    s_mov_b32 s25, 0
    v_mfma_f32_16x16x32_bf16 v[144:147], v[84:87], a[212:215], v[112:115]
    s_mov_b32 s7, s28
    v_mfma_f32_16x16x32_bf16 v[116:119], v[76:79], v[240:243], v[116:119]
    buffer_load_dwordx4 v[72:75], v192, s[48:51], s23 offen offset:3072 sc1
    v_mfma_f32_16x16x32_bf16 v[116:119], v[80:83], v[244:247], v[116:119]
    s_add_u32 s23, s23, 36864
    v_mfma_f32_16x16x32_bf16 v[148:151], v[84:87], v[248:251], v[116:119]
    v_add_u32 v12, s7, v184
    s_add_u32 s25, s25, 1
L_ffn_gu_34:
    s_waitcnt vmcnt(12)
    v_mfma_f32_16x16x32_bf16 v[88:91], v[16:19], a[0:3], 0
    v_mfma_f32_16x16x32_bf16 v[88:91], v[20:23], a[4:7], v[88:91]
    buffer_load_dwordx4 v[76:79], v184, s[48:51], s23 offen offset:0 sc1
    v_mfma_f32_16x16x32_bf16 v[88:91], v[24:27], a[8:11], v[88:91]
    v_mul_f32 v152, v120, v120
    v_mul_f32 v153, v121, v121
    v_mfma_f32_16x16x32_bf16 v[92:95], v[16:19], a[72:75], 0
    v_mul_f32 v154, v122, v122
    v_mul_f32 v155, v123, v123
    v_mfma_f32_16x16x32_bf16 v[92:95], v[20:23], a[76:79], v[92:95]
    v_fma_f32 v152, v152, v8, v4
    v_fma_f32 v153, v153, v8, v4
    v_mfma_f32_16x16x32_bf16 v[92:95], v[24:27], a[80:83], v[92:95]
    buffer_load_dwordx4 v[80:83], v184, s[48:51], s23 offen offset:1024 sc1
    v_mfma_f32_16x16x32_bf16 v[96:99], v[16:19], a[144:147], 0
    v_fma_f32 v154, v154, v8, v4
    v_fma_f32 v155, v155, v8, v4
    v_mfma_f32_16x16x32_bf16 v[96:99], v[20:23], a[148:151], v[96:99]
    v_mul_f32 v152, v120, v152
    v_mul_f32 v153, v121, v153
    v_mfma_f32_16x16x32_bf16 v[96:99], v[24:27], a[152:155], v[96:99]
    v_mul_f32 v154, v122, v154
    v_mul_f32 v155, v123, v155
    v_mfma_f32_16x16x32_bf16 v[100:103], v[16:19], a[216:219], 0
    buffer_load_dwordx4 v[84:87], v184, s[48:51], s23 offen offset:2048 sc1
    v_mfma_f32_16x16x32_bf16 v[100:103], v[20:23], a[220:223], v[100:103]
    v_exp_f32 v152, v152
    v_mfma_f32_16x16x32_bf16 v[100:103], v[24:27], a[224:227], v[100:103]
    v_exp_f32 v153, v153
    s_waitcnt vmcnt(12)
    v_mfma_f32_16x16x32_bf16 v[104:107], v[28:31], a[0:3], 0
    v_exp_f32 v154, v154
    v_mfma_f32_16x16x32_bf16 v[104:107], v[32:35], a[4:7], v[104:107]
    buffer_load_dwordx4 v[16:19], v184, s[48:51], s23 offen offset:3072 sc1
    v_mfma_f32_16x16x32_bf16 v[104:107], v[36:39], a[8:11], v[104:107]
    v_exp_f32 v155, v155
    v_mfma_f32_16x16x32_bf16 v[108:111], v[28:31], a[72:75], 0
    v_mul_f32 v156, v120, v136
    v_mul_f32 v157, v121, v137
    v_mfma_f32_16x16x32_bf16 v[108:111], v[32:35], a[76:79], v[108:111]
    v_mul_f32 v158, v122, v138
    v_mul_f32 v159, v123, v139
    v_mfma_f32_16x16x32_bf16 v[108:111], v[36:39], a[80:83], v[108:111]
    buffer_load_dwordx4 v[20:23], v185, s[48:51], s23 offen offset:0 sc1
    v_mfma_f32_16x16x32_bf16 v[112:115], v[28:31], a[144:147], 0
    v_fma_f32 v152, v152, v193, v193
    v_fma_f32 v153, v153, v193, v193
    v_mfma_f32_16x16x32_bf16 v[112:115], v[32:35], a[148:151], v[112:115]
    v_fma_f32 v154, v154, v193, v193
    v_fma_f32 v155, v155, v193, v193
    v_mfma_f32_16x16x32_bf16 v[112:115], v[36:39], a[152:155], v[112:115]
    v_rcp_f32 v152, v152
    v_mfma_f32_16x16x32_bf16 v[116:119], v[28:31], a[216:219], 0
    buffer_load_dwordx4 v[24:27], v185, s[48:51], s23 offen offset:1024 sc1
    v_mfma_f32_16x16x32_bf16 v[116:119], v[32:35], a[220:223], v[116:119]
    v_rcp_f32 v153, v153
    v_mfma_f32_16x16x32_bf16 v[116:119], v[36:39], a[224:227], v[116:119]
    v_rcp_f32 v154, v154
    s_waitcnt vmcnt(12)
    v_mfma_f32_16x16x32_bf16 v[88:91], v[40:43], a[12:15], v[88:91]
    v_rcp_f32 v155, v155
    v_mfma_f32_16x16x32_bf16 v[88:91], v[44:47], a[16:19], v[88:91]
    buffer_load_dwordx4 v[28:31], v185, s[48:51], s23 offen offset:2048 sc1
    v_mfma_f32_16x16x32_bf16 v[88:91], v[48:51], a[20:23], v[88:91]
    v_mul_f32 v156, v156, v152
    v_mul_f32 v157, v157, v153
    v_mfma_f32_16x16x32_bf16 v[92:95], v[40:43], a[84:87], v[92:95]
    v_mul_f32 v158, v158, v154
    v_mul_f32 v159, v159, v155
    v_mfma_f32_16x16x32_bf16 v[92:95], v[44:47], a[88:91], v[92:95]
    v_cvt_pk_bf16_f32 v160, v156, v157
    v_cvt_pk_bf16_f32 v161, v158, v159
    v_mfma_f32_16x16x32_bf16 v[92:95], v[48:51], a[92:95], v[92:95]
    buffer_load_dwordx4 v[32:35], v185, s[48:51], s23 offen offset:3072 sc1
    v_mfma_f32_16x16x32_bf16 v[96:99], v[40:43], a[156:159], v[96:99]
    ds_write_b64 v12, v[160:161] offset:0
    v_mfma_f32_16x16x32_bf16 v[96:99], v[44:47], a[160:163], v[96:99]
    v_mul_f32 v162, v124, v124
    v_mul_f32 v163, v125, v125
    v_mfma_f32_16x16x32_bf16 v[96:99], v[48:51], a[164:167], v[96:99]
    v_mul_f32 v164, v126, v126
    v_mul_f32 v165, v127, v127
    v_mfma_f32_16x16x32_bf16 v[100:103], v[40:43], a[228:231], v[100:103]
    buffer_load_dwordx4 v[36:39], v186, s[48:51], s23 offen offset:0 sc1
    v_mfma_f32_16x16x32_bf16 v[100:103], v[44:47], a[232:235], v[100:103]
    v_fma_f32 v162, v162, v9, v5
    v_fma_f32 v163, v163, v9, v5
    v_mfma_f32_16x16x32_bf16 v[100:103], v[48:51], a[236:239], v[100:103]
    v_fma_f32 v164, v164, v9, v5
    v_fma_f32 v165, v165, v9, v5
    s_waitcnt vmcnt(12)
    v_mfma_f32_16x16x32_bf16 v[104:107], v[52:55], a[12:15], v[104:107]
    v_mul_f32 v162, v124, v162
    v_mul_f32 v163, v125, v163
    v_mfma_f32_16x16x32_bf16 v[104:107], v[56:59], a[16:19], v[104:107]
    buffer_load_dwordx4 v[40:43], v186, s[48:51], s23 offen offset:1024 sc1
    v_mfma_f32_16x16x32_bf16 v[104:107], v[60:63], a[20:23], v[104:107]
    v_mul_f32 v164, v126, v164
    v_mul_f32 v165, v127, v165
    v_mfma_f32_16x16x32_bf16 v[108:111], v[52:55], a[84:87], v[108:111]
    v_exp_f32 v162, v162
    v_mfma_f32_16x16x32_bf16 v[108:111], v[56:59], a[88:91], v[108:111]
    v_exp_f32 v163, v163
    v_mfma_f32_16x16x32_bf16 v[108:111], v[60:63], a[92:95], v[108:111]
    buffer_load_dwordx4 v[44:47], v186, s[48:51], s23 offen offset:2048 sc1
    v_mfma_f32_16x16x32_bf16 v[112:115], v[52:55], a[156:159], v[112:115]
    v_exp_f32 v164, v164
    v_mfma_f32_16x16x32_bf16 v[112:115], v[56:59], a[160:163], v[112:115]
    v_exp_f32 v165, v165
    v_mfma_f32_16x16x32_bf16 v[112:115], v[60:63], a[164:167], v[112:115]
    v_mul_f32 v166, v124, v140
    v_mul_f32 v167, v125, v141
    v_mfma_f32_16x16x32_bf16 v[116:119], v[52:55], a[228:231], v[116:119]
    buffer_load_dwordx4 v[48:51], v186, s[48:51], s23 offen offset:3072 sc1
    v_mfma_f32_16x16x32_bf16 v[116:119], v[56:59], a[232:235], v[116:119]
    v_mul_f32 v168, v126, v142
    v_mul_f32 v169, v127, v143
    v_mfma_f32_16x16x32_bf16 v[116:119], v[60:63], a[236:239], v[116:119]
    v_fma_f32 v162, v162, v194, v194
    v_fma_f32 v163, v163, v194, v194
    s_waitcnt vmcnt(12)
    v_mfma_f32_16x16x32_bf16 v[88:91], v[64:67], a[24:27], v[88:91]
    v_fma_f32 v164, v164, v194, v194
    v_fma_f32 v165, v165, v194, v194
    v_mfma_f32_16x16x32_bf16 v[88:91], v[68:71], a[28:31], v[88:91]
    buffer_load_dwordx4 v[52:55], v187, s[48:51], s23 offen offset:0 sc1
    v_mfma_f32_16x16x32_bf16 v[88:91], v[72:75], a[32:35], v[88:91]
    v_rcp_f32 v162, v162
    v_mfma_f32_16x16x32_bf16 v[92:95], v[64:67], a[96:99], v[92:95]
    v_rcp_f32 v163, v163
    v_mfma_f32_16x16x32_bf16 v[92:95], v[68:71], a[100:103], v[92:95]
    v_rcp_f32 v164, v164
    v_mfma_f32_16x16x32_bf16 v[92:95], v[72:75], a[104:107], v[92:95]
    buffer_load_dwordx4 v[56:59], v187, s[48:51], s23 offen offset:1024 sc1
    v_mfma_f32_16x16x32_bf16 v[96:99], v[64:67], a[168:171], v[96:99]
    v_rcp_f32 v165, v165
    v_mfma_f32_16x16x32_bf16 v[96:99], v[68:71], a[172:175], v[96:99]
    v_mul_f32 v166, v166, v162
    v_mul_f32 v167, v167, v163
    v_mfma_f32_16x16x32_bf16 v[96:99], v[72:75], a[176:179], v[96:99]
    v_mul_f32 v168, v168, v164
    v_mul_f32 v169, v169, v165
    v_mfma_f32_16x16x32_bf16 v[100:103], v[64:67], a[240:243], v[100:103]
    buffer_load_dwordx4 v[60:63], v187, s[48:51], s23 offen offset:2048 sc1
    v_mfma_f32_16x16x32_bf16 v[100:103], v[68:71], a[244:247], v[100:103]
    v_cvt_pk_bf16_f32 v170, v166, v167
    v_cvt_pk_bf16_f32 v171, v168, v169
    v_mfma_f32_16x16x32_bf16 v[100:103], v[72:75], a[248:251], v[100:103]
    ds_write_b64 v12, v[170:171] offset:18432
    s_waitcnt vmcnt(12)
    v_mfma_f32_16x16x32_bf16 v[104:107], v[76:79], a[24:27], v[104:107]
    v_mul_f32 v152, v128, v128
    v_mul_f32 v153, v129, v129
    v_mfma_f32_16x16x32_bf16 v[104:107], v[80:83], a[28:31], v[104:107]
    buffer_load_dwordx4 v[64:67], v187, s[48:51], s23 offen offset:3072 sc1
    v_mfma_f32_16x16x32_bf16 v[104:107], v[84:87], a[32:35], v[104:107]
    v_mul_f32 v154, v130, v130
    v_mul_f32 v155, v131, v131
    v_mfma_f32_16x16x32_bf16 v[108:111], v[76:79], a[96:99], v[108:111]
    v_fma_f32 v152, v152, v13, v6
    v_fma_f32 v153, v153, v13, v6
    v_mfma_f32_16x16x32_bf16 v[108:111], v[80:83], a[100:103], v[108:111]
    v_fma_f32 v154, v154, v13, v6
    v_fma_f32 v155, v155, v13, v6
    v_mfma_f32_16x16x32_bf16 v[108:111], v[84:87], a[104:107], v[108:111]
    buffer_load_dwordx4 v[68:71], v188, s[48:51], s23 offen offset:0 sc1
    v_mfma_f32_16x16x32_bf16 v[112:115], v[76:79], a[168:171], v[112:115]
    v_mul_f32 v152, v128, v152
    v_mul_f32 v153, v129, v153
    v_mfma_f32_16x16x32_bf16 v[112:115], v[80:83], a[172:175], v[112:115]
    v_mul_f32 v154, v130, v154
    v_mul_f32 v155, v131, v155
    v_mfma_f32_16x16x32_bf16 v[112:115], v[84:87], a[176:179], v[112:115]
    v_exp_f32 v152, v152
    v_mfma_f32_16x16x32_bf16 v[116:119], v[76:79], a[240:243], v[116:119]
    buffer_load_dwordx4 v[72:75], v188, s[48:51], s23 offen offset:1024 sc1
    v_mfma_f32_16x16x32_bf16 v[116:119], v[80:83], a[244:247], v[116:119]
    v_exp_f32 v153, v153
    v_mfma_f32_16x16x32_bf16 v[116:119], v[84:87], a[248:251], v[116:119]
    v_exp_f32 v154, v154
    s_waitcnt vmcnt(12)
    v_mfma_f32_16x16x32_bf16 v[88:91], v[16:19], a[36:39], v[88:91]
    v_exp_f32 v155, v155
    v_mfma_f32_16x16x32_bf16 v[88:91], v[20:23], a[40:43], v[88:91]
    buffer_load_dwordx4 v[76:79], v188, s[48:51], s23 offen offset:2048 sc1
    v_mfma_f32_16x16x32_bf16 v[88:91], v[24:27], a[44:47], v[88:91]
    v_mul_f32 v156, v128, v144
    v_mul_f32 v157, v129, v145
    v_mfma_f32_16x16x32_bf16 v[92:95], v[16:19], a[108:111], v[92:95]
    v_mul_f32 v158, v130, v146
    v_mul_f32 v159, v131, v147
    v_mfma_f32_16x16x32_bf16 v[92:95], v[20:23], a[112:115], v[92:95]
    v_fma_f32 v152, v152, v195, v195
    v_fma_f32 v153, v153, v195, v195
    v_mfma_f32_16x16x32_bf16 v[92:95], v[24:27], a[116:119], v[92:95]
    buffer_load_dwordx4 v[80:83], v188, s[48:51], s23 offen offset:3072 sc1
    v_mfma_f32_16x16x32_bf16 v[96:99], v[16:19], a[180:183], v[96:99]
    v_fma_f32 v154, v154, v195, v195
    v_fma_f32 v155, v155, v195, v195
    v_mfma_f32_16x16x32_bf16 v[96:99], v[20:23], a[184:187], v[96:99]
    v_rcp_f32 v152, v152
    v_mfma_f32_16x16x32_bf16 v[96:99], v[24:27], a[188:191], v[96:99]
    v_rcp_f32 v153, v153
    v_mfma_f32_16x16x32_bf16 v[100:103], v[16:19], a[252:255], v[100:103]
    buffer_load_dwordx4 v[84:87], v189, s[48:51], s23 offen offset:0 sc1
    v_mfma_f32_16x16x32_bf16 v[100:103], v[20:23], v[220:223], v[100:103]
    v_rcp_f32 v154, v154
    v_mfma_f32_16x16x32_bf16 v[100:103], v[24:27], v[224:227], v[100:103]
    v_rcp_f32 v155, v155
    s_waitcnt vmcnt(12)
    v_mfma_f32_16x16x32_bf16 v[104:107], v[28:31], a[36:39], v[104:107]
    v_mul_f32 v156, v156, v152
    v_mul_f32 v157, v157, v153
    v_mfma_f32_16x16x32_bf16 v[104:107], v[32:35], a[40:43], v[104:107]
    buffer_load_dwordx4 v[16:19], v189, s[48:51], s23 offen offset:1024 sc1
    v_mfma_f32_16x16x32_bf16 v[104:107], v[36:39], a[44:47], v[104:107]
    v_mul_f32 v158, v158, v154
    v_mul_f32 v159, v159, v155
    v_mfma_f32_16x16x32_bf16 v[108:111], v[28:31], a[108:111], v[108:111]
    v_cvt_pk_bf16_f32 v160, v156, v157
    v_cvt_pk_bf16_f32 v161, v158, v159
    v_mfma_f32_16x16x32_bf16 v[108:111], v[32:35], a[112:115], v[108:111]
    ds_write_b64 v12, v[160:161] offset:36864
    v_mfma_f32_16x16x32_bf16 v[108:111], v[36:39], a[116:119], v[108:111]
    buffer_load_dwordx4 v[20:23], v189, s[48:51], s23 offen offset:2048 sc1
    v_mfma_f32_16x16x32_bf16 v[112:115], v[28:31], a[180:183], v[112:115]
    v_mul_f32 v162, v132, v132
    v_mul_f32 v163, v133, v133
    v_mfma_f32_16x16x32_bf16 v[112:115], v[32:35], a[184:187], v[112:115]
    v_mul_f32 v164, v134, v134
    v_mul_f32 v165, v135, v135
    v_mfma_f32_16x16x32_bf16 v[112:115], v[36:39], a[188:191], v[112:115]
    v_fma_f32 v162, v162, v14, v7
    v_fma_f32 v163, v163, v14, v7
    v_mfma_f32_16x16x32_bf16 v[116:119], v[28:31], a[252:255], v[116:119]
    buffer_load_dwordx4 v[24:27], v189, s[48:51], s23 offen offset:3072 sc1
    v_mfma_f32_16x16x32_bf16 v[116:119], v[32:35], v[220:223], v[116:119]
    v_fma_f32 v164, v164, v14, v7
    v_fma_f32 v165, v165, v14, v7
    v_mfma_f32_16x16x32_bf16 v[116:119], v[36:39], v[224:227], v[116:119]
    v_mul_f32 v162, v132, v162
    v_mul_f32 v163, v133, v163
    s_waitcnt vmcnt(12)
    v_mfma_f32_16x16x32_bf16 v[88:91], v[40:43], a[48:51], v[88:91]
    v_mul_f32 v164, v134, v164
    v_mul_f32 v165, v135, v165
    v_mfma_f32_16x16x32_bf16 v[88:91], v[44:47], a[52:55], v[88:91]
    buffer_load_dwordx4 v[28:31], v190, s[48:51], s23 offen offset:0 sc1
    v_mfma_f32_16x16x32_bf16 v[88:91], v[48:51], a[56:59], v[88:91]
    v_exp_f32 v162, v162
    v_mfma_f32_16x16x32_bf16 v[92:95], v[40:43], a[120:123], v[92:95]
    v_exp_f32 v163, v163
    v_mfma_f32_16x16x32_bf16 v[92:95], v[44:47], a[124:127], v[92:95]
    v_exp_f32 v164, v164
    v_mfma_f32_16x16x32_bf16 v[92:95], v[48:51], a[128:131], v[92:95]
    buffer_load_dwordx4 v[32:35], v190, s[48:51], s23 offen offset:1024 sc1
    v_mfma_f32_16x16x32_bf16 v[96:99], v[40:43], a[192:195], v[96:99]
    v_exp_f32 v165, v165
    v_mfma_f32_16x16x32_bf16 v[96:99], v[44:47], a[196:199], v[96:99]
    v_mul_f32 v166, v132, v148
    v_mul_f32 v167, v133, v149
    v_mfma_f32_16x16x32_bf16 v[96:99], v[48:51], a[200:203], v[96:99]
    v_mul_f32 v168, v134, v150
    v_mul_f32 v169, v135, v151
    v_mfma_f32_16x16x32_bf16 v[100:103], v[40:43], v[228:231], v[100:103]
    buffer_load_dwordx4 v[36:39], v190, s[48:51], s23 offen offset:2048 sc1
    v_mfma_f32_16x16x32_bf16 v[100:103], v[44:47], v[232:235], v[100:103]
    v_fma_f32 v162, v162, v252, v252
    v_fma_f32 v163, v163, v252, v252
    v_mfma_f32_16x16x32_bf16 v[100:103], v[48:51], v[236:239], v[100:103]
    v_fma_f32 v164, v164, v252, v252
    v_fma_f32 v165, v165, v252, v252
    s_waitcnt vmcnt(12)
    v_mfma_f32_16x16x32_bf16 v[104:107], v[52:55], a[48:51], v[104:107]
    v_rcp_f32 v162, v162
    v_mfma_f32_16x16x32_bf16 v[104:107], v[56:59], a[52:55], v[104:107]
    buffer_load_dwordx4 v[40:43], v190, s[48:51], s23 offen offset:3072 sc1
    v_mfma_f32_16x16x32_bf16 v[104:107], v[60:63], a[56:59], v[104:107]
    v_rcp_f32 v163, v163
    v_mfma_f32_16x16x32_bf16 v[108:111], v[52:55], a[120:123], v[108:111]
    v_rcp_f32 v164, v164
    v_mfma_f32_16x16x32_bf16 v[108:111], v[56:59], a[124:127], v[108:111]
    v_rcp_f32 v165, v165
    v_mfma_f32_16x16x32_bf16 v[108:111], v[60:63], a[128:131], v[108:111]
    buffer_load_dwordx4 v[44:47], v191, s[48:51], s23 offen offset:0 sc1
    v_mfma_f32_16x16x32_bf16 v[112:115], v[52:55], a[192:195], v[112:115]
    v_mul_f32 v166, v166, v162
    v_mul_f32 v167, v167, v163
    v_mfma_f32_16x16x32_bf16 v[112:115], v[56:59], a[196:199], v[112:115]
    v_mul_f32 v168, v168, v164
    v_mul_f32 v169, v169, v165
    v_mfma_f32_16x16x32_bf16 v[112:115], v[60:63], a[200:203], v[112:115]
    v_cvt_pk_bf16_f32 v170, v166, v167
    v_cvt_pk_bf16_f32 v171, v168, v169
    v_mfma_f32_16x16x32_bf16 v[116:119], v[52:55], v[228:231], v[116:119]
    buffer_load_dwordx4 v[48:51], v191, s[48:51], s23 offen offset:1024 sc1
    v_mfma_f32_16x16x32_bf16 v[116:119], v[56:59], v[232:235], v[116:119]
    ds_write_b64 v12, v[170:171] offset:55296
    v_mfma_f32_16x16x32_bf16 v[116:119], v[60:63], v[236:239], v[116:119]
    s_waitcnt vmcnt(12)
    v_mfma_f32_16x16x32_bf16 v[88:91], v[64:67], a[60:63], v[88:91]
    v_mfma_f32_16x16x32_bf16 v[88:91], v[68:71], a[64:67], v[88:91]
    buffer_load_dwordx4 v[52:55], v191, s[48:51], s23 offen offset:2048 sc1
    v_mfma_f32_16x16x32_bf16 v[120:123], v[72:75], a[68:71], v[88:91]
    v_mfma_f32_16x16x32_bf16 v[92:95], v[64:67], a[132:135], v[92:95]
    v_mfma_f32_16x16x32_bf16 v[92:95], v[68:71], a[136:139], v[92:95]
    v_mfma_f32_16x16x32_bf16 v[124:127], v[72:75], a[140:143], v[92:95]
    buffer_load_dwordx4 v[56:59], v191, s[48:51], s23 offen offset:3072 sc1
    v_mfma_f32_16x16x32_bf16 v[96:99], v[64:67], a[204:207], v[96:99]
    v_mfma_f32_16x16x32_bf16 v[96:99], v[68:71], a[208:211], v[96:99]
    v_mfma_f32_16x16x32_bf16 v[128:131], v[72:75], a[212:215], v[96:99]
    v_mfma_f32_16x16x32_bf16 v[100:103], v[64:67], v[240:243], v[100:103]
    buffer_load_dwordx4 v[60:63], v192, s[48:51], s23 offen offset:0 sc1
    v_mfma_f32_16x16x32_bf16 v[100:103], v[68:71], v[244:247], v[100:103]
    v_mfma_f32_16x16x32_bf16 v[132:135], v[72:75], v[248:251], v[100:103]
    s_waitcnt vmcnt(12)
    v_mfma_f32_16x16x32_bf16 v[104:107], v[76:79], a[60:63], v[104:107]
    v_mfma_f32_16x16x32_bf16 v[104:107], v[80:83], a[64:67], v[104:107]
    buffer_load_dwordx4 v[64:67], v192, s[48:51], s23 offen offset:1024 sc1
    v_mfma_f32_16x16x32_bf16 v[136:139], v[84:87], a[68:71], v[104:107]
    v_mfma_f32_16x16x32_bf16 v[108:111], v[76:79], a[132:135], v[108:111]
    v_mfma_f32_16x16x32_bf16 v[108:111], v[80:83], a[136:139], v[108:111]
    v_mfma_f32_16x16x32_bf16 v[140:143], v[84:87], a[140:143], v[108:111]
    buffer_load_dwordx4 v[68:71], v192, s[48:51], s23 offen offset:2048 sc1
    v_mfma_f32_16x16x32_bf16 v[112:115], v[76:79], a[204:207], v[112:115]
    v_mfma_f32_16x16x32_bf16 v[112:115], v[80:83], a[208:211], v[112:115]
    s_lshl_b32 s7, s25, 11
    v_mfma_f32_16x16x32_bf16 v[144:147], v[84:87], a[212:215], v[112:115]
    s_add_u32 s7, s7, s28
    v_mfma_f32_16x16x32_bf16 v[116:119], v[76:79], v[240:243], v[116:119]
    buffer_load_dwordx4 v[72:75], v192, s[48:51], s23 offen offset:3072 sc1
    v_mfma_f32_16x16x32_bf16 v[116:119], v[80:83], v[244:247], v[116:119]
    s_add_u32 s23, s23, 36864
    v_mfma_f32_16x16x32_bf16 v[148:151], v[84:87], v[248:251], v[116:119]
    v_add_u32 v12, s7, v184
    s_add_u32 s25, s25, 1
    s_cmp_lt_u32 s25, 8
    s_cbranch_scc1 L_ffn_gu_34
    v_add_u32 v10, 73728, v184
    v_add_u32 v11, 110592, v184
    s_lshr_b32 s7, s2, 3
    s_lshl_b32 s7, s7, 2
    s_add_u32 s7, s7, s3
    s_lshl_b32 s7, s7, 9
    v_lshrrev_b32 v1, 1, v253
    v_add_u32 v1, s7, v1
    buffer_load_dwordx2 v[2:3], v1, s[96:99], 0 offen
    s_waitcnt lgkmcnt(0)
    s_barrier
    s_waitcnt vmcnt(12)
    v_mfma_f32_16x16x32_bf16 v[88:91], v[16:19], a[0:3], 0
    v_mfma_f32_16x16x32_bf16 v[88:91], v[20:23], a[4:7], v[88:91]
    buffer_load_dwordx4 v[76:79], v184, s[48:51], s23 offen offset:0 sc1
    v_mfma_f32_16x16x32_bf16 v[88:91], v[24:27], a[8:11], v[88:91]
    v_mul_f32 v152, v120, v120
    v_mul_f32 v153, v121, v121
    v_mfma_f32_16x16x32_bf16 v[92:95], v[16:19], a[72:75], 0
    v_mul_f32 v154, v122, v122
    v_mul_f32 v155, v123, v123
    v_mfma_f32_16x16x32_bf16 v[92:95], v[20:23], a[76:79], v[92:95]
    v_fma_f32 v152, v152, v8, v4
    v_fma_f32 v153, v153, v8, v4
    v_mfma_f32_16x16x32_bf16 v[92:95], v[24:27], a[80:83], v[92:95]
    buffer_load_dwordx4 v[80:83], v184, s[48:51], s23 offen offset:1024 sc1
    v_mfma_f32_16x16x32_bf16 v[96:99], v[16:19], a[144:147], 0
    v_fma_f32 v154, v154, v8, v4
    v_fma_f32 v155, v155, v8, v4
    v_mfma_f32_16x16x32_bf16 v[96:99], v[20:23], a[148:151], v[96:99]
    v_mul_f32 v152, v120, v152
    v_mul_f32 v153, v121, v153
    v_mfma_f32_16x16x32_bf16 v[96:99], v[24:27], a[152:155], v[96:99]
    v_mul_f32 v154, v122, v154
    v_mul_f32 v155, v123, v155
    v_mfma_f32_16x16x32_bf16 v[100:103], v[16:19], a[216:219], 0
    buffer_load_dwordx4 v[84:87], v184, s[48:51], s23 offen offset:2048 sc1
    v_mfma_f32_16x16x32_bf16 v[100:103], v[20:23], a[220:223], v[100:103]
    v_exp_f32 v152, v152
    v_mfma_f32_16x16x32_bf16 v[100:103], v[24:27], a[224:227], v[100:103]
    v_exp_f32 v153, v153
    s_waitcnt vmcnt(12)
    v_mfma_f32_16x16x32_bf16 v[104:107], v[28:31], a[0:3], 0
    v_exp_f32 v154, v154
    ds_read_b128 a[0:3], v10 offset:0
    v_mfma_f32_16x16x32_bf16 v[104:107], v[32:35], a[4:7], v[104:107]
    buffer_load_dwordx4 v[16:19], v184, s[48:51], s23 offen offset:3072 sc1
    v_mfma_f32_16x16x32_bf16 v[104:107], v[36:39], a[8:11], v[104:107]
    v_exp_f32 v155, v155
    v_mfma_f32_16x16x32_bf16 v[108:111], v[28:31], a[72:75], 0
    v_mul_f32 v156, v120, v136
    v_mul_f32 v157, v121, v137
    ds_read_b128 a[72:75], v10 offset:18432
    v_mfma_f32_16x16x32_bf16 v[108:111], v[32:35], a[76:79], v[108:111]
    v_mul_f32 v158, v122, v138
    v_mul_f32 v159, v123, v139
    v_mfma_f32_16x16x32_bf16 v[108:111], v[36:39], a[80:83], v[108:111]
    buffer_load_dwordx4 v[20:23], v185, s[48:51], s23 offen offset:0 sc1
    v_mfma_f32_16x16x32_bf16 v[112:115], v[28:31], a[144:147], 0
    v_fma_f32 v152, v152, v193, v193
    v_fma_f32 v153, v153, v193, v193
    ds_read_b128 a[144:147], v11 offset:0
    v_mfma_f32_16x16x32_bf16 v[112:115], v[32:35], a[148:151], v[112:115]
    v_fma_f32 v154, v154, v193, v193
    v_fma_f32 v155, v155, v193, v193
    v_mfma_f32_16x16x32_bf16 v[112:115], v[36:39], a[152:155], v[112:115]
    v_rcp_f32 v152, v152
    v_mfma_f32_16x16x32_bf16 v[116:119], v[28:31], a[216:219], 0
    buffer_load_dwordx4 v[24:27], v185, s[48:51], s23 offen offset:1024 sc1
    v_mfma_f32_16x16x32_bf16 v[116:119], v[32:35], a[220:223], v[116:119]
    v_rcp_f32 v153, v153
    ds_read_b128 a[216:219], v11 offset:18432
    v_mfma_f32_16x16x32_bf16 v[116:119], v[36:39], a[224:227], v[116:119]
    v_rcp_f32 v154, v154
    ds_read_b128 a[4:7], v10 offset:1024
    s_waitcnt vmcnt(12)
    v_mfma_f32_16x16x32_bf16 v[88:91], v[40:43], a[12:15], v[88:91]
    v_rcp_f32 v155, v155
    ds_read_b128 a[76:79], v10 offset:19456
    v_mfma_f32_16x16x32_bf16 v[88:91], v[44:47], a[16:19], v[88:91]
    buffer_load_dwordx4 v[28:31], v185, s[48:51], s23 offen offset:2048 sc1
    v_mfma_f32_16x16x32_bf16 v[88:91], v[48:51], a[20:23], v[88:91]
    v_mul_f32 v156, v156, v152
    v_mul_f32 v157, v157, v153
    ds_read_b128 a[148:151], v11 offset:1024
    v_mfma_f32_16x16x32_bf16 v[92:95], v[40:43], a[84:87], v[92:95]
    v_mul_f32 v158, v158, v154
    v_mul_f32 v159, v159, v155
    ds_read_b128 a[220:223], v11 offset:19456
    v_mfma_f32_16x16x32_bf16 v[92:95], v[44:47], a[88:91], v[92:95]
    v_cvt_pk_bf16_f32 v160, v156, v157
    v_cvt_pk_bf16_f32 v161, v158, v159
    ds_read_b128 a[8:11], v10 offset:2048
    v_mfma_f32_16x16x32_bf16 v[92:95], v[48:51], a[92:95], v[92:95]
    buffer_load_dwordx4 v[32:35], v185, s[48:51], s23 offen offset:3072 sc1
    v_mfma_f32_16x16x32_bf16 v[96:99], v[40:43], a[156:159], v[96:99]
    ds_write_b64 v12, v[160:161] offset:0
    v_mfma_f32_16x16x32_bf16 v[96:99], v[44:47], a[160:163], v[96:99]
    v_mul_f32 v162, v124, v124
    v_mul_f32 v163, v125, v125
    ds_read_b128 a[80:83], v10 offset:20480
    v_mfma_f32_16x16x32_bf16 v[96:99], v[48:51], a[164:167], v[96:99]
    v_mul_f32 v164, v126, v126
    v_mul_f32 v165, v127, v127
    ds_read_b128 a[152:155], v11 offset:2048
    v_mfma_f32_16x16x32_bf16 v[100:103], v[40:43], a[228:231], v[100:103]
    buffer_load_dwordx4 v[36:39], v186, s[48:51], s23 offen offset:0 sc1
    v_mfma_f32_16x16x32_bf16 v[100:103], v[44:47], a[232:235], v[100:103]
    v_fma_f32 v162, v162, v9, v5
    v_fma_f32 v163, v163, v9, v5
    ds_read_b128 a[224:227], v11 offset:20480
    v_mfma_f32_16x16x32_bf16 v[100:103], v[48:51], a[236:239], v[100:103]
    v_fma_f32 v164, v164, v9, v5
    v_fma_f32 v165, v165, v9, v5
    s_waitcnt vmcnt(12)
    v_mfma_f32_16x16x32_bf16 v[104:107], v[52:55], a[12:15], v[104:107]
    v_mul_f32 v162, v124, v162
    v_mul_f32 v163, v125, v163
    ds_read_b128 a[12:15], v10 offset:3072
    v_mfma_f32_16x16x32_bf16 v[104:107], v[56:59], a[16:19], v[104:107]
    buffer_load_dwordx4 v[40:43], v186, s[48:51], s23 offen offset:1024 sc1
    v_mfma_f32_16x16x32_bf16 v[104:107], v[60:63], a[20:23], v[104:107]
    v_mul_f32 v164, v126, v164
    v_mul_f32 v165, v127, v165
    v_mfma_f32_16x16x32_bf16 v[108:111], v[52:55], a[84:87], v[108:111]
    v_exp_f32 v162, v162
    ds_read_b128 a[84:87], v10 offset:21504
    v_mfma_f32_16x16x32_bf16 v[108:111], v[56:59], a[88:91], v[108:111]
    v_exp_f32 v163, v163
    v_mfma_f32_16x16x32_bf16 v[108:111], v[60:63], a[92:95], v[108:111]
    buffer_load_dwordx4 v[44:47], v186, s[48:51], s23 offen offset:2048 sc1
    v_mfma_f32_16x16x32_bf16 v[112:115], v[52:55], a[156:159], v[112:115]
    v_exp_f32 v164, v164
    ds_read_b128 a[156:159], v11 offset:3072
    v_mfma_f32_16x16x32_bf16 v[112:115], v[56:59], a[160:163], v[112:115]
    v_exp_f32 v165, v165
    v_mfma_f32_16x16x32_bf16 v[112:115], v[60:63], a[164:167], v[112:115]
    v_mul_f32 v166, v124, v140
    v_mul_f32 v167, v125, v141
    v_mfma_f32_16x16x32_bf16 v[116:119], v[52:55], a[228:231], v[116:119]
    buffer_load_dwordx4 v[48:51], v186, s[48:51], s23 offen offset:3072 sc1
    v_mfma_f32_16x16x32_bf16 v[116:119], v[56:59], a[232:235], v[116:119]
    v_mul_f32 v168, v126, v142
    v_mul_f32 v169, v127, v143
    ds_read_b128 a[228:231], v11 offset:21504
    v_mfma_f32_16x16x32_bf16 v[116:119], v[60:63], a[236:239], v[116:119]
    v_fma_f32 v162, v162, v194, v194
    v_fma_f32 v163, v163, v194, v194
    ds_read_b128 a[16:19], v10 offset:4096
    s_waitcnt vmcnt(12)
    v_mfma_f32_16x16x32_bf16 v[88:91], v[64:67], a[24:27], v[88:91]
    v_fma_f32 v164, v164, v194, v194
    v_fma_f32 v165, v165, v194, v194
    ds_read_b128 a[88:91], v10 offset:22528
    v_mfma_f32_16x16x32_bf16 v[88:91], v[68:71], a[28:31], v[88:91]
    buffer_load_dwordx4 v[52:55], v187, s[48:51], s23 offen offset:0 sc1
    v_mfma_f32_16x16x32_bf16 v[88:91], v[72:75], a[32:35], v[88:91]
    v_rcp_f32 v162, v162
    ds_read_b128 a[160:163], v11 offset:4096
    v_mfma_f32_16x16x32_bf16 v[92:95], v[64:67], a[96:99], v[92:95]
    v_rcp_f32 v163, v163
    ds_read_b128 a[232:235], v11 offset:22528
    v_mfma_f32_16x16x32_bf16 v[92:95], v[68:71], a[100:103], v[92:95]
    v_rcp_f32 v164, v164
    ds_read_b128 a[20:23], v10 offset:5120
    v_mfma_f32_16x16x32_bf16 v[92:95], v[72:75], a[104:107], v[92:95]
    buffer_load_dwordx4 v[56:59], v187, s[48:51], s23 offen offset:1024 sc1
    v_mfma_f32_16x16x32_bf16 v[96:99], v[64:67], a[168:171], v[96:99]
    v_rcp_f32 v165, v165
    ds_read_b128 a[92:95], v10 offset:23552
    v_mfma_f32_16x16x32_bf16 v[96:99], v[68:71], a[172:175], v[96:99]
    v_mul_f32 v166, v166, v162
    v_mul_f32 v167, v167, v163
    ds_read_b128 a[164:167], v11 offset:5120
    v_mfma_f32_16x16x32_bf16 v[96:99], v[72:75], a[176:179], v[96:99]
    v_mul_f32 v168, v168, v164
    v_mul_f32 v169, v169, v165
    ds_read_b128 a[236:239], v11 offset:23552
    v_mfma_f32_16x16x32_bf16 v[100:103], v[64:67], a[240:243], v[100:103]
    buffer_load_dwordx4 v[60:63], v187, s[48:51], s23 offen offset:2048 sc1
    v_mfma_f32_16x16x32_bf16 v[100:103], v[68:71], a[244:247], v[100:103]
    v_cvt_pk_bf16_f32 v170, v166, v167
    v_cvt_pk_bf16_f32 v171, v168, v169
    v_mfma_f32_16x16x32_bf16 v[100:103], v[72:75], a[248:251], v[100:103]
    ds_write_b64 v12, v[170:171] offset:18432
    s_waitcnt vmcnt(12)
    v_mfma_f32_16x16x32_bf16 v[104:107], v[76:79], a[24:27], v[104:107]
    v_mul_f32 v152, v128, v128
    v_mul_f32 v153, v129, v129
    ds_read_b128 a[24:27], v10 offset:6144
    v_mfma_f32_16x16x32_bf16 v[104:107], v[80:83], a[28:31], v[104:107]
    buffer_load_dwordx4 v[64:67], v187, s[48:51], s23 offen offset:3072 sc1
    v_mfma_f32_16x16x32_bf16 v[104:107], v[84:87], a[32:35], v[104:107]
    v_mul_f32 v154, v130, v130
    v_mul_f32 v155, v131, v131
    v_mfma_f32_16x16x32_bf16 v[108:111], v[76:79], a[96:99], v[108:111]
    v_fma_f32 v152, v152, v13, v6
    v_fma_f32 v153, v153, v13, v6
    ds_read_b128 a[96:99], v10 offset:24576
    v_mfma_f32_16x16x32_bf16 v[108:111], v[80:83], a[100:103], v[108:111]
    v_fma_f32 v154, v154, v13, v6
    v_fma_f32 v155, v155, v13, v6
    v_mfma_f32_16x16x32_bf16 v[108:111], v[84:87], a[104:107], v[108:111]
    buffer_load_dwordx4 v[68:71], v188, s[48:51], s23 offen offset:0 sc1
    v_mfma_f32_16x16x32_bf16 v[112:115], v[76:79], a[168:171], v[112:115]
    v_mul_f32 v152, v128, v152
    v_mul_f32 v153, v129, v153
    ds_read_b128 a[168:171], v11 offset:6144
    v_mfma_f32_16x16x32_bf16 v[112:115], v[80:83], a[172:175], v[112:115]
    v_mul_f32 v154, v130, v154
    v_mul_f32 v155, v131, v155
    v_mfma_f32_16x16x32_bf16 v[112:115], v[84:87], a[176:179], v[112:115]
    v_exp_f32 v152, v152
    v_mfma_f32_16x16x32_bf16 v[116:119], v[76:79], a[240:243], v[116:119]
    buffer_load_dwordx4 v[72:75], v188, s[48:51], s23 offen offset:1024 sc1
    v_mfma_f32_16x16x32_bf16 v[116:119], v[80:83], a[244:247], v[116:119]
    v_exp_f32 v153, v153
    ds_read_b128 a[240:243], v11 offset:24576
    v_mfma_f32_16x16x32_bf16 v[116:119], v[84:87], a[248:251], v[116:119]
    v_exp_f32 v154, v154
    ds_read_b128 a[28:31], v10 offset:7168
    s_waitcnt vmcnt(12)
    v_mfma_f32_16x16x32_bf16 v[88:91], v[16:19], a[36:39], v[88:91]
    v_exp_f32 v155, v155
    ds_read_b128 a[100:103], v10 offset:25600
    v_mfma_f32_16x16x32_bf16 v[88:91], v[20:23], a[40:43], v[88:91]
    buffer_load_dwordx4 v[76:79], v188, s[48:51], s23 offen offset:2048 sc1
    v_mfma_f32_16x16x32_bf16 v[88:91], v[24:27], a[44:47], v[88:91]
    v_mul_f32 v156, v128, v144
    v_mul_f32 v157, v129, v145
    ds_read_b128 a[172:175], v11 offset:7168
    v_mfma_f32_16x16x32_bf16 v[92:95], v[16:19], a[108:111], v[92:95]
    v_mul_f32 v158, v130, v146
    v_mul_f32 v159, v131, v147
    ds_read_b128 a[244:247], v11 offset:25600
    v_mfma_f32_16x16x32_bf16 v[92:95], v[20:23], a[112:115], v[92:95]
    v_fma_f32 v152, v152, v195, v195
    v_fma_f32 v153, v153, v195, v195
    ds_read_b128 a[32:35], v10 offset:8192
    v_mfma_f32_16x16x32_bf16 v[92:95], v[24:27], a[116:119], v[92:95]
    buffer_load_dwordx4 v[80:83], v188, s[48:51], s23 offen offset:3072 sc1
    v_mfma_f32_16x16x32_bf16 v[96:99], v[16:19], a[180:183], v[96:99]
    v_fma_f32 v154, v154, v195, v195
    v_fma_f32 v155, v155, v195, v195
    ds_read_b128 a[104:107], v10 offset:26624
    v_mfma_f32_16x16x32_bf16 v[96:99], v[20:23], a[184:187], v[96:99]
    v_rcp_f32 v152, v152
    ds_read_b128 a[176:179], v11 offset:8192
    v_mfma_f32_16x16x32_bf16 v[96:99], v[24:27], a[188:191], v[96:99]
    v_rcp_f32 v153, v153
    ds_read_b128 a[248:251], v11 offset:26624
    v_mfma_f32_16x16x32_bf16 v[100:103], v[16:19], a[252:255], v[100:103]
    buffer_load_dwordx4 v[84:87], v189, s[48:51], s23 offen offset:0 sc1
    v_mfma_f32_16x16x32_bf16 v[100:103], v[20:23], v[220:223], v[100:103]
    v_rcp_f32 v154, v154
    v_mfma_f32_16x16x32_bf16 v[100:103], v[24:27], v[224:227], v[100:103]
    v_rcp_f32 v155, v155
    s_waitcnt vmcnt(12)
    v_mfma_f32_16x16x32_bf16 v[104:107], v[28:31], a[36:39], v[104:107]
    v_mul_f32 v156, v156, v152
    v_mul_f32 v157, v157, v153
    ds_read_b128 a[36:39], v10 offset:9216
    v_mfma_f32_16x16x32_bf16 v[104:107], v[32:35], a[40:43], v[104:107]
    buffer_load_dwordx4 v[16:19], v189, s[48:51], s23 offen offset:1024 sc1
    v_mfma_f32_16x16x32_bf16 v[104:107], v[36:39], a[44:47], v[104:107]
    v_mul_f32 v158, v158, v154
    v_mul_f32 v159, v159, v155
    v_mfma_f32_16x16x32_bf16 v[108:111], v[28:31], a[108:111], v[108:111]
    v_cvt_pk_bf16_f32 v160, v156, v157
    v_cvt_pk_bf16_f32 v161, v158, v159
    ds_read_b128 a[108:111], v10 offset:27648
    v_mfma_f32_16x16x32_bf16 v[108:111], v[32:35], a[112:115], v[108:111]
    ds_write_b64 v12, v[160:161] offset:36864
    v_mfma_f32_16x16x32_bf16 v[108:111], v[36:39], a[116:119], v[108:111]
    buffer_load_dwordx4 v[20:23], v189, s[48:51], s23 offen offset:2048 sc1
    v_mfma_f32_16x16x32_bf16 v[112:115], v[28:31], a[180:183], v[112:115]
    v_mul_f32 v162, v132, v132
    v_mul_f32 v163, v133, v133
    ds_read_b128 a[180:183], v11 offset:9216
    v_mfma_f32_16x16x32_bf16 v[112:115], v[32:35], a[184:187], v[112:115]
    v_mul_f32 v164, v134, v134
    v_mul_f32 v165, v135, v135
    v_mfma_f32_16x16x32_bf16 v[112:115], v[36:39], a[188:191], v[112:115]
    v_fma_f32 v162, v162, v14, v7
    v_fma_f32 v163, v163, v14, v7
    v_mfma_f32_16x16x32_bf16 v[116:119], v[28:31], a[252:255], v[116:119]
    buffer_load_dwordx4 v[24:27], v189, s[48:51], s23 offen offset:3072 sc1
    v_mfma_f32_16x16x32_bf16 v[116:119], v[32:35], v[220:223], v[116:119]
    v_fma_f32 v164, v164, v14, v7
    v_fma_f32 v165, v165, v14, v7
    ds_read_b128 a[252:255], v11 offset:27648
    v_mfma_f32_16x16x32_bf16 v[116:119], v[36:39], v[224:227], v[116:119]
    v_mul_f32 v162, v132, v162
    v_mul_f32 v163, v133, v163
    ds_read_b128 a[40:43], v10 offset:10240
    s_waitcnt vmcnt(12)
    v_mfma_f32_16x16x32_bf16 v[88:91], v[40:43], a[48:51], v[88:91]
    v_mul_f32 v164, v134, v164
    v_mul_f32 v165, v135, v165
    ds_read_b128 a[112:115], v10 offset:28672
    v_mfma_f32_16x16x32_bf16 v[88:91], v[44:47], a[52:55], v[88:91]
    buffer_load_dwordx4 v[28:31], v190, s[48:51], s23 offen offset:0 sc1
    v_mfma_f32_16x16x32_bf16 v[88:91], v[48:51], a[56:59], v[88:91]
    v_exp_f32 v162, v162
    ds_read_b128 a[184:187], v11 offset:10240
    v_mfma_f32_16x16x32_bf16 v[92:95], v[40:43], a[120:123], v[92:95]
    v_exp_f32 v163, v163
    ds_read_b128 v[220:223], v11 offset:28672
    v_mfma_f32_16x16x32_bf16 v[92:95], v[44:47], a[124:127], v[92:95]
    v_exp_f32 v164, v164
    ds_read_b128 a[44:47], v10 offset:11264
    v_mfma_f32_16x16x32_bf16 v[92:95], v[48:51], a[128:131], v[92:95]
    buffer_load_dwordx4 v[32:35], v190, s[48:51], s23 offen offset:1024 sc1
    v_mfma_f32_16x16x32_bf16 v[96:99], v[40:43], a[192:195], v[96:99]
    v_exp_f32 v165, v165
    ds_read_b128 a[116:119], v10 offset:29696
    v_mfma_f32_16x16x32_bf16 v[96:99], v[44:47], a[196:199], v[96:99]
    v_mul_f32 v166, v132, v148
    v_mul_f32 v167, v133, v149
    ds_read_b128 a[188:191], v11 offset:11264
    v_mfma_f32_16x16x32_bf16 v[96:99], v[48:51], a[200:203], v[96:99]
    v_mul_f32 v168, v134, v150
    v_mul_f32 v169, v135, v151
    ds_read_b128 v[224:227], v11 offset:29696
    v_mfma_f32_16x16x32_bf16 v[100:103], v[40:43], v[228:231], v[100:103]
    buffer_load_dwordx4 v[36:39], v190, s[48:51], s23 offen offset:2048 sc1
    v_mfma_f32_16x16x32_bf16 v[100:103], v[44:47], v[232:235], v[100:103]
    v_fma_f32 v162, v162, v252, v252
    v_fma_f32 v163, v163, v252, v252
    v_mfma_f32_16x16x32_bf16 v[100:103], v[48:51], v[236:239], v[100:103]
    v_fma_f32 v164, v164, v252, v252
    v_fma_f32 v165, v165, v252, v252
    s_waitcnt vmcnt(12)
    v_mfma_f32_16x16x32_bf16 v[104:107], v[52:55], a[48:51], v[104:107]
    v_rcp_f32 v162, v162
    ds_read_b128 a[48:51], v10 offset:12288
    v_mfma_f32_16x16x32_bf16 v[104:107], v[56:59], a[52:55], v[104:107]
    buffer_load_dwordx4 v[40:43], v190, s[48:51], s23 offen offset:3072 sc1
    v_mfma_f32_16x16x32_bf16 v[104:107], v[60:63], a[56:59], v[104:107]
    v_rcp_f32 v163, v163
    v_mfma_f32_16x16x32_bf16 v[108:111], v[52:55], a[120:123], v[108:111]
    v_rcp_f32 v164, v164
    ds_read_b128 a[120:123], v10 offset:30720
    v_mfma_f32_16x16x32_bf16 v[108:111], v[56:59], a[124:127], v[108:111]
    v_rcp_f32 v165, v165
    v_mfma_f32_16x16x32_bf16 v[108:111], v[60:63], a[128:131], v[108:111]
    buffer_load_dwordx4 v[44:47], v191, s[48:51], s23 offen offset:0 sc1
    v_mfma_f32_16x16x32_bf16 v[112:115], v[52:55], a[192:195], v[112:115]
    v_mul_f32 v166, v166, v162
    v_mul_f32 v167, v167, v163
    ds_read_b128 a[192:195], v11 offset:12288
    v_mfma_f32_16x16x32_bf16 v[112:115], v[56:59], a[196:199], v[112:115]
    v_mul_f32 v168, v168, v164
    v_mul_f32 v169, v169, v165
    v_mfma_f32_16x16x32_bf16 v[112:115], v[60:63], a[200:203], v[112:115]
    v_cvt_pk_bf16_f32 v170, v166, v167
    v_cvt_pk_bf16_f32 v171, v168, v169
    v_mfma_f32_16x16x32_bf16 v[116:119], v[52:55], v[228:231], v[116:119]
    buffer_load_dwordx4 v[48:51], v191, s[48:51], s23 offen offset:1024 sc1
    v_mfma_f32_16x16x32_bf16 v[116:119], v[56:59], v[232:235], v[116:119]
    ds_write_b64 v12, v[170:171] offset:55296
    v_mfma_f32_16x16x32_bf16 v[116:119], v[60:63], v[236:239], v[116:119]
    ds_read_b128 v[228:231], v11 offset:30720
    s_waitcnt vmcnt(12)
    v_mfma_f32_16x16x32_bf16 v[88:91], v[64:67], a[60:63], v[88:91]
    ds_read_b128 a[52:55], v10 offset:13312
    v_mfma_f32_16x16x32_bf16 v[88:91], v[68:71], a[64:67], v[88:91]
    buffer_load_dwordx4 v[52:55], v191, s[48:51], s23 offen offset:2048 sc1
    v_mfma_f32_16x16x32_bf16 v[120:123], v[72:75], a[68:71], v[88:91]
    ds_read_b128 a[124:127], v10 offset:31744
    v_mfma_f32_16x16x32_bf16 v[92:95], v[64:67], a[132:135], v[92:95]
    ds_read_b128 a[196:199], v11 offset:13312
    v_mfma_f32_16x16x32_bf16 v[92:95], v[68:71], a[136:139], v[92:95]
    ds_read_b128 v[232:235], v11 offset:31744
    v_mfma_f32_16x16x32_bf16 v[124:127], v[72:75], a[140:143], v[92:95]
    buffer_load_dwordx4 v[56:59], v191, s[48:51], s23 offen offset:3072 sc1
    v_mfma_f32_16x16x32_bf16 v[96:99], v[64:67], a[204:207], v[96:99]
    v_mfma_f32_16x16x32_bf16 v[96:99], v[68:71], a[208:211], v[96:99]
    v_mfma_f32_16x16x32_bf16 v[128:131], v[72:75], a[212:215], v[96:99]
    v_mfma_f32_16x16x32_bf16 v[100:103], v[64:67], v[240:243], v[100:103]
    buffer_load_dwordx4 v[60:63], v192, s[48:51], s23 offen offset:0 sc1
    v_mfma_f32_16x16x32_bf16 v[100:103], v[68:71], v[244:247], v[100:103]
    v_mfma_f32_16x16x32_bf16 v[132:135], v[72:75], v[248:251], v[100:103]
    s_waitcnt vmcnt(12)
    v_mfma_f32_16x16x32_bf16 v[104:107], v[76:79], a[60:63], v[104:107]
    v_mfma_f32_16x16x32_bf16 v[104:107], v[80:83], a[64:67], v[104:107]
    buffer_load_dwordx4 v[64:67], v192, s[48:51], s23 offen offset:1024 sc1
    v_mfma_f32_16x16x32_bf16 v[136:139], v[84:87], a[68:71], v[104:107]
    v_mfma_f32_16x16x32_bf16 v[108:111], v[76:79], a[132:135], v[108:111]
    v_mfma_f32_16x16x32_bf16 v[108:111], v[80:83], a[136:139], v[108:111]
    v_mfma_f32_16x16x32_bf16 v[140:143], v[84:87], a[140:143], v[108:111]
    buffer_load_dwordx4 v[68:71], v192, s[48:51], s23 offen offset:2048 sc1
    v_mfma_f32_16x16x32_bf16 v[112:115], v[76:79], a[204:207], v[112:115]
    v_mfma_f32_16x16x32_bf16 v[112:115], v[80:83], a[208:211], v[112:115]
    s_lshl_b32 s7, s25, 11
    v_mfma_f32_16x16x32_bf16 v[144:147], v[84:87], a[212:215], v[112:115]
    s_add_u32 s7, s7, s28
    v_mfma_f32_16x16x32_bf16 v[116:119], v[76:79], v[240:243], v[116:119]
    buffer_load_dwordx4 v[72:75], v192, s[48:51], s23 offen offset:3072 sc1
    v_mfma_f32_16x16x32_bf16 v[116:119], v[80:83], v[244:247], v[116:119]
    s_add_u32 s23, s23, 36864
    v_mfma_f32_16x16x32_bf16 v[148:151], v[84:87], v[248:251], v[116:119]
    v_add_u32 v12, s7, v184
    s_add_u32 s25, s25, 1
    s_waitcnt lgkmcnt(0)
    s_barrier
    v_pk_mul_f32 v[152:153], v[120:121], v[120:121]
    ds_read_b128 a[56:59], v10 offset:14336
    v_pk_mul_f32 v[154:155], v[122:123], v[122:123]
    ds_read_b128 a[128:131], v10 offset:32768
    v_pk_fma_f32 v[152:153], v[152:153], v[8:9], v[4:5] op_sel:[0,0,0] op_sel_hi:[1,0,0]
    ds_read_b128 a[200:203], v11 offset:14336
    v_pk_fma_f32 v[154:155], v[154:155], v[8:9], v[4:5] op_sel:[0,0,0] op_sel_hi:[1,0,0]
    v_pk_mul_f32 v[152:153], v[120:121], v[152:153]
    ds_read_b128 v[236:239], v11 offset:32768
    v_pk_mul_f32 v[154:155], v[122:123], v[154:155]
    ds_read_b128 a[60:63], v10 offset:15360
    buffer_load_dwordx4 v[76:79], v184, s[48:51], s23 offen offset:0 sc1
    v_exp_f32 v152, v152
    ds_read_b128 a[132:135], v10 offset:33792
    v_exp_f32 v153, v153
    v_exp_f32 v154, v154
    ds_read_b128 a[204:207], v11 offset:15360
    v_exp_f32 v155, v155
    ds_read_b128 v[240:243], v11 offset:33792
    v_pk_mul_f32 v[156:157], v[120:121], v[136:137]
    v_pk_mul_f32 v[158:159], v[122:123], v[138:139]
    buffer_load_dwordx4 v[80:83], v184, s[48:51], s23 offen offset:1024 sc1
    v_pk_fma_f32 v[152:153], v[152:153], v[192:193], v[192:193] op_sel:[0,1,1] op_sel_hi:[1,1,1]
    v_pk_fma_f32 v[154:155], v[154:155], v[192:193], v[192:193] op_sel:[0,1,1] op_sel_hi:[1,1,1]
    v_rcp_f32 v152, v152
    v_rcp_f32 v153, v153
    v_rcp_f32 v154, v154
    v_rcp_f32 v155, v155
    buffer_load_dwordx4 v[84:87], v184, s[48:51], s23 offen offset:2048 sc1
    s_nop 0
    v_pk_mul_f32 v[156:157], v[156:157], v[152:153]
    v_pk_mul_f32 v[158:159], v[158:159], v[154:155]
    v_cvt_pk_bf16_f32 v160, v156, v157
    v_cvt_pk_bf16_f32 v161, v158, v159
    ds_write_b64 v12, v[160:161] offset:0
    buffer_load_dwordx4 v[104:107], v184, s[48:51], s23 offen offset:3072 sc1
    v_pk_mul_f32 v[162:163], v[124:125], v[124:125]
    v_pk_mul_f32 v[164:165], v[126:127], v[126:127]
    v_pk_fma_f32 v[162:163], v[162:163], v[8:9], v[4:5] op_sel:[0,1,1] op_sel_hi:[1,1,1]
    v_pk_fma_f32 v[164:165], v[164:165], v[8:9], v[4:5] op_sel:[0,1,1] op_sel_hi:[1,1,1]
    v_pk_mul_f32 v[162:163], v[124:125], v[162:163]
    v_pk_mul_f32 v[164:165], v[126:127], v[164:165]
    buffer_load_dwordx4 v[108:111], v185, s[48:51], s23 offen offset:0 sc1
    v_exp_f32 v162, v162
    v_exp_f32 v163, v163
    v_exp_f32 v164, v164
    v_exp_f32 v165, v165
    v_pk_mul_f32 v[166:167], v[124:125], v[140:141]
    v_pk_mul_f32 v[168:169], v[126:127], v[142:143]
    buffer_load_dwordx4 v[112:115], v185, s[48:51], s23 offen offset:1024 sc1
    v_pk_fma_f32 v[162:163], v[162:163], v[194:195], v[194:195] op_sel:[0,0,0] op_sel_hi:[1,0,0]
    v_pk_fma_f32 v[164:165], v[164:165], v[194:195], v[194:195] op_sel:[0,0,0] op_sel_hi:[1,0,0]
    v_rcp_f32 v162, v162
    v_rcp_f32 v163, v163
    v_rcp_f32 v164, v164
    v_rcp_f32 v165, v165
    buffer_load_dwordx4 v[116:119], v185, s[48:51], s23 offen offset:2048 sc1
    s_nop 0
    v_pk_mul_f32 v[166:167], v[166:167], v[162:163]
    v_pk_mul_f32 v[168:169], v[168:169], v[164:165]
    v_cvt_pk_bf16_f32 v170, v166, v167
    v_cvt_pk_bf16_f32 v171, v168, v169
    ds_write_b64 v12, v[170:171] offset:18432
    buffer_load_dwordx4 v[180:183], v185, s[48:51], s23 offen offset:3072 sc1
    v_pk_mul_f32 v[152:153], v[128:129], v[128:129]
    v_pk_mul_f32 v[154:155], v[130:131], v[130:131]
    v_pk_fma_f32 v[152:153], v[152:153], v[12:13], v[6:7] op_sel:[0,1,0] op_sel_hi:[1,1,0]
    v_pk_fma_f32 v[154:155], v[154:155], v[12:13], v[6:7] op_sel:[0,1,0] op_sel_hi:[1,1,0]
    v_pk_mul_f32 v[152:153], v[128:129], v[152:153]
    v_pk_mul_f32 v[154:155], v[130:131], v[154:155]
    buffer_load_dwordx4 v[196:199], v186, s[48:51], s23 offen offset:0 sc1
    v_exp_f32 v152, v152
    v_exp_f32 v153, v153
    v_exp_f32 v154, v154
    v_exp_f32 v155, v155
    v_pk_mul_f32 v[156:157], v[128:129], v[144:145]
    v_pk_mul_f32 v[158:159], v[130:131], v[146:147]
    buffer_load_dwordx4 v[200:203], v186, s[48:51], s23 offen offset:1024 sc1
    v_pk_fma_f32 v[152:153], v[152:153], v[194:195], v[194:195] op_sel:[0,1,1] op_sel_hi:[1,1,1]
    v_pk_fma_f32 v[154:155], v[154:155], v[194:195], v[194:195] op_sel:[0,1,1] op_sel_hi:[1,1,1]
    v_rcp_f32 v152, v152
    v_rcp_f32 v153, v153
    v_rcp_f32 v154, v154
    v_rcp_f32 v155, v155
    buffer_load_dwordx4 v[204:207], v186, s[48:51], s23 offen offset:2048 sc1
    s_nop 0
    v_pk_mul_f32 v[156:157], v[156:157], v[152:153]
    v_pk_mul_f32 v[158:159], v[158:159], v[154:155]
    v_cvt_pk_bf16_f32 v160, v156, v157
    v_cvt_pk_bf16_f32 v161, v158, v159
    ds_write_b64 v12, v[160:161] offset:36864
    buffer_load_dwordx4 v[208:211], v186, s[48:51], s23 offen offset:3072 sc1
    v_pk_mul_f32 v[162:163], v[132:133], v[132:133]
    v_pk_mul_f32 v[164:165], v[134:135], v[134:135]
    v_pk_fma_f32 v[162:163], v[162:163], v[14:15], v[6:7] op_sel:[0,0,1] op_sel_hi:[1,0,1]
    v_pk_fma_f32 v[164:165], v[164:165], v[14:15], v[6:7] op_sel:[0,0,1] op_sel_hi:[1,0,1]
    v_pk_mul_f32 v[162:163], v[132:133], v[162:163]
    v_pk_mul_f32 v[164:165], v[134:135], v[164:165]
    buffer_load_dwordx4 v[212:215], v187, s[48:51], s23 offen offset:0 sc1
    v_exp_f32 v162, v162
    v_exp_f32 v163, v163
    v_exp_f32 v164, v164
    v_exp_f32 v165, v165
    v_pk_mul_f32 v[166:167], v[132:133], v[148:149]
    v_pk_mul_f32 v[168:169], v[134:135], v[150:151]
    v_pk_fma_f32 v[162:163], v[162:163], v[252:253], v[252:253] op_sel:[0,0,0] op_sel_hi:[1,0,0]
    v_pk_fma_f32 v[164:165], v[164:165], v[252:253], v[252:253] op_sel:[0,0,0] op_sel_hi:[1,0,0]
    v_rcp_f32 v162, v162
    v_rcp_f32 v163, v163
    v_rcp_f32 v164, v164
    v_rcp_f32 v165, v165
    s_nop 0
    v_pk_mul_f32 v[166:167], v[166:167], v[162:163]
    v_pk_mul_f32 v[168:169], v[168:169], v[164:165]
    v_cvt_pk_bf16_f32 v170, v166, v167
    v_cvt_pk_bf16_f32 v171, v168, v169
    ds_write_b64 v12, v[170:171] offset:55296
    buffer_load_dwordx4 v[136:139], v187, s[48:51], s23 offen offset:1024 sc1
    buffer_load_dwordx4 v[140:143], v187, s[48:51], s23 offen offset:2048 sc1
    buffer_load_dwordx4 v[144:147], v187, s[48:51], s23 offen offset:3072 sc1
    buffer_load_dwordx4 v[160:163], v188, s[48:51], s23 offen offset:0 sc1
    buffer_load_dwordx4 v[164:167], v188, s[48:51], s23 offen offset:1024 sc1
    s_add_u32 s23, s23, 18432
    s_waitcnt lgkmcnt(0)
    s_barrier
    ds_read_b128 a[64:67], v10 offset:16384
    ds_read_b128 a[136:139], v10 offset:34816
    ds_read_b128 a[208:211], v11 offset:16384
    ds_read_b128 v[244:247], v11 offset:34816
    ds_read_b128 a[68:71], v10 offset:17408
    ds_read_b128 a[140:143], v10 offset:35840
    ds_read_b128 a[212:215], v11 offset:17408
    ds_read_b128 v[248:251], v11 offset:35840
    s_mov_b32 s25, 0
    s_waitcnt lgkmcnt(0)
    s_branch L_ffn_dn_mid_36
L_ffn_dn_35:
    s_waitcnt vmcnt(32)
    v_mfma_f32_16x16x32_bf16 v[88:91], v[104:107], a[0:3], 0
    v_mfma_f32_16x16x32_bf16 v[88:91], v[108:111], a[4:7], v[88:91]
    buffer_load_dwordx4 v[76:79], v184, s[48:51], s23 offen offset:0 sc1
    v_mfma_f32_16x16x32_bf16 v[88:91], v[112:115], a[8:11], v[88:91]
    v_mfma_f32_16x16x32_bf16 v[92:95], v[104:107], a[72:75], 0
    v_mfma_f32_16x16x32_bf16 v[92:95], v[108:111], a[76:79], v[92:95]
    v_mfma_f32_16x16x32_bf16 v[92:95], v[112:115], a[80:83], v[92:95]
    buffer_load_dwordx4 v[80:83], v184, s[48:51], s23 offen offset:1024 sc1
    v_mfma_f32_16x16x32_bf16 v[96:99], v[104:107], a[144:147], 0
    v_cvt_pk_bf16_f32 v152, v120, v121
    v_cvt_pk_bf16_f32 v153, v122, v123
    v_mfma_f32_16x16x32_bf16 v[96:99], v[108:111], a[148:151], v[96:99]
    v_cvt_pk_bf16_f32 v154, v124, v125
    v_cvt_pk_bf16_f32 v155, v126, v127
    v_mfma_f32_16x16x32_bf16 v[96:99], v[112:115], a[152:155], v[96:99]
    s_nop 0
    v_permlane16_swap_b32 v152, v154
    v_mfma_f32_16x16x32_bf16 v[100:103], v[104:107], a[216:219], 0
    buffer_load_dwordx4 v[84:87], v184, s[48:51], s23 offen offset:2048 sc1
    v_mfma_f32_16x16x32_bf16 v[100:103], v[108:111], a[220:223], v[100:103]
    v_permlane16_swap_b32 v153, v155
    v_mfma_f32_16x16x32_bf16 v[100:103], v[112:115], a[224:227], v[100:103]
    buffer_store_dwordx4 v[152:155], v178, s[72:75], s27 offen sc1
    s_waitcnt vmcnt(33)
    v_mfma_f32_16x16x32_bf16 v[88:91], v[116:119], a[12:15], v[88:91]
    ds_write_b128 v216, v[152:155]
    v_mfma_f32_16x16x32_bf16 v[88:91], v[180:183], a[16:19], v[88:91]
    buffer_load_dwordx4 v[104:107], v184, s[48:51], s23 offen offset:3072 sc1
    v_mfma_f32_16x16x32_bf16 v[88:91], v[196:199], a[20:23], v[88:91]
    v_add_u32 v216, v216, v218
    v_mfma_f32_16x16x32_bf16 v[92:95], v[116:119], a[84:87], v[92:95]
    v_mfma_f32_16x16x32_bf16 v[92:95], v[180:183], a[88:91], v[92:95]
    v_mfma_f32_16x16x32_bf16 v[92:95], v[196:199], a[92:95], v[92:95]
    buffer_load_dwordx4 v[108:111], v185, s[48:51], s23 offen offset:0 sc1
    v_mfma_f32_16x16x32_bf16 v[96:99], v[116:119], a[156:159], v[96:99]
    v_mfma_f32_16x16x32_bf16 v[96:99], v[180:183], a[160:163], v[96:99]
    v_mfma_f32_16x16x32_bf16 v[96:99], v[196:199], a[164:167], v[96:99]
    v_mfma_f32_16x16x32_bf16 v[100:103], v[116:119], a[228:231], v[100:103]
    buffer_load_dwordx4 v[112:115], v185, s[48:51], s23 offen offset:1024 sc1
    v_mfma_f32_16x16x32_bf16 v[100:103], v[180:183], a[232:235], v[100:103]
    v_mfma_f32_16x16x32_bf16 v[100:103], v[196:199], a[236:239], v[100:103]
    s_waitcnt vmcnt(33)
    v_mfma_f32_16x16x32_bf16 v[88:91], v[200:203], a[24:27], v[88:91]
    v_mfma_f32_16x16x32_bf16 v[88:91], v[204:207], a[28:31], v[88:91]
    buffer_load_dwordx4 v[116:119], v185, s[48:51], s23 offen offset:2048 sc1
    v_mfma_f32_16x16x32_bf16 v[88:91], v[208:211], a[32:35], v[88:91]
    v_mfma_f32_16x16x32_bf16 v[92:95], v[200:203], a[96:99], v[92:95]
    v_mfma_f32_16x16x32_bf16 v[92:95], v[204:207], a[100:103], v[92:95]
    v_mfma_f32_16x16x32_bf16 v[92:95], v[208:211], a[104:107], v[92:95]
    buffer_load_dwordx4 v[180:183], v185, s[48:51], s23 offen offset:3072 sc1
    v_mfma_f32_16x16x32_bf16 v[96:99], v[200:203], a[168:171], v[96:99]
    v_mfma_f32_16x16x32_bf16 v[96:99], v[204:207], a[172:175], v[96:99]
    v_mfma_f32_16x16x32_bf16 v[96:99], v[208:211], a[176:179], v[96:99]
    v_mfma_f32_16x16x32_bf16 v[100:103], v[200:203], a[240:243], v[100:103]
    buffer_load_dwordx4 v[196:199], v186, s[48:51], s23 offen offset:0 sc1
    v_mfma_f32_16x16x32_bf16 v[100:103], v[204:207], a[244:247], v[100:103]
    v_mfma_f32_16x16x32_bf16 v[100:103], v[208:211], a[248:251], v[100:103]
    s_waitcnt vmcnt(33)
    v_mfma_f32_16x16x32_bf16 v[88:91], v[212:215], a[36:39], v[88:91]
    v_mfma_f32_16x16x32_bf16 v[88:91], v[136:139], a[40:43], v[88:91]
    buffer_load_dwordx4 v[200:203], v186, s[48:51], s23 offen offset:1024 sc1
    v_mfma_f32_16x16x32_bf16 v[88:91], v[140:143], a[44:47], v[88:91]
    v_mfma_f32_16x16x32_bf16 v[92:95], v[212:215], a[108:111], v[92:95]
    v_mfma_f32_16x16x32_bf16 v[92:95], v[136:139], a[112:115], v[92:95]
    v_cvt_pk_bf16_f32 v156, v128, v129
    v_cvt_pk_bf16_f32 v157, v130, v131
    v_mfma_f32_16x16x32_bf16 v[92:95], v[140:143], a[116:119], v[92:95]
    buffer_load_dwordx4 v[204:207], v186, s[48:51], s23 offen offset:2048 sc1
    v_mfma_f32_16x16x32_bf16 v[96:99], v[212:215], a[180:183], v[96:99]
    v_cvt_pk_bf16_f32 v158, v132, v133
    v_cvt_pk_bf16_f32 v159, v134, v135
    v_mfma_f32_16x16x32_bf16 v[96:99], v[136:139], a[184:187], v[96:99]
    s_nop 0
    v_permlane16_swap_b32 v156, v158
    v_mfma_f32_16x16x32_bf16 v[96:99], v[140:143], a[188:191], v[96:99]
    v_permlane16_swap_b32 v157, v159
    v_mfma_f32_16x16x32_bf16 v[100:103], v[212:215], a[252:255], v[100:103]
    buffer_load_dwordx4 v[208:211], v186, s[48:51], s23 offen offset:3072 sc1
    v_mfma_f32_16x16x32_bf16 v[100:103], v[136:139], v[220:223], v[100:103]
    buffer_store_dwordx4 v[156:159], v179, s[72:75], s27 offen sc1
    v_mfma_f32_16x16x32_bf16 v[100:103], v[140:143], v[224:227], v[100:103]
    ds_write_b128 v217, v[156:159]
    s_waitcnt vmcnt(34)
    v_mfma_f32_16x16x32_bf16 v[88:91], v[144:147], a[48:51], v[88:91]
    v_add_u32 v217, v217, v219
    v_mfma_f32_16x16x32_bf16 v[88:91], v[160:163], a[52:55], v[88:91]
    buffer_load_dwordx4 v[212:215], v187, s[48:51], s23 offen offset:0 sc1
    v_mfma_f32_16x16x32_bf16 v[88:91], v[164:167], a[56:59], v[88:91]
    v_mfma_f32_16x16x32_bf16 v[92:95], v[144:147], a[120:123], v[92:95]
    v_mfma_f32_16x16x32_bf16 v[92:95], v[160:163], a[124:127], v[92:95]
    v_mfma_f32_16x16x32_bf16 v[92:95], v[164:167], a[128:131], v[92:95]
    buffer_load_dwordx4 v[136:139], v187, s[48:51], s23 offen offset:1024 sc1
    v_mfma_f32_16x16x32_bf16 v[96:99], v[144:147], a[192:195], v[96:99]
    v_mfma_f32_16x16x32_bf16 v[96:99], v[160:163], a[196:199], v[96:99]
    v_mfma_f32_16x16x32_bf16 v[96:99], v[164:167], a[200:203], v[96:99]
    v_mfma_f32_16x16x32_bf16 v[100:103], v[144:147], v[228:231], v[100:103]
    buffer_load_dwordx4 v[140:143], v187, s[48:51], s23 offen offset:2048 sc1
    v_mfma_f32_16x16x32_bf16 v[100:103], v[160:163], v[232:235], v[100:103]
    v_mfma_f32_16x16x32_bf16 v[100:103], v[164:167], v[236:239], v[100:103]
    s_waitcnt vmcnt(34)
    v_mfma_f32_16x16x32_bf16 v[88:91], v[168:171], a[60:63], v[88:91]
    v_mfma_f32_16x16x32_bf16 v[88:91], v[148:151], a[64:67], v[88:91]
    buffer_load_dwordx4 v[144:147], v187, s[48:51], s23 offen offset:3072 sc1
    v_mfma_f32_16x16x32_bf16 v[120:123], v[4:7], a[68:71], v[88:91]
    v_mfma_f32_16x16x32_bf16 v[92:95], v[168:171], a[132:135], v[92:95]
    v_mfma_f32_16x16x32_bf16 v[92:95], v[148:151], a[136:139], v[92:95]
    v_mfma_f32_16x16x32_bf16 v[124:127], v[4:7], a[140:143], v[92:95]
    buffer_load_dwordx4 v[160:163], v188, s[48:51], s23 offen offset:0 sc1
    v_mfma_f32_16x16x32_bf16 v[96:99], v[168:171], a[204:207], v[96:99]
    s_mov_b32 s74, 268435456
    v_mfma_f32_16x16x32_bf16 v[96:99], v[148:151], a[208:211], v[96:99]
    s_add_u32 s27, s27, 1024
    v_mfma_f32_16x16x32_bf16 v[128:131], v[4:7], a[212:215], v[96:99]
    s_add_u32 s25, s25, 1
    v_mfma_f32_16x16x32_bf16 v[100:103], v[168:171], v[240:243], v[100:103]
    buffer_load_dwordx4 v[164:167], v188, s[48:51], s23 offen offset:1024 sc1
    v_mfma_f32_16x16x32_bf16 v[100:103], v[148:151], v[244:247], v[100:103]
    s_add_u32 s23, s23, 18432
    v_mfma_f32_16x16x32_bf16 v[132:135], v[4:7], v[248:251], v[100:103]
L_ffn_dn_mid_36:
    s_waitcnt vmcnt(30)
    v_mfma_f32_16x16x32_bf16 v[88:91], v[16:19], a[0:3], 0
    v_mfma_f32_16x16x32_bf16 v[88:91], v[20:23], a[4:7], v[88:91]
    buffer_load_dwordx4 v[168:171], v184, s[48:51], s23 offen offset:0 sc1
    v_mfma_f32_16x16x32_bf16 v[88:91], v[24:27], a[8:11], v[88:91]
    v_mfma_f32_16x16x32_bf16 v[92:95], v[16:19], a[72:75], 0
    v_mfma_f32_16x16x32_bf16 v[92:95], v[20:23], a[76:79], v[92:95]
    v_mfma_f32_16x16x32_bf16 v[92:95], v[24:27], a[80:83], v[92:95]
    buffer_load_dwordx4 v[148:151], v184, s[48:51], s23 offen offset:1024 sc1
    v_mfma_f32_16x16x32_bf16 v[96:99], v[16:19], a[144:147], 0
    v_cvt_pk_bf16_f32 v152, v120, v121
    v_cvt_pk_bf16_f32 v153, v122, v123
    v_mfma_f32_16x16x32_bf16 v[96:99], v[20:23], a[148:151], v[96:99]
    v_cvt_pk_bf16_f32 v154, v124, v125
    v_cvt_pk_bf16_f32 v155, v126, v127
    v_mfma_f32_16x16x32_bf16 v[96:99], v[24:27], a[152:155], v[96:99]
    s_nop 0
    v_permlane16_swap_b32 v152, v154
    v_mfma_f32_16x16x32_bf16 v[100:103], v[16:19], a[216:219], 0
    buffer_load_dwordx4 v[4:7], v184, s[48:51], s23 offen offset:2048 sc1
    v_mfma_f32_16x16x32_bf16 v[100:103], v[20:23], a[220:223], v[100:103]
    v_permlane16_swap_b32 v153, v155
    v_mfma_f32_16x16x32_bf16 v[100:103], v[24:27], a[224:227], v[100:103]
    buffer_store_dwordx4 v[152:155], v178, s[72:75], s27 offen sc1
    s_waitcnt vmcnt(31)
    v_mfma_f32_16x16x32_bf16 v[88:91], v[28:31], a[12:15], v[88:91]
    ds_write_b128 v216, v[152:155]
    v_mfma_f32_16x16x32_bf16 v[88:91], v[32:35], a[16:19], v[88:91]
    buffer_load_dwordx4 v[16:19], v184, s[48:51], s23 offen offset:3072 sc1
    v_mfma_f32_16x16x32_bf16 v[88:91], v[36:39], a[20:23], v[88:91]
    v_add_u32 v216, v216, v218
    v_mfma_f32_16x16x32_bf16 v[92:95], v[28:31], a[84:87], v[92:95]
    v_mfma_f32_16x16x32_bf16 v[92:95], v[32:35], a[88:91], v[92:95]
    v_mfma_f32_16x16x32_bf16 v[92:95], v[36:39], a[92:95], v[92:95]
    buffer_load_dwordx4 v[20:23], v185, s[48:51], s23 offen offset:0 sc1
    v_mfma_f32_16x16x32_bf16 v[96:99], v[28:31], a[156:159], v[96:99]
    v_mfma_f32_16x16x32_bf16 v[96:99], v[32:35], a[160:163], v[96:99]
    v_mfma_f32_16x16x32_bf16 v[96:99], v[36:39], a[164:167], v[96:99]
    v_mfma_f32_16x16x32_bf16 v[100:103], v[28:31], a[228:231], v[100:103]
    buffer_load_dwordx4 v[24:27], v185, s[48:51], s23 offen offset:1024 sc1
    v_mfma_f32_16x16x32_bf16 v[100:103], v[32:35], a[232:235], v[100:103]
    v_mfma_f32_16x16x32_bf16 v[100:103], v[36:39], a[236:239], v[100:103]
    s_waitcnt vmcnt(31)
    v_mfma_f32_16x16x32_bf16 v[88:91], v[40:43], a[24:27], v[88:91]
    v_mfma_f32_16x16x32_bf16 v[88:91], v[44:47], a[28:31], v[88:91]
    buffer_load_dwordx4 v[28:31], v185, s[48:51], s23 offen offset:2048 sc1
    v_mfma_f32_16x16x32_bf16 v[88:91], v[48:51], a[32:35], v[88:91]
    v_mfma_f32_16x16x32_bf16 v[92:95], v[40:43], a[96:99], v[92:95]
    v_mfma_f32_16x16x32_bf16 v[92:95], v[44:47], a[100:103], v[92:95]
    v_mfma_f32_16x16x32_bf16 v[92:95], v[48:51], a[104:107], v[92:95]
    buffer_load_dwordx4 v[32:35], v185, s[48:51], s23 offen offset:3072 sc1
    v_mfma_f32_16x16x32_bf16 v[96:99], v[40:43], a[168:171], v[96:99]
    v_mfma_f32_16x16x32_bf16 v[96:99], v[44:47], a[172:175], v[96:99]
    v_mfma_f32_16x16x32_bf16 v[96:99], v[48:51], a[176:179], v[96:99]
    v_mfma_f32_16x16x32_bf16 v[100:103], v[40:43], a[240:243], v[100:103]
    buffer_load_dwordx4 v[36:39], v186, s[48:51], s23 offen offset:0 sc1
    v_mfma_f32_16x16x32_bf16 v[100:103], v[44:47], a[244:247], v[100:103]
    v_mfma_f32_16x16x32_bf16 v[100:103], v[48:51], a[248:251], v[100:103]
    s_waitcnt vmcnt(31)
    s_cmp_lg_u32 s25, 6
    s_cbranch_scc1 L_early_37
    s_waitcnt vmcnt(16)
    s_barrier
    s_cmp_lg_u32 s3, 0
    s_cbranch_scc1 L_early_37
    v_lshlrev_b32 v15, 7, v0
    v_mov_b32 v1, s76
    s_mov_b64 exec, 0xff
    buffer_store_dword v1, v15, s[8:11], s29 offen sc1
    s_mov_b64 exec, -1
L_early_37:
    v_mfma_f32_16x16x32_bf16 v[88:91], v[52:55], a[36:39], v[88:91]
    v_mfma_f32_16x16x32_bf16 v[88:91], v[56:59], a[40:43], v[88:91]
    buffer_load_dwordx4 v[40:43], v186, s[48:51], s23 offen offset:1024 sc1
    v_mfma_f32_16x16x32_bf16 v[88:91], v[60:63], a[44:47], v[88:91]
    v_mfma_f32_16x16x32_bf16 v[92:95], v[52:55], a[108:111], v[92:95]
    v_mfma_f32_16x16x32_bf16 v[92:95], v[56:59], a[112:115], v[92:95]
    v_cvt_pk_bf16_f32 v156, v128, v129
    v_cvt_pk_bf16_f32 v157, v130, v131
    v_mfma_f32_16x16x32_bf16 v[92:95], v[60:63], a[116:119], v[92:95]
    buffer_load_dwordx4 v[44:47], v186, s[48:51], s23 offen offset:2048 sc1
    v_mfma_f32_16x16x32_bf16 v[96:99], v[52:55], a[180:183], v[96:99]
    v_cvt_pk_bf16_f32 v158, v132, v133
    v_cvt_pk_bf16_f32 v159, v134, v135
    v_mfma_f32_16x16x32_bf16 v[96:99], v[56:59], a[184:187], v[96:99]
    s_nop 0
    v_permlane16_swap_b32 v156, v158
    v_mfma_f32_16x16x32_bf16 v[96:99], v[60:63], a[188:191], v[96:99]
    v_permlane16_swap_b32 v157, v159
    v_mfma_f32_16x16x32_bf16 v[100:103], v[52:55], a[252:255], v[100:103]
    buffer_load_dwordx4 v[48:51], v186, s[48:51], s23 offen offset:3072 sc1
    v_mfma_f32_16x16x32_bf16 v[100:103], v[56:59], v[220:223], v[100:103]
    buffer_store_dwordx4 v[156:159], v179, s[72:75], s27 offen sc1
    v_mfma_f32_16x16x32_bf16 v[100:103], v[60:63], v[224:227], v[100:103]
    ds_write_b128 v217, v[156:159]
    s_waitcnt vmcnt(32)
    v_mfma_f32_16x16x32_bf16 v[88:91], v[64:67], a[48:51], v[88:91]
    v_add_u32 v217, v217, v219
    v_mfma_f32_16x16x32_bf16 v[88:91], v[68:71], a[52:55], v[88:91]
    buffer_load_dwordx4 v[52:55], v187, s[48:51], s23 offen offset:0 sc1
    v_mfma_f32_16x16x32_bf16 v[88:91], v[72:75], a[56:59], v[88:91]
    v_mfma_f32_16x16x32_bf16 v[92:95], v[64:67], a[120:123], v[92:95]
    v_mfma_f32_16x16x32_bf16 v[92:95], v[68:71], a[124:127], v[92:95]
    v_mfma_f32_16x16x32_bf16 v[92:95], v[72:75], a[128:131], v[92:95]
    buffer_load_dwordx4 v[56:59], v187, s[48:51], s23 offen offset:1024 sc1
    v_mfma_f32_16x16x32_bf16 v[96:99], v[64:67], a[192:195], v[96:99]
    v_mfma_f32_16x16x32_bf16 v[96:99], v[68:71], a[196:199], v[96:99]
    v_mfma_f32_16x16x32_bf16 v[96:99], v[72:75], a[200:203], v[96:99]
    v_mfma_f32_16x16x32_bf16 v[100:103], v[64:67], v[228:231], v[100:103]
    buffer_load_dwordx4 v[60:63], v187, s[48:51], s23 offen offset:2048 sc1
    v_mfma_f32_16x16x32_bf16 v[100:103], v[68:71], v[232:235], v[100:103]
    v_mfma_f32_16x16x32_bf16 v[100:103], v[72:75], v[236:239], v[100:103]
    s_waitcnt vmcnt(32)
    v_mfma_f32_16x16x32_bf16 v[88:91], v[76:79], a[60:63], v[88:91]
    v_mfma_f32_16x16x32_bf16 v[88:91], v[80:83], a[64:67], v[88:91]
    buffer_load_dwordx4 v[64:67], v187, s[48:51], s23 offen offset:3072 sc1
    v_mfma_f32_16x16x32_bf16 v[120:123], v[84:87], a[68:71], v[88:91]
    v_mfma_f32_16x16x32_bf16 v[92:95], v[76:79], a[132:135], v[92:95]
    v_mfma_f32_16x16x32_bf16 v[92:95], v[80:83], a[136:139], v[92:95]
    v_mfma_f32_16x16x32_bf16 v[124:127], v[84:87], a[140:143], v[92:95]
    buffer_load_dwordx4 v[68:71], v188, s[48:51], s23 offen offset:0 sc1
    v_mfma_f32_16x16x32_bf16 v[96:99], v[76:79], a[204:207], v[96:99]
    s_mov_b32 s74, 268435456
    v_mfma_f32_16x16x32_bf16 v[96:99], v[80:83], a[208:211], v[96:99]
    s_add_u32 s27, s27, 1024
    v_mfma_f32_16x16x32_bf16 v[128:131], v[84:87], a[212:215], v[96:99]
    s_add_u32 s25, s25, 1
    v_mfma_f32_16x16x32_bf16 v[100:103], v[76:79], v[240:243], v[100:103]
    buffer_load_dwordx4 v[72:75], v188, s[48:51], s23 offen offset:1024 sc1
    v_mfma_f32_16x16x32_bf16 v[100:103], v[80:83], v[244:247], v[100:103]
    s_add_u32 s23, s23, 18432
    v_mfma_f32_16x16x32_bf16 v[132:135], v[84:87], v[248:251], v[100:103]
    s_cmp_lt_u32 s25, 7
    s_cbranch_scc1 L_ffn_dn_35
    s_waitcnt vmcnt(33)
    v_mfma_f32_16x16x32_bf16 v[88:91], v[104:107], a[0:3], 0
    v_mfma_f32_16x16x32_bf16 v[88:91], v[108:111], a[4:7], v[88:91]
    buffer_load_dwordx4 v[76:79], v184, s[48:51], s23 offen offset:0 sc1
    v_mfma_f32_16x16x32_bf16 v[88:91], v[112:115], a[8:11], v[88:91]
    v_mfma_f32_16x16x32_bf16 v[92:95], v[104:107], a[72:75], 0
    v_mfma_f32_16x16x32_bf16 v[92:95], v[108:111], a[76:79], v[92:95]
    v_mfma_f32_16x16x32_bf16 v[92:95], v[112:115], a[80:83], v[92:95]
    buffer_load_dwordx4 v[80:83], v184, s[48:51], s23 offen offset:1024 sc1
    v_mfma_f32_16x16x32_bf16 v[96:99], v[104:107], a[144:147], 0
    v_cvt_pk_bf16_f32 v152, v120, v121
    v_cvt_pk_bf16_f32 v153, v122, v123
    v_mfma_f32_16x16x32_bf16 v[96:99], v[108:111], a[148:151], v[96:99]
    v_cvt_pk_bf16_f32 v154, v124, v125
    v_cvt_pk_bf16_f32 v155, v126, v127
    v_mfma_f32_16x16x32_bf16 v[96:99], v[112:115], a[152:155], v[96:99]
    s_nop 0
    v_permlane16_swap_b32 v152, v154
    v_mfma_f32_16x16x32_bf16 v[100:103], v[104:107], a[216:219], 0
    buffer_load_dwordx4 v[84:87], v184, s[48:51], s23 offen offset:2048 sc1
    v_mfma_f32_16x16x32_bf16 v[100:103], v[108:111], a[220:223], v[100:103]
    v_permlane16_swap_b32 v153, v155
    v_mfma_f32_16x16x32_bf16 v[100:103], v[112:115], a[224:227], v[100:103]
    buffer_store_dwordx4 v[152:155], v178, s[72:75], s27 offen sc1
    s_waitcnt vmcnt(34)
    v_mfma_f32_16x16x32_bf16 v[88:91], v[116:119], a[12:15], v[88:91]
    ds_write_b128 v216, v[152:155]
    v_mfma_f32_16x16x32_bf16 v[88:91], v[180:183], a[16:19], v[88:91]
    v_add_u32 v216, v216, v218
    v_cvt_pk_bf16_f32 v156, v128, v129
    v_mfma_f32_16x16x32_bf16 v[88:91], v[196:199], a[20:23], v[88:91]
    v_cvt_pk_bf16_f32 v157, v130, v131
    v_cvt_pk_bf16_f32 v158, v132, v133
    s_load_dwordx8 s[56:63], s[38:39], 0 glc
    v_mfma_f32_16x16x32_bf16 v[92:95], v[116:119], a[84:87], v[92:95]
    v_cvt_pk_bf16_f32 v159, v134, v135
    s_mov_b32 s6, 0
    v_mfma_f32_16x16x32_bf16 v[92:95], v[180:183], a[88:91], v[92:95]
    s_nop 0
    v_permlane16_swap_b32 v156, v158
    v_mfma_f32_16x16x32_bf16 v[92:95], v[196:199], a[92:95], v[92:95]
    v_permlane16_swap_b32 v157, v159
    v_mfma_f32_16x16x32_bf16 v[96:99], v[116:119], a[156:159], v[96:99]
    buffer_store_dwordx4 v[156:159], v179, s[72:75], s27 offen sc1
    v_mfma_f32_16x16x32_bf16 v[96:99], v[180:183], a[160:163], v[96:99]
    ds_write_b128 v217, v[156:159]
    v_mfma_f32_16x16x32_bf16 v[96:99], v[196:199], a[164:167], v[96:99]
    v_add_u32 v217, v217, v219
    v_mfma_f32_16x16x32_bf16 v[100:103], v[116:119], a[228:231], v[100:103]
    v_mfma_f32_16x16x32_bf16 v[100:103], v[180:183], a[232:235], v[100:103]
    v_mfma_f32_16x16x32_bf16 v[100:103], v[196:199], a[236:239], v[100:103]
    s_waitcnt vmcnt(32)
L_epoll_38:
    s_waitcnt lgkmcnt(0)
    s_xor_b64 s[56:57], s[56:57], s[76:77]
    s_xor_b64 s[58:59], s[58:59], s[76:77]
    s_xor_b64 s[60:61], s[60:61], s[76:77]
    s_xor_b64 s[62:63], s[62:63], s[76:77]
    s_or_b64 s[56:57], s[56:57], s[58:59]
    s_or_b64 s[60:61], s[60:61], s[62:63]
    s_or_b64 s[56:57], s[56:57], s[60:61]
    s_cbranch_scc0 L_epolled_39
    s_load_dwordx8 s[56:63], s[38:39], 0 glc
    s_add_u32 s6, s6, 1
    s_cmp_lt_u32 s6, 1048576
    s_cbranch_scc1 L_epoll_38
    s_branch L_main_end
L_epolled_39:
    v_mfma_f32_16x16x32_bf16 v[88:91], v[200:203], a[24:27], v[88:91]
    v_mfma_f32_16x16x32_bf16 v[88:91], v[204:207], a[28:31], v[88:91]
    s_add_u32 s7, s40, 1
    s_and_b32 s7, s7, 7
    s_mul_i32 s7, s7, 9216
    s_add_u32 s19, s7, s20
    buffer_load_dwordx4 v[104:107], v172, s[8:11], s19 offen sc1
    v_mfma_f32_16x16x32_bf16 v[88:91], v[208:211], a[32:35], v[88:91]
    v_mfma_f32_16x16x32_bf16 v[92:95], v[200:203], a[96:99], v[92:95]
    v_mfma_f32_16x16x32_bf16 v[92:95], v[204:207], a[100:103], v[92:95]
    v_mfma_f32_16x16x32_bf16 v[92:95], v[208:211], a[104:107], v[92:95]
    buffer_load_dwordx4 v[108:111], v173, s[8:11], s19 offen sc1
    v_mfma_f32_16x16x32_bf16 v[96:99], v[200:203], a[168:171], v[96:99]
    v_mfma_f32_16x16x32_bf16 v[96:99], v[204:207], a[172:175], v[96:99]
    v_mfma_f32_16x16x32_bf16 v[96:99], v[208:211], a[176:179], v[96:99]
    v_mfma_f32_16x16x32_bf16 v[100:103], v[200:203], a[240:243], v[100:103]
    s_add_u32 s7, s40, 2
    s_and_b32 s7, s7, 7
    s_mul_i32 s7, s7, 9216
    s_add_u32 s19, s7, s20
    buffer_load_dwordx4 v[112:115], v172, s[8:11], s19 offen sc1
    v_mfma_f32_16x16x32_bf16 v[100:103], v[204:207], a[244:247], v[100:103]
    v_mfma_f32_16x16x32_bf16 v[100:103], v[208:211], a[248:251], v[100:103]
    s_waitcnt vmcnt(31)
    v_mfma_f32_16x16x32_bf16 v[88:91], v[212:215], a[36:39], v[88:91]
    v_mfma_f32_16x16x32_bf16 v[88:91], v[136:139], a[40:43], v[88:91]
    buffer_load_dwordx4 v[116:119], v173, s[8:11], s19 offen sc1
    v_mfma_f32_16x16x32_bf16 v[88:91], v[140:143], a[44:47], v[88:91]
    v_mfma_f32_16x16x32_bf16 v[92:95], v[212:215], a[108:111], v[92:95]
    v_mfma_f32_16x16x32_bf16 v[92:95], v[136:139], a[112:115], v[92:95]
    v_mfma_f32_16x16x32_bf16 v[92:95], v[140:143], a[116:119], v[92:95]
    s_add_u32 s7, s40, 3
    s_and_b32 s7, s7, 7
    s_mul_i32 s7, s7, 9216
    s_add_u32 s19, s7, s20
    buffer_load_dwordx4 v[180:183], v172, s[8:11], s19 offen sc1
    v_mfma_f32_16x16x32_bf16 v[96:99], v[212:215], a[180:183], v[96:99]
    v_mfma_f32_16x16x32_bf16 v[96:99], v[136:139], a[184:187], v[96:99]
    v_mfma_f32_16x16x32_bf16 v[96:99], v[140:143], a[188:191], v[96:99]
    v_mfma_f32_16x16x32_bf16 v[100:103], v[212:215], a[252:255], v[100:103]
    buffer_load_dwordx4 v[196:199], v173, s[8:11], s19 offen sc1
    v_mfma_f32_16x16x32_bf16 v[100:103], v[136:139], v[220:223], v[100:103]
    v_mfma_f32_16x16x32_bf16 v[100:103], v[140:143], v[224:227], v[100:103]
    s_waitcnt vmcnt(31)
    v_mfma_f32_16x16x32_bf16 v[88:91], v[144:147], a[48:51], v[88:91]
    v_mfma_f32_16x16x32_bf16 v[88:91], v[160:163], a[52:55], v[88:91]
    s_add_u32 s7, s40, 4
    s_and_b32 s7, s7, 7
    s_mul_i32 s7, s7, 9216
    s_add_u32 s19, s7, s20
    buffer_load_dwordx4 v[200:203], v172, s[8:11], s19 offen sc1
    v_mfma_f32_16x16x32_bf16 v[88:91], v[164:167], a[56:59], v[88:91]
    v_mfma_f32_16x16x32_bf16 v[92:95], v[144:147], a[120:123], v[92:95]
    v_mfma_f32_16x16x32_bf16 v[92:95], v[160:163], a[124:127], v[92:95]
    v_mfma_f32_16x16x32_bf16 v[92:95], v[164:167], a[128:131], v[92:95]
    buffer_load_dwordx4 v[204:207], v173, s[8:11], s19 offen sc1
    v_mfma_f32_16x16x32_bf16 v[96:99], v[144:147], a[192:195], v[96:99]
    v_mfma_f32_16x16x32_bf16 v[96:99], v[160:163], a[196:199], v[96:99]
    v_mfma_f32_16x16x32_bf16 v[96:99], v[164:167], a[200:203], v[96:99]
    v_mfma_f32_16x16x32_bf16 v[100:103], v[144:147], v[228:231], v[100:103]
    s_add_u32 s7, s40, 5
    s_and_b32 s7, s7, 7
    s_mul_i32 s7, s7, 9216
    s_add_u32 s19, s7, s20
    buffer_load_dwordx4 v[208:211], v172, s[8:11], s19 offen sc1
    v_mfma_f32_16x16x32_bf16 v[100:103], v[160:163], v[232:235], v[100:103]
    v_mfma_f32_16x16x32_bf16 v[100:103], v[164:167], v[236:239], v[100:103]
    s_waitcnt vmcnt(31)
    v_mfma_f32_16x16x32_bf16 v[88:91], v[168:171], a[60:63], v[88:91]
    v_mfma_f32_16x16x32_bf16 v[88:91], v[148:151], a[64:67], v[88:91]
    buffer_load_dwordx4 v[212:215], v173, s[8:11], s19 offen sc1
    v_mfma_f32_16x16x32_bf16 v[120:123], v[4:7], a[68:71], v[88:91]
    v_mfma_f32_16x16x32_bf16 v[92:95], v[168:171], a[132:135], v[92:95]
    v_mfma_f32_16x16x32_bf16 v[92:95], v[148:151], a[136:139], v[92:95]
    v_mfma_f32_16x16x32_bf16 v[124:127], v[4:7], a[140:143], v[92:95]
    s_add_u32 s7, s40, 6
    s_and_b32 s7, s7, 7
    s_mul_i32 s7, s7, 9216
    s_add_u32 s19, s7, s20
    buffer_load_dwordx4 v[136:139], v172, s[8:11], s19 offen sc1
    v_mfma_f32_16x16x32_bf16 v[96:99], v[168:171], a[204:207], v[96:99]
    s_mov_b32 s74, 268435456
    v_mfma_f32_16x16x32_bf16 v[96:99], v[148:151], a[208:211], v[96:99]
    s_add_u32 s27, s27, 1024
    v_mfma_f32_16x16x32_bf16 v[128:131], v[4:7], a[212:215], v[96:99]
    s_add_u32 s25, s25, 1
    v_mfma_f32_16x16x32_bf16 v[100:103], v[168:171], v[240:243], v[100:103]
    buffer_load_dwordx4 v[140:143], v173, s[8:11], s19 offen sc1
    v_mfma_f32_16x16x32_bf16 v[100:103], v[148:151], v[244:247], v[100:103]
    s_add_u32 s23, s23, 18432
    v_mfma_f32_16x16x32_bf16 v[132:135], v[4:7], v[248:251], v[100:103]
    s_waitcnt vmcnt(30)
    v_mfma_f32_16x16x32_bf16 v[88:91], v[16:19], a[0:3], 0
    v_mfma_f32_16x16x32_bf16 v[88:91], v[20:23], a[4:7], v[88:91]
    s_add_u32 s7, s40, 7
    s_and_b32 s7, s7, 7
    s_mul_i32 s7, s7, 9216
    s_add_u32 s19, s7, s20
    buffer_load_dwordx4 v[144:147], v172, s[8:11], s19 offen sc1
    v_mfma_f32_16x16x32_bf16 v[88:91], v[24:27], a[8:11], v[88:91]
    v_mfma_f32_16x16x32_bf16 v[92:95], v[16:19], a[72:75], 0
    v_mfma_f32_16x16x32_bf16 v[92:95], v[20:23], a[76:79], v[92:95]
    v_mfma_f32_16x16x32_bf16 v[92:95], v[24:27], a[80:83], v[92:95]
    buffer_load_dwordx4 v[160:163], v173, s[8:11], s19 offen sc1
    v_mfma_f32_16x16x32_bf16 v[96:99], v[16:19], a[144:147], 0
    v_cvt_pk_bf16_f32 v152, v120, v121
    v_cvt_pk_bf16_f32 v153, v122, v123
    v_mfma_f32_16x16x32_bf16 v[96:99], v[20:23], a[148:151], v[96:99]
    v_cvt_pk_bf16_f32 v154, v124, v125
    v_cvt_pk_bf16_f32 v155, v126, v127
    v_mfma_f32_16x16x32_bf16 v[96:99], v[24:27], a[152:155], v[96:99]
    s_nop 0
    v_permlane16_swap_b32 v152, v154
    v_mfma_f32_16x16x32_bf16 v[100:103], v[16:19], a[216:219], 0
    v_permlane16_swap_b32 v153, v155
    v_mfma_f32_16x16x32_bf16 v[100:103], v[20:23], a[220:223], v[100:103]
    buffer_store_dwordx4 v[152:155], v178, s[72:75], s27 offen sc1
    v_mfma_f32_16x16x32_bf16 v[100:103], v[24:27], a[224:227], v[100:103]
    ds_write_b128 v216, v[152:155]
    s_waitcnt vmcnt(30)
    v_mfma_f32_16x16x32_bf16 v[88:91], v[28:31], a[12:15], v[88:91]
    v_add_u32 v216, v216, v218
    v_cvt_pk_bf16_f32 v156, v128, v129
    v_mfma_f32_16x16x32_bf16 v[88:91], v[32:35], a[16:19], v[88:91]
    v_cvt_pk_bf16_f32 v157, v130, v131
    v_cvt_pk_bf16_f32 v158, v132, v133
    v_mfma_f32_16x16x32_bf16 v[88:91], v[36:39], a[20:23], v[88:91]
    v_cvt_pk_bf16_f32 v159, v134, v135
    v_mfma_f32_16x16x32_bf16 v[92:95], v[28:31], a[84:87], v[92:95]
    s_nop 0
    v_permlane16_swap_b32 v156, v158
    v_mfma_f32_16x16x32_bf16 v[92:95], v[32:35], a[88:91], v[92:95]
    v_permlane16_swap_b32 v157, v159
    v_mfma_f32_16x16x32_bf16 v[92:95], v[36:39], a[92:95], v[92:95]
    buffer_store_dwordx4 v[156:159], v179, s[72:75], s27 offen sc1
    v_mfma_f32_16x16x32_bf16 v[96:99], v[28:31], a[156:159], v[96:99]
    ds_write_b128 v217, v[156:159]
    v_mfma_f32_16x16x32_bf16 v[96:99], v[32:35], a[160:163], v[96:99]
    v_add_u32 v217, v217, v219
    v_mfma_f32_16x16x32_bf16 v[96:99], v[36:39], a[164:167], v[96:99]
    v_mfma_f32_16x16x32_bf16 v[100:103], v[28:31], a[228:231], v[100:103]
    v_mfma_f32_16x16x32_bf16 v[100:103], v[32:35], a[232:235], v[100:103]
    v_mfma_f32_16x16x32_bf16 v[100:103], v[36:39], a[236:239], v[100:103]
    s_waitcnt vmcnt(28)
    v_mfma_f32_16x16x32_bf16 v[88:91], v[40:43], a[24:27], v[88:91]
    v_mfma_f32_16x16x32_bf16 v[88:91], v[44:47], a[28:31], v[88:91]
    v_mfma_f32_16x16x32_bf16 v[88:91], v[48:51], a[32:35], v[88:91]
    v_mfma_f32_16x16x32_bf16 v[92:95], v[40:43], a[96:99], v[92:95]
    v_mfma_f32_16x16x32_bf16 v[92:95], v[44:47], a[100:103], v[92:95]
    v_mfma_f32_16x16x32_bf16 v[92:95], v[48:51], a[104:107], v[92:95]
    v_mfma_f32_16x16x32_bf16 v[96:99], v[40:43], a[168:171], v[96:99]
    v_mfma_f32_16x16x32_bf16 v[96:99], v[44:47], a[172:175], v[96:99]
    v_mfma_f32_16x16x32_bf16 v[96:99], v[48:51], a[176:179], v[96:99]
    v_mfma_f32_16x16x32_bf16 v[100:103], v[40:43], a[240:243], v[100:103]
    v_mfma_f32_16x16x32_bf16 v[100:103], v[44:47], a[244:247], v[100:103]
    v_mfma_f32_16x16x32_bf16 v[100:103], v[48:51], a[248:251], v[100:103]
    s_waitcnt vmcnt(24)
    v_mfma_f32_16x16x32_bf16 v[88:91], v[52:55], a[36:39], v[88:91]
    v_mfma_f32_16x16x32_bf16 v[88:91], v[56:59], a[40:43], v[88:91]
    v_mfma_f32_16x16x32_bf16 v[88:91], v[60:63], a[44:47], v[88:91]
    v_mfma_f32_16x16x32_bf16 v[92:95], v[52:55], a[108:111], v[92:95]
    v_mfma_f32_16x16x32_bf16 v[92:95], v[56:59], a[112:115], v[92:95]
    v_mfma_f32_16x16x32_bf16 v[92:95], v[60:63], a[116:119], v[92:95]
    v_mfma_f32_16x16x32_bf16 v[96:99], v[52:55], a[180:183], v[96:99]
    v_mfma_f32_16x16x32_bf16 v[96:99], v[56:59], a[184:187], v[96:99]
    v_mfma_f32_16x16x32_bf16 v[96:99], v[60:63], a[188:191], v[96:99]
    v_mfma_f32_16x16x32_bf16 v[100:103], v[52:55], a[252:255], v[100:103]
    v_mfma_f32_16x16x32_bf16 v[100:103], v[56:59], v[220:223], v[100:103]
    v_mfma_f32_16x16x32_bf16 v[100:103], v[60:63], v[224:227], v[100:103]
    s_waitcnt vmcnt(21)
    v_mfma_f32_16x16x32_bf16 v[88:91], v[64:67], a[48:51], v[88:91]
    v_mfma_f32_16x16x32_bf16 v[88:91], v[68:71], a[52:55], v[88:91]
    v_mfma_f32_16x16x32_bf16 v[88:91], v[72:75], a[56:59], v[88:91]
    v_mfma_f32_16x16x32_bf16 v[92:95], v[64:67], a[120:123], v[92:95]
    v_mfma_f32_16x16x32_bf16 v[92:95], v[68:71], a[124:127], v[92:95]
    v_mfma_f32_16x16x32_bf16 v[92:95], v[72:75], a[128:131], v[92:95]
    v_mfma_f32_16x16x32_bf16 v[96:99], v[64:67], a[192:195], v[96:99]
    v_mfma_f32_16x16x32_bf16 v[96:99], v[68:71], a[196:199], v[96:99]
    v_mfma_f32_16x16x32_bf16 v[96:99], v[72:75], a[200:203], v[96:99]
    v_mfma_f32_16x16x32_bf16 v[100:103], v[64:67], v[228:231], v[100:103]
    v_mfma_f32_16x16x32_bf16 v[100:103], v[68:71], v[232:235], v[100:103]
    v_mfma_f32_16x16x32_bf16 v[100:103], v[72:75], v[236:239], v[100:103]
    s_waitcnt vmcnt(18)
    v_mfma_f32_16x16x32_bf16 v[88:91], v[76:79], a[60:63], v[88:91]
    v_mfma_f32_16x16x32_bf16 v[88:91], v[80:83], a[64:67], v[88:91]
    v_mfma_f32_16x16x32_bf16 v[120:123], v[84:87], a[68:71], v[88:91]
    v_mfma_f32_16x16x32_bf16 v[92:95], v[76:79], a[132:135], v[92:95]
    v_mfma_f32_16x16x32_bf16 v[92:95], v[80:83], a[136:139], v[92:95]
    v_mfma_f32_16x16x32_bf16 v[124:127], v[84:87], a[140:143], v[92:95]
    v_mfma_f32_16x16x32_bf16 v[96:99], v[76:79], a[204:207], v[96:99]
    s_mov_b32 s74, 268435456
    v_mfma_f32_16x16x32_bf16 v[96:99], v[80:83], a[208:211], v[96:99]
    s_add_u32 s27, s27, 1024
    v_mfma_f32_16x16x32_bf16 v[128:131], v[84:87], a[212:215], v[96:99]
    s_add_u32 s25, s25, 1
    v_mfma_f32_16x16x32_bf16 v[100:103], v[76:79], v[240:243], v[100:103]
    v_mfma_f32_16x16x32_bf16 v[100:103], v[80:83], v[244:247], v[100:103]
    s_add_u32 s23, s23, 18432
    v_mfma_f32_16x16x32_bf16 v[132:135], v[84:87], v[248:251], v[100:103]
    s_nop 7
    v_cvt_pk_bf16_f32 v152, v120, v121
    v_cvt_pk_bf16_f32 v153, v122, v123
    v_cvt_pk_bf16_f32 v154, v124, v125
    v_cvt_pk_bf16_f32 v155, v126, v127
    v_cvt_pk_bf16_f32 v156, v128, v129
    v_cvt_pk_bf16_f32 v157, v130, v131
    v_cvt_pk_bf16_f32 v158, v132, v133
    v_cvt_pk_bf16_f32 v159, v134, v135
    s_nop 0
    v_permlane16_swap_b32 v152, v154
    v_permlane16_swap_b32 v153, v155
    buffer_store_dwordx4 v[152:155], v178, s[72:75], s27 offen sc1
    s_nop 0
    v_permlane16_swap_b32 v156, v158
    v_permlane16_swap_b32 v157, v159
    buffer_store_dwordx4 v[156:159], v179, s[72:75], s27 offen sc1
    ds_write_b128 v216, v[152:155]
    ds_write_b128 v217, v[156:159]
    s_waitcnt lgkmcnt(0)
    v_lshlrev_b32 v15, 7, v0
    s_lshl_b32 s6, s40, 2
    s_add_u32 s6, s6, s44
    s_add_u32 s6, s6, 65536
    v_mov_b32 v1, s76
    s_mov_b64 vcc, 0xff
    s_waitcnt vmcnt(0)
    s_barrier
    s_cmp_lg_u32 s3, 0
    s_cbranch_scc1 L_pub_40
    s_mov_b64 exec, vcc
    buffer_store_dword v1, v15, s[8:11], s6 offen sc1
L_pub_40:
    s_mov_b64 exec, -1
    s_add_u32 s19, s18, s43
    s_add_u32 s22, s19, 45875200
    s_lshl_b32 s23, s21, 5
    s_add_u32 s23, s23, s43
    s_add_u32 s23, s23, 48431104
    v_and_b32 v12, 7, v0
    v_lshlrev_b32 v12, 2, v12
    buffer_load_dword v10, v12, s[8:11], s23 offen sc1
    buffer_load_dwordx4 v[92:95], v172, s[8:11], s22 offen sc1
    buffer_load_dwordx4 v[96:99], v173, s[8:11], s22 offen sc1
    buffer_load_dwordx4 v[100:103], v174, s[8:11], s22 offen sc1
    v_min_u32 v13, 9216, v173
    ds_read_b128 v[148:151], v172 offset:4096
    ds_read_b128 v[152:155], v13 offset:4096
    ds_read_b128 v[156:159], v174 offset:4096
    s_lshl_b32 s28, s40, 2
    s_add_u32 s28, s28, s3
    s_mul_i32 s28, s28, 73728
    v_and_b32 v229, 8, v0
    v_lshl_add_u32 v229, v229, 27, v253
    s_mul_i32 s7, s42, 1073741824
    v_add_u32 v3, s7, v253
    v_or_b32 v229, s7, v229
    v_lshlrev_b32 v16, 16, v104
    v_and_b32 v17, s16, v104
    v_lshlrev_b32 v18, 16, v105
    v_and_b32 v19, s16, v105
    v_lshlrev_b32 v20, 16, v106
    v_and_b32 v21, s16, v106
    v_lshlrev_b32 v22, 16, v107
    v_and_b32 v23, s16, v107
    v_lshlrev_b32 v24, 16, v108
    v_and_b32 v25, s16, v108
    v_lshlrev_b32 v26, 16, v109
    v_and_b32 v27, s16, v109
    v_lshlrev_b32 v28, 16, v110
    v_and_b32 v29, s16, v110
    v_lshlrev_b32 v30, 16, v111
    v_and_b32 v31, s16, v111
    s_cmp_lg_u32 s42, 0
    s_cbranch_scc1 L_nopf_41
    buffer_load_dwordx4 a[0:3], v3, s[8:11], s28 offen offset:0 sc1
    buffer_load_dwordx4 a[4:7], v3, s[8:11], s28 offen offset:1024 sc1
    buffer_load_dwordx4 a[8:11], v3, s[8:11], s28 offen offset:2048 sc1
    buffer_load_dwordx4 a[12:15], v229, s[8:11], s28 offen offset:3072 sc1
    s_add_u32 s28, s28, 4096
    buffer_load_dwordx4 a[16:19], v3, s[8:11], s28 offen offset:0 sc1
    buffer_load_dwordx4 a[20:23], v3, s[8:11], s28 offen offset:1024 sc1
    buffer_load_dwordx4 a[24:27], v3, s[8:11], s28 offen offset:2048 sc1
    buffer_load_dwordx4 a[28:31], v229, s[8:11], s28 offen offset:3072 sc1
L_nopf_41:
    v_lshlrev_b32 v40, 16, v112
    v_and_b32 v41, s16, v112
    v_lshlrev_b32 v42, 16, v113
    v_and_b32 v43, s16, v113
    v_lshlrev_b32 v44, 16, v114
    v_and_b32 v45, s16, v114
    v_lshlrev_b32 v46, 16, v115
    v_and_b32 v47, s16, v115
    v_pk_add_f32 v[16:17], v[16:17], v[40:41]
    v_pk_add_f32 v[18:19], v[18:19], v[42:43]
    v_pk_add_f32 v[20:21], v[20:21], v[44:45]
    v_pk_add_f32 v[22:23], v[22:23], v[46:47]
    v_lshlrev_b32 v40, 16, v116
    v_and_b32 v41, s16, v116
    v_lshlrev_b32 v42, 16, v117
    v_and_b32 v43, s16, v117
    v_lshlrev_b32 v44, 16, v118
    v_and_b32 v45, s16, v118
    v_lshlrev_b32 v46, 16, v119
    v_and_b32 v47, s16, v119
    v_pk_add_f32 v[24:25], v[24:25], v[40:41]
    v_pk_add_f32 v[26:27], v[26:27], v[42:43]
    v_pk_add_f32 v[28:29], v[28:29], v[44:45]
    v_pk_add_f32 v[30:31], v[30:31], v[46:47]
    s_cmp_lg_u32 s42, 0
    s_cbranch_scc1 L_nopf_42
    s_add_u32 s28, s28, 4096
    buffer_load_dwordx4 a[32:35], v3, s[8:11], s28 offen offset:0 sc1
    buffer_load_dwordx4 a[36:39], v3, s[8:11], s28 offen offset:1024 sc1
    buffer_load_dwordx4 a[40:43], v3, s[8:11], s28 offen offset:2048 sc1
    buffer_load_dwordx4 a[44:47], v229, s[8:11], s28 offen offset:3072 sc1
    s_add_u32 s28, s28, 4096
    buffer_load_dwordx4 a[48:51], v3, s[8:11], s28 offen offset:0 sc1
    buffer_load_dwordx4 a[52:55], v3, s[8:11], s28 offen offset:1024 sc1
    buffer_load_dwordx4 a[56:59], v3, s[8:11], s28 offen offset:2048 sc1
    buffer_load_dwordx4 a[60:63], v229, s[8:11], s28 offen offset:3072 sc1
L_nopf_42:
    v_lshlrev_b32 v40, 16, v180
    v_and_b32 v41, s16, v180
    v_lshlrev_b32 v42, 16, v181
    v_and_b32 v43, s16, v181
    v_lshlrev_b32 v44, 16, v182
    v_and_b32 v45, s16, v182
    v_lshlrev_b32 v46, 16, v183
    v_and_b32 v47, s16, v183
    v_pk_add_f32 v[16:17], v[16:17], v[40:41]
    v_pk_add_f32 v[18:19], v[18:19], v[42:43]
    v_pk_add_f32 v[20:21], v[20:21], v[44:45]
    v_pk_add_f32 v[22:23], v[22:23], v[46:47]
    v_lshlrev_b32 v40, 16, v196
    v_and_b32 v41, s16, v196
    v_lshlrev_b32 v42, 16, v197
    v_and_b32 v43, s16, v197
    v_lshlrev_b32 v44, 16, v198
    v_and_b32 v45, s16, v198
    v_lshlrev_b32 v46, 16, v199
    v_and_b32 v47, s16, v199
    v_pk_add_f32 v[24:25], v[24:25], v[40:41]
    v_pk_add_f32 v[26:27], v[26:27], v[42:43]
    v_pk_add_f32 v[28:29], v[28:29], v[44:45]
    v_pk_add_f32 v[30:31], v[30:31], v[46:47]
    v_lshlrev_b32 v40, 16, v200
    v_and_b32 v41, s16, v200
    v_lshlrev_b32 v42, 16, v201
    v_and_b32 v43, s16, v201
    v_lshlrev_b32 v44, 16, v202
    v_and_b32 v45, s16, v202
    v_lshlrev_b32 v46, 16, v203
    v_and_b32 v47, s16, v203
    v_pk_add_f32 v[16:17], v[16:17], v[40:41]
    v_pk_add_f32 v[18:19], v[18:19], v[42:43]
    v_pk_add_f32 v[20:21], v[20:21], v[44:45]
    v_pk_add_f32 v[22:23], v[22:23], v[46:47]
    v_lshlrev_b32 v40, 16, v204
    v_and_b32 v41, s16, v204
    v_lshlrev_b32 v42, 16, v205
    v_and_b32 v43, s16, v205
    v_lshlrev_b32 v44, 16, v206
    v_and_b32 v45, s16, v206
    v_lshlrev_b32 v46, 16, v207
    v_and_b32 v47, s16, v207
    v_pk_add_f32 v[24:25], v[24:25], v[40:41]
    v_pk_add_f32 v[26:27], v[26:27], v[42:43]
    v_pk_add_f32 v[28:29], v[28:29], v[44:45]
    v_pk_add_f32 v[30:31], v[30:31], v[46:47]
    s_cmp_lg_u32 s3, 3
    s_cbranch_scc1 L_pollout_45
    s_lshl_b32 s7, s40, 7
    s_add_u32 s7, s7, s44
    s_add_u32 s7, s7, 65536
    s_add_u32 s52, s4, s7
    s_addc_u32 s53, s5, 0
    s_mov_b32 s6, 0
L_poll_43:
    s_load_dwordx8 s[56:63], s[52:53], 0 glc
    s_add_u32 s6, s6, 1
    s_waitcnt lgkmcnt(0)
    s_xor_b64 s[56:57], s[56:57], s[76:77]
    s_xor_b64 s[58:59], s[58:59], s[76:77]
    s_xor_b64 s[60:61], s[60:61], s[76:77]
    s_xor_b64 s[62:63], s[62:63], s[76:77]
    s_or_b64 s[56:57], s[56:57], s[58:59]
    s_or_b64 s[60:61], s[60:61], s[62:63]
    s_or_b64 s[56:57], s[56:57], s[60:61]
    s_cbranch_scc0 L_polled_44
    s_cmp_lt_u32 s6, 1048576
    s_cbranch_scc1 L_poll_43
    s_branch L_main_end
L_polled_44:
L_pollout_45:
    s_barrier
    s_add_u32 s7, s40, 1
    s_and_b32 s7, s7, 7
    s_mul_i32 s7, s7, 9216
    s_add_u32 s19, s7, s20
    buffer_load_dwordx4 v[60:63], v174, s[8:11], s19 offen sc1
    s_add_u32 s7, s40, 2
    s_and_b32 s7, s7, 7
    s_mul_i32 s7, s7, 9216
    s_add_u32 s19, s7, s20
    buffer_load_dwordx4 v[64:67], v174, s[8:11], s19 offen sc1
    s_add_u32 s7, s40, 3
    s_and_b32 s7, s7, 7
    s_mul_i32 s7, s7, 9216
    s_add_u32 s19, s7, s20
    buffer_load_dwordx4 v[68:71], v174, s[8:11], s19 offen sc1
    s_add_u32 s7, s40, 4
    s_and_b32 s7, s7, 7
    s_mul_i32 s7, s7, 9216
    s_add_u32 s19, s7, s20
    buffer_load_dwordx4 v[72:75], v174, s[8:11], s19 offen sc1
    s_add_u32 s7, s40, 5
    s_and_b32 s7, s7, 7
    s_mul_i32 s7, s7, 9216
    s_add_u32 s19, s7, s20
    buffer_load_dwordx4 v[76:79], v174, s[8:11], s19 offen sc1
    s_add_u32 s7, s40, 6
    s_and_b32 s7, s7, 7
    s_mul_i32 s7, s7, 9216
    s_add_u32 s19, s7, s20
    buffer_load_dwordx4 v[80:83], v174, s[8:11], s19 offen sc1
    s_add_u32 s7, s40, 7
    s_and_b32 s7, s7, 7
    s_mul_i32 s7, s7, 9216
    s_add_u32 s19, s7, s20
    buffer_load_dwordx4 v[84:87], v174, s[8:11], s19 offen sc1
    v_lshlrev_b32 v40, 16, v208
    v_and_b32 v41, s16, v208
    v_lshlrev_b32 v42, 16, v209
    v_and_b32 v43, s16, v209
    v_lshlrev_b32 v44, 16, v210
    v_and_b32 v45, s16, v210
    v_lshlrev_b32 v46, 16, v211
    v_and_b32 v47, s16, v211
    v_pk_add_f32 v[16:17], v[16:17], v[40:41]
    v_pk_add_f32 v[18:19], v[18:19], v[42:43]
    v_pk_add_f32 v[20:21], v[20:21], v[44:45]
    v_pk_add_f32 v[22:23], v[22:23], v[46:47]
    v_lshlrev_b32 v40, 16, v212
    v_and_b32 v41, s16, v212
    v_lshlrev_b32 v42, 16, v213
    v_and_b32 v43, s16, v213
    v_lshlrev_b32 v44, 16, v214
    v_and_b32 v45, s16, v214
    v_lshlrev_b32 v46, 16, v215
    v_and_b32 v47, s16, v215
    v_pk_add_f32 v[24:25], v[24:25], v[40:41]
    v_pk_add_f32 v[26:27], v[26:27], v[42:43]
    v_pk_add_f32 v[28:29], v[28:29], v[44:45]
    v_pk_add_f32 v[30:31], v[30:31], v[46:47]
    v_lshlrev_b32 v40, 16, v136
    v_and_b32 v41, s16, v136
    v_lshlrev_b32 v42, 16, v137
    v_and_b32 v43, s16, v137
    v_lshlrev_b32 v44, 16, v138
    v_and_b32 v45, s16, v138
    v_lshlrev_b32 v46, 16, v139
    v_and_b32 v47, s16, v139
    v_pk_add_f32 v[16:17], v[16:17], v[40:41]
    v_pk_add_f32 v[18:19], v[18:19], v[42:43]
    v_pk_add_f32 v[20:21], v[20:21], v[44:45]
    v_pk_add_f32 v[22:23], v[22:23], v[46:47]
    v_lshlrev_b32 v40, 16, v140
    v_and_b32 v41, s16, v140
    v_lshlrev_b32 v42, 16, v141
    v_and_b32 v43, s16, v141
    v_lshlrev_b32 v44, 16, v142
    v_and_b32 v45, s16, v142
    v_lshlrev_b32 v46, 16, v143
    v_and_b32 v47, s16, v143
    v_pk_add_f32 v[24:25], v[24:25], v[40:41]
    v_pk_add_f32 v[26:27], v[26:27], v[42:43]
    v_pk_add_f32 v[28:29], v[28:29], v[44:45]
    v_pk_add_f32 v[30:31], v[30:31], v[46:47]
    v_lshlrev_b32 v40, 16, v144
    v_and_b32 v41, s16, v144
    v_lshlrev_b32 v42, 16, v145
    v_and_b32 v43, s16, v145
    v_lshlrev_b32 v44, 16, v146
    v_and_b32 v45, s16, v146
    v_lshlrev_b32 v46, 16, v147
    v_and_b32 v47, s16, v147
    v_pk_add_f32 v[16:17], v[16:17], v[40:41]
    v_pk_add_f32 v[18:19], v[18:19], v[42:43]
    v_pk_add_f32 v[20:21], v[20:21], v[44:45]
    v_pk_add_f32 v[22:23], v[22:23], v[46:47]
    v_lshlrev_b32 v40, 16, v160
    v_and_b32 v41, s16, v160
    v_lshlrev_b32 v42, 16, v161
    v_and_b32 v43, s16, v161
    v_lshlrev_b32 v44, 16, v162
    v_and_b32 v45, s16, v162
    v_lshlrev_b32 v46, 16, v163
    v_and_b32 v47, s16, v163
    v_pk_add_f32 v[24:25], v[24:25], v[40:41]
    v_pk_add_f32 v[26:27], v[26:27], v[42:43]
    v_pk_add_f32 v[28:29], v[28:29], v[44:45]
    v_pk_add_f32 v[30:31], v[30:31], v[46:47]
    s_cmp_eq_u32 s3, 0
    s_cselect_b32 s7, 1.0, 0
    s_cselect_b32 s6, -1, 0
    s_waitcnt vmcnt(7) lgkmcnt(0)
    v_and_b32 v152, s6, v152
    v_and_b32 v153, s6, v153
    v_and_b32 v154, s6, v154
    v_and_b32 v155, s6, v155
    v_mul_f32 v11, s7, v10
    v_lshlrev_b32 v40, 16, v92
    v_and_b32 v41, s16, v92
    v_lshlrev_b32 v42, 16, v93
    v_and_b32 v43, s16, v93
    v_lshlrev_b32 v44, 16, v94
    v_and_b32 v45, s16, v94
    v_lshlrev_b32 v46, 16, v95
    v_and_b32 v47, s16, v95
    v_pk_add_f32 v[16:17], v[16:17], v[40:41]
    v_pk_add_f32 v[18:19], v[18:19], v[42:43]
    v_pk_add_f32 v[20:21], v[20:21], v[44:45]
    v_pk_add_f32 v[22:23], v[22:23], v[46:47]
    v_lshlrev_b32 v40, 16, v96
    v_and_b32 v41, s16, v96
    v_lshlrev_b32 v42, 16, v97
    v_and_b32 v43, s16, v97
    v_lshlrev_b32 v44, 16, v98
    v_and_b32 v45, s16, v98
    v_lshlrev_b32 v46, 16, v99
    v_and_b32 v47, s16, v99
    v_pk_add_f32 v[24:25], v[24:25], v[40:41]
    v_pk_add_f32 v[26:27], v[26:27], v[42:43]
    v_pk_add_f32 v[28:29], v[28:29], v[44:45]
    v_pk_add_f32 v[30:31], v[30:31], v[46:47]
    v_lshlrev_b32 v32, 16, v100
    v_and_b32 v33, s16, v100
    v_lshlrev_b32 v34, 16, v101
    v_and_b32 v35, s16, v101
    v_lshlrev_b32 v36, 16, v102
    v_and_b32 v37, s16, v102
    v_lshlrev_b32 v38, 16, v103
    v_and_b32 v39, s16, v103
    v_lshlrev_b32 v40, 16, v148
    v_and_b32 v41, s16, v148
    v_lshlrev_b32 v42, 16, v149
    v_and_b32 v43, s16, v149
    v_lshlrev_b32 v44, 16, v150
    v_and_b32 v45, s16, v150
    v_lshlrev_b32 v46, 16, v151
    v_and_b32 v47, s16, v151
    v_pk_add_f32 v[16:17], v[16:17], v[40:41]
    v_pk_add_f32 v[18:19], v[18:19], v[42:43]
    v_pk_add_f32 v[20:21], v[20:21], v[44:45]
    v_pk_add_f32 v[22:23], v[22:23], v[46:47]
    v_lshlrev_b32 v40, 16, v152
    v_and_b32 v41, s16, v152
    v_lshlrev_b32 v42, 16, v153
    v_and_b32 v43, s16, v153
    v_lshlrev_b32 v44, 16, v154
    v_and_b32 v45, s16, v154
    v_lshlrev_b32 v46, 16, v155
    v_and_b32 v47, s16, v155
    v_pk_add_f32 v[24:25], v[24:25], v[40:41]
    v_pk_add_f32 v[26:27], v[26:27], v[42:43]
    v_pk_add_f32 v[28:29], v[28:29], v[44:45]
    v_pk_add_f32 v[30:31], v[30:31], v[46:47]
    v_lshlrev_b32 v40, 16, v156
    v_and_b32 v41, s16, v156
    v_lshlrev_b32 v42, 16, v157
    v_and_b32 v43, s16, v157
    v_lshlrev_b32 v44, 16, v158
    v_and_b32 v45, s16, v158
    v_lshlrev_b32 v46, 16, v159
    v_and_b32 v47, s16, v159
    v_pk_add_f32 v[32:33], v[32:33], v[40:41]
    v_pk_add_f32 v[34:35], v[34:35], v[42:43]
    v_pk_add_f32 v[36:37], v[36:37], v[44:45]
    v_pk_add_f32 v[38:39], v[38:39], v[46:47]
    v_pk_add_f32 v[16:17], v[16:17], v[10:11] op_sel_hi:[1,0]
    v_pk_add_f32 v[18:19], v[18:19], v[10:11] op_sel_hi:[1,0]
    v_pk_add_f32 v[20:21], v[20:21], v[10:11] op_sel_hi:[1,0]
    v_pk_add_f32 v[22:23], v[22:23], v[10:11] op_sel_hi:[1,0]
    v_pk_add_f32 v[24:25], v[24:25], v[10:11] op_sel:[0,1] op_sel_hi:[1,1]
    v_pk_add_f32 v[26:27], v[26:27], v[10:11] op_sel:[0,1] op_sel_hi:[1,1]
    v_pk_add_f32 v[28:29], v[28:29], v[10:11] op_sel:[0,1] op_sel_hi:[1,1]
    v_pk_add_f32 v[30:31], v[30:31], v[10:11] op_sel:[0,1] op_sel_hi:[1,1]
    v_pk_add_f32 v[32:33], v[32:33], v[10:11] op_sel_hi:[1,0]
    v_pk_add_f32 v[34:35], v[34:35], v[10:11] op_sel_hi:[1,0]
    v_pk_add_f32 v[36:37], v[36:37], v[10:11] op_sel_hi:[1,0]
    v_pk_add_f32 v[38:39], v[38:39], v[10:11] op_sel_hi:[1,0]
    s_waitcnt vmcnt(6)
    s_add_u32 s28, s28, 4096
    buffer_load_dwordx4 a[64:67], v3, s[8:11], s28 offen offset:0 sc1
    v_lshlrev_b32 v40, 16, v60
    v_and_b32 v41, s16, v60
    v_lshlrev_b32 v42, 16, v61
    v_and_b32 v43, s16, v61
    v_lshlrev_b32 v44, 16, v62
    v_and_b32 v45, s16, v62
    v_lshlrev_b32 v46, 16, v63
    v_and_b32 v47, s16, v63
    v_pk_add_f32 v[32:33], v[32:33], v[40:41]
    v_pk_add_f32 v[34:35], v[34:35], v[42:43]
    v_pk_add_f32 v[36:37], v[36:37], v[44:45]
    v_pk_add_f32 v[38:39], v[38:39], v[46:47]
    s_waitcnt vmcnt(6)
    buffer_load_dwordx4 a[68:71], v3, s[8:11], s28 offen offset:1024 sc1
    v_lshlrev_b32 v40, 16, v64
    v_and_b32 v41, s16, v64
    v_lshlrev_b32 v42, 16, v65
    v_and_b32 v43, s16, v65
    v_lshlrev_b32 v44, 16, v66
    v_and_b32 v45, s16, v66
    v_lshlrev_b32 v46, 16, v67
    v_and_b32 v47, s16, v67
    v_pk_add_f32 v[32:33], v[32:33], v[40:41]
    v_pk_add_f32 v[34:35], v[34:35], v[42:43]
    v_pk_add_f32 v[36:37], v[36:37], v[44:45]
    v_pk_add_f32 v[38:39], v[38:39], v[46:47]
    s_waitcnt vmcnt(6)
    buffer_load_dwordx4 a[72:75], v3, s[8:11], s28 offen offset:2048 sc1
    v_lshlrev_b32 v40, 16, v68
    v_and_b32 v41, s16, v68
    v_lshlrev_b32 v42, 16, v69
    v_and_b32 v43, s16, v69
    v_lshlrev_b32 v44, 16, v70
    v_and_b32 v45, s16, v70
    v_lshlrev_b32 v46, 16, v71
    v_and_b32 v47, s16, v71
    v_pk_add_f32 v[32:33], v[32:33], v[40:41]
    v_pk_add_f32 v[34:35], v[34:35], v[42:43]
    v_pk_add_f32 v[36:37], v[36:37], v[44:45]
    v_pk_add_f32 v[38:39], v[38:39], v[46:47]
    s_waitcnt vmcnt(6)
    buffer_load_dwordx4 a[76:79], v229, s[8:11], s28 offen offset:3072 sc1
    v_lshlrev_b32 v40, 16, v72
    v_and_b32 v41, s16, v72
    v_lshlrev_b32 v42, 16, v73
    v_and_b32 v43, s16, v73
    v_lshlrev_b32 v44, 16, v74
    v_and_b32 v45, s16, v74
    v_lshlrev_b32 v46, 16, v75
    v_and_b32 v47, s16, v75
    v_pk_add_f32 v[32:33], v[32:33], v[40:41]
    v_pk_add_f32 v[34:35], v[34:35], v[42:43]
    v_pk_add_f32 v[36:37], v[36:37], v[44:45]
    v_pk_add_f32 v[38:39], v[38:39], v[46:47]
    s_waitcnt vmcnt(6)
    s_add_u32 s28, s28, 4096
    buffer_load_dwordx4 a[80:83], v3, s[8:11], s28 offen offset:0 sc1
    v_lshlrev_b32 v40, 16, v76
    v_and_b32 v41, s16, v76
    v_lshlrev_b32 v42, 16, v77
    v_and_b32 v43, s16, v77
    v_lshlrev_b32 v44, 16, v78
    v_and_b32 v45, s16, v78
    v_lshlrev_b32 v46, 16, v79
    v_and_b32 v47, s16, v79
    v_pk_add_f32 v[32:33], v[32:33], v[40:41]
    v_pk_add_f32 v[34:35], v[34:35], v[42:43]
    v_pk_add_f32 v[36:37], v[36:37], v[44:45]
    v_pk_add_f32 v[38:39], v[38:39], v[46:47]
    s_waitcnt vmcnt(6)
    buffer_load_dwordx4 a[84:87], v3, s[8:11], s28 offen offset:1024 sc1
    v_lshlrev_b32 v40, 16, v80
    v_and_b32 v41, s16, v80
    v_lshlrev_b32 v42, 16, v81
    v_and_b32 v43, s16, v81
    v_lshlrev_b32 v44, 16, v82
    v_and_b32 v45, s16, v82
    v_lshlrev_b32 v46, 16, v83
    v_and_b32 v47, s16, v83
    v_pk_add_f32 v[32:33], v[32:33], v[40:41]
    v_pk_add_f32 v[34:35], v[34:35], v[42:43]
    v_pk_add_f32 v[36:37], v[36:37], v[44:45]
    v_pk_add_f32 v[38:39], v[38:39], v[46:47]
    s_waitcnt vmcnt(6)
    buffer_load_dwordx4 a[88:91], v3, s[8:11], s28 offen offset:2048 sc1
    v_lshlrev_b32 v40, 16, v84
    v_and_b32 v41, s16, v84
    v_lshlrev_b32 v42, 16, v85
    v_and_b32 v43, s16, v85
    v_lshlrev_b32 v44, 16, v86
    v_and_b32 v45, s16, v86
    v_lshlrev_b32 v46, 16, v87
    v_and_b32 v47, s16, v87
    v_pk_add_f32 v[32:33], v[32:33], v[40:41]
    v_pk_add_f32 v[34:35], v[34:35], v[42:43]
    v_pk_add_f32 v[36:37], v[36:37], v[44:45]
    v_pk_add_f32 v[38:39], v[38:39], v[46:47]
    buffer_load_dwordx4 a[92:95], v229, s[8:11], s28 offen offset:3072 sc1
    v_cvt_pk_bf16_f32 v120, v16, v17
    v_cvt_pk_bf16_f32 v121, v18, v19
    v_cvt_pk_bf16_f32 v122, v20, v21
    v_cvt_pk_bf16_f32 v123, v22, v23
    v_cvt_pk_bf16_f32 v124, v24, v25
    v_cvt_pk_bf16_f32 v125, v26, v27
    v_cvt_pk_bf16_f32 v126, v28, v29
    v_cvt_pk_bf16_f32 v127, v30, v31
    v_cvt_pk_bf16_f32 v128, v32, v33
    v_cvt_pk_bf16_f32 v129, v34, v35
    v_cvt_pk_bf16_f32 v130, v36, v37
    v_cvt_pk_bf16_f32 v131, v38, v39
    s_cmp_lg_u32 s42, 0
    s_cbranch_scc1 L_main_last
    s_add_u32 s19, s18, 43515904
    s_add_u32 s20, s18, 38797312
    s_lshl_b32 s22, s21, 7
    s_add_u32 s22, s22, 48234496
    buffer_store_dwordx4 v[120:123], v172, s[8:11], s19 offen sc1
    buffer_store_dwordx4 v[124:127], v173, s[8:11], s19 offen sc1
    buffer_store_dwordx4 v[128:131], v174, s[8:11], s19 offen sc1
    s_mov_b32 s17, 0x3f803f80
    v_mov_b32 v8, 0
    v_mov_b32 v9, 0
    v_mov_b32 v10, 0
    v_mov_b32 v11, 0
    v_dot2c_f32_bf16 v8, s17, v120
    v_dot2c_f32_bf16 v9, v120, v120
    v_dot2c_f32_bf16 v10, s17, v121
    v_dot2c_f32_bf16 v11, v121, v121
    v_dot2c_f32_bf16 v8, s17, v122
    v_dot2c_f32_bf16 v9, v122, v122
    v_dot2c_f32_bf16 v10, s17, v123
    v_dot2c_f32_bf16 v11, v123, v123
    v_dot2c_f32_bf16 v8, s17, v124
    v_dot2c_f32_bf16 v9, v124, v124
    v_dot2c_f32_bf16 v10, s17, v125
    v_dot2c_f32_bf16 v11, v125, v125
    v_dot2c_f32_bf16 v8, s17, v126
    v_dot2c_f32_bf16 v9, v126, v126
    v_dot2c_f32_bf16 v10, s17, v127
    v_dot2c_f32_bf16 v11, v127, v127
    v_dot2c_f32_bf16 v8, s17, v128
    v_dot2c_f32_bf16 v9, v128, v128
    v_dot2c_f32_bf16 v10, s17, v129
    v_dot2c_f32_bf16 v11, v129, v129
    v_dot2c_f32_bf16 v8, s17, v130
    v_dot2c_f32_bf16 v9, v130, v130
    v_dot2c_f32_bf16 v10, s17, v131
    v_dot2c_f32_bf16 v11, v131, v131
    v_and_b32 v12, 7, v0
    v_lshlrev_b32 v12, 3, v12
    s_lshl_b32 s7, s3, 6
    v_add_u32 v13, s7, v12
    v_pk_add_f32 v[8:9], v[8:9], v[10:11]
    s_nop 1
    v_add_f32_dpp v8, v8, v8 row_ror:8 row_mask:0xf bank_mask:0xf
    v_add_f32_dpp v9, v9, v9 row_ror:8 row_mask:0xf bank_mask:0xf
    v_mov_b32 v10, v8
    v_mov_b32 v11, v9
    s_nop 1
    v_permlane32_swap_b32 v10, v8
    v_permlane32_swap_b32 v11, v9
    v_add_f32 v8, v8, v10
    v_add_f32 v9, v9, v11
    v_mov_b32 v10, v8
    v_mov_b32 v11, v9
    s_nop 1
    v_permlane16_swap_b32 v10, v8
    v_permlane16_swap_b32 v11, v9
    v_add_f32 v8, v8, v10
    v_add_f32 v9, v9, v11
    ds_write_b64 v13, v[8:9]
    s_waitcnt lgkmcnt(0)
    s_barrier
    ds_read_b64 v[40:41], v12 offset:0
    ds_read_b64 v[42:43], v12 offset:64
    ds_read_b64 v[44:45], v12 offset:128
    ds_read_b64 v[46:47], v12 offset:192
    s_waitcnt lgkmcnt(0)
    v_pk_add_f32 v[40:41], v[40:41], v[42:43]
    v_pk_add_f32 v[44:45], v[44:45], v[46:47]
    v_pk_add_f32 v[8:9], v[40:41], v[44:45]
    v_mul_f32 v8, 0x3ae38e39, v8
    v_mul_f32 v9, 0x3ae38e39, v9
    v_fma_f32 v9, -v8, v8, v9
    v_max_f32 v9, 0, v9
    v_add_f32 v9, 0x3727c5ac, v9
    v_rsq_f32 v10, v9
    s_nop 0
    v_mul_f32 v12, v8, v10
    v_mov_b32 v11, v10
    v_sub_f32 v12, 0, v12
    v_mov_b32 v13, v12
    s_cmp_eq_u32 s3, 0
    s_cselect_b32 s7, 32, 0
    v_lshlrev_b32 v14, 2, v0
    v_cmp_gt_u32 vcc, s7, v0
    v_mov_b32 v9, 1073741824
    s_nop 0
    v_cndmask_b32 v14, v9, v14, vcc
    buffer_store_dword v8, v14, s[8:11], s22 offen sc1
    v_lshlrev_b32 v40, 16, v120
    v_and_b32 v41, s16, v120
    v_lshlrev_b32 v42, 16, v121
    v_and_b32 v43, s16, v121
    v_lshlrev_b32 v44, 16, v122
    v_and_b32 v45, s16, v122
    v_lshlrev_b32 v46, 16, v123
    v_and_b32 v47, s16, v123
    v_pk_fma_f32 v[40:41], v[40:41], v[10:11], v[12:13]
    v_pk_fma_f32 v[42:43], v[42:43], v[10:11], v[12:13]
    v_pk_fma_f32 v[44:45], v[44:45], v[10:11], v[12:13]
    v_pk_fma_f32 v[46:47], v[46:47], v[10:11], v[12:13]
    v_cvt_pk_bf16_f32 v48, v40, v41
    v_cvt_pk_bf16_f32 v49, v42, v43
    v_cvt_pk_bf16_f32 v50, v44, v45
    v_cvt_pk_bf16_f32 v51, v46, v47
    v_lshlrev_b32 v40, 16, v124
    v_and_b32 v41, s16, v124
    v_lshlrev_b32 v42, 16, v125
    v_and_b32 v43, s16, v125
    v_lshlrev_b32 v44, 16, v126
    v_and_b32 v45, s16, v126
    v_lshlrev_b32 v46, 16, v127
    v_and_b32 v47, s16, v127
    v_pk_fma_f32 v[40:41], v[40:41], v[10:11], v[12:13]
    v_pk_fma_f32 v[42:43], v[42:43], v[10:11], v[12:13]
    v_pk_fma_f32 v[44:45], v[44:45], v[10:11], v[12:13]
    v_pk_fma_f32 v[46:47], v[46:47], v[10:11], v[12:13]
    v_cvt_pk_bf16_f32 v52, v40, v41
    v_cvt_pk_bf16_f32 v53, v42, v43
    v_cvt_pk_bf16_f32 v54, v44, v45
    v_cvt_pk_bf16_f32 v55, v46, v47
    v_lshlrev_b32 v40, 16, v128
    v_and_b32 v41, s16, v128
    v_lshlrev_b32 v42, 16, v129
    v_and_b32 v43, s16, v129
    v_lshlrev_b32 v44, 16, v130
    v_and_b32 v45, s16, v130
    v_lshlrev_b32 v46, 16, v131
    v_and_b32 v47, s16, v131
    v_pk_fma_f32 v[40:41], v[40:41], v[10:11], v[12:13]
    v_pk_fma_f32 v[42:43], v[42:43], v[10:11], v[12:13]
    v_pk_fma_f32 v[44:45], v[44:45], v[10:11], v[12:13]
    v_pk_fma_f32 v[46:47], v[46:47], v[10:11], v[12:13]
    v_cvt_pk_bf16_f32 v56, v40, v41
    v_cvt_pk_bf16_f32 v57, v42, v43
    v_cvt_pk_bf16_f32 v58, v44, v45
    v_cvt_pk_bf16_f32 v59, v46, v47
    buffer_store_dwordx4 v[48:51], v172, s[8:11], s20 offen sc1
    buffer_store_dwordx4 v[52:55], v173, s[8:11], s20 offen sc1
    buffer_store_dwordx4 v[56:59], v174, s[8:11], s20 offen sc1
    v_lshlrev_b32 v15, 7, v0
    s_lshl_b32 s6, s40, 2
    s_add_u32 s6, s6, s44
    s_add_u32 s6, s6, 98304
    v_mov_b32 v1, s76
    s_mov_b64 vcc, 0xff
    v_lshrrev_b32 v14, 3, v0
    v_lshl_add_u32 v15, v14, 3, v15
    s_cmp_ge_u32 s40, 6
    s_cselect_b32 s7, s41, 31
    s_cmp_lt_u32 s7, 31
    s_cmov_b64 vcc, 0xffff
    s_waitcnt vmcnt(0)
    s_barrier
    s_cmp_lg_u32 s3, 0
    s_cbranch_scc1 L_pub_46
    s_mov_b64 exec, vcc
    buffer_store_dword v1, v15, s[8:11], s6 offen sc1
L_pub_46:
    s_mov_b64 exec, -1
    s_add_u32 s28, s28, 4096
    buffer_load_dwordx4 a[96:99], v3, s[8:11], s28 offen offset:0 sc1
    buffer_load_dwordx4 a[100:103], v3, s[8:11], s28 offen offset:1024 sc1
    buffer_load_dwordx4 a[104:107], v3, s[8:11], s28 offen offset:2048 sc1
    buffer_load_dwordx4 a[108:111], v229, s[8:11], s28 offen offset:3072 sc1
    s_add_u32 s28, s28, 4096
    buffer_load_dwordx4 a[112:115], v3, s[8:11], s28 offen offset:0 sc1
    buffer_load_dwordx4 a[116:119], v3, s[8:11], s28 offen offset:1024 sc1
    buffer_load_dwordx4 a[120:123], v3, s[8:11], s28 offen offset:2048 sc1
    buffer_load_dwordx4 a[124:127], v229, s[8:11], s28 offen offset:3072 sc1
    s_add_u32 s28, s28, 4096
    buffer_load_dwordx4 a[128:131], v3, s[8:11], s28 offen offset:0 sc1
    buffer_load_dwordx4 a[132:135], v3, s[8:11], s28 offen offset:1024 sc1
    buffer_load_dwordx4 a[136:139], v3, s[8:11], s28 offen offset:2048 sc1
    buffer_load_dwordx4 a[140:143], v229, s[8:11], s28 offen offset:3072 sc1
    s_add_u32 s28, s28, 4096
    s_mov_b32 s42, 1
    s_mov_b32 s43, 0
    s_add_u32 s44, s44, 131072
    s_mov_b32 s74, 0
    s_branch L_main_layer
L_main_last:
    buffer_store_dwordx4 v[120:123], v175, s[12:15], s18 offen sc0 sc1
    buffer_store_dwordx4 v[124:127], v176, s[12:15], s18 offen sc0 sc1
    buffer_store_dwordx4 v[128:131], v177, s[12:15], s18 offen sc0 sc1
    s_or_b32 s7, s40, s41
    s_or_b32 s7, s7, s3
    s_cbranch_scc1 L_done_47
    v_mov_b32 v1, s76
    s_mov_b32 s7, 19660800
    s_mov_b64 exec, 1
    buffer_store_dword v1, off, s[8:11], s7 sc1
    s_mov_b64 exec, -1
L_done_47:
L_main_end:
    s_endpgm
L_main_code_end:
.section .rodata,"a"
.p2align 6
.amdhsa_kernel interleave_layers__sliding_local_dilated__glu_gated_geglu__prompt_kernel
.amdhsa_next_free_vgpr 512
.amdhsa_next_free_sgpr 102
.amdhsa_accum_offset 256
.amdhsa_group_segment_fixed_size 0
.amdhsa_kernarg_size 80
.amdhsa_user_sgpr_count 2
.amdhsa_user_sgpr_kernarg_segment_ptr 1
.amdhsa_system_sgpr_workgroup_id_x 1
.amdhsa_float_denorm_mode_32 3
.amdhsa_float_denorm_mode_16_64 3
.end_amdhsa_kernel
```

```asm
; @launch grid=(256,1,1) block=(256,1,1) lds=163840
.amdgcn_target "amdgcn-amd-amdhsa--gfx950"
.text
.globl interleave_layers__sliding_local_dilated__glu_gated_geglu__prompt_kernel
.p2align 8
.type interleave_layers__sliding_local_dilated__glu_gated_geglu__prompt_kernel,@function
interleave_layers__sliding_local_dilated__glu_gated_geglu__prompt_kernel:
    s_cmp_ge_u32 s2, 256
    s_cbranch_scc1 L_main_end
    s_load_dwordx2 s[4:5], s[0:1], 72
    s_load_dwordx4 s[16:19], s[0:1], 0
    s_load_dwordx2 s[22:23], s[0:1], 16
    s_load_dwordx8 s[24:31], s[0:1], 32
    s_getpc_b64 s[96:97]
L_main_pc:
    s_sub_u32 s96, s96, L_main_pc-interleave_layers__sliding_local_dilated__glu_gated_geglu__prompt_kernel
    s_subb_u32 s97, s97, 0
    s_and_b32 s97, s97, 0xffff
    s_mov_b32 s98, L_main_code_end-interleave_layers__sliding_local_dilated__glu_gated_geglu__prompt_kernel
    s_mov_b32 s99, 0x20000
    s_lshr_b32 s7, s2, 3
    s_lshl_b32 s7, s7, 11
    v_lshl_add_u32 v253, v0, 3, s7
    buffer_load_dwordx2 v[2:3], v253, s[96:99], 0 offen
    v_lshrrev_b32 v1, 6, v0
    v_and_b32 v0, 63, v0
    v_readfirstlane_b32 s3, v1
    s_waitcnt lgkmcnt(0)
    s_mov_b32 s8, s4
    s_and_b32 s9, s5, 0xffff
    s_mov_b32 s10, 268435456
    s_mov_b32 s11, 0x20000
    s_mov_b32 s7, 19660800
    s_load_dword s76, s[4:5], s7
    s_mov_b64 s[20:21], s[18:19]
    s_mov_b64 s[18:19], s[16:17]
    s_mov_b32 s48, s4
    s_and_b32 s49, s5, 0xffff
    s_mov_b32 s50, 268435456
    s_mov_b32 s51, 0x20000
    s_and_b32 s40, s2, 3
    s_lshl_b32 s40, s40, 1
    s_bfe_u32 s7, s2, 65539
    s_add_u32 s40, s40, s7
    s_bfe_u32 s41, s2, 65538
    s_lshl_b32 s41, s41, 4
    s_lshr_b32 s7, s2, 4
    s_add_u32 s41, s41, s7
    s_mov_b32 s42, 0
    s_mov_b32 s43, 0
    s_lshl_b32 s44, s41, 10
    s_add_u32 s44, s44, 19169280
    v_lshlrev_b32 v253, 4, v0
    s_mov_b32 s12, s18
    s_and_b32 s13, s19, 0xffff
    s_mov_b32 s14, 2359296
    s_mov_b32 s15, 0x20000
    s_mov_b32 s64, s20
    s_and_b32 s65, s21, 0xffff
    s_mov_b32 s66, 1990656
    s_mov_b32 s67, 0x20000
    s_mov_b32 s68, s22
    s_and_b32 s69, s23, 0xffff
    s_mov_b32 s70, 663552
    s_mov_b32 s71, 0x20000
    s_mov_b32 s16, 0xffff0000
    s_lshl_b32 s7, s3, 10
    v_add_u32 v172, s7, v253
    v_add_u32 v174, 5120, v172
    v_and_b32 v178, 7, v0
    v_mul_u32_u24 v178, 1152, v178
    v_lshrrev_b32 v179, 3, v0
    v_lshl_add_u32 v178, v179, 4, v178
    s_lshl_b32 s7, s3, 7
    v_add_u32 v175, s7, v178
    v_add_u32 v177, 640, v175
    s_cmp_eq_u32 s3, 0
    s_mov_b32 s17, 1073741824
    s_cmov_b32 s17, 4096
    v_add_u32 v173, s17, v172
    s_mov_b32 s17, 1073741824
    s_cmov_b32 s17, 512
    v_add_u32 v176, s17, v175
    s_lshl_b32 s21, s41, 3
    s_add_u32 s21, s21, s40
    s_mul_i32 s18, s21, 9216
    buffer_load_dwordx4 v[16:19], v175, s[12:15], s18 offen nt
    buffer_load_dwordx4 v[20:23], v176, s[12:15], s18 offen nt
    buffer_load_dwordx4 v[24:27], v177, s[12:15], s18 offen nt
    s_mov_b32 s12, s30
    s_and_b32 s13, s31, 0xffff
    s_mov_b32 s14, 2359296
    s_mov_b32 s15, 0x20000
    s_lshl_b32 s79, s3, 14
    s_add_u32 s79, s79, 98304
    s_and_b32 s32, s41, 15
    s_lshl_b32 s32, s32, 1
    s_lshr_b32 s7, s41, 4
    s_add_u32 s32, s32, s7
    s_lshl_b32 s36, s32, 3
    s_add_u32 s36, s36, s40
    s_sub_u32 s36, s36, 144
    s_cmp_ge_u32 s32, 18
    s_cbranch_scc1 L_prep_o_1
    s_mul_i32 s35, s32, 110592
    s_mul_i32 s7, s40, 144
    s_and_b32 s46, s7, 127
    s_sub_u32 s7, s7, s46
    s_add_u32 s35, s35, s7
    s_mul_i32 s7, s3, 13824
    s_add_u32 s35, s35, s7
    v_lshrrev_b32 v8, 4, v0
    v_mul_u32_u24 v8, 3456, v8
    v_and_b32 v9, 15, v0
    v_lshl_add_u32 v8, v9, 4, v8
    s_lshl_b32 s34, s3, 10
    s_add_u32 m0, s34, 8192
    s_add_u32 s7, s35, 0
    buffer_load_dwordx4 v8, s[64:67], s7 offen nt lds
    s_add_u32 m0, s34, 12288
    s_add_u32 s7, s35, 55296
    buffer_load_dwordx4 v8, s[64:67], s7 offen nt lds
    s_add_u32 m0, s34, 16384
    s_add_u32 s7, s35, 1152
    buffer_load_dwordx4 v8, s[64:67], s7 offen nt lds
    s_add_u32 m0, s34, 20480
    s_add_u32 s7, s35, 56448
    buffer_load_dwordx4 v8, s[64:67], s7 offen nt lds
    s_add_u32 m0, s34, 24576
    s_add_u32 s7, s35, 2304
    buffer_load_dwordx4 v8, s[64:67], s7 offen nt lds
    s_add_u32 m0, s34, 28672
    s_add_u32 s7, s35, 57600
    buffer_load_dwordx4 v8, s[64:67], s7 offen nt lds
    s_branch L_prep_go_3
L_prep_o_1:
    s_cmp_ge_u32 s36, 54
    s_cbranch_scc1 L_prep_m_2
    s_mul_i32 s33, s36, 349526
    s_lshr_b32 s33, s33, 20
    s_mul_i32 s34, s33, 3
    s_sub_u32 s34, s36, s34
    s_lshl_b32 s7, s33, 2
    s_add_u32 s7, s7, s3
    v_mov_b32 v8, s7
    v_lshrrev_b32 v9, 3, v0
    v_mul_u32_u24 v11, 7282, v8
    v_lshrrev_b32 v11, 16, v11
    v_mul_u32_u24 v12, 9, v11
    v_sub_u32 v12, v8, v12
    v_mul_u32_u24 v11, 72, v11
    v_cmp_eq_u32 vcc, 8, v12
    v_lshrrev_b32 v10, 1, v12
    v_mad_u32_u24 v10, v10, 18, v11
    v_and_b32 v12, 1, v12
    v_lshl_add_u32 v10, v12, 3, v10
    v_add_u32 v10, v10, v9
    v_lshrrev_b32 v12, 1, v9
    v_mad_u32_u24 v11, v12, 18, v11
    v_and_b32 v12, 1, v9
    v_add3_u32 v11, v11, v12, 16
    v_cndmask_b32 v10, v10, v11, vcc
    v_mul_u32_u24 v10, 1152, v10
    v_and_b32 v9, 7, v0
    v_lshl_add_u32 v10, v9, 4, v10
    s_mul_i32 s35, s34, 384
    s_lshl_b32 s6, s3, 10
    s_add_u32 m0, s6, 8192
    s_add_u32 s7, s35, 0
    buffer_load_dwordx4 v10, s[68:71], s7 offen nt lds
    s_add_u32 m0, s6, 12288
    s_add_u32 s7, s35, 128
    buffer_load_dwordx4 v10, s[68:71], s7 offen nt lds
    s_add_u32 m0, s6, 16384
    s_add_u32 s7, s35, 256
    buffer_load_dwordx4 v10, s[68:71], s7 offen nt lds
    s_branch L_prep_go_3
L_prep_m_2:
    s_sub_u32 s37, s36, 54
    s_lshl_b32 s7, s3, 6
    s_add_u32 s37, s37, s7
    s_cmp_ge_u32 s37, 36
    s_cbranch_scc1 L_prep_go_3
    s_lshl_b32 s7, s37, 1
    v_bfe_u32 v8, v0, 3, 1
    v_add_u32 v8, s7, v8
    v_and_b32 v9, 7, v0
    v_mul_u32_u24 v11, 7282, v8
    v_lshrrev_b32 v11, 16, v11
    v_mul_u32_u24 v12, 9, v11
    v_sub_u32 v12, v8, v12
    v_mul_u32_u24 v11, 72, v11
    v_cmp_eq_u32 vcc, 8, v12
    v_lshrrev_b32 v10, 1, v12
    v_mad_u32_u24 v10, v10, 18, v11
    v_and_b32 v12, 1, v12
    v_lshl_add_u32 v10, v12, 3, v10
    v_add_u32 v10, v10, v9
    v_lshrrev_b32 v12, 1, v9
    v_mad_u32_u24 v11, v12, 18, v11
    v_and_b32 v12, 1, v9
    v_add3_u32 v11, v11, v12, 16
    v_cndmask_b32 v10, v10, v11, vcc
    v_mul_u32_u24 v10, 1152, v10
    v_lshrrev_b32 v9, 4, v0
    v_lshl_add_u32 v10, v9, 4, v10
    buffer_load_dwordx4 v[64:67], v10, s[68:71], 0 offen offset:0
    buffer_load_dwordx4 v[68:71], v10, s[68:71], 0 offen offset:64
    buffer_load_dwordx4 v[72:75], v10, s[68:71], 0 offen offset:128
    buffer_load_dwordx4 v[76:79], v10, s[68:71], 0 offen offset:192
    buffer_load_dwordx4 v[80:83], v10, s[68:71], 0 offen offset:256
    buffer_load_dwordx4 v[84:87], v10, s[68:71], 0 offen offset:320
    buffer_load_dwordx4 v[88:91], v10, s[68:71], 0 offen offset:384
    buffer_load_dwordx4 v[92:95], v10, s[68:71], 0 offen offset:448
    buffer_load_dwordx4 v[96:99], v10, s[68:71], 0 offen offset:512
    buffer_load_dwordx4 v[100:103], v10, s[68:71], 0 offen offset:576
    buffer_load_dwordx4 v[104:107], v10, s[68:71], 0 offen offset:640
    buffer_load_dwordx4 v[108:111], v10, s[68:71], 0 offen offset:704
    buffer_load_dwordx4 v[112:115], v10, s[68:71], 0 offen offset:768
    buffer_load_dwordx4 v[116:119], v10, s[68:71], 0 offen offset:832
    buffer_load_dwordx4 v[120:123], v10, s[68:71], 0 offen offset:896
    buffer_load_dwordx4 v[124:127], v10, s[68:71], 0 offen offset:960
    buffer_load_dwordx4 v[128:131], v10, s[68:71], 0 offen offset:1024
    buffer_load_dwordx4 v[132:135], v10, s[68:71], 0 offen offset:1088
L_prep_go_3:
    s_lshl_b32 s7, s41, 2
    s_add_u32 s7, s7, s3
    s_mul_i32 s93, s7, 25576
    s_lshr_b32 s93, s93, 20
    s_min_u32 s93, s93, 2
    s_mul_i32 s6, s93, 41
    s_sub_u32 s7, s7, s6
    s_lshl_b32 s17, s7, 2
    s_cmp_eq_u32 s93, 1
    s_cselect_b32 s72, s26, s24
    s_cselect_b32 s73, s27, s25
    s_cmp_eq_u32 s93, 2
    s_cselect_b32 s72, s28, s72
    s_cselect_b32 s73, s29, s73
    s_mov_b32 s92, 73728
    s_cmov_b32 s92, 9216
    s_mov_b32 s47, 1152
    s_cmov_b32 s47, 663552
    s_and_b32 s73, s73, 0xffff
    s_mov_b32 s74, 5308416
    s_mov_b32 s75, 0x20000
    s_mul_i32 s47, s47, s40
    s_add_u32 s7, s17, 0
    s_min_u32 s7, s7, 161
    s_mul_i32 s84, s7, 116509
    s_lshr_b32 s84, s84, 20
    s_mul_i32 s88, s84, 9
    s_sub_u32 s88, s7, s88
    s_mul_i32 s7, s84, s92
    s_lshl_b32 s7, s7, 2
    s_add_u32 s7, s7, s47
    s_lshl_b32 s6, s88, 7
    s_add_u32 s80, s7, s6
    s_add_u32 s7, s17, 1
    s_min_u32 s7, s7, 161
    s_mul_i32 s85, s7, 116509
    s_lshr_b32 s85, s85, 20
    s_mul_i32 s89, s85, 9
    s_sub_u32 s89, s7, s89
    s_mul_i32 s7, s85, s92
    s_lshl_b32 s7, s7, 2
    s_add_u32 s7, s7, s47
    s_lshl_b32 s6, s89, 7
    s_add_u32 s81, s7, s6
    s_add_u32 s7, s17, 2
    s_min_u32 s7, s7, 161
    s_mul_i32 s86, s7, 116509
    s_lshr_b32 s86, s86, 20
    s_mul_i32 s90, s86, 9
    s_sub_u32 s90, s7, s90
    s_mul_i32 s7, s86, s92
    s_lshl_b32 s7, s7, 2
    s_add_u32 s7, s7, s47
    s_lshl_b32 s6, s90, 7
    s_add_u32 s82, s7, s6
    s_add_u32 s7, s17, 3
    s_min_u32 s7, s7, 161
    s_mul_i32 s87, s7, 116509
    s_lshr_b32 s87, s87, 20
    s_mul_i32 s91, s87, 9
    s_sub_u32 s91, s7, s91
    s_mul_i32 s7, s87, s92
    s_lshl_b32 s7, s7, 2
    s_add_u32 s7, s7, s47
    s_lshl_b32 s6, s91, 7
    s_add_u32 s83, s7, s6
    s_lshr_b32 s7, s92, 3
    v_lshrrev_b32 v224, 3, v0
    v_mul_lo_u32 v224, v224, s7
    v_and_b32 v8, 7, v0
    v_lshl_add_u32 v224, v8, 4, v224
    s_waitcnt lgkmcnt(0)
    s_mul_i32 s76, s76, 0x9e3779b1
    s_add_u32 s76, s76, 0x7f4a7c15
    s_mov_b32 s77, s76
    s_add_u32 m0, s79, 0
    s_mov_b32 s71, s80
    buffer_load_dwordx4 v224, s[72:75], s71 offen nt lds
    s_add_u32 m0, s79, 1024
    s_add_u32 s71, s71, s92
    buffer_load_dwordx4 v224, s[72:75], s71 offen nt lds
    s_add_u32 m0, s79, 2048
    s_add_u32 s71, s71, s92
    buffer_load_dwordx4 v224, s[72:75], s71 offen nt lds
    s_add_u32 m0, s79, 3072
    s_add_u32 s71, s71, s92
    buffer_load_dwordx4 v224, s[72:75], s71 offen nt lds
    s_waitcnt vmcnt(4)
    s_barrier
    s_cmp_ge_u32 s32, 18
    s_cbranch_scc1 L_prep_o_4
    s_mul_i32 s7, s3, 36
    s_add_u32 s7, s7, s46
    v_lshrrev_b32 v8, 4, v0
    v_lshlrev_b32 v8, 11, v8
    v_add_u32 v8, s7, v8
    v_and_b32 v9, 15, v0
    v_cmp_gt_u32 s[22:23], 6, v9
    v_lshrrev_b32 v10, 1, v9
    v_min_u32 v10, 2, v10
    v_lshl_add_u32 v10, v10, 13, v8
    v_and_b32 v11, 1, v0
    v_lshl_add_u32 v10, v11, 1, v10
    v_lshl_add_u32 v8, v9, 1, v8
    ds_read_u16 v136, v8 offset:8192
    ds_read_u16 v137, v8 offset:8448
    ds_read_u16 v138, v8 offset:8704
    ds_read_u16 v139, v8 offset:8960
    ds_read_u16 v140, v8 offset:9216
    ds_read_u16 v141, v8 offset:9472
    ds_read_u16 v142, v8 offset:9728
    ds_read_u16 v143, v8 offset:9984
    s_lshl_b32 s33, s40, 2
    s_add_u32 s33, s33, s3
    s_mul_i32 s33, s33, 18
    s_add_u32 s33, s33, s32
    s_lshl_b32 s33, s33, 12
    ds_read_u16 v144, v8 offset:16384
    ds_read_u16 v145, v8 offset:16640
    ds_read_u16 v146, v8 offset:16896
    ds_read_u16 v147, v8 offset:17152
    ds_read_u16 v148, v8 offset:17408
    ds_read_u16 v149, v8 offset:17664
    ds_read_u16 v150, v8 offset:17920
    ds_read_u16 v151, v8 offset:18176
    s_waitcnt lgkmcnt(8)
    v_lshl_or_b32 v32, v137, 16, v136
    v_lshl_or_b32 v33, v139, 16, v138
    v_lshl_or_b32 v34, v141, 16, v140
    v_lshl_or_b32 v35, v143, 16, v142
    buffer_store_dwordx4 v[32:35], v253, s[8:11], s33 offen offset:0 sc1
    ds_read_u16 v152, v8 offset:24576
    ds_read_u16 v153, v8 offset:24832
    ds_read_u16 v154, v8 offset:25088
    ds_read_u16 v155, v8 offset:25344
    ds_read_u16 v156, v8 offset:25600
    ds_read_u16 v157, v8 offset:25856
    ds_read_u16 v158, v8 offset:26112
    ds_read_u16 v159, v8 offset:26368
    s_waitcnt lgkmcnt(8)
    v_lshl_or_b32 v36, v145, 16, v144
    v_lshl_or_b32 v37, v147, 16, v146
    v_lshl_or_b32 v38, v149, 16, v148
    v_lshl_or_b32 v39, v151, 16, v150
    buffer_store_dwordx4 v[36:39], v253, s[8:11], s33 offen offset:1024 sc1
    ds_read_u16 v160, v10 offset:8224
    ds_read_u16 v161, v10 offset:8480
    ds_read_u16 v162, v10 offset:8736
    ds_read_u16 v163, v10 offset:8992
    ds_read_u16 v164, v10 offset:9248
    ds_read_u16 v165, v10 offset:9504
    ds_read_u16 v166, v10 offset:9760
    ds_read_u16 v167, v10 offset:10016
    s_waitcnt lgkmcnt(8)
    v_lshl_or_b32 v40, v153, 16, v152
    v_lshl_or_b32 v41, v155, 16, v154
    v_lshl_or_b32 v42, v157, 16, v156
    v_lshl_or_b32 v43, v159, 16, v158
    buffer_store_dwordx4 v[40:43], v253, s[8:11], s33 offen offset:2048 sc1
    s_waitcnt lgkmcnt(0)
    v_lshl_or_b32 v44, v161, 16, v160
    v_cndmask_b32 v44, 0, v44, s[22:23]
    v_lshl_or_b32 v45, v163, 16, v162
    v_cndmask_b32 v45, 0, v45, s[22:23]
    v_lshl_or_b32 v46, v165, 16, v164
    v_cndmask_b32 v46, 0, v46, s[22:23]
    v_lshl_or_b32 v47, v167, 16, v166
    v_cndmask_b32 v47, 0, v47, s[22:23]
    buffer_store_dwordx4 v[44:47], v253, s[8:11], s33 offen offset:3072 sc1
    s_branch L_prep_done_6
L_prep_o_4:
    s_cmp_ge_u32 s36, 54
    s_cbranch_scc1 L_prep_m_5
    v_lshrrev_b32 v8, 4, v0
    v_lshlrev_b32 v8, 3, v8
    v_bfe_u32 v9, v0, 2, 2
    v_add_u32 v8, v8, v9
    v_mul_u32_u24 v8, 128, v8
    v_and_b32 v9, 3, v0
    v_lshl_add_u32 v8, v9, 3, v8
    s_lshl_b32 s7, s3, 5
    v_add_u32 v8, s7, v8
    ds_read_b64_tr_b16 v[32:33], v8 offset:8192
    ds_read_b64_tr_b16 v[34:35], v8 offset:8704
    ds_read_b64_tr_b16 v[36:37], v8 offset:12288
    ds_read_b64_tr_b16 v[38:39], v8 offset:12800
    ds_read_b64_tr_b16 v[40:41], v8 offset:16384
    ds_read_b64_tr_b16 v[42:43], v8 offset:16896
    s_mul_i32 s34, s34, 12
    s_add_u32 s34, s34, s3
    s_mul_i32 s34, s34, 18
    s_add_u32 s34, s34, s33
    s_lshl_b32 s34, s34, 10
    s_add_u32 s7, s34, 2359296
    s_waitcnt lgkmcnt(4)
    buffer_store_dwordx4 v[32:35], v253, s[8:11], s7 offen sc1
    s_add_u32 s7, s34, 2433024
    s_waitcnt lgkmcnt(2)
    buffer_store_dwordx4 v[36:39], v253, s[8:11], s7 offen sc1
    s_add_u32 s7, s34, 2506752
    s_waitcnt lgkmcnt(0)
    buffer_store_dwordx4 v[40:43], v253, s[8:11], s7 offen sc1
    s_branch L_prep_done_6
L_prep_m_5:
    s_cmp_ge_u32 s37, 36
    s_cbranch_scc1 L_prep_done_6
    v_mov_b32 v28, 0x3f803f80
    v_mov_b32 v29, 0x3f803f80
    v_mov_b32 v30, 0x3f803f80
    v_mov_b32 v31, 0x3f803f80
    v_and_b32 v9, 15, v0
    v_cmp_eq_u32 vcc, 0, v9
    v_cmp_eq_u32 s[22:23], 1, v9
    v_mfma_f32_16x16x32_bf16 v[32:35], v[64:67], v[28:31], 0
    v_mfma_f32_16x16x32_bf16 v[32:35], v[68:71], v[28:31], v[32:35]
    v_mfma_f32_16x16x32_bf16 v[32:35], v[72:75], v[28:31], v[32:35]
    v_mfma_f32_16x16x32_bf16 v[32:35], v[76:79], v[28:31], v[32:35]
    v_mfma_f32_16x16x32_bf16 v[32:35], v[80:83], v[28:31], v[32:35]
    v_mfma_f32_16x16x32_bf16 v[32:35], v[84:87], v[28:31], v[32:35]
    v_mfma_f32_16x16x32_bf16 v[32:35], v[88:91], v[28:31], v[32:35]
    v_mfma_f32_16x16x32_bf16 v[32:35], v[92:95], v[28:31], v[32:35]
    v_mfma_f32_16x16x32_bf16 v[32:35], v[96:99], v[28:31], v[32:35]
    v_mfma_f32_16x16x32_bf16 v[32:35], v[100:103], v[28:31], v[32:35]
    v_mfma_f32_16x16x32_bf16 v[32:35], v[104:107], v[28:31], v[32:35]
    v_mfma_f32_16x16x32_bf16 v[32:35], v[108:111], v[28:31], v[32:35]
    v_mfma_f32_16x16x32_bf16 v[32:35], v[112:115], v[28:31], v[32:35]
    v_mfma_f32_16x16x32_bf16 v[32:35], v[116:119], v[28:31], v[32:35]
    v_mfma_f32_16x16x32_bf16 v[32:35], v[120:123], v[28:31], v[32:35]
    v_mfma_f32_16x16x32_bf16 v[32:35], v[124:127], v[28:31], v[32:35]
    v_mfma_f32_16x16x32_bf16 v[32:35], v[128:131], v[28:31], v[32:35]
    v_mfma_f32_16x16x32_bf16 v[32:35], v[132:135], v[28:31], v[32:35]
    v_lshrrev_b32 v10, 5, v0
    v_lshlrev_b32 v10, 8, v10
    v_lshl_add_u32 v10, v9, 4, v10
    v_bfe_u32 v9, v0, 4, 1
    v_lshl_add_u32 v10, v9, 3, v10
    s_lshl_b32 s7, s37, 9
    s_add_u32 s7, s7, 3022848
    s_nop 0
    v_mul_f32 v32, 0x3ae38e39, v32
    v_mul_f32 v33, 0x3ae38e39, v33
    v_mul_f32 v34, 0x3ae38e39, v34
    v_mul_f32 v35, 0x3ae38e39, v35
    v_cvt_pk_bf16_f32 v36, v32, v33
    v_cvt_pk_bf16_f32 v37, v34, v35
    v_lshlrev_b32 v38, 16, v36
    v_and_b32 v39, s16, v36
    v_sub_f32 v38, v32, v38
    v_sub_f32 v39, v33, v39
    v_cvt_pk_bf16_f32 v28, v38, v39
    v_cndmask_b32 v28, 0, v28, s[22:23]
    v_cndmask_b32 v28, v28, v36, vcc
    v_lshlrev_b32 v38, 16, v37
    v_and_b32 v39, s16, v37
    v_sub_f32 v38, v34, v38
    v_sub_f32 v39, v35, v39
    v_cvt_pk_bf16_f32 v29, v38, v39
    v_cndmask_b32 v29, 0, v29, s[22:23]
    v_cndmask_b32 v29, v29, v37, vcc
    buffer_store_dwordx2 v[28:29], v10, s[8:11], s7 offen sc1
L_prep_done_6:
    s_add_u32 s19, s18, 43515904
    s_add_u32 s20, s18, 38797312
    s_lshl_b32 s22, s21, 7
    s_add_u32 s22, s22, 48234496
    buffer_store_dwordx4 v[16:19], v172, s[8:11], s19 offen sc1
    buffer_store_dwordx4 v[20:23], v173, s[8:11], s19 offen sc1
    buffer_store_dwordx4 v[24:27], v174, s[8:11], s19 offen sc1
    s_mov_b32 s17, 0x3f803f80
    v_mov_b32 v8, 0
    v_mov_b32 v9, 0
    v_mov_b32 v10, 0
    v_mov_b32 v11, 0
    v_dot2c_f32_bf16 v8, s17, v16
    v_dot2c_f32_bf16 v9, v16, v16
    v_dot2c_f32_bf16 v10, s17, v17
    v_dot2c_f32_bf16 v11, v17, v17
    v_dot2c_f32_bf16 v8, s17, v18
    v_dot2c_f32_bf16 v9, v18, v18
    v_dot2c_f32_bf16 v10, s17, v19
    v_dot2c_f32_bf16 v11, v19, v19
    v_dot2c_f32_bf16 v8, s17, v20
    v_dot2c_f32_bf16 v9, v20, v20
    v_dot2c_f32_bf16 v10, s17, v21
    v_dot2c_f32_bf16 v11, v21, v21
    v_dot2c_f32_bf16 v8, s17, v22
    v_dot2c_f32_bf16 v9, v22, v22
    v_dot2c_f32_bf16 v10, s17, v23
    v_dot2c_f32_bf16 v11, v23, v23
    v_dot2c_f32_bf16 v8, s17, v24
    v_dot2c_f32_bf16 v9, v24, v24
    v_dot2c_f32_bf16 v10, s17, v25
    v_dot2c_f32_bf16 v11, v25, v25
    v_dot2c_f32_bf16 v8, s17, v26
    v_dot2c_f32_bf16 v9, v26, v26
    v_dot2c_f32_bf16 v10, s17, v27
    v_dot2c_f32_bf16 v11, v27, v27
    v_and_b32 v12, 7, v0
    v_lshlrev_b32 v12, 3, v12
    s_lshl_b32 s7, s3, 6
    v_add_u32 v13, s7, v12
    v_pk_add_f32 v[8:9], v[8:9], v[10:11]
    s_nop 1
    v_add_f32_dpp v8, v8, v8 row_ror:8 row_mask:0xf bank_mask:0xf
    v_add_f32_dpp v9, v9, v9 row_ror:8 row_mask:0xf bank_mask:0xf
    v_mov_b32 v10, v8
    v_mov_b32 v11, v9
    s_nop 1
    v_permlane32_swap_b32 v10, v8
    v_permlane32_swap_b32 v11, v9
    v_add_f32 v8, v8, v10
    v_add_f32 v9, v9, v11
    v_mov_b32 v10, v8
    v_mov_b32 v11, v9
    s_nop 1
    v_permlane16_swap_b32 v10, v8
    v_permlane16_swap_b32 v11, v9
    v_add_f32 v8, v8, v10
    v_add_f32 v9, v9, v11
    ds_write_b64 v13, v[8:9]
    s_waitcnt lgkmcnt(0)
    s_barrier
    ds_read_b64 v[40:41], v12 offset:0
    ds_read_b64 v[42:43], v12 offset:64
    ds_read_b64 v[44:45], v12 offset:128
    ds_read_b64 v[46:47], v12 offset:192
    s_waitcnt lgkmcnt(0)
    v_pk_add_f32 v[40:41], v[40:41], v[42:43]
    v_pk_add_f32 v[44:45], v[44:45], v[46:47]
    v_pk_add_f32 v[8:9], v[40:41], v[44:45]
    v_mul_f32 v8, 0x3ae38e39, v8
    v_mul_f32 v9, 0x3ae38e39, v9
    v_fma_f32 v9, -v8, v8, v9
    v_max_f32 v9, 0, v9
    v_add_f32 v9, 0x3727c5ac, v9
    v_rsq_f32 v10, v9
    s_nop 0
    v_mul_f32 v12, v8, v10
    v_mov_b32 v11, v10
    v_sub_f32 v12, 0, v12
    v_mov_b32 v13, v12
    s_cmp_eq_u32 s3, 0
    s_cselect_b32 s7, 32, 0
    v_lshlrev_b32 v14, 2, v0
    v_cmp_gt_u32 vcc, s7, v0
    v_mov_b32 v9, 1073741824
    s_nop 0
    v_cndmask_b32 v14, v9, v14, vcc
    buffer_store_dword v8, v14, s[8:11], s22 offen sc1
    v_lshlrev_b32 v40, 16, v16
    v_and_b32 v41, s16, v16
    v_lshlrev_b32 v42, 16, v17
    v_and_b32 v43, s16, v17
    v_lshlrev_b32 v44, 16, v18
    v_and_b32 v45, s16, v18
    v_lshlrev_b32 v46, 16, v19
    v_and_b32 v47, s16, v19
    v_pk_fma_f32 v[40:41], v[40:41], v[10:11], v[12:13]
    v_pk_fma_f32 v[42:43], v[42:43], v[10:11], v[12:13]
    v_pk_fma_f32 v[44:45], v[44:45], v[10:11], v[12:13]
    v_pk_fma_f32 v[46:47], v[46:47], v[10:11], v[12:13]
    v_cvt_pk_bf16_f32 v48, v40, v41
    v_cvt_pk_bf16_f32 v49, v42, v43
    v_cvt_pk_bf16_f32 v50, v44, v45
    v_cvt_pk_bf16_f32 v51, v46, v47
    v_lshlrev_b32 v40, 16, v20
    v_and_b32 v41, s16, v20
    v_lshlrev_b32 v42, 16, v21
    v_and_b32 v43, s16, v21
    v_lshlrev_b32 v44, 16, v22
    v_and_b32 v45, s16, v22
    v_lshlrev_b32 v46, 16, v23
    v_and_b32 v47, s16, v23
    v_pk_fma_f32 v[40:41], v[40:41], v[10:11], v[12:13]
    v_pk_fma_f32 v[42:43], v[42:43], v[10:11], v[12:13]
    v_pk_fma_f32 v[44:45], v[44:45], v[10:11], v[12:13]
    v_pk_fma_f32 v[46:47], v[46:47], v[10:11], v[12:13]
    v_cvt_pk_bf16_f32 v52, v40, v41
    v_cvt_pk_bf16_f32 v53, v42, v43
    v_cvt_pk_bf16_f32 v54, v44, v45
    v_cvt_pk_bf16_f32 v55, v46, v47
    v_lshlrev_b32 v40, 16, v24
    v_and_b32 v41, s16, v24
    v_lshlrev_b32 v42, 16, v25
    v_and_b32 v43, s16, v25
    v_lshlrev_b32 v44, 16, v26
    v_and_b32 v45, s16, v26
    v_lshlrev_b32 v46, 16, v27
    v_and_b32 v47, s16, v27
    v_pk_fma_f32 v[40:41], v[40:41], v[10:11], v[12:13]
    v_pk_fma_f32 v[42:43], v[42:43], v[10:11], v[12:13]
    v_pk_fma_f32 v[44:45], v[44:45], v[10:11], v[12:13]
    v_pk_fma_f32 v[46:47], v[46:47], v[10:11], v[12:13]
    v_cvt_pk_bf16_f32 v56, v40, v41
    v_cvt_pk_bf16_f32 v57, v42, v43
    v_cvt_pk_bf16_f32 v58, v44, v45
    v_cvt_pk_bf16_f32 v59, v46, v47
    buffer_store_dwordx4 v[48:51], v172, s[8:11], s20 offen sc1
    buffer_store_dwordx4 v[52:55], v173, s[8:11], s20 offen sc1
    buffer_store_dwordx4 v[56:59], v174, s[8:11], s20 offen sc1
    v_lshlrev_b32 v15, 7, v0
    s_lshl_b32 s6, s40, 2
    s_add_u32 s6, s6, s44
    s_sub_u32 s6, s6, 32768
    v_mov_b32 v1, s76
    s_mov_b64 vcc, 0xff
    v_lshrrev_b32 v14, 3, v0
    v_lshl_add_u32 v15, v14, 3, v15
    s_cmp_ge_u32 s40, 6
    s_cselect_b32 s7, s41, 31
    s_cmp_lt_u32 s7, 31
    s_cmov_b64 vcc, 0xffff
    s_waitcnt vmcnt(0)
    s_barrier
    s_cmp_lg_u32 s3, 0
    s_cbranch_scc1 L_pub_7
    s_mov_b64 exec, vcc
    buffer_store_dword v1, v15, s[8:11], s6 offen sc1
    s_lshl_b32 s6, s40, 7
    s_lshl_b32 s7, s32, 2
    s_add_u32 s6, s6, s7
    s_add_u32 s6, s6, 19431424
    s_mov_b64 exec, 0xffffffff
    v_lshlrev_b32 v15, 10, v0
    v_mov_b32 v1, s76
    buffer_store_dword v1, v15, s[8:11], s6 offen sc1
    s_cmp_lt_u32 s32, 18
    s_cbranch_scc1 L_pub_7
    s_lshl_b32 s6, s36, 2
    s_add_u32 s6, s6, 19496960
    s_mov_b64 exec, 1
    buffer_store_dword v1, off, s[8:11], s6 sc1
L_pub_7:
    s_mov_b64 exec, -1
    s_add_u32 m0, s79, 4096
    s_mov_b32 s71, s81
    buffer_load_dwordx4 v224, s[72:75], s71 offen nt lds
    s_add_u32 m0, s79, 5120
    s_add_u32 s71, s71, s92
    buffer_load_dwordx4 v224, s[72:75], s71 offen nt lds
    s_add_u32 m0, s79, 6144
    s_add_u32 s71, s71, s92
    buffer_load_dwordx4 v224, s[72:75], s71 offen nt lds
    s_add_u32 m0, s79, 7168
    s_add_u32 s71, s71, s92
    buffer_load_dwordx4 v224, s[72:75], s71 offen nt lds
    s_add_u32 m0, s79, 8192
    s_mov_b32 s71, s82
    buffer_load_dwordx4 v224, s[72:75], s71 offen nt lds
    s_add_u32 m0, s79, 9216
    s_add_u32 s71, s71, s92
    buffer_load_dwordx4 v224, s[72:75], s71 offen nt lds
    s_add_u32 m0, s79, 10240
    s_add_u32 s71, s71, s92
    buffer_load_dwordx4 v224, s[72:75], s71 offen nt lds
    s_add_u32 m0, s79, 11264
    s_add_u32 s71, s71, s92
    buffer_load_dwordx4 v224, s[72:75], s71 offen nt lds
    s_add_u32 m0, s79, 12288
    s_mov_b32 s71, s83
    buffer_load_dwordx4 v224, s[72:75], s71 offen nt lds
    s_add_u32 m0, s79, 13312
    s_add_u32 s71, s71, s92
    buffer_load_dwordx4 v224, s[72:75], s71 offen nt lds
    s_add_u32 m0, s79, 14336
    s_add_u32 s71, s71, s92
    buffer_load_dwordx4 v224, s[72:75], s71 offen nt lds
    s_add_u32 m0, s79, 15360
    s_add_u32 s71, s71, s92
    buffer_load_dwordx4 v224, s[72:75], s71 offen nt lds
    s_cmp_lg_u32 s3, 0
    s_cbranch_scc1 L_wq_ready_8
    s_lshl_b32 s7, s41, 3
    s_add_u32 s7, s7, s40
    s_lshl_b32 s7, s7, 7
    s_add_u32 s7, s7, 19431424
    s_add_u32 s68, s4, s7
    s_addc_u32 s69, s5, 0
    s_mov_b32 s6, 0
    s_mov_b32 s7, 0
L_cpoll_9:
    s_load_dwordx16 s[52:67], s[68:69], s7 glc
    s_add_u32 s6, s6, 1
    s_waitcnt lgkmcnt(0)
    s_xor_b64 s[52:53], s[52:53], s[76:77]
    s_xor_b64 s[54:55], s[54:55], s[76:77]
    s_xor_b64 s[56:57], s[56:57], s[76:77]
    s_xor_b64 s[58:59], s[58:59], s[76:77]
    s_xor_b64 s[60:61], s[60:61], s[76:77]
    s_xor_b64 s[62:63], s[62:63], s[76:77]
    s_xor_b64 s[64:65], s[64:65], s[76:77]
    s_xor_b64 s[66:67], s[66:67], s[76:77]
    s_or_b64 s[52:53], s[52:53], s[60:61]
    s_or_b64 s[54:55], s[54:55], s[62:63]
    s_or_b64 s[56:57], s[56:57], s[64:65]
    s_or_b64 s[58:59], s[58:59], s[66:67]
    s_or_b64 s[52:53], s[52:53], s[56:57]
    s_or_b64 s[54:55], s[54:55], s[58:59]
    s_or_b64 s[52:53], s[52:53], s[54:55]
    s_cbranch_scc1 L_cpoll_10
    s_add_u32 s7, s7, 8
    s_cmp_eq_u32 s7, 16
    s_cbranch_scc1 L_cpolled_11
L_cpoll_10:
    s_cmp_lt_u32 s6, 1048576
    s_cbranch_scc1 L_cpoll_9
    s_branch L_main_end
L_cpolled_11:
L_wq_ready_8:
    s_barrier
    s_lshl_b32 s28, s40, 2
    s_add_u32 s28, s28, s3
    s_mul_i32 s28, s28, 73728
    v_and_b32 v229, 8, v0
    v_lshl_add_u32 v229, v229, 27, v253
    buffer_load_dwordx4 a[0:3], v253, s[8:11], s28 offen offset:0 sc1
    buffer_load_dwordx4 a[4:7], v253, s[8:11], s28 offen offset:1024 sc1
    buffer_load_dwordx4 a[8:11], v253, s[8:11], s28 offen offset:2048 sc1
    buffer_load_dwordx4 a[12:15], v229, s[8:11], s28 offen offset:3072 sc1
    s_add_u32 s28, s28, 4096
    buffer_load_dwordx4 a[16:19], v253, s[8:11], s28 offen offset:0 sc1
    buffer_load_dwordx4 a[20:23], v253, s[8:11], s28 offen offset:1024 sc1
    buffer_load_dwordx4 a[24:27], v253, s[8:11], s28 offen offset:2048 sc1
    buffer_load_dwordx4 a[28:31], v229, s[8:11], s28 offen offset:3072 sc1
    s_add_u32 s28, s28, 4096
    buffer_load_dwordx4 a[32:35], v253, s[8:11], s28 offen offset:0 sc1
    buffer_load_dwordx4 a[36:39], v253, s[8:11], s28 offen offset:1024 sc1
    buffer_load_dwordx4 a[40:43], v253, s[8:11], s28 offen offset:2048 sc1
    buffer_load_dwordx4 a[44:47], v229, s[8:11], s28 offen offset:3072 sc1
    s_add_u32 s28, s28, 4096
    buffer_load_dwordx4 a[48:51], v253, s[8:11], s28 offen offset:0 sc1
    buffer_load_dwordx4 a[52:55], v253, s[8:11], s28 offen offset:1024 sc1
    buffer_load_dwordx4 a[56:59], v253, s[8:11], s28 offen offset:2048 sc1
    buffer_load_dwordx4 a[60:63], v229, s[8:11], s28 offen offset:3072 sc1
    s_add_u32 s28, s28, 4096
    buffer_load_dwordx4 a[64:67], v253, s[8:11], s28 offen offset:0 sc1
    buffer_load_dwordx4 a[68:71], v253, s[8:11], s28 offen offset:1024 sc1
    buffer_load_dwordx4 a[72:75], v253, s[8:11], s28 offen offset:2048 sc1
    buffer_load_dwordx4 a[76:79], v229, s[8:11], s28 offen offset:3072 sc1
    s_add_u32 s28, s28, 4096
    buffer_load_dwordx4 a[80:83], v253, s[8:11], s28 offen offset:0 sc1
    buffer_load_dwordx4 a[84:87], v253, s[8:11], s28 offen offset:1024 sc1
    buffer_load_dwordx4 a[88:91], v253, s[8:11], s28 offen offset:2048 sc1
    buffer_load_dwordx4 a[92:95], v229, s[8:11], s28 offen offset:3072 sc1
    s_add_u32 s28, s28, 4096
    buffer_load_dwordx4 a[96:99], v253, s[8:11], s28 offen offset:0 sc1
    buffer_load_dwordx4 a[100:103], v253, s[8:11], s28 offen offset:1024 sc1
    buffer_load_dwordx4 a[104:107], v253, s[8:11], s28 offen offset:2048 sc1
    buffer_load_dwordx4 a[108:111], v229, s[8:11], s28 offen offset:3072 sc1
    s_add_u32 s28, s28, 4096
    buffer_load_dwordx4 a[112:115], v253, s[8:11], s28 offen offset:0 sc1
    buffer_load_dwordx4 a[116:119], v253, s[8:11], s28 offen offset:1024 sc1
    buffer_load_dwordx4 a[120:123], v253, s[8:11], s28 offen offset:2048 sc1
    buffer_load_dwordx4 a[124:127], v229, s[8:11], s28 offen offset:3072 sc1
    s_add_u32 s28, s28, 4096
    buffer_load_dwordx4 a[128:131], v253, s[8:11], s28 offen offset:0 sc1
    buffer_load_dwordx4 a[132:135], v253, s[8:11], s28 offen offset:1024 sc1
    buffer_load_dwordx4 a[136:139], v253, s[8:11], s28 offen offset:2048 sc1
    buffer_load_dwordx4 a[140:143], v229, s[8:11], s28 offen offset:3072 sc1
    s_add_u32 s28, s28, 4096
L_main_layer:
    v_bfe_u32 v3, v0, 3, 1
    v_mul_u32_u24 v2, 9216, v3
    v_lshrrev_b32 v3, 4, v0
    v_lshl_add_u32 v2, v3, 7, v2
    v_and_b32 v3, 7, v0
    v_lshl_add_u32 v2, v3, 4, v2
    v_bfe_u32 v3, v0, 3, 2
    s_mov_b32 s7, 9216
    v_mul_lo_u32 v9, v3, s7
    v_lshrrev_b32 v3, 5, v0
    v_lshl_add_u32 v9, v3, 7, v9
    v_and_b32 v3, 7, v0
    v_lshl_add_u32 v9, v3, 4, v9
    s_mul_i32 s22, s41, 73728
    s_add_u32 s22, s22, s43
    s_add_u32 s23, s22, 38797312
    s_mul_i32 s7, s3, 18432
    s_add_u32 s24, s23, s7
    s_cmp_eq_u32 s41, 0
    s_cselect_b32 s7, 0, 18432
    s_sub_u32 s23, s23, s7
    s_lshl_b32 s25, s3, 10
    s_add_u32 s25, s25, 1024
    s_mul_i32 s26, s3, 5120
    s_lshl_b32 s7, s3, 9
    s_add_u32 s27, s23, s7
    s_and_b32 s7, s3, 1
    s_add_u32 s7, s7, 4
    s_mul_i32 s29, s7, 5120
    s_lshl_b32 s7, s7, 9
    s_add_u32 s23, s23, s7
    s_cmp_lg_u32 s3, 3
    s_cbranch_scc1 L_pollout_14
    s_lshl_b32 s7, s40, 7
    s_add_u32 s7, s7, s44
    s_sub_u32 s7, s7, 32768
    s_add_u32 s52, s4, s7
    s_addc_u32 s53, s5, 0
    s_cmp_eq_u32 s41, 0
    s_cselect_b32 s7, 0, 32
    s_mov_b32 s6, 0
L_poll_12:
    s_load_dwordx8 s[56:63], s[52:53], 0 glc
    s_load_dwordx2 s[54:55], s[52:53], s7 glc
    s_add_u32 s6, s6, 1
    s_waitcnt lgkmcnt(0)
    s_xor_b64 s[54:55], s[54:55], s[76:77]
    s_xor_b64 s[56:57], s[56:57], s[76:77]
    s_xor_b64 s[58:59], s[58:59], s[76:77]
    s_xor_b64 s[60:61], s[60:61], s[76:77]
    s_xor_b64 s[62:63], s[62:63], s[76:77]
    s_or_b64 s[56:57], s[56:57], s[58:59]
    s_or_b64 s[60:61], s[60:61], s[62:63]
    s_or_b64 s[56:57], s[56:57], s[54:55]
    s_or_b64 s[56:57], s[56:57], s[60:61]
    s_cbranch_scc0 L_polled_13
    s_cmp_lt_u32 s6, 1048576
    s_cbranch_scc1 L_poll_12
    s_branch L_main_end
L_polled_13:
L_pollout_14:
    s_barrier
    s_add_u32 m0, s25, 0
    s_nop 0
    buffer_load_dwordx4 v2, s[8:11], s24 offen offset:0 sc1 lds
    s_add_u32 m0, s25, 4608
    s_nop 0
    buffer_load_dwordx4 v2, s[8:11], s24 offen offset:512 sc1 lds
    s_add_u32 m0, s25, 9216
    s_nop 0
    buffer_load_dwordx4 v2, s[8:11], s24 offen offset:1024 sc1 lds
    s_add_u32 m0, s25, 13824
    s_nop 0
    buffer_load_dwordx4 v2, s[8:11], s24 offen offset:1536 sc1 lds
    s_add_u32 m0, s25, 18432
    s_nop 0
    buffer_load_dwordx4 v2, s[8:11], s24 offen offset:2048 sc1 lds
    s_add_u32 m0, s25, 23040
    s_nop 0
    buffer_load_dwordx4 v2, s[8:11], s24 offen offset:2560 sc1 lds
    s_add_u32 m0, s26, 0
    s_add_u32 s7, s27, 0
    buffer_load_dwordx4 v2, s[8:11], s7 offen sc1 lds
    s_add_u32 m0, s29, 0
    s_add_u32 s7, s23, 0
    buffer_load_dwordx4 v2, s[8:11], s7 offen sc1 lds
    v_add_u32 v6, 46080, v253
    s_waitcnt vmcnt(0)
    s_barrier
    ds_read_b128 v[16:19], v253 offset:0
    ds_read_b128 v[20:23], v253 offset:1024
    ds_read_b128 v[24:27], v253 offset:2048
    ds_read_b128 v[28:31], v253 offset:3072
    ds_read_b128 v[32:35], v253 offset:4096
    s_waitcnt lgkmcnt(0)
    v_mfma_f32_16x16x32_bf16 v[56:59], a[0:3], v[20:23], 0
    ds_read_b128 v[36:39], v253 offset:5120
    v_mfma_f32_16x16x32_bf16 v[60:63], a[0:3], v[24:27], 0
    ds_read_b128 v[40:43], v253 offset:6144
    v_mfma_f32_16x16x32_bf16 v[64:67], a[0:3], v[28:31], 0
    ds_read_b128 v[44:47], v253 offset:7168
    v_mfma_f32_16x16x32_bf16 v[68:71], a[0:3], v[32:35], 0
    ds_read_b128 v[48:51], v253 offset:8192
    v_mfma_f32_16x16x32_bf16 v[72:75], a[4:7], v[16:19], 0
    ds_read_b128 v[52:55], v253 offset:9216
    v_mfma_f32_16x16x32_bf16 v[76:79], a[4:7], v[20:23], 0
    s_add_u32 m0, s25, 27648
    s_nop 0
    buffer_load_dwordx4 v2, s[8:11], s24 offen offset:3072 sc1 lds
    v_mfma_f32_16x16x32_bf16 v[80:83], a[4:7], v[24:27], 0
    v_mov_b32 v132, 0
    v_mov_b32 v133, 0
    v_mfma_f32_16x16x32_bf16 v[84:87], a[4:7], v[28:31], 0
    s_add_u32 m0, s25, 32256
    s_nop 0
    buffer_load_dwordx4 v2, s[8:11], s24 offen offset:3584 sc1 lds
    v_mfma_f32_16x16x32_bf16 v[88:91], a[4:7], v[32:35], 0
    v_mov_b32 v192, 0
    v_mov_b32 v193, 0
    v_mfma_f32_16x16x32_bf16 v[92:95], v[16:19], a[8:11], 0
    buffer_load_dwordx4 a[144:147], v253, s[8:11], s28 offen offset:0 sc1
    v_mfma_f32_16x16x32_bf16 v[96:99], v[20:23], a[8:11], 0
    v_mov_b32 v195, 0
    v_mov_b32 v135, 0
    v_mfma_f32_16x16x32_bf16 v[100:103], v[24:27], a[8:11], 0
    buffer_load_dwordx4 a[148:151], v253, s[8:11], s28 offen offset:1024 sc1
    v_mfma_f32_16x16x32_bf16 v[104:107], v[28:31], a[8:11], 0
    v_mov_b32 v139, 0
    v_mov_b32 v143, 0
    v_mfma_f32_16x16x32_bf16 v[108:111], v[32:35], a[8:11], 0
    buffer_load_dwordx4 a[152:155], v253, s[8:11], s28 offen offset:2048 sc1
    v_mfma_f32_16x16x32_bf16 v[112:115], a[12:15], v[16:19], 0
    v_mov_b32 v147, 0
    v_mov_b32 v151, 0
    v_mfma_f32_16x16x32_bf16 v[116:119], a[12:15], v[20:23], 0
    v_mov_b32 v155, 0
    v_mov_b32 v159, 0
    v_mfma_f32_16x16x32_bf16 v[120:123], a[12:15], v[24:27], 0
    v_mov_b32 v163, 0
    v_mov_b32 v167, 0
    v_mfma_f32_16x16x32_bf16 v[124:127], a[12:15], v[28:31], 0
    v_mov_b32 v171, 0
    v_cmp_eq_u32 vcc, 16, v0
    v_mov_b32 v10, 0x3f80
    v_mfma_f32_16x16x32_bf16 v[128:131], a[12:15], v[32:35], 0
    v_cmp_eq_u32 s[20:21], 17, v0
    v_cndmask_b32 v194, 0, v10, vcc
    v_and_b32 v11, 3, v0
    s_waitcnt lgkmcnt(0)
    v_mfma_f32_16x16x32_bf16 v[56:59], a[16:19], v[40:43], v[56:59]
    ds_read_b128 v[16:19], v253 offset:10240
    v_mfma_f32_16x16x32_bf16 v[60:63], a[16:19], v[44:47], v[60:63]
    ds_read_b128 v[20:23], v253 offset:11264
    v_mfma_f32_16x16x32_bf16 v[64:67], a[16:19], v[48:51], v[64:67]
    ds_read_b128 v[24:27], v253 offset:12288
    v_mfma_f32_16x16x32_bf16 v[68:71], a[16:19], v[52:55], v[68:71]
    ds_read_b128 v[28:31], v253 offset:13312
    v_mfma_f32_16x16x32_bf16 v[72:75], a[20:23], v[36:39], v[72:75]
    ds_read_b128 v[32:35], v253 offset:14336
    v_mfma_f32_16x16x32_bf16 v[76:79], a[20:23], v[40:43], v[76:79]
    s_add_u32 m0, s25, 40960
    s_add_u32 s24, s24, 4096
    buffer_load_dwordx4 v2, s[8:11], s24 offen offset:0 sc1 lds
    v_mfma_f32_16x16x32_bf16 v[80:83], a[20:23], v[44:47], v[80:83]
    v_cndmask_b32 v194, v194, 1.0, s[20:21]
    v_cmp_eq_u32 vcc, 2, v11
    v_and_b32 v10, 15, v0
    v_mfma_f32_16x16x32_bf16 v[84:87], a[20:23], v[48:51], v[84:87]
    s_add_u32 m0, s25, 45568
    s_nop 0
    buffer_load_dwordx4 v2, s[8:11], s24 offen offset:512 sc1 lds
    v_mfma_f32_16x16x32_bf16 v[88:91], a[20:23], v[52:55], v[88:91]
    v_lshrrev_b32 v11, 4, v0
    v_cndmask_b32 v196, 0, 1.0, vcc
    v_mfma_f32_16x16x32_bf16 v[92:95], v[36:39], a[24:27], v[92:95]
    buffer_load_dwordx4 a[156:159], v229, s[8:11], s28 offen offset:3072 sc1
    s_add_u32 s28, s28, 4096
    v_mfma_f32_16x16x32_bf16 v[96:99], v[40:43], a[24:27], v[96:99]
    v_cndmask_b32 v197, 0, 1.0, vcc
    v_cndmask_b32 v198, 0, 1.0, vcc
    v_mfma_f32_16x16x32_bf16 v[100:103], v[44:47], a[24:27], v[100:103]
    buffer_load_dwordx4 a[0:3], v253, s[8:11], s28 offen offset:0 sc1
    v_mfma_f32_16x16x32_bf16 v[104:107], v[48:51], a[24:27], v[104:107]
    v_cndmask_b32 v199, 0, 1.0, vcc
    v_lshlrev_b32 v11, 2, v11
    v_mfma_f32_16x16x32_bf16 v[108:111], v[52:55], a[24:27], v[108:111]
    buffer_load_dwordx4 a[4:7], v253, s[8:11], s28 offen offset:1024 sc1
    v_mfma_f32_16x16x32_bf16 v[112:115], a[28:31], v[36:39], v[112:115]
    v_sub_u32 v10, v11, v10
    v_mov_b32 v12, 0xf149f2ca
    v_mfma_f32_16x16x32_bf16 v[116:119], a[28:31], v[40:43], v[116:119]
    s_cmp_eq_u32 s41, 0
    s_cselect_b64 s[38:39], 0, -1
    v_add_u32 v11, 0, v10
    v_and_b32 v13, 1, v11
    v_mfma_f32_16x16x32_bf16 v[120:123], a[28:31], v[44:47], v[120:123]
    v_cmp_eq_u32 s[20:21], 0, v13
    v_cmp_lt_i32 vcc, 1, v11
    v_cmp_gt_i32 s[18:19], 1, v11
    s_and_b64 vcc, vcc, s[20:21]
    s_and_b64 s[18:19], s[18:19], s[20:21]
    s_and_b64 s[20:21], vcc, s[38:39]
    v_cndmask_b32 v200, v12, 0, vcc
    v_cndmask_b32 v204, v12, 0, s[18:19]
    v_mfma_f32_16x16x32_bf16 v[124:127], a[28:31], v[48:51], v[124:127]
    v_cndmask_b32 v208, v12, 0, s[20:21]
    v_add_u32 v11, 1, v10
    v_mfma_f32_16x16x32_bf16 v[128:131], a[28:31], v[52:55], v[128:131]
    v_and_b32 v13, 1, v11
    v_cmp_eq_u32 s[20:21], 0, v13
    v_cmp_lt_i32 vcc, 1, v11
    v_cmp_gt_i32 s[18:19], 1, v11
    s_and_b64 vcc, vcc, s[20:21]
    s_and_b64 s[18:19], s[18:19], s[20:21]
    s_and_b64 s[20:21], vcc, s[38:39]
    v_cndmask_b32 v201, v12, 0, vcc
    s_waitcnt lgkmcnt(0)
    v_mfma_f32_16x16x32_bf16 v[56:59], a[32:35], v[20:23], v[56:59]
    ds_read_b128 v[36:39], v253 offset:15360
    v_mfma_f32_16x16x32_bf16 v[60:63], a[32:35], v[24:27], v[60:63]
    ds_read_b128 v[40:43], v253 offset:16384
    v_mfma_f32_16x16x32_bf16 v[64:67], a[32:35], v[28:31], v[64:67]
    ds_read_b128 v[44:47], v253 offset:17408
    v_mfma_f32_16x16x32_bf16 v[68:71], a[32:35], v[32:35], v[68:71]
    ds_read_b128 v[48:51], v253 offset:18432
    v_mfma_f32_16x16x32_bf16 v[72:75], a[36:39], v[16:19], v[72:75]
    ds_read_b128 v[52:55], v253 offset:19456
    v_mfma_f32_16x16x32_bf16 v[76:79], a[36:39], v[20:23], v[76:79]
    s_add_u32 m0, s25, 50176
    s_nop 0
    buffer_load_dwordx4 v2, s[8:11], s24 offen offset:1024 sc1 lds
    v_mfma_f32_16x16x32_bf16 v[80:83], a[36:39], v[24:27], v[80:83]
    v_cndmask_b32 v205, v12, 0, s[18:19]
    v_cndmask_b32 v209, v12, 0, s[20:21]
    v_mfma_f32_16x16x32_bf16 v[84:87], a[36:39], v[28:31], v[84:87]
    s_add_u32 m0, s25, 54784
    s_nop 0
    buffer_load_dwordx4 v2, s[8:11], s24 offen offset:1536 sc1 lds
    v_mfma_f32_16x16x32_bf16 v[88:91], a[36:39], v[32:35], v[88:91]
    v_add_u32 v11, 2, v10
    v_and_b32 v13, 1, v11
    v_mfma_f32_16x16x32_bf16 v[92:95], v[16:19], a[40:43], v[92:95]
    buffer_load_dwordx4 a[8:11], v253, s[8:11], s28 offen offset:2048 sc1
    v_mfma_f32_16x16x32_bf16 v[96:99], v[20:23], a[40:43], v[96:99]
    v_cmp_eq_u32 s[20:21], 0, v13
    v_cmp_lt_i32 vcc, 1, v11
    v_cmp_gt_i32 s[18:19], 1, v11
    s_and_b64 vcc, vcc, s[20:21]
    s_and_b64 s[18:19], s[18:19], s[20:21]
    s_and_b64 s[20:21], vcc, s[38:39]
    v_cndmask_b32 v202, v12, 0, vcc
    v_cndmask_b32 v206, v12, 0, s[18:19]
    v_mfma_f32_16x16x32_bf16 v[100:103], v[24:27], a[40:43], v[100:103]
    buffer_load_dwordx4 a[12:15], v229, s[8:11], s28 offen offset:3072 sc1
    s_add_u32 s28, s28, 4096
    v_mfma_f32_16x16x32_bf16 v[104:107], v[28:31], a[40:43], v[104:107]
    v_cndmask_b32 v210, v12, 0, s[20:21]
    v_add_u32 v11, 3, v10
    v_mfma_f32_16x16x32_bf16 v[108:111], v[32:35], a[40:43], v[108:111]
    buffer_load_dwordx4 a[16:19], v253, s[8:11], s28 offen offset:0 sc1
    v_mfma_f32_16x16x32_bf16 v[112:115], a[44:47], v[16:19], v[112:115]
    v_and_b32 v13, 1, v11
    v_cmp_eq_u32 s[20:21], 0, v13
    v_cmp_lt_i32 vcc, 1, v11
    v_cmp_gt_i32 s[18:19], 1, v11
    s_and_b64 vcc, vcc, s[20:21]
    s_and_b64 s[18:19], s[18:19], s[20:21]
    s_and_b64 s[20:21], vcc, s[38:39]
    v_cndmask_b32 v203, v12, 0, vcc
    v_mfma_f32_16x16x32_bf16 v[116:119], a[44:47], v[20:23], v[116:119]
    v_cndmask_b32 v207, v12, 0, s[18:19]
    v_cndmask_b32 v211, v12, 0, s[20:21]
    v_mfma_f32_16x16x32_bf16 v[120:123], a[44:47], v[24:27], v[120:123]
    s_lshl_b32 s45, s41, 1
    s_lshr_b32 s7, s40, 2
    s_add_u32 s45, s45, s7
    s_mul_i32 s30, s45, 36864
    s_add_u32 s30, s30, s43
    s_and_b32 s31, s40, 3
    s_mul_i32 s31, s31, 9
    s_add_u32 s31, s31, s3
    s_mul_i32 s32, s31, 18432
    s_add_u32 s32, s32, 2359296
    s_add_u32 s33, s32, 73728
    s_add_u32 s34, s32, 147456
    s_mov_b32 s39, 19496960
    v_min_u32 v228, 44, v0
    v_lshlrev_b32 v228, 3, v228
    v_mfma_f32_16x16x32_bf16 v[124:127], a[44:47], v[28:31], v[124:127]
    s_cmp_eq_u32 s3, 1
    s_cmov_b32 s34, 3022848
    s_cmp_lt_u32 s3, 2
    s_cselect_b32 s35, 0, 1073741824
    v_add_u32 v5, s35, v253
    s_cmp_eq_u32 s3, 1
    s_cselect_b32 s7, 8, 0
    v_and_b32 v10, s7, v0
    v_mfma_f32_16x16x32_bf16 v[128:131], a[44:47], v[32:35], v[128:131]
    v_lshl_add_u32 v5, v10, 27, v5
    s_cmp_eq_u32 s3, 0
    s_cselect_b32 s35, 0, 1073741824
    v_add_u32 v7, s35, v9
    s_waitcnt lgkmcnt(0)
    v_mfma_f32_16x16x32_bf16 v[56:59], a[48:51], v[40:43], v[56:59]
    ds_read_b128 v[16:19], v253 offset:20480
    v_mfma_f32_16x16x32_bf16 v[60:63], a[48:51], v[44:47], v[60:63]
    ds_read_b128 v[20:23], v253 offset:21504
    v_mfma_f32_16x16x32_bf16 v[64:67], a[48:51], v[48:51], v[64:67]
    ds_read_b128 v[24:27], v253 offset:22528
    v_mfma_f32_16x16x32_bf16 v[68:71], a[48:51], v[52:55], v[68:71]
    ds_read_b128 v[28:31], v253 offset:23552
    v_mfma_f32_16x16x32_bf16 v[72:75], a[52:55], v[36:39], v[72:75]
    ds_read_b128 v[32:35], v253 offset:24576
    v_mfma_f32_16x16x32_bf16 v[76:79], a[52:55], v[40:43], v[76:79]
    s_add_u32 m0, s26, 30720
    s_add_u32 s7, s27, 3072
    buffer_load_dwordx4 v2, s[8:11], s7 offen sc1 lds
    v_mfma_f32_16x16x32_bf16 v[80:83], a[52:55], v[44:47], v[80:83]
    s_lshl_b32 s7, s31, 8
    s_add_u32 s36, s30, s7
    s_add_u32 s37, s36, 43515904
    s_add_u32 s46, s36, 45875200
    s_lshl_b32 s36, s45, 7
    s_add_u32 s36, s36, s43
    s_add_u32 s36, s36, 48431104
    s_lshl_b32 s47, s45, 9
    s_add_u32 s47, s47, s43
    s_add_u32 s47, s47, 48234496
    v_bfe_u32 v10, v0, 3, 2
    v_and_b32 v8, 7, v0
    v_mfma_f32_16x16x32_bf16 v[84:87], a[52:55], v[48:51], v[84:87]
    s_add_u32 m0, s29, 30720
    s_add_u32 s7, s23, 3072
    buffer_load_dwordx4 v2, s[8:11], s7 offen sc1 lds
    v_mfma_f32_16x16x32_bf16 v[88:91], a[52:55], v[52:55], v[88:91]
    v_lshlrev_b32 v8, 2, v8
    v_lshl_add_u32 v8, v10, 7, v8
    v_mfma_f32_16x16x32_bf16 v[92:95], v[36:39], a[56:59], v[92:95]
    buffer_load_dwordx4 a[20:23], v253, s[8:11], s28 offen offset:1024 sc1
    v_mfma_f32_16x16x32_bf16 v[96:99], v[40:43], a[56:59], v[96:99]
    v_mfma_f32_16x16x32_bf16 v[100:103], v[44:47], a[56:59], v[100:103]
    buffer_load_dwordx4 a[24:27], v253, s[8:11], s28 offen offset:2048 sc1
    v_mfma_f32_16x16x32_bf16 v[104:107], v[48:51], a[56:59], v[104:107]
    v_mfma_f32_16x16x32_bf16 v[108:111], v[52:55], a[56:59], v[108:111]
    buffer_load_dwordx4 a[28:31], v229, s[8:11], s28 offen offset:3072 sc1
    s_add_u32 s28, s28, 4096
    v_mfma_f32_16x16x32_bf16 v[112:115], a[60:63], v[36:39], v[112:115]
    v_mfma_f32_16x16x32_bf16 v[116:119], a[60:63], v[40:43], v[116:119]
    v_mfma_f32_16x16x32_bf16 v[120:123], a[60:63], v[44:47], v[120:123]
    v_mfma_f32_16x16x32_bf16 v[124:127], a[60:63], v[48:51], v[124:127]
    v_mfma_f32_16x16x32_bf16 v[128:131], a[60:63], v[52:55], v[128:131]
    s_waitcnt lgkmcnt(0)
    v_mfma_f32_16x16x32_bf16 v[56:59], a[64:67], v[20:23], v[56:59]
    ds_read_b128 v[36:39], v253 offset:25600
    v_mfma_f32_16x16x32_bf16 v[60:63], a[64:67], v[24:27], v[60:63]
    ds_read_b128 v[40:43], v253 offset:26624
    v_mfma_f32_16x16x32_bf16 v[64:67], a[64:67], v[28:31], v[64:67]
    ds_read_b128 v[44:47], v253 offset:27648
    v_mfma_f32_16x16x32_bf16 v[68:71], a[64:67], v[32:35], v[68:71]
    ds_read_b128 v[48:51], v253 offset:28672
    v_mfma_f32_16x16x32_bf16 v[72:75], a[68:71], v[16:19], v[72:75]
    ds_read_b128 v[52:55], v253 offset:29696
    v_mfma_f32_16x16x32_bf16 v[76:79], a[68:71], v[20:23], v[76:79]
    buffer_load_dwordx4 a[32:35], v253, s[8:11], s28 offen offset:0 sc1
    v_mfma_f32_16x16x32_bf16 v[80:83], a[68:71], v[24:27], v[80:83]
    v_mfma_f32_16x16x32_bf16 v[84:87], a[68:71], v[28:31], v[84:87]
    buffer_load_dwordx4 a[36:39], v253, s[8:11], s28 offen offset:1024 sc1
    v_mfma_f32_16x16x32_bf16 v[88:91], a[68:71], v[32:35], v[88:91]
    v_mfma_f32_16x16x32_bf16 v[92:95], v[16:19], a[72:75], v[92:95]
    buffer_load_dwordx4 a[40:43], v253, s[8:11], s28 offen offset:2048 sc1
    v_mfma_f32_16x16x32_bf16 v[96:99], v[20:23], a[72:75], v[96:99]
    v_mfma_f32_16x16x32_bf16 v[100:103], v[24:27], a[72:75], v[100:103]
    v_mfma_f32_16x16x32_bf16 v[104:107], v[28:31], a[72:75], v[104:107]
    v_mfma_f32_16x16x32_bf16 v[108:111], v[32:35], a[72:75], v[108:111]
    v_mfma_f32_16x16x32_bf16 v[112:115], a[76:79], v[16:19], v[112:115]
    v_mfma_f32_16x16x32_bf16 v[116:119], a[76:79], v[20:23], v[116:119]
    v_mfma_f32_16x16x32_bf16 v[120:123], a[76:79], v[24:27], v[120:123]
    v_mfma_f32_16x16x32_bf16 v[124:127], a[76:79], v[28:31], v[124:127]
    v_mfma_f32_16x16x32_bf16 v[128:131], a[76:79], v[32:35], v[128:131]
    s_waitcnt vmcnt(6) lgkmcnt(0)
    s_barrier
    v_mfma_f32_16x16x32_bf16 v[56:59], a[80:83], v[40:43], v[56:59]
    ds_read_b128 v[16:19], v253 offset:30720
    v_mfma_f32_16x16x32_bf16 v[60:63], a[80:83], v[44:47], v[60:63]
    ds_read_b128 v[20:23], v253 offset:31744
    v_mfma_f32_16x16x32_bf16 v[64:67], a[80:83], v[48:51], v[64:67]
    ds_read_b128 v[24:27], v253 offset:32768
    v_mfma_f32_16x16x32_bf16 v[68:71], a[80:83], v[52:55], v[68:71]
    ds_read_b128 v[28:31], v253 offset:33792
    v_mfma_f32_16x16x32_bf16 v[72:75], a[84:87], v[36:39], v[72:75]
    ds_read_b128 v[32:35], v253 offset:34816
    v_mfma_f32_16x16x32_bf16 v[76:79], a[84:87], v[40:43], v[76:79]
    s_add_u32 m0, s25, 59392
    s_nop 0
    buffer_load_dwordx4 v2, s[8:11], s24 offen offset:2048 sc1 lds
    v_mfma_f32_16x16x32_bf16 v[80:83], a[84:87], v[44:47], v[80:83]
    v_mfma_f32_16x16x32_bf16 v[84:87], a[84:87], v[48:51], v[84:87]
    s_add_u32 m0, s25, 64000
    s_nop 0
    buffer_load_dwordx4 v2, s[8:11], s24 offen offset:2560 sc1 lds
    v_mfma_f32_16x16x32_bf16 v[88:91], a[84:87], v[52:55], v[88:91]
    v_mfma_f32_16x16x32_bf16 v[92:95], v[36:39], a[88:91], v[92:95]
    buffer_load_dwordx4 a[44:47], v229, s[8:11], s28 offen offset:3072 sc1
    s_add_u32 s28, s28, 4096
    v_mfma_f32_16x16x32_bf16 v[96:99], v[40:43], a[88:91], v[96:99]
    v_mfma_f32_16x16x32_bf16 v[100:103], v[44:47], a[88:91], v[100:103]
    buffer_load_dwordx4 a[48:51], v253, s[8:11], s28 offen offset:0 sc1
    v_mfma_f32_16x16x32_bf16 v[104:107], v[48:51], a[88:91], v[104:107]
    v_mfma_f32_16x16x32_bf16 v[108:111], v[52:55], a[88:91], v[108:111]
    buffer_load_dwordx4 a[52:55], v253, s[8:11], s28 offen offset:1024 sc1
    v_mfma_f32_16x16x32_bf16 v[112:115], a[92:95], v[36:39], v[112:115]
    v_mfma_f32_16x16x32_bf16 v[116:119], a[92:95], v[40:43], v[116:119]
    v_mfma_f32_16x16x32_bf16 v[120:123], a[92:95], v[44:47], v[120:123]
    v_mfma_f32_16x16x32_bf16 v[124:127], a[92:95], v[48:51], v[124:127]
    v_mfma_f32_16x16x32_bf16 v[128:131], a[92:95], v[52:55], v[128:131]
    s_waitcnt lgkmcnt(0)
    v_mfma_f32_16x16x32_bf16 v[56:59], a[96:99], v[20:23], v[56:59]
    ds_read_b128 v[36:39], v253 offset:35840
    v_mfma_f32_16x16x32_bf16 v[60:63], a[96:99], v[24:27], v[60:63]
    ds_read_b128 v[40:43], v253 offset:36864
    v_mfma_f32_16x16x32_bf16 v[64:67], a[96:99], v[28:31], v[64:67]
    ds_read_b128 v[44:47], v253 offset:37888
    v_mfma_f32_16x16x32_bf16 v[68:71], a[96:99], v[32:35], v[68:71]
    ds_read_b128 v[48:51], v253 offset:38912
    v_mfma_f32_16x16x32_bf16 v[72:75], a[100:103], v[16:19], v[72:75]
    ds_read_b128 v[52:55], v253 offset:39936
    v_mfma_f32_16x16x32_bf16 v[76:79], a[100:103], v[20:23], v[76:79]
    s_add_u32 m0, s25, 68608
    s_nop 0
    buffer_load_dwordx4 v2, s[8:11], s24 offen offset:3072 sc1 lds
    v_mfma_f32_16x16x32_bf16 v[80:83], a[100:103], v[24:27], v[80:83]
    v_mfma_f32_16x16x32_bf16 v[84:87], a[100:103], v[28:31], v[84:87]
    s_add_u32 m0, s25, 73216
    s_nop 0
    buffer_load_dwordx4 v2, s[8:11], s24 offen offset:3584 sc1 lds
    v_mfma_f32_16x16x32_bf16 v[88:91], a[100:103], v[32:35], v[88:91]
    v_mfma_f32_16x16x32_bf16 v[92:95], v[16:19], a[104:107], v[92:95]
    buffer_load_dwordx4 a[56:59], v253, s[8:11], s28 offen offset:2048 sc1
    v_mfma_f32_16x16x32_bf16 v[96:99], v[20:23], a[104:107], v[96:99]
    v_mfma_f32_16x16x32_bf16 v[100:103], v[24:27], a[104:107], v[100:103]
    buffer_load_dwordx4 a[60:63], v229, s[8:11], s28 offen offset:3072 sc1
    s_add_u32 s28, s28, 4096
    v_mfma_f32_16x16x32_bf16 v[104:107], v[28:31], a[104:107], v[104:107]
    v_mfma_f32_16x16x32_bf16 v[108:111], v[32:35], a[104:107], v[108:111]
    buffer_load_dwordx4 a[64:67], v253, s[8:11], s28 offen offset:0 sc1
    v_mfma_f32_16x16x32_bf16 v[112:115], a[108:111], v[16:19], v[112:115]
    v_mfma_f32_16x16x32_bf16 v[116:119], a[108:111], v[20:23], v[116:119]
    buffer_load_dwordx2 v[226:227], v228, s[8:11], s39 offen sc1
    v_mfma_f32_16x16x32_bf16 v[120:123], a[108:111], v[24:27], v[120:123]
    v_mfma_f32_16x16x32_bf16 v[124:127], a[108:111], v[28:31], v[124:127]
    v_mfma_f32_16x16x32_bf16 v[128:131], a[108:111], v[32:35], v[128:131]
    s_waitcnt lgkmcnt(0)
    v_mfma_f32_16x16x32_bf16 v[56:59], a[112:115], v[40:43], v[56:59]
    ds_read_b128 v[16:19], v253 offset:40960
    v_mfma_f32_16x16x32_bf16 v[60:63], a[112:115], v[44:47], v[60:63]
    ds_read_b128 v[20:23], v253 offset:41984
    v_mfma_f32_16x16x32_bf16 v[64:67], a[112:115], v[48:51], v[64:67]
    ds_read_b128 v[24:27], v253 offset:43008
    v_mfma_f32_16x16x32_bf16 v[68:71], a[112:115], v[52:55], v[68:71]
    ds_read_b128 v[28:31], v253 offset:44032
    v_mfma_f32_16x16x32_bf16 v[72:75], a[116:119], v[36:39], v[72:75]
    ds_read_b128 v[32:35], v253 offset:45056
    v_mfma_f32_16x16x32_bf16 v[76:79], a[116:119], v[40:43], v[76:79]
    s_add_u32 m0, s25, 81920
    s_add_u32 s24, s24, 4096
    buffer_load_dwordx4 v2, s[8:11], s24 offen offset:0 sc1 lds
    v_mfma_f32_16x16x32_bf16 v[80:83], a[116:119], v[44:47], v[80:83]
    v_mfma_f32_16x16x32_bf16 v[84:87], a[116:119], v[48:51], v[84:87]
    s_add_u32 m0, s25, 86528
    s_nop 0
    buffer_load_dwordx4 v2, s[8:11], s24 offen offset:512 sc1 lds
    v_mfma_f32_16x16x32_bf16 v[88:91], a[116:119], v[52:55], v[88:91]
    v_mfma_f32_16x16x32_bf16 v[92:95], v[36:39], a[120:123], v[92:95]
    buffer_load_dwordx4 a[68:71], v253, s[8:11], s28 offen offset:1024 sc1
    v_mfma_f32_16x16x32_bf16 v[96:99], v[40:43], a[120:123], v[96:99]
    v_mfma_f32_16x16x32_bf16 v[100:103], v[44:47], a[120:123], v[100:103]
    buffer_load_dwordx4 a[72:75], v253, s[8:11], s28 offen offset:2048 sc1
    v_mfma_f32_16x16x32_bf16 v[104:107], v[48:51], a[120:123], v[104:107]
    v_mfma_f32_16x16x32_bf16 v[108:111], v[52:55], a[120:123], v[108:111]
    buffer_load_dwordx4 a[76:79], v229, s[8:11], s28 offen offset:3072 sc1
    s_add_u32 s28, s28, 4096
    v_mfma_f32_16x16x32_bf16 v[112:115], a[124:127], v[36:39], v[112:115]
    v_mfma_f32_16x16x32_bf16 v[116:119], a[124:127], v[40:43], v[116:119]
    v_mfma_f32_16x16x32_bf16 v[120:123], a[124:127], v[44:47], v[120:123]
    v_mfma_f32_16x16x32_bf16 v[124:127], a[124:127], v[48:51], v[124:127]
    v_mfma_f32_16x16x32_bf16 v[128:131], a[124:127], v[52:55], v[128:131]
    s_waitcnt lgkmcnt(0)
    v_mfma_f32_16x16x32_bf16 v[56:59], a[128:131], v[20:23], v[56:59]
    ds_read_b128 v[36:39], v6 offset:0
    v_mfma_f32_16x16x32_bf16 v[60:63], a[128:131], v[24:27], v[60:63]
    ds_read_b128 v[40:43], v6 offset:1024
    v_mfma_f32_16x16x32_bf16 v[64:67], a[128:131], v[28:31], v[64:67]
    ds_read_b128 v[44:47], v6 offset:2048
    v_mfma_f32_16x16x32_bf16 v[68:71], a[128:131], v[32:35], v[68:71]
    ds_read_b128 v[48:51], v6 offset:3072
    v_mfma_f32_16x16x32_bf16 v[72:75], a[132:135], v[16:19], v[72:75]
    ds_read_b128 v[52:55], v6 offset:4096
    v_mfma_f32_16x16x32_bf16 v[76:79], a[132:135], v[20:23], v[76:79]
    s_add_u32 m0, s26, 61440
    s_add_u32 s7, s27, 6144
    buffer_load_dwordx4 v2, s[8:11], s7 offen sc1 lds
    v_mfma_f32_16x16x32_bf16 v[80:83], a[132:135], v[24:27], v[80:83]
    v_mfma_f32_16x16x32_bf16 v[84:87], a[132:135], v[28:31], v[84:87]
    s_add_u32 m0, s29, 61440
    s_add_u32 s7, s23, 6144
    buffer_load_dwordx4 v2, s[8:11], s7 offen sc1 lds
    v_mfma_f32_16x16x32_bf16 v[88:91], a[132:135], v[32:35], v[88:91]
    v_mfma_f32_16x16x32_bf16 v[92:95], v[16:19], a[136:139], v[92:95]
    buffer_load_dwordx4 a[80:83], v253, s[8:11], s28 offen offset:0 sc1
    v_mfma_f32_16x16x32_bf16 v[96:99], v[20:23], a[136:139], v[96:99]
    v_mfma_f32_16x16x32_bf16 v[100:103], v[24:27], a[136:139], v[100:103]
    buffer_load_dwordx4 a[84:87], v253, s[8:11], s28 offen offset:1024 sc1
    v_mfma_f32_16x16x32_bf16 v[104:107], v[28:31], a[136:139], v[104:107]
    v_mfma_f32_16x16x32_bf16 v[108:111], v[32:35], a[136:139], v[108:111]
    buffer_load_dwordx4 a[88:91], v253, s[8:11], s28 offen offset:2048 sc1
    v_mfma_f32_16x16x32_bf16 v[112:115], a[140:143], v[16:19], v[112:115]
    v_mfma_f32_16x16x32_bf16 v[116:119], a[140:143], v[20:23], v[116:119]
    v_mfma_f32_16x16x32_bf16 v[120:123], a[140:143], v[24:27], v[120:123]
    v_mfma_f32_16x16x32_bf16 v[124:127], a[140:143], v[28:31], v[124:127]
    v_mfma_f32_16x16x32_bf16 v[128:131], a[140:143], v[32:35], v[128:131]
    s_waitcnt vmcnt(10) lgkmcnt(0)
    s_mov_b32 s6, 0
L_wo_poll_15:
    v_cmp_eq_u32 vcc, s76, v226
    v_cmp_eq_u32 s[20:21], s76, v227
    s_and_b64 vcc, vcc, s[20:21]
    s_cmp_eq_u64 vcc, exec
    s_cbranch_scc1 L_wo_ready_16
    buffer_load_dwordx2 v[226:227], v228, s[8:11], s39 offen sc1
    s_add_u32 s6, s6, 1
    s_cmp_lt_u32 s6, 1048576
    s_waitcnt vmcnt(0)
    s_cbranch_scc1 L_wo_poll_15
    s_branch L_main_end
L_wo_ready_16:
    v_mfma_f32_16x16x32_bf16 v[56:59], a[144:147], v[40:43], v[56:59]
    ds_read_b128 v[16:19], v6 offset:5120
    v_mfma_f32_16x16x32_bf16 v[60:63], a[144:147], v[44:47], v[60:63]
    ds_read_b128 v[20:23], v6 offset:6144
    v_mfma_f32_16x16x32_bf16 v[64:67], a[144:147], v[48:51], v[64:67]
    ds_read_b128 v[24:27], v6 offset:7168
    v_mfma_f32_16x16x32_bf16 v[68:71], a[144:147], v[52:55], v[68:71]
    ds_read_b128 v[28:31], v6 offset:8192
    v_mfma_f32_16x16x32_bf16 v[72:75], a[148:151], v[36:39], v[72:75]
    ds_read_b128 v[32:35], v6 offset:9216
    v_mfma_f32_16x16x32_bf16 v[76:79], a[148:151], v[40:43], v[76:79]
    buffer_load_dwordx4 a[92:95], v229, s[8:11], s28 offen offset:3072 sc1
    s_add_u32 s28, s28, 4096
    v_mfma_f32_16x16x32_bf16 v[80:83], a[148:151], v[44:47], v[80:83]
    v_mfma_f32_16x16x32_bf16 v[84:87], a[148:151], v[48:51], v[84:87]
    buffer_load_dwordx4 a[96:99], v253, s[8:11], s28 offen offset:0 sc1
    v_mfma_f32_16x16x32_bf16 v[88:91], a[148:151], v[52:55], v[88:91]
    v_mfma_f32_16x16x32_bf16 v[92:95], v[36:39], a[152:155], v[92:95]
    buffer_load_dwordx4 a[100:103], v253, s[8:11], s28 offen offset:1024 sc1
    v_mfma_f32_16x16x32_bf16 v[96:99], v[40:43], a[152:155], v[96:99]
    v_mfma_f32_16x16x32_bf16 v[100:103], v[44:47], a[152:155], v[100:103]
    buffer_load_dwordx4 a[160:163], v253, s[8:11], s32 offen offset:0 sc1
    v_mfma_f32_16x16x32_bf16 v[104:107], v[48:51], a[152:155], v[104:107]
    v_mfma_f32_16x16x32_bf16 v[108:111], v[52:55], a[152:155], v[108:111]
    v_mfma_f32_16x16x32_bf16 v[112:115], a[156:159], v[36:39], v[112:115]
    v_mfma_f32_16x16x32_bf16 v[116:119], a[156:159], v[40:43], v[116:119]
    v_mfma_f32_16x16x32_bf16 v[120:123], a[156:159], v[44:47], v[120:123]
    v_mfma_f32_16x16x32_bf16 v[124:127], a[156:159], v[48:51], v[124:127]
    v_mfma_f32_16x16x32_bf16 v[128:131], a[156:159], v[52:55], v[128:131]
    s_waitcnt vmcnt(34) lgkmcnt(0)
    v_mfma_f32_16x16x32_bf16 v[56:59], a[0:3], v[20:23], v[56:59]
    ds_read_b128 v[36:39], v6 offset:10240
    v_mfma_f32_16x16x32_bf16 v[60:63], a[0:3], v[24:27], v[60:63]
    ds_read_b128 v[40:43], v6 offset:11264
    v_mfma_f32_16x16x32_bf16 v[64:67], a[0:3], v[28:31], v[64:67]
    ds_read_b128 v[44:47], v6 offset:12288
    v_mfma_f32_16x16x32_bf16 v[68:71], a[0:3], v[32:35], v[68:71]
    ds_read_b128 v[48:51], v6 offset:13312
    v_mfma_f32_16x16x32_bf16 v[72:75], a[4:7], v[16:19], v[72:75]
    ds_read_b128 v[52:55], v6 offset:14336
    v_mfma_f32_16x16x32_bf16 v[76:79], a[4:7], v[20:23], v[76:79]
    buffer_load_dwordx4 a[104:107], v253, s[8:11], s28 offen offset:2048 sc1
    v_mfma_f32_16x16x32_bf16 v[80:83], a[4:7], v[24:27], v[80:83]
    v_mfma_f32_16x16x32_bf16 v[84:87], a[4:7], v[28:31], v[84:87]
    buffer_load_dwordx4 a[108:111], v229, s[8:11], s28 offen offset:3072 sc1
    s_add_u32 s28, s28, 4096
    v_mfma_f32_16x16x32_bf16 v[88:91], a[4:7], v[32:35], v[88:91]
    v_mfma_f32_16x16x32_bf16 v[92:95], v[16:19], a[8:11], v[92:95]
    buffer_load_dwordx4 a[112:115], v253, s[8:11], s28 offen offset:0 sc1
    v_mfma_f32_16x16x32_bf16 v[96:99], v[20:23], a[8:11], v[96:99]
    v_mfma_f32_16x16x32_bf16 v[100:103], v[24:27], a[8:11], v[100:103]
    buffer_load_dwordx4 a[164:167], v253, s[8:11], s33 offen offset:0 sc1
    v_mfma_f32_16x16x32_bf16 v[104:107], v[28:31], a[8:11], v[104:107]
    v_mfma_f32_16x16x32_bf16 v[108:111], v[32:35], a[8:11], v[108:111]
    v_mfma_f32_16x16x32_bf16 v[112:115], a[12:15], v[16:19], v[112:115]
    v_mfma_f32_16x16x32_bf16 v[116:119], a[12:15], v[20:23], v[116:119]
    v_mfma_f32_16x16x32_bf16 v[120:123], a[12:15], v[24:27], v[120:123]
    v_mfma_f32_16x16x32_bf16 v[124:127], a[12:15], v[28:31], v[124:127]
    v_mfma_f32_16x16x32_bf16 v[128:131], a[12:15], v[32:35], v[128:131]
    s_waitcnt vmcnt(11) lgkmcnt(0)
    s_barrier
    v_mfma_f32_16x16x32_bf16 v[56:59], a[16:19], v[40:43], v[56:59]
    ds_read_b128 v[16:19], v6 offset:15360
    v_mfma_f32_16x16x32_bf16 v[60:63], a[16:19], v[44:47], v[60:63]
    ds_read_b128 v[20:23], v6 offset:16384
    v_mfma_f32_16x16x32_bf16 v[64:67], a[16:19], v[48:51], v[64:67]
    ds_read_b128 v[24:27], v6 offset:17408
    v_mfma_f32_16x16x32_bf16 v[68:71], a[16:19], v[52:55], v[68:71]
    ds_read_b128 v[28:31], v6 offset:18432
    v_mfma_f32_16x16x32_bf16 v[72:75], a[20:23], v[36:39], v[72:75]
    ds_read_b128 v[32:35], v6 offset:19456
    v_mfma_f32_16x16x32_bf16 v[76:79], a[20:23], v[40:43], v[76:79]
    buffer_load_dwordx4 a[116:119], v253, s[8:11], s28 offen offset:1024 sc1
    v_mfma_f32_16x16x32_bf16 v[80:83], a[20:23], v[44:47], v[80:83]
    v_mfma_f32_16x16x32_bf16 v[84:87], a[20:23], v[48:51], v[84:87]
    buffer_load_dwordx4 a[120:123], v253, s[8:11], s28 offen offset:2048 sc1
    v_mfma_f32_16x16x32_bf16 v[88:91], a[20:23], v[52:55], v[88:91]
    v_mfma_f32_16x16x32_bf16 v[92:95], v[36:39], a[24:27], v[92:95]
    buffer_load_dwordx4 a[124:127], v229, s[8:11], s28 offen offset:3072 sc1
    s_add_u32 s28, s28, 4096
    v_mfma_f32_16x16x32_bf16 v[96:99], v[40:43], a[24:27], v[96:99]
    v_mfma_f32_16x16x32_bf16 v[100:103], v[44:47], a[24:27], v[100:103]
    buffer_load_dwordx4 a[168:171], v5, s[8:11], s34 offen offset:0 sc1
    v_mfma_f32_16x16x32_bf16 v[104:107], v[48:51], a[24:27], v[104:107]
    v_mfma_f32_16x16x32_bf16 v[108:111], v[52:55], a[24:27], v[108:111]
    v_mfma_f32_16x16x32_bf16 v[112:115], a[28:31], v[36:39], v[112:115]
    v_mfma_f32_16x16x32_bf16 v[116:119], a[28:31], v[40:43], v[116:119]
    v_mfma_f32_16x16x32_bf16 v[120:123], a[28:31], v[44:47], v[120:123]
    v_mfma_f32_16x16x32_bf16 v[124:127], a[28:31], v[48:51], v[124:127]
    v_mfma_f32_16x16x32_bf16 v[128:131], a[28:31], v[52:55], v[128:131]
    s_waitcnt vmcnt(30) lgkmcnt(0)
    v_mfma_f32_16x16x32_bf16 v[56:59], a[32:35], v[20:23], v[56:59]
    ds_read_b128 v[36:39], v6 offset:20480
    v_mfma_f32_16x16x32_bf16 v[60:63], a[32:35], v[24:27], v[60:63]
    ds_read_b128 v[40:43], v6 offset:21504
    v_mfma_f32_16x16x32_bf16 v[64:67], a[32:35], v[28:31], v[64:67]
    ds_read_b128 v[44:47], v6 offset:22528
    v_mfma_f32_16x16x32_bf16 v[68:71], a[32:35], v[32:35], v[68:71]
    ds_read_b128 v[48:51], v6 offset:23552
    v_mfma_f32_16x16x32_bf16 v[72:75], a[36:39], v[16:19], v[72:75]
    ds_read_b128 v[52:55], v6 offset:24576
    v_mfma_f32_16x16x32_bf16 v[76:79], a[36:39], v[20:23], v[76:79]
    buffer_load_dwordx4 a[172:175], v253, s[8:11], s32 offen offset:1024 sc1
    v_mfma_f32_16x16x32_bf16 v[80:83], a[36:39], v[24:27], v[80:83]
    v_mfma_f32_16x16x32_bf16 v[84:87], a[36:39], v[28:31], v[84:87]
    buffer_load_dwordx4 a[176:179], v253, s[8:11], s33 offen offset:1024 sc1
    v_mfma_f32_16x16x32_bf16 v[88:91], a[36:39], v[32:35], v[88:91]
    v_mfma_f32_16x16x32_bf16 v[92:95], v[16:19], a[40:43], v[92:95]
    buffer_load_dwordx4 a[180:183], v5, s[8:11], s34 offen offset:1024 sc1
    v_mfma_f32_16x16x32_bf16 v[96:99], v[20:23], a[40:43], v[96:99]
    v_mfma_f32_16x16x32_bf16 v[100:103], v[24:27], a[40:43], v[100:103]
    buffer_load_dwordx4 a[184:187], v253, s[8:11], s32 offen offset:2048 sc1
    v_mfma_f32_16x16x32_bf16 v[104:107], v[28:31], a[40:43], v[104:107]
    v_mfma_f32_16x16x32_bf16 v[108:111], v[32:35], a[40:43], v[108:111]
    v_mfma_f32_16x16x32_bf16 v[112:115], a[44:47], v[16:19], v[112:115]
    v_mfma_f32_16x16x32_bf16 v[116:119], a[44:47], v[20:23], v[116:119]
    v_mfma_f32_16x16x32_bf16 v[120:123], a[44:47], v[24:27], v[120:123]
    v_mfma_f32_16x16x32_bf16 v[124:127], a[44:47], v[28:31], v[124:127]
    v_mfma_f32_16x16x32_bf16 v[128:131], a[44:47], v[32:35], v[128:131]
    s_waitcnt vmcnt(28) lgkmcnt(0)
    v_mfma_f32_16x16x32_bf16 v[56:59], a[48:51], v[40:43], v[56:59]
    ds_read_b128 v[16:19], v6 offset:25600
    v_mfma_f32_16x16x32_bf16 v[60:63], a[48:51], v[44:47], v[60:63]
    ds_read_b128 v[20:23], v6 offset:26624
    v_mfma_f32_16x16x32_bf16 v[64:67], a[48:51], v[48:51], v[64:67]
    ds_read_b128 v[24:27], v6 offset:27648
    v_mfma_f32_16x16x32_bf16 v[68:71], a[48:51], v[52:55], v[68:71]
    ds_read_b128 v[28:31], v6 offset:28672
    v_mfma_f32_16x16x32_bf16 v[72:75], a[52:55], v[36:39], v[72:75]
    ds_read_b128 v[32:35], v6 offset:29696
    v_mfma_f32_16x16x32_bf16 v[76:79], a[52:55], v[40:43], v[76:79]
    buffer_load_dwordx4 a[188:191], v253, s[8:11], s33 offen offset:2048 sc1
    v_mfma_f32_16x16x32_bf16 v[80:83], a[52:55], v[44:47], v[80:83]
    v_mfma_f32_16x16x32_bf16 v[84:87], a[52:55], v[48:51], v[84:87]
    buffer_load_dwordx4 a[192:195], v5, s[8:11], s34 offen offset:2048 sc1
    v_mfma_f32_16x16x32_bf16 v[88:91], a[52:55], v[52:55], v[88:91]
    v_mfma_f32_16x16x32_bf16 v[92:95], v[36:39], a[56:59], v[92:95]
    buffer_load_dwordx4 a[196:199], v253, s[8:11], s32 offen offset:3072 sc1
    s_add_u32 s32, s32, 4096
    v_mfma_f32_16x16x32_bf16 v[96:99], v[40:43], a[56:59], v[96:99]
    v_mfma_f32_16x16x32_bf16 v[100:103], v[44:47], a[56:59], v[100:103]
    buffer_load_dwordx4 a[200:203], v253, s[8:11], s33 offen offset:3072 sc1
    s_add_u32 s33, s33, 4096
    v_mfma_f32_16x16x32_bf16 v[104:107], v[48:51], a[56:59], v[104:107]
    v_mfma_f32_16x16x32_bf16 v[108:111], v[52:55], a[56:59], v[108:111]
    v_mfma_f32_16x16x32_bf16 v[112:115], a[60:63], v[36:39], v[112:115]
    v_mfma_f32_16x16x32_bf16 v[116:119], a[60:63], v[40:43], v[116:119]
    v_mfma_f32_16x16x32_bf16 v[120:123], a[60:63], v[44:47], v[120:123]
    v_mfma_f32_16x16x32_bf16 v[124:127], a[60:63], v[48:51], v[124:127]
    v_mfma_f32_16x16x32_bf16 v[128:131], a[60:63], v[52:55], v[128:131]
    s_waitcnt vmcnt(25) lgkmcnt(0)
    v_mfma_f32_16x16x32_bf16 v[56:59], a[64:67], v[20:23], v[56:59]
    ds_read_b128 v[36:39], v6 offset:30720
    v_mfma_f32_16x16x32_bf16 v[60:63], a[64:67], v[24:27], v[60:63]
    ds_read_b128 v[40:43], v6 offset:31744
    v_mfma_f32_16x16x32_bf16 v[64:67], a[64:67], v[28:31], v[64:67]
    ds_read_b128 v[44:47], v6 offset:32768
    v_mfma_f32_16x16x32_bf16 v[68:71], a[64:67], v[32:35], v[68:71]
    ds_read_b128 v[48:51], v6 offset:33792
    v_mfma_f32_16x16x32_bf16 v[72:75], a[68:71], v[16:19], v[72:75]
    ds_read_b128 v[52:55], v6 offset:34816
    v_mfma_f32_16x16x32_bf16 v[76:79], a[68:71], v[20:23], v[76:79]
    buffer_load_dwordx4 a[204:207], v5, s[8:11], s34 offen offset:3072 sc1
    s_add_u32 s34, s34, 4096
    v_mfma_f32_16x16x32_bf16 v[80:83], a[68:71], v[24:27], v[80:83]
    v_mfma_f32_16x16x32_bf16 v[84:87], a[68:71], v[28:31], v[84:87]
    buffer_load_dwordx4 a[208:211], v253, s[8:11], s32 offen offset:0 sc1
    v_mfma_f32_16x16x32_bf16 v[88:91], a[68:71], v[32:35], v[88:91]
    v_mfma_f32_16x16x32_bf16 v[92:95], v[16:19], a[72:75], v[92:95]
    buffer_load_dwordx4 a[212:215], v253, s[8:11], s33 offen offset:0 sc1
    v_mfma_f32_16x16x32_bf16 v[96:99], v[20:23], a[72:75], v[96:99]
    v_mfma_f32_16x16x32_bf16 v[100:103], v[24:27], a[72:75], v[100:103]
    buffer_load_dwordx4 a[216:219], v5, s[8:11], s34 offen offset:0 sc1
    v_mfma_f32_16x16x32_bf16 v[104:107], v[28:31], a[72:75], v[104:107]
    v_mfma_f32_16x16x32_bf16 v[108:111], v[32:35], a[72:75], v[108:111]
    v_mfma_f32_16x16x32_bf16 v[112:115], a[76:79], v[16:19], v[112:115]
    v_mfma_f32_16x16x32_bf16 v[116:119], a[76:79], v[20:23], v[116:119]
    v_mfma_f32_16x16x32_bf16 v[120:123], a[76:79], v[24:27], v[120:123]
    v_mfma_f32_16x16x32_bf16 v[124:127], a[76:79], v[28:31], v[124:127]
    v_mfma_f32_16x16x32_bf16 v[128:131], a[76:79], v[32:35], v[128:131]
    s_waitcnt vmcnt(23) lgkmcnt(0)
    v_mfma_f32_16x16x32_bf16 v[56:59], a[80:83], v[40:43], v[56:59]
    ds_read_b128 v[16:19], v6 offset:35840
    v_mfma_f32_16x16x32_bf16 v[60:63], a[80:83], v[44:47], v[60:63]
    ds_read_b128 v[20:23], v6 offset:36864
    v_mfma_f32_16x16x32_bf16 v[64:67], a[80:83], v[48:51], v[64:67]
    ds_read_b128 v[24:27], v6 offset:37888
    v_mfma_f32_16x16x32_bf16 v[68:71], a[80:83], v[52:55], v[68:71]
    ds_read_b128 v[28:31], v6 offset:38912
    v_mfma_f32_16x16x32_bf16 v[72:75], a[84:87], v[36:39], v[72:75]
    ds_read_b128 v[32:35], v6 offset:39936
    v_mfma_f32_16x16x32_bf16 v[76:79], a[84:87], v[40:43], v[76:79]
    buffer_load_dwordx4 a[220:223], v253, s[8:11], s32 offen offset:1024 sc1
    v_mfma_f32_16x16x32_bf16 v[80:83], a[84:87], v[44:47], v[80:83]
    v_mfma_f32_16x16x32_bf16 v[84:87], a[84:87], v[48:51], v[84:87]
    buffer_load_dwordx4 a[224:227], v253, s[8:11], s33 offen offset:1024 sc1
    v_mfma_f32_16x16x32_bf16 v[88:91], a[84:87], v[52:55], v[88:91]
    v_mfma_f32_16x16x32_bf16 v[92:95], v[36:39], a[88:91], v[92:95]
    buffer_load_dwordx4 a[228:231], v5, s[8:11], s34 offen offset:1024 sc1
    v_mfma_f32_16x16x32_bf16 v[96:99], v[40:43], a[88:91], v[96:99]
    v_mfma_f32_16x16x32_bf16 v[100:103], v[44:47], a[88:91], v[100:103]
    buffer_load_dwordx4 a[232:235], v253, s[8:11], s32 offen offset:2048 sc1
    v_mfma_f32_16x16x32_bf16 v[104:107], v[48:51], a[88:91], v[104:107]
    v_mfma_f32_16x16x32_bf16 v[108:111], v[52:55], a[88:91], v[108:111]
    v_mfma_f32_16x16x32_bf16 v[112:115], a[92:95], v[36:39], v[112:115]
    v_mfma_f32_16x16x32_bf16 v[116:119], a[92:95], v[40:43], v[116:119]
    v_mfma_f32_16x16x32_bf16 v[120:123], a[92:95], v[44:47], v[120:123]
    v_mfma_f32_16x16x32_bf16 v[124:127], a[92:95], v[48:51], v[124:127]
    v_mfma_f32_16x16x32_bf16 v[128:131], a[92:95], v[52:55], v[128:131]
    s_waitcnt vmcnt(22) lgkmcnt(0)
    v_mfma_f32_16x16x32_bf16 v[56:59], a[96:99], v[20:23], v[56:59]
    ds_read_b128 v[36:39], v6 offset:40960
    v_mfma_f32_16x16x32_bf16 v[60:63], a[96:99], v[24:27], v[60:63]
    ds_read_b128 v[40:43], v6 offset:41984
    v_mfma_f32_16x16x32_bf16 v[64:67], a[96:99], v[28:31], v[64:67]
    ds_read_b128 v[44:47], v6 offset:43008
    v_mfma_f32_16x16x32_bf16 v[68:71], a[96:99], v[32:35], v[68:71]
    ds_read_b128 v[48:51], v6 offset:44032
    v_mfma_f32_16x16x32_bf16 v[72:75], a[100:103], v[16:19], v[72:75]
    ds_read_b128 v[52:55], v6 offset:45056
    v_mfma_f32_16x16x32_bf16 v[76:79], a[100:103], v[20:23], v[76:79]
    buffer_load_dwordx4 a[236:239], v253, s[8:11], s33 offen offset:2048 sc1
    v_mfma_f32_16x16x32_bf16 v[80:83], a[100:103], v[24:27], v[80:83]
    v_mfma_f32_16x16x32_bf16 v[84:87], a[100:103], v[28:31], v[84:87]
    buffer_load_dwordx4 a[240:243], v5, s[8:11], s34 offen offset:2048 sc1
    v_mfma_f32_16x16x32_bf16 v[88:91], a[100:103], v[32:35], v[88:91]
    v_mfma_f32_16x16x32_bf16 v[92:95], v[16:19], a[104:107], v[92:95]
    buffer_load_dwordx4 a[244:247], v253, s[8:11], s32 offen offset:3072 sc1
    s_add_u32 s32, s32, 4096
    v_mfma_f32_16x16x32_bf16 v[96:99], v[20:23], a[104:107], v[96:99]
    v_mfma_f32_16x16x32_bf16 v[100:103], v[24:27], a[104:107], v[100:103]
    buffer_load_dwordx4 a[248:251], v253, s[8:11], s33 offen offset:3072 sc1
    s_add_u32 s33, s33, 4096
    v_mfma_f32_16x16x32_bf16 v[104:107], v[28:31], a[104:107], v[104:107]
    v_mfma_f32_16x16x32_bf16 v[108:111], v[32:35], a[104:107], v[108:111]
    v_mfma_f32_16x16x32_bf16 v[112:115], a[108:111], v[16:19], v[112:115]
    v_mfma_f32_16x16x32_bf16 v[116:119], a[108:111], v[20:23], v[116:119]
    v_mfma_f32_16x16x32_bf16 v[120:123], a[108:111], v[24:27], v[120:123]
    v_mfma_f32_16x16x32_bf16 v[124:127], a[108:111], v[28:31], v[124:127]
    v_mfma_f32_16x16x32_bf16 v[128:131], a[108:111], v[32:35], v[128:131]
    s_waitcnt vmcnt(21) lgkmcnt(0)
    v_mfma_f32_16x16x32_bf16 v[56:59], a[112:115], v[40:43], v[56:59]
    v_mfma_f32_16x16x32_bf16 v[60:63], a[112:115], v[44:47], v[60:63]
    v_mfma_f32_16x16x32_bf16 v[64:67], a[112:115], v[48:51], v[64:67]
    v_mfma_f32_16x16x32_bf16 v[68:71], a[112:115], v[52:55], v[68:71]
    v_mfma_f32_16x16x32_bf16 v[72:75], a[116:119], v[36:39], v[72:75]
    v_mfma_f32_16x16x32_bf16 v[76:79], a[116:119], v[40:43], v[76:79]
    buffer_load_dwordx4 a[252:255], v5, s[8:11], s34 offen offset:3072 sc1
    s_add_u32 s34, s34, 4096
    v_mfma_f32_16x16x32_bf16 v[80:83], a[116:119], v[44:47], v[80:83]
    v_mfma_f32_16x16x32_bf16 v[84:87], a[116:119], v[48:51], v[84:87]
    buffer_load_dwordx4 a[128:131], v253, s[8:11], s32 offen offset:0 sc1
    v_mfma_f32_16x16x32_bf16 v[88:91], a[116:119], v[52:55], v[88:91]
    v_mfma_f32_16x16x32_bf16 v[92:95], v[36:39], a[120:123], v[92:95]
    buffer_load_dwordx4 a[132:135], v253, s[8:11], s33 offen offset:0 sc1
    v_mfma_f32_16x16x32_bf16 v[96:99], v[40:43], a[120:123], v[96:99]
    v_mfma_f32_16x16x32_bf16 v[100:103], v[44:47], a[120:123], v[100:103]
    buffer_load_dwordx4 a[136:139], v5, s[8:11], s34 offen offset:0 sc1
    v_mfma_f32_16x16x32_bf16 v[104:107], v[48:51], a[120:123], v[104:107]
    v_mfma_f32_16x16x32_bf16 v[108:111], v[52:55], a[120:123], v[108:111]
    v_mfma_f32_16x16x32_bf16 v[112:115], a[124:127], v[36:39], v[112:115]
    v_mfma_f32_16x16x32_bf16 v[116:119], a[124:127], v[40:43], v[116:119]
    v_mfma_f32_16x16x32_bf16 v[120:123], a[124:127], v[44:47], v[120:123]
    v_mfma_f32_16x16x32_bf16 v[124:127], a[124:127], v[48:51], v[124:127]
    v_mfma_f32_16x16x32_bf16 v[128:131], a[124:127], v[52:55], v[128:131]
    v_cvt_pk_bf16_f32 v136, v56, v57
    v_cvt_pk_bf16_f32 v137, v58, v59
    v_cvt_pk_bf16_f32 v140, v60, v61
    v_cvt_pk_bf16_f32 v141, v62, v63
    v_cvt_pk_bf16_f32 v144, v64, v65
    v_cvt_pk_bf16_f32 v145, v66, v67
    v_cvt_pk_bf16_f32 v148, v68, v69
    v_cvt_pk_bf16_f32 v149, v70, v71
    v_cvt_pk_bf16_f32 v152, v72, v73
    buffer_load_dwordx4 a[140:143], v253, s[8:11], s32 offen offset:1024 sc1
    v_cvt_pk_bf16_f32 v153, v74, v75
    v_cvt_pk_bf16_f32 v156, v76, v77
    v_cvt_pk_bf16_f32 v157, v78, v79
    v_cvt_pk_bf16_f32 v160, v80, v81
    v_cvt_pk_bf16_f32 v161, v82, v83
    v_cvt_pk_bf16_f32 v164, v84, v85
    v_cvt_pk_bf16_f32 v165, v86, v87
    v_cvt_pk_bf16_f32 v168, v88, v89
    v_cvt_pk_bf16_f32 v169, v90, v91
    buffer_load_dwordx4 a[144:147], v253, s[8:11], s33 offen offset:1024 sc1
    v_cvt_pk_bf16_f32 v134, v112, v113
    v_cvt_pk_bf16_f32 v154, v114, v115
    v_cvt_pk_bf16_f32 v138, v116, v117
    v_cvt_pk_bf16_f32 v158, v118, v119
    v_cvt_pk_bf16_f32 v142, v120, v121
    v_cvt_pk_bf16_f32 v162, v122, v123
    v_cvt_pk_bf16_f32 v146, v124, v125
    v_cvt_pk_bf16_f32 v166, v126, v127
    v_cvt_pk_bf16_f32 v150, v128, v129
    buffer_load_dwordx4 a[148:151], v5, s[8:11], s34 offen offset:1024 sc1
    v_cvt_pk_bf16_f32 v170, v130, v131
    v_cvt_pk_bf16_f32 v172, v92, v93
    v_cvt_pk_bf16_f32 v173, v94, v95
    v_cvt_pk_bf16_f32 v174, v96, v97
    v_cvt_pk_bf16_f32 v175, v98, v99
    v_cvt_pk_bf16_f32 v176, v100, v101
    v_cvt_pk_bf16_f32 v177, v102, v103
    v_cvt_pk_bf16_f32 v178, v104, v105
    v_cvt_pk_bf16_f32 v179, v106, v107
    buffer_load_dwordx4 a[152:155], v253, s[8:11], s32 offen offset:2048 sc1
    v_cvt_pk_bf16_f32 v180, v108, v109
    v_cvt_pk_bf16_f32 v181, v110, v111
    v_mfma_f32_16x16x32_bf16 v[16:19], v[152:155], v[136:139], v[208:211]
    v_mfma_f32_16x16x32_bf16 v[20:23], v[156:159], v[136:139], v[204:207]
    v_mfma_f32_16x16x32_bf16 v[24:27], v[156:159], v[140:143], v[200:203]
    v_mfma_f32_16x16x32_bf16 v[28:31], v[160:163], v[140:143], v[204:207]
    v_mfma_f32_16x16x32_bf16 v[32:35], v[160:163], v[144:147], v[200:203]
    v_mfma_f32_16x16x32_bf16 v[36:39], v[164:167], v[144:147], v[204:207]
    v_mfma_f32_16x16x32_bf16 v[40:43], v[164:167], v[148:151], v[200:203]
    buffer_load_dwordx4 a[156:159], v253, s[8:11], s33 offen offset:2048 sc1
    v_mfma_f32_16x16x32_bf16 v[44:47], v[168:171], v[148:151], v[204:207]
    v_mfma_f32_16x16x32_bf16 v[56:59], v[132:135], v[192:195], v[196:199]
    v_mfma_f32_16x16x32_bf16 v[60:63], v[136:139], v[192:195], v[196:199]
    v_mfma_f32_16x16x32_bf16 v[64:67], v[140:143], v[192:195], v[196:199]
    v_mfma_f32_16x16x32_bf16 v[68:71], v[144:147], v[192:195], v[196:199]
    v_mfma_f32_16x16x32_bf16 v[72:75], v[148:151], v[192:195], v[196:199]
    v_max3_f32 v92, v16, v17, v18
    v_max3_f32 v96, v19, v20, v21
    v_max3_f32 v93, v24, v25, v26
    buffer_load_dwordx4 a[0:3], v5, s[8:11], s34 offen offset:2048 sc1
    v_max3_f32 v97, v27, v28, v29
    v_max3_f32 v94, v32, v33, v34
    v_max3_f32 v98, v35, v36, v37
    v_max3_f32 v95, v40, v41, v42
    v_max3_f32 v99, v43, v44, v45
    v_max3_f32 v92, v92, v22, v23
    v_max3_f32 v93, v93, v30, v31
    v_max3_f32 v94, v94, v38, v39
    v_max3_f32 v95, v95, v46, v47
    buffer_load_dwordx4 a[4:7], v253, s[8:11], s32 offen offset:3072 sc1
    s_add_u32 s32, s32, 4096
    v_max_f32 v92, v92, v96
    v_max_f32 v93, v93, v97
    v_max_f32 v94, v94, v98
    v_max_f32 v95, v95, v99
    s_mov_b32 s18, 0x3eae1a93
    v_cvt_pk_bf16_f32 v182, v56, v57
    v_permlane32_swap_b32 v92, v93
    v_permlane32_swap_b32 v94, v95
    v_max_f32 v92, v92, v93
    buffer_load_dwordx4 a[8:11], v253, s[8:11], s33 offen offset:3072 sc1
    s_add_u32 s33, s33, 4096
    v_max_f32 v94, v94, v95
    v_cvt_pk_bf16_f32 v183, v58, v59
    v_cvt_pk_bf16_f32 v184, v60, v61
    v_permlane16_swap_b32 v92, v94
    v_max_f32 v92, v92, v94
    v_mul_f32 v92, 0xbeae1a93, v92
    v_mov_b32 v94, v92
    v_cvt_pk_bf16_f32 v185, v62, v63
    v_cvt_pk_bf16_f32 v186, v64, v65
    buffer_load_dwordx4 a[12:15], v5, s[8:11], s34 offen offset:3072 sc1
    s_add_u32 s34, s34, 4096
    v_permlane16_swap_b32 v92, v94
    v_mov_b32 v93, v92
    v_mov_b32 v95, v94
    v_cvt_pk_bf16_f32 v187, v66, v67
    v_cvt_pk_bf16_f32 v188, v68, v69
    v_permlane32_swap_b32 v92, v93
    v_permlane32_swap_b32 v94, v95
    v_cvt_pk_bf16_f32 v189, v70, v71
    v_cvt_pk_bf16_f32 v190, v72, v73
    buffer_load_dwordx4 a[16:19], v253, s[8:11], s32 offen offset:0 sc1
    v_cvt_pk_bf16_f32 v191, v74, v75
    v_fma_f32 v16, v16, s18, v92
    v_fma_f32 v17, v17, s18, v92
    v_fma_f32 v18, v18, s18, v92
    v_fma_f32 v19, v19, s18, v92
    v_fma_f32 v20, v20, s18, v92
    v_fma_f32 v21, v21, s18, v92
    v_fma_f32 v22, v22, s18, v92
    v_fma_f32 v23, v23, s18, v92
    buffer_load_dwordx4 a[20:23], v253, s[8:11], s33 offen offset:0 sc1
    v_exp_f32 v16, v16
    v_exp_f32 v17, v17
    v_exp_f32 v18, v18
    v_exp_f32 v19, v19
    v_exp_f32 v20, v20
    v_exp_f32 v21, v21
    v_exp_f32 v22, v22
    v_exp_f32 v23, v23
    s_nop 0
    buffer_load_dwordx4 a[24:27], v5, s[8:11], s34 offen offset:0 sc1
    v_cvt_pk_bf16_f32 v76, v16, v17
    v_cvt_pk_bf16_f32 v77, v18, v19
    v_cvt_pk_bf16_f32 v78, v20, v21
    v_cvt_pk_bf16_f32 v79, v22, v23
    v_fma_f32 v24, v24, s18, v93
    v_fma_f32 v25, v25, s18, v93
    v_fma_f32 v26, v26, s18, v93
    v_fma_f32 v27, v27, s18, v93
    v_fma_f32 v28, v28, s18, v93
    buffer_load_dwordx4 a[28:31], v253, s[8:11], s32 offen offset:1024 sc1
    v_fma_f32 v29, v29, s18, v93
    v_fma_f32 v30, v30, s18, v93
    v_fma_f32 v31, v31, s18, v93
    v_exp_f32 v24, v24
    v_exp_f32 v25, v25
    v_exp_f32 v26, v26
    v_exp_f32 v27, v27
    v_exp_f32 v28, v28
    v_exp_f32 v29, v29
    buffer_load_dwordx4 a[32:35], v253, s[8:11], s33 offen offset:1024 sc1
    v_exp_f32 v30, v30
    v_exp_f32 v31, v31
    v_mfma_f32_16x16x32_bf16 v[100:103], v[172:175], v[76:79], 0
    v_mfma_f32_16x16x32_bf16 v[116:119], v[182:185], v[76:79], 0
    v_cvt_pk_bf16_f32 v80, v24, v25
    v_cvt_pk_bf16_f32 v81, v26, v27
    v_cvt_pk_bf16_f32 v82, v28, v29
    v_cvt_pk_bf16_f32 v83, v30, v31
    v_fma_f32 v32, v32, s18, v94
    buffer_load_dwordx4 a[36:39], v5, s[8:11], s34 offen offset:1024 sc1
    v_fma_f32 v33, v33, s18, v94
    v_fma_f32 v34, v34, s18, v94
    v_fma_f32 v35, v35, s18, v94
    v_fma_f32 v36, v36, s18, v94
    v_fma_f32 v37, v37, s18, v94
    v_fma_f32 v38, v38, s18, v94
    v_fma_f32 v39, v39, s18, v94
    v_exp_f32 v32, v32
    v_exp_f32 v33, v33
    buffer_load_dwordx4 a[40:43], v253, s[8:11], s32 offen offset:2048 sc1
    v_exp_f32 v34, v34
    v_exp_f32 v35, v35
    v_exp_f32 v36, v36
    v_exp_f32 v37, v37
    v_exp_f32 v38, v38
    v_exp_f32 v39, v39
    v_mfma_f32_16x16x32_bf16 v[104:107], v[174:177], v[80:83], 0
    v_mfma_f32_16x16x32_bf16 v[120:123], v[184:187], v[80:83], 0
    v_cvt_pk_bf16_f32 v84, v32, v33
    buffer_load_dwordx4 a[44:47], v253, s[8:11], s33 offen offset:2048 sc1
    v_cvt_pk_bf16_f32 v85, v34, v35
    v_cvt_pk_bf16_f32 v86, v36, v37
    v_cvt_pk_bf16_f32 v87, v38, v39
    v_fma_f32 v40, v40, s18, v95
    v_fma_f32 v41, v41, s18, v95
    v_fma_f32 v42, v42, s18, v95
    v_fma_f32 v43, v43, s18, v95
    v_fma_f32 v44, v44, s18, v95
    v_fma_f32 v45, v45, s18, v95
    buffer_load_dwordx4 a[48:51], v5, s[8:11], s34 offen offset:2048 sc1
    v_fma_f32 v46, v46, s18, v95
    v_fma_f32 v47, v47, s18, v95
    v_exp_f32 v40, v40
    v_exp_f32 v41, v41
    v_exp_f32 v42, v42
    v_exp_f32 v43, v43
    v_exp_f32 v44, v44
    v_exp_f32 v45, v45
    v_exp_f32 v46, v46
    buffer_load_dwordx4 a[52:55], v253, s[8:11], s32 offen offset:3072 sc1
    s_add_u32 s32, s32, 4096
    v_exp_f32 v47, v47
    v_mfma_f32_16x16x32_bf16 v[108:111], v[176:179], v[84:87], 0
    v_mfma_f32_16x16x32_bf16 v[124:127], v[186:189], v[84:87], 0
    v_cvt_pk_bf16_f32 v88, v40, v41
    v_cvt_pk_bf16_f32 v89, v42, v43
    v_cvt_pk_bf16_f32 v90, v44, v45
    v_cvt_pk_bf16_f32 v91, v46, v47
    v_rcp_f32 v96, v118
    v_rcp_f32 v97, v122
    buffer_load_dwordx4 v[240:243], v9, s[8:11], s37 offen offset:0 sc1
    v_mfma_f32_16x16x32_bf16 v[112:115], v[178:181], v[88:91], 0
    v_mfma_f32_16x16x32_bf16 v[128:131], v[188:191], v[88:91], 0
    v_pk_mul_f32 v[100:101], v[96:97], v[100:101] op_sel:[0,0] op_sel_hi:[0,1]
    v_pk_mul_f32 v[102:103], v[96:97], v[102:103] op_sel:[0,0] op_sel_hi:[0,1]
    v_pk_mul_f32 v[116:117], v[96:97], v[116:117] op_sel:[0,0] op_sel_hi:[0,1]
    v_cvt_pk_bf16_f32 v212, v100, v101
    v_cvt_pk_bf16_f32 v213, v102, v103
    v_cvt_pk_bf16_f32 v220, v116, v117
    v_rcp_f32 v98, v126
    buffer_load_dwordx4 v[244:247], v9, s[8:11], s37 offen offset:1024 sc1
    v_pk_mul_f32 v[104:105], v[96:97], v[104:105] op_sel:[1,0] op_sel_hi:[1,1]
    v_pk_mul_f32 v[106:107], v[96:97], v[106:107] op_sel:[1,0] op_sel_hi:[1,1]
    v_pk_mul_f32 v[120:121], v[96:97], v[120:121] op_sel:[1,0] op_sel_hi:[1,1]
    v_cvt_pk_bf16_f32 v214, v104, v105
    v_cvt_pk_bf16_f32 v215, v106, v107
    v_cvt_pk_bf16_f32 v221, v120, v121
    v_rcp_f32 v99, v130
    v_permlane16_swap_b32 v212, v214
    v_permlane16_swap_b32 v213, v215
    buffer_load_dwordx4 v[248:251], v7, s[8:11], s37 offen offset:2048 sc1
    v_pk_mul_f32 v[108:109], v[98:99], v[108:109] op_sel:[0,0] op_sel_hi:[0,1]
    v_pk_mul_f32 v[110:111], v[98:99], v[110:111] op_sel:[0,0] op_sel_hi:[0,1]
    v_pk_mul_f32 v[124:125], v[98:99], v[124:125] op_sel:[0,0] op_sel_hi:[0,1]
    v_cvt_pk_bf16_f32 v216, v108, v109
    v_cvt_pk_bf16_f32 v217, v110, v111
    v_cvt_pk_bf16_f32 v222, v124, v125
    v_pk_mul_f32 v[112:113], v[98:99], v[112:113] op_sel:[1,0] op_sel_hi:[1,1]
    v_pk_mul_f32 v[114:115], v[98:99], v[114:115] op_sel:[1,0] op_sel_hi:[1,1]
    v_pk_mul_f32 v[128:129], v[98:99], v[128:129] op_sel:[1,0] op_sel_hi:[1,1]
    buffer_load_dword v252, v8, s[8:11], s47 offen sc1
    v_cvt_pk_bf16_f32 v218, v112, v113
    v_cvt_pk_bf16_f32 v219, v114, v115
    v_cvt_pk_bf16_f32 v223, v128, v129
    s_lshl_b32 s7, s3, 2
    s_add_u32 s7, s7, 94208
    v_permlane16_swap_b32 v220, v221
    v_permlane16_swap_b32 v222, v223
    v_add_u32 v11, s7, v253
    v_lshrrev_b32 v10, 3, v0
    v_permlane32_swap_b32 v220, v222
    v_mul_u32_u24 v10, 9216, v10
    ds_write_b32 v11, v220
    v_permlane16_swap_b32 v216, v218
    v_permlane16_swap_b32 v217, v219
    s_mul_i32 s7, s40, 1152
    s_add_u32 s22, s22, s7
    s_add_u32 s22, s22, 41156608
    s_lshl_b32 s7, s3, 8
    s_add_u32 s23, s22, s7
    s_add_u32 s24, s23, 36864
    buffer_store_dwordx4 v[212:215], v9, s[8:11], s23 offen sc1
    buffer_store_dwordx4 v[216:219], v9, s[8:11], s24 offen sc1
    v_and_b32 v11, 7, v0
    v_lshl_add_u32 v10, v11, 4, v10
    s_cmp_eq_u32 s3, 3
    s_cselect_b32 s7, 0, 1073741824
    v_add_u32 v10, s7, v10
    v_add_u32 v11, 94208, v253
    s_waitcnt lgkmcnt(0)
    s_barrier
    ds_read_b128 v[220:223], v11
    s_waitcnt lgkmcnt(0)
    buffer_store_dwordx4 v[220:223], v10, s[8:11], s22 offen offset:1024 sc1
    v_lshlrev_b32 v15, 7, v0
    s_lshl_b32 s6, s40, 2
    s_add_u32 s6, s6, s44
    v_mov_b32 v1, s76
    s_mov_b64 vcc, 0xff
    s_waitcnt vmcnt(0)
    s_barrier
    s_cmp_lg_u32 s3, 0
    s_cbranch_scc1 L_pub_17
    s_mov_b64 exec, vcc
    buffer_store_dword v1, v15, s[8:11], s6 offen sc1
L_pub_17:
    s_mov_b64 exec, -1
    buffer_load_dwordx4 a[56:59], v253, s[8:11], s33 offen offset:3072 sc1
    s_add_u32 s33, s33, 4096
    buffer_load_dwordx4 a[60:63], v5, s[8:11], s34 offen offset:3072 sc1
    s_add_u32 s34, s34, 4096
    buffer_load_dwordx4 a[64:67], v253, s[8:11], s32 offen offset:0 sc1
    buffer_load_dwordx4 a[68:71], v253, s[8:11], s33 offen offset:0 sc1
    buffer_load_dwordx4 a[72:75], v5, s[8:11], s34 offen offset:0 sc1
    buffer_load_dwordx4 a[76:79], v253, s[8:11], s32 offen offset:1024 sc1
    buffer_load_dwordx4 a[80:83], v253, s[8:11], s33 offen offset:1024 sc1
    buffer_load_dwordx4 a[84:87], v5, s[8:11], s34 offen offset:1024 sc1
    s_cmp_lg_u32 s42, 0
    s_cbranch_scc1 L_swz_18
    s_cmp_eq_u32 s93, 2
    s_cselect_b32 s6, 2, 3
    s_mov_b32 s7, 512
    s_cmov_b32 s7, 2048
    v_lshrrev_b32 v14, 4, v0
    v_lshlrev_b32 v14, s6, v14
    v_bfe_u32 v15, v0, 2, 2
    v_add_u32 v14, v14, v15
    v_mul_u32_u24 v14, 128, v14
    v_and_b32 v15, 3, v0
    v_lshl_add_u32 v14, v15, 3, v14
    v_add_u32 v14, s79, v14
    v_add_u32 v15, s7, v14
    ds_read_b64_tr_b16 v[76:77], v14 offset:0
    ds_read_b64_tr_b16 v[78:79], v15 offset:0
    ds_read_b64_tr_b16 v[80:81], v14 offset:32
    ds_read_b64_tr_b16 v[82:83], v15 offset:32
    ds_read_b64_tr_b16 v[84:85], v14 offset:64
    ds_read_b64_tr_b16 v[86:87], v15 offset:64
    ds_read_b64_tr_b16 v[88:89], v14 offset:96
    ds_read_b64_tr_b16 v[90:91], v15 offset:96
    ds_read_b64_tr_b16 v[92:93], v14 offset:4096
    ds_read_b64_tr_b16 v[94:95], v15 offset:4096
    ds_read_b64_tr_b16 v[96:97], v14 offset:4128
    ds_read_b64_tr_b16 v[98:99], v15 offset:4128
    ds_read_b64_tr_b16 v[176:177], v14 offset:4160
    ds_read_b64_tr_b16 v[178:179], v15 offset:4160
    ds_read_b64_tr_b16 v[180:181], v14 offset:4192
    ds_read_b64_tr_b16 v[182:183], v15 offset:4192
    ds_read_b64_tr_b16 v[196:197], v14 offset:8192
    ds_read_b64_tr_b16 v[198:199], v15 offset:8192
    ds_read_b64_tr_b16 v[200:201], v14 offset:8224
    ds_read_b64_tr_b16 v[202:203], v15 offset:8224
    ds_read_b64_tr_b16 v[204:205], v14 offset:8256
    ds_read_b64_tr_b16 v[206:207], v15 offset:8256
    ds_read_b64_tr_b16 v[208:209], v14 offset:8288
    ds_read_b64_tr_b16 v[210:211], v15 offset:8288
    ds_read_b64_tr_b16 v[212:213], v14 offset:12288
    ds_read_b64_tr_b16 v[214:215], v15 offset:12288
    ds_read_b64_tr_b16 v[216:217], v14 offset:12320
    ds_read_b64_tr_b16 v[218:219], v15 offset:12320
    ds_read_b64_tr_b16 v[220:221], v14 offset:12352
    ds_read_b64_tr_b16 v[222:223], v15 offset:12352
    ds_read_b64_tr_b16 v[228:229], v14 offset:12384
    ds_read_b64_tr_b16 v[230:231], v15 offset:12384
    s_mul_i32 s68, s40, 1990656
    s_add_u32 s68, s68, 3145728
    s_cmp_eq_u32 s93, 2
    s_cbranch_scc1 L_swz_down_19
    s_mul_i32 s6, s84, 349526
    s_lshr_b32 s6, s6, 20
    s_mul_i32 s7, s6, 3
    s_sub_u32 s7, s84, s7
    s_mul_i32 s6, s6, 6
    s_add_u32 s7, s7, s6
    s_mul_i32 s6, s88, 36
    s_add_u32 s7, s7, s6
    s_mul_i32 s6, s93, 3
    s_add_u32 s7, s7, s6
    s_lshl_b32 s7, s7, 10
    s_add_u32 s7, s7, s68
    s_add_u32 s80, s7, 0
    s_add_u32 s81, s7, 497664
    s_add_u32 s82, s7, 995328
    s_add_u32 s83, s7, 1492992
    s_mul_i32 s6, s85, 349526
    s_lshr_b32 s6, s6, 20
    s_mul_i32 s7, s6, 3
    s_sub_u32 s7, s85, s7
    s_mul_i32 s6, s6, 6
    s_add_u32 s7, s7, s6
    s_mul_i32 s6, s89, 36
    s_add_u32 s7, s7, s6
    s_mul_i32 s6, s93, 3
    s_add_u32 s7, s7, s6
    s_lshl_b32 s7, s7, 10
    s_add_u32 s7, s7, s68
    s_add_u32 s64, s7, 0
    s_add_u32 s65, s7, 497664
    s_add_u32 s18, s7, 995328
    s_add_u32 s19, s7, 1492992
    s_mul_i32 s6, s86, 349526
    s_lshr_b32 s6, s6, 20
    s_mul_i32 s7, s6, 3
    s_sub_u32 s7, s86, s7
    s_mul_i32 s6, s6, 6
    s_add_u32 s7, s7, s6
    s_mul_i32 s6, s90, 36
    s_add_u32 s7, s7, s6
    s_mul_i32 s6, s93, 3
    s_add_u32 s7, s7, s6
    s_lshl_b32 s7, s7, 10
    s_add_u32 s7, s7, s68
    s_add_u32 s20, s7, 0
    s_add_u32 s21, s7, 497664
    s_add_u32 s22, s7, 995328
    s_add_u32 s25, s7, 1492992
    s_mul_i32 s6, s87, 349526
    s_lshr_b32 s6, s6, 20
    s_mul_i32 s7, s6, 3
    s_sub_u32 s7, s87, s7
    s_mul_i32 s6, s6, 6
    s_add_u32 s7, s7, s6
    s_mul_i32 s6, s91, 36
    s_add_u32 s7, s7, s6
    s_mul_i32 s6, s93, 3
    s_add_u32 s7, s7, s6
    s_lshl_b32 s7, s7, 10
    s_add_u32 s7, s7, s68
    s_add_u32 s26, s7, 0
    s_add_u32 s27, s7, 497664
    s_add_u32 s28, s7, 995328
    s_add_u32 s29, s7, 1492992
    s_branch L_swz_dest_20
L_swz_down_19:
    s_mul_i32 s7, s88, 18
    s_add_u32 s7, s7, s84
    s_add_u32 s7, s7, 324
    s_lshl_b32 s7, s7, 10
    s_add_u32 s7, s7, s68
    s_add_u32 s80, s7, 0
    s_add_u32 s81, s7, 497664
    s_add_u32 s82, s7, 995328
    s_add_u32 s83, s7, 1492992
    s_mul_i32 s7, s89, 18
    s_add_u32 s7, s7, s85
    s_add_u32 s7, s7, 324
    s_lshl_b32 s7, s7, 10
    s_add_u32 s7, s7, s68
    s_add_u32 s64, s7, 0
    s_add_u32 s65, s7, 497664
    s_add_u32 s18, s7, 995328
    s_add_u32 s19, s7, 1492992
    s_mul_i32 s7, s90, 18
    s_add_u32 s7, s7, s86
    s_add_u32 s7, s7, 324
    s_lshl_b32 s7, s7, 10
    s_add_u32 s7, s7, s68
    s_add_u32 s20, s7, 0
    s_add_u32 s21, s7, 497664
    s_add_u32 s22, s7, 995328
    s_add_u32 s25, s7, 1492992
    s_mul_i32 s7, s91, 18
    s_add_u32 s7, s7, s87
    s_add_u32 s7, s7, 324
    s_lshl_b32 s7, s7, 10
    s_add_u32 s7, s7, s68
    s_add_u32 s26, s7, 0
    s_add_u32 s27, s7, 497664
    s_add_u32 s28, s7, 995328
    s_add_u32 s29, s7, 1492992
L_swz_dest_20:
    s_mov_b32 s72, s8
    s_mov_b32 s73, s9
    s_mov_b32 s74, 268435456
    s_waitcnt lgkmcnt(0)
    buffer_store_dwordx4 v[76:79], v253, s[72:75], s80 offen sc1
    buffer_store_dwordx4 v[80:83], v253, s[72:75], s81 offen sc1
    buffer_store_dwordx4 v[84:87], v253, s[72:75], s82 offen sc1
    buffer_store_dwordx4 v[88:91], v253, s[72:75], s83 offen sc1
    buffer_store_dwordx4 v[92:95], v253, s[72:75], s64 offen sc1
    buffer_store_dwordx4 v[96:99], v253, s[72:75], s65 offen sc1
    buffer_store_dwordx4 v[176:179], v253, s[72:75], s18 offen sc1
    buffer_store_dwordx4 v[180:183], v253, s[72:75], s19 offen sc1
    buffer_store_dwordx4 v[196:199], v253, s[72:75], s20 offen sc1
    buffer_store_dwordx4 v[200:203], v253, s[72:75], s21 offen sc1
    buffer_store_dwordx4 v[204:207], v253, s[72:75], s22 offen sc1
    buffer_store_dwordx4 v[208:211], v253, s[72:75], s25 offen sc1
    buffer_store_dwordx4 v[212:215], v253, s[72:75], s26 offen sc1
    buffer_store_dwordx4 v[216:219], v253, s[72:75], s27 offen sc1
    buffer_store_dwordx4 v[220:223], v253, s[72:75], s28 offen sc1
    buffer_store_dwordx4 v[228:231], v253, s[72:75], s29 offen sc1
    s_lshr_b32 s7, s2, 3
    s_lshl_b32 s7, s7, 2
    s_add_u32 s7, s7, s3
    s_lshl_b32 s7, s7, 9
    v_lshrrev_b32 v1, 1, v253
    v_add_u32 v1, s7, v1
    buffer_load_dwordx2 v[14:15], v1, s[96:99], 0 offen
L_swz_18:
    s_and_b32 s7, s3, 1
    s_mul_i32 s7, s7, 18432
    s_add_u32 s24, s30, s7
    s_lshr_b32 s7, s3, 1
    s_lshl_b32 s7, s7, 9
    s_add_u32 s24, s24, s7
    s_add_u32 s24, s24, 41156608
    s_mov_b32 s16, 0xffff0000
    v_lshlrev_b32 v124, 16, v240
    v_and_b32 v125, s16, v240
    v_lshlrev_b32 v126, 16, v241
    v_and_b32 v127, s16, v241
    v_lshlrev_b32 v128, 16, v242
    v_and_b32 v129, s16, v242
    v_lshlrev_b32 v130, 16, v243
    v_and_b32 v131, s16, v243
    v_lshlrev_b32 v132, 16, v244
    v_and_b32 v133, s16, v244
    v_lshlrev_b32 v134, 16, v245
    v_and_b32 v135, s16, v245
    v_lshlrev_b32 v136, 16, v246
    v_and_b32 v137, s16, v246
    v_lshlrev_b32 v138, 16, v247
    v_and_b32 v139, s16, v247
    v_lshlrev_b32 v140, 16, v248
    v_and_b32 v141, s16, v248
    v_lshlrev_b32 v142, 16, v249
    v_and_b32 v143, s16, v249
    v_lshlrev_b32 v144, 16, v250
    v_and_b32 v145, s16, v250
    v_lshlrev_b32 v146, 16, v251
    v_and_b32 v147, s16, v251
    s_cmp_eq_u32 s3, 1
    s_cselect_b32 s7, 16, 0
    v_lshlrev_b32 v12, 2, v0
    v_cmp_gt_u32 vcc, s7, v0
    v_add_u32 v10, 40960, v12
    v_add_u32 v11, 41472, v12
    v_cndmask_b32 v10, v11, v10, vcc
    v_and_b32 v11, 0x7c, v12
    v_cmp_gt_u32 vcc, 32, v0
    v_mov_b32 v13, 1073741824
    s_and_b32 s7, s40, 3
    s_lshl_b32 s45, s45, 2
    v_cndmask_b32 v8, v13, v12, vcc
    s_add_u32 s6, s7, s3
    s_cmp_eq_u32 s6, 0
    s_cselect_b32 s6, 0, 1073741824
    v_add_u32 v6, s6, v8
    s_add_u32 s45, s45, s7
    s_lshl_b32 s45, s45, 2
    s_add_u32 s45, s45, s3
    s_lshl_b32 s45, s45, 7
    s_add_u32 s45, s45, s43
    s_add_u32 s45, s45, 48300032
    s_cmp_eq_u32 s3, 0
    s_cselect_b32 s35, 1.0, 0
    s_lshl_b32 s7, s40, 2
    s_add_u32 s7, s7, s3
    s_mul_i32 s23, s7, 497664
    s_add_u32 s23, s23, 3145728
    s_add_u32 s50, s23, 497664
    s_mul_i32 s50, s50, s42
    v_mov_b32 v184, v253
    v_add_u32 v185, 4096, v253
    v_add_u32 v186, 8192, v253
    v_add_u32 v187, 12288, v253
    v_add_u32 v188, 16384, v253
    v_add_u32 v189, 20480, v253
    v_add_u32 v190, 24576, v253
    v_add_u32 v191, 28672, v253
    v_add_u32 v192, 32768, v253
    s_cmp_lg_u32 s3, 3
    s_cbranch_scc1 L_pollout_23
    s_lshl_b32 s7, s40, 7
    s_add_u32 s7, s7, s44
    s_add_u32 s52, s4, s7
    s_addc_u32 s53, s5, 0
    s_mov_b32 s6, 0
L_poll_21:
    s_load_dwordx8 s[56:63], s[52:53], 0 glc
    s_add_u32 s6, s6, 1
    s_waitcnt lgkmcnt(0)
    s_xor_b64 s[56:57], s[56:57], s[76:77]
    s_xor_b64 s[58:59], s[58:59], s[76:77]
    s_xor_b64 s[60:61], s[60:61], s[76:77]
    s_xor_b64 s[62:63], s[62:63], s[76:77]
    s_or_b64 s[56:57], s[56:57], s[58:59]
    s_or_b64 s[60:61], s[60:61], s[62:63]
    s_or_b64 s[56:57], s[56:57], s[60:61]
    s_cbranch_scc0 L_polled_22
    s_cmp_lt_u32 s6, 1048576
    s_cbranch_scc1 L_poll_21
    s_branch L_main_end
L_polled_22:
L_pollout_23:
    s_barrier
    s_lshl_b32 m0, s3, 10
    s_nop 0
    buffer_load_dwordx4 v2, s[8:11], s24 offen sc1 lds
    s_add_u32 m0, m0, 4096
    s_add_u32 s24, s24, 1024
    buffer_load_dwordx4 v2, s[8:11], s24 offen sc1 lds
    s_add_u32 m0, m0, 4096
    s_add_u32 s24, s24, 1024
    buffer_load_dwordx4 v2, s[8:11], s24 offen sc1 lds
    s_add_u32 m0, m0, 4096
    s_add_u32 s24, s24, 1024
    buffer_load_dwordx4 v2, s[8:11], s24 offen sc1 lds
    s_add_u32 m0, m0, 4096
    s_add_u32 s24, s24, 1024
    buffer_load_dwordx4 v2, s[8:11], s24 offen sc1 lds
    s_add_u32 m0, m0, 4096
    s_add_u32 s24, s24, 1024
    buffer_load_dwordx4 v2, s[8:11], s24 offen sc1 lds
    s_add_u32 m0, m0, 4096
    s_add_u32 s24, s24, 1024
    buffer_load_dwordx4 v2, s[8:11], s24 offen sc1 lds
    s_add_u32 m0, m0, 4096
    s_add_u32 s24, s24, 1024
    buffer_load_dwordx4 v2, s[8:11], s24 offen sc1 lds
    s_add_u32 m0, m0, 4096
    s_add_u32 s24, s24, 1024
    buffer_load_dwordx4 v2, s[8:11], s24 offen sc1 lds
    s_waitcnt vmcnt(4)
    s_barrier
    ds_read_b128 v[160:163], v253 offset:0
    ds_read_b128 v[164:167], v253 offset:1024
    s_waitcnt lgkmcnt(0)
    v_mfma_f32_16x16x32_bf16 v[100:103], a[160:163], v[160:163], 0
    ds_read_b128 v[168:171], v253 offset:2048
    v_mfma_f32_16x16x32_bf16 v[104:107], a[160:163], v[164:167], 0
    ds_read_b128 v[172:175], v253 offset:3072
    v_mfma_f32_16x16x32_bf16 v[108:111], a[164:167], v[160:163], 0
    v_mfma_f32_16x16x32_bf16 v[112:115], a[164:167], v[164:167], 0
    buffer_load_dwordx4 v[16:19], v184, s[48:51], s23 offen offset:0 sc1
    v_mfma_f32_16x16x32_bf16 v[116:119], a[168:171], v[160:163], 0
    v_mfma_f32_16x16x32_bf16 v[120:123], a[168:171], v[164:167], 0
    s_waitcnt lgkmcnt(0)
    v_mfma_f32_16x16x32_bf16 v[100:103], a[172:175], v[168:171], v[100:103]
    ds_read_b128 v[160:163], v253 offset:4096
    v_mfma_f32_16x16x32_bf16 v[104:107], a[172:175], v[172:175], v[104:107]
    ds_read_b128 v[164:167], v253 offset:5120
    v_mfma_f32_16x16x32_bf16 v[108:111], a[176:179], v[168:171], v[108:111]
    v_mfma_f32_16x16x32_bf16 v[112:115], a[176:179], v[172:175], v[112:115]
    buffer_load_dwordx4 v[20:23], v184, s[48:51], s23 offen offset:1024 sc1
    v_mfma_f32_16x16x32_bf16 v[116:119], a[180:183], v[168:171], v[116:119]
    v_mfma_f32_16x16x32_bf16 v[120:123], a[180:183], v[172:175], v[120:123]
    s_waitcnt lgkmcnt(0)
    v_mfma_f32_16x16x32_bf16 v[100:103], a[184:187], v[160:163], v[100:103]
    ds_read_b128 v[168:171], v253 offset:6144
    v_mfma_f32_16x16x32_bf16 v[104:107], a[184:187], v[164:167], v[104:107]
    ds_read_b128 v[172:175], v253 offset:7168
    v_mfma_f32_16x16x32_bf16 v[108:111], a[188:191], v[160:163], v[108:111]
    v_mfma_f32_16x16x32_bf16 v[112:115], a[188:191], v[164:167], v[112:115]
    buffer_load_dwordx4 v[24:27], v184, s[48:51], s23 offen offset:2048 sc1
    v_mfma_f32_16x16x32_bf16 v[116:119], a[192:195], v[160:163], v[116:119]
    v_mfma_f32_16x16x32_bf16 v[120:123], a[192:195], v[164:167], v[120:123]
    s_waitcnt lgkmcnt(0)
    v_mfma_f32_16x16x32_bf16 v[100:103], a[196:199], v[168:171], v[100:103]
    ds_read_b128 v[160:163], v253 offset:8192
    v_mfma_f32_16x16x32_bf16 v[104:107], a[196:199], v[172:175], v[104:107]
    ds_read_b128 v[164:167], v253 offset:9216
    v_mfma_f32_16x16x32_bf16 v[108:111], a[200:203], v[168:171], v[108:111]
    v_mfma_f32_16x16x32_bf16 v[112:115], a[200:203], v[172:175], v[112:115]
    buffer_load_dwordx4 v[28:31], v184, s[48:51], s23 offen offset:3072 sc1
    v_mfma_f32_16x16x32_bf16 v[116:119], a[204:207], v[168:171], v[116:119]
    v_mfma_f32_16x16x32_bf16 v[120:123], a[204:207], v[172:175], v[120:123]
    s_waitcnt lgkmcnt(0)
    v_mfma_f32_16x16x32_bf16 v[100:103], a[208:211], v[160:163], v[100:103]
    ds_read_b128 v[168:171], v253 offset:10240
    v_mfma_f32_16x16x32_bf16 v[104:107], a[208:211], v[164:167], v[104:107]
    ds_read_b128 v[172:175], v253 offset:11264
    v_mfma_f32_16x16x32_bf16 v[108:111], a[212:215], v[160:163], v[108:111]
    v_mfma_f32_16x16x32_bf16 v[112:115], a[212:215], v[164:167], v[112:115]
    buffer_load_dwordx4 v[32:35], v185, s[48:51], s23 offen offset:0 sc1
    v_mfma_f32_16x16x32_bf16 v[116:119], a[216:219], v[160:163], v[116:119]
    v_mfma_f32_16x16x32_bf16 v[120:123], a[216:219], v[164:167], v[120:123]
    s_waitcnt lgkmcnt(0)
    v_mfma_f32_16x16x32_bf16 v[100:103], a[220:223], v[168:171], v[100:103]
    ds_read_b128 v[160:163], v253 offset:12288
    v_mfma_f32_16x16x32_bf16 v[104:107], a[220:223], v[172:175], v[104:107]
    ds_read_b128 v[164:167], v253 offset:13312
    v_mfma_f32_16x16x32_bf16 v[108:111], a[224:227], v[168:171], v[108:111]
    v_mfma_f32_16x16x32_bf16 v[112:115], a[224:227], v[172:175], v[112:115]
    buffer_load_dwordx4 v[36:39], v185, s[48:51], s23 offen offset:1024 sc1
    v_mfma_f32_16x16x32_bf16 v[116:119], a[228:231], v[168:171], v[116:119]
    v_mfma_f32_16x16x32_bf16 v[120:123], a[228:231], v[172:175], v[120:123]
    s_waitcnt lgkmcnt(0)
    v_mfma_f32_16x16x32_bf16 v[100:103], a[232:235], v[160:163], v[100:103]
    ds_read_b128 v[168:171], v253 offset:14336
    v_mfma_f32_16x16x32_bf16 v[104:107], a[232:235], v[164:167], v[104:107]
    ds_read_b128 v[172:175], v253 offset:15360
    v_mfma_f32_16x16x32_bf16 v[108:111], a[236:239], v[160:163], v[108:111]
    v_mfma_f32_16x16x32_bf16 v[112:115], a[236:239], v[164:167], v[112:115]
    buffer_load_dwordx4 v[40:43], v185, s[48:51], s23 offen offset:2048 sc1
    v_mfma_f32_16x16x32_bf16 v[116:119], a[240:243], v[160:163], v[116:119]
    v_mfma_f32_16x16x32_bf16 v[120:123], a[240:243], v[164:167], v[120:123]
    s_waitcnt lgkmcnt(0)
    v_mfma_f32_16x16x32_bf16 v[100:103], a[244:247], v[168:171], v[100:103]
    ds_read_b128 v[160:163], v253 offset:16384
    v_mfma_f32_16x16x32_bf16 v[104:107], a[244:247], v[172:175], v[104:107]
    ds_read_b128 v[164:167], v253 offset:17408
    v_mfma_f32_16x16x32_bf16 v[108:111], a[248:251], v[168:171], v[108:111]
    v_mfma_f32_16x16x32_bf16 v[112:115], a[248:251], v[172:175], v[112:115]
    buffer_load_dwordx4 v[44:47], v185, s[48:51], s23 offen offset:3072 sc1
    v_mfma_f32_16x16x32_bf16 v[116:119], a[252:255], v[168:171], v[116:119]
    v_mfma_f32_16x16x32_bf16 v[120:123], a[252:255], v[172:175], v[120:123]
    s_waitcnt lgkmcnt(0)
    v_mfma_f32_16x16x32_bf16 v[100:103], a[128:131], v[160:163], v[100:103]
    ds_read_b128 v[168:171], v253 offset:18432
    v_mfma_f32_16x16x32_bf16 v[104:107], a[128:131], v[164:167], v[104:107]
    ds_read_b128 v[172:175], v253 offset:19456
    v_mfma_f32_16x16x32_bf16 v[108:111], a[132:135], v[160:163], v[108:111]
    v_mfma_f32_16x16x32_bf16 v[112:115], a[132:135], v[164:167], v[112:115]
    buffer_load_dwordx4 v[48:51], v186, s[48:51], s23 offen offset:0 sc1
    v_mfma_f32_16x16x32_bf16 v[116:119], a[136:139], v[160:163], v[116:119]
    v_mfma_f32_16x16x32_bf16 v[120:123], a[136:139], v[164:167], v[120:123]
    s_waitcnt vmcnt(9) lgkmcnt(0)
    s_barrier
    s_xor_b32 s7, s3, 0
    s_or_b32 s7, s7, s42
    s_cbranch_scc1 L_swz_24
    s_lshl_b32 s6, s40, 7
    s_lshl_b32 s7, s41, 2
    s_add_u32 s6, s6, s7
    s_add_u32 s6, s6, 19464192
    s_mov_b64 exec, 0xffffffff
    v_lshlrev_b32 v15, 10, v0
    v_mov_b32 v1, s76
    buffer_store_dword v1, v15, s[8:11], s6 offen sc1
    s_mov_b64 exec, -1
L_swz_24:
    v_mfma_f32_16x16x32_bf16 v[100:103], a[140:143], v[168:171], v[100:103]
    ds_read_b128 v[160:163], v253 offset:20480
    v_mfma_f32_16x16x32_bf16 v[104:107], a[140:143], v[172:175], v[104:107]
    ds_read_b128 v[164:167], v253 offset:21504
    v_mfma_f32_16x16x32_bf16 v[108:111], a[144:147], v[168:171], v[108:111]
    v_mfma_f32_16x16x32_bf16 v[112:115], a[144:147], v[172:175], v[112:115]
    buffer_load_dwordx4 v[52:55], v186, s[48:51], s23 offen offset:1024 sc1
    v_mfma_f32_16x16x32_bf16 v[116:119], a[148:151], v[168:171], v[116:119]
    v_mfma_f32_16x16x32_bf16 v[120:123], a[148:151], v[172:175], v[120:123]
    s_waitcnt lgkmcnt(0)
    v_mfma_f32_16x16x32_bf16 v[100:103], a[152:155], v[160:163], v[100:103]
    ds_read_b128 v[168:171], v253 offset:22528
    v_mfma_f32_16x16x32_bf16 v[104:107], a[152:155], v[164:167], v[104:107]
    ds_read_b128 v[172:175], v253 offset:23552
    v_mfma_f32_16x16x32_bf16 v[108:111], a[156:159], v[160:163], v[108:111]
    v_mfma_f32_16x16x32_bf16 v[112:115], a[156:159], v[164:167], v[112:115]
    buffer_load_dwordx4 v[56:59], v186, s[48:51], s23 offen offset:2048 sc1
    v_mfma_f32_16x16x32_bf16 v[116:119], a[0:3], v[160:163], v[116:119]
    v_mfma_f32_16x16x32_bf16 v[120:123], a[0:3], v[164:167], v[120:123]
    s_waitcnt lgkmcnt(0)
    v_mfma_f32_16x16x32_bf16 v[100:103], a[4:7], v[168:171], v[100:103]
    ds_read_b128 v[160:163], v253 offset:24576
    v_mfma_f32_16x16x32_bf16 v[104:107], a[4:7], v[172:175], v[104:107]
    ds_read_b128 v[164:167], v253 offset:25600
    v_mfma_f32_16x16x32_bf16 v[108:111], a[8:11], v[168:171], v[108:111]
    v_mfma_f32_16x16x32_bf16 v[112:115], a[8:11], v[172:175], v[112:115]
    buffer_load_dwordx4 v[60:63], v186, s[48:51], s23 offen offset:3072 sc1
    v_mfma_f32_16x16x32_bf16 v[116:119], a[12:15], v[168:171], v[116:119]
    v_mfma_f32_16x16x32_bf16 v[120:123], a[12:15], v[172:175], v[120:123]
    s_waitcnt lgkmcnt(0)
    v_mfma_f32_16x16x32_bf16 v[100:103], a[16:19], v[160:163], v[100:103]
    ds_read_b128 v[168:171], v253 offset:26624
    v_mfma_f32_16x16x32_bf16 v[104:107], a[16:19], v[164:167], v[104:107]
    ds_read_b128 v[172:175], v253 offset:27648
    v_mfma_f32_16x16x32_bf16 v[108:111], a[20:23], v[160:163], v[108:111]
    v_mfma_f32_16x16x32_bf16 v[112:115], a[20:23], v[164:167], v[112:115]
    buffer_load_dwordx4 v[64:67], v187, s[48:51], s23 offen offset:0 sc1
    v_mfma_f32_16x16x32_bf16 v[116:119], a[24:27], v[160:163], v[116:119]
    v_mfma_f32_16x16x32_bf16 v[120:123], a[24:27], v[164:167], v[120:123]
    s_waitcnt lgkmcnt(0)
    v_mfma_f32_16x16x32_bf16 v[100:103], a[28:31], v[168:171], v[100:103]
    ds_read_b128 v[160:163], v253 offset:28672
    v_mfma_f32_16x16x32_bf16 v[104:107], a[28:31], v[172:175], v[104:107]
    ds_read_b128 v[164:167], v253 offset:29696
    v_mfma_f32_16x16x32_bf16 v[108:111], a[32:35], v[168:171], v[108:111]
    v_mfma_f32_16x16x32_bf16 v[112:115], a[32:35], v[172:175], v[112:115]
    buffer_load_dwordx4 v[68:71], v187, s[48:51], s23 offen offset:1024 sc1
    v_mfma_f32_16x16x32_bf16 v[116:119], a[36:39], v[168:171], v[116:119]
    v_mfma_f32_16x16x32_bf16 v[120:123], a[36:39], v[172:175], v[120:123]
    s_waitcnt lgkmcnt(0)
    v_mfma_f32_16x16x32_bf16 v[100:103], a[40:43], v[160:163], v[100:103]
    ds_read_b128 v[168:171], v253 offset:30720
    v_mfma_f32_16x16x32_bf16 v[104:107], a[40:43], v[164:167], v[104:107]
    ds_read_b128 v[172:175], v253 offset:31744
    v_mfma_f32_16x16x32_bf16 v[108:111], a[44:47], v[160:163], v[108:111]
    v_mfma_f32_16x16x32_bf16 v[112:115], a[44:47], v[164:167], v[112:115]
    buffer_load_dwordx4 v[72:75], v187, s[48:51], s23 offen offset:2048 sc1
    v_mfma_f32_16x16x32_bf16 v[116:119], a[48:51], v[160:163], v[116:119]
    v_mfma_f32_16x16x32_bf16 v[120:123], a[48:51], v[164:167], v[120:123]
    s_waitcnt lgkmcnt(0)
    v_mfma_f32_16x16x32_bf16 v[100:103], a[52:55], v[168:171], v[100:103]
    ds_read_b128 v[160:163], v253 offset:32768
    v_mfma_f32_16x16x32_bf16 v[104:107], a[52:55], v[172:175], v[104:107]
    ds_read_b128 v[164:167], v253 offset:33792
    v_mfma_f32_16x16x32_bf16 v[108:111], a[56:59], v[168:171], v[108:111]
    v_mfma_f32_16x16x32_bf16 v[112:115], a[56:59], v[172:175], v[112:115]
    v_mfma_f32_16x16x32_bf16 v[116:119], a[60:63], v[168:171], v[116:119]
    v_mfma_f32_16x16x32_bf16 v[120:123], a[60:63], v[172:175], v[120:123]
    s_waitcnt lgkmcnt(0)
    v_mfma_f32_16x16x32_bf16 v[100:103], a[64:67], v[160:163], v[100:103]
    ds_read_b128 v[168:171], v253 offset:34816
    v_mfma_f32_16x16x32_bf16 v[104:107], a[64:67], v[164:167], v[104:107]
    ds_read_b128 v[172:175], v253 offset:35840
    v_mfma_f32_16x16x32_bf16 v[108:111], a[68:71], v[160:163], v[108:111]
    v_mfma_f32_16x16x32_bf16 v[112:115], a[68:71], v[164:167], v[112:115]
    v_mfma_f32_16x16x32_bf16 v[116:119], a[72:75], v[160:163], v[116:119]
    v_mfma_f32_16x16x32_bf16 v[120:123], a[72:75], v[164:167], v[120:123]
    s_waitcnt lgkmcnt(0)
    v_mfma_f32_16x16x32_bf16 v[100:103], a[76:79], v[168:171], v[100:103]
    v_mfma_f32_16x16x32_bf16 v[104:107], a[76:79], v[172:175], v[104:107]
    v_mfma_f32_16x16x32_bf16 v[108:111], a[80:83], v[168:171], v[108:111]
    v_mfma_f32_16x16x32_bf16 v[112:115], a[80:83], v[172:175], v[112:115]
    v_mfma_f32_16x16x32_bf16 v[116:119], a[84:87], v[168:171], v[116:119]
    v_mfma_f32_16x16x32_bf16 v[120:123], a[84:87], v[172:175], v[120:123]
    s_nop 3
    v_permlane16_swap_b32 v100, v104
    v_permlane16_swap_b32 v101, v105
    v_permlane16_swap_b32 v102, v106
    v_permlane16_swap_b32 v103, v107
    v_add_f32 v12, v116, v117
    v_add_f32 v13, v120, v121
    ds_write_b32 v10, v12
    ds_write_b32 v10, v13 offset:64
    v_permlane16_swap_b32 v108, v112
    v_permlane16_swap_b32 v109, v113
    v_permlane16_swap_b32 v110, v114
    v_permlane16_swap_b32 v111, v115
    v_permlane16_swap_b32 v116, v120
    v_permlane16_swap_b32 v117, v121
    v_permlane16_swap_b32 v118, v122
    v_permlane16_swap_b32 v119, v123
    s_waitcnt lgkmcnt(0)
    s_barrier
    ds_read_b32 v12, v11 offset:40960
    v_pk_add_f32 v[124:125], v[124:125], v[100:101]
    v_pk_add_f32 v[126:127], v[126:127], v[102:103]
    v_pk_add_f32 v[128:129], v[128:129], v[104:105]
    v_pk_add_f32 v[130:131], v[130:131], v[106:107]
    v_pk_add_f32 v[132:133], v[132:133], v[108:109]
    v_pk_add_f32 v[134:135], v[134:135], v[110:111]
    v_pk_add_f32 v[136:137], v[136:137], v[112:113]
    v_pk_add_f32 v[138:139], v[138:139], v[114:115]
    v_pk_add_f32 v[140:141], v[140:141], v[116:117]
    v_pk_add_f32 v[142:143], v[142:143], v[118:119]
    v_pk_add_f32 v[144:145], v[144:145], v[120:121]
    v_pk_add_f32 v[146:147], v[146:147], v[122:123]
    v_mov_b32 v14, 0
    v_mov_b32 v15, 0
    s_waitcnt lgkmcnt(0)
    v_add_f32 v12, v12, v252
    v_pk_add_f32 v[100:101], v[124:125], v[12:13] op_sel_hi:[1,0] neg_lo:[0,1] neg_hi:[0,1]
    v_pk_add_f32 v[102:103], v[126:127], v[12:13] op_sel_hi:[1,0] neg_lo:[0,1] neg_hi:[0,1]
    v_pk_add_f32 v[104:105], v[128:129], v[12:13] op_sel_hi:[1,0] neg_lo:[0,1] neg_hi:[0,1]
    v_pk_add_f32 v[106:107], v[130:131], v[12:13] op_sel_hi:[1,0] neg_lo:[0,1] neg_hi:[0,1]
    v_cvt_pk_bf16_f32 v148, v100, v101
    v_cvt_pk_bf16_f32 v149, v102, v103
    v_cvt_pk_bf16_f32 v150, v104, v105
    v_cvt_pk_bf16_f32 v151, v106, v107
    buffer_store_dwordx4 v[148:151], v9, s[8:11], s46 offen offset:0 sc1
    v_pk_add_f32 v[108:109], v[132:133], v[12:13] op_sel_hi:[1,0] neg_lo:[0,1] neg_hi:[0,1]
    v_pk_add_f32 v[110:111], v[134:135], v[12:13] op_sel_hi:[1,0] neg_lo:[0,1] neg_hi:[0,1]
    v_pk_add_f32 v[112:113], v[136:137], v[12:13] op_sel_hi:[1,0] neg_lo:[0,1] neg_hi:[0,1]
    v_pk_add_f32 v[114:115], v[138:139], v[12:13] op_sel_hi:[1,0] neg_lo:[0,1] neg_hi:[0,1]
    v_cvt_pk_bf16_f32 v152, v108, v109
    v_cvt_pk_bf16_f32 v153, v110, v111
    v_cvt_pk_bf16_f32 v154, v112, v113
    v_cvt_pk_bf16_f32 v155, v114, v115
    buffer_store_dwordx4 v[152:155], v9, s[8:11], s46 offen offset:1024 sc1
    v_pk_add_f32 v[116:117], v[140:141], v[12:13] op_sel_hi:[1,0] neg_lo:[0,1] neg_hi:[0,1]
    v_pk_add_f32 v[118:119], v[142:143], v[12:13] op_sel_hi:[1,0] neg_lo:[0,1] neg_hi:[0,1]
    v_pk_add_f32 v[120:121], v[144:145], v[12:13] op_sel_hi:[1,0] neg_lo:[0,1] neg_hi:[0,1]
    v_pk_add_f32 v[122:123], v[146:147], v[12:13] op_sel_hi:[1,0] neg_lo:[0,1] neg_hi:[0,1]
    v_cvt_pk_bf16_f32 v156, v116, v117
    v_cvt_pk_bf16_f32 v157, v118, v119
    v_cvt_pk_bf16_f32 v158, v120, v121
    v_cvt_pk_bf16_f32 v159, v122, v123
    buffer_store_dwordx4 v[156:159], v7, s[8:11], s46 offen offset:2048 sc1
    v_dot2c_f32_bf16 v14, v148, v148
    v_dot2c_f32_bf16 v14, v149, v149
    v_dot2c_f32_bf16 v14, v150, v150
    v_dot2c_f32_bf16 v14, v151, v151
    v_dot2c_f32_bf16 v14, v152, v152
    v_dot2c_f32_bf16 v14, v153, v153
    v_dot2c_f32_bf16 v14, v154, v154
    v_dot2c_f32_bf16 v14, v155, v155
    v_dot2c_f32_bf16 v15, v156, v156
    v_dot2c_f32_bf16 v15, v157, v157
    v_dot2c_f32_bf16 v15, v158, v158
    v_dot2c_f32_bf16 v15, v159, v159
    buffer_store_dword v12, v6, s[8:11], s36 offen sc1
    s_nop 1
    v_fma_f32 v14, v15, s35, v14
    v_mov_b32 v15, v14
    s_nop 1
    v_permlane32_swap_b32 v14, v15
    v_add_f32 v14, v14, v15
    buffer_store_dword v14, v8, s[8:11], s45 offen sc1
    v_lshlrev_b32 v15, 7, v0
    s_lshl_b32 s6, s40, 2
    s_add_u32 s6, s6, s44
    s_add_u32 s6, s6, 32768
    v_mov_b32 v1, s76
    s_mov_b64 vcc, 0xff
    s_waitcnt vmcnt(0)
    s_barrier
    s_cmp_lg_u32 s3, 0
    s_cbranch_scc1 L_pub_25
    s_mov_b64 exec, vcc
    buffer_store_dword v1, v15, s[8:11], s6 offen sc1
L_pub_25:
    s_mov_b64 exec, -1
    s_lshl_b32 s7, s41, 2
    s_add_u32 s7, s7, s3
    s_mul_i32 s22, s7, 18432
    s_add_u32 s22, s22, s43
    s_add_u32 s22, s22, 45875200
    s_mul_i32 s24, s3, 18432
    s_lshl_b32 s25, s41, 12
    s_add_u32 s25, s25, s43
    s_add_u32 s25, s25, 48300032
    v_lshrrev_b32 v3, 5, v0
    v_and_b32 v10, 31, v0
    v_lshlrev_b32 v10, 2, v10
    v_lshl_add_u32 v3, v3, 11, v10
    v_add_u32 v11, 36864, v184
    s_mov_b32 s16, 0xffff0000
    s_lshl_b32 s7, s3, 10
    v_add_u32 v172, s7, v253
    v_add_u32 v174, 5120, v172
    v_and_b32 v178, 7, v0
    v_mul_u32_u24 v178, 1152, v178
    v_lshrrev_b32 v179, 3, v0
    v_lshl_add_u32 v178, v179, 4, v178
    s_lshl_b32 s7, s3, 7
    v_add_u32 v175, s7, v178
    v_add_u32 v177, 640, v175
    s_cmp_eq_u32 s3, 0
    s_mov_b32 s17, 1073741824
    s_cmov_b32 s17, 4096
    v_add_u32 v173, s17, v172
    s_mov_b32 s17, 1073741824
    s_cmov_b32 s17, 512
    v_add_u32 v176, s17, v175
    s_lshl_b32 s21, s41, 3
    s_add_u32 s21, s21, s40
    s_mul_i32 s18, s21, 9216
    s_mul_i32 s20, s21, 73728
    s_add_u32 s20, s20, 19922944
    v_bfe_u32 v1, v0, 3, 2
    s_mov_b32 s7, 73728
    v_mul_lo_u32 v178, v1, s7
    v_lshrrev_b32 v1, 5, v0
    v_lshl_add_u32 v178, v1, 7, v178
    v_and_b32 v1, 7, v0
    v_lshl_add_u32 v178, v1, 4, v178
    v_add_u32 v179, 294912, v178
    v_lshrrev_b32 v1, 5, v0
    v_and_b32 v15, 7, v0
    v_lshlrev_b32 v15, 4, v15
    v_lshl_add_u32 v15, v1, 7, v15
    s_lshl_b32 s7, s3, 8
    s_add_u32 s7, s7, 3072
    v_add_u32 v15, s7, v15
    v_bfe_u32 v1, v0, 3, 2
    v_mov_b32 v182, 1073741824
    v_add_u32 v183, 14336, v253
    s_sub_u32 s7, s40, 0
    v_cmp_eq_u32 vcc, s7, v1
    s_nop 1
    v_cndmask_b32 v178, v178, v182, vcc
    v_cndmask_b32 v216, v183, v15, vcc
    v_cndmask_b32 v218, 0, 1, vcc
    v_lshlrev_b32 v218, 10, v218
    s_sub_u32 s7, s40, 4
    v_cmp_eq_u32 vcc, s7, v1
    s_nop 1
    v_cndmask_b32 v179, v179, v182, vcc
    v_cndmask_b32 v217, v183, v15, vcc
    v_cndmask_b32 v219, 0, 1, vcc
    v_lshlrev_b32 v219, 10, v219
    s_mul_i32 s26, s41, 589824
    s_mul_i32 s7, s40, 9216
    s_add_u32 s26, s26, s7
    s_lshl_b32 s7, s3, 8
    s_add_u32 s27, s26, s7
    s_add_u32 s27, s27, 19921920
    s_mov_b32 s74, 0
    s_mul_i32 s7, s42, 98304
    s_sub_u32 s29, s44, s7
    s_add_u32 s29, s29, 360448
    s_lshl_b32 s7, s40, 7
    s_add_u32 s7, s7, s29
    s_add_u32 s38, s4, s7
    s_addc_u32 s39, s5, 0
    s_lshl_b32 s7, s40, 2
    s_add_u32 s29, s29, s7
    s_add_u32 s50, s23, 497664
    s_cmp_lg_u32 s42, 0
    s_cbranch_scc1 L_ring_26
    s_cmp_lg_u32 s3, 0
    s_cbranch_scc1 L_ring_27
    s_lshl_b32 s7, s41, 3
    s_add_u32 s7, s7, s40
    s_lshl_b32 s7, s7, 7
    s_add_u32 s7, s7, 19464192
    s_add_u32 s68, s4, s7
    s_addc_u32 s69, s5, 0
    s_mov_b32 s6, 0
    s_mov_b32 s7, 0
L_cpoll_28:
    s_load_dwordx16 s[52:67], s[68:69], s7 glc
    s_add_u32 s6, s6, 1
    s_waitcnt lgkmcnt(0)
    s_xor_b64 s[52:53], s[52:53], s[76:77]
    s_xor_b64 s[54:55], s[54:55], s[76:77]
    s_xor_b64 s[56:57], s[56:57], s[76:77]
    s_xor_b64 s[58:59], s[58:59], s[76:77]
    s_xor_b64 s[60:61], s[60:61], s[76:77]
    s_xor_b64 s[62:63], s[62:63], s[76:77]
    s_xor_b64 s[64:65], s[64:65], s[76:77]
    s_xor_b64 s[66:67], s[66:67], s[76:77]
    s_or_b64 s[52:53], s[52:53], s[60:61]
    s_or_b64 s[54:55], s[54:55], s[62:63]
    s_or_b64 s[56:57], s[56:57], s[64:65]
    s_or_b64 s[58:59], s[58:59], s[66:67]
    s_or_b64 s[52:53], s[52:53], s[56:57]
    s_or_b64 s[54:55], s[54:55], s[58:59]
    s_or_b64 s[52:53], s[52:53], s[54:55]
    s_cbranch_scc1 L_cpoll_29
    s_add_u32 s7, s7, 64
    s_cmp_eq_u32 s7, 128
    s_cbranch_scc1 L_cpolled_30
L_cpoll_29:
    s_cmp_lt_u32 s6, 1048576
    s_cbranch_scc1 L_cpoll_28
    s_branch L_main_end
L_cpolled_30:
L_ring_27:
    s_barrier
    buffer_load_dwordx4 v[16:19], v184, s[48:51], s23 offen offset:0 sc1
    buffer_load_dwordx4 v[20:23], v184, s[48:51], s23 offen offset:1024 sc1
    buffer_load_dwordx4 v[24:27], v184, s[48:51], s23 offen offset:2048 sc1
    buffer_load_dwordx4 v[28:31], v184, s[48:51], s23 offen offset:3072 sc1
    buffer_load_dwordx4 v[32:35], v185, s[48:51], s23 offen offset:0 sc1
    buffer_load_dwordx4 v[36:39], v185, s[48:51], s23 offen offset:1024 sc1
    buffer_load_dwordx4 v[40:43], v185, s[48:51], s23 offen offset:2048 sc1
    buffer_load_dwordx4 v[44:47], v185, s[48:51], s23 offen offset:3072 sc1
    buffer_load_dwordx4 v[48:51], v186, s[48:51], s23 offen offset:0 sc1
    buffer_load_dwordx4 v[52:55], v186, s[48:51], s23 offen offset:1024 sc1
    buffer_load_dwordx4 v[56:59], v186, s[48:51], s23 offen offset:2048 sc1
    buffer_load_dwordx4 v[60:63], v186, s[48:51], s23 offen offset:3072 sc1
    buffer_load_dwordx4 v[64:67], v187, s[48:51], s23 offen offset:0 sc1
    buffer_load_dwordx4 v[68:71], v187, s[48:51], s23 offen offset:1024 sc1
    buffer_load_dwordx4 v[72:75], v187, s[48:51], s23 offen offset:2048 sc1
L_ring_26:
    s_cmp_lg_u32 s3, 3
    s_cbranch_scc1 L_pollout_33
    s_lshl_b32 s7, s40, 7
    s_add_u32 s7, s7, s44
    s_add_u32 s7, s7, 32768
    s_add_u32 s52, s4, s7
    s_addc_u32 s53, s5, 0
    s_mov_b32 s6, 0
L_poll_31:
    s_load_dwordx8 s[56:63], s[52:53], 0 glc
    s_add_u32 s6, s6, 1
    s_waitcnt lgkmcnt(0)
    s_xor_b64 s[56:57], s[56:57], s[76:77]
    s_xor_b64 s[58:59], s[58:59], s[76:77]
    s_xor_b64 s[60:61], s[60:61], s[76:77]
    s_xor_b64 s[62:63], s[62:63], s[76:77]
    s_or_b64 s[56:57], s[56:57], s[58:59]
    s_or_b64 s[60:61], s[60:61], s[62:63]
    s_or_b64 s[56:57], s[56:57], s[60:61]
    s_cbranch_scc0 L_polled_32
    s_cmp_lt_u32 s6, 1048576
    s_cbranch_scc1 L_poll_31
    s_branch L_main_end
L_polled_32:
L_pollout_33:
    s_barrier
    s_add_u32 m0, s24, 0
    s_nop 0
    buffer_load_dwordx4 v2, s[8:11], s22 offen offset:0 sc1 lds
    s_add_u32 m0, s24, 512
    s_nop 0
    buffer_load_dwordx4 v2, s[8:11], s22 offen offset:512 sc1 lds
    s_add_u32 m0, s24, 1024
    s_nop 0
    buffer_load_dwordx4 v2, s[8:11], s22 offen offset:1024 sc1 lds
    s_add_u32 m0, s24, 1536
    s_nop 0
    buffer_load_dwordx4 v2, s[8:11], s22 offen offset:1536 sc1 lds
    s_add_u32 m0, s24, 2048
    s_nop 0
    buffer_load_dwordx4 v2, s[8:11], s22 offen offset:2048 sc1 lds
    s_add_u32 m0, s24, 2560
    s_nop 0
    buffer_load_dwordx4 v2, s[8:11], s22 offen offset:2560 sc1 lds
    s_add_u32 m0, s24, 3072
    s_nop 0
    buffer_load_dwordx4 v2, s[8:11], s22 offen offset:3072 sc1 lds
    s_add_u32 m0, s24, 3584
    s_nop 0
    buffer_load_dwordx4 v2, s[8:11], s22 offen offset:3584 sc1 lds
    s_add_u32 m0, s24, 8192
    s_add_u32 s22, s22, 4096
    buffer_load_dwordx4 v2, s[8:11], s22 offen offset:0 sc1 lds
    s_add_u32 m0, s24, 8704
    s_nop 0
    buffer_load_dwordx4 v2, s[8:11], s22 offen offset:512 sc1 lds
    s_add_u32 m0, s24, 9216
    s_nop 0
    buffer_load_dwordx4 v2, s[8:11], s22 offen offset:1024 sc1 lds
    s_add_u32 m0, s24, 9728
    s_nop 0
    buffer_load_dwordx4 v2, s[8:11], s22 offen offset:1536 sc1 lds
    s_add_u32 s23, s23, 15360
    s_lshr_b32 s7, s3, 1
    s_lshl_b32 s7, s7, 10
    s_and_b32 s6, s3, 1
    s_lshl_b32 s6, s6, 3
    s_add_u32 s28, s7, s6
    s_add_u32 s28, s28, 73728
    s_waitcnt vmcnt(6)
    s_barrier
    ds_read_b128 a[0:3], v184 offset:0
    ds_read_b128 a[72:75], v184 offset:18432
    ds_read_b128 a[144:147], v11 offset:0
    ds_read_b128 a[216:219], v11 offset:18432
    ds_read_b128 a[4:7], v184 offset:1024
    ds_read_b128 a[76:79], v184 offset:19456
    ds_read_b128 a[148:151], v11 offset:1024
    ds_read_b128 a[220:223], v11 offset:19456
    ds_read_b128 a[8:11], v184 offset:2048
    ds_read_b128 a[80:83], v184 offset:20480
    ds_read_b128 a[152:155], v11 offset:2048
    ds_read_b128 a[224:227], v11 offset:20480
    s_waitcnt vmcnt(24) lgkmcnt(0)
    v_mfma_f32_16x16x32_bf16 v[88:91], v[16:19], a[0:3], 0
    ds_read_b128 a[12:15], v184 offset:3072
    v_mfma_f32_16x16x32_bf16 v[88:91], v[20:23], a[4:7], v[88:91]
    buffer_load_dwordx4 v[76:79], v184, s[48:51], s23 offen offset:0 sc1
    v_mfma_f32_16x16x32_bf16 v[88:91], v[24:27], a[8:11], v[88:91]
    ds_read_b128 a[84:87], v184 offset:21504
    v_mfma_f32_16x16x32_bf16 v[92:95], v[16:19], a[72:75], 0
    s_add_u32 m0, s24, 10240
    s_nop 0
    buffer_load_dwordx4 v2, s[8:11], s22 offen offset:2048 sc1 lds
    v_mfma_f32_16x16x32_bf16 v[92:95], v[20:23], a[76:79], v[92:95]
    ds_read_b128 a[156:159], v11 offset:3072
    ds_read_b128 a[228:231], v11 offset:21504
    v_mfma_f32_16x16x32_bf16 v[92:95], v[24:27], a[80:83], v[92:95]
    buffer_load_dwordx4 v[80:83], v184, s[48:51], s23 offen offset:1024 sc1
    v_mfma_f32_16x16x32_bf16 v[96:99], v[16:19], a[144:147], 0
    ds_read_b128 a[16:19], v184 offset:4096
    v_mfma_f32_16x16x32_bf16 v[96:99], v[20:23], a[148:151], v[96:99]
    s_add_u32 m0, s24, 10752
    s_nop 0
    buffer_load_dwordx4 v2, s[8:11], s22 offen offset:2560 sc1 lds
    v_mfma_f32_16x16x32_bf16 v[96:99], v[24:27], a[152:155], v[96:99]
    ds_read_b128 a[88:91], v184 offset:22528
    v_mfma_f32_16x16x32_bf16 v[100:103], v[16:19], a[216:219], 0
    buffer_load_dwordx4 v[84:87], v184, s[48:51], s23 offen offset:2048 sc1
    v_mfma_f32_16x16x32_bf16 v[100:103], v[20:23], a[220:223], v[100:103]
    ds_read_b128 a[160:163], v11 offset:4096
    ds_read_b128 a[232:235], v11 offset:22528
    v_mfma_f32_16x16x32_bf16 v[100:103], v[24:27], a[224:227], v[100:103]
    s_add_u32 m0, s24, 11264
    s_nop 0
    buffer_load_dwordx4 v2, s[8:11], s22 offen offset:3072 sc1 lds
    s_waitcnt vmcnt(27) lgkmcnt(8)
    v_mfma_f32_16x16x32_bf16 v[104:107], v[28:31], a[0:3], 0
    ds_read_b128 a[20:23], v184 offset:5120
    v_mfma_f32_16x16x32_bf16 v[104:107], v[32:35], a[4:7], v[104:107]
    buffer_load_dwordx4 v[16:19], v184, s[48:51], s23 offen offset:3072 sc1
    v_mfma_f32_16x16x32_bf16 v[104:107], v[36:39], a[8:11], v[104:107]
    ds_read_b128 a[92:95], v184 offset:23552
    v_mfma_f32_16x16x32_bf16 v[108:111], v[28:31], a[72:75], 0
    s_add_u32 m0, s24, 11776
    s_nop 0
    buffer_load_dwordx4 v2, s[8:11], s22 offen offset:3584 sc1 lds
    v_mfma_f32_16x16x32_bf16 v[108:111], v[32:35], a[76:79], v[108:111]
    ds_read_b128 a[164:167], v11 offset:5120
    ds_read_b128 a[236:239], v11 offset:23552
    v_mfma_f32_16x16x32_bf16 v[108:111], v[36:39], a[80:83], v[108:111]
    buffer_load_dwordx4 v[20:23], v185, s[48:51], s23 offen offset:0 sc1
    v_mfma_f32_16x16x32_bf16 v[112:115], v[28:31], a[144:147], 0
    v_mfma_f32_16x16x32_bf16 v[112:115], v[32:35], a[148:151], v[112:115]
    s_add_u32 m0, s24, 16384
    s_add_u32 s22, s22, 4096
    buffer_load_dwordx4 v2, s[8:11], s22 offen offset:0 sc1 lds
    v_mfma_f32_16x16x32_bf16 v[112:115], v[36:39], a[152:155], v[112:115]
    v_mfma_f32_16x16x32_bf16 v[116:119], v[28:31], a[216:219], 0
    buffer_load_dwordx4 v[24:27], v185, s[48:51], s23 offen offset:1024 sc1
    v_mfma_f32_16x16x32_bf16 v[116:119], v[32:35], a[220:223], v[116:119]
    v_mfma_f32_16x16x32_bf16 v[116:119], v[36:39], a[224:227], v[116:119]
    s_add_u32 m0, s24, 16896
    s_nop 0
    buffer_load_dwordx4 v2, s[8:11], s22 offen offset:512 sc1 lds
    s_waitcnt vmcnt(12) lgkmcnt(0)
    s_barrier
    v_mfma_f32_16x16x32_bf16 v[88:91], v[40:43], a[12:15], v[88:91]
    ds_read_b128 a[24:27], v184 offset:6144
    v_mfma_f32_16x16x32_bf16 v[88:91], v[44:47], a[16:19], v[88:91]
    buffer_load_dwordx4 v[28:31], v185, s[48:51], s23 offen offset:2048 sc1
    v_mfma_f32_16x16x32_bf16 v[88:91], v[48:51], a[20:23], v[88:91]
    ds_read_b128 a[96:99], v184 offset:24576
    v_mfma_f32_16x16x32_bf16 v[92:95], v[40:43], a[84:87], v[92:95]
    buffer_load_dword v136, v3, s[8:11], s25 offen offset:0 sc1
    v_mfma_f32_16x16x32_bf16 v[92:95], v[44:47], a[88:91], v[92:95]
    ds_read_b128 a[168:171], v11 offset:6144
    ds_read_b128 a[240:243], v11 offset:24576
    v_mfma_f32_16x16x32_bf16 v[92:95], v[48:51], a[92:95], v[92:95]
    buffer_load_dwordx4 v[32:35], v185, s[48:51], s23 offen offset:3072 sc1
    v_mfma_f32_16x16x32_bf16 v[96:99], v[40:43], a[156:159], v[96:99]
    buffer_load_dword v137, v3, s[8:11], s25 offen offset:128 sc1
    v_mfma_f32_16x16x32_bf16 v[96:99], v[44:47], a[160:163], v[96:99]
    buffer_load_dword v138, v3, s[8:11], s25 offen offset:256 sc1
    v_mfma_f32_16x16x32_bf16 v[96:99], v[48:51], a[164:167], v[96:99]
    ds_read_b128 a[28:31], v184 offset:7168
    ds_read_b128 a[100:103], v184 offset:25600
    v_mfma_f32_16x16x32_bf16 v[100:103], v[40:43], a[228:231], v[100:103]
    buffer_load_dwordx4 v[36:39], v186, s[48:51], s23 offen offset:0 sc1
    v_mfma_f32_16x16x32_bf16 v[100:103], v[44:47], a[232:235], v[100:103]
    buffer_load_dword v139, v3, s[8:11], s25 offen offset:384 sc1
    v_mfma_f32_16x16x32_bf16 v[100:103], v[48:51], a[236:239], v[100:103]
    buffer_load_dword v140, v3, s[8:11], s25 offen offset:512 sc1
    s_waitcnt vmcnt(35) lgkmcnt(6)
    v_mfma_f32_16x16x32_bf16 v[104:107], v[52:55], a[12:15], v[104:107]
    ds_read_b128 a[172:175], v11 offset:7168
    ds_read_b128 a[244:247], v11 offset:25600
    v_mfma_f32_16x16x32_bf16 v[104:107], v[56:59], a[16:19], v[104:107]
    buffer_load_dwordx4 v[40:43], v186, s[48:51], s23 offen offset:1024 sc1
    v_mfma_f32_16x16x32_bf16 v[104:107], v[60:63], a[20:23], v[104:107]
    ds_read_b128 a[32:35], v184 offset:8192
    ds_read_b128 a[104:107], v184 offset:26624
    v_mfma_f32_16x16x32_bf16 v[108:111], v[52:55], a[84:87], v[108:111]
    buffer_load_dword v141, v3, s[8:11], s25 offen offset:640 sc1
    v_mfma_f32_16x16x32_bf16 v[108:111], v[56:59], a[88:91], v[108:111]
    ds_read_b128 a[176:179], v11 offset:8192
    ds_read_b128 a[248:251], v11 offset:26624
    v_mfma_f32_16x16x32_bf16 v[108:111], v[60:63], a[92:95], v[108:111]
    buffer_load_dwordx4 v[44:47], v186, s[48:51], s23 offen offset:2048 sc1
    v_mfma_f32_16x16x32_bf16 v[112:115], v[52:55], a[156:159], v[112:115]
    buffer_load_dword v142, v3, s[8:11], s25 offen offset:768 sc1
    v_mfma_f32_16x16x32_bf16 v[112:115], v[56:59], a[160:163], v[112:115]
    buffer_load_dword v143, v3, s[8:11], s25 offen offset:896 sc1
    v_mfma_f32_16x16x32_bf16 v[112:115], v[60:63], a[164:167], v[112:115]
    v_mfma_f32_16x16x32_bf16 v[116:119], v[52:55], a[228:231], v[116:119]
    buffer_load_dwordx4 v[48:51], v186, s[48:51], s23 offen offset:3072 sc1
    v_mfma_f32_16x16x32_bf16 v[116:119], v[56:59], a[232:235], v[116:119]
    buffer_load_dword v144, v3, s[8:11], s25 offen offset:1024 sc1
    v_mfma_f32_16x16x32_bf16 v[116:119], v[60:63], a[236:239], v[116:119]
    buffer_load_dword v145, v3, s[8:11], s25 offen offset:1152 sc1
    s_waitcnt vmcnt(40) lgkmcnt(0)
    v_mfma_f32_16x16x32_bf16 v[88:91], v[64:67], a[24:27], v[88:91]
    ds_read_b128 a[36:39], v184 offset:9216
    v_mfma_f32_16x16x32_bf16 v[88:91], v[68:71], a[28:31], v[88:91]
    buffer_load_dwordx4 v[52:55], v187, s[48:51], s23 offen offset:0 sc1
    v_mfma_f32_16x16x32_bf16 v[88:91], v[72:75], a[32:35], v[88:91]
    ds_read_b128 a[108:111], v184 offset:27648
    v_mfma_f32_16x16x32_bf16 v[92:95], v[64:67], a[96:99], v[92:95]
    buffer_load_dword v146, v3, s[8:11], s25 offen offset:1280 sc1
    v_mfma_f32_16x16x32_bf16 v[92:95], v[68:71], a[100:103], v[92:95]
    ds_read_b128 a[180:183], v11 offset:9216
    ds_read_b128 a[252:255], v11 offset:27648
    v_mfma_f32_16x16x32_bf16 v[92:95], v[72:75], a[104:107], v[92:95]
    buffer_load_dwordx4 v[56:59], v187, s[48:51], s23 offen offset:1024 sc1
    v_mfma_f32_16x16x32_bf16 v[96:99], v[64:67], a[168:171], v[96:99]
    buffer_load_dword v147, v3, s[8:11], s25 offen offset:1408 sc1
    v_mfma_f32_16x16x32_bf16 v[96:99], v[68:71], a[172:175], v[96:99]
    buffer_load_dword v148, v3, s[8:11], s25 offen offset:1536 sc1
    v_mfma_f32_16x16x32_bf16 v[96:99], v[72:75], a[176:179], v[96:99]
    ds_read_b128 a[40:43], v184 offset:10240
    ds_read_b128 a[112:115], v184 offset:28672
    v_mfma_f32_16x16x32_bf16 v[100:103], v[64:67], a[240:243], v[100:103]
    buffer_load_dwordx4 v[60:63], v187, s[48:51], s23 offen offset:2048 sc1
    v_mfma_f32_16x16x32_bf16 v[100:103], v[68:71], a[244:247], v[100:103]
    buffer_load_dword v149, v3, s[8:11], s25 offen offset:1664 sc1
    v_mfma_f32_16x16x32_bf16 v[100:103], v[72:75], a[248:251], v[100:103]
    buffer_load_dword v150, v3, s[8:11], s25 offen offset:1792 sc1
    s_waitcnt vmcnt(31) lgkmcnt(6)
    v_mfma_f32_16x16x32_bf16 v[104:107], v[76:79], a[24:27], v[104:107]
    ds_read_b128 a[184:187], v11 offset:10240
    ds_read_b128 v[220:223], v11 offset:28672
    v_mfma_f32_16x16x32_bf16 v[104:107], v[80:83], a[28:31], v[104:107]
    buffer_load_dwordx4 v[64:67], v187, s[48:51], s23 offen offset:3072 sc1
    v_mfma_f32_16x16x32_bf16 v[104:107], v[84:87], a[32:35], v[104:107]
    ds_read_b128 a[44:47], v184 offset:11264
    ds_read_b128 a[116:119], v184 offset:29696
    v_mfma_f32_16x16x32_bf16 v[108:111], v[76:79], a[96:99], v[108:111]
    buffer_load_dword v151, v3, s[8:11], s25 offen offset:1920 sc1
    v_mfma_f32_16x16x32_bf16 v[108:111], v[80:83], a[100:103], v[108:111]
    ds_read_b128 a[188:191], v11 offset:11264
    ds_read_b128 v[224:227], v11 offset:29696
    v_mfma_f32_16x16x32_bf16 v[108:111], v[84:87], a[104:107], v[108:111]
    buffer_load_dwordx4 v[68:71], v188, s[48:51], s23 offen offset:0 sc1
    v_mfma_f32_16x16x32_bf16 v[112:115], v[76:79], a[168:171], v[112:115]
    v_mfma_f32_16x16x32_bf16 v[112:115], v[80:83], a[172:175], v[112:115]
    v_mfma_f32_16x16x32_bf16 v[112:115], v[84:87], a[176:179], v[112:115]
    v_mfma_f32_16x16x32_bf16 v[116:119], v[76:79], a[240:243], v[116:119]
    buffer_load_dwordx4 v[72:75], v188, s[48:51], s23 offen offset:1024 sc1
    v_mfma_f32_16x16x32_bf16 v[116:119], v[80:83], a[244:247], v[116:119]
    v_mfma_f32_16x16x32_bf16 v[116:119], v[84:87], a[248:251], v[116:119]
    s_waitcnt vmcnt(28) lgkmcnt(0)
    s_barrier
    v_mfma_f32_16x16x32_bf16 v[88:91], v[16:19], a[36:39], v[88:91]
    ds_read_b128 a[48:51], v184 offset:12288
    v_mfma_f32_16x16x32_bf16 v[88:91], v[20:23], a[40:43], v[88:91]
    buffer_load_dwordx4 v[76:79], v188, s[48:51], s23 offen offset:2048 sc1
    v_mfma_f32_16x16x32_bf16 v[88:91], v[24:27], a[44:47], v[88:91]
    ds_read_b128 a[120:123], v184 offset:30720
    v_mfma_f32_16x16x32_bf16 v[92:95], v[16:19], a[108:111], v[92:95]
    ds_read_b128 a[192:195], v11 offset:12288
    v_mfma_f32_16x16x32_bf16 v[92:95], v[20:23], a[112:115], v[92:95]
    ds_read_b128 v[228:231], v11 offset:30720
    v_mfma_f32_16x16x32_bf16 v[92:95], v[24:27], a[116:119], v[92:95]
    buffer_load_dwordx4 v[80:83], v188, s[48:51], s23 offen offset:3072 sc1
    v_mfma_f32_16x16x32_bf16 v[96:99], v[16:19], a[180:183], v[96:99]
    ds_read_b128 a[52:55], v184 offset:13312
    v_mfma_f32_16x16x32_bf16 v[96:99], v[20:23], a[184:187], v[96:99]
    ds_read_b128 a[124:127], v184 offset:31744
    v_mfma_f32_16x16x32_bf16 v[96:99], v[24:27], a[188:191], v[96:99]
    v_mfma_f32_16x16x32_bf16 v[100:103], v[16:19], a[252:255], v[100:103]
    buffer_load_dwordx4 v[84:87], v189, s[48:51], s23 offen offset:0 sc1
    v_mfma_f32_16x16x32_bf16 v[100:103], v[20:23], v[220:223], v[100:103]
    ds_read_b128 a[196:199], v11 offset:13312
    ds_read_b128 v[232:235], v11 offset:31744
    v_mfma_f32_16x16x32_bf16 v[100:103], v[24:27], v[224:227], v[100:103]
    s_waitcnt vmcnt(25) lgkmcnt(8)
    v_mfma_f32_16x16x32_bf16 v[104:107], v[28:31], a[36:39], v[104:107]
    ds_read_b128 a[56:59], v184 offset:14336
    v_mfma_f32_16x16x32_bf16 v[104:107], v[32:35], a[40:43], v[104:107]
    buffer_load_dwordx4 v[16:19], v189, s[48:51], s23 offen offset:1024 sc1
    v_mfma_f32_16x16x32_bf16 v[104:107], v[36:39], a[44:47], v[104:107]
    ds_read_b128 a[128:131], v184 offset:32768
    v_mfma_f32_16x16x32_bf16 v[108:111], v[28:31], a[108:111], v[108:111]
    ds_read_b128 a[200:203], v11 offset:14336
    v_mfma_f32_16x16x32_bf16 v[108:111], v[32:35], a[112:115], v[108:111]
    ds_read_b128 v[236:239], v11 offset:32768
    v_mfma_f32_16x16x32_bf16 v[108:111], v[36:39], a[116:119], v[108:111]
    buffer_load_dwordx4 v[20:23], v189, s[48:51], s23 offen offset:2048 sc1
    v_mfma_f32_16x16x32_bf16 v[112:115], v[28:31], a[180:183], v[112:115]
    v_mfma_f32_16x16x32_bf16 v[112:115], v[32:35], a[184:187], v[112:115]
    v_mfma_f32_16x16x32_bf16 v[112:115], v[36:39], a[188:191], v[112:115]
    v_mfma_f32_16x16x32_bf16 v[116:119], v[28:31], a[252:255], v[116:119]
    buffer_load_dwordx4 v[24:27], v189, s[48:51], s23 offen offset:3072 sc1
    v_mfma_f32_16x16x32_bf16 v[116:119], v[32:35], v[220:223], v[116:119]
    v_mfma_f32_16x16x32_bf16 v[116:119], v[36:39], v[224:227], v[116:119]
    s_waitcnt vmcnt(8) lgkmcnt(0)
    v_mfma_f32_16x16x32_bf16 v[88:91], v[40:43], a[48:51], v[88:91]
    ds_read_b128 a[60:63], v184 offset:15360
    v_add_f32 v136, v136, v144
    v_mfma_f32_16x16x32_bf16 v[88:91], v[44:47], a[52:55], v[88:91]
    buffer_load_dwordx4 v[28:31], v190, s[48:51], s23 offen offset:0 sc1
    v_mfma_f32_16x16x32_bf16 v[88:91], v[48:51], a[56:59], v[88:91]
    ds_read_b128 a[132:135], v184 offset:33792
    v_add_f32 v137, v137, v145
    v_mfma_f32_16x16x32_bf16 v[92:95], v[40:43], a[120:123], v[92:95]
    ds_read_b128 a[204:207], v11 offset:15360
    v_add_f32 v138, v138, v146
    v_mfma_f32_16x16x32_bf16 v[92:95], v[44:47], a[124:127], v[92:95]
    ds_read_b128 v[240:243], v11 offset:33792
    v_add_f32 v139, v139, v147
    v_mfma_f32_16x16x32_bf16 v[92:95], v[48:51], a[128:131], v[92:95]
    buffer_load_dwordx4 v[32:35], v190, s[48:51], s23 offen offset:1024 sc1
    v_mfma_f32_16x16x32_bf16 v[96:99], v[40:43], a[192:195], v[96:99]
    ds_read_b128 a[64:67], v184 offset:16384
    v_add_f32 v140, v140, v148
    v_mfma_f32_16x16x32_bf16 v[96:99], v[44:47], a[196:199], v[96:99]
    ds_read_b128 a[136:139], v184 offset:34816
    v_add_f32 v141, v141, v149
    v_mfma_f32_16x16x32_bf16 v[96:99], v[48:51], a[200:203], v[96:99]
    v_add_f32 v142, v142, v150
    v_add_f32 v143, v143, v151
    v_mfma_f32_16x16x32_bf16 v[100:103], v[40:43], v[228:231], v[100:103]
    buffer_load_dwordx4 v[36:39], v190, s[48:51], s23 offen offset:2048 sc1
    v_mfma_f32_16x16x32_bf16 v[100:103], v[44:47], v[232:235], v[100:103]
    ds_read_b128 a[208:211], v11 offset:16384
    ds_read_b128 v[244:247], v11 offset:34816
    v_mfma_f32_16x16x32_bf16 v[100:103], v[48:51], v[236:239], v[100:103]
    v_add_f32 v136, v136, v140
    v_add_f32 v137, v137, v141
    s_waitcnt vmcnt(15) lgkmcnt(8)
    v_mfma_f32_16x16x32_bf16 v[104:107], v[52:55], a[48:51], v[104:107]
    ds_read_b128 a[68:71], v184 offset:17408
    v_add_f32 v138, v138, v142
    v_mfma_f32_16x16x32_bf16 v[104:107], v[56:59], a[52:55], v[104:107]
    buffer_load_dwordx4 v[40:43], v190, s[48:51], s23 offen offset:3072 sc1
    v_mfma_f32_16x16x32_bf16 v[104:107], v[60:63], a[56:59], v[104:107]
    ds_read_b128 a[140:143], v184 offset:35840
    v_add_f32 v139, v139, v143
    v_mfma_f32_16x16x32_bf16 v[108:111], v[52:55], a[120:123], v[108:111]
    ds_read_b128 a[212:215], v11 offset:17408
    v_add_f32 v136, v136, v138
    v_mfma_f32_16x16x32_bf16 v[108:111], v[56:59], a[124:127], v[108:111]
    ds_read_b128 v[248:251], v11 offset:35840
    v_add_f32 v137, v137, v139
    v_mfma_f32_16x16x32_bf16 v[108:111], v[60:63], a[128:131], v[108:111]
    buffer_load_dwordx4 v[44:47], v191, s[48:51], s23 offen offset:0 sc1
    v_mfma_f32_16x16x32_bf16 v[112:115], v[52:55], a[192:195], v[112:115]
    v_add_f32 v136, v136, v137
    v_mov_b32 v137, 0x3727c5ac
    v_mfma_f32_16x16x32_bf16 v[112:115], v[56:59], a[196:199], v[112:115]
    v_fmac_f32 v137, 0x3ae38e39, v136
    v_mov_b32 v193, v137
    v_mfma_f32_16x16x32_bf16 v[112:115], v[60:63], a[200:203], v[112:115]
    s_nop 0
    v_permlane16_swap_b32 v193, v137
    v_mfma_f32_16x16x32_bf16 v[116:119], v[52:55], v[228:231], v[116:119]
    buffer_load_dwordx4 v[48:51], v191, s[48:51], s23 offen offset:1024 sc1
    v_mfma_f32_16x16x32_bf16 v[116:119], v[56:59], v[232:235], v[116:119]
    v_mov_b32 v195, v193
    v_mov_b32 v194, v137
    v_mfma_f32_16x16x32_bf16 v[116:119], v[60:63], v[236:239], v[116:119]
    v_mov_b32 v252, v137
    s_waitcnt vmcnt(12) lgkmcnt(0)
    v_mfma_f32_16x16x32_bf16 v[88:91], v[64:67], a[60:63], v[88:91]
    s_nop 0
    v_permlane32_swap_b32 v193, v195
    v_mfma_f32_16x16x32_bf16 v[88:91], v[68:71], a[64:67], v[88:91]
    buffer_load_dwordx4 v[52:55], v191, s[48:51], s23 offen offset:2048 sc1
    v_mfma_f32_16x16x32_bf16 v[120:123], v[72:75], a[68:71], v[88:91]
    v_permlane32_swap_b32 v194, v252
    v_mfma_f32_16x16x32_bf16 v[92:95], v[64:67], a[132:135], v[92:95]
    v_rsq_f32 v4, v193
    v_mfma_f32_16x16x32_bf16 v[92:95], v[68:71], a[136:139], v[92:95]
    v_rsq_f32 v5, v194
    v_mfma_f32_16x16x32_bf16 v[124:127], v[72:75], a[140:143], v[92:95]
    buffer_load_dwordx4 v[56:59], v191, s[48:51], s23 offen offset:3072 sc1
    v_mfma_f32_16x16x32_bf16 v[96:99], v[64:67], a[204:207], v[96:99]
    v_rsq_f32 v6, v195
    v_mfma_f32_16x16x32_bf16 v[96:99], v[68:71], a[208:211], v[96:99]
    v_rsq_f32 v7, v252
    v_mfma_f32_16x16x32_bf16 v[128:131], v[72:75], a[212:215], v[96:99]
    v_mul_f32 v8, v4, v4
    v_mul_f32 v9, v5, v5
    v_mfma_f32_16x16x32_bf16 v[100:103], v[64:67], v[240:243], v[100:103]
    buffer_load_dwordx4 v[60:63], v192, s[48:51], s23 offen offset:0 sc1
    v_mfma_f32_16x16x32_bf16 v[100:103], v[68:71], v[244:247], v[100:103]
    v_mul_f32 v13, v6, v6
    v_mul_f32 v14, v7, v7
    v_mfma_f32_16x16x32_bf16 v[132:135], v[72:75], v[248:251], v[100:103]
    v_mul_f32 v4, 0xc0135761, v4
    v_mul_f32 v5, 0xc0135761, v5
    s_waitcnt vmcnt(12) lgkmcnt(0)
    v_mfma_f32_16x16x32_bf16 v[104:107], v[76:79], a[60:63], v[104:107]
    v_mul_f32 v6, 0xc0135761, v6
    v_mul_f32 v7, 0xc0135761, v7
    v_mfma_f32_16x16x32_bf16 v[104:107], v[80:83], a[64:67], v[104:107]
    buffer_load_dwordx4 v[64:67], v192, s[48:51], s23 offen offset:1024 sc1
    v_mfma_f32_16x16x32_bf16 v[136:139], v[84:87], a[68:71], v[104:107]
    v_mul_f32 v8, 0x3d372713, v8
    v_mul_f32 v9, 0x3d372713, v9
    v_mfma_f32_16x16x32_bf16 v[108:111], v[76:79], a[132:135], v[108:111]
    v_mul_f32 v13, 0x3d372713, v13
    v_mul_f32 v14, 0x3d372713, v14
    v_mfma_f32_16x16x32_bf16 v[108:111], v[80:83], a[136:139], v[108:111]
    v_mul_f32 v8, v8, v4
    v_mul_f32 v9, v9, v5
    v_mfma_f32_16x16x32_bf16 v[140:143], v[84:87], a[140:143], v[108:111]
    buffer_load_dwordx4 v[68:71], v192, s[48:51], s23 offen offset:2048 sc1
    v_mfma_f32_16x16x32_bf16 v[112:115], v[76:79], a[204:207], v[112:115]
    v_mul_f32 v13, v13, v6
    v_mul_f32 v14, v14, v7
    v_mfma_f32_16x16x32_bf16 v[112:115], v[80:83], a[208:211], v[112:115]
    s_mov_b32 s25, 0
    v_mfma_f32_16x16x32_bf16 v[144:147], v[84:87], a[212:215], v[112:115]
    s_mov_b32 s7, s28
    v_mfma_f32_16x16x32_bf16 v[116:119], v[76:79], v[240:243], v[116:119]
    buffer_load_dwordx4 v[72:75], v192, s[48:51], s23 offen offset:3072 sc1
    v_mfma_f32_16x16x32_bf16 v[116:119], v[80:83], v[244:247], v[116:119]
    s_add_u32 s23, s23, 36864
    v_mfma_f32_16x16x32_bf16 v[148:151], v[84:87], v[248:251], v[116:119]
    v_add_u32 v12, s7, v184
    s_add_u32 s25, s25, 1
L_ffn_gu_34:
    s_waitcnt vmcnt(12)
    v_mfma_f32_16x16x32_bf16 v[88:91], v[16:19], a[0:3], 0
    v_mfma_f32_16x16x32_bf16 v[88:91], v[20:23], a[4:7], v[88:91]
    buffer_load_dwordx4 v[76:79], v184, s[48:51], s23 offen offset:0 sc1
    v_mfma_f32_16x16x32_bf16 v[88:91], v[24:27], a[8:11], v[88:91]
    v_mul_f32 v152, v120, v120
    v_mul_f32 v153, v121, v121
    v_mfma_f32_16x16x32_bf16 v[92:95], v[16:19], a[72:75], 0
    v_mul_f32 v154, v122, v122
    v_mul_f32 v155, v123, v123
    v_mfma_f32_16x16x32_bf16 v[92:95], v[20:23], a[76:79], v[92:95]
    v_fma_f32 v152, v152, v8, v4
    v_fma_f32 v153, v153, v8, v4
    v_mfma_f32_16x16x32_bf16 v[92:95], v[24:27], a[80:83], v[92:95]
    buffer_load_dwordx4 v[80:83], v184, s[48:51], s23 offen offset:1024 sc1
    v_mfma_f32_16x16x32_bf16 v[96:99], v[16:19], a[144:147], 0
    v_fma_f32 v154, v154, v8, v4
    v_fma_f32 v155, v155, v8, v4
    v_mfma_f32_16x16x32_bf16 v[96:99], v[20:23], a[148:151], v[96:99]
    v_mul_f32 v152, v120, v152
    v_mul_f32 v153, v121, v153
    v_mfma_f32_16x16x32_bf16 v[96:99], v[24:27], a[152:155], v[96:99]
    v_mul_f32 v154, v122, v154
    v_mul_f32 v155, v123, v155
    v_mfma_f32_16x16x32_bf16 v[100:103], v[16:19], a[216:219], 0
    buffer_load_dwordx4 v[84:87], v184, s[48:51], s23 offen offset:2048 sc1
    v_mfma_f32_16x16x32_bf16 v[100:103], v[20:23], a[220:223], v[100:103]
    v_exp_f32 v152, v152
    v_mfma_f32_16x16x32_bf16 v[100:103], v[24:27], a[224:227], v[100:103]
    v_exp_f32 v153, v153
    s_waitcnt vmcnt(12)
    v_mfma_f32_16x16x32_bf16 v[104:107], v[28:31], a[0:3], 0
    v_exp_f32 v154, v154
    v_mfma_f32_16x16x32_bf16 v[104:107], v[32:35], a[4:7], v[104:107]
    buffer_load_dwordx4 v[16:19], v184, s[48:51], s23 offen offset:3072 sc1
    v_mfma_f32_16x16x32_bf16 v[104:107], v[36:39], a[8:11], v[104:107]
    v_exp_f32 v155, v155
    v_mfma_f32_16x16x32_bf16 v[108:111], v[28:31], a[72:75], 0
    v_mul_f32 v156, v120, v136
    v_mul_f32 v157, v121, v137
    v_mfma_f32_16x16x32_bf16 v[108:111], v[32:35], a[76:79], v[108:111]
    v_mul_f32 v158, v122, v138
    v_mul_f32 v159, v123, v139
    v_mfma_f32_16x16x32_bf16 v[108:111], v[36:39], a[80:83], v[108:111]
    buffer_load_dwordx4 v[20:23], v185, s[48:51], s23 offen offset:0 sc1
    v_mfma_f32_16x16x32_bf16 v[112:115], v[28:31], a[144:147], 0
    v_fma_f32 v152, v152, v193, v193
    v_fma_f32 v153, v153, v193, v193
    v_mfma_f32_16x16x32_bf16 v[112:115], v[32:35], a[148:151], v[112:115]
    v_fma_f32 v154, v154, v193, v193
    v_fma_f32 v155, v155, v193, v193
    v_mfma_f32_16x16x32_bf16 v[112:115], v[36:39], a[152:155], v[112:115]
    v_rcp_f32 v152, v152
    v_mfma_f32_16x16x32_bf16 v[116:119], v[28:31], a[216:219], 0
    buffer_load_dwordx4 v[24:27], v185, s[48:51], s23 offen offset:1024 sc1
    v_mfma_f32_16x16x32_bf16 v[116:119], v[32:35], a[220:223], v[116:119]
    v_rcp_f32 v153, v153
    v_mfma_f32_16x16x32_bf16 v[116:119], v[36:39], a[224:227], v[116:119]
    v_rcp_f32 v154, v154
    s_waitcnt vmcnt(12)
    v_mfma_f32_16x16x32_bf16 v[88:91], v[40:43], a[12:15], v[88:91]
    v_rcp_f32 v155, v155
    v_mfma_f32_16x16x32_bf16 v[88:91], v[44:47], a[16:19], v[88:91]
    buffer_load_dwordx4 v[28:31], v185, s[48:51], s23 offen offset:2048 sc1
    v_mfma_f32_16x16x32_bf16 v[88:91], v[48:51], a[20:23], v[88:91]
    v_mul_f32 v156, v156, v152
    v_mul_f32 v157, v157, v153
    v_mfma_f32_16x16x32_bf16 v[92:95], v[40:43], a[84:87], v[92:95]
    v_mul_f32 v158, v158, v154
    v_mul_f32 v159, v159, v155
    v_mfma_f32_16x16x32_bf16 v[92:95], v[44:47], a[88:91], v[92:95]
    v_cvt_pk_bf16_f32 v160, v156, v157
    v_cvt_pk_bf16_f32 v161, v158, v159
    v_mfma_f32_16x16x32_bf16 v[92:95], v[48:51], a[92:95], v[92:95]
    buffer_load_dwordx4 v[32:35], v185, s[48:51], s23 offen offset:3072 sc1
    v_mfma_f32_16x16x32_bf16 v[96:99], v[40:43], a[156:159], v[96:99]
    ds_write_b64 v12, v[160:161] offset:0
    v_mfma_f32_16x16x32_bf16 v[96:99], v[44:47], a[160:163], v[96:99]
    v_mul_f32 v162, v124, v124
    v_mul_f32 v163, v125, v125
    v_mfma_f32_16x16x32_bf16 v[96:99], v[48:51], a[164:167], v[96:99]
    v_mul_f32 v164, v126, v126
    v_mul_f32 v165, v127, v127
    v_mfma_f32_16x16x32_bf16 v[100:103], v[40:43], a[228:231], v[100:103]
    buffer_load_dwordx4 v[36:39], v186, s[48:51], s23 offen offset:0 sc1
    v_mfma_f32_16x16x32_bf16 v[100:103], v[44:47], a[232:235], v[100:103]
    v_fma_f32 v162, v162, v9, v5
    v_fma_f32 v163, v163, v9, v5
    v_mfma_f32_16x16x32_bf16 v[100:103], v[48:51], a[236:239], v[100:103]
    v_fma_f32 v164, v164, v9, v5
    v_fma_f32 v165, v165, v9, v5
    s_waitcnt vmcnt(12)
    v_mfma_f32_16x16x32_bf16 v[104:107], v[52:55], a[12:15], v[104:107]
    v_mul_f32 v162, v124, v162
    v_mul_f32 v163, v125, v163
    v_mfma_f32_16x16x32_bf16 v[104:107], v[56:59], a[16:19], v[104:107]
    buffer_load_dwordx4 v[40:43], v186, s[48:51], s23 offen offset:1024 sc1
    v_mfma_f32_16x16x32_bf16 v[104:107], v[60:63], a[20:23], v[104:107]
    v_mul_f32 v164, v126, v164
    v_mul_f32 v165, v127, v165
    v_mfma_f32_16x16x32_bf16 v[108:111], v[52:55], a[84:87], v[108:111]
    v_exp_f32 v162, v162
    v_mfma_f32_16x16x32_bf16 v[108:111], v[56:59], a[88:91], v[108:111]
    v_exp_f32 v163, v163
    v_mfma_f32_16x16x32_bf16 v[108:111], v[60:63], a[92:95], v[108:111]
    buffer_load_dwordx4 v[44:47], v186, s[48:51], s23 offen offset:2048 sc1
    v_mfma_f32_16x16x32_bf16 v[112:115], v[52:55], a[156:159], v[112:115]
    v_exp_f32 v164, v164
    v_mfma_f32_16x16x32_bf16 v[112:115], v[56:59], a[160:163], v[112:115]
    v_exp_f32 v165, v165
    v_mfma_f32_16x16x32_bf16 v[112:115], v[60:63], a[164:167], v[112:115]
    v_mul_f32 v166, v124, v140
    v_mul_f32 v167, v125, v141
    v_mfma_f32_16x16x32_bf16 v[116:119], v[52:55], a[228:231], v[116:119]
    buffer_load_dwordx4 v[48:51], v186, s[48:51], s23 offen offset:3072 sc1
    v_mfma_f32_16x16x32_bf16 v[116:119], v[56:59], a[232:235], v[116:119]
    v_mul_f32 v168, v126, v142
    v_mul_f32 v169, v127, v143
    v_mfma_f32_16x16x32_bf16 v[116:119], v[60:63], a[236:239], v[116:119]
    v_fma_f32 v162, v162, v194, v194
    v_fma_f32 v163, v163, v194, v194
    s_waitcnt vmcnt(12)
    v_mfma_f32_16x16x32_bf16 v[88:91], v[64:67], a[24:27], v[88:91]
    v_fma_f32 v164, v164, v194, v194
    v_fma_f32 v165, v165, v194, v194
    v_mfma_f32_16x16x32_bf16 v[88:91], v[68:71], a[28:31], v[88:91]
    buffer_load_dwordx4 v[52:55], v187, s[48:51], s23 offen offset:0 sc1
    v_mfma_f32_16x16x32_bf16 v[88:91], v[72:75], a[32:35], v[88:91]
    v_rcp_f32 v162, v162
    v_mfma_f32_16x16x32_bf16 v[92:95], v[64:67], a[96:99], v[92:95]
    v_rcp_f32 v163, v163
    v_mfma_f32_16x16x32_bf16 v[92:95], v[68:71], a[100:103], v[92:95]
    v_rcp_f32 v164, v164
    v_mfma_f32_16x16x32_bf16 v[92:95], v[72:75], a[104:107], v[92:95]
    buffer_load_dwordx4 v[56:59], v187, s[48:51], s23 offen offset:1024 sc1
    v_mfma_f32_16x16x32_bf16 v[96:99], v[64:67], a[168:171], v[96:99]
    v_rcp_f32 v165, v165
    v_mfma_f32_16x16x32_bf16 v[96:99], v[68:71], a[172:175], v[96:99]
    v_mul_f32 v166, v166, v162
    v_mul_f32 v167, v167, v163
    v_mfma_f32_16x16x32_bf16 v[96:99], v[72:75], a[176:179], v[96:99]
    v_mul_f32 v168, v168, v164
    v_mul_f32 v169, v169, v165
    v_mfma_f32_16x16x32_bf16 v[100:103], v[64:67], a[240:243], v[100:103]
    buffer_load_dwordx4 v[60:63], v187, s[48:51], s23 offen offset:2048 sc1
    v_mfma_f32_16x16x32_bf16 v[100:103], v[68:71], a[244:247], v[100:103]
    v_cvt_pk_bf16_f32 v170, v166, v167
    v_cvt_pk_bf16_f32 v171, v168, v169
    v_mfma_f32_16x16x32_bf16 v[100:103], v[72:75], a[248:251], v[100:103]
    ds_write_b64 v12, v[170:171] offset:18432
    s_waitcnt vmcnt(12)
    v_mfma_f32_16x16x32_bf16 v[104:107], v[76:79], a[24:27], v[104:107]
    v_mul_f32 v152, v128, v128
    v_mul_f32 v153, v129, v129
    v_mfma_f32_16x16x32_bf16 v[104:107], v[80:83], a[28:31], v[104:107]
    buffer_load_dwordx4 v[64:67], v187, s[48:51], s23 offen offset:3072 sc1
    v_mfma_f32_16x16x32_bf16 v[104:107], v[84:87], a[32:35], v[104:107]
    v_mul_f32 v154, v130, v130
    v_mul_f32 v155, v131, v131
    v_mfma_f32_16x16x32_bf16 v[108:111], v[76:79], a[96:99], v[108:111]
    v_fma_f32 v152, v152, v13, v6
    v_fma_f32 v153, v153, v13, v6
    v_mfma_f32_16x16x32_bf16 v[108:111], v[80:83], a[100:103], v[108:111]
    v_fma_f32 v154, v154, v13, v6
    v_fma_f32 v155, v155, v13, v6
    v_mfma_f32_16x16x32_bf16 v[108:111], v[84:87], a[104:107], v[108:111]
    buffer_load_dwordx4 v[68:71], v188, s[48:51], s23 offen offset:0 sc1
    v_mfma_f32_16x16x32_bf16 v[112:115], v[76:79], a[168:171], v[112:115]
    v_mul_f32 v152, v128, v152
    v_mul_f32 v153, v129, v153
    v_mfma_f32_16x16x32_bf16 v[112:115], v[80:83], a[172:175], v[112:115]
    v_mul_f32 v154, v130, v154
    v_mul_f32 v155, v131, v155
    v_mfma_f32_16x16x32_bf16 v[112:115], v[84:87], a[176:179], v[112:115]
    v_exp_f32 v152, v152
    v_mfma_f32_16x16x32_bf16 v[116:119], v[76:79], a[240:243], v[116:119]
    buffer_load_dwordx4 v[72:75], v188, s[48:51], s23 offen offset:1024 sc1
    v_mfma_f32_16x16x32_bf16 v[116:119], v[80:83], a[244:247], v[116:119]
    v_exp_f32 v153, v153
    v_mfma_f32_16x16x32_bf16 v[116:119], v[84:87], a[248:251], v[116:119]
    v_exp_f32 v154, v154
    s_waitcnt vmcnt(12)
    v_mfma_f32_16x16x32_bf16 v[88:91], v[16:19], a[36:39], v[88:91]
    v_exp_f32 v155, v155
    v_mfma_f32_16x16x32_bf16 v[88:91], v[20:23], a[40:43], v[88:91]
    buffer_load_dwordx4 v[76:79], v188, s[48:51], s23 offen offset:2048 sc1
    v_mfma_f32_16x16x32_bf16 v[88:91], v[24:27], a[44:47], v[88:91]
    v_mul_f32 v156, v128, v144
    v_mul_f32 v157, v129, v145
    v_mfma_f32_16x16x32_bf16 v[92:95], v[16:19], a[108:111], v[92:95]
    v_mul_f32 v158, v130, v146
    v_mul_f32 v159, v131, v147
    v_mfma_f32_16x16x32_bf16 v[92:95], v[20:23], a[112:115], v[92:95]
    v_fma_f32 v152, v152, v195, v195
    v_fma_f32 v153, v153, v195, v195
    v_mfma_f32_16x16x32_bf16 v[92:95], v[24:27], a[116:119], v[92:95]
    buffer_load_dwordx4 v[80:83], v188, s[48:51], s23 offen offset:3072 sc1
    v_mfma_f32_16x16x32_bf16 v[96:99], v[16:19], a[180:183], v[96:99]
    v_fma_f32 v154, v154, v195, v195
    v_fma_f32 v155, v155, v195, v195
    v_mfma_f32_16x16x32_bf16 v[96:99], v[20:23], a[184:187], v[96:99]
    v_rcp_f32 v152, v152
    v_mfma_f32_16x16x32_bf16 v[96:99], v[24:27], a[188:191], v[96:99]
    v_rcp_f32 v153, v153
    v_mfma_f32_16x16x32_bf16 v[100:103], v[16:19], a[252:255], v[100:103]
    buffer_load_dwordx4 v[84:87], v189, s[48:51], s23 offen offset:0 sc1
    v_mfma_f32_16x16x32_bf16 v[100:103], v[20:23], v[220:223], v[100:103]
    v_rcp_f32 v154, v154
    v_mfma_f32_16x16x32_bf16 v[100:103], v[24:27], v[224:227], v[100:103]
    v_rcp_f32 v155, v155
    s_waitcnt vmcnt(12)
    v_mfma_f32_16x16x32_bf16 v[104:107], v[28:31], a[36:39], v[104:107]
    v_mul_f32 v156, v156, v152
    v_mul_f32 v157, v157, v153
    v_mfma_f32_16x16x32_bf16 v[104:107], v[32:35], a[40:43], v[104:107]
    buffer_load_dwordx4 v[16:19], v189, s[48:51], s23 offen offset:1024 sc1
    v_mfma_f32_16x16x32_bf16 v[104:107], v[36:39], a[44:47], v[104:107]
    v_mul_f32 v158, v158, v154
    v_mul_f32 v159, v159, v155
    v_mfma_f32_16x16x32_bf16 v[108:111], v[28:31], a[108:111], v[108:111]
    v_cvt_pk_bf16_f32 v160, v156, v157
    v_cvt_pk_bf16_f32 v161, v158, v159
    v_mfma_f32_16x16x32_bf16 v[108:111], v[32:35], a[112:115], v[108:111]
    ds_write_b64 v12, v[160:161] offset:36864
    v_mfma_f32_16x16x32_bf16 v[108:111], v[36:39], a[116:119], v[108:111]
    buffer_load_dwordx4 v[20:23], v189, s[48:51], s23 offen offset:2048 sc1
    v_mfma_f32_16x16x32_bf16 v[112:115], v[28:31], a[180:183], v[112:115]
    v_mul_f32 v162, v132, v132
    v_mul_f32 v163, v133, v133
    v_mfma_f32_16x16x32_bf16 v[112:115], v[32:35], a[184:187], v[112:115]
    v_mul_f32 v164, v134, v134
    v_mul_f32 v165, v135, v135
    v_mfma_f32_16x16x32_bf16 v[112:115], v[36:39], a[188:191], v[112:115]
    v_fma_f32 v162, v162, v14, v7
    v_fma_f32 v163, v163, v14, v7
    v_mfma_f32_16x16x32_bf16 v[116:119], v[28:31], a[252:255], v[116:119]
    buffer_load_dwordx4 v[24:27], v189, s[48:51], s23 offen offset:3072 sc1
    v_mfma_f32_16x16x32_bf16 v[116:119], v[32:35], v[220:223], v[116:119]
    v_fma_f32 v164, v164, v14, v7
    v_fma_f32 v165, v165, v14, v7
    v_mfma_f32_16x16x32_bf16 v[116:119], v[36:39], v[224:227], v[116:119]
    v_mul_f32 v162, v132, v162
    v_mul_f32 v163, v133, v163
    s_waitcnt vmcnt(12)
    v_mfma_f32_16x16x32_bf16 v[88:91], v[40:43], a[48:51], v[88:91]
    v_mul_f32 v164, v134, v164
    v_mul_f32 v165, v135, v165
    v_mfma_f32_16x16x32_bf16 v[88:91], v[44:47], a[52:55], v[88:91]
    buffer_load_dwordx4 v[28:31], v190, s[48:51], s23 offen offset:0 sc1
    v_mfma_f32_16x16x32_bf16 v[88:91], v[48:51], a[56:59], v[88:91]
    v_exp_f32 v162, v162
    v_mfma_f32_16x16x32_bf16 v[92:95], v[40:43], a[120:123], v[92:95]
    v_exp_f32 v163, v163
    v_mfma_f32_16x16x32_bf16 v[92:95], v[44:47], a[124:127], v[92:95]
    v_exp_f32 v164, v164
    v_mfma_f32_16x16x32_bf16 v[92:95], v[48:51], a[128:131], v[92:95]
    buffer_load_dwordx4 v[32:35], v190, s[48:51], s23 offen offset:1024 sc1
    v_mfma_f32_16x16x32_bf16 v[96:99], v[40:43], a[192:195], v[96:99]
    v_exp_f32 v165, v165
    v_mfma_f32_16x16x32_bf16 v[96:99], v[44:47], a[196:199], v[96:99]
    v_mul_f32 v166, v132, v148
    v_mul_f32 v167, v133, v149
    v_mfma_f32_16x16x32_bf16 v[96:99], v[48:51], a[200:203], v[96:99]
    v_mul_f32 v168, v134, v150
    v_mul_f32 v169, v135, v151
    v_mfma_f32_16x16x32_bf16 v[100:103], v[40:43], v[228:231], v[100:103]
    buffer_load_dwordx4 v[36:39], v190, s[48:51], s23 offen offset:2048 sc1
    v_mfma_f32_16x16x32_bf16 v[100:103], v[44:47], v[232:235], v[100:103]
    v_fma_f32 v162, v162, v252, v252
    v_fma_f32 v163, v163, v252, v252
    v_mfma_f32_16x16x32_bf16 v[100:103], v[48:51], v[236:239], v[100:103]
    v_fma_f32 v164, v164, v252, v252
    v_fma_f32 v165, v165, v252, v252
    s_waitcnt vmcnt(12)
    v_mfma_f32_16x16x32_bf16 v[104:107], v[52:55], a[48:51], v[104:107]
    v_rcp_f32 v162, v162
    v_mfma_f32_16x16x32_bf16 v[104:107], v[56:59], a[52:55], v[104:107]
    buffer_load_dwordx4 v[40:43], v190, s[48:51], s23 offen offset:3072 sc1
    v_mfma_f32_16x16x32_bf16 v[104:107], v[60:63], a[56:59], v[104:107]
    v_rcp_f32 v163, v163
    v_mfma_f32_16x16x32_bf16 v[108:111], v[52:55], a[120:123], v[108:111]
    v_rcp_f32 v164, v164
    v_mfma_f32_16x16x32_bf16 v[108:111], v[56:59], a[124:127], v[108:111]
    v_rcp_f32 v165, v165
    v_mfma_f32_16x16x32_bf16 v[108:111], v[60:63], a[128:131], v[108:111]
    buffer_load_dwordx4 v[44:47], v191, s[48:51], s23 offen offset:0 sc1
    v_mfma_f32_16x16x32_bf16 v[112:115], v[52:55], a[192:195], v[112:115]
    v_mul_f32 v166, v166, v162
    v_mul_f32 v167, v167, v163
    v_mfma_f32_16x16x32_bf16 v[112:115], v[56:59], a[196:199], v[112:115]
    v_mul_f32 v168, v168, v164
    v_mul_f32 v169, v169, v165
    v_mfma_f32_16x16x32_bf16 v[112:115], v[60:63], a[200:203], v[112:115]
    v_cvt_pk_bf16_f32 v170, v166, v167
    v_cvt_pk_bf16_f32 v171, v168, v169
    v_mfma_f32_16x16x32_bf16 v[116:119], v[52:55], v[228:231], v[116:119]
    buffer_load_dwordx4 v[48:51], v191, s[48:51], s23 offen offset:1024 sc1
    v_mfma_f32_16x16x32_bf16 v[116:119], v[56:59], v[232:235], v[116:119]
    ds_write_b64 v12, v[170:171] offset:55296
    v_mfma_f32_16x16x32_bf16 v[116:119], v[60:63], v[236:239], v[116:119]
    s_waitcnt vmcnt(12)
    v_mfma_f32_16x16x32_bf16 v[88:91], v[64:67], a[60:63], v[88:91]
    v_mfma_f32_16x16x32_bf16 v[88:91], v[68:71], a[64:67], v[88:91]
    buffer_load_dwordx4 v[52:55], v191, s[48:51], s23 offen offset:2048 sc1
    v_mfma_f32_16x16x32_bf16 v[120:123], v[72:75], a[68:71], v[88:91]
    v_mfma_f32_16x16x32_bf16 v[92:95], v[64:67], a[132:135], v[92:95]
    v_mfma_f32_16x16x32_bf16 v[92:95], v[68:71], a[136:139], v[92:95]
    v_mfma_f32_16x16x32_bf16 v[124:127], v[72:75], a[140:143], v[92:95]
    buffer_load_dwordx4 v[56:59], v191, s[48:51], s23 offen offset:3072 sc1
    v_mfma_f32_16x16x32_bf16 v[96:99], v[64:67], a[204:207], v[96:99]
    v_mfma_f32_16x16x32_bf16 v[96:99], v[68:71], a[208:211], v[96:99]
    v_mfma_f32_16x16x32_bf16 v[128:131], v[72:75], a[212:215], v[96:99]
    v_mfma_f32_16x16x32_bf16 v[100:103], v[64:67], v[240:243], v[100:103]
    buffer_load_dwordx4 v[60:63], v192, s[48:51], s23 offen offset:0 sc1
    v_mfma_f32_16x16x32_bf16 v[100:103], v[68:71], v[244:247], v[100:103]
    v_mfma_f32_16x16x32_bf16 v[132:135], v[72:75], v[248:251], v[100:103]
    s_waitcnt vmcnt(12)
    v_mfma_f32_16x16x32_bf16 v[104:107], v[76:79], a[60:63], v[104:107]
    v_mfma_f32_16x16x32_bf16 v[104:107], v[80:83], a[64:67], v[104:107]
    buffer_load_dwordx4 v[64:67], v192, s[48:51], s23 offen offset:1024 sc1
    v_mfma_f32_16x16x32_bf16 v[136:139], v[84:87], a[68:71], v[104:107]
    v_mfma_f32_16x16x32_bf16 v[108:111], v[76:79], a[132:135], v[108:111]
    v_mfma_f32_16x16x32_bf16 v[108:111], v[80:83], a[136:139], v[108:111]
    v_mfma_f32_16x16x32_bf16 v[140:143], v[84:87], a[140:143], v[108:111]
    buffer_load_dwordx4 v[68:71], v192, s[48:51], s23 offen offset:2048 sc1
    v_mfma_f32_16x16x32_bf16 v[112:115], v[76:79], a[204:207], v[112:115]
    v_mfma_f32_16x16x32_bf16 v[112:115], v[80:83], a[208:211], v[112:115]
    s_lshl_b32 s7, s25, 11
    v_mfma_f32_16x16x32_bf16 v[144:147], v[84:87], a[212:215], v[112:115]
    s_add_u32 s7, s7, s28
    v_mfma_f32_16x16x32_bf16 v[116:119], v[76:79], v[240:243], v[116:119]
    buffer_load_dwordx4 v[72:75], v192, s[48:51], s23 offen offset:3072 sc1
    v_mfma_f32_16x16x32_bf16 v[116:119], v[80:83], v[244:247], v[116:119]
    s_add_u32 s23, s23, 36864
    v_mfma_f32_16x16x32_bf16 v[148:151], v[84:87], v[248:251], v[116:119]
    v_add_u32 v12, s7, v184
    s_add_u32 s25, s25, 1
    s_cmp_lt_u32 s25, 8
    s_cbranch_scc1 L_ffn_gu_34
    v_add_u32 v10, 73728, v184
    v_add_u32 v11, 110592, v184
    s_lshr_b32 s7, s2, 3
    s_lshl_b32 s7, s7, 2
    s_add_u32 s7, s7, s3
    s_lshl_b32 s7, s7, 9
    v_lshrrev_b32 v1, 1, v253
    v_add_u32 v1, s7, v1
    buffer_load_dwordx2 v[2:3], v1, s[96:99], 0 offen
    s_waitcnt lgkmcnt(0)
    s_barrier
    s_waitcnt vmcnt(12)
    v_mfma_f32_16x16x32_bf16 v[88:91], v[16:19], a[0:3], 0
    v_mfma_f32_16x16x32_bf16 v[88:91], v[20:23], a[4:7], v[88:91]
    buffer_load_dwordx4 v[76:79], v184, s[48:51], s23 offen offset:0 sc1
    v_mfma_f32_16x16x32_bf16 v[88:91], v[24:27], a[8:11], v[88:91]
    v_mul_f32 v152, v120, v120
    v_mul_f32 v153, v121, v121
    v_mfma_f32_16x16x32_bf16 v[92:95], v[16:19], a[72:75], 0
    v_mul_f32 v154, v122, v122
    v_mul_f32 v155, v123, v123
    v_mfma_f32_16x16x32_bf16 v[92:95], v[20:23], a[76:79], v[92:95]
    v_fma_f32 v152, v152, v8, v4
    v_fma_f32 v153, v153, v8, v4
    v_mfma_f32_16x16x32_bf16 v[92:95], v[24:27], a[80:83], v[92:95]
    buffer_load_dwordx4 v[80:83], v184, s[48:51], s23 offen offset:1024 sc1
    v_mfma_f32_16x16x32_bf16 v[96:99], v[16:19], a[144:147], 0
    v_fma_f32 v154, v154, v8, v4
    v_fma_f32 v155, v155, v8, v4
    v_mfma_f32_16x16x32_bf16 v[96:99], v[20:23], a[148:151], v[96:99]
    v_mul_f32 v152, v120, v152
    v_mul_f32 v153, v121, v153
    v_mfma_f32_16x16x32_bf16 v[96:99], v[24:27], a[152:155], v[96:99]
    v_mul_f32 v154, v122, v154
    v_mul_f32 v155, v123, v155
    v_mfma_f32_16x16x32_bf16 v[100:103], v[16:19], a[216:219], 0
    buffer_load_dwordx4 v[84:87], v184, s[48:51], s23 offen offset:2048 sc1
    v_mfma_f32_16x16x32_bf16 v[100:103], v[20:23], a[220:223], v[100:103]
    v_exp_f32 v152, v152
    v_mfma_f32_16x16x32_bf16 v[100:103], v[24:27], a[224:227], v[100:103]
    v_exp_f32 v153, v153
    s_waitcnt vmcnt(12)
    v_mfma_f32_16x16x32_bf16 v[104:107], v[28:31], a[0:3], 0
    v_exp_f32 v154, v154
    ds_read_b128 a[0:3], v10 offset:0
    v_mfma_f32_16x16x32_bf16 v[104:107], v[32:35], a[4:7], v[104:107]
    buffer_load_dwordx4 v[16:19], v184, s[48:51], s23 offen offset:3072 sc1
    v_mfma_f32_16x16x32_bf16 v[104:107], v[36:39], a[8:11], v[104:107]
    v_exp_f32 v155, v155
    v_mfma_f32_16x16x32_bf16 v[108:111], v[28:31], a[72:75], 0
    v_mul_f32 v156, v120, v136
    v_mul_f32 v157, v121, v137
    ds_read_b128 a[72:75], v10 offset:18432
    v_mfma_f32_16x16x32_bf16 v[108:111], v[32:35], a[76:79], v[108:111]
    v_mul_f32 v158, v122, v138
    v_mul_f32 v159, v123, v139
    v_mfma_f32_16x16x32_bf16 v[108:111], v[36:39], a[80:83], v[108:111]
    buffer_load_dwordx4 v[20:23], v185, s[48:51], s23 offen offset:0 sc1
    v_mfma_f32_16x16x32_bf16 v[112:115], v[28:31], a[144:147], 0
    v_fma_f32 v152, v152, v193, v193
    v_fma_f32 v153, v153, v193, v193
    ds_read_b128 a[144:147], v11 offset:0
    v_mfma_f32_16x16x32_bf16 v[112:115], v[32:35], a[148:151], v[112:115]
    v_fma_f32 v154, v154, v193, v193
    v_fma_f32 v155, v155, v193, v193
    v_mfma_f32_16x16x32_bf16 v[112:115], v[36:39], a[152:155], v[112:115]
    v_rcp_f32 v152, v152
    v_mfma_f32_16x16x32_bf16 v[116:119], v[28:31], a[216:219], 0
    buffer_load_dwordx4 v[24:27], v185, s[48:51], s23 offen offset:1024 sc1
    v_mfma_f32_16x16x32_bf16 v[116:119], v[32:35], a[220:223], v[116:119]
    v_rcp_f32 v153, v153
    ds_read_b128 a[216:219], v11 offset:18432
    v_mfma_f32_16x16x32_bf16 v[116:119], v[36:39], a[224:227], v[116:119]
    v_rcp_f32 v154, v154
    ds_read_b128 a[4:7], v10 offset:1024
    s_waitcnt vmcnt(12)
    v_mfma_f32_16x16x32_bf16 v[88:91], v[40:43], a[12:15], v[88:91]
    v_rcp_f32 v155, v155
    ds_read_b128 a[76:79], v10 offset:19456
    v_mfma_f32_16x16x32_bf16 v[88:91], v[44:47], a[16:19], v[88:91]
    buffer_load_dwordx4 v[28:31], v185, s[48:51], s23 offen offset:2048 sc1
    v_mfma_f32_16x16x32_bf16 v[88:91], v[48:51], a[20:23], v[88:91]
    v_mul_f32 v156, v156, v152
    v_mul_f32 v157, v157, v153
    ds_read_b128 a[148:151], v11 offset:1024
    v_mfma_f32_16x16x32_bf16 v[92:95], v[40:43], a[84:87], v[92:95]
    v_mul_f32 v158, v158, v154
    v_mul_f32 v159, v159, v155
    ds_read_b128 a[220:223], v11 offset:19456
    v_mfma_f32_16x16x32_bf16 v[92:95], v[44:47], a[88:91], v[92:95]
    v_cvt_pk_bf16_f32 v160, v156, v157
    v_cvt_pk_bf16_f32 v161, v158, v159
    ds_read_b128 a[8:11], v10 offset:2048
    v_mfma_f32_16x16x32_bf16 v[92:95], v[48:51], a[92:95], v[92:95]
    buffer_load_dwordx4 v[32:35], v185, s[48:51], s23 offen offset:3072 sc1
    v_mfma_f32_16x16x32_bf16 v[96:99], v[40:43], a[156:159], v[96:99]
    ds_write_b64 v12, v[160:161] offset:0
    v_mfma_f32_16x16x32_bf16 v[96:99], v[44:47], a[160:163], v[96:99]
    v_mul_f32 v162, v124, v124
    v_mul_f32 v163, v125, v125
    ds_read_b128 a[80:83], v10 offset:20480
    v_mfma_f32_16x16x32_bf16 v[96:99], v[48:51], a[164:167], v[96:99]
    v_mul_f32 v164, v126, v126
    v_mul_f32 v165, v127, v127
    ds_read_b128 a[152:155], v11 offset:2048
    v_mfma_f32_16x16x32_bf16 v[100:103], v[40:43], a[228:231], v[100:103]
    buffer_load_dwordx4 v[36:39], v186, s[48:51], s23 offen offset:0 sc1
    v_mfma_f32_16x16x32_bf16 v[100:103], v[44:47], a[232:235], v[100:103]
    v_fma_f32 v162, v162, v9, v5
    v_fma_f32 v163, v163, v9, v5
    ds_read_b128 a[224:227], v11 offset:20480
    v_mfma_f32_16x16x32_bf16 v[100:103], v[48:51], a[236:239], v[100:103]
    v_fma_f32 v164, v164, v9, v5
    v_fma_f32 v165, v165, v9, v5
    s_waitcnt vmcnt(12)
    v_mfma_f32_16x16x32_bf16 v[104:107], v[52:55], a[12:15], v[104:107]
    v_mul_f32 v162, v124, v162
    v_mul_f32 v163, v125, v163
    ds_read_b128 a[12:15], v10 offset:3072
    v_mfma_f32_16x16x32_bf16 v[104:107], v[56:59], a[16:19], v[104:107]
    buffer_load_dwordx4 v[40:43], v186, s[48:51], s23 offen offset:1024 sc1
    v_mfma_f32_16x16x32_bf16 v[104:107], v[60:63], a[20:23], v[104:107]
    v_mul_f32 v164, v126, v164
    v_mul_f32 v165, v127, v165
    v_mfma_f32_16x16x32_bf16 v[108:111], v[52:55], a[84:87], v[108:111]
    v_exp_f32 v162, v162
    ds_read_b128 a[84:87], v10 offset:21504
    v_mfma_f32_16x16x32_bf16 v[108:111], v[56:59], a[88:91], v[108:111]
    v_exp_f32 v163, v163
    v_mfma_f32_16x16x32_bf16 v[108:111], v[60:63], a[92:95], v[108:111]
    buffer_load_dwordx4 v[44:47], v186, s[48:51], s23 offen offset:2048 sc1
    v_mfma_f32_16x16x32_bf16 v[112:115], v[52:55], a[156:159], v[112:115]
    v_exp_f32 v164, v164
    ds_read_b128 a[156:159], v11 offset:3072
    v_mfma_f32_16x16x32_bf16 v[112:115], v[56:59], a[160:163], v[112:115]
    v_exp_f32 v165, v165
    v_mfma_f32_16x16x32_bf16 v[112:115], v[60:63], a[164:167], v[112:115]
    v_mul_f32 v166, v124, v140
    v_mul_f32 v167, v125, v141
    v_mfma_f32_16x16x32_bf16 v[116:119], v[52:55], a[228:231], v[116:119]
    buffer_load_dwordx4 v[48:51], v186, s[48:51], s23 offen offset:3072 sc1
    v_mfma_f32_16x16x32_bf16 v[116:119], v[56:59], a[232:235], v[116:119]
    v_mul_f32 v168, v126, v142
    v_mul_f32 v169, v127, v143
    ds_read_b128 a[228:231], v11 offset:21504
    v_mfma_f32_16x16x32_bf16 v[116:119], v[60:63], a[236:239], v[116:119]
    v_fma_f32 v162, v162, v194, v194
    v_fma_f32 v163, v163, v194, v194
    ds_read_b128 a[16:19], v10 offset:4096
    s_waitcnt vmcnt(12)
    v_mfma_f32_16x16x32_bf16 v[88:91], v[64:67], a[24:27], v[88:91]
    v_fma_f32 v164, v164, v194, v194
    v_fma_f32 v165, v165, v194, v194
    ds_read_b128 a[88:91], v10 offset:22528
    v_mfma_f32_16x16x32_bf16 v[88:91], v[68:71], a[28:31], v[88:91]
    buffer_load_dwordx4 v[52:55], v187, s[48:51], s23 offen offset:0 sc1
    v_mfma_f32_16x16x32_bf16 v[88:91], v[72:75], a[32:35], v[88:91]
    v_rcp_f32 v162, v162
    ds_read_b128 a[160:163], v11 offset:4096
    v_mfma_f32_16x16x32_bf16 v[92:95], v[64:67], a[96:99], v[92:95]
    v_rcp_f32 v163, v163
    ds_read_b128 a[232:235], v11 offset:22528
    v_mfma_f32_16x16x32_bf16 v[92:95], v[68:71], a[100:103], v[92:95]
    v_rcp_f32 v164, v164
    ds_read_b128 a[20:23], v10 offset:5120
    v_mfma_f32_16x16x32_bf16 v[92:95], v[72:75], a[104:107], v[92:95]
    buffer_load_dwordx4 v[56:59], v187, s[48:51], s23 offen offset:1024 sc1
    v_mfma_f32_16x16x32_bf16 v[96:99], v[64:67], a[168:171], v[96:99]
    v_rcp_f32 v165, v165
    ds_read_b128 a[92:95], v10 offset:23552
    v_mfma_f32_16x16x32_bf16 v[96:99], v[68:71], a[172:175], v[96:99]
    v_mul_f32 v166, v166, v162
    v_mul_f32 v167, v167, v163
    ds_read_b128 a[164:167], v11 offset:5120
    v_mfma_f32_16x16x32_bf16 v[96:99], v[72:75], a[176:179], v[96:99]
    v_mul_f32 v168, v168, v164
    v_mul_f32 v169, v169, v165
    ds_read_b128 a[236:239], v11 offset:23552
    v_mfma_f32_16x16x32_bf16 v[100:103], v[64:67], a[240:243], v[100:103]
    buffer_load_dwordx4 v[60:63], v187, s[48:51], s23 offen offset:2048 sc1
    v_mfma_f32_16x16x32_bf16 v[100:103], v[68:71], a[244:247], v[100:103]
    v_cvt_pk_bf16_f32 v170, v166, v167
    v_cvt_pk_bf16_f32 v171, v168, v169
    v_mfma_f32_16x16x32_bf16 v[100:103], v[72:75], a[248:251], v[100:103]
    ds_write_b64 v12, v[170:171] offset:18432
    s_waitcnt vmcnt(12)
    v_mfma_f32_16x16x32_bf16 v[104:107], v[76:79], a[24:27], v[104:107]
    v_mul_f32 v152, v128, v128
    v_mul_f32 v153, v129, v129
    ds_read_b128 a[24:27], v10 offset:6144
    v_mfma_f32_16x16x32_bf16 v[104:107], v[80:83], a[28:31], v[104:107]
    buffer_load_dwordx4 v[64:67], v187, s[48:51], s23 offen offset:3072 sc1
    v_mfma_f32_16x16x32_bf16 v[104:107], v[84:87], a[32:35], v[104:107]
    v_mul_f32 v154, v130, v130
    v_mul_f32 v155, v131, v131
    v_mfma_f32_16x16x32_bf16 v[108:111], v[76:79], a[96:99], v[108:111]
    v_fma_f32 v152, v152, v13, v6
    v_fma_f32 v153, v153, v13, v6
    ds_read_b128 a[96:99], v10 offset:24576
    v_mfma_f32_16x16x32_bf16 v[108:111], v[80:83], a[100:103], v[108:111]
    v_fma_f32 v154, v154, v13, v6
    v_fma_f32 v155, v155, v13, v6
    v_mfma_f32_16x16x32_bf16 v[108:111], v[84:87], a[104:107], v[108:111]
    buffer_load_dwordx4 v[68:71], v188, s[48:51], s23 offen offset:0 sc1
    v_mfma_f32_16x16x32_bf16 v[112:115], v[76:79], a[168:171], v[112:115]
    v_mul_f32 v152, v128, v152
    v_mul_f32 v153, v129, v153
    ds_read_b128 a[168:171], v11 offset:6144
    v_mfma_f32_16x16x32_bf16 v[112:115], v[80:83], a[172:175], v[112:115]
    v_mul_f32 v154, v130, v154
    v_mul_f32 v155, v131, v155
    v_mfma_f32_16x16x32_bf16 v[112:115], v[84:87], a[176:179], v[112:115]
    v_exp_f32 v152, v152
    v_mfma_f32_16x16x32_bf16 v[116:119], v[76:79], a[240:243], v[116:119]
    buffer_load_dwordx4 v[72:75], v188, s[48:51], s23 offen offset:1024 sc1
    v_mfma_f32_16x16x32_bf16 v[116:119], v[80:83], a[244:247], v[116:119]
    v_exp_f32 v153, v153
    ds_read_b128 a[240:243], v11 offset:24576
    v_mfma_f32_16x16x32_bf16 v[116:119], v[84:87], a[248:251], v[116:119]
    v_exp_f32 v154, v154
    ds_read_b128 a[28:31], v10 offset:7168
    s_waitcnt vmcnt(12)
    v_mfma_f32_16x16x32_bf16 v[88:91], v[16:19], a[36:39], v[88:91]
    v_exp_f32 v155, v155
    ds_read_b128 a[100:103], v10 offset:25600
    v_mfma_f32_16x16x32_bf16 v[88:91], v[20:23], a[40:43], v[88:91]
    buffer_load_dwordx4 v[76:79], v188, s[48:51], s23 offen offset:2048 sc1
    v_mfma_f32_16x16x32_bf16 v[88:91], v[24:27], a[44:47], v[88:91]
    v_mul_f32 v156, v128, v144
    v_mul_f32 v157, v129, v145
    ds_read_b128 a[172:175], v11 offset:7168
    v_mfma_f32_16x16x32_bf16 v[92:95], v[16:19], a[108:111], v[92:95]
    v_mul_f32 v158, v130, v146
    v_mul_f32 v159, v131, v147
    ds_read_b128 a[244:247], v11 offset:25600
    v_mfma_f32_16x16x32_bf16 v[92:95], v[20:23], a[112:115], v[92:95]
    v_fma_f32 v152, v152, v195, v195
    v_fma_f32 v153, v153, v195, v195
    ds_read_b128 a[32:35], v10 offset:8192
    v_mfma_f32_16x16x32_bf16 v[92:95], v[24:27], a[116:119], v[92:95]
    buffer_load_dwordx4 v[80:83], v188, s[48:51], s23 offen offset:3072 sc1
    v_mfma_f32_16x16x32_bf16 v[96:99], v[16:19], a[180:183], v[96:99]
    v_fma_f32 v154, v154, v195, v195
    v_fma_f32 v155, v155, v195, v195
    ds_read_b128 a[104:107], v10 offset:26624
    v_mfma_f32_16x16x32_bf16 v[96:99], v[20:23], a[184:187], v[96:99]
    v_rcp_f32 v152, v152
    ds_read_b128 a[176:179], v11 offset:8192
    v_mfma_f32_16x16x32_bf16 v[96:99], v[24:27], a[188:191], v[96:99]
    v_rcp_f32 v153, v153
    ds_read_b128 a[248:251], v11 offset:26624
    v_mfma_f32_16x16x32_bf16 v[100:103], v[16:19], a[252:255], v[100:103]
    buffer_load_dwordx4 v[84:87], v189, s[48:51], s23 offen offset:0 sc1
    v_mfma_f32_16x16x32_bf16 v[100:103], v[20:23], v[220:223], v[100:103]
    v_rcp_f32 v154, v154
    v_mfma_f32_16x16x32_bf16 v[100:103], v[24:27], v[224:227], v[100:103]
    v_rcp_f32 v155, v155
    s_waitcnt vmcnt(12)
    v_mfma_f32_16x16x32_bf16 v[104:107], v[28:31], a[36:39], v[104:107]
    v_mul_f32 v156, v156, v152
    v_mul_f32 v157, v157, v153
    ds_read_b128 a[36:39], v10 offset:9216
    v_mfma_f32_16x16x32_bf16 v[104:107], v[32:35], a[40:43], v[104:107]
    buffer_load_dwordx4 v[16:19], v189, s[48:51], s23 offen offset:1024 sc1
    v_mfma_f32_16x16x32_bf16 v[104:107], v[36:39], a[44:47], v[104:107]
    v_mul_f32 v158, v158, v154
    v_mul_f32 v159, v159, v155
    v_mfma_f32_16x16x32_bf16 v[108:111], v[28:31], a[108:111], v[108:111]
    v_cvt_pk_bf16_f32 v160, v156, v157
    v_cvt_pk_bf16_f32 v161, v158, v159
    ds_read_b128 a[108:111], v10 offset:27648
    v_mfma_f32_16x16x32_bf16 v[108:111], v[32:35], a[112:115], v[108:111]
    ds_write_b64 v12, v[160:161] offset:36864
    v_mfma_f32_16x16x32_bf16 v[108:111], v[36:39], a[116:119], v[108:111]
    buffer_load_dwordx4 v[20:23], v189, s[48:51], s23 offen offset:2048 sc1
    v_mfma_f32_16x16x32_bf16 v[112:115], v[28:31], a[180:183], v[112:115]
    v_mul_f32 v162, v132, v132
    v_mul_f32 v163, v133, v133
    ds_read_b128 a[180:183], v11 offset:9216
    v_mfma_f32_16x16x32_bf16 v[112:115], v[32:35], a[184:187], v[112:115]
    v_mul_f32 v164, v134, v134
    v_mul_f32 v165, v135, v135
    v_mfma_f32_16x16x32_bf16 v[112:115], v[36:39], a[188:191], v[112:115]
    v_fma_f32 v162, v162, v14, v7
    v_fma_f32 v163, v163, v14, v7
    v_mfma_f32_16x16x32_bf16 v[116:119], v[28:31], a[252:255], v[116:119]
    buffer_load_dwordx4 v[24:27], v189, s[48:51], s23 offen offset:3072 sc1
    v_mfma_f32_16x16x32_bf16 v[116:119], v[32:35], v[220:223], v[116:119]
    v_fma_f32 v164, v164, v14, v7
    v_fma_f32 v165, v165, v14, v7
    ds_read_b128 a[252:255], v11 offset:27648
    v_mfma_f32_16x16x32_bf16 v[116:119], v[36:39], v[224:227], v[116:119]
    v_mul_f32 v162, v132, v162
    v_mul_f32 v163, v133, v163
    ds_read_b128 a[40:43], v10 offset:10240
    s_waitcnt vmcnt(12)
    v_mfma_f32_16x16x32_bf16 v[88:91], v[40:43], a[48:51], v[88:91]
    v_mul_f32 v164, v134, v164
    v_mul_f32 v165, v135, v165
    ds_read_b128 a[112:115], v10 offset:28672
    v_mfma_f32_16x16x32_bf16 v[88:91], v[44:47], a[52:55], v[88:91]
    buffer_load_dwordx4 v[28:31], v190, s[48:51], s23 offen offset:0 sc1
    v_mfma_f32_16x16x32_bf16 v[88:91], v[48:51], a[56:59], v[88:91]
    v_exp_f32 v162, v162
    ds_read_b128 a[184:187], v11 offset:10240
    v_mfma_f32_16x16x32_bf16 v[92:95], v[40:43], a[120:123], v[92:95]
    v_exp_f32 v163, v163
    ds_read_b128 v[220:223], v11 offset:28672
    v_mfma_f32_16x16x32_bf16 v[92:95], v[44:47], a[124:127], v[92:95]
    v_exp_f32 v164, v164
    ds_read_b128 a[44:47], v10 offset:11264
    v_mfma_f32_16x16x32_bf16 v[92:95], v[48:51], a[128:131], v[92:95]
    buffer_load_dwordx4 v[32:35], v190, s[48:51], s23 offen offset:1024 sc1
    v_mfma_f32_16x16x32_bf16 v[96:99], v[40:43], a[192:195], v[96:99]
    v_exp_f32 v165, v165
    ds_read_b128 a[116:119], v10 offset:29696
    v_mfma_f32_16x16x32_bf16 v[96:99], v[44:47], a[196:199], v[96:99]
    v_mul_f32 v166, v132, v148
    v_mul_f32 v167, v133, v149
    ds_read_b128 a[188:191], v11 offset:11264
    v_mfma_f32_16x16x32_bf16 v[96:99], v[48:51], a[200:203], v[96:99]
    v_mul_f32 v168, v134, v150
    v_mul_f32 v169, v135, v151
    ds_read_b128 v[224:227], v11 offset:29696
    v_mfma_f32_16x16x32_bf16 v[100:103], v[40:43], v[228:231], v[100:103]
    buffer_load_dwordx4 v[36:39], v190, s[48:51], s23 offen offset:2048 sc1
    v_mfma_f32_16x16x32_bf16 v[100:103], v[44:47], v[232:235], v[100:103]
    v_fma_f32 v162, v162, v252, v252
    v_fma_f32 v163, v163, v252, v252
    v_mfma_f32_16x16x32_bf16 v[100:103], v[48:51], v[236:239], v[100:103]
    v_fma_f32 v164, v164, v252, v252
    v_fma_f32 v165, v165, v252, v252
    s_waitcnt vmcnt(12)
    v_mfma_f32_16x16x32_bf16 v[104:107], v[52:55], a[48:51], v[104:107]
    v_rcp_f32 v162, v162
    ds_read_b128 a[48:51], v10 offset:12288
    v_mfma_f32_16x16x32_bf16 v[104:107], v[56:59], a[52:55], v[104:107]
    buffer_load_dwordx4 v[40:43], v190, s[48:51], s23 offen offset:3072 sc1
    v_mfma_f32_16x16x32_bf16 v[104:107], v[60:63], a[56:59], v[104:107]
    v_rcp_f32 v163, v163
    v_mfma_f32_16x16x32_bf16 v[108:111], v[52:55], a[120:123], v[108:111]
    v_rcp_f32 v164, v164
    ds_read_b128 a[120:123], v10 offset:30720
    v_mfma_f32_16x16x32_bf16 v[108:111], v[56:59], a[124:127], v[108:111]
    v_rcp_f32 v165, v165
    v_mfma_f32_16x16x32_bf16 v[108:111], v[60:63], a[128:131], v[108:111]
    buffer_load_dwordx4 v[44:47], v191, s[48:51], s23 offen offset:0 sc1
    v_mfma_f32_16x16x32_bf16 v[112:115], v[52:55], a[192:195], v[112:115]
    v_mul_f32 v166, v166, v162
    v_mul_f32 v167, v167, v163
    ds_read_b128 a[192:195], v11 offset:12288
    v_mfma_f32_16x16x32_bf16 v[112:115], v[56:59], a[196:199], v[112:115]
    v_mul_f32 v168, v168, v164
    v_mul_f32 v169, v169, v165
    v_mfma_f32_16x16x32_bf16 v[112:115], v[60:63], a[200:203], v[112:115]
    v_cvt_pk_bf16_f32 v170, v166, v167
    v_cvt_pk_bf16_f32 v171, v168, v169
    v_mfma_f32_16x16x32_bf16 v[116:119], v[52:55], v[228:231], v[116:119]
    buffer_load_dwordx4 v[48:51], v191, s[48:51], s23 offen offset:1024 sc1
    v_mfma_f32_16x16x32_bf16 v[116:119], v[56:59], v[232:235], v[116:119]
    ds_write_b64 v12, v[170:171] offset:55296
    v_mfma_f32_16x16x32_bf16 v[116:119], v[60:63], v[236:239], v[116:119]
    ds_read_b128 v[228:231], v11 offset:30720
    s_waitcnt vmcnt(12)
    v_mfma_f32_16x16x32_bf16 v[88:91], v[64:67], a[60:63], v[88:91]
    ds_read_b128 a[52:55], v10 offset:13312
    v_mfma_f32_16x16x32_bf16 v[88:91], v[68:71], a[64:67], v[88:91]
    buffer_load_dwordx4 v[52:55], v191, s[48:51], s23 offen offset:2048 sc1
    v_mfma_f32_16x16x32_bf16 v[120:123], v[72:75], a[68:71], v[88:91]
    ds_read_b128 a[124:127], v10 offset:31744
    v_mfma_f32_16x16x32_bf16 v[92:95], v[64:67], a[132:135], v[92:95]
    ds_read_b128 a[196:199], v11 offset:13312
    v_mfma_f32_16x16x32_bf16 v[92:95], v[68:71], a[136:139], v[92:95]
    ds_read_b128 v[232:235], v11 offset:31744
    v_mfma_f32_16x16x32_bf16 v[124:127], v[72:75], a[140:143], v[92:95]
    buffer_load_dwordx4 v[56:59], v191, s[48:51], s23 offen offset:3072 sc1
    v_mfma_f32_16x16x32_bf16 v[96:99], v[64:67], a[204:207], v[96:99]
    v_mfma_f32_16x16x32_bf16 v[96:99], v[68:71], a[208:211], v[96:99]
    v_mfma_f32_16x16x32_bf16 v[128:131], v[72:75], a[212:215], v[96:99]
    v_mfma_f32_16x16x32_bf16 v[100:103], v[64:67], v[240:243], v[100:103]
    buffer_load_dwordx4 v[60:63], v192, s[48:51], s23 offen offset:0 sc1
    v_mfma_f32_16x16x32_bf16 v[100:103], v[68:71], v[244:247], v[100:103]
    v_mfma_f32_16x16x32_bf16 v[132:135], v[72:75], v[248:251], v[100:103]
    s_waitcnt vmcnt(12)
    v_mfma_f32_16x16x32_bf16 v[104:107], v[76:79], a[60:63], v[104:107]
    v_mfma_f32_16x16x32_bf16 v[104:107], v[80:83], a[64:67], v[104:107]
    buffer_load_dwordx4 v[64:67], v192, s[48:51], s23 offen offset:1024 sc1
    v_mfma_f32_16x16x32_bf16 v[136:139], v[84:87], a[68:71], v[104:107]
    v_mfma_f32_16x16x32_bf16 v[108:111], v[76:79], a[132:135], v[108:111]
    v_mfma_f32_16x16x32_bf16 v[108:111], v[80:83], a[136:139], v[108:111]
    v_mfma_f32_16x16x32_bf16 v[140:143], v[84:87], a[140:143], v[108:111]
    buffer_load_dwordx4 v[68:71], v192, s[48:51], s23 offen offset:2048 sc1
    v_mfma_f32_16x16x32_bf16 v[112:115], v[76:79], a[204:207], v[112:115]
    v_mfma_f32_16x16x32_bf16 v[112:115], v[80:83], a[208:211], v[112:115]
    s_lshl_b32 s7, s25, 11
    v_mfma_f32_16x16x32_bf16 v[144:147], v[84:87], a[212:215], v[112:115]
    s_add_u32 s7, s7, s28
    v_mfma_f32_16x16x32_bf16 v[116:119], v[76:79], v[240:243], v[116:119]
    buffer_load_dwordx4 v[72:75], v192, s[48:51], s23 offen offset:3072 sc1
    v_mfma_f32_16x16x32_bf16 v[116:119], v[80:83], v[244:247], v[116:119]
    s_add_u32 s23, s23, 36864
    v_mfma_f32_16x16x32_bf16 v[148:151], v[84:87], v[248:251], v[116:119]
    v_add_u32 v12, s7, v184
    s_add_u32 s25, s25, 1
    s_waitcnt lgkmcnt(0)
    s_barrier
    v_pk_mul_f32 v[152:153], v[120:121], v[120:121]
    ds_read_b128 a[56:59], v10 offset:14336
    v_pk_mul_f32 v[154:155], v[122:123], v[122:123]
    ds_read_b128 a[128:131], v10 offset:32768
    v_pk_fma_f32 v[152:153], v[152:153], v[8:9], v[4:5] op_sel:[0,0,0] op_sel_hi:[1,0,0]
    ds_read_b128 a[200:203], v11 offset:14336
    v_pk_fma_f32 v[154:155], v[154:155], v[8:9], v[4:5] op_sel:[0,0,0] op_sel_hi:[1,0,0]
    v_pk_mul_f32 v[152:153], v[120:121], v[152:153]
    ds_read_b128 v[236:239], v11 offset:32768
    v_pk_mul_f32 v[154:155], v[122:123], v[154:155]
    ds_read_b128 a[60:63], v10 offset:15360
    buffer_load_dwordx4 v[76:79], v184, s[48:51], s23 offen offset:0 sc1
    v_exp_f32 v152, v152
    ds_read_b128 a[132:135], v10 offset:33792
    v_exp_f32 v153, v153
    v_exp_f32 v154, v154
    ds_read_b128 a[204:207], v11 offset:15360
    v_exp_f32 v155, v155
    ds_read_b128 v[240:243], v11 offset:33792
    v_pk_mul_f32 v[156:157], v[120:121], v[136:137]
    v_pk_mul_f32 v[158:159], v[122:123], v[138:139]
    buffer_load_dwordx4 v[80:83], v184, s[48:51], s23 offen offset:1024 sc1
    v_pk_fma_f32 v[152:153], v[152:153], v[192:193], v[192:193] op_sel:[0,1,1] op_sel_hi:[1,1,1]
    v_pk_fma_f32 v[154:155], v[154:155], v[192:193], v[192:193] op_sel:[0,1,1] op_sel_hi:[1,1,1]
    v_rcp_f32 v152, v152
    v_rcp_f32 v153, v153
    v_rcp_f32 v154, v154
    v_rcp_f32 v155, v155
    buffer_load_dwordx4 v[84:87], v184, s[48:51], s23 offen offset:2048 sc1
    s_nop 0
    v_pk_mul_f32 v[156:157], v[156:157], v[152:153]
    v_pk_mul_f32 v[158:159], v[158:159], v[154:155]
    v_cvt_pk_bf16_f32 v160, v156, v157
    v_cvt_pk_bf16_f32 v161, v158, v159
    ds_write_b64 v12, v[160:161] offset:0
    buffer_load_dwordx4 v[104:107], v184, s[48:51], s23 offen offset:3072 sc1
    v_pk_mul_f32 v[162:163], v[124:125], v[124:125]
    v_pk_mul_f32 v[164:165], v[126:127], v[126:127]
    v_pk_fma_f32 v[162:163], v[162:163], v[8:9], v[4:5] op_sel:[0,1,1] op_sel_hi:[1,1,1]
    v_pk_fma_f32 v[164:165], v[164:165], v[8:9], v[4:5] op_sel:[0,1,1] op_sel_hi:[1,1,1]
    v_pk_mul_f32 v[162:163], v[124:125], v[162:163]
    v_pk_mul_f32 v[164:165], v[126:127], v[164:165]
    buffer_load_dwordx4 v[108:111], v185, s[48:51], s23 offen offset:0 sc1
    v_exp_f32 v162, v162
    v_exp_f32 v163, v163
    v_exp_f32 v164, v164
    v_exp_f32 v165, v165
    v_pk_mul_f32 v[166:167], v[124:125], v[140:141]
    v_pk_mul_f32 v[168:169], v[126:127], v[142:143]
    buffer_load_dwordx4 v[112:115], v185, s[48:51], s23 offen offset:1024 sc1
    v_pk_fma_f32 v[162:163], v[162:163], v[194:195], v[194:195] op_sel:[0,0,0] op_sel_hi:[1,0,0]
    v_pk_fma_f32 v[164:165], v[164:165], v[194:195], v[194:195] op_sel:[0,0,0] op_sel_hi:[1,0,0]
    v_rcp_f32 v162, v162
    v_rcp_f32 v163, v163
    v_rcp_f32 v164, v164
    v_rcp_f32 v165, v165
    buffer_load_dwordx4 v[116:119], v185, s[48:51], s23 offen offset:2048 sc1
    s_nop 0
    v_pk_mul_f32 v[166:167], v[166:167], v[162:163]
    v_pk_mul_f32 v[168:169], v[168:169], v[164:165]
    v_cvt_pk_bf16_f32 v170, v166, v167
    v_cvt_pk_bf16_f32 v171, v168, v169
    ds_write_b64 v12, v[170:171] offset:18432
    buffer_load_dwordx4 v[180:183], v185, s[48:51], s23 offen offset:3072 sc1
    v_pk_mul_f32 v[152:153], v[128:129], v[128:129]
    v_pk_mul_f32 v[154:155], v[130:131], v[130:131]
    v_pk_fma_f32 v[152:153], v[152:153], v[12:13], v[6:7] op_sel:[0,1,0] op_sel_hi:[1,1,0]
    v_pk_fma_f32 v[154:155], v[154:155], v[12:13], v[6:7] op_sel:[0,1,0] op_sel_hi:[1,1,0]
    v_pk_mul_f32 v[152:153], v[128:129], v[152:153]
    v_pk_mul_f32 v[154:155], v[130:131], v[154:155]
    buffer_load_dwordx4 v[196:199], v186, s[48:51], s23 offen offset:0 sc1
    v_exp_f32 v152, v152
    v_exp_f32 v153, v153
    v_exp_f32 v154, v154
    v_exp_f32 v155, v155
    v_pk_mul_f32 v[156:157], v[128:129], v[144:145]
    v_pk_mul_f32 v[158:159], v[130:131], v[146:147]
    buffer_load_dwordx4 v[200:203], v186, s[48:51], s23 offen offset:1024 sc1
    v_pk_fma_f32 v[152:153], v[152:153], v[194:195], v[194:195] op_sel:[0,1,1] op_sel_hi:[1,1,1]
    v_pk_fma_f32 v[154:155], v[154:155], v[194:195], v[194:195] op_sel:[0,1,1] op_sel_hi:[1,1,1]
    v_rcp_f32 v152, v152
    v_rcp_f32 v153, v153
    v_rcp_f32 v154, v154
    v_rcp_f32 v155, v155
    buffer_load_dwordx4 v[204:207], v186, s[48:51], s23 offen offset:2048 sc1
    s_nop 0
    v_pk_mul_f32 v[156:157], v[156:157], v[152:153]
    v_pk_mul_f32 v[158:159], v[158:159], v[154:155]
    v_cvt_pk_bf16_f32 v160, v156, v157
    v_cvt_pk_bf16_f32 v161, v158, v159
    ds_write_b64 v12, v[160:161] offset:36864
    buffer_load_dwordx4 v[208:211], v186, s[48:51], s23 offen offset:3072 sc1
    v_pk_mul_f32 v[162:163], v[132:133], v[132:133]
    v_pk_mul_f32 v[164:165], v[134:135], v[134:135]
    v_pk_fma_f32 v[162:163], v[162:163], v[14:15], v[6:7] op_sel:[0,0,1] op_sel_hi:[1,0,1]
    v_pk_fma_f32 v[164:165], v[164:165], v[14:15], v[6:7] op_sel:[0,0,1] op_sel_hi:[1,0,1]
    v_pk_mul_f32 v[162:163], v[132:133], v[162:163]
    v_pk_mul_f32 v[164:165], v[134:135], v[164:165]
    buffer_load_dwordx4 v[212:215], v187, s[48:51], s23 offen offset:0 sc1
    v_exp_f32 v162, v162
    v_exp_f32 v163, v163
    v_exp_f32 v164, v164
    v_exp_f32 v165, v165
    v_pk_mul_f32 v[166:167], v[132:133], v[148:149]
    v_pk_mul_f32 v[168:169], v[134:135], v[150:151]
    v_pk_fma_f32 v[162:163], v[162:163], v[252:253], v[252:253] op_sel:[0,0,0] op_sel_hi:[1,0,0]
    v_pk_fma_f32 v[164:165], v[164:165], v[252:253], v[252:253] op_sel:[0,0,0] op_sel_hi:[1,0,0]
    v_rcp_f32 v162, v162
    v_rcp_f32 v163, v163
    v_rcp_f32 v164, v164
    v_rcp_f32 v165, v165
    s_nop 0
    v_pk_mul_f32 v[166:167], v[166:167], v[162:163]
    v_pk_mul_f32 v[168:169], v[168:169], v[164:165]
    v_cvt_pk_bf16_f32 v170, v166, v167
    v_cvt_pk_bf16_f32 v171, v168, v169
    ds_write_b64 v12, v[170:171] offset:55296
    buffer_load_dwordx4 v[136:139], v187, s[48:51], s23 offen offset:1024 sc1
    buffer_load_dwordx4 v[140:143], v187, s[48:51], s23 offen offset:2048 sc1
    buffer_load_dwordx4 v[144:147], v187, s[48:51], s23 offen offset:3072 sc1
    buffer_load_dwordx4 v[160:163], v188, s[48:51], s23 offen offset:0 sc1
    buffer_load_dwordx4 v[164:167], v188, s[48:51], s23 offen offset:1024 sc1
    s_add_u32 s23, s23, 18432
    s_waitcnt lgkmcnt(0)
    s_barrier
    ds_read_b128 a[64:67], v10 offset:16384
    ds_read_b128 a[136:139], v10 offset:34816
    ds_read_b128 a[208:211], v11 offset:16384
    ds_read_b128 v[244:247], v11 offset:34816
    ds_read_b128 a[68:71], v10 offset:17408
    ds_read_b128 a[140:143], v10 offset:35840
    ds_read_b128 a[212:215], v11 offset:17408
    ds_read_b128 v[248:251], v11 offset:35840
    s_mov_b32 s25, 0
    s_waitcnt lgkmcnt(0)
    s_branch L_ffn_dn_mid_36
L_ffn_dn_35:
    s_waitcnt vmcnt(32)
    v_mfma_f32_16x16x32_bf16 v[88:91], v[104:107], a[0:3], 0
    v_mfma_f32_16x16x32_bf16 v[88:91], v[108:111], a[4:7], v[88:91]
    buffer_load_dwordx4 v[76:79], v184, s[48:51], s23 offen offset:0 sc1
    v_mfma_f32_16x16x32_bf16 v[88:91], v[112:115], a[8:11], v[88:91]
    v_mfma_f32_16x16x32_bf16 v[92:95], v[104:107], a[72:75], 0
    v_mfma_f32_16x16x32_bf16 v[92:95], v[108:111], a[76:79], v[92:95]
    v_mfma_f32_16x16x32_bf16 v[92:95], v[112:115], a[80:83], v[92:95]
    buffer_load_dwordx4 v[80:83], v184, s[48:51], s23 offen offset:1024 sc1
    v_mfma_f32_16x16x32_bf16 v[96:99], v[104:107], a[144:147], 0
    v_cvt_pk_bf16_f32 v152, v120, v121
    v_cvt_pk_bf16_f32 v153, v122, v123
    v_mfma_f32_16x16x32_bf16 v[96:99], v[108:111], a[148:151], v[96:99]
    v_cvt_pk_bf16_f32 v154, v124, v125
    v_cvt_pk_bf16_f32 v155, v126, v127
    v_mfma_f32_16x16x32_bf16 v[96:99], v[112:115], a[152:155], v[96:99]
    s_nop 0
    v_permlane16_swap_b32 v152, v154
    v_mfma_f32_16x16x32_bf16 v[100:103], v[104:107], a[216:219], 0
    buffer_load_dwordx4 v[84:87], v184, s[48:51], s23 offen offset:2048 sc1
    v_mfma_f32_16x16x32_bf16 v[100:103], v[108:111], a[220:223], v[100:103]
    v_permlane16_swap_b32 v153, v155
    v_mfma_f32_16x16x32_bf16 v[100:103], v[112:115], a[224:227], v[100:103]
    buffer_store_dwordx4 v[152:155], v178, s[72:75], s27 offen sc1
    s_waitcnt vmcnt(33)
    v_mfma_f32_16x16x32_bf16 v[88:91], v[116:119], a[12:15], v[88:91]
    ds_write_b128 v216, v[152:155]
    v_mfma_f32_16x16x32_bf16 v[88:91], v[180:183], a[16:19], v[88:91]
    buffer_load_dwordx4 v[104:107], v184, s[48:51], s23 offen offset:3072 sc1
    v_mfma_f32_16x16x32_bf16 v[88:91], v[196:199], a[20:23], v[88:91]
    v_add_u32 v216, v216, v218
    v_mfma_f32_16x16x32_bf16 v[92:95], v[116:119], a[84:87], v[92:95]
    v_mfma_f32_16x16x32_bf16 v[92:95], v[180:183], a[88:91], v[92:95]
    v_mfma_f32_16x16x32_bf16 v[92:95], v[196:199], a[92:95], v[92:95]
    buffer_load_dwordx4 v[108:111], v185, s[48:51], s23 offen offset:0 sc1
    v_mfma_f32_16x16x32_bf16 v[96:99], v[116:119], a[156:159], v[96:99]
    v_mfma_f32_16x16x32_bf16 v[96:99], v[180:183], a[160:163], v[96:99]
    v_mfma_f32_16x16x32_bf16 v[96:99], v[196:199], a[164:167], v[96:99]
    v_mfma_f32_16x16x32_bf16 v[100:103], v[116:119], a[228:231], v[100:103]
    buffer_load_dwordx4 v[112:115], v185, s[48:51], s23 offen offset:1024 sc1
    v_mfma_f32_16x16x32_bf16 v[100:103], v[180:183], a[232:235], v[100:103]
    v_mfma_f32_16x16x32_bf16 v[100:103], v[196:199], a[236:239], v[100:103]
    s_waitcnt vmcnt(33)
    v_mfma_f32_16x16x32_bf16 v[88:91], v[200:203], a[24:27], v[88:91]
    v_mfma_f32_16x16x32_bf16 v[88:91], v[204:207], a[28:31], v[88:91]
    buffer_load_dwordx4 v[116:119], v185, s[48:51], s23 offen offset:2048 sc1
    v_mfma_f32_16x16x32_bf16 v[88:91], v[208:211], a[32:35], v[88:91]
    v_mfma_f32_16x16x32_bf16 v[92:95], v[200:203], a[96:99], v[92:95]
    v_mfma_f32_16x16x32_bf16 v[92:95], v[204:207], a[100:103], v[92:95]
    v_mfma_f32_16x16x32_bf16 v[92:95], v[208:211], a[104:107], v[92:95]
    buffer_load_dwordx4 v[180:183], v185, s[48:51], s23 offen offset:3072 sc1
    v_mfma_f32_16x16x32_bf16 v[96:99], v[200:203], a[168:171], v[96:99]
    v_mfma_f32_16x16x32_bf16 v[96:99], v[204:207], a[172:175], v[96:99]
    v_mfma_f32_16x16x32_bf16 v[96:99], v[208:211], a[176:179], v[96:99]
    v_mfma_f32_16x16x32_bf16 v[100:103], v[200:203], a[240:243], v[100:103]
    buffer_load_dwordx4 v[196:199], v186, s[48:51], s23 offen offset:0 sc1
    v_mfma_f32_16x16x32_bf16 v[100:103], v[204:207], a[244:247], v[100:103]
    v_mfma_f32_16x16x32_bf16 v[100:103], v[208:211], a[248:251], v[100:103]
    s_waitcnt vmcnt(33)
    v_mfma_f32_16x16x32_bf16 v[88:91], v[212:215], a[36:39], v[88:91]
    v_mfma_f32_16x16x32_bf16 v[88:91], v[136:139], a[40:43], v[88:91]
    buffer_load_dwordx4 v[200:203], v186, s[48:51], s23 offen offset:1024 sc1
    v_mfma_f32_16x16x32_bf16 v[88:91], v[140:143], a[44:47], v[88:91]
    v_mfma_f32_16x16x32_bf16 v[92:95], v[212:215], a[108:111], v[92:95]
    v_mfma_f32_16x16x32_bf16 v[92:95], v[136:139], a[112:115], v[92:95]
    v_cvt_pk_bf16_f32 v156, v128, v129
    v_cvt_pk_bf16_f32 v157, v130, v131
    v_mfma_f32_16x16x32_bf16 v[92:95], v[140:143], a[116:119], v[92:95]
    buffer_load_dwordx4 v[204:207], v186, s[48:51], s23 offen offset:2048 sc1
    v_mfma_f32_16x16x32_bf16 v[96:99], v[212:215], a[180:183], v[96:99]
    v_cvt_pk_bf16_f32 v158, v132, v133
    v_cvt_pk_bf16_f32 v159, v134, v135
    v_mfma_f32_16x16x32_bf16 v[96:99], v[136:139], a[184:187], v[96:99]
    s_nop 0
    v_permlane16_swap_b32 v156, v158
    v_mfma_f32_16x16x32_bf16 v[96:99], v[140:143], a[188:191], v[96:99]
    v_permlane16_swap_b32 v157, v159
    v_mfma_f32_16x16x32_bf16 v[100:103], v[212:215], a[252:255], v[100:103]
    buffer_load_dwordx4 v[208:211], v186, s[48:51], s23 offen offset:3072 sc1
    v_mfma_f32_16x16x32_bf16 v[100:103], v[136:139], v[220:223], v[100:103]
    buffer_store_dwordx4 v[156:159], v179, s[72:75], s27 offen sc1
    v_mfma_f32_16x16x32_bf16 v[100:103], v[140:143], v[224:227], v[100:103]
    ds_write_b128 v217, v[156:159]
    s_waitcnt vmcnt(34)
    v_mfma_f32_16x16x32_bf16 v[88:91], v[144:147], a[48:51], v[88:91]
    v_add_u32 v217, v217, v219
    v_mfma_f32_16x16x32_bf16 v[88:91], v[160:163], a[52:55], v[88:91]
    buffer_load_dwordx4 v[212:215], v187, s[48:51], s23 offen offset:0 sc1
    v_mfma_f32_16x16x32_bf16 v[88:91], v[164:167], a[56:59], v[88:91]
    v_mfma_f32_16x16x32_bf16 v[92:95], v[144:147], a[120:123], v[92:95]
    v_mfma_f32_16x16x32_bf16 v[92:95], v[160:163], a[124:127], v[92:95]
    v_mfma_f32_16x16x32_bf16 v[92:95], v[164:167], a[128:131], v[92:95]
    buffer_load_dwordx4 v[136:139], v187, s[48:51], s23 offen offset:1024 sc1
    v_mfma_f32_16x16x32_bf16 v[96:99], v[144:147], a[192:195], v[96:99]
    v_mfma_f32_16x16x32_bf16 v[96:99], v[160:163], a[196:199], v[96:99]
    v_mfma_f32_16x16x32_bf16 v[96:99], v[164:167], a[200:203], v[96:99]
    v_mfma_f32_16x16x32_bf16 v[100:103], v[144:147], v[228:231], v[100:103]
    buffer_load_dwordx4 v[140:143], v187, s[48:51], s23 offen offset:2048 sc1
    v_mfma_f32_16x16x32_bf16 v[100:103], v[160:163], v[232:235], v[100:103]
    v_mfma_f32_16x16x32_bf16 v[100:103], v[164:167], v[236:239], v[100:103]
    s_waitcnt vmcnt(34)
    v_mfma_f32_16x16x32_bf16 v[88:91], v[168:171], a[60:63], v[88:91]
    v_mfma_f32_16x16x32_bf16 v[88:91], v[148:151], a[64:67], v[88:91]
    buffer_load_dwordx4 v[144:147], v187, s[48:51], s23 offen offset:3072 sc1
    v_mfma_f32_16x16x32_bf16 v[120:123], v[4:7], a[68:71], v[88:91]
    v_mfma_f32_16x16x32_bf16 v[92:95], v[168:171], a[132:135], v[92:95]
    v_mfma_f32_16x16x32_bf16 v[92:95], v[148:151], a[136:139], v[92:95]
    v_mfma_f32_16x16x32_bf16 v[124:127], v[4:7], a[140:143], v[92:95]
    buffer_load_dwordx4 v[160:163], v188, s[48:51], s23 offen offset:0 sc1
    v_mfma_f32_16x16x32_bf16 v[96:99], v[168:171], a[204:207], v[96:99]
    s_mov_b32 s74, 268435456
    v_mfma_f32_16x16x32_bf16 v[96:99], v[148:151], a[208:211], v[96:99]
    s_add_u32 s27, s27, 1024
    v_mfma_f32_16x16x32_bf16 v[128:131], v[4:7], a[212:215], v[96:99]
    s_add_u32 s25, s25, 1
    v_mfma_f32_16x16x32_bf16 v[100:103], v[168:171], v[240:243], v[100:103]
    buffer_load_dwordx4 v[164:167], v188, s[48:51], s23 offen offset:1024 sc1
    v_mfma_f32_16x16x32_bf16 v[100:103], v[148:151], v[244:247], v[100:103]
    s_add_u32 s23, s23, 18432
    v_mfma_f32_16x16x32_bf16 v[132:135], v[4:7], v[248:251], v[100:103]
L_ffn_dn_mid_36:
    s_waitcnt vmcnt(30)
    v_mfma_f32_16x16x32_bf16 v[88:91], v[16:19], a[0:3], 0
    v_mfma_f32_16x16x32_bf16 v[88:91], v[20:23], a[4:7], v[88:91]
    buffer_load_dwordx4 v[168:171], v184, s[48:51], s23 offen offset:0 sc1
    v_mfma_f32_16x16x32_bf16 v[88:91], v[24:27], a[8:11], v[88:91]
    v_mfma_f32_16x16x32_bf16 v[92:95], v[16:19], a[72:75], 0
    v_mfma_f32_16x16x32_bf16 v[92:95], v[20:23], a[76:79], v[92:95]
    v_mfma_f32_16x16x32_bf16 v[92:95], v[24:27], a[80:83], v[92:95]
    buffer_load_dwordx4 v[148:151], v184, s[48:51], s23 offen offset:1024 sc1
    v_mfma_f32_16x16x32_bf16 v[96:99], v[16:19], a[144:147], 0
    v_cvt_pk_bf16_f32 v152, v120, v121
    v_cvt_pk_bf16_f32 v153, v122, v123
    v_mfma_f32_16x16x32_bf16 v[96:99], v[20:23], a[148:151], v[96:99]
    v_cvt_pk_bf16_f32 v154, v124, v125
    v_cvt_pk_bf16_f32 v155, v126, v127
    v_mfma_f32_16x16x32_bf16 v[96:99], v[24:27], a[152:155], v[96:99]
    s_nop 0
    v_permlane16_swap_b32 v152, v154
    v_mfma_f32_16x16x32_bf16 v[100:103], v[16:19], a[216:219], 0
    buffer_load_dwordx4 v[4:7], v184, s[48:51], s23 offen offset:2048 sc1
    v_mfma_f32_16x16x32_bf16 v[100:103], v[20:23], a[220:223], v[100:103]
    v_permlane16_swap_b32 v153, v155
    v_mfma_f32_16x16x32_bf16 v[100:103], v[24:27], a[224:227], v[100:103]
    buffer_store_dwordx4 v[152:155], v178, s[72:75], s27 offen sc1
    s_waitcnt vmcnt(31)
    v_mfma_f32_16x16x32_bf16 v[88:91], v[28:31], a[12:15], v[88:91]
    ds_write_b128 v216, v[152:155]
    v_mfma_f32_16x16x32_bf16 v[88:91], v[32:35], a[16:19], v[88:91]
    buffer_load_dwordx4 v[16:19], v184, s[48:51], s23 offen offset:3072 sc1
    v_mfma_f32_16x16x32_bf16 v[88:91], v[36:39], a[20:23], v[88:91]
    v_add_u32 v216, v216, v218
    v_mfma_f32_16x16x32_bf16 v[92:95], v[28:31], a[84:87], v[92:95]
    v_mfma_f32_16x16x32_bf16 v[92:95], v[32:35], a[88:91], v[92:95]
    v_mfma_f32_16x16x32_bf16 v[92:95], v[36:39], a[92:95], v[92:95]
    buffer_load_dwordx4 v[20:23], v185, s[48:51], s23 offen offset:0 sc1
    v_mfma_f32_16x16x32_bf16 v[96:99], v[28:31], a[156:159], v[96:99]
    v_mfma_f32_16x16x32_bf16 v[96:99], v[32:35], a[160:163], v[96:99]
    v_mfma_f32_16x16x32_bf16 v[96:99], v[36:39], a[164:167], v[96:99]
    v_mfma_f32_16x16x32_bf16 v[100:103], v[28:31], a[228:231], v[100:103]
    buffer_load_dwordx4 v[24:27], v185, s[48:51], s23 offen offset:1024 sc1
    v_mfma_f32_16x16x32_bf16 v[100:103], v[32:35], a[232:235], v[100:103]
    v_mfma_f32_16x16x32_bf16 v[100:103], v[36:39], a[236:239], v[100:103]
    s_waitcnt vmcnt(31)
    v_mfma_f32_16x16x32_bf16 v[88:91], v[40:43], a[24:27], v[88:91]
    v_mfma_f32_16x16x32_bf16 v[88:91], v[44:47], a[28:31], v[88:91]
    buffer_load_dwordx4 v[28:31], v185, s[48:51], s23 offen offset:2048 sc1
    v_mfma_f32_16x16x32_bf16 v[88:91], v[48:51], a[32:35], v[88:91]
    v_mfma_f32_16x16x32_bf16 v[92:95], v[40:43], a[96:99], v[92:95]
    v_mfma_f32_16x16x32_bf16 v[92:95], v[44:47], a[100:103], v[92:95]
    v_mfma_f32_16x16x32_bf16 v[92:95], v[48:51], a[104:107], v[92:95]
    buffer_load_dwordx4 v[32:35], v185, s[48:51], s23 offen offset:3072 sc1
    v_mfma_f32_16x16x32_bf16 v[96:99], v[40:43], a[168:171], v[96:99]
    v_mfma_f32_16x16x32_bf16 v[96:99], v[44:47], a[172:175], v[96:99]
    v_mfma_f32_16x16x32_bf16 v[96:99], v[48:51], a[176:179], v[96:99]
    v_mfma_f32_16x16x32_bf16 v[100:103], v[40:43], a[240:243], v[100:103]
    buffer_load_dwordx4 v[36:39], v186, s[48:51], s23 offen offset:0 sc1
    v_mfma_f32_16x16x32_bf16 v[100:103], v[44:47], a[244:247], v[100:103]
    v_mfma_f32_16x16x32_bf16 v[100:103], v[48:51], a[248:251], v[100:103]
    s_waitcnt vmcnt(31)
    s_cmp_lg_u32 s25, 6
    s_cbranch_scc1 L_early_37
    s_waitcnt vmcnt(16)
    s_barrier
    s_cmp_lg_u32 s3, 0
    s_cbranch_scc1 L_early_37
    v_lshlrev_b32 v15, 7, v0
    v_mov_b32 v1, s76
    s_mov_b64 exec, 0xff
    buffer_store_dword v1, v15, s[8:11], s29 offen sc1
    s_mov_b64 exec, -1
L_early_37:
    v_mfma_f32_16x16x32_bf16 v[88:91], v[52:55], a[36:39], v[88:91]
    v_mfma_f32_16x16x32_bf16 v[88:91], v[56:59], a[40:43], v[88:91]
    buffer_load_dwordx4 v[40:43], v186, s[48:51], s23 offen offset:1024 sc1
    v_mfma_f32_16x16x32_bf16 v[88:91], v[60:63], a[44:47], v[88:91]
    v_mfma_f32_16x16x32_bf16 v[92:95], v[52:55], a[108:111], v[92:95]
    v_mfma_f32_16x16x32_bf16 v[92:95], v[56:59], a[112:115], v[92:95]
    v_cvt_pk_bf16_f32 v156, v128, v129
    v_cvt_pk_bf16_f32 v157, v130, v131
    v_mfma_f32_16x16x32_bf16 v[92:95], v[60:63], a[116:119], v[92:95]
    buffer_load_dwordx4 v[44:47], v186, s[48:51], s23 offen offset:2048 sc1
    v_mfma_f32_16x16x32_bf16 v[96:99], v[52:55], a[180:183], v[96:99]
    v_cvt_pk_bf16_f32 v158, v132, v133
    v_cvt_pk_bf16_f32 v159, v134, v135
    v_mfma_f32_16x16x32_bf16 v[96:99], v[56:59], a[184:187], v[96:99]
    s_nop 0
    v_permlane16_swap_b32 v156, v158
    v_mfma_f32_16x16x32_bf16 v[96:99], v[60:63], a[188:191], v[96:99]
    v_permlane16_swap_b32 v157, v159
    v_mfma_f32_16x16x32_bf16 v[100:103], v[52:55], a[252:255], v[100:103]
    buffer_load_dwordx4 v[48:51], v186, s[48:51], s23 offen offset:3072 sc1
    v_mfma_f32_16x16x32_bf16 v[100:103], v[56:59], v[220:223], v[100:103]
    buffer_store_dwordx4 v[156:159], v179, s[72:75], s27 offen sc1
    v_mfma_f32_16x16x32_bf16 v[100:103], v[60:63], v[224:227], v[100:103]
    ds_write_b128 v217, v[156:159]
    s_waitcnt vmcnt(32)
    v_mfma_f32_16x16x32_bf16 v[88:91], v[64:67], a[48:51], v[88:91]
    v_add_u32 v217, v217, v219
    v_mfma_f32_16x16x32_bf16 v[88:91], v[68:71], a[52:55], v[88:91]
    buffer_load_dwordx4 v[52:55], v187, s[48:51], s23 offen offset:0 sc1
    v_mfma_f32_16x16x32_bf16 v[88:91], v[72:75], a[56:59], v[88:91]
    v_mfma_f32_16x16x32_bf16 v[92:95], v[64:67], a[120:123], v[92:95]
    v_mfma_f32_16x16x32_bf16 v[92:95], v[68:71], a[124:127], v[92:95]
    v_mfma_f32_16x16x32_bf16 v[92:95], v[72:75], a[128:131], v[92:95]
    buffer_load_dwordx4 v[56:59], v187, s[48:51], s23 offen offset:1024 sc1
    v_mfma_f32_16x16x32_bf16 v[96:99], v[64:67], a[192:195], v[96:99]
    v_mfma_f32_16x16x32_bf16 v[96:99], v[68:71], a[196:199], v[96:99]
    v_mfma_f32_16x16x32_bf16 v[96:99], v[72:75], a[200:203], v[96:99]
    v_mfma_f32_16x16x32_bf16 v[100:103], v[64:67], v[228:231], v[100:103]
    buffer_load_dwordx4 v[60:63], v187, s[48:51], s23 offen offset:2048 sc1
    v_mfma_f32_16x16x32_bf16 v[100:103], v[68:71], v[232:235], v[100:103]
    v_mfma_f32_16x16x32_bf16 v[100:103], v[72:75], v[236:239], v[100:103]
    s_waitcnt vmcnt(32)
    v_mfma_f32_16x16x32_bf16 v[88:91], v[76:79], a[60:63], v[88:91]
    v_mfma_f32_16x16x32_bf16 v[88:91], v[80:83], a[64:67], v[88:91]
    buffer_load_dwordx4 v[64:67], v187, s[48:51], s23 offen offset:3072 sc1
    v_mfma_f32_16x16x32_bf16 v[120:123], v[84:87], a[68:71], v[88:91]
    v_mfma_f32_16x16x32_bf16 v[92:95], v[76:79], a[132:135], v[92:95]
    v_mfma_f32_16x16x32_bf16 v[92:95], v[80:83], a[136:139], v[92:95]
    v_mfma_f32_16x16x32_bf16 v[124:127], v[84:87], a[140:143], v[92:95]
    buffer_load_dwordx4 v[68:71], v188, s[48:51], s23 offen offset:0 sc1
    v_mfma_f32_16x16x32_bf16 v[96:99], v[76:79], a[204:207], v[96:99]
    s_mov_b32 s74, 268435456
    v_mfma_f32_16x16x32_bf16 v[96:99], v[80:83], a[208:211], v[96:99]
    s_add_u32 s27, s27, 1024
    v_mfma_f32_16x16x32_bf16 v[128:131], v[84:87], a[212:215], v[96:99]
    s_add_u32 s25, s25, 1
    v_mfma_f32_16x16x32_bf16 v[100:103], v[76:79], v[240:243], v[100:103]
    buffer_load_dwordx4 v[72:75], v188, s[48:51], s23 offen offset:1024 sc1
    v_mfma_f32_16x16x32_bf16 v[100:103], v[80:83], v[244:247], v[100:103]
    s_add_u32 s23, s23, 18432
    v_mfma_f32_16x16x32_bf16 v[132:135], v[84:87], v[248:251], v[100:103]
    s_cmp_lt_u32 s25, 7
    s_cbranch_scc1 L_ffn_dn_35
    s_waitcnt vmcnt(33)
    v_mfma_f32_16x16x32_bf16 v[88:91], v[104:107], a[0:3], 0
    v_mfma_f32_16x16x32_bf16 v[88:91], v[108:111], a[4:7], v[88:91]
    buffer_load_dwordx4 v[76:79], v184, s[48:51], s23 offen offset:0 sc1
    v_mfma_f32_16x16x32_bf16 v[88:91], v[112:115], a[8:11], v[88:91]
    v_mfma_f32_16x16x32_bf16 v[92:95], v[104:107], a[72:75], 0
    v_mfma_f32_16x16x32_bf16 v[92:95], v[108:111], a[76:79], v[92:95]
    v_mfma_f32_16x16x32_bf16 v[92:95], v[112:115], a[80:83], v[92:95]
    buffer_load_dwordx4 v[80:83], v184, s[48:51], s23 offen offset:1024 sc1
    v_mfma_f32_16x16x32_bf16 v[96:99], v[104:107], a[144:147], 0
    v_cvt_pk_bf16_f32 v152, v120, v121
    v_cvt_pk_bf16_f32 v153, v122, v123
    v_mfma_f32_16x16x32_bf16 v[96:99], v[108:111], a[148:151], v[96:99]
    v_cvt_pk_bf16_f32 v154, v124, v125
    v_cvt_pk_bf16_f32 v155, v126, v127
    v_mfma_f32_16x16x32_bf16 v[96:99], v[112:115], a[152:155], v[96:99]
    s_nop 0
    v_permlane16_swap_b32 v152, v154
    v_mfma_f32_16x16x32_bf16 v[100:103], v[104:107], a[216:219], 0
    buffer_load_dwordx4 v[84:87], v184, s[48:51], s23 offen offset:2048 sc1
    v_mfma_f32_16x16x32_bf16 v[100:103], v[108:111], a[220:223], v[100:103]
    v_permlane16_swap_b32 v153, v155
    v_mfma_f32_16x16x32_bf16 v[100:103], v[112:115], a[224:227], v[100:103]
    buffer_store_dwordx4 v[152:155], v178, s[72:75], s27 offen sc1
    s_waitcnt vmcnt(34)
    v_mfma_f32_16x16x32_bf16 v[88:91], v[116:119], a[12:15], v[88:91]
    ds_write_b128 v216, v[152:155]
    v_mfma_f32_16x16x32_bf16 v[88:91], v[180:183], a[16:19], v[88:91]
    v_add_u32 v216, v216, v218
    v_cvt_pk_bf16_f32 v156, v128, v129
    v_mfma_f32_16x16x32_bf16 v[88:91], v[196:199], a[20:23], v[88:91]
    v_cvt_pk_bf16_f32 v157, v130, v131
    v_cvt_pk_bf16_f32 v158, v132, v133
    s_load_dwordx8 s[56:63], s[38:39], 0 glc
    v_mfma_f32_16x16x32_bf16 v[92:95], v[116:119], a[84:87], v[92:95]
    v_cvt_pk_bf16_f32 v159, v134, v135
    s_mov_b32 s6, 0
    v_mfma_f32_16x16x32_bf16 v[92:95], v[180:183], a[88:91], v[92:95]
    s_nop 0
    v_permlane16_swap_b32 v156, v158
    v_mfma_f32_16x16x32_bf16 v[92:95], v[196:199], a[92:95], v[92:95]
    v_permlane16_swap_b32 v157, v159
    v_mfma_f32_16x16x32_bf16 v[96:99], v[116:119], a[156:159], v[96:99]
    buffer_store_dwordx4 v[156:159], v179, s[72:75], s27 offen sc1
    v_mfma_f32_16x16x32_bf16 v[96:99], v[180:183], a[160:163], v[96:99]
    ds_write_b128 v217, v[156:159]
    v_mfma_f32_16x16x32_bf16 v[96:99], v[196:199], a[164:167], v[96:99]
    v_add_u32 v217, v217, v219
    v_mfma_f32_16x16x32_bf16 v[100:103], v[116:119], a[228:231], v[100:103]
    v_mfma_f32_16x16x32_bf16 v[100:103], v[180:183], a[232:235], v[100:103]
    v_mfma_f32_16x16x32_bf16 v[100:103], v[196:199], a[236:239], v[100:103]
    s_waitcnt vmcnt(32)
L_epoll_38:
    s_waitcnt lgkmcnt(0)
    s_xor_b64 s[56:57], s[56:57], s[76:77]
    s_xor_b64 s[58:59], s[58:59], s[76:77]
    s_xor_b64 s[60:61], s[60:61], s[76:77]
    s_xor_b64 s[62:63], s[62:63], s[76:77]
    s_or_b64 s[56:57], s[56:57], s[58:59]
    s_or_b64 s[60:61], s[60:61], s[62:63]
    s_or_b64 s[56:57], s[56:57], s[60:61]
    s_cbranch_scc0 L_epolled_39
    s_load_dwordx8 s[56:63], s[38:39], 0 glc
    s_add_u32 s6, s6, 1
    s_cmp_lt_u32 s6, 1048576
    s_cbranch_scc1 L_epoll_38
    s_branch L_main_end
L_epolled_39:
    v_mfma_f32_16x16x32_bf16 v[88:91], v[200:203], a[24:27], v[88:91]
    v_mfma_f32_16x16x32_bf16 v[88:91], v[204:207], a[28:31], v[88:91]
    s_add_u32 s7, s40, 1
    s_and_b32 s7, s7, 7
    s_mul_i32 s7, s7, 9216
    s_add_u32 s19, s7, s20
    buffer_load_dwordx4 v[104:107], v172, s[8:11], s19 offen sc1
    v_mfma_f32_16x16x32_bf16 v[88:91], v[208:211], a[32:35], v[88:91]
    v_mfma_f32_16x16x32_bf16 v[92:95], v[200:203], a[96:99], v[92:95]
    v_mfma_f32_16x16x32_bf16 v[92:95], v[204:207], a[100:103], v[92:95]
    v_mfma_f32_16x16x32_bf16 v[92:95], v[208:211], a[104:107], v[92:95]
    buffer_load_dwordx4 v[108:111], v173, s[8:11], s19 offen sc1
    v_mfma_f32_16x16x32_bf16 v[96:99], v[200:203], a[168:171], v[96:99]
    v_mfma_f32_16x16x32_bf16 v[96:99], v[204:207], a[172:175], v[96:99]
    v_mfma_f32_16x16x32_bf16 v[96:99], v[208:211], a[176:179], v[96:99]
    v_mfma_f32_16x16x32_bf16 v[100:103], v[200:203], a[240:243], v[100:103]
    s_add_u32 s7, s40, 2
    s_and_b32 s7, s7, 7
    s_mul_i32 s7, s7, 9216
    s_add_u32 s19, s7, s20
    buffer_load_dwordx4 v[112:115], v172, s[8:11], s19 offen sc1
    v_mfma_f32_16x16x32_bf16 v[100:103], v[204:207], a[244:247], v[100:103]
    v_mfma_f32_16x16x32_bf16 v[100:103], v[208:211], a[248:251], v[100:103]
    s_waitcnt vmcnt(31)
    v_mfma_f32_16x16x32_bf16 v[88:91], v[212:215], a[36:39], v[88:91]
    v_mfma_f32_16x16x32_bf16 v[88:91], v[136:139], a[40:43], v[88:91]
    buffer_load_dwordx4 v[116:119], v173, s[8:11], s19 offen sc1
    v_mfma_f32_16x16x32_bf16 v[88:91], v[140:143], a[44:47], v[88:91]
    v_mfma_f32_16x16x32_bf16 v[92:95], v[212:215], a[108:111], v[92:95]
    v_mfma_f32_16x16x32_bf16 v[92:95], v[136:139], a[112:115], v[92:95]
    v_mfma_f32_16x16x32_bf16 v[92:95], v[140:143], a[116:119], v[92:95]
    s_add_u32 s7, s40, 3
    s_and_b32 s7, s7, 7
    s_mul_i32 s7, s7, 9216
    s_add_u32 s19, s7, s20
    buffer_load_dwordx4 v[180:183], v172, s[8:11], s19 offen sc1
    v_mfma_f32_16x16x32_bf16 v[96:99], v[212:215], a[180:183], v[96:99]
    v_mfma_f32_16x16x32_bf16 v[96:99], v[136:139], a[184:187], v[96:99]
    v_mfma_f32_16x16x32_bf16 v[96:99], v[140:143], a[188:191], v[96:99]
    v_mfma_f32_16x16x32_bf16 v[100:103], v[212:215], a[252:255], v[100:103]
    buffer_load_dwordx4 v[196:199], v173, s[8:11], s19 offen sc1
    v_mfma_f32_16x16x32_bf16 v[100:103], v[136:139], v[220:223], v[100:103]
    v_mfma_f32_16x16x32_bf16 v[100:103], v[140:143], v[224:227], v[100:103]
    s_waitcnt vmcnt(31)
    v_mfma_f32_16x16x32_bf16 v[88:91], v[144:147], a[48:51], v[88:91]
    v_mfma_f32_16x16x32_bf16 v[88:91], v[160:163], a[52:55], v[88:91]
    s_add_u32 s7, s40, 4
    s_and_b32 s7, s7, 7
    s_mul_i32 s7, s7, 9216
    s_add_u32 s19, s7, s20
    buffer_load_dwordx4 v[200:203], v172, s[8:11], s19 offen sc1
    v_mfma_f32_16x16x32_bf16 v[88:91], v[164:167], a[56:59], v[88:91]
    v_mfma_f32_16x16x32_bf16 v[92:95], v[144:147], a[120:123], v[92:95]
    v_mfma_f32_16x16x32_bf16 v[92:95], v[160:163], a[124:127], v[92:95]
    v_mfma_f32_16x16x32_bf16 v[92:95], v[164:167], a[128:131], v[92:95]
    buffer_load_dwordx4 v[204:207], v173, s[8:11], s19 offen sc1
    v_mfma_f32_16x16x32_bf16 v[96:99], v[144:147], a[192:195], v[96:99]
    v_mfma_f32_16x16x32_bf16 v[96:99], v[160:163], a[196:199], v[96:99]
    v_mfma_f32_16x16x32_bf16 v[96:99], v[164:167], a[200:203], v[96:99]
    v_mfma_f32_16x16x32_bf16 v[100:103], v[144:147], v[228:231], v[100:103]
    s_add_u32 s7, s40, 5
    s_and_b32 s7, s7, 7
    s_mul_i32 s7, s7, 9216
    s_add_u32 s19, s7, s20
    buffer_load_dwordx4 v[208:211], v172, s[8:11], s19 offen sc1
    v_mfma_f32_16x16x32_bf16 v[100:103], v[160:163], v[232:235], v[100:103]
    v_mfma_f32_16x16x32_bf16 v[100:103], v[164:167], v[236:239], v[100:103]
    s_waitcnt vmcnt(31)
    v_mfma_f32_16x16x32_bf16 v[88:91], v[168:171], a[60:63], v[88:91]
    v_mfma_f32_16x16x32_bf16 v[88:91], v[148:151], a[64:67], v[88:91]
    buffer_load_dwordx4 v[212:215], v173, s[8:11], s19 offen sc1
    v_mfma_f32_16x16x32_bf16 v[120:123], v[4:7], a[68:71], v[88:91]
    v_mfma_f32_16x16x32_bf16 v[92:95], v[168:171], a[132:135], v[92:95]
    v_mfma_f32_16x16x32_bf16 v[92:95], v[148:151], a[136:139], v[92:95]
    v_mfma_f32_16x16x32_bf16 v[124:127], v[4:7], a[140:143], v[92:95]
    s_add_u32 s7, s40, 6
    s_and_b32 s7, s7, 7
    s_mul_i32 s7, s7, 9216
    s_add_u32 s19, s7, s20
    buffer_load_dwordx4 v[136:139], v172, s[8:11], s19 offen sc1
    v_mfma_f32_16x16x32_bf16 v[96:99], v[168:171], a[204:207], v[96:99]
    s_mov_b32 s74, 268435456
    v_mfma_f32_16x16x32_bf16 v[96:99], v[148:151], a[208:211], v[96:99]
    s_add_u32 s27, s27, 1024
    v_mfma_f32_16x16x32_bf16 v[128:131], v[4:7], a[212:215], v[96:99]
    s_add_u32 s25, s25, 1
    v_mfma_f32_16x16x32_bf16 v[100:103], v[168:171], v[240:243], v[100:103]
    buffer_load_dwordx4 v[140:143], v173, s[8:11], s19 offen sc1
    v_mfma_f32_16x16x32_bf16 v[100:103], v[148:151], v[244:247], v[100:103]
    s_add_u32 s23, s23, 18432
    v_mfma_f32_16x16x32_bf16 v[132:135], v[4:7], v[248:251], v[100:103]
    s_waitcnt vmcnt(30)
    v_mfma_f32_16x16x32_bf16 v[88:91], v[16:19], a[0:3], 0
    v_mfma_f32_16x16x32_bf16 v[88:91], v[20:23], a[4:7], v[88:91]
    s_add_u32 s7, s40, 7
    s_and_b32 s7, s7, 7
    s_mul_i32 s7, s7, 9216
    s_add_u32 s19, s7, s20
    buffer_load_dwordx4 v[144:147], v172, s[8:11], s19 offen sc1
    v_mfma_f32_16x16x32_bf16 v[88:91], v[24:27], a[8:11], v[88:91]
    v_mfma_f32_16x16x32_bf16 v[92:95], v[16:19], a[72:75], 0
    v_mfma_f32_16x16x32_bf16 v[92:95], v[20:23], a[76:79], v[92:95]
    v_mfma_f32_16x16x32_bf16 v[92:95], v[24:27], a[80:83], v[92:95]
    buffer_load_dwordx4 v[160:163], v173, s[8:11], s19 offen sc1
    v_mfma_f32_16x16x32_bf16 v[96:99], v[16:19], a[144:147], 0
    v_cvt_pk_bf16_f32 v152, v120, v121
    v_cvt_pk_bf16_f32 v153, v122, v123
    v_mfma_f32_16x16x32_bf16 v[96:99], v[20:23], a[148:151], v[96:99]
    v_cvt_pk_bf16_f32 v154, v124, v125
    v_cvt_pk_bf16_f32 v155, v126, v127
    v_mfma_f32_16x16x32_bf16 v[96:99], v[24:27], a[152:155], v[96:99]
    s_nop 0
    v_permlane16_swap_b32 v152, v154
    v_mfma_f32_16x16x32_bf16 v[100:103], v[16:19], a[216:219], 0
    v_permlane16_swap_b32 v153, v155
    v_mfma_f32_16x16x32_bf16 v[100:103], v[20:23], a[220:223], v[100:103]
    buffer_store_dwordx4 v[152:155], v178, s[72:75], s27 offen sc1
    v_mfma_f32_16x16x32_bf16 v[100:103], v[24:27], a[224:227], v[100:103]
    ds_write_b128 v216, v[152:155]
    s_waitcnt vmcnt(30)
    v_mfma_f32_16x16x32_bf16 v[88:91], v[28:31], a[12:15], v[88:91]
    v_add_u32 v216, v216, v218
    v_cvt_pk_bf16_f32 v156, v128, v129
    v_mfma_f32_16x16x32_bf16 v[88:91], v[32:35], a[16:19], v[88:91]
    v_cvt_pk_bf16_f32 v157, v130, v131
    v_cvt_pk_bf16_f32 v158, v132, v133
    v_mfma_f32_16x16x32_bf16 v[88:91], v[36:39], a[20:23], v[88:91]
    v_cvt_pk_bf16_f32 v159, v134, v135
    v_mfma_f32_16x16x32_bf16 v[92:95], v[28:31], a[84:87], v[92:95]
    s_nop 0
    v_permlane16_swap_b32 v156, v158
    v_mfma_f32_16x16x32_bf16 v[92:95], v[32:35], a[88:91], v[92:95]
    v_permlane16_swap_b32 v157, v159
    v_mfma_f32_16x16x32_bf16 v[92:95], v[36:39], a[92:95], v[92:95]
    buffer_store_dwordx4 v[156:159], v179, s[72:75], s27 offen sc1
    v_mfma_f32_16x16x32_bf16 v[96:99], v[28:31], a[156:159], v[96:99]
    ds_write_b128 v217, v[156:159]
    v_mfma_f32_16x16x32_bf16 v[96:99], v[32:35], a[160:163], v[96:99]
    v_add_u32 v217, v217, v219
    v_mfma_f32_16x16x32_bf16 v[96:99], v[36:39], a[164:167], v[96:99]
    v_mfma_f32_16x16x32_bf16 v[100:103], v[28:31], a[228:231], v[100:103]
    v_mfma_f32_16x16x32_bf16 v[100:103], v[32:35], a[232:235], v[100:103]
    v_mfma_f32_16x16x32_bf16 v[100:103], v[36:39], a[236:239], v[100:103]
    s_waitcnt vmcnt(28)
    v_mfma_f32_16x16x32_bf16 v[88:91], v[40:43], a[24:27], v[88:91]
    v_mfma_f32_16x16x32_bf16 v[88:91], v[44:47], a[28:31], v[88:91]
    v_mfma_f32_16x16x32_bf16 v[88:91], v[48:51], a[32:35], v[88:91]
    v_mfma_f32_16x16x32_bf16 v[92:95], v[40:43], a[96:99], v[92:95]
    v_mfma_f32_16x16x32_bf16 v[92:95], v[44:47], a[100:103], v[92:95]
    v_mfma_f32_16x16x32_bf16 v[92:95], v[48:51], a[104:107], v[92:95]
    v_mfma_f32_16x16x32_bf16 v[96:99], v[40:43], a[168:171], v[96:99]
    v_mfma_f32_16x16x32_bf16 v[96:99], v[44:47], a[172:175], v[96:99]
    v_mfma_f32_16x16x32_bf16 v[96:99], v[48:51], a[176:179], v[96:99]
    v_mfma_f32_16x16x32_bf16 v[100:103], v[40:43], a[240:243], v[100:103]
    v_mfma_f32_16x16x32_bf16 v[100:103], v[44:47], a[244:247], v[100:103]
    v_mfma_f32_16x16x32_bf16 v[100:103], v[48:51], a[248:251], v[100:103]
    s_waitcnt vmcnt(24)
    v_mfma_f32_16x16x32_bf16 v[88:91], v[52:55], a[36:39], v[88:91]
    v_mfma_f32_16x16x32_bf16 v[88:91], v[56:59], a[40:43], v[88:91]
    v_mfma_f32_16x16x32_bf16 v[88:91], v[60:63], a[44:47], v[88:91]
    v_mfma_f32_16x16x32_bf16 v[92:95], v[52:55], a[108:111], v[92:95]
    v_mfma_f32_16x16x32_bf16 v[92:95], v[56:59], a[112:115], v[92:95]
    v_mfma_f32_16x16x32_bf16 v[92:95], v[60:63], a[116:119], v[92:95]
    v_mfma_f32_16x16x32_bf16 v[96:99], v[52:55], a[180:183], v[96:99]
    v_mfma_f32_16x16x32_bf16 v[96:99], v[56:59], a[184:187], v[96:99]
    v_mfma_f32_16x16x32_bf16 v[96:99], v[60:63], a[188:191], v[96:99]
    v_mfma_f32_16x16x32_bf16 v[100:103], v[52:55], a[252:255], v[100:103]
    v_mfma_f32_16x16x32_bf16 v[100:103], v[56:59], v[220:223], v[100:103]
    v_mfma_f32_16x16x32_bf16 v[100:103], v[60:63], v[224:227], v[100:103]
    s_waitcnt vmcnt(21)
    v_mfma_f32_16x16x32_bf16 v[88:91], v[64:67], a[48:51], v[88:91]
    v_mfma_f32_16x16x32_bf16 v[88:91], v[68:71], a[52:55], v[88:91]
    v_mfma_f32_16x16x32_bf16 v[88:91], v[72:75], a[56:59], v[88:91]
    v_mfma_f32_16x16x32_bf16 v[92:95], v[64:67], a[120:123], v[92:95]
    v_mfma_f32_16x16x32_bf16 v[92:95], v[68:71], a[124:127], v[92:95]
    v_mfma_f32_16x16x32_bf16 v[92:95], v[72:75], a[128:131], v[92:95]
    v_mfma_f32_16x16x32_bf16 v[96:99], v[64:67], a[192:195], v[96:99]
    v_mfma_f32_16x16x32_bf16 v[96:99], v[68:71], a[196:199], v[96:99]
    v_mfma_f32_16x16x32_bf16 v[96:99], v[72:75], a[200:203], v[96:99]
    v_mfma_f32_16x16x32_bf16 v[100:103], v[64:67], v[228:231], v[100:103]
    v_mfma_f32_16x16x32_bf16 v[100:103], v[68:71], v[232:235], v[100:103]
    v_mfma_f32_16x16x32_bf16 v[100:103], v[72:75], v[236:239], v[100:103]
    s_waitcnt vmcnt(18)
    v_mfma_f32_16x16x32_bf16 v[88:91], v[76:79], a[60:63], v[88:91]
    v_mfma_f32_16x16x32_bf16 v[88:91], v[80:83], a[64:67], v[88:91]
    v_mfma_f32_16x16x32_bf16 v[120:123], v[84:87], a[68:71], v[88:91]
    v_mfma_f32_16x16x32_bf16 v[92:95], v[76:79], a[132:135], v[92:95]
    v_mfma_f32_16x16x32_bf16 v[92:95], v[80:83], a[136:139], v[92:95]
    v_mfma_f32_16x16x32_bf16 v[124:127], v[84:87], a[140:143], v[92:95]
    v_mfma_f32_16x16x32_bf16 v[96:99], v[76:79], a[204:207], v[96:99]
    s_mov_b32 s74, 268435456
    v_mfma_f32_16x16x32_bf16 v[96:99], v[80:83], a[208:211], v[96:99]
    s_add_u32 s27, s27, 1024
    v_mfma_f32_16x16x32_bf16 v[128:131], v[84:87], a[212:215], v[96:99]
    s_add_u32 s25, s25, 1
    v_mfma_f32_16x16x32_bf16 v[100:103], v[76:79], v[240:243], v[100:103]
    v_mfma_f32_16x16x32_bf16 v[100:103], v[80:83], v[244:247], v[100:103]
    s_add_u32 s23, s23, 18432
    v_mfma_f32_16x16x32_bf16 v[132:135], v[84:87], v[248:251], v[100:103]
    s_nop 7
    v_cvt_pk_bf16_f32 v152, v120, v121
    v_cvt_pk_bf16_f32 v153, v122, v123
    v_cvt_pk_bf16_f32 v154, v124, v125
    v_cvt_pk_bf16_f32 v155, v126, v127
    v_cvt_pk_bf16_f32 v156, v128, v129
    v_cvt_pk_bf16_f32 v157, v130, v131
    v_cvt_pk_bf16_f32 v158, v132, v133
    v_cvt_pk_bf16_f32 v159, v134, v135
    s_nop 0
    v_permlane16_swap_b32 v152, v154
    v_permlane16_swap_b32 v153, v155
    buffer_store_dwordx4 v[152:155], v178, s[72:75], s27 offen sc1
    s_nop 0
    v_permlane16_swap_b32 v156, v158
    v_permlane16_swap_b32 v157, v159
    buffer_store_dwordx4 v[156:159], v179, s[72:75], s27 offen sc1
    ds_write_b128 v216, v[152:155]
    ds_write_b128 v217, v[156:159]
    s_waitcnt lgkmcnt(0)
    v_lshlrev_b32 v15, 7, v0
    s_lshl_b32 s6, s40, 2
    s_add_u32 s6, s6, s44
    s_add_u32 s6, s6, 65536
    v_mov_b32 v1, s76
    s_mov_b64 vcc, 0xff
    s_waitcnt vmcnt(0)
    s_barrier
    s_cmp_lg_u32 s3, 0
    s_cbranch_scc1 L_pub_40
    s_mov_b64 exec, vcc
    buffer_store_dword v1, v15, s[8:11], s6 offen sc1
L_pub_40:
    s_mov_b64 exec, -1
    s_add_u32 s19, s18, s43
    s_add_u32 s22, s19, 45875200
    s_lshl_b32 s23, s21, 5
    s_add_u32 s23, s23, s43
    s_add_u32 s23, s23, 48431104
    v_and_b32 v12, 7, v0
    v_lshlrev_b32 v12, 2, v12
    buffer_load_dword v10, v12, s[8:11], s23 offen sc1
    buffer_load_dwordx4 v[92:95], v172, s[8:11], s22 offen sc1
    buffer_load_dwordx4 v[96:99], v173, s[8:11], s22 offen sc1
    buffer_load_dwordx4 v[100:103], v174, s[8:11], s22 offen sc1
    v_min_u32 v13, 9216, v173
    ds_read_b128 v[148:151], v172 offset:4096
    ds_read_b128 v[152:155], v13 offset:4096
    ds_read_b128 v[156:159], v174 offset:4096
    s_lshl_b32 s28, s40, 2
    s_add_u32 s28, s28, s3
    s_mul_i32 s28, s28, 73728
    v_and_b32 v229, 8, v0
    v_lshl_add_u32 v229, v229, 27, v253
    s_mul_i32 s7, s42, 1073741824
    v_add_u32 v3, s7, v253
    v_or_b32 v229, s7, v229
    v_lshlrev_b32 v16, 16, v104
    v_and_b32 v17, s16, v104
    v_lshlrev_b32 v18, 16, v105
    v_and_b32 v19, s16, v105
    v_lshlrev_b32 v20, 16, v106
    v_and_b32 v21, s16, v106
    v_lshlrev_b32 v22, 16, v107
    v_and_b32 v23, s16, v107
    v_lshlrev_b32 v24, 16, v108
    v_and_b32 v25, s16, v108
    v_lshlrev_b32 v26, 16, v109
    v_and_b32 v27, s16, v109
    v_lshlrev_b32 v28, 16, v110
    v_and_b32 v29, s16, v110
    v_lshlrev_b32 v30, 16, v111
    v_and_b32 v31, s16, v111
    s_cmp_lg_u32 s42, 0
    s_cbranch_scc1 L_nopf_41
    buffer_load_dwordx4 a[0:3], v3, s[8:11], s28 offen offset:0 sc1
    buffer_load_dwordx4 a[4:7], v3, s[8:11], s28 offen offset:1024 sc1
    buffer_load_dwordx4 a[8:11], v3, s[8:11], s28 offen offset:2048 sc1
    buffer_load_dwordx4 a[12:15], v229, s[8:11], s28 offen offset:3072 sc1
    s_add_u32 s28, s28, 4096
    buffer_load_dwordx4 a[16:19], v3, s[8:11], s28 offen offset:0 sc1
    buffer_load_dwordx4 a[20:23], v3, s[8:11], s28 offen offset:1024 sc1
    buffer_load_dwordx4 a[24:27], v3, s[8:11], s28 offen offset:2048 sc1
    buffer_load_dwordx4 a[28:31], v229, s[8:11], s28 offen offset:3072 sc1
L_nopf_41:
    v_lshlrev_b32 v40, 16, v112
    v_and_b32 v41, s16, v112
    v_lshlrev_b32 v42, 16, v113
    v_and_b32 v43, s16, v113
    v_lshlrev_b32 v44, 16, v114
    v_and_b32 v45, s16, v114
    v_lshlrev_b32 v46, 16, v115
    v_and_b32 v47, s16, v115
    v_pk_add_f32 v[16:17], v[16:17], v[40:41]
    v_pk_add_f32 v[18:19], v[18:19], v[42:43]
    v_pk_add_f32 v[20:21], v[20:21], v[44:45]
    v_pk_add_f32 v[22:23], v[22:23], v[46:47]
    v_lshlrev_b32 v40, 16, v116
    v_and_b32 v41, s16, v116
    v_lshlrev_b32 v42, 16, v117
    v_and_b32 v43, s16, v117
    v_lshlrev_b32 v44, 16, v118
    v_and_b32 v45, s16, v118
    v_lshlrev_b32 v46, 16, v119
    v_and_b32 v47, s16, v119
    v_pk_add_f32 v[24:25], v[24:25], v[40:41]
    v_pk_add_f32 v[26:27], v[26:27], v[42:43]
    v_pk_add_f32 v[28:29], v[28:29], v[44:45]
    v_pk_add_f32 v[30:31], v[30:31], v[46:47]
    s_cmp_lg_u32 s42, 0
    s_cbranch_scc1 L_nopf_42
    s_add_u32 s28, s28, 4096
    buffer_load_dwordx4 a[32:35], v3, s[8:11], s28 offen offset:0 sc1
    buffer_load_dwordx4 a[36:39], v3, s[8:11], s28 offen offset:1024 sc1
    buffer_load_dwordx4 a[40:43], v3, s[8:11], s28 offen offset:2048 sc1
    buffer_load_dwordx4 a[44:47], v229, s[8:11], s28 offen offset:3072 sc1
    s_add_u32 s28, s28, 4096
    buffer_load_dwordx4 a[48:51], v3, s[8:11], s28 offen offset:0 sc1
    buffer_load_dwordx4 a[52:55], v3, s[8:11], s28 offen offset:1024 sc1
    buffer_load_dwordx4 a[56:59], v3, s[8:11], s28 offen offset:2048 sc1
    buffer_load_dwordx4 a[60:63], v229, s[8:11], s28 offen offset:3072 sc1
L_nopf_42:
    v_lshlrev_b32 v40, 16, v180
    v_and_b32 v41, s16, v180
    v_lshlrev_b32 v42, 16, v181
    v_and_b32 v43, s16, v181
    v_lshlrev_b32 v44, 16, v182
    v_and_b32 v45, s16, v182
    v_lshlrev_b32 v46, 16, v183
    v_and_b32 v47, s16, v183
    v_pk_add_f32 v[16:17], v[16:17], v[40:41]
    v_pk_add_f32 v[18:19], v[18:19], v[42:43]
    v_pk_add_f32 v[20:21], v[20:21], v[44:45]
    v_pk_add_f32 v[22:23], v[22:23], v[46:47]
    v_lshlrev_b32 v40, 16, v196
    v_and_b32 v41, s16, v196
    v_lshlrev_b32 v42, 16, v197
    v_and_b32 v43, s16, v197
    v_lshlrev_b32 v44, 16, v198
    v_and_b32 v45, s16, v198
    v_lshlrev_b32 v46, 16, v199
    v_and_b32 v47, s16, v199
    v_pk_add_f32 v[24:25], v[24:25], v[40:41]
    v_pk_add_f32 v[26:27], v[26:27], v[42:43]
    v_pk_add_f32 v[28:29], v[28:29], v[44:45]
    v_pk_add_f32 v[30:31], v[30:31], v[46:47]
    v_lshlrev_b32 v40, 16, v200
    v_and_b32 v41, s16, v200
    v_lshlrev_b32 v42, 16, v201
    v_and_b32 v43, s16, v201
    v_lshlrev_b32 v44, 16, v202
    v_and_b32 v45, s16, v202
    v_lshlrev_b32 v46, 16, v203
    v_and_b32 v47, s16, v203
    v_pk_add_f32 v[16:17], v[16:17], v[40:41]
    v_pk_add_f32 v[18:19], v[18:19], v[42:43]
    v_pk_add_f32 v[20:21], v[20:21], v[44:45]
    v_pk_add_f32 v[22:23], v[22:23], v[46:47]
    v_lshlrev_b32 v40, 16, v204
    v_and_b32 v41, s16, v204
    v_lshlrev_b32 v42, 16, v205
    v_and_b32 v43, s16, v205
    v_lshlrev_b32 v44, 16, v206
    v_and_b32 v45, s16, v206
    v_lshlrev_b32 v46, 16, v207
    v_and_b32 v47, s16, v207
    v_pk_add_f32 v[24:25], v[24:25], v[40:41]
    v_pk_add_f32 v[26:27], v[26:27], v[42:43]
    v_pk_add_f32 v[28:29], v[28:29], v[44:45]
    v_pk_add_f32 v[30:31], v[30:31], v[46:47]
    s_cmp_lg_u32 s3, 3
    s_cbranch_scc1 L_pollout_45
    s_lshl_b32 s7, s40, 7
    s_add_u32 s7, s7, s44
    s_add_u32 s7, s7, 65536
    s_add_u32 s52, s4, s7
    s_addc_u32 s53, s5, 0
    s_mov_b32 s6, 0
L_poll_43:
    s_load_dwordx8 s[56:63], s[52:53], 0 glc
    s_add_u32 s6, s6, 1
    s_waitcnt lgkmcnt(0)
    s_xor_b64 s[56:57], s[56:57], s[76:77]
    s_xor_b64 s[58:59], s[58:59], s[76:77]
    s_xor_b64 s[60:61], s[60:61], s[76:77]
    s_xor_b64 s[62:63], s[62:63], s[76:77]
    s_or_b64 s[56:57], s[56:57], s[58:59]
    s_or_b64 s[60:61], s[60:61], s[62:63]
    s_or_b64 s[56:57], s[56:57], s[60:61]
    s_cbranch_scc0 L_polled_44
    s_cmp_lt_u32 s6, 1048576
    s_cbranch_scc1 L_poll_43
    s_branch L_main_end
L_polled_44:
L_pollout_45:
    s_barrier
    s_add_u32 s7, s40, 1
    s_and_b32 s7, s7, 7
    s_mul_i32 s7, s7, 9216
    s_add_u32 s19, s7, s20
    buffer_load_dwordx4 v[60:63], v174, s[8:11], s19 offen sc1
    s_add_u32 s7, s40, 2
    s_and_b32 s7, s7, 7
    s_mul_i32 s7, s7, 9216
    s_add_u32 s19, s7, s20
    buffer_load_dwordx4 v[64:67], v174, s[8:11], s19 offen sc1
    s_add_u32 s7, s40, 3
    s_and_b32 s7, s7, 7
    s_mul_i32 s7, s7, 9216
    s_add_u32 s19, s7, s20
    buffer_load_dwordx4 v[68:71], v174, s[8:11], s19 offen sc1
    s_add_u32 s7, s40, 4
    s_and_b32 s7, s7, 7
    s_mul_i32 s7, s7, 9216
    s_add_u32 s19, s7, s20
    buffer_load_dwordx4 v[72:75], v174, s[8:11], s19 offen sc1
    s_add_u32 s7, s40, 5
    s_and_b32 s7, s7, 7
    s_mul_i32 s7, s7, 9216
    s_add_u32 s19, s7, s20
    buffer_load_dwordx4 v[76:79], v174, s[8:11], s19 offen sc1
    s_add_u32 s7, s40, 6
    s_and_b32 s7, s7, 7
    s_mul_i32 s7, s7, 9216
    s_add_u32 s19, s7, s20
    buffer_load_dwordx4 v[80:83], v174, s[8:11], s19 offen sc1
    s_add_u32 s7, s40, 7
    s_and_b32 s7, s7, 7
    s_mul_i32 s7, s7, 9216
    s_add_u32 s19, s7, s20
    buffer_load_dwordx4 v[84:87], v174, s[8:11], s19 offen sc1
    v_lshlrev_b32 v40, 16, v208
    v_and_b32 v41, s16, v208
    v_lshlrev_b32 v42, 16, v209
    v_and_b32 v43, s16, v209
    v_lshlrev_b32 v44, 16, v210
    v_and_b32 v45, s16, v210
    v_lshlrev_b32 v46, 16, v211
    v_and_b32 v47, s16, v211
    v_pk_add_f32 v[16:17], v[16:17], v[40:41]
    v_pk_add_f32 v[18:19], v[18:19], v[42:43]
    v_pk_add_f32 v[20:21], v[20:21], v[44:45]
    v_pk_add_f32 v[22:23], v[22:23], v[46:47]
    v_lshlrev_b32 v40, 16, v212
    v_and_b32 v41, s16, v212
    v_lshlrev_b32 v42, 16, v213
    v_and_b32 v43, s16, v213
    v_lshlrev_b32 v44, 16, v214
    v_and_b32 v45, s16, v214
    v_lshlrev_b32 v46, 16, v215
    v_and_b32 v47, s16, v215
    v_pk_add_f32 v[24:25], v[24:25], v[40:41]
    v_pk_add_f32 v[26:27], v[26:27], v[42:43]
    v_pk_add_f32 v[28:29], v[28:29], v[44:45]
    v_pk_add_f32 v[30:31], v[30:31], v[46:47]
    v_lshlrev_b32 v40, 16, v136
    v_and_b32 v41, s16, v136
    v_lshlrev_b32 v42, 16, v137
    v_and_b32 v43, s16, v137
    v_lshlrev_b32 v44, 16, v138
    v_and_b32 v45, s16, v138
    v_lshlrev_b32 v46, 16, v139
    v_and_b32 v47, s16, v139
    v_pk_add_f32 v[16:17], v[16:17], v[40:41]
    v_pk_add_f32 v[18:19], v[18:19], v[42:43]
    v_pk_add_f32 v[20:21], v[20:21], v[44:45]
    v_pk_add_f32 v[22:23], v[22:23], v[46:47]
    v_lshlrev_b32 v40, 16, v140
    v_and_b32 v41, s16, v140
    v_lshlrev_b32 v42, 16, v141
    v_and_b32 v43, s16, v141
    v_lshlrev_b32 v44, 16, v142
    v_and_b32 v45, s16, v142
    v_lshlrev_b32 v46, 16, v143
    v_and_b32 v47, s16, v143
    v_pk_add_f32 v[24:25], v[24:25], v[40:41]
    v_pk_add_f32 v[26:27], v[26:27], v[42:43]
    v_pk_add_f32 v[28:29], v[28:29], v[44:45]
    v_pk_add_f32 v[30:31], v[30:31], v[46:47]
    v_lshlrev_b32 v40, 16, v144
    v_and_b32 v41, s16, v144
    v_lshlrev_b32 v42, 16, v145
    v_and_b32 v43, s16, v145
    v_lshlrev_b32 v44, 16, v146
    v_and_b32 v45, s16, v146
    v_lshlrev_b32 v46, 16, v147
    v_and_b32 v47, s16, v147
    v_pk_add_f32 v[16:17], v[16:17], v[40:41]
    v_pk_add_f32 v[18:19], v[18:19], v[42:43]
    v_pk_add_f32 v[20:21], v[20:21], v[44:45]
    v_pk_add_f32 v[22:23], v[22:23], v[46:47]
    v_lshlrev_b32 v40, 16, v160
    v_and_b32 v41, s16, v160
    v_lshlrev_b32 v42, 16, v161
    v_and_b32 v43, s16, v161
    v_lshlrev_b32 v44, 16, v162
    v_and_b32 v45, s16, v162
    v_lshlrev_b32 v46, 16, v163
    v_and_b32 v47, s16, v163
    v_pk_add_f32 v[24:25], v[24:25], v[40:41]
    v_pk_add_f32 v[26:27], v[26:27], v[42:43]
    v_pk_add_f32 v[28:29], v[28:29], v[44:45]
    v_pk_add_f32 v[30:31], v[30:31], v[46:47]
    s_cmp_eq_u32 s3, 0
    s_cselect_b32 s7, 1.0, 0
    s_cselect_b32 s6, -1, 0
    s_waitcnt vmcnt(7) lgkmcnt(0)
    v_and_b32 v152, s6, v152
    v_and_b32 v153, s6, v153
    v_and_b32 v154, s6, v154
    v_and_b32 v155, s6, v155
    v_mul_f32 v11, s7, v10
    v_lshlrev_b32 v40, 16, v92
    v_and_b32 v41, s16, v92
    v_lshlrev_b32 v42, 16, v93
    v_and_b32 v43, s16, v93
    v_lshlrev_b32 v44, 16, v94
    v_and_b32 v45, s16, v94
    v_lshlrev_b32 v46, 16, v95
    v_and_b32 v47, s16, v95
    v_pk_add_f32 v[16:17], v[16:17], v[40:41]
    v_pk_add_f32 v[18:19], v[18:19], v[42:43]
    v_pk_add_f32 v[20:21], v[20:21], v[44:45]
    v_pk_add_f32 v[22:23], v[22:23], v[46:47]
    v_lshlrev_b32 v40, 16, v96
    v_and_b32 v41, s16, v96
    v_lshlrev_b32 v42, 16, v97
    v_and_b32 v43, s16, v97
    v_lshlrev_b32 v44, 16, v98
    v_and_b32 v45, s16, v98
    v_lshlrev_b32 v46, 16, v99
    v_and_b32 v47, s16, v99
    v_pk_add_f32 v[24:25], v[24:25], v[40:41]
    v_pk_add_f32 v[26:27], v[26:27], v[42:43]
    v_pk_add_f32 v[28:29], v[28:29], v[44:45]
    v_pk_add_f32 v[30:31], v[30:31], v[46:47]
    v_lshlrev_b32 v32, 16, v100
    v_and_b32 v33, s16, v100
    v_lshlrev_b32 v34, 16, v101
    v_and_b32 v35, s16, v101
    v_lshlrev_b32 v36, 16, v102
    v_and_b32 v37, s16, v102
    v_lshlrev_b32 v38, 16, v103
    v_and_b32 v39, s16, v103
    v_lshlrev_b32 v40, 16, v148
    v_and_b32 v41, s16, v148
    v_lshlrev_b32 v42, 16, v149
    v_and_b32 v43, s16, v149
    v_lshlrev_b32 v44, 16, v150
    v_and_b32 v45, s16, v150
    v_lshlrev_b32 v46, 16, v151
    v_and_b32 v47, s16, v151
    v_pk_add_f32 v[16:17], v[16:17], v[40:41]
    v_pk_add_f32 v[18:19], v[18:19], v[42:43]
    v_pk_add_f32 v[20:21], v[20:21], v[44:45]
    v_pk_add_f32 v[22:23], v[22:23], v[46:47]
    v_lshlrev_b32 v40, 16, v152
    v_and_b32 v41, s16, v152
    v_lshlrev_b32 v42, 16, v153
    v_and_b32 v43, s16, v153
    v_lshlrev_b32 v44, 16, v154
    v_and_b32 v45, s16, v154
    v_lshlrev_b32 v46, 16, v155
    v_and_b32 v47, s16, v155
    v_pk_add_f32 v[24:25], v[24:25], v[40:41]
    v_pk_add_f32 v[26:27], v[26:27], v[42:43]
    v_pk_add_f32 v[28:29], v[28:29], v[44:45]
    v_pk_add_f32 v[30:31], v[30:31], v[46:47]
    v_lshlrev_b32 v40, 16, v156
    v_and_b32 v41, s16, v156
    v_lshlrev_b32 v42, 16, v157
    v_and_b32 v43, s16, v157
    v_lshlrev_b32 v44, 16, v158
    v_and_b32 v45, s16, v158
    v_lshlrev_b32 v46, 16, v159
    v_and_b32 v47, s16, v159
    v_pk_add_f32 v[32:33], v[32:33], v[40:41]
    v_pk_add_f32 v[34:35], v[34:35], v[42:43]
    v_pk_add_f32 v[36:37], v[36:37], v[44:45]
    v_pk_add_f32 v[38:39], v[38:39], v[46:47]
    v_pk_add_f32 v[16:17], v[16:17], v[10:11] op_sel_hi:[1,0]
    v_pk_add_f32 v[18:19], v[18:19], v[10:11] op_sel_hi:[1,0]
    v_pk_add_f32 v[20:21], v[20:21], v[10:11] op_sel_hi:[1,0]
    v_pk_add_f32 v[22:23], v[22:23], v[10:11] op_sel_hi:[1,0]
    v_pk_add_f32 v[24:25], v[24:25], v[10:11] op_sel:[0,1] op_sel_hi:[1,1]
    v_pk_add_f32 v[26:27], v[26:27], v[10:11] op_sel:[0,1] op_sel_hi:[1,1]
    v_pk_add_f32 v[28:29], v[28:29], v[10:11] op_sel:[0,1] op_sel_hi:[1,1]
    v_pk_add_f32 v[30:31], v[30:31], v[10:11] op_sel:[0,1] op_sel_hi:[1,1]
    v_pk_add_f32 v[32:33], v[32:33], v[10:11] op_sel_hi:[1,0]
    v_pk_add_f32 v[34:35], v[34:35], v[10:11] op_sel_hi:[1,0]
    v_pk_add_f32 v[36:37], v[36:37], v[10:11] op_sel_hi:[1,0]
    v_pk_add_f32 v[38:39], v[38:39], v[10:11] op_sel_hi:[1,0]
    s_waitcnt vmcnt(6)
    s_add_u32 s28, s28, 4096
    buffer_load_dwordx4 a[64:67], v3, s[8:11], s28 offen offset:0 sc1
    v_lshlrev_b32 v40, 16, v60
    v_and_b32 v41, s16, v60
    v_lshlrev_b32 v42, 16, v61
    v_and_b32 v43, s16, v61
    v_lshlrev_b32 v44, 16, v62
    v_and_b32 v45, s16, v62
    v_lshlrev_b32 v46, 16, v63
    v_and_b32 v47, s16, v63
    v_pk_add_f32 v[32:33], v[32:33], v[40:41]
    v_pk_add_f32 v[34:35], v[34:35], v[42:43]
    v_pk_add_f32 v[36:37], v[36:37], v[44:45]
    v_pk_add_f32 v[38:39], v[38:39], v[46:47]
    s_waitcnt vmcnt(6)
    buffer_load_dwordx4 a[68:71], v3, s[8:11], s28 offen offset:1024 sc1
    v_lshlrev_b32 v40, 16, v64
    v_and_b32 v41, s16, v64
    v_lshlrev_b32 v42, 16, v65
    v_and_b32 v43, s16, v65
    v_lshlrev_b32 v44, 16, v66
    v_and_b32 v45, s16, v66
    v_lshlrev_b32 v46, 16, v67
    v_and_b32 v47, s16, v67
    v_pk_add_f32 v[32:33], v[32:33], v[40:41]
    v_pk_add_f32 v[34:35], v[34:35], v[42:43]
    v_pk_add_f32 v[36:37], v[36:37], v[44:45]
    v_pk_add_f32 v[38:39], v[38:39], v[46:47]
    s_waitcnt vmcnt(6)
    buffer_load_dwordx4 a[72:75], v3, s[8:11], s28 offen offset:2048 sc1
    v_lshlrev_b32 v40, 16, v68
    v_and_b32 v41, s16, v68
    v_lshlrev_b32 v42, 16, v69
    v_and_b32 v43, s16, v69
    v_lshlrev_b32 v44, 16, v70
    v_and_b32 v45, s16, v70
    v_lshlrev_b32 v46, 16, v71
    v_and_b32 v47, s16, v71
    v_pk_add_f32 v[32:33], v[32:33], v[40:41]
    v_pk_add_f32 v[34:35], v[34:35], v[42:43]
    v_pk_add_f32 v[36:37], v[36:37], v[44:45]
    v_pk_add_f32 v[38:39], v[38:39], v[46:47]
    s_waitcnt vmcnt(6)
    buffer_load_dwordx4 a[76:79], v229, s[8:11], s28 offen offset:3072 sc1
    v_lshlrev_b32 v40, 16, v72
    v_and_b32 v41, s16, v72
    v_lshlrev_b32 v42, 16, v73
    v_and_b32 v43, s16, v73
    v_lshlrev_b32 v44, 16, v74
    v_and_b32 v45, s16, v74
    v_lshlrev_b32 v46, 16, v75
    v_and_b32 v47, s16, v75
    v_pk_add_f32 v[32:33], v[32:33], v[40:41]
    v_pk_add_f32 v[34:35], v[34:35], v[42:43]
    v_pk_add_f32 v[36:37], v[36:37], v[44:45]
    v_pk_add_f32 v[38:39], v[38:39], v[46:47]
    s_waitcnt vmcnt(6)
    s_add_u32 s28, s28, 4096
    buffer_load_dwordx4 a[80:83], v3, s[8:11], s28 offen offset:0 sc1
    v_lshlrev_b32 v40, 16, v76
    v_and_b32 v41, s16, v76
    v_lshlrev_b32 v42, 16, v77
    v_and_b32 v43, s16, v77
    v_lshlrev_b32 v44, 16, v78
    v_and_b32 v45, s16, v78
    v_lshlrev_b32 v46, 16, v79
    v_and_b32 v47, s16, v79
    v_pk_add_f32 v[32:33], v[32:33], v[40:41]
    v_pk_add_f32 v[34:35], v[34:35], v[42:43]
    v_pk_add_f32 v[36:37], v[36:37], v[44:45]
    v_pk_add_f32 v[38:39], v[38:39], v[46:47]
    s_waitcnt vmcnt(6)
    buffer_load_dwordx4 a[84:87], v3, s[8:11], s28 offen offset:1024 sc1
    v_lshlrev_b32 v40, 16, v80
    v_and_b32 v41, s16, v80
    v_lshlrev_b32 v42, 16, v81
    v_and_b32 v43, s16, v81
    v_lshlrev_b32 v44, 16, v82
    v_and_b32 v45, s16, v82
    v_lshlrev_b32 v46, 16, v83
    v_and_b32 v47, s16, v83
    v_pk_add_f32 v[32:33], v[32:33], v[40:41]
    v_pk_add_f32 v[34:35], v[34:35], v[42:43]
    v_pk_add_f32 v[36:37], v[36:37], v[44:45]
    v_pk_add_f32 v[38:39], v[38:39], v[46:47]
    s_waitcnt vmcnt(6)
    buffer_load_dwordx4 a[88:91], v3, s[8:11], s28 offen offset:2048 sc1
    v_lshlrev_b32 v40, 16, v84
    v_and_b32 v41, s16, v84
    v_lshlrev_b32 v42, 16, v85
    v_and_b32 v43, s16, v85
    v_lshlrev_b32 v44, 16, v86
    v_and_b32 v45, s16, v86
    v_lshlrev_b32 v46, 16, v87
    v_and_b32 v47, s16, v87
    v_pk_add_f32 v[32:33], v[32:33], v[40:41]
    v_pk_add_f32 v[34:35], v[34:35], v[42:43]
    v_pk_add_f32 v[36:37], v[36:37], v[44:45]
    v_pk_add_f32 v[38:39], v[38:39], v[46:47]
    buffer_load_dwordx4 a[92:95], v229, s[8:11], s28 offen offset:3072 sc1
    v_cvt_pk_bf16_f32 v120, v16, v17
    v_cvt_pk_bf16_f32 v121, v18, v19
    v_cvt_pk_bf16_f32 v122, v20, v21
    v_cvt_pk_bf16_f32 v123, v22, v23
    v_cvt_pk_bf16_f32 v124, v24, v25
    v_cvt_pk_bf16_f32 v125, v26, v27
    v_cvt_pk_bf16_f32 v126, v28, v29
    v_cvt_pk_bf16_f32 v127, v30, v31
    v_cvt_pk_bf16_f32 v128, v32, v33
    v_cvt_pk_bf16_f32 v129, v34, v35
    v_cvt_pk_bf16_f32 v130, v36, v37
    v_cvt_pk_bf16_f32 v131, v38, v39
    s_cmp_lg_u32 s42, 0
    s_cbranch_scc1 L_main_last
    s_add_u32 s19, s18, 53215232
    s_add_u32 s20, s18, 48496640
    s_lshl_b32 s22, s21, 7
    s_add_u32 s22, s22, 57933824
    buffer_store_dwordx4 v[120:123], v172, s[8:11], s19 offen sc1
    buffer_store_dwordx4 v[124:127], v173, s[8:11], s19 offen sc1
    buffer_store_dwordx4 v[128:131], v174, s[8:11], s19 offen sc1
    s_mov_b32 s17, 0x3f803f80
    v_mov_b32 v8, 0
    v_mov_b32 v9, 0
    v_mov_b32 v10, 0
    v_mov_b32 v11, 0
    v_dot2c_f32_bf16 v8, s17, v120
    v_dot2c_f32_bf16 v9, v120, v120
    v_dot2c_f32_bf16 v10, s17, v121
    v_dot2c_f32_bf16 v11, v121, v121
    v_dot2c_f32_bf16 v8, s17, v122
    v_dot2c_f32_bf16 v9, v122, v122
    v_dot2c_f32_bf16 v10, s17, v123
    v_dot2c_f32_bf16 v11, v123, v123
    v_dot2c_f32_bf16 v8, s17, v124
    v_dot2c_f32_bf16 v9, v124, v124
    v_dot2c_f32_bf16 v10, s17, v125
    v_dot2c_f32_bf16 v11, v125, v125
    v_dot2c_f32_bf16 v8, s17, v126
    v_dot2c_f32_bf16 v9, v126, v126
    v_dot2c_f32_bf16 v10, s17, v127
    v_dot2c_f32_bf16 v11, v127, v127
    v_dot2c_f32_bf16 v8, s17, v128
    v_dot2c_f32_bf16 v9, v128, v128
    v_dot2c_f32_bf16 v10, s17, v129
    v_dot2c_f32_bf16 v11, v129, v129
    v_dot2c_f32_bf16 v8, s17, v130
    v_dot2c_f32_bf16 v9, v130, v130
    v_dot2c_f32_bf16 v10, s17, v131
    v_dot2c_f32_bf16 v11, v131, v131
    v_and_b32 v12, 7, v0
    v_lshlrev_b32 v12, 3, v12
    s_lshl_b32 s7, s3, 6
    v_add_u32 v13, s7, v12
    v_pk_add_f32 v[8:9], v[8:9], v[10:11]
    s_nop 1
    v_add_f32_dpp v8, v8, v8 row_ror:8 row_mask:0xf bank_mask:0xf
    v_add_f32_dpp v9, v9, v9 row_ror:8 row_mask:0xf bank_mask:0xf
    v_mov_b32 v10, v8
    v_mov_b32 v11, v9
    s_nop 1
    v_permlane32_swap_b32 v10, v8
    v_permlane32_swap_b32 v11, v9
    v_add_f32 v8, v8, v10
    v_add_f32 v9, v9, v11
    v_mov_b32 v10, v8
    v_mov_b32 v11, v9
    s_nop 1
    v_permlane16_swap_b32 v10, v8
    v_permlane16_swap_b32 v11, v9
    v_add_f32 v8, v8, v10
    v_add_f32 v9, v9, v11
    ds_write_b64 v13, v[8:9]
    s_waitcnt lgkmcnt(0)
    s_barrier
    ds_read_b64 v[40:41], v12 offset:0
    ds_read_b64 v[42:43], v12 offset:64
    ds_read_b64 v[44:45], v12 offset:128
    ds_read_b64 v[46:47], v12 offset:192
    s_waitcnt lgkmcnt(0)
    v_pk_add_f32 v[40:41], v[40:41], v[42:43]
    v_pk_add_f32 v[44:45], v[44:45], v[46:47]
    v_pk_add_f32 v[8:9], v[40:41], v[44:45]
    v_mul_f32 v8, 0x3ae38e39, v8
    v_mul_f32 v9, 0x3ae38e39, v9
    v_fma_f32 v9, -v8, v8, v9
    v_max_f32 v9, 0, v9
    v_add_f32 v9, 0x3727c5ac, v9
    v_rsq_f32 v10, v9
    s_nop 0
    v_mul_f32 v12, v8, v10
    v_mov_b32 v11, v10
    v_sub_f32 v12, 0, v12
    v_mov_b32 v13, v12
    s_cmp_eq_u32 s3, 0
    s_cselect_b32 s7, 32, 0
    v_lshlrev_b32 v14, 2, v0
    v_cmp_gt_u32 vcc, s7, v0
    v_mov_b32 v9, 1073741824
    s_nop 0
    v_cndmask_b32 v14, v9, v14, vcc
    buffer_store_dword v8, v14, s[8:11], s22 offen sc1
    v_lshlrev_b32 v40, 16, v120
    v_and_b32 v41, s16, v120
    v_lshlrev_b32 v42, 16, v121
    v_and_b32 v43, s16, v121
    v_lshlrev_b32 v44, 16, v122
    v_and_b32 v45, s16, v122
    v_lshlrev_b32 v46, 16, v123
    v_and_b32 v47, s16, v123
    v_pk_fma_f32 v[40:41], v[40:41], v[10:11], v[12:13]
    v_pk_fma_f32 v[42:43], v[42:43], v[10:11], v[12:13]
    v_pk_fma_f32 v[44:45], v[44:45], v[10:11], v[12:13]
    v_pk_fma_f32 v[46:47], v[46:47], v[10:11], v[12:13]
    v_cvt_pk_bf16_f32 v48, v40, v41
    v_cvt_pk_bf16_f32 v49, v42, v43
    v_cvt_pk_bf16_f32 v50, v44, v45
    v_cvt_pk_bf16_f32 v51, v46, v47
    v_lshlrev_b32 v40, 16, v124
    v_and_b32 v41, s16, v124
    v_lshlrev_b32 v42, 16, v125
    v_and_b32 v43, s16, v125
    v_lshlrev_b32 v44, 16, v126
    v_and_b32 v45, s16, v126
    v_lshlrev_b32 v46, 16, v127
    v_and_b32 v47, s16, v127
    v_pk_fma_f32 v[40:41], v[40:41], v[10:11], v[12:13]
    v_pk_fma_f32 v[42:43], v[42:43], v[10:11], v[12:13]
    v_pk_fma_f32 v[44:45], v[44:45], v[10:11], v[12:13]
    v_pk_fma_f32 v[46:47], v[46:47], v[10:11], v[12:13]
    v_cvt_pk_bf16_f32 v52, v40, v41
    v_cvt_pk_bf16_f32 v53, v42, v43
    v_cvt_pk_bf16_f32 v54, v44, v45
    v_cvt_pk_bf16_f32 v55, v46, v47
    v_lshlrev_b32 v40, 16, v128
    v_and_b32 v41, s16, v128
    v_lshlrev_b32 v42, 16, v129
    v_and_b32 v43, s16, v129
    v_lshlrev_b32 v44, 16, v130
    v_and_b32 v45, s16, v130
    v_lshlrev_b32 v46, 16, v131
    v_and_b32 v47, s16, v131
    v_pk_fma_f32 v[40:41], v[40:41], v[10:11], v[12:13]
    v_pk_fma_f32 v[42:43], v[42:43], v[10:11], v[12:13]
    v_pk_fma_f32 v[44:45], v[44:45], v[10:11], v[12:13]
    v_pk_fma_f32 v[46:47], v[46:47], v[10:11], v[12:13]
    v_cvt_pk_bf16_f32 v56, v40, v41
    v_cvt_pk_bf16_f32 v57, v42, v43
    v_cvt_pk_bf16_f32 v58, v44, v45
    v_cvt_pk_bf16_f32 v59, v46, v47
    buffer_store_dwordx4 v[48:51], v172, s[8:11], s20 offen sc1
    buffer_store_dwordx4 v[52:55], v173, s[8:11], s20 offen sc1
    buffer_store_dwordx4 v[56:59], v174, s[8:11], s20 offen sc1
    v_lshlrev_b32 v15, 7, v0
    s_lshl_b32 s6, s40, 2
    s_add_u32 s6, s6, s44
    s_add_u32 s6, s6, 98304
    v_mov_b32 v1, s76
    s_mov_b64 vcc, 0xff
    v_lshrrev_b32 v14, 3, v0
    v_lshl_add_u32 v15, v14, 3, v15
    s_cmp_ge_u32 s40, 6
    s_cselect_b32 s7, s41, 31
    s_cmp_lt_u32 s7, 31
    s_cmov_b64 vcc, 0xffff
    s_waitcnt vmcnt(0)
    s_barrier
    s_cmp_lg_u32 s3, 0
    s_cbranch_scc1 L_pub_46
    s_mov_b64 exec, vcc
    buffer_store_dword v1, v15, s[8:11], s6 offen sc1
L_pub_46:
    s_mov_b64 exec, -1
    s_add_u32 s28, s28, 4096
    buffer_load_dwordx4 a[96:99], v3, s[8:11], s28 offen offset:0 sc1
    buffer_load_dwordx4 a[100:103], v3, s[8:11], s28 offen offset:1024 sc1
    buffer_load_dwordx4 a[104:107], v3, s[8:11], s28 offen offset:2048 sc1
    buffer_load_dwordx4 a[108:111], v229, s[8:11], s28 offen offset:3072 sc1
    s_add_u32 s28, s28, 4096
    buffer_load_dwordx4 a[112:115], v3, s[8:11], s28 offen offset:0 sc1
    buffer_load_dwordx4 a[116:119], v3, s[8:11], s28 offen offset:1024 sc1
    buffer_load_dwordx4 a[120:123], v3, s[8:11], s28 offen offset:2048 sc1
    buffer_load_dwordx4 a[124:127], v229, s[8:11], s28 offen offset:3072 sc1
    s_add_u32 s28, s28, 4096
    buffer_load_dwordx4 a[128:131], v3, s[8:11], s28 offen offset:0 sc1
    buffer_load_dwordx4 a[132:135], v3, s[8:11], s28 offen offset:1024 sc1
    buffer_load_dwordx4 a[136:139], v3, s[8:11], s28 offen offset:2048 sc1
    buffer_load_dwordx4 a[140:143], v229, s[8:11], s28 offen offset:3072 sc1
    s_add_u32 s28, s28, 4096
    s_mov_b32 s42, 1
    s_mov_b32 s43, 9699328
    s_add_u32 s44, s44, 131072
    s_branch L_main_layer
L_main_last:
    buffer_store_dwordx4 v[120:123], v175, s[12:15], s18 offen sc0 sc1
    buffer_store_dwordx4 v[124:127], v176, s[12:15], s18 offen sc0 sc1
    buffer_store_dwordx4 v[128:131], v177, s[12:15], s18 offen sc0 sc1
    s_or_b32 s7, s40, s41
    s_or_b32 s7, s7, s3
    s_cbranch_scc1 L_done_47
    v_mov_b32 v1, s76
    s_mov_b32 s7, 19660800
    s_mov_b64 exec, 1
    buffer_store_dword v1, off, s[8:11], s7 sc1
    s_mov_b64 exec, -1
L_done_47:
L_main_end:
    s_endpgm
L_main_code_end:
.section .rodata,"a"
.p2align 6
.amdhsa_kernel interleave_layers__sliding_local_dilated__glu_gated_geglu__prompt_kernel
.amdhsa_next_free_vgpr 512
.amdhsa_next_free_sgpr 102
.amdhsa_accum_offset 256
.amdhsa_group_segment_fixed_size 0
.amdhsa_kernarg_size 80
.amdhsa_user_sgpr_count 2
.amdhsa_user_sgpr_kernarg_segment_ptr 1
.amdhsa_system_sgpr_workgroup_id_x 1
.amdhsa_float_denorm_mode_32 3
.amdhsa_float_denorm_mode_16_64 3
.end_amdhsa_kernel
```

```asm
; @launch grid=(256,1,1) block=(256,1,1) lds=163840
.amdgcn_target "amdgcn-amd-amdhsa--gfx950"
.text
.globl interleave_layers__sliding_local_dilated__glu_gated_geglu__prompt_kernel
.p2align 8
.type interleave_layers__sliding_local_dilated__glu_gated_geglu__prompt_kernel,@function
interleave_layers__sliding_local_dilated__glu_gated_geglu__prompt_kernel:
    s_cmp_ge_u32 s2, 256
    s_cbranch_scc1 L_main_end
    s_load_dwordx2 s[4:5], s[0:1], 72
    s_load_dwordx4 s[16:19], s[0:1], 0
    s_load_dwordx2 s[22:23], s[0:1], 16
    s_load_dwordx8 s[24:31], s[0:1], 32
    s_getpc_b64 s[96:97]
L_main_pc:
    s_sub_u32 s96, s96, L_main_pc-interleave_layers__sliding_local_dilated__glu_gated_geglu__prompt_kernel
    s_subb_u32 s97, s97, 0
    s_and_b32 s97, s97, 0xffff
    s_mov_b32 s98, L_main_code_end-interleave_layers__sliding_local_dilated__glu_gated_geglu__prompt_kernel
    s_mov_b32 s99, 0x20000
    s_lshr_b32 s7, s2, 3
    s_lshl_b32 s7, s7, 11
    v_lshl_add_u32 v253, v0, 3, s7
    buffer_load_dwordx2 v[2:3], v253, s[96:99], 0 offen
    v_lshrrev_b32 v1, 6, v0
    v_and_b32 v0, 63, v0
    v_readfirstlane_b32 s3, v1
    s_waitcnt lgkmcnt(0)
    s_mov_b32 s8, s4
    s_and_b32 s9, s5, 0xffff
    s_mov_b32 s10, 268435456
    s_mov_b32 s11, 0x20000
    s_mov_b32 s7, 19660800
    s_load_dword s76, s[4:5], s7
    s_mov_b64 s[20:21], s[18:19]
    s_mov_b64 s[18:19], s[16:17]
    s_mov_b32 s48, s4
    s_and_b32 s49, s5, 0xffff
    s_mov_b32 s50, 268435456
    s_mov_b32 s51, 0x20000
    s_and_b32 s40, s2, 3
    s_lshl_b32 s40, s40, 1
    s_bfe_u32 s7, s2, 65539
    s_add_u32 s40, s40, s7
    s_bfe_u32 s41, s2, 65538
    s_lshl_b32 s41, s41, 4
    s_lshr_b32 s7, s2, 4
    s_add_u32 s41, s41, s7
    s_mov_b32 s42, 0
    s_mov_b32 s43, 0
    s_lshl_b32 s44, s41, 10
    s_add_u32 s44, s44, 19169280
    v_lshlrev_b32 v253, 4, v0
    s_mov_b32 s12, s18
    s_and_b32 s13, s19, 0xffff
    s_mov_b32 s14, 2359296
    s_mov_b32 s15, 0x20000
    s_mov_b32 s64, s20
    s_and_b32 s65, s21, 0xffff
    s_mov_b32 s66, 1990656
    s_mov_b32 s67, 0x20000
    s_mov_b32 s68, s22
    s_and_b32 s69, s23, 0xffff
    s_mov_b32 s70, 663552
    s_mov_b32 s71, 0x20000
    s_mov_b32 s16, 0xffff0000
    s_lshl_b32 s7, s3, 10
    v_add_u32 v172, s7, v253
    v_add_u32 v174, 5120, v172
    v_and_b32 v178, 7, v0
    v_mul_u32_u24 v178, 1152, v178
    v_lshrrev_b32 v179, 3, v0
    v_lshl_add_u32 v178, v179, 4, v178
    s_lshl_b32 s7, s3, 7
    v_add_u32 v175, s7, v178
    v_add_u32 v177, 640, v175
    s_cmp_eq_u32 s3, 0
    s_mov_b32 s17, 1073741824
    s_cmov_b32 s17, 4096
    v_add_u32 v173, s17, v172
    s_mov_b32 s17, 1073741824
    s_cmov_b32 s17, 512
    v_add_u32 v176, s17, v175
    s_lshl_b32 s21, s41, 3
    s_add_u32 s21, s21, s40
    s_mul_i32 s18, s21, 9216
    buffer_load_dwordx4 v[16:19], v175, s[12:15], s18 offen nt
    buffer_load_dwordx4 v[20:23], v176, s[12:15], s18 offen nt
    buffer_load_dwordx4 v[24:27], v177, s[12:15], s18 offen nt
    s_mov_b32 s12, s30
    s_and_b32 s13, s31, 0xffff
    s_mov_b32 s14, 2359296
    s_mov_b32 s15, 0x20000
    s_lshl_b32 s79, s3, 14
    s_add_u32 s79, s79, 98304
    s_and_b32 s32, s41, 15
    s_lshl_b32 s32, s32, 1
    s_lshr_b32 s7, s41, 4
    s_add_u32 s32, s32, s7
    s_lshl_b32 s36, s32, 3
    s_add_u32 s36, s36, s40
    s_sub_u32 s36, s36, 144
    s_cmp_ge_u32 s32, 18
    s_cbranch_scc1 L_prep_o_1
    s_mul_i32 s35, s32, 110592
    s_mul_i32 s7, s40, 144
    s_and_b32 s46, s7, 127
    s_sub_u32 s7, s7, s46
    s_add_u32 s35, s35, s7
    s_mul_i32 s7, s3, 13824
    s_add_u32 s35, s35, s7
    v_lshrrev_b32 v8, 4, v0
    v_mul_u32_u24 v8, 3456, v8
    v_and_b32 v9, 15, v0
    v_lshl_add_u32 v8, v9, 4, v8
    s_lshl_b32 s34, s3, 10
    s_add_u32 m0, s34, 8192
    s_add_u32 s7, s35, 0
    buffer_load_dwordx4 v8, s[64:67], s7 offen nt lds
    s_add_u32 m0, s34, 12288
    s_add_u32 s7, s35, 55296
    buffer_load_dwordx4 v8, s[64:67], s7 offen nt lds
    s_add_u32 m0, s34, 16384
    s_add_u32 s7, s35, 1152
    buffer_load_dwordx4 v8, s[64:67], s7 offen nt lds
    s_add_u32 m0, s34, 20480
    s_add_u32 s7, s35, 56448
    buffer_load_dwordx4 v8, s[64:67], s7 offen nt lds
    s_add_u32 m0, s34, 24576
    s_add_u32 s7, s35, 2304
    buffer_load_dwordx4 v8, s[64:67], s7 offen nt lds
    s_add_u32 m0, s34, 28672
    s_add_u32 s7, s35, 57600
    buffer_load_dwordx4 v8, s[64:67], s7 offen nt lds
    s_branch L_prep_go_3
L_prep_o_1:
    s_cmp_ge_u32 s36, 54
    s_cbranch_scc1 L_prep_m_2
    s_mul_i32 s33, s36, 349526
    s_lshr_b32 s33, s33, 20
    s_mul_i32 s34, s33, 3
    s_sub_u32 s34, s36, s34
    s_lshl_b32 s7, s33, 2
    s_add_u32 s7, s7, s3
    v_mov_b32 v8, s7
    v_lshrrev_b32 v9, 3, v0
    v_mul_u32_u24 v11, 7282, v8
    v_lshrrev_b32 v11, 16, v11
    v_mul_u32_u24 v12, 9, v11
    v_sub_u32 v12, v8, v12
    v_mul_u32_u24 v11, 72, v11
    v_cmp_eq_u32 vcc, 8, v12
    v_lshrrev_b32 v10, 1, v12
    v_mad_u32_u24 v10, v10, 18, v11
    v_and_b32 v12, 1, v12
    v_lshl_add_u32 v10, v12, 3, v10
    v_add_u32 v10, v10, v9
    v_lshrrev_b32 v12, 1, v9
    v_mad_u32_u24 v11, v12, 18, v11
    v_and_b32 v12, 1, v9
    v_add3_u32 v11, v11, v12, 16
    v_cndmask_b32 v10, v10, v11, vcc
    v_mul_u32_u24 v10, 1152, v10
    v_and_b32 v9, 7, v0
    v_lshl_add_u32 v10, v9, 4, v10
    s_mul_i32 s35, s34, 384
    s_lshl_b32 s6, s3, 10
    s_add_u32 m0, s6, 8192
    s_add_u32 s7, s35, 0
    buffer_load_dwordx4 v10, s[68:71], s7 offen nt lds
    s_add_u32 m0, s6, 12288
    s_add_u32 s7, s35, 128
    buffer_load_dwordx4 v10, s[68:71], s7 offen nt lds
    s_add_u32 m0, s6, 16384
    s_add_u32 s7, s35, 256
    buffer_load_dwordx4 v10, s[68:71], s7 offen nt lds
    s_branch L_prep_go_3
L_prep_m_2:
    s_sub_u32 s37, s36, 54
    s_lshl_b32 s7, s3, 6
    s_add_u32 s37, s37, s7
    s_cmp_ge_u32 s37, 36
    s_cbranch_scc1 L_prep_go_3
    s_lshl_b32 s7, s37, 1
    v_bfe_u32 v8, v0, 3, 1
    v_add_u32 v8, s7, v8
    v_and_b32 v9, 7, v0
    v_mul_u32_u24 v11, 7282, v8
    v_lshrrev_b32 v11, 16, v11
    v_mul_u32_u24 v12, 9, v11
    v_sub_u32 v12, v8, v12
    v_mul_u32_u24 v11, 72, v11
    v_cmp_eq_u32 vcc, 8, v12
    v_lshrrev_b32 v10, 1, v12
    v_mad_u32_u24 v10, v10, 18, v11
    v_and_b32 v12, 1, v12
    v_lshl_add_u32 v10, v12, 3, v10
    v_add_u32 v10, v10, v9
    v_lshrrev_b32 v12, 1, v9
    v_mad_u32_u24 v11, v12, 18, v11
    v_and_b32 v12, 1, v9
    v_add3_u32 v11, v11, v12, 16
    v_cndmask_b32 v10, v10, v11, vcc
    v_mul_u32_u24 v10, 1152, v10
    v_lshrrev_b32 v9, 4, v0
    v_lshl_add_u32 v10, v9, 4, v10
    buffer_load_dwordx4 v[64:67], v10, s[68:71], 0 offen offset:0
    buffer_load_dwordx4 v[68:71], v10, s[68:71], 0 offen offset:64
    buffer_load_dwordx4 v[72:75], v10, s[68:71], 0 offen offset:128
    buffer_load_dwordx4 v[76:79], v10, s[68:71], 0 offen offset:192
    buffer_load_dwordx4 v[80:83], v10, s[68:71], 0 offen offset:256
    buffer_load_dwordx4 v[84:87], v10, s[68:71], 0 offen offset:320
    buffer_load_dwordx4 v[88:91], v10, s[68:71], 0 offen offset:384
    buffer_load_dwordx4 v[92:95], v10, s[68:71], 0 offen offset:448
    buffer_load_dwordx4 v[96:99], v10, s[68:71], 0 offen offset:512
    buffer_load_dwordx4 v[100:103], v10, s[68:71], 0 offen offset:576
    buffer_load_dwordx4 v[104:107], v10, s[68:71], 0 offen offset:640
    buffer_load_dwordx4 v[108:111], v10, s[68:71], 0 offen offset:704
    buffer_load_dwordx4 v[112:115], v10, s[68:71], 0 offen offset:768
    buffer_load_dwordx4 v[116:119], v10, s[68:71], 0 offen offset:832
    buffer_load_dwordx4 v[120:123], v10, s[68:71], 0 offen offset:896
    buffer_load_dwordx4 v[124:127], v10, s[68:71], 0 offen offset:960
    buffer_load_dwordx4 v[128:131], v10, s[68:71], 0 offen offset:1024
    buffer_load_dwordx4 v[132:135], v10, s[68:71], 0 offen offset:1088
L_prep_go_3:
    s_lshl_b32 s7, s41, 2
    s_add_u32 s7, s7, s3
    s_mul_i32 s93, s7, 25576
    s_lshr_b32 s93, s93, 20
    s_min_u32 s93, s93, 2
    s_mul_i32 s6, s93, 41
    s_sub_u32 s7, s7, s6
    s_lshl_b32 s17, s7, 2
    s_cmp_eq_u32 s93, 1
    s_cselect_b32 s72, s26, s24
    s_cselect_b32 s73, s27, s25
    s_cmp_eq_u32 s93, 2
    s_cselect_b32 s72, s28, s72
    s_cselect_b32 s73, s29, s73
    s_mov_b32 s92, 73728
    s_cmov_b32 s92, 9216
    s_mov_b32 s47, 1152
    s_cmov_b32 s47, 663552
    s_and_b32 s73, s73, 0xffff
    s_mov_b32 s74, 5308416
    s_mov_b32 s75, 0x20000
    s_mul_i32 s47, s47, s40
    s_add_u32 s7, s17, 0
    s_min_u32 s7, s7, 161
    s_mul_i32 s84, s7, 116509
    s_lshr_b32 s84, s84, 20
    s_mul_i32 s88, s84, 9
    s_sub_u32 s88, s7, s88
    s_mul_i32 s7, s84, s92
    s_lshl_b32 s7, s7, 2
    s_add_u32 s7, s7, s47
    s_lshl_b32 s6, s88, 7
    s_add_u32 s80, s7, s6
    s_add_u32 s7, s17, 1
    s_min_u32 s7, s7, 161
    s_mul_i32 s85, s7, 116509
    s_lshr_b32 s85, s85, 20
    s_mul_i32 s89, s85, 9
    s_sub_u32 s89, s7, s89
    s_mul_i32 s7, s85, s92
    s_lshl_b32 s7, s7, 2
    s_add_u32 s7, s7, s47
    s_lshl_b32 s6, s89, 7
    s_add_u32 s81, s7, s6
    s_add_u32 s7, s17, 2
    s_min_u32 s7, s7, 161
    s_mul_i32 s86, s7, 116509
    s_lshr_b32 s86, s86, 20
    s_mul_i32 s90, s86, 9
    s_sub_u32 s90, s7, s90
    s_mul_i32 s7, s86, s92
    s_lshl_b32 s7, s7, 2
    s_add_u32 s7, s7, s47
    s_lshl_b32 s6, s90, 7
    s_add_u32 s82, s7, s6
    s_add_u32 s7, s17, 3
    s_min_u32 s7, s7, 161
    s_mul_i32 s87, s7, 116509
    s_lshr_b32 s87, s87, 20
    s_mul_i32 s91, s87, 9
    s_sub_u32 s91, s7, s91
    s_mul_i32 s7, s87, s92
    s_lshl_b32 s7, s7, 2
    s_add_u32 s7, s7, s47
    s_lshl_b32 s6, s91, 7
    s_add_u32 s83, s7, s6
    s_lshr_b32 s7, s92, 3
    v_lshrrev_b32 v224, 3, v0
    v_mul_lo_u32 v224, v224, s7
    v_and_b32 v8, 7, v0
    v_lshl_add_u32 v224, v8, 4, v224
    s_waitcnt lgkmcnt(0)
    s_mul_i32 s76, s76, 0x9e3779b1
    s_add_u32 s76, s76, 0x7f4a7c15
    s_mov_b32 s77, s76
    s_add_u32 m0, s79, 0
    s_mov_b32 s71, s80
    buffer_load_dwordx4 v224, s[72:75], s71 offen nt lds
    s_add_u32 m0, s79, 1024
    s_add_u32 s71, s71, s92
    buffer_load_dwordx4 v224, s[72:75], s71 offen nt lds
    s_add_u32 m0, s79, 2048
    s_add_u32 s71, s71, s92
    buffer_load_dwordx4 v224, s[72:75], s71 offen nt lds
    s_add_u32 m0, s79, 3072
    s_add_u32 s71, s71, s92
    buffer_load_dwordx4 v224, s[72:75], s71 offen nt lds
    s_waitcnt vmcnt(4)
    s_barrier
    s_cmp_ge_u32 s32, 18
    s_cbranch_scc1 L_prep_o_4
    s_mul_i32 s7, s3, 36
    s_add_u32 s7, s7, s46
    v_lshrrev_b32 v8, 4, v0
    v_lshlrev_b32 v8, 11, v8
    v_add_u32 v8, s7, v8
    v_and_b32 v9, 15, v0
    v_cmp_gt_u32 s[22:23], 6, v9
    v_lshrrev_b32 v10, 1, v9
    v_min_u32 v10, 2, v10
    v_lshl_add_u32 v10, v10, 13, v8
    v_and_b32 v11, 1, v0
    v_lshl_add_u32 v10, v11, 1, v10
    v_lshl_add_u32 v8, v9, 1, v8
    ds_read_u16 v136, v8 offset:8192
    ds_read_u16 v137, v8 offset:8448
    ds_read_u16 v138, v8 offset:8704
    ds_read_u16 v139, v8 offset:8960
    ds_read_u16 v140, v8 offset:9216
    ds_read_u16 v141, v8 offset:9472
    ds_read_u16 v142, v8 offset:9728
    ds_read_u16 v143, v8 offset:9984
    s_lshl_b32 s33, s40, 2
    s_add_u32 s33, s33, s3
    s_mul_i32 s33, s33, 18
    s_add_u32 s33, s33, s32
    s_lshl_b32 s33, s33, 12
    ds_read_u16 v144, v8 offset:16384
    ds_read_u16 v145, v8 offset:16640
    ds_read_u16 v146, v8 offset:16896
    ds_read_u16 v147, v8 offset:17152
    ds_read_u16 v148, v8 offset:17408
    ds_read_u16 v149, v8 offset:17664
    ds_read_u16 v150, v8 offset:17920
    ds_read_u16 v151, v8 offset:18176
    s_waitcnt lgkmcnt(8)
    v_lshl_or_b32 v32, v137, 16, v136
    v_lshl_or_b32 v33, v139, 16, v138
    v_lshl_or_b32 v34, v141, 16, v140
    v_lshl_or_b32 v35, v143, 16, v142
    buffer_store_dwordx4 v[32:35], v253, s[8:11], s33 offen offset:0 sc1
    ds_read_u16 v152, v8 offset:24576
    ds_read_u16 v153, v8 offset:24832
    ds_read_u16 v154, v8 offset:25088
    ds_read_u16 v155, v8 offset:25344
    ds_read_u16 v156, v8 offset:25600
    ds_read_u16 v157, v8 offset:25856
    ds_read_u16 v158, v8 offset:26112
    ds_read_u16 v159, v8 offset:26368
    s_waitcnt lgkmcnt(8)
    v_lshl_or_b32 v36, v145, 16, v144
    v_lshl_or_b32 v37, v147, 16, v146
    v_lshl_or_b32 v38, v149, 16, v148
    v_lshl_or_b32 v39, v151, 16, v150
    buffer_store_dwordx4 v[36:39], v253, s[8:11], s33 offen offset:1024 sc1
    ds_read_u16 v160, v10 offset:8224
    ds_read_u16 v161, v10 offset:8480
    ds_read_u16 v162, v10 offset:8736
    ds_read_u16 v163, v10 offset:8992
    ds_read_u16 v164, v10 offset:9248
    ds_read_u16 v165, v10 offset:9504
    ds_read_u16 v166, v10 offset:9760
    ds_read_u16 v167, v10 offset:10016
    s_waitcnt lgkmcnt(8)
    v_lshl_or_b32 v40, v153, 16, v152
    v_lshl_or_b32 v41, v155, 16, v154
    v_lshl_or_b32 v42, v157, 16, v156
    v_lshl_or_b32 v43, v159, 16, v158
    buffer_store_dwordx4 v[40:43], v253, s[8:11], s33 offen offset:2048 sc1
    s_waitcnt lgkmcnt(0)
    v_lshl_or_b32 v44, v161, 16, v160
    v_cndmask_b32 v44, 0, v44, s[22:23]
    v_lshl_or_b32 v45, v163, 16, v162
    v_cndmask_b32 v45, 0, v45, s[22:23]
    v_lshl_or_b32 v46, v165, 16, v164
    v_cndmask_b32 v46, 0, v46, s[22:23]
    v_lshl_or_b32 v47, v167, 16, v166
    v_cndmask_b32 v47, 0, v47, s[22:23]
    buffer_store_dwordx4 v[44:47], v253, s[8:11], s33 offen offset:3072 sc1
    s_branch L_prep_done_6
L_prep_o_4:
    s_cmp_ge_u32 s36, 54
    s_cbranch_scc1 L_prep_m_5
    v_lshrrev_b32 v8, 4, v0
    v_lshlrev_b32 v8, 3, v8
    v_bfe_u32 v9, v0, 2, 2
    v_add_u32 v8, v8, v9
    v_mul_u32_u24 v8, 128, v8
    v_and_b32 v9, 3, v0
    v_lshl_add_u32 v8, v9, 3, v8
    s_lshl_b32 s7, s3, 5
    v_add_u32 v8, s7, v8
    ds_read_b64_tr_b16 v[32:33], v8 offset:8192
    ds_read_b64_tr_b16 v[34:35], v8 offset:8704
    ds_read_b64_tr_b16 v[36:37], v8 offset:12288
    ds_read_b64_tr_b16 v[38:39], v8 offset:12800
    ds_read_b64_tr_b16 v[40:41], v8 offset:16384
    ds_read_b64_tr_b16 v[42:43], v8 offset:16896
    s_mul_i32 s34, s34, 12
    s_add_u32 s34, s34, s3
    s_mul_i32 s34, s34, 18
    s_add_u32 s34, s34, s33
    s_lshl_b32 s34, s34, 10
    s_add_u32 s7, s34, 2359296
    s_waitcnt lgkmcnt(4)
    buffer_store_dwordx4 v[32:35], v253, s[8:11], s7 offen sc1
    s_add_u32 s7, s34, 2433024
    s_waitcnt lgkmcnt(2)
    buffer_store_dwordx4 v[36:39], v253, s[8:11], s7 offen sc1
    s_add_u32 s7, s34, 2506752
    s_waitcnt lgkmcnt(0)
    buffer_store_dwordx4 v[40:43], v253, s[8:11], s7 offen sc1
    s_branch L_prep_done_6
L_prep_m_5:
    s_cmp_ge_u32 s37, 36
    s_cbranch_scc1 L_prep_done_6
    v_mov_b32 v28, 0x3f803f80
    v_mov_b32 v29, 0x3f803f80
    v_mov_b32 v30, 0x3f803f80
    v_mov_b32 v31, 0x3f803f80
    v_and_b32 v9, 15, v0
    v_cmp_eq_u32 vcc, 0, v9
    v_cmp_eq_u32 s[22:23], 1, v9
    v_mfma_f32_16x16x32_bf16 v[32:35], v[64:67], v[28:31], 0
    v_mfma_f32_16x16x32_bf16 v[32:35], v[68:71], v[28:31], v[32:35]
    v_mfma_f32_16x16x32_bf16 v[32:35], v[72:75], v[28:31], v[32:35]
    v_mfma_f32_16x16x32_bf16 v[32:35], v[76:79], v[28:31], v[32:35]
    v_mfma_f32_16x16x32_bf16 v[32:35], v[80:83], v[28:31], v[32:35]
    v_mfma_f32_16x16x32_bf16 v[32:35], v[84:87], v[28:31], v[32:35]
    v_mfma_f32_16x16x32_bf16 v[32:35], v[88:91], v[28:31], v[32:35]
    v_mfma_f32_16x16x32_bf16 v[32:35], v[92:95], v[28:31], v[32:35]
    v_mfma_f32_16x16x32_bf16 v[32:35], v[96:99], v[28:31], v[32:35]
    v_mfma_f32_16x16x32_bf16 v[32:35], v[100:103], v[28:31], v[32:35]
    v_mfma_f32_16x16x32_bf16 v[32:35], v[104:107], v[28:31], v[32:35]
    v_mfma_f32_16x16x32_bf16 v[32:35], v[108:111], v[28:31], v[32:35]
    v_mfma_f32_16x16x32_bf16 v[32:35], v[112:115], v[28:31], v[32:35]
    v_mfma_f32_16x16x32_bf16 v[32:35], v[116:119], v[28:31], v[32:35]
    v_mfma_f32_16x16x32_bf16 v[32:35], v[120:123], v[28:31], v[32:35]
    v_mfma_f32_16x16x32_bf16 v[32:35], v[124:127], v[28:31], v[32:35]
    v_mfma_f32_16x16x32_bf16 v[32:35], v[128:131], v[28:31], v[32:35]
    v_mfma_f32_16x16x32_bf16 v[32:35], v[132:135], v[28:31], v[32:35]
    v_lshrrev_b32 v10, 5, v0
    v_lshlrev_b32 v10, 8, v10
    v_lshl_add_u32 v10, v9, 4, v10
    v_bfe_u32 v9, v0, 4, 1
    v_lshl_add_u32 v10, v9, 3, v10
    s_lshl_b32 s7, s37, 9
    s_add_u32 s7, s7, 3022848
    s_nop 0
    v_mul_f32 v32, 0x3ae38e39, v32
    v_mul_f32 v33, 0x3ae38e39, v33
    v_mul_f32 v34, 0x3ae38e39, v34
    v_mul_f32 v35, 0x3ae38e39, v35
    v_cvt_pk_bf16_f32 v36, v32, v33
    v_cvt_pk_bf16_f32 v37, v34, v35
    v_lshlrev_b32 v38, 16, v36
    v_and_b32 v39, s16, v36
    v_sub_f32 v38, v32, v38
    v_sub_f32 v39, v33, v39
    v_cvt_pk_bf16_f32 v28, v38, v39
    v_cndmask_b32 v28, 0, v28, s[22:23]
    v_cndmask_b32 v28, v28, v36, vcc
    v_lshlrev_b32 v38, 16, v37
    v_and_b32 v39, s16, v37
    v_sub_f32 v38, v34, v38
    v_sub_f32 v39, v35, v39
    v_cvt_pk_bf16_f32 v29, v38, v39
    v_cndmask_b32 v29, 0, v29, s[22:23]
    v_cndmask_b32 v29, v29, v37, vcc
    buffer_store_dwordx2 v[28:29], v10, s[8:11], s7 offen sc1
L_prep_done_6:
    s_add_u32 s19, s18, 43515904
    s_add_u32 s20, s18, 38797312
    s_lshl_b32 s22, s21, 7
    s_add_u32 s22, s22, 48234496
    buffer_store_dwordx4 v[16:19], v172, s[8:11], s19 offen sc1
    buffer_store_dwordx4 v[20:23], v173, s[8:11], s19 offen sc1
    buffer_store_dwordx4 v[24:27], v174, s[8:11], s19 offen sc1
    s_mov_b32 s17, 0x3f803f80
    v_mov_b32 v8, 0
    v_mov_b32 v9, 0
    v_mov_b32 v10, 0
    v_mov_b32 v11, 0
    v_dot2c_f32_bf16 v8, s17, v16
    v_dot2c_f32_bf16 v9, v16, v16
    v_dot2c_f32_bf16 v10, s17, v17
    v_dot2c_f32_bf16 v11, v17, v17
    v_dot2c_f32_bf16 v8, s17, v18
    v_dot2c_f32_bf16 v9, v18, v18
    v_dot2c_f32_bf16 v10, s17, v19
    v_dot2c_f32_bf16 v11, v19, v19
    v_dot2c_f32_bf16 v8, s17, v20
    v_dot2c_f32_bf16 v9, v20, v20
    v_dot2c_f32_bf16 v10, s17, v21
    v_dot2c_f32_bf16 v11, v21, v21
    v_dot2c_f32_bf16 v8, s17, v22
    v_dot2c_f32_bf16 v9, v22, v22
    v_dot2c_f32_bf16 v10, s17, v23
    v_dot2c_f32_bf16 v11, v23, v23
    v_dot2c_f32_bf16 v8, s17, v24
    v_dot2c_f32_bf16 v9, v24, v24
    v_dot2c_f32_bf16 v10, s17, v25
    v_dot2c_f32_bf16 v11, v25, v25
    v_dot2c_f32_bf16 v8, s17, v26
    v_dot2c_f32_bf16 v9, v26, v26
    v_dot2c_f32_bf16 v10, s17, v27
    v_dot2c_f32_bf16 v11, v27, v27
    v_and_b32 v12, 7, v0
    v_lshlrev_b32 v12, 3, v12
    s_lshl_b32 s7, s3, 6
    v_add_u32 v13, s7, v12
    v_pk_add_f32 v[8:9], v[8:9], v[10:11]
    s_nop 1
    v_add_f32_dpp v8, v8, v8 row_ror:8 row_mask:0xf bank_mask:0xf
    v_add_f32_dpp v9, v9, v9 row_ror:8 row_mask:0xf bank_mask:0xf
    v_mov_b32 v10, v8
    v_mov_b32 v11, v9
    s_nop 1
    v_permlane32_swap_b32 v10, v8
    v_permlane32_swap_b32 v11, v9
    v_add_f32 v8, v8, v10
    v_add_f32 v9, v9, v11
    v_mov_b32 v10, v8
    v_mov_b32 v11, v9
    s_nop 1
    v_permlane16_swap_b32 v10, v8
    v_permlane16_swap_b32 v11, v9
    v_add_f32 v8, v8, v10
    v_add_f32 v9, v9, v11
    ds_write_b64 v13, v[8:9]
    s_waitcnt lgkmcnt(0)
    s_barrier
    ds_read_b64 v[40:41], v12 offset:0
    ds_read_b64 v[42:43], v12 offset:64
    ds_read_b64 v[44:45], v12 offset:128
    ds_read_b64 v[46:47], v12 offset:192
    s_waitcnt lgkmcnt(0)
    v_pk_add_f32 v[40:41], v[40:41], v[42:43]
    v_pk_add_f32 v[44:45], v[44:45], v[46:47]
    v_pk_add_f32 v[8:9], v[40:41], v[44:45]
    v_mul_f32 v8, 0x3ae38e39, v8
    v_mul_f32 v9, 0x3ae38e39, v9
    v_fma_f32 v9, -v8, v8, v9
    v_max_f32 v9, 0, v9
    v_add_f32 v9, 0x3727c5ac, v9
    v_rsq_f32 v10, v9
    s_nop 0
    v_mul_f32 v12, v8, v10
    v_mov_b32 v11, v10
    v_sub_f32 v12, 0, v12
    v_mov_b32 v13, v12
    s_cmp_eq_u32 s3, 0
    s_cselect_b32 s7, 32, 0
    v_lshlrev_b32 v14, 2, v0
    v_cmp_gt_u32 vcc, s7, v0
    v_mov_b32 v9, 1073741824
    s_nop 0
    v_cndmask_b32 v14, v9, v14, vcc
    buffer_store_dword v8, v14, s[8:11], s22 offen sc1
    v_lshlrev_b32 v40, 16, v16
    v_and_b32 v41, s16, v16
    v_lshlrev_b32 v42, 16, v17
    v_and_b32 v43, s16, v17
    v_lshlrev_b32 v44, 16, v18
    v_and_b32 v45, s16, v18
    v_lshlrev_b32 v46, 16, v19
    v_and_b32 v47, s16, v19
    v_pk_fma_f32 v[40:41], v[40:41], v[10:11], v[12:13]
    v_pk_fma_f32 v[42:43], v[42:43], v[10:11], v[12:13]
    v_pk_fma_f32 v[44:45], v[44:45], v[10:11], v[12:13]
    v_pk_fma_f32 v[46:47], v[46:47], v[10:11], v[12:13]
    v_cvt_pk_bf16_f32 v48, v40, v41
    v_cvt_pk_bf16_f32 v49, v42, v43
    v_cvt_pk_bf16_f32 v50, v44, v45
    v_cvt_pk_bf16_f32 v51, v46, v47
    v_lshlrev_b32 v40, 16, v20
    v_and_b32 v41, s16, v20
    v_lshlrev_b32 v42, 16, v21
    v_and_b32 v43, s16, v21
    v_lshlrev_b32 v44, 16, v22
    v_and_b32 v45, s16, v22
    v_lshlrev_b32 v46, 16, v23
    v_and_b32 v47, s16, v23
    v_pk_fma_f32 v[40:41], v[40:41], v[10:11], v[12:13]
    v_pk_fma_f32 v[42:43], v[42:43], v[10:11], v[12:13]
    v_pk_fma_f32 v[44:45], v[44:45], v[10:11], v[12:13]
    v_pk_fma_f32 v[46:47], v[46:47], v[10:11], v[12:13]
    v_cvt_pk_bf16_f32 v52, v40, v41
    v_cvt_pk_bf16_f32 v53, v42, v43
    v_cvt_pk_bf16_f32 v54, v44, v45
    v_cvt_pk_bf16_f32 v55, v46, v47
    v_lshlrev_b32 v40, 16, v24
    v_and_b32 v41, s16, v24
    v_lshlrev_b32 v42, 16, v25
    v_and_b32 v43, s16, v25
    v_lshlrev_b32 v44, 16, v26
    v_and_b32 v45, s16, v26
    v_lshlrev_b32 v46, 16, v27
    v_and_b32 v47, s16, v27
    v_pk_fma_f32 v[40:41], v[40:41], v[10:11], v[12:13]
    v_pk_fma_f32 v[42:43], v[42:43], v[10:11], v[12:13]
    v_pk_fma_f32 v[44:45], v[44:45], v[10:11], v[12:13]
    v_pk_fma_f32 v[46:47], v[46:47], v[10:11], v[12:13]
    v_cvt_pk_bf16_f32 v56, v40, v41
    v_cvt_pk_bf16_f32 v57, v42, v43
    v_cvt_pk_bf16_f32 v58, v44, v45
    v_cvt_pk_bf16_f32 v59, v46, v47
    buffer_store_dwordx4 v[48:51], v172, s[8:11], s20 offen sc1
    buffer_store_dwordx4 v[52:55], v173, s[8:11], s20 offen sc1
    buffer_store_dwordx4 v[56:59], v174, s[8:11], s20 offen sc1
    v_lshlrev_b32 v15, 7, v0
    s_lshl_b32 s6, s40, 2
    s_add_u32 s6, s6, s44
    s_sub_u32 s6, s6, 32768
    v_mov_b32 v1, s76
    s_mov_b64 vcc, 0xff
    v_lshrrev_b32 v14, 3, v0
    v_lshl_add_u32 v15, v14, 3, v15
    s_cmp_ge_u32 s40, 6
    s_cselect_b32 s7, s41, 31
    s_cmp_lt_u32 s7, 31
    s_cmov_b64 vcc, 0xffff
    s_waitcnt vmcnt(0)
    s_barrier
    s_cmp_lg_u32 s3, 0
    s_cbranch_scc1 L_pub_7
    s_mov_b64 exec, vcc
    buffer_store_dword v1, v15, s[8:11], s6 offen sc1
    s_lshl_b32 s6, s40, 7
    s_lshl_b32 s7, s32, 2
    s_add_u32 s6, s6, s7
    s_add_u32 s6, s6, 19431424
    s_mov_b64 exec, 0xffffffff
    v_lshlrev_b32 v15, 10, v0
    v_mov_b32 v1, s76
    buffer_store_dword v1, v15, s[8:11], s6 offen sc1
    s_cmp_lt_u32 s32, 18
    s_cbranch_scc1 L_pub_7
    s_lshl_b32 s6, s36, 2
    s_add_u32 s6, s6, 19496960
    s_mov_b64 exec, 1
    buffer_store_dword v1, off, s[8:11], s6 sc1
L_pub_7:
    s_mov_b64 exec, -1
    s_add_u32 m0, s79, 4096
    s_mov_b32 s71, s81
    buffer_load_dwordx4 v224, s[72:75], s71 offen nt lds
    s_add_u32 m0, s79, 5120
    s_add_u32 s71, s71, s92
    buffer_load_dwordx4 v224, s[72:75], s71 offen nt lds
    s_add_u32 m0, s79, 6144
    s_add_u32 s71, s71, s92
    buffer_load_dwordx4 v224, s[72:75], s71 offen nt lds
    s_add_u32 m0, s79, 7168
    s_add_u32 s71, s71, s92
    buffer_load_dwordx4 v224, s[72:75], s71 offen nt lds
    s_add_u32 m0, s79, 8192
    s_mov_b32 s71, s82
    buffer_load_dwordx4 v224, s[72:75], s71 offen nt lds
    s_add_u32 m0, s79, 9216
    s_add_u32 s71, s71, s92
    buffer_load_dwordx4 v224, s[72:75], s71 offen nt lds
    s_add_u32 m0, s79, 10240
    s_add_u32 s71, s71, s92
    buffer_load_dwordx4 v224, s[72:75], s71 offen nt lds
    s_add_u32 m0, s79, 11264
    s_add_u32 s71, s71, s92
    buffer_load_dwordx4 v224, s[72:75], s71 offen nt lds
    s_add_u32 m0, s79, 12288
    s_mov_b32 s71, s83
    buffer_load_dwordx4 v224, s[72:75], s71 offen nt lds
    s_add_u32 m0, s79, 13312
    s_add_u32 s71, s71, s92
    buffer_load_dwordx4 v224, s[72:75], s71 offen nt lds
    s_add_u32 m0, s79, 14336
    s_add_u32 s71, s71, s92
    buffer_load_dwordx4 v224, s[72:75], s71 offen nt lds
    s_add_u32 m0, s79, 15360
    s_add_u32 s71, s71, s92
    buffer_load_dwordx4 v224, s[72:75], s71 offen nt lds
    s_cmp_lg_u32 s3, 0
    s_cbranch_scc1 L_wq_ready_8
    s_lshl_b32 s7, s41, 3
    s_add_u32 s7, s7, s40
    s_lshl_b32 s7, s7, 7
    s_add_u32 s7, s7, 19431424
    s_add_u32 s68, s4, s7
    s_addc_u32 s69, s5, 0
    s_mov_b32 s6, 0
    s_mov_b32 s7, 0
L_cpoll_9:
    s_load_dwordx16 s[52:67], s[68:69], s7 glc
    s_add_u32 s6, s6, 1
    s_waitcnt lgkmcnt(0)
    s_xor_b64 s[52:53], s[52:53], s[76:77]
    s_xor_b64 s[54:55], s[54:55], s[76:77]
    s_xor_b64 s[56:57], s[56:57], s[76:77]
    s_xor_b64 s[58:59], s[58:59], s[76:77]
    s_xor_b64 s[60:61], s[60:61], s[76:77]
    s_xor_b64 s[62:63], s[62:63], s[76:77]
    s_xor_b64 s[64:65], s[64:65], s[76:77]
    s_xor_b64 s[66:67], s[66:67], s[76:77]
    s_or_b64 s[52:53], s[52:53], s[60:61]
    s_or_b64 s[54:55], s[54:55], s[62:63]
    s_or_b64 s[56:57], s[56:57], s[64:65]
    s_or_b64 s[58:59], s[58:59], s[66:67]
    s_or_b64 s[52:53], s[52:53], s[56:57]
    s_or_b64 s[54:55], s[54:55], s[58:59]
    s_or_b64 s[52:53], s[52:53], s[54:55]
    s_cbranch_scc1 L_cpoll_10
    s_add_u32 s7, s7, 8
    s_cmp_eq_u32 s7, 16
    s_cbranch_scc1 L_cpolled_11
L_cpoll_10:
    s_cmp_lt_u32 s6, 1048576
    s_cbranch_scc1 L_cpoll_9
    s_branch L_main_end
L_cpolled_11:
L_wq_ready_8:
    s_barrier
    s_lshl_b32 s28, s40, 2
    s_add_u32 s28, s28, s3
    s_mul_i32 s28, s28, 73728
    v_and_b32 v229, 8, v0
    v_lshl_add_u32 v229, v229, 27, v253
    buffer_load_dwordx4 a[0:3], v253, s[8:11], s28 offen offset:0 sc1
    buffer_load_dwordx4 a[4:7], v253, s[8:11], s28 offen offset:1024 sc1
    buffer_load_dwordx4 a[8:11], v253, s[8:11], s28 offen offset:2048 sc1
    buffer_load_dwordx4 a[12:15], v229, s[8:11], s28 offen offset:3072 sc1
    s_add_u32 s28, s28, 4096
    buffer_load_dwordx4 a[16:19], v253, s[8:11], s28 offen offset:0 sc1
    buffer_load_dwordx4 a[20:23], v253, s[8:11], s28 offen offset:1024 sc1
    buffer_load_dwordx4 a[24:27], v253, s[8:11], s28 offen offset:2048 sc1
    buffer_load_dwordx4 a[28:31], v229, s[8:11], s28 offen offset:3072 sc1
    s_add_u32 s28, s28, 4096
    buffer_load_dwordx4 a[32:35], v253, s[8:11], s28 offen offset:0 sc1
    buffer_load_dwordx4 a[36:39], v253, s[8:11], s28 offen offset:1024 sc1
    buffer_load_dwordx4 a[40:43], v253, s[8:11], s28 offen offset:2048 sc1
    buffer_load_dwordx4 a[44:47], v229, s[8:11], s28 offen offset:3072 sc1
    s_add_u32 s28, s28, 4096
    buffer_load_dwordx4 a[48:51], v253, s[8:11], s28 offen offset:0 sc1
    buffer_load_dwordx4 a[52:55], v253, s[8:11], s28 offen offset:1024 sc1
    buffer_load_dwordx4 a[56:59], v253, s[8:11], s28 offen offset:2048 sc1
    buffer_load_dwordx4 a[60:63], v229, s[8:11], s28 offen offset:3072 sc1
    s_add_u32 s28, s28, 4096
    buffer_load_dwordx4 a[64:67], v253, s[8:11], s28 offen offset:0 sc1
    buffer_load_dwordx4 a[68:71], v253, s[8:11], s28 offen offset:1024 sc1
    buffer_load_dwordx4 a[72:75], v253, s[8:11], s28 offen offset:2048 sc1
    buffer_load_dwordx4 a[76:79], v229, s[8:11], s28 offen offset:3072 sc1
    s_add_u32 s28, s28, 4096
    buffer_load_dwordx4 a[80:83], v253, s[8:11], s28 offen offset:0 sc1
    buffer_load_dwordx4 a[84:87], v253, s[8:11], s28 offen offset:1024 sc1
    buffer_load_dwordx4 a[88:91], v253, s[8:11], s28 offen offset:2048 sc1
    buffer_load_dwordx4 a[92:95], v229, s[8:11], s28 offen offset:3072 sc1
    s_add_u32 s28, s28, 4096
    buffer_load_dwordx4 a[96:99], v253, s[8:11], s28 offen offset:0 sc1
    buffer_load_dwordx4 a[100:103], v253, s[8:11], s28 offen offset:1024 sc1
    buffer_load_dwordx4 a[104:107], v253, s[8:11], s28 offen offset:2048 sc1
    buffer_load_dwordx4 a[108:111], v229, s[8:11], s28 offen offset:3072 sc1
    s_add_u32 s28, s28, 4096
    buffer_load_dwordx4 a[112:115], v253, s[8:11], s28 offen offset:0 sc1
    buffer_load_dwordx4 a[116:119], v253, s[8:11], s28 offen offset:1024 sc1
    buffer_load_dwordx4 a[120:123], v253, s[8:11], s28 offen offset:2048 sc1
    buffer_load_dwordx4 a[124:127], v229, s[8:11], s28 offen offset:3072 sc1
    s_add_u32 s28, s28, 4096
    buffer_load_dwordx4 a[128:131], v253, s[8:11], s28 offen offset:0 sc1
    buffer_load_dwordx4 a[132:135], v253, s[8:11], s28 offen offset:1024 sc1
    buffer_load_dwordx4 a[136:139], v253, s[8:11], s28 offen offset:2048 sc1
    buffer_load_dwordx4 a[140:143], v229, s[8:11], s28 offen offset:3072 sc1
    s_add_u32 s28, s28, 4096
L_main_layer:
    v_bfe_u32 v3, v0, 3, 1
    v_mul_u32_u24 v2, 9216, v3
    v_lshrrev_b32 v3, 4, v0
    v_lshl_add_u32 v2, v3, 7, v2
    v_and_b32 v3, 7, v0
    v_lshl_add_u32 v2, v3, 4, v2
    v_bfe_u32 v3, v0, 3, 2
    s_mov_b32 s7, 9216
    v_mul_lo_u32 v9, v3, s7
    v_lshrrev_b32 v3, 5, v0
    v_lshl_add_u32 v9, v3, 7, v9
    v_and_b32 v3, 7, v0
    v_lshl_add_u32 v9, v3, 4, v9
    s_mul_i32 s22, s41, 73728
    s_add_u32 s22, s22, s43
    s_add_u32 s23, s22, 38797312
    s_mul_i32 s7, s3, 18432
    s_add_u32 s24, s23, s7
    s_cmp_eq_u32 s41, 0
    s_cselect_b32 s7, 0, 18432
    s_sub_u32 s23, s23, s7
    s_lshl_b32 s25, s3, 10
    s_add_u32 s25, s25, 1024
    s_mul_i32 s26, s3, 5120
    s_lshl_b32 s7, s3, 9
    s_add_u32 s27, s23, s7
    s_and_b32 s7, s3, 1
    s_add_u32 s7, s7, 4
    s_mul_i32 s29, s7, 5120
    s_lshl_b32 s7, s7, 9
    s_add_u32 s23, s23, s7
    s_cmp_lg_u32 s3, 3
    s_cbranch_scc1 L_pollout_14
    s_lshl_b32 s7, s40, 7
    s_add_u32 s7, s7, s44
    s_sub_u32 s7, s7, 32768
    s_add_u32 s52, s4, s7
    s_addc_u32 s53, s5, 0
    s_cmp_eq_u32 s41, 0
    s_cselect_b32 s7, 0, 32
    s_mov_b32 s6, 0
L_poll_12:
    s_load_dwordx8 s[56:63], s[52:53], 0 glc
    s_load_dwordx2 s[54:55], s[52:53], s7 glc
    s_add_u32 s6, s6, 1
    s_waitcnt lgkmcnt(0)
    s_xor_b64 s[54:55], s[54:55], s[76:77]
    s_xor_b64 s[56:57], s[56:57], s[76:77]
    s_xor_b64 s[58:59], s[58:59], s[76:77]
    s_xor_b64 s[60:61], s[60:61], s[76:77]
    s_xor_b64 s[62:63], s[62:63], s[76:77]
    s_or_b64 s[56:57], s[56:57], s[58:59]
    s_or_b64 s[60:61], s[60:61], s[62:63]
    s_or_b64 s[56:57], s[56:57], s[54:55]
    s_or_b64 s[56:57], s[56:57], s[60:61]
    s_cbranch_scc0 L_polled_13
    s_cmp_lt_u32 s6, 1048576
    s_cbranch_scc1 L_poll_12
    s_branch L_main_end
L_polled_13:
L_pollout_14:
    s_barrier
    s_add_u32 m0, s25, 0
    s_nop 0
    buffer_load_dwordx4 v2, s[8:11], s24 offen offset:0 sc1 lds
    s_add_u32 m0, s25, 4608
    s_nop 0
    buffer_load_dwordx4 v2, s[8:11], s24 offen offset:512 sc1 lds
    s_add_u32 m0, s25, 9216
    s_nop 0
    buffer_load_dwordx4 v2, s[8:11], s24 offen offset:1024 sc1 lds
    s_add_u32 m0, s25, 13824
    s_nop 0
    buffer_load_dwordx4 v2, s[8:11], s24 offen offset:1536 sc1 lds
    s_add_u32 m0, s25, 18432
    s_nop 0
    buffer_load_dwordx4 v2, s[8:11], s24 offen offset:2048 sc1 lds
    s_add_u32 m0, s25, 23040
    s_nop 0
    buffer_load_dwordx4 v2, s[8:11], s24 offen offset:2560 sc1 lds
    s_add_u32 m0, s26, 0
    s_add_u32 s7, s27, 0
    buffer_load_dwordx4 v2, s[8:11], s7 offen sc1 lds
    s_add_u32 m0, s29, 0
    s_add_u32 s7, s23, 0
    buffer_load_dwordx4 v2, s[8:11], s7 offen sc1 lds
    v_add_u32 v6, 46080, v253
    s_waitcnt vmcnt(0)
    s_barrier
    ds_read_b128 v[16:19], v253 offset:0
    ds_read_b128 v[20:23], v253 offset:1024
    ds_read_b128 v[24:27], v253 offset:2048
    ds_read_b128 v[28:31], v253 offset:3072
    ds_read_b128 v[32:35], v253 offset:4096
    s_waitcnt lgkmcnt(0)
    v_mfma_f32_16x16x32_bf16 v[56:59], a[0:3], v[20:23], 0
    ds_read_b128 v[36:39], v253 offset:5120
    v_mfma_f32_16x16x32_bf16 v[60:63], a[0:3], v[24:27], 0
    ds_read_b128 v[40:43], v253 offset:6144
    v_mfma_f32_16x16x32_bf16 v[64:67], a[0:3], v[28:31], 0
    ds_read_b128 v[44:47], v253 offset:7168
    v_mfma_f32_16x16x32_bf16 v[68:71], a[0:3], v[32:35], 0
    ds_read_b128 v[48:51], v253 offset:8192
    v_mfma_f32_16x16x32_bf16 v[72:75], a[4:7], v[16:19], 0
    ds_read_b128 v[52:55], v253 offset:9216
    v_mfma_f32_16x16x32_bf16 v[76:79], a[4:7], v[20:23], 0
    s_add_u32 m0, s25, 27648
    s_nop 0
    buffer_load_dwordx4 v2, s[8:11], s24 offen offset:3072 sc1 lds
    v_mfma_f32_16x16x32_bf16 v[80:83], a[4:7], v[24:27], 0
    v_mov_b32 v132, 0
    v_mov_b32 v133, 0
    v_mfma_f32_16x16x32_bf16 v[84:87], a[4:7], v[28:31], 0
    s_add_u32 m0, s25, 32256
    s_nop 0
    buffer_load_dwordx4 v2, s[8:11], s24 offen offset:3584 sc1 lds
    v_mfma_f32_16x16x32_bf16 v[88:91], a[4:7], v[32:35], 0
    v_mov_b32 v192, 0
    v_mov_b32 v193, 0
    v_mfma_f32_16x16x32_bf16 v[92:95], v[16:19], a[8:11], 0
    buffer_load_dwordx4 a[144:147], v253, s[8:11], s28 offen offset:0 sc1
    v_mfma_f32_16x16x32_bf16 v[96:99], v[20:23], a[8:11], 0
    v_mov_b32 v195, 0
    v_mov_b32 v135, 0
    v_mfma_f32_16x16x32_bf16 v[100:103], v[24:27], a[8:11], 0
    buffer_load_dwordx4 a[148:151], v253, s[8:11], s28 offen offset:1024 sc1
    v_mfma_f32_16x16x32_bf16 v[104:107], v[28:31], a[8:11], 0
    v_mov_b32 v139, 0
    v_mov_b32 v143, 0
    v_mfma_f32_16x16x32_bf16 v[108:111], v[32:35], a[8:11], 0
    buffer_load_dwordx4 a[152:155], v253, s[8:11], s28 offen offset:2048 sc1
    v_mfma_f32_16x16x32_bf16 v[112:115], a[12:15], v[16:19], 0
    v_mov_b32 v147, 0
    v_mov_b32 v151, 0
    v_mfma_f32_16x16x32_bf16 v[116:119], a[12:15], v[20:23], 0
    v_mov_b32 v155, 0
    v_mov_b32 v159, 0
    v_mfma_f32_16x16x32_bf16 v[120:123], a[12:15], v[24:27], 0
    v_mov_b32 v163, 0
    v_mov_b32 v167, 0
    v_mfma_f32_16x16x32_bf16 v[124:127], a[12:15], v[28:31], 0
    v_mov_b32 v171, 0
    v_cmp_eq_u32 vcc, 16, v0
    v_mov_b32 v10, 0x3f80
    v_mfma_f32_16x16x32_bf16 v[128:131], a[12:15], v[32:35], 0
    v_cmp_eq_u32 s[20:21], 17, v0
    v_cndmask_b32 v194, 0, v10, vcc
    v_and_b32 v11, 3, v0
    s_waitcnt lgkmcnt(0)
    v_mfma_f32_16x16x32_bf16 v[56:59], a[16:19], v[40:43], v[56:59]
    ds_read_b128 v[16:19], v253 offset:10240
    v_mfma_f32_16x16x32_bf16 v[60:63], a[16:19], v[44:47], v[60:63]
    ds_read_b128 v[20:23], v253 offset:11264
    v_mfma_f32_16x16x32_bf16 v[64:67], a[16:19], v[48:51], v[64:67]
    ds_read_b128 v[24:27], v253 offset:12288
    v_mfma_f32_16x16x32_bf16 v[68:71], a[16:19], v[52:55], v[68:71]
    ds_read_b128 v[28:31], v253 offset:13312
    v_mfma_f32_16x16x32_bf16 v[72:75], a[20:23], v[36:39], v[72:75]
    ds_read_b128 v[32:35], v253 offset:14336
    v_mfma_f32_16x16x32_bf16 v[76:79], a[20:23], v[40:43], v[76:79]
    s_add_u32 m0, s25, 40960
    s_add_u32 s24, s24, 4096
    buffer_load_dwordx4 v2, s[8:11], s24 offen offset:0 sc1 lds
    v_mfma_f32_16x16x32_bf16 v[80:83], a[20:23], v[44:47], v[80:83]
    v_cndmask_b32 v194, v194, 1.0, s[20:21]
    v_cmp_eq_u32 vcc, 2, v11
    v_and_b32 v10, 15, v0
    v_mfma_f32_16x16x32_bf16 v[84:87], a[20:23], v[48:51], v[84:87]
    s_add_u32 m0, s25, 45568
    s_nop 0
    buffer_load_dwordx4 v2, s[8:11], s24 offen offset:512 sc1 lds
    v_mfma_f32_16x16x32_bf16 v[88:91], a[20:23], v[52:55], v[88:91]
    v_lshrrev_b32 v11, 4, v0
    v_cndmask_b32 v196, 0, 1.0, vcc
    v_mfma_f32_16x16x32_bf16 v[92:95], v[36:39], a[24:27], v[92:95]
    buffer_load_dwordx4 a[156:159], v229, s[8:11], s28 offen offset:3072 sc1
    s_add_u32 s28, s28, 4096
    v_mfma_f32_16x16x32_bf16 v[96:99], v[40:43], a[24:27], v[96:99]
    v_cndmask_b32 v197, 0, 1.0, vcc
    v_cndmask_b32 v198, 0, 1.0, vcc
    v_mfma_f32_16x16x32_bf16 v[100:103], v[44:47], a[24:27], v[100:103]
    buffer_load_dwordx4 a[0:3], v253, s[8:11], s28 offen offset:0 sc1
    v_mfma_f32_16x16x32_bf16 v[104:107], v[48:51], a[24:27], v[104:107]
    v_cndmask_b32 v199, 0, 1.0, vcc
    v_lshlrev_b32 v11, 2, v11
    v_mfma_f32_16x16x32_bf16 v[108:111], v[52:55], a[24:27], v[108:111]
    buffer_load_dwordx4 a[4:7], v253, s[8:11], s28 offen offset:1024 sc1
    v_mfma_f32_16x16x32_bf16 v[112:115], a[28:31], v[36:39], v[112:115]
    v_sub_u32 v10, v11, v10
    v_mov_b32 v12, 0xf149f2ca
    v_mfma_f32_16x16x32_bf16 v[116:119], a[28:31], v[40:43], v[116:119]
    s_cmp_eq_u32 s41, 0
    s_cselect_b64 s[38:39], 0, -1
    v_add_u32 v11, 0, v10
    v_and_b32 v13, 1, v11
    v_mfma_f32_16x16x32_bf16 v[120:123], a[28:31], v[44:47], v[120:123]
    v_cmp_eq_u32 s[20:21], 0, v13
    v_cmp_lt_i32 vcc, 1, v11
    v_cmp_gt_i32 s[18:19], 1, v11
    s_and_b64 vcc, vcc, s[20:21]
    s_and_b64 s[18:19], s[18:19], s[20:21]
    s_and_b64 s[20:21], vcc, s[38:39]
    v_cndmask_b32 v200, v12, 0, vcc
    v_cndmask_b32 v204, v12, 0, s[18:19]
    v_mfma_f32_16x16x32_bf16 v[124:127], a[28:31], v[48:51], v[124:127]
    v_cndmask_b32 v208, v12, 0, s[20:21]
    v_add_u32 v11, 1, v10
    v_mfma_f32_16x16x32_bf16 v[128:131], a[28:31], v[52:55], v[128:131]
    v_and_b32 v13, 1, v11
    v_cmp_eq_u32 s[20:21], 0, v13
    v_cmp_lt_i32 vcc, 1, v11
    v_cmp_gt_i32 s[18:19], 1, v11
    s_and_b64 vcc, vcc, s[20:21]
    s_and_b64 s[18:19], s[18:19], s[20:21]
    s_and_b64 s[20:21], vcc, s[38:39]
    v_cndmask_b32 v201, v12, 0, vcc
    s_waitcnt lgkmcnt(0)
    v_mfma_f32_16x16x32_bf16 v[56:59], a[32:35], v[20:23], v[56:59]
    ds_read_b128 v[36:39], v253 offset:15360
    v_mfma_f32_16x16x32_bf16 v[60:63], a[32:35], v[24:27], v[60:63]
    ds_read_b128 v[40:43], v253 offset:16384
    v_mfma_f32_16x16x32_bf16 v[64:67], a[32:35], v[28:31], v[64:67]
    ds_read_b128 v[44:47], v253 offset:17408
    v_mfma_f32_16x16x32_bf16 v[68:71], a[32:35], v[32:35], v[68:71]
    ds_read_b128 v[48:51], v253 offset:18432
    v_mfma_f32_16x16x32_bf16 v[72:75], a[36:39], v[16:19], v[72:75]
    ds_read_b128 v[52:55], v253 offset:19456
    v_mfma_f32_16x16x32_bf16 v[76:79], a[36:39], v[20:23], v[76:79]
    s_add_u32 m0, s25, 50176
    s_nop 0
    buffer_load_dwordx4 v2, s[8:11], s24 offen offset:1024 sc1 lds
    v_mfma_f32_16x16x32_bf16 v[80:83], a[36:39], v[24:27], v[80:83]
    v_cndmask_b32 v205, v12, 0, s[18:19]
    v_cndmask_b32 v209, v12, 0, s[20:21]
    v_mfma_f32_16x16x32_bf16 v[84:87], a[36:39], v[28:31], v[84:87]
    s_add_u32 m0, s25, 54784
    s_nop 0
    buffer_load_dwordx4 v2, s[8:11], s24 offen offset:1536 sc1 lds
    v_mfma_f32_16x16x32_bf16 v[88:91], a[36:39], v[32:35], v[88:91]
    v_add_u32 v11, 2, v10
    v_and_b32 v13, 1, v11
    v_mfma_f32_16x16x32_bf16 v[92:95], v[16:19], a[40:43], v[92:95]
    buffer_load_dwordx4 a[8:11], v253, s[8:11], s28 offen offset:2048 sc1
    v_mfma_f32_16x16x32_bf16 v[96:99], v[20:23], a[40:43], v[96:99]
    v_cmp_eq_u32 s[20:21], 0, v13
    v_cmp_lt_i32 vcc, 1, v11
    v_cmp_gt_i32 s[18:19], 1, v11
    s_and_b64 vcc, vcc, s[20:21]
    s_and_b64 s[18:19], s[18:19], s[20:21]
    s_and_b64 s[20:21], vcc, s[38:39]
    v_cndmask_b32 v202, v12, 0, vcc
    v_cndmask_b32 v206, v12, 0, s[18:19]
    v_mfma_f32_16x16x32_bf16 v[100:103], v[24:27], a[40:43], v[100:103]
    buffer_load_dwordx4 a[12:15], v229, s[8:11], s28 offen offset:3072 sc1
    s_add_u32 s28, s28, 4096
    v_mfma_f32_16x16x32_bf16 v[104:107], v[28:31], a[40:43], v[104:107]
    v_cndmask_b32 v210, v12, 0, s[20:21]
    v_add_u32 v11, 3, v10
    v_mfma_f32_16x16x32_bf16 v[108:111], v[32:35], a[40:43], v[108:111]
    buffer_load_dwordx4 a[16:19], v253, s[8:11], s28 offen offset:0 sc1
    v_mfma_f32_16x16x32_bf16 v[112:115], a[44:47], v[16:19], v[112:115]
    v_and_b32 v13, 1, v11
    v_cmp_eq_u32 s[20:21], 0, v13
    v_cmp_lt_i32 vcc, 1, v11
    v_cmp_gt_i32 s[18:19], 1, v11
    s_and_b64 vcc, vcc, s[20:21]
    s_and_b64 s[18:19], s[18:19], s[20:21]
    s_and_b64 s[20:21], vcc, s[38:39]
    v_cndmask_b32 v203, v12, 0, vcc
    v_mfma_f32_16x16x32_bf16 v[116:119], a[44:47], v[20:23], v[116:119]
    v_cndmask_b32 v207, v12, 0, s[18:19]
    v_cndmask_b32 v211, v12, 0, s[20:21]
    v_mfma_f32_16x16x32_bf16 v[120:123], a[44:47], v[24:27], v[120:123]
    s_lshl_b32 s45, s41, 1
    s_lshr_b32 s7, s40, 2
    s_add_u32 s45, s45, s7
    s_mul_i32 s30, s45, 36864
    s_add_u32 s30, s30, s43
    s_and_b32 s31, s40, 3
    s_mul_i32 s31, s31, 9
    s_add_u32 s31, s31, s3
    s_mul_i32 s32, s31, 18432
    s_add_u32 s32, s32, 2359296
    s_add_u32 s33, s32, 73728
    s_add_u32 s34, s32, 147456
    s_mov_b32 s39, 19496960
    v_min_u32 v228, 44, v0
    v_lshlrev_b32 v228, 3, v228
    v_mfma_f32_16x16x32_bf16 v[124:127], a[44:47], v[28:31], v[124:127]
    s_cmp_eq_u32 s3, 1
    s_cmov_b32 s34, 3022848
    s_cmp_lt_u32 s3, 2
    s_cselect_b32 s35, 0, 1073741824
    v_add_u32 v5, s35, v253
    s_cmp_eq_u32 s3, 1
    s_cselect_b32 s7, 8, 0
    v_and_b32 v10, s7, v0
    v_mfma_f32_16x16x32_bf16 v[128:131], a[44:47], v[32:35], v[128:131]
    v_lshl_add_u32 v5, v10, 27, v5
    s_cmp_eq_u32 s3, 0
    s_cselect_b32 s35, 0, 1073741824
    v_add_u32 v7, s35, v9
    s_waitcnt lgkmcnt(0)
    v_mfma_f32_16x16x32_bf16 v[56:59], a[48:51], v[40:43], v[56:59]
    ds_read_b128 v[16:19], v253 offset:20480
    v_mfma_f32_16x16x32_bf16 v[60:63], a[48:51], v[44:47], v[60:63]
    ds_read_b128 v[20:23], v253 offset:21504
    v_mfma_f32_16x16x32_bf16 v[64:67], a[48:51], v[48:51], v[64:67]
    ds_read_b128 v[24:27], v253 offset:22528
    v_mfma_f32_16x16x32_bf16 v[68:71], a[48:51], v[52:55], v[68:71]
    ds_read_b128 v[28:31], v253 offset:23552
    v_mfma_f32_16x16x32_bf16 v[72:75], a[52:55], v[36:39], v[72:75]
    ds_read_b128 v[32:35], v253 offset:24576
    v_mfma_f32_16x16x32_bf16 v[76:79], a[52:55], v[40:43], v[76:79]
    s_add_u32 m0, s26, 30720
    s_add_u32 s7, s27, 3072
    buffer_load_dwordx4 v2, s[8:11], s7 offen sc1 lds
    v_mfma_f32_16x16x32_bf16 v[80:83], a[52:55], v[44:47], v[80:83]
    s_lshl_b32 s7, s31, 8
    s_add_u32 s36, s30, s7
    s_add_u32 s37, s36, 43515904
    s_add_u32 s46, s36, 45875200
    s_lshl_b32 s36, s45, 7
    s_add_u32 s36, s36, s43
    s_add_u32 s36, s36, 48431104
    s_lshl_b32 s47, s45, 9
    s_add_u32 s47, s47, s43
    s_add_u32 s47, s47, 48234496
    v_bfe_u32 v10, v0, 3, 2
    v_and_b32 v8, 7, v0
    v_mfma_f32_16x16x32_bf16 v[84:87], a[52:55], v[48:51], v[84:87]
    s_add_u32 m0, s29, 30720
    s_add_u32 s7, s23, 3072
    buffer_load_dwordx4 v2, s[8:11], s7 offen sc1 lds
    v_mfma_f32_16x16x32_bf16 v[88:91], a[52:55], v[52:55], v[88:91]
    v_lshlrev_b32 v8, 2, v8
    v_lshl_add_u32 v8, v10, 7, v8
    v_mfma_f32_16x16x32_bf16 v[92:95], v[36:39], a[56:59], v[92:95]
    buffer_load_dwordx4 a[20:23], v253, s[8:11], s28 offen offset:1024 sc1
    v_mfma_f32_16x16x32_bf16 v[96:99], v[40:43], a[56:59], v[96:99]
    v_mfma_f32_16x16x32_bf16 v[100:103], v[44:47], a[56:59], v[100:103]
    buffer_load_dwordx4 a[24:27], v253, s[8:11], s28 offen offset:2048 sc1
    v_mfma_f32_16x16x32_bf16 v[104:107], v[48:51], a[56:59], v[104:107]
    v_mfma_f32_16x16x32_bf16 v[108:111], v[52:55], a[56:59], v[108:111]
    buffer_load_dwordx4 a[28:31], v229, s[8:11], s28 offen offset:3072 sc1
    s_add_u32 s28, s28, 4096
    v_mfma_f32_16x16x32_bf16 v[112:115], a[60:63], v[36:39], v[112:115]
    v_mfma_f32_16x16x32_bf16 v[116:119], a[60:63], v[40:43], v[116:119]
    v_mfma_f32_16x16x32_bf16 v[120:123], a[60:63], v[44:47], v[120:123]
    v_mfma_f32_16x16x32_bf16 v[124:127], a[60:63], v[48:51], v[124:127]
    v_mfma_f32_16x16x32_bf16 v[128:131], a[60:63], v[52:55], v[128:131]
    s_waitcnt lgkmcnt(0)
    v_mfma_f32_16x16x32_bf16 v[56:59], a[64:67], v[20:23], v[56:59]
    ds_read_b128 v[36:39], v253 offset:25600
    v_mfma_f32_16x16x32_bf16 v[60:63], a[64:67], v[24:27], v[60:63]
    ds_read_b128 v[40:43], v253 offset:26624
    v_mfma_f32_16x16x32_bf16 v[64:67], a[64:67], v[28:31], v[64:67]
    ds_read_b128 v[44:47], v253 offset:27648
    v_mfma_f32_16x16x32_bf16 v[68:71], a[64:67], v[32:35], v[68:71]
    ds_read_b128 v[48:51], v253 offset:28672
    v_mfma_f32_16x16x32_bf16 v[72:75], a[68:71], v[16:19], v[72:75]
    ds_read_b128 v[52:55], v253 offset:29696
    v_mfma_f32_16x16x32_bf16 v[76:79], a[68:71], v[20:23], v[76:79]
    buffer_load_dwordx4 a[32:35], v253, s[8:11], s28 offen offset:0 sc1
    v_mfma_f32_16x16x32_bf16 v[80:83], a[68:71], v[24:27], v[80:83]
    v_mfma_f32_16x16x32_bf16 v[84:87], a[68:71], v[28:31], v[84:87]
    buffer_load_dwordx4 a[36:39], v253, s[8:11], s28 offen offset:1024 sc1
    v_mfma_f32_16x16x32_bf16 v[88:91], a[68:71], v[32:35], v[88:91]
    v_mfma_f32_16x16x32_bf16 v[92:95], v[16:19], a[72:75], v[92:95]
    buffer_load_dwordx4 a[40:43], v253, s[8:11], s28 offen offset:2048 sc1
    v_mfma_f32_16x16x32_bf16 v[96:99], v[20:23], a[72:75], v[96:99]
    v_mfma_f32_16x16x32_bf16 v[100:103], v[24:27], a[72:75], v[100:103]
    v_mfma_f32_16x16x32_bf16 v[104:107], v[28:31], a[72:75], v[104:107]
    v_mfma_f32_16x16x32_bf16 v[108:111], v[32:35], a[72:75], v[108:111]
    v_mfma_f32_16x16x32_bf16 v[112:115], a[76:79], v[16:19], v[112:115]
    v_mfma_f32_16x16x32_bf16 v[116:119], a[76:79], v[20:23], v[116:119]
    v_mfma_f32_16x16x32_bf16 v[120:123], a[76:79], v[24:27], v[120:123]
    v_mfma_f32_16x16x32_bf16 v[124:127], a[76:79], v[28:31], v[124:127]
    v_mfma_f32_16x16x32_bf16 v[128:131], a[76:79], v[32:35], v[128:131]
    s_waitcnt vmcnt(6) lgkmcnt(0)
    s_barrier
    v_mfma_f32_16x16x32_bf16 v[56:59], a[80:83], v[40:43], v[56:59]
    ds_read_b128 v[16:19], v253 offset:30720
    v_mfma_f32_16x16x32_bf16 v[60:63], a[80:83], v[44:47], v[60:63]
    ds_read_b128 v[20:23], v253 offset:31744
    v_mfma_f32_16x16x32_bf16 v[64:67], a[80:83], v[48:51], v[64:67]
    ds_read_b128 v[24:27], v253 offset:32768
    v_mfma_f32_16x16x32_bf16 v[68:71], a[80:83], v[52:55], v[68:71]
    ds_read_b128 v[28:31], v253 offset:33792
    v_mfma_f32_16x16x32_bf16 v[72:75], a[84:87], v[36:39], v[72:75]
    ds_read_b128 v[32:35], v253 offset:34816
    v_mfma_f32_16x16x32_bf16 v[76:79], a[84:87], v[40:43], v[76:79]
    s_add_u32 m0, s25, 59392
    s_nop 0
    buffer_load_dwordx4 v2, s[8:11], s24 offen offset:2048 sc1 lds
    v_mfma_f32_16x16x32_bf16 v[80:83], a[84:87], v[44:47], v[80:83]
    v_mfma_f32_16x16x32_bf16 v[84:87], a[84:87], v[48:51], v[84:87]
    s_add_u32 m0, s25, 64000
    s_nop 0
    buffer_load_dwordx4 v2, s[8:11], s24 offen offset:2560 sc1 lds
    v_mfma_f32_16x16x32_bf16 v[88:91], a[84:87], v[52:55], v[88:91]
    v_mfma_f32_16x16x32_bf16 v[92:95], v[36:39], a[88:91], v[92:95]
    buffer_load_dwordx4 a[44:47], v229, s[8:11], s28 offen offset:3072 sc1
    s_add_u32 s28, s28, 4096
    v_mfma_f32_16x16x32_bf16 v[96:99], v[40:43], a[88:91], v[96:99]
    v_mfma_f32_16x16x32_bf16 v[100:103], v[44:47], a[88:91], v[100:103]
    buffer_load_dwordx4 a[48:51], v253, s[8:11], s28 offen offset:0 sc1
    v_mfma_f32_16x16x32_bf16 v[104:107], v[48:51], a[88:91], v[104:107]
    v_mfma_f32_16x16x32_bf16 v[108:111], v[52:55], a[88:91], v[108:111]
    buffer_load_dwordx4 a[52:55], v253, s[8:11], s28 offen offset:1024 sc1
    v_mfma_f32_16x16x32_bf16 v[112:115], a[92:95], v[36:39], v[112:115]
    v_mfma_f32_16x16x32_bf16 v[116:119], a[92:95], v[40:43], v[116:119]
    v_mfma_f32_16x16x32_bf16 v[120:123], a[92:95], v[44:47], v[120:123]
    v_mfma_f32_16x16x32_bf16 v[124:127], a[92:95], v[48:51], v[124:127]
    v_mfma_f32_16x16x32_bf16 v[128:131], a[92:95], v[52:55], v[128:131]
    s_waitcnt lgkmcnt(0)
    v_mfma_f32_16x16x32_bf16 v[56:59], a[96:99], v[20:23], v[56:59]
    ds_read_b128 v[36:39], v253 offset:35840
    v_mfma_f32_16x16x32_bf16 v[60:63], a[96:99], v[24:27], v[60:63]
    ds_read_b128 v[40:43], v253 offset:36864
    v_mfma_f32_16x16x32_bf16 v[64:67], a[96:99], v[28:31], v[64:67]
    ds_read_b128 v[44:47], v253 offset:37888
    v_mfma_f32_16x16x32_bf16 v[68:71], a[96:99], v[32:35], v[68:71]
    ds_read_b128 v[48:51], v253 offset:38912
    v_mfma_f32_16x16x32_bf16 v[72:75], a[100:103], v[16:19], v[72:75]
    ds_read_b128 v[52:55], v253 offset:39936
    v_mfma_f32_16x16x32_bf16 v[76:79], a[100:103], v[20:23], v[76:79]
    s_add_u32 m0, s25, 68608
    s_nop 0
    buffer_load_dwordx4 v2, s[8:11], s24 offen offset:3072 sc1 lds
    v_mfma_f32_16x16x32_bf16 v[80:83], a[100:103], v[24:27], v[80:83]
    v_mfma_f32_16x16x32_bf16 v[84:87], a[100:103], v[28:31], v[84:87]
    s_add_u32 m0, s25, 73216
    s_nop 0
    buffer_load_dwordx4 v2, s[8:11], s24 offen offset:3584 sc1 lds
    v_mfma_f32_16x16x32_bf16 v[88:91], a[100:103], v[32:35], v[88:91]
    v_mfma_f32_16x16x32_bf16 v[92:95], v[16:19], a[104:107], v[92:95]
    buffer_load_dwordx4 a[56:59], v253, s[8:11], s28 offen offset:2048 sc1
    v_mfma_f32_16x16x32_bf16 v[96:99], v[20:23], a[104:107], v[96:99]
    v_mfma_f32_16x16x32_bf16 v[100:103], v[24:27], a[104:107], v[100:103]
    buffer_load_dwordx4 a[60:63], v229, s[8:11], s28 offen offset:3072 sc1
    s_add_u32 s28, s28, 4096
    v_mfma_f32_16x16x32_bf16 v[104:107], v[28:31], a[104:107], v[104:107]
    v_mfma_f32_16x16x32_bf16 v[108:111], v[32:35], a[104:107], v[108:111]
    buffer_load_dwordx4 a[64:67], v253, s[8:11], s28 offen offset:0 sc1
    v_mfma_f32_16x16x32_bf16 v[112:115], a[108:111], v[16:19], v[112:115]
    v_mfma_f32_16x16x32_bf16 v[116:119], a[108:111], v[20:23], v[116:119]
    buffer_load_dwordx2 v[226:227], v228, s[8:11], s39 offen sc1
    v_mfma_f32_16x16x32_bf16 v[120:123], a[108:111], v[24:27], v[120:123]
    v_mfma_f32_16x16x32_bf16 v[124:127], a[108:111], v[28:31], v[124:127]
    v_mfma_f32_16x16x32_bf16 v[128:131], a[108:111], v[32:35], v[128:131]
    s_waitcnt lgkmcnt(0)
    v_mfma_f32_16x16x32_bf16 v[56:59], a[112:115], v[40:43], v[56:59]
    ds_read_b128 v[16:19], v253 offset:40960
    v_mfma_f32_16x16x32_bf16 v[60:63], a[112:115], v[44:47], v[60:63]
    ds_read_b128 v[20:23], v253 offset:41984
    v_mfma_f32_16x16x32_bf16 v[64:67], a[112:115], v[48:51], v[64:67]
    ds_read_b128 v[24:27], v253 offset:43008
    v_mfma_f32_16x16x32_bf16 v[68:71], a[112:115], v[52:55], v[68:71]
    ds_read_b128 v[28:31], v253 offset:44032
    v_mfma_f32_16x16x32_bf16 v[72:75], a[116:119], v[36:39], v[72:75]
    ds_read_b128 v[32:35], v253 offset:45056
    v_mfma_f32_16x16x32_bf16 v[76:79], a[116:119], v[40:43], v[76:79]
    s_add_u32 m0, s25, 81920
    s_add_u32 s24, s24, 4096
    buffer_load_dwordx4 v2, s[8:11], s24 offen offset:0 sc1 lds
    v_mfma_f32_16x16x32_bf16 v[80:83], a[116:119], v[44:47], v[80:83]
    v_mfma_f32_16x16x32_bf16 v[84:87], a[116:119], v[48:51], v[84:87]
    s_add_u32 m0, s25, 86528
    s_nop 0
    buffer_load_dwordx4 v2, s[8:11], s24 offen offset:512 sc1 lds
    v_mfma_f32_16x16x32_bf16 v[88:91], a[116:119], v[52:55], v[88:91]
    v_mfma_f32_16x16x32_bf16 v[92:95], v[36:39], a[120:123], v[92:95]
    buffer_load_dwordx4 a[68:71], v253, s[8:11], s28 offen offset:1024 sc1
    v_mfma_f32_16x16x32_bf16 v[96:99], v[40:43], a[120:123], v[96:99]
    v_mfma_f32_16x16x32_bf16 v[100:103], v[44:47], a[120:123], v[100:103]
    buffer_load_dwordx4 a[72:75], v253, s[8:11], s28 offen offset:2048 sc1
    v_mfma_f32_16x16x32_bf16 v[104:107], v[48:51], a[120:123], v[104:107]
    v_mfma_f32_16x16x32_bf16 v[108:111], v[52:55], a[120:123], v[108:111]
    buffer_load_dwordx4 a[76:79], v229, s[8:11], s28 offen offset:3072 sc1
    s_add_u32 s28, s28, 4096
    v_mfma_f32_16x16x32_bf16 v[112:115], a[124:127], v[36:39], v[112:115]
    v_mfma_f32_16x16x32_bf16 v[116:119], a[124:127], v[40:43], v[116:119]
    v_mfma_f32_16x16x32_bf16 v[120:123], a[124:127], v[44:47], v[120:123]
    v_mfma_f32_16x16x32_bf16 v[124:127], a[124:127], v[48:51], v[124:127]
    v_mfma_f32_16x16x32_bf16 v[128:131], a[124:127], v[52:55], v[128:131]
    s_waitcnt lgkmcnt(0)
    v_mfma_f32_16x16x32_bf16 v[56:59], a[128:131], v[20:23], v[56:59]
    ds_read_b128 v[36:39], v6 offset:0
    v_mfma_f32_16x16x32_bf16 v[60:63], a[128:131], v[24:27], v[60:63]
    ds_read_b128 v[40:43], v6 offset:1024
    v_mfma_f32_16x16x32_bf16 v[64:67], a[128:131], v[28:31], v[64:67]
    ds_read_b128 v[44:47], v6 offset:2048
    v_mfma_f32_16x16x32_bf16 v[68:71], a[128:131], v[32:35], v[68:71]
    ds_read_b128 v[48:51], v6 offset:3072
    v_mfma_f32_16x16x32_bf16 v[72:75], a[132:135], v[16:19], v[72:75]
    ds_read_b128 v[52:55], v6 offset:4096
    v_mfma_f32_16x16x32_bf16 v[76:79], a[132:135], v[20:23], v[76:79]
    s_add_u32 m0, s26, 61440
    s_add_u32 s7, s27, 6144
    buffer_load_dwordx4 v2, s[8:11], s7 offen sc1 lds
    v_mfma_f32_16x16x32_bf16 v[80:83], a[132:135], v[24:27], v[80:83]
    v_mfma_f32_16x16x32_bf16 v[84:87], a[132:135], v[28:31], v[84:87]
    s_add_u32 m0, s29, 61440
    s_add_u32 s7, s23, 6144
    buffer_load_dwordx4 v2, s[8:11], s7 offen sc1 lds
    v_mfma_f32_16x16x32_bf16 v[88:91], a[132:135], v[32:35], v[88:91]
    v_mfma_f32_16x16x32_bf16 v[92:95], v[16:19], a[136:139], v[92:95]
    buffer_load_dwordx4 a[80:83], v253, s[8:11], s28 offen offset:0 sc1
    v_mfma_f32_16x16x32_bf16 v[96:99], v[20:23], a[136:139], v[96:99]
    v_mfma_f32_16x16x32_bf16 v[100:103], v[24:27], a[136:139], v[100:103]
    buffer_load_dwordx4 a[84:87], v253, s[8:11], s28 offen offset:1024 sc1
    v_mfma_f32_16x16x32_bf16 v[104:107], v[28:31], a[136:139], v[104:107]
    v_mfma_f32_16x16x32_bf16 v[108:111], v[32:35], a[136:139], v[108:111]
    buffer_load_dwordx4 a[88:91], v253, s[8:11], s28 offen offset:2048 sc1
    v_mfma_f32_16x16x32_bf16 v[112:115], a[140:143], v[16:19], v[112:115]
    v_mfma_f32_16x16x32_bf16 v[116:119], a[140:143], v[20:23], v[116:119]
    v_mfma_f32_16x16x32_bf16 v[120:123], a[140:143], v[24:27], v[120:123]
    v_mfma_f32_16x16x32_bf16 v[124:127], a[140:143], v[28:31], v[124:127]
    v_mfma_f32_16x16x32_bf16 v[128:131], a[140:143], v[32:35], v[128:131]
    s_waitcnt vmcnt(10) lgkmcnt(0)
    s_mov_b32 s6, 0
L_wo_poll_15:
    v_cmp_eq_u32 vcc, s76, v226
    v_cmp_eq_u32 s[20:21], s76, v227
    s_and_b64 vcc, vcc, s[20:21]
    s_cmp_eq_u64 vcc, exec
    s_cbranch_scc1 L_wo_ready_16
    buffer_load_dwordx2 v[226:227], v228, s[8:11], s39 offen sc1
    s_add_u32 s6, s6, 1
    s_cmp_lt_u32 s6, 1048576
    s_waitcnt vmcnt(0)
    s_cbranch_scc1 L_wo_poll_15
    s_branch L_main_end
L_wo_ready_16:
    v_mfma_f32_16x16x32_bf16 v[56:59], a[144:147], v[40:43], v[56:59]
    ds_read_b128 v[16:19], v6 offset:5120
    v_mfma_f32_16x16x32_bf16 v[60:63], a[144:147], v[44:47], v[60:63]
    ds_read_b128 v[20:23], v6 offset:6144
    v_mfma_f32_16x16x32_bf16 v[64:67], a[144:147], v[48:51], v[64:67]
    ds_read_b128 v[24:27], v6 offset:7168
    v_mfma_f32_16x16x32_bf16 v[68:71], a[144:147], v[52:55], v[68:71]
    ds_read_b128 v[28:31], v6 offset:8192
    v_mfma_f32_16x16x32_bf16 v[72:75], a[148:151], v[36:39], v[72:75]
    ds_read_b128 v[32:35], v6 offset:9216
    v_mfma_f32_16x16x32_bf16 v[76:79], a[148:151], v[40:43], v[76:79]
    buffer_load_dwordx4 a[92:95], v229, s[8:11], s28 offen offset:3072 sc1
    s_add_u32 s28, s28, 4096
    v_mfma_f32_16x16x32_bf16 v[80:83], a[148:151], v[44:47], v[80:83]
    v_mfma_f32_16x16x32_bf16 v[84:87], a[148:151], v[48:51], v[84:87]
    buffer_load_dwordx4 a[96:99], v253, s[8:11], s28 offen offset:0 sc1
    v_mfma_f32_16x16x32_bf16 v[88:91], a[148:151], v[52:55], v[88:91]
    v_mfma_f32_16x16x32_bf16 v[92:95], v[36:39], a[152:155], v[92:95]
    buffer_load_dwordx4 a[100:103], v253, s[8:11], s28 offen offset:1024 sc1
    v_mfma_f32_16x16x32_bf16 v[96:99], v[40:43], a[152:155], v[96:99]
    v_mfma_f32_16x16x32_bf16 v[100:103], v[44:47], a[152:155], v[100:103]
    buffer_load_dwordx4 a[160:163], v253, s[8:11], s32 offen offset:0 sc1
    v_mfma_f32_16x16x32_bf16 v[104:107], v[48:51], a[152:155], v[104:107]
    v_mfma_f32_16x16x32_bf16 v[108:111], v[52:55], a[152:155], v[108:111]
    v_mfma_f32_16x16x32_bf16 v[112:115], a[156:159], v[36:39], v[112:115]
    v_mfma_f32_16x16x32_bf16 v[116:119], a[156:159], v[40:43], v[116:119]
    v_mfma_f32_16x16x32_bf16 v[120:123], a[156:159], v[44:47], v[120:123]
    v_mfma_f32_16x16x32_bf16 v[124:127], a[156:159], v[48:51], v[124:127]
    v_mfma_f32_16x16x32_bf16 v[128:131], a[156:159], v[52:55], v[128:131]
    s_waitcnt vmcnt(34) lgkmcnt(0)
    v_mfma_f32_16x16x32_bf16 v[56:59], a[0:3], v[20:23], v[56:59]
    ds_read_b128 v[36:39], v6 offset:10240
    v_mfma_f32_16x16x32_bf16 v[60:63], a[0:3], v[24:27], v[60:63]
    ds_read_b128 v[40:43], v6 offset:11264
    v_mfma_f32_16x16x32_bf16 v[64:67], a[0:3], v[28:31], v[64:67]
    ds_read_b128 v[44:47], v6 offset:12288
    v_mfma_f32_16x16x32_bf16 v[68:71], a[0:3], v[32:35], v[68:71]
    ds_read_b128 v[48:51], v6 offset:13312
    v_mfma_f32_16x16x32_bf16 v[72:75], a[4:7], v[16:19], v[72:75]
    ds_read_b128 v[52:55], v6 offset:14336
    v_mfma_f32_16x16x32_bf16 v[76:79], a[4:7], v[20:23], v[76:79]
    buffer_load_dwordx4 a[104:107], v253, s[8:11], s28 offen offset:2048 sc1
    v_mfma_f32_16x16x32_bf16 v[80:83], a[4:7], v[24:27], v[80:83]
    v_mfma_f32_16x16x32_bf16 v[84:87], a[4:7], v[28:31], v[84:87]
    buffer_load_dwordx4 a[108:111], v229, s[8:11], s28 offen offset:3072 sc1
    s_add_u32 s28, s28, 4096
    v_mfma_f32_16x16x32_bf16 v[88:91], a[4:7], v[32:35], v[88:91]
    v_mfma_f32_16x16x32_bf16 v[92:95], v[16:19], a[8:11], v[92:95]
    buffer_load_dwordx4 a[112:115], v253, s[8:11], s28 offen offset:0 sc1
    v_mfma_f32_16x16x32_bf16 v[96:99], v[20:23], a[8:11], v[96:99]
    v_mfma_f32_16x16x32_bf16 v[100:103], v[24:27], a[8:11], v[100:103]
    buffer_load_dwordx4 a[164:167], v253, s[8:11], s33 offen offset:0 sc1
    v_mfma_f32_16x16x32_bf16 v[104:107], v[28:31], a[8:11], v[104:107]
    v_mfma_f32_16x16x32_bf16 v[108:111], v[32:35], a[8:11], v[108:111]
    v_mfma_f32_16x16x32_bf16 v[112:115], a[12:15], v[16:19], v[112:115]
    v_mfma_f32_16x16x32_bf16 v[116:119], a[12:15], v[20:23], v[116:119]
    v_mfma_f32_16x16x32_bf16 v[120:123], a[12:15], v[24:27], v[120:123]
    v_mfma_f32_16x16x32_bf16 v[124:127], a[12:15], v[28:31], v[124:127]
    v_mfma_f32_16x16x32_bf16 v[128:131], a[12:15], v[32:35], v[128:131]
    s_waitcnt vmcnt(11) lgkmcnt(0)
    s_barrier
    v_mfma_f32_16x16x32_bf16 v[56:59], a[16:19], v[40:43], v[56:59]
    ds_read_b128 v[16:19], v6 offset:15360
    v_mfma_f32_16x16x32_bf16 v[60:63], a[16:19], v[44:47], v[60:63]
    ds_read_b128 v[20:23], v6 offset:16384
    v_mfma_f32_16x16x32_bf16 v[64:67], a[16:19], v[48:51], v[64:67]
    ds_read_b128 v[24:27], v6 offset:17408
    v_mfma_f32_16x16x32_bf16 v[68:71], a[16:19], v[52:55], v[68:71]
    ds_read_b128 v[28:31], v6 offset:18432
    v_mfma_f32_16x16x32_bf16 v[72:75], a[20:23], v[36:39], v[72:75]
    ds_read_b128 v[32:35], v6 offset:19456
    v_mfma_f32_16x16x32_bf16 v[76:79], a[20:23], v[40:43], v[76:79]
    buffer_load_dwordx4 a[116:119], v253, s[8:11], s28 offen offset:1024 sc1
    v_mfma_f32_16x16x32_bf16 v[80:83], a[20:23], v[44:47], v[80:83]
    v_mfma_f32_16x16x32_bf16 v[84:87], a[20:23], v[48:51], v[84:87]
    buffer_load_dwordx4 a[120:123], v253, s[8:11], s28 offen offset:2048 sc1
    v_mfma_f32_16x16x32_bf16 v[88:91], a[20:23], v[52:55], v[88:91]
    v_mfma_f32_16x16x32_bf16 v[92:95], v[36:39], a[24:27], v[92:95]
    buffer_load_dwordx4 a[124:127], v229, s[8:11], s28 offen offset:3072 sc1
    s_add_u32 s28, s28, 4096
    v_mfma_f32_16x16x32_bf16 v[96:99], v[40:43], a[24:27], v[96:99]
    v_mfma_f32_16x16x32_bf16 v[100:103], v[44:47], a[24:27], v[100:103]
    buffer_load_dwordx4 a[168:171], v5, s[8:11], s34 offen offset:0 sc1
    v_mfma_f32_16x16x32_bf16 v[104:107], v[48:51], a[24:27], v[104:107]
    v_mfma_f32_16x16x32_bf16 v[108:111], v[52:55], a[24:27], v[108:111]
    v_mfma_f32_16x16x32_bf16 v[112:115], a[28:31], v[36:39], v[112:115]
    v_mfma_f32_16x16x32_bf16 v[116:119], a[28:31], v[40:43], v[116:119]
    v_mfma_f32_16x16x32_bf16 v[120:123], a[28:31], v[44:47], v[120:123]
    v_mfma_f32_16x16x32_bf16 v[124:127], a[28:31], v[48:51], v[124:127]
    v_mfma_f32_16x16x32_bf16 v[128:131], a[28:31], v[52:55], v[128:131]
    s_waitcnt vmcnt(30) lgkmcnt(0)
    v_mfma_f32_16x16x32_bf16 v[56:59], a[32:35], v[20:23], v[56:59]
    ds_read_b128 v[36:39], v6 offset:20480
    v_mfma_f32_16x16x32_bf16 v[60:63], a[32:35], v[24:27], v[60:63]
    ds_read_b128 v[40:43], v6 offset:21504
    v_mfma_f32_16x16x32_bf16 v[64:67], a[32:35], v[28:31], v[64:67]
    ds_read_b128 v[44:47], v6 offset:22528
    v_mfma_f32_16x16x32_bf16 v[68:71], a[32:35], v[32:35], v[68:71]
    ds_read_b128 v[48:51], v6 offset:23552
    v_mfma_f32_16x16x32_bf16 v[72:75], a[36:39], v[16:19], v[72:75]
    ds_read_b128 v[52:55], v6 offset:24576
    v_mfma_f32_16x16x32_bf16 v[76:79], a[36:39], v[20:23], v[76:79]
    buffer_load_dwordx4 a[172:175], v253, s[8:11], s32 offen offset:1024 sc1
    v_mfma_f32_16x16x32_bf16 v[80:83], a[36:39], v[24:27], v[80:83]
    v_mfma_f32_16x16x32_bf16 v[84:87], a[36:39], v[28:31], v[84:87]
    buffer_load_dwordx4 a[176:179], v253, s[8:11], s33 offen offset:1024 sc1
    v_mfma_f32_16x16x32_bf16 v[88:91], a[36:39], v[32:35], v[88:91]
    v_mfma_f32_16x16x32_bf16 v[92:95], v[16:19], a[40:43], v[92:95]
    buffer_load_dwordx4 a[180:183], v5, s[8:11], s34 offen offset:1024 sc1
    v_mfma_f32_16x16x32_bf16 v[96:99], v[20:23], a[40:43], v[96:99]
    v_mfma_f32_16x16x32_bf16 v[100:103], v[24:27], a[40:43], v[100:103]
    buffer_load_dwordx4 a[184:187], v253, s[8:11], s32 offen offset:2048 sc1
    v_mfma_f32_16x16x32_bf16 v[104:107], v[28:31], a[40:43], v[104:107]
    v_mfma_f32_16x16x32_bf16 v[108:111], v[32:35], a[40:43], v[108:111]
    v_mfma_f32_16x16x32_bf16 v[112:115], a[44:47], v[16:19], v[112:115]
    v_mfma_f32_16x16x32_bf16 v[116:119], a[44:47], v[20:23], v[116:119]
    v_mfma_f32_16x16x32_bf16 v[120:123], a[44:47], v[24:27], v[120:123]
    v_mfma_f32_16x16x32_bf16 v[124:127], a[44:47], v[28:31], v[124:127]
    v_mfma_f32_16x16x32_bf16 v[128:131], a[44:47], v[32:35], v[128:131]
    s_waitcnt vmcnt(28) lgkmcnt(0)
    v_mfma_f32_16x16x32_bf16 v[56:59], a[48:51], v[40:43], v[56:59]
    ds_read_b128 v[16:19], v6 offset:25600
    v_mfma_f32_16x16x32_bf16 v[60:63], a[48:51], v[44:47], v[60:63]
    ds_read_b128 v[20:23], v6 offset:26624
    v_mfma_f32_16x16x32_bf16 v[64:67], a[48:51], v[48:51], v[64:67]
    ds_read_b128 v[24:27], v6 offset:27648
    v_mfma_f32_16x16x32_bf16 v[68:71], a[48:51], v[52:55], v[68:71]
    ds_read_b128 v[28:31], v6 offset:28672
    v_mfma_f32_16x16x32_bf16 v[72:75], a[52:55], v[36:39], v[72:75]
    ds_read_b128 v[32:35], v6 offset:29696
    v_mfma_f32_16x16x32_bf16 v[76:79], a[52:55], v[40:43], v[76:79]
    buffer_load_dwordx4 a[188:191], v253, s[8:11], s33 offen offset:2048 sc1
    v_mfma_f32_16x16x32_bf16 v[80:83], a[52:55], v[44:47], v[80:83]
    v_mfma_f32_16x16x32_bf16 v[84:87], a[52:55], v[48:51], v[84:87]
    buffer_load_dwordx4 a[192:195], v5, s[8:11], s34 offen offset:2048 sc1
    v_mfma_f32_16x16x32_bf16 v[88:91], a[52:55], v[52:55], v[88:91]
    v_mfma_f32_16x16x32_bf16 v[92:95], v[36:39], a[56:59], v[92:95]
    buffer_load_dwordx4 a[196:199], v253, s[8:11], s32 offen offset:3072 sc1
    s_add_u32 s32, s32, 4096
    v_mfma_f32_16x16x32_bf16 v[96:99], v[40:43], a[56:59], v[96:99]
    v_mfma_f32_16x16x32_bf16 v[100:103], v[44:47], a[56:59], v[100:103]
    buffer_load_dwordx4 a[200:203], v253, s[8:11], s33 offen offset:3072 sc1
    s_add_u32 s33, s33, 4096
    v_mfma_f32_16x16x32_bf16 v[104:107], v[48:51], a[56:59], v[104:107]
    v_mfma_f32_16x16x32_bf16 v[108:111], v[52:55], a[56:59], v[108:111]
    v_mfma_f32_16x16x32_bf16 v[112:115], a[60:63], v[36:39], v[112:115]
    v_mfma_f32_16x16x32_bf16 v[116:119], a[60:63], v[40:43], v[116:119]
    v_mfma_f32_16x16x32_bf16 v[120:123], a[60:63], v[44:47], v[120:123]
    v_mfma_f32_16x16x32_bf16 v[124:127], a[60:63], v[48:51], v[124:127]
    v_mfma_f32_16x16x32_bf16 v[128:131], a[60:63], v[52:55], v[128:131]
    s_waitcnt vmcnt(25) lgkmcnt(0)
    v_mfma_f32_16x16x32_bf16 v[56:59], a[64:67], v[20:23], v[56:59]
    ds_read_b128 v[36:39], v6 offset:30720
    v_mfma_f32_16x16x32_bf16 v[60:63], a[64:67], v[24:27], v[60:63]
    ds_read_b128 v[40:43], v6 offset:31744
    v_mfma_f32_16x16x32_bf16 v[64:67], a[64:67], v[28:31], v[64:67]
    ds_read_b128 v[44:47], v6 offset:32768
    v_mfma_f32_16x16x32_bf16 v[68:71], a[64:67], v[32:35], v[68:71]
    ds_read_b128 v[48:51], v6 offset:33792
    v_mfma_f32_16x16x32_bf16 v[72:75], a[68:71], v[16:19], v[72:75]
    ds_read_b128 v[52:55], v6 offset:34816
    v_mfma_f32_16x16x32_bf16 v[76:79], a[68:71], v[20:23], v[76:79]
    buffer_load_dwordx4 a[204:207], v5, s[8:11], s34 offen offset:3072 sc1
    s_add_u32 s34, s34, 4096
    v_mfma_f32_16x16x32_bf16 v[80:83], a[68:71], v[24:27], v[80:83]
    v_mfma_f32_16x16x32_bf16 v[84:87], a[68:71], v[28:31], v[84:87]
    buffer_load_dwordx4 a[208:211], v253, s[8:11], s32 offen offset:0 sc1
    v_mfma_f32_16x16x32_bf16 v[88:91], a[68:71], v[32:35], v[88:91]
    v_mfma_f32_16x16x32_bf16 v[92:95], v[16:19], a[72:75], v[92:95]
    buffer_load_dwordx4 a[212:215], v253, s[8:11], s33 offen offset:0 sc1
    v_mfma_f32_16x16x32_bf16 v[96:99], v[20:23], a[72:75], v[96:99]
    v_mfma_f32_16x16x32_bf16 v[100:103], v[24:27], a[72:75], v[100:103]
    buffer_load_dwordx4 a[216:219], v5, s[8:11], s34 offen offset:0 sc1
    v_mfma_f32_16x16x32_bf16 v[104:107], v[28:31], a[72:75], v[104:107]
    v_mfma_f32_16x16x32_bf16 v[108:111], v[32:35], a[72:75], v[108:111]
    v_mfma_f32_16x16x32_bf16 v[112:115], a[76:79], v[16:19], v[112:115]
    v_mfma_f32_16x16x32_bf16 v[116:119], a[76:79], v[20:23], v[116:119]
    v_mfma_f32_16x16x32_bf16 v[120:123], a[76:79], v[24:27], v[120:123]
    v_mfma_f32_16x16x32_bf16 v[124:127], a[76:79], v[28:31], v[124:127]
    v_mfma_f32_16x16x32_bf16 v[128:131], a[76:79], v[32:35], v[128:131]
    s_waitcnt vmcnt(23) lgkmcnt(0)
    v_mfma_f32_16x16x32_bf16 v[56:59], a[80:83], v[40:43], v[56:59]
    ds_read_b128 v[16:19], v6 offset:35840
    v_mfma_f32_16x16x32_bf16 v[60:63], a[80:83], v[44:47], v[60:63]
    ds_read_b128 v[20:23], v6 offset:36864
    v_mfma_f32_16x16x32_bf16 v[64:67], a[80:83], v[48:51], v[64:67]
    ds_read_b128 v[24:27], v6 offset:37888
    v_mfma_f32_16x16x32_bf16 v[68:71], a[80:83], v[52:55], v[68:71]
    ds_read_b128 v[28:31], v6 offset:38912
    v_mfma_f32_16x16x32_bf16 v[72:75], a[84:87], v[36:39], v[72:75]
    ds_read_b128 v[32:35], v6 offset:39936
    v_mfma_f32_16x16x32_bf16 v[76:79], a[84:87], v[40:43], v[76:79]
    buffer_load_dwordx4 a[220:223], v253, s[8:11], s32 offen offset:1024 sc1
    v_mfma_f32_16x16x32_bf16 v[80:83], a[84:87], v[44:47], v[80:83]
    v_mfma_f32_16x16x32_bf16 v[84:87], a[84:87], v[48:51], v[84:87]
    buffer_load_dwordx4 a[224:227], v253, s[8:11], s33 offen offset:1024 sc1
    v_mfma_f32_16x16x32_bf16 v[88:91], a[84:87], v[52:55], v[88:91]
    v_mfma_f32_16x16x32_bf16 v[92:95], v[36:39], a[88:91], v[92:95]
    buffer_load_dwordx4 a[228:231], v5, s[8:11], s34 offen offset:1024 sc1
    v_mfma_f32_16x16x32_bf16 v[96:99], v[40:43], a[88:91], v[96:99]
    v_mfma_f32_16x16x32_bf16 v[100:103], v[44:47], a[88:91], v[100:103]
    buffer_load_dwordx4 a[232:235], v253, s[8:11], s32 offen offset:2048 sc1
    v_mfma_f32_16x16x32_bf16 v[104:107], v[48:51], a[88:91], v[104:107]
    v_mfma_f32_16x16x32_bf16 v[108:111], v[52:55], a[88:91], v[108:111]
    v_mfma_f32_16x16x32_bf16 v[112:115], a[92:95], v[36:39], v[112:115]
    v_mfma_f32_16x16x32_bf16 v[116:119], a[92:95], v[40:43], v[116:119]
    v_mfma_f32_16x16x32_bf16 v[120:123], a[92:95], v[44:47], v[120:123]
    v_mfma_f32_16x16x32_bf16 v[124:127], a[92:95], v[48:51], v[124:127]
    v_mfma_f32_16x16x32_bf16 v[128:131], a[92:95], v[52:55], v[128:131]
    s_waitcnt vmcnt(22) lgkmcnt(0)
    v_mfma_f32_16x16x32_bf16 v[56:59], a[96:99], v[20:23], v[56:59]
    ds_read_b128 v[36:39], v6 offset:40960
    v_mfma_f32_16x16x32_bf16 v[60:63], a[96:99], v[24:27], v[60:63]
    ds_read_b128 v[40:43], v6 offset:41984
    v_mfma_f32_16x16x32_bf16 v[64:67], a[96:99], v[28:31], v[64:67]
    ds_read_b128 v[44:47], v6 offset:43008
    v_mfma_f32_16x16x32_bf16 v[68:71], a[96:99], v[32:35], v[68:71]
    ds_read_b128 v[48:51], v6 offset:44032
    v_mfma_f32_16x16x32_bf16 v[72:75], a[100:103], v[16:19], v[72:75]
    ds_read_b128 v[52:55], v6 offset:45056
    v_mfma_f32_16x16x32_bf16 v[76:79], a[100:103], v[20:23], v[76:79]
    buffer_load_dwordx4 a[236:239], v253, s[8:11], s33 offen offset:2048 sc1
    v_mfma_f32_16x16x32_bf16 v[80:83], a[100:103], v[24:27], v[80:83]
    v_mfma_f32_16x16x32_bf16 v[84:87], a[100:103], v[28:31], v[84:87]
    buffer_load_dwordx4 a[240:243], v5, s[8:11], s34 offen offset:2048 sc1
    v_mfma_f32_16x16x32_bf16 v[88:91], a[100:103], v[32:35], v[88:91]
    v_mfma_f32_16x16x32_bf16 v[92:95], v[16:19], a[104:107], v[92:95]
    buffer_load_dwordx4 a[244:247], v253, s[8:11], s32 offen offset:3072 sc1
    s_add_u32 s32, s32, 4096
    v_mfma_f32_16x16x32_bf16 v[96:99], v[20:23], a[104:107], v[96:99]
    v_mfma_f32_16x16x32_bf16 v[100:103], v[24:27], a[104:107], v[100:103]
    buffer_load_dwordx4 a[248:251], v253, s[8:11], s33 offen offset:3072 sc1
    s_add_u32 s33, s33, 4096
    v_mfma_f32_16x16x32_bf16 v[104:107], v[28:31], a[104:107], v[104:107]
    v_mfma_f32_16x16x32_bf16 v[108:111], v[32:35], a[104:107], v[108:111]
    v_mfma_f32_16x16x32_bf16 v[112:115], a[108:111], v[16:19], v[112:115]
    v_mfma_f32_16x16x32_bf16 v[116:119], a[108:111], v[20:23], v[116:119]
    v_mfma_f32_16x16x32_bf16 v[120:123], a[108:111], v[24:27], v[120:123]
    v_mfma_f32_16x16x32_bf16 v[124:127], a[108:111], v[28:31], v[124:127]
    v_mfma_f32_16x16x32_bf16 v[128:131], a[108:111], v[32:35], v[128:131]
    s_waitcnt vmcnt(21) lgkmcnt(0)
    v_mfma_f32_16x16x32_bf16 v[56:59], a[112:115], v[40:43], v[56:59]
    v_mfma_f32_16x16x32_bf16 v[60:63], a[112:115], v[44:47], v[60:63]
    v_mfma_f32_16x16x32_bf16 v[64:67], a[112:115], v[48:51], v[64:67]
    v_mfma_f32_16x16x32_bf16 v[68:71], a[112:115], v[52:55], v[68:71]
    v_mfma_f32_16x16x32_bf16 v[72:75], a[116:119], v[36:39], v[72:75]
    v_mfma_f32_16x16x32_bf16 v[76:79], a[116:119], v[40:43], v[76:79]
    buffer_load_dwordx4 a[252:255], v5, s[8:11], s34 offen offset:3072 sc1
    s_add_u32 s34, s34, 4096
    v_mfma_f32_16x16x32_bf16 v[80:83], a[116:119], v[44:47], v[80:83]
    v_mfma_f32_16x16x32_bf16 v[84:87], a[116:119], v[48:51], v[84:87]
    buffer_load_dwordx4 a[128:131], v253, s[8:11], s32 offen offset:0 sc1
    v_mfma_f32_16x16x32_bf16 v[88:91], a[116:119], v[52:55], v[88:91]
    v_mfma_f32_16x16x32_bf16 v[92:95], v[36:39], a[120:123], v[92:95]
    buffer_load_dwordx4 a[132:135], v253, s[8:11], s33 offen offset:0 sc1
    v_mfma_f32_16x16x32_bf16 v[96:99], v[40:43], a[120:123], v[96:99]
    v_mfma_f32_16x16x32_bf16 v[100:103], v[44:47], a[120:123], v[100:103]
    buffer_load_dwordx4 a[136:139], v5, s[8:11], s34 offen offset:0 sc1
    v_mfma_f32_16x16x32_bf16 v[104:107], v[48:51], a[120:123], v[104:107]
    v_mfma_f32_16x16x32_bf16 v[108:111], v[52:55], a[120:123], v[108:111]
    v_mfma_f32_16x16x32_bf16 v[112:115], a[124:127], v[36:39], v[112:115]
    v_mfma_f32_16x16x32_bf16 v[116:119], a[124:127], v[40:43], v[116:119]
    v_mfma_f32_16x16x32_bf16 v[120:123], a[124:127], v[44:47], v[120:123]
    v_mfma_f32_16x16x32_bf16 v[124:127], a[124:127], v[48:51], v[124:127]
    v_mfma_f32_16x16x32_bf16 v[128:131], a[124:127], v[52:55], v[128:131]
    v_cvt_pk_bf16_f32 v136, v56, v57
    v_cvt_pk_bf16_f32 v137, v58, v59
    v_cvt_pk_bf16_f32 v140, v60, v61
    v_cvt_pk_bf16_f32 v141, v62, v63
    v_cvt_pk_bf16_f32 v144, v64, v65
    v_cvt_pk_bf16_f32 v145, v66, v67
    v_cvt_pk_bf16_f32 v148, v68, v69
    v_cvt_pk_bf16_f32 v149, v70, v71
    v_cvt_pk_bf16_f32 v152, v72, v73
    buffer_load_dwordx4 a[140:143], v253, s[8:11], s32 offen offset:1024 sc1
    v_cvt_pk_bf16_f32 v153, v74, v75
    v_cvt_pk_bf16_f32 v156, v76, v77
    v_cvt_pk_bf16_f32 v157, v78, v79
    v_cvt_pk_bf16_f32 v160, v80, v81
    v_cvt_pk_bf16_f32 v161, v82, v83
    v_cvt_pk_bf16_f32 v164, v84, v85
    v_cvt_pk_bf16_f32 v165, v86, v87
    v_cvt_pk_bf16_f32 v168, v88, v89
    v_cvt_pk_bf16_f32 v169, v90, v91
    buffer_load_dwordx4 a[144:147], v253, s[8:11], s33 offen offset:1024 sc1
    v_cvt_pk_bf16_f32 v134, v112, v113
    v_cvt_pk_bf16_f32 v154, v114, v115
    v_cvt_pk_bf16_f32 v138, v116, v117
    v_cvt_pk_bf16_f32 v158, v118, v119
    v_cvt_pk_bf16_f32 v142, v120, v121
    v_cvt_pk_bf16_f32 v162, v122, v123
    v_cvt_pk_bf16_f32 v146, v124, v125
    v_cvt_pk_bf16_f32 v166, v126, v127
    v_cvt_pk_bf16_f32 v150, v128, v129
    buffer_load_dwordx4 a[148:151], v5, s[8:11], s34 offen offset:1024 sc1
    v_cvt_pk_bf16_f32 v170, v130, v131
    v_cvt_pk_bf16_f32 v172, v92, v93
    v_cvt_pk_bf16_f32 v173, v94, v95
    v_cvt_pk_bf16_f32 v174, v96, v97
    v_cvt_pk_bf16_f32 v175, v98, v99
    v_cvt_pk_bf16_f32 v176, v100, v101
    v_cvt_pk_bf16_f32 v177, v102, v103
    v_cvt_pk_bf16_f32 v178, v104, v105
    v_cvt_pk_bf16_f32 v179, v106, v107
    buffer_load_dwordx4 a[152:155], v253, s[8:11], s32 offen offset:2048 sc1
    v_cvt_pk_bf16_f32 v180, v108, v109
    v_cvt_pk_bf16_f32 v181, v110, v111
    v_mfma_f32_16x16x32_bf16 v[16:19], v[152:155], v[136:139], v[208:211]
    v_mfma_f32_16x16x32_bf16 v[20:23], v[156:159], v[136:139], v[204:207]
    v_mfma_f32_16x16x32_bf16 v[24:27], v[156:159], v[140:143], v[200:203]
    v_mfma_f32_16x16x32_bf16 v[28:31], v[160:163], v[140:143], v[204:207]
    v_mfma_f32_16x16x32_bf16 v[32:35], v[160:163], v[144:147], v[200:203]
    v_mfma_f32_16x16x32_bf16 v[36:39], v[164:167], v[144:147], v[204:207]
    v_mfma_f32_16x16x32_bf16 v[40:43], v[164:167], v[148:151], v[200:203]
    buffer_load_dwordx4 a[156:159], v253, s[8:11], s33 offen offset:2048 sc1
    v_mfma_f32_16x16x32_bf16 v[44:47], v[168:171], v[148:151], v[204:207]
    v_mfma_f32_16x16x32_bf16 v[56:59], v[132:135], v[192:195], v[196:199]
    v_mfma_f32_16x16x32_bf16 v[60:63], v[136:139], v[192:195], v[196:199]
    v_mfma_f32_16x16x32_bf16 v[64:67], v[140:143], v[192:195], v[196:199]
    v_mfma_f32_16x16x32_bf16 v[68:71], v[144:147], v[192:195], v[196:199]
    v_mfma_f32_16x16x32_bf16 v[72:75], v[148:151], v[192:195], v[196:199]
    v_max3_f32 v92, v16, v17, v18
    v_max3_f32 v96, v19, v20, v21
    v_max3_f32 v93, v24, v25, v26
    buffer_load_dwordx4 a[0:3], v5, s[8:11], s34 offen offset:2048 sc1
    v_max3_f32 v97, v27, v28, v29
    v_max3_f32 v94, v32, v33, v34
    v_max3_f32 v98, v35, v36, v37
    v_max3_f32 v95, v40, v41, v42
    v_max3_f32 v99, v43, v44, v45
    v_max3_f32 v92, v92, v22, v23
    v_max3_f32 v93, v93, v30, v31
    v_max3_f32 v94, v94, v38, v39
    v_max3_f32 v95, v95, v46, v47
    buffer_load_dwordx4 a[4:7], v253, s[8:11], s32 offen offset:3072 sc1
    s_add_u32 s32, s32, 4096
    v_max_f32 v92, v92, v96
    v_max_f32 v93, v93, v97
    v_max_f32 v94, v94, v98
    v_max_f32 v95, v95, v99
    s_mov_b32 s18, 0x3eae1a93
    v_cvt_pk_bf16_f32 v182, v56, v57
    v_permlane32_swap_b32 v92, v93
    v_permlane32_swap_b32 v94, v95
    v_max_f32 v92, v92, v93
    buffer_load_dwordx4 a[8:11], v253, s[8:11], s33 offen offset:3072 sc1
    s_add_u32 s33, s33, 4096
    v_max_f32 v94, v94, v95
    v_cvt_pk_bf16_f32 v183, v58, v59
    v_cvt_pk_bf16_f32 v184, v60, v61
    v_permlane16_swap_b32 v92, v94
    v_max_f32 v92, v92, v94
    v_mul_f32 v92, 0xbeae1a93, v92
    v_mov_b32 v94, v92
    v_cvt_pk_bf16_f32 v185, v62, v63
    v_cvt_pk_bf16_f32 v186, v64, v65
    buffer_load_dwordx4 a[12:15], v5, s[8:11], s34 offen offset:3072 sc1
    s_add_u32 s34, s34, 4096
    v_permlane16_swap_b32 v92, v94
    v_mov_b32 v93, v92
    v_mov_b32 v95, v94
    v_cvt_pk_bf16_f32 v187, v66, v67
    v_cvt_pk_bf16_f32 v188, v68, v69
    v_permlane32_swap_b32 v92, v93
    v_permlane32_swap_b32 v94, v95
    v_cvt_pk_bf16_f32 v189, v70, v71
    v_cvt_pk_bf16_f32 v190, v72, v73
    buffer_load_dwordx4 a[16:19], v253, s[8:11], s32 offen offset:0 sc1
    v_cvt_pk_bf16_f32 v191, v74, v75
    v_fma_f32 v16, v16, s18, v92
    v_fma_f32 v17, v17, s18, v92
    v_fma_f32 v18, v18, s18, v92
    v_fma_f32 v19, v19, s18, v92
    v_fma_f32 v20, v20, s18, v92
    v_fma_f32 v21, v21, s18, v92
    v_fma_f32 v22, v22, s18, v92
    v_fma_f32 v23, v23, s18, v92
    buffer_load_dwordx4 a[20:23], v253, s[8:11], s33 offen offset:0 sc1
    v_exp_f32 v16, v16
    v_exp_f32 v17, v17
    v_exp_f32 v18, v18
    v_exp_f32 v19, v19
    v_exp_f32 v20, v20
    v_exp_f32 v21, v21
    v_exp_f32 v22, v22
    v_exp_f32 v23, v23
    s_nop 0
    buffer_load_dwordx4 a[24:27], v5, s[8:11], s34 offen offset:0 sc1
    v_cvt_pk_bf16_f32 v76, v16, v17
    v_cvt_pk_bf16_f32 v77, v18, v19
    v_cvt_pk_bf16_f32 v78, v20, v21
    v_cvt_pk_bf16_f32 v79, v22, v23
    v_fma_f32 v24, v24, s18, v93
    v_fma_f32 v25, v25, s18, v93
    v_fma_f32 v26, v26, s18, v93
    v_fma_f32 v27, v27, s18, v93
    v_fma_f32 v28, v28, s18, v93
    buffer_load_dwordx4 a[28:31], v253, s[8:11], s32 offen offset:1024 sc1
    v_fma_f32 v29, v29, s18, v93
    v_fma_f32 v30, v30, s18, v93
    v_fma_f32 v31, v31, s18, v93
    v_exp_f32 v24, v24
    v_exp_f32 v25, v25
    v_exp_f32 v26, v26
    v_exp_f32 v27, v27
    v_exp_f32 v28, v28
    v_exp_f32 v29, v29
    buffer_load_dwordx4 a[32:35], v253, s[8:11], s33 offen offset:1024 sc1
    v_exp_f32 v30, v30
    v_exp_f32 v31, v31
    v_mfma_f32_16x16x32_bf16 v[100:103], v[172:175], v[76:79], 0
    v_mfma_f32_16x16x32_bf16 v[116:119], v[182:185], v[76:79], 0
    v_cvt_pk_bf16_f32 v80, v24, v25
    v_cvt_pk_bf16_f32 v81, v26, v27
    v_cvt_pk_bf16_f32 v82, v28, v29
    v_cvt_pk_bf16_f32 v83, v30, v31
    v_fma_f32 v32, v32, s18, v94
    buffer_load_dwordx4 a[36:39], v5, s[8:11], s34 offen offset:1024 sc1
    v_fma_f32 v33, v33, s18, v94
    v_fma_f32 v34, v34, s18, v94
    v_fma_f32 v35, v35, s18, v94
    v_fma_f32 v36, v36, s18, v94
    v_fma_f32 v37, v37, s18, v94
    v_fma_f32 v38, v38, s18, v94
    v_fma_f32 v39, v39, s18, v94
    v_exp_f32 v32, v32
    v_exp_f32 v33, v33
    buffer_load_dwordx4 a[40:43], v253, s[8:11], s32 offen offset:2048 sc1
    v_exp_f32 v34, v34
    v_exp_f32 v35, v35
    v_exp_f32 v36, v36
    v_exp_f32 v37, v37
    v_exp_f32 v38, v38
    v_exp_f32 v39, v39
    v_mfma_f32_16x16x32_bf16 v[104:107], v[174:177], v[80:83], 0
    v_mfma_f32_16x16x32_bf16 v[120:123], v[184:187], v[80:83], 0
    v_cvt_pk_bf16_f32 v84, v32, v33
    buffer_load_dwordx4 a[44:47], v253, s[8:11], s33 offen offset:2048 sc1
    v_cvt_pk_bf16_f32 v85, v34, v35
    v_cvt_pk_bf16_f32 v86, v36, v37
    v_cvt_pk_bf16_f32 v87, v38, v39
    v_fma_f32 v40, v40, s18, v95
    v_fma_f32 v41, v41, s18, v95
    v_fma_f32 v42, v42, s18, v95
    v_fma_f32 v43, v43, s18, v95
    v_fma_f32 v44, v44, s18, v95
    v_fma_f32 v45, v45, s18, v95
    buffer_load_dwordx4 a[48:51], v5, s[8:11], s34 offen offset:2048 sc1
    v_fma_f32 v46, v46, s18, v95
    v_fma_f32 v47, v47, s18, v95
    v_exp_f32 v40, v40
    v_exp_f32 v41, v41
    v_exp_f32 v42, v42
    v_exp_f32 v43, v43
    v_exp_f32 v44, v44
    v_exp_f32 v45, v45
    v_exp_f32 v46, v46
    buffer_load_dwordx4 a[52:55], v253, s[8:11], s32 offen offset:3072 sc1
    s_add_u32 s32, s32, 4096
    v_exp_f32 v47, v47
    v_mfma_f32_16x16x32_bf16 v[108:111], v[176:179], v[84:87], 0
    v_mfma_f32_16x16x32_bf16 v[124:127], v[186:189], v[84:87], 0
    v_cvt_pk_bf16_f32 v88, v40, v41
    v_cvt_pk_bf16_f32 v89, v42, v43
    v_cvt_pk_bf16_f32 v90, v44, v45
    v_cvt_pk_bf16_f32 v91, v46, v47
    v_rcp_f32 v96, v118
    v_rcp_f32 v97, v122
    buffer_load_dwordx4 v[240:243], v9, s[8:11], s37 offen offset:0 sc1
    v_mfma_f32_16x16x32_bf16 v[112:115], v[178:181], v[88:91], 0
    v_mfma_f32_16x16x32_bf16 v[128:131], v[188:191], v[88:91], 0
    v_pk_mul_f32 v[100:101], v[96:97], v[100:101] op_sel:[0,0] op_sel_hi:[0,1]
    v_pk_mul_f32 v[102:103], v[96:97], v[102:103] op_sel:[0,0] op_sel_hi:[0,1]
    v_pk_mul_f32 v[116:117], v[96:97], v[116:117] op_sel:[0,0] op_sel_hi:[0,1]
    v_cvt_pk_bf16_f32 v212, v100, v101
    v_cvt_pk_bf16_f32 v213, v102, v103
    v_cvt_pk_bf16_f32 v220, v116, v117
    v_rcp_f32 v98, v126
    buffer_load_dwordx4 v[244:247], v9, s[8:11], s37 offen offset:1024 sc1
    v_pk_mul_f32 v[104:105], v[96:97], v[104:105] op_sel:[1,0] op_sel_hi:[1,1]
    v_pk_mul_f32 v[106:107], v[96:97], v[106:107] op_sel:[1,0] op_sel_hi:[1,1]
    v_pk_mul_f32 v[120:121], v[96:97], v[120:121] op_sel:[1,0] op_sel_hi:[1,1]
    v_cvt_pk_bf16_f32 v214, v104, v105
    v_cvt_pk_bf16_f32 v215, v106, v107
    v_cvt_pk_bf16_f32 v221, v120, v121
    v_rcp_f32 v99, v130
    v_permlane16_swap_b32 v212, v214
    v_permlane16_swap_b32 v213, v215
    buffer_load_dwordx4 v[248:251], v7, s[8:11], s37 offen offset:2048 sc1
    v_pk_mul_f32 v[108:109], v[98:99], v[108:109] op_sel:[0,0] op_sel_hi:[0,1]
    v_pk_mul_f32 v[110:111], v[98:99], v[110:111] op_sel:[0,0] op_sel_hi:[0,1]
    v_pk_mul_f32 v[124:125], v[98:99], v[124:125] op_sel:[0,0] op_sel_hi:[0,1]
    v_cvt_pk_bf16_f32 v216, v108, v109
    v_cvt_pk_bf16_f32 v217, v110, v111
    v_cvt_pk_bf16_f32 v222, v124, v125
    v_pk_mul_f32 v[112:113], v[98:99], v[112:113] op_sel:[1,0] op_sel_hi:[1,1]
    v_pk_mul_f32 v[114:115], v[98:99], v[114:115] op_sel:[1,0] op_sel_hi:[1,1]
    v_pk_mul_f32 v[128:129], v[98:99], v[128:129] op_sel:[1,0] op_sel_hi:[1,1]
    buffer_load_dword v252, v8, s[8:11], s47 offen sc1
    v_cvt_pk_bf16_f32 v218, v112, v113
    v_cvt_pk_bf16_f32 v219, v114, v115
    v_cvt_pk_bf16_f32 v223, v128, v129
    s_lshl_b32 s7, s3, 2
    s_add_u32 s7, s7, 94208
    v_permlane16_swap_b32 v220, v221
    v_permlane16_swap_b32 v222, v223
    v_add_u32 v11, s7, v253
    v_lshrrev_b32 v10, 3, v0
    v_permlane32_swap_b32 v220, v222
    v_mul_u32_u24 v10, 9216, v10
    ds_write_b32 v11, v220
    v_permlane16_swap_b32 v216, v218
    v_permlane16_swap_b32 v217, v219
    s_mul_i32 s7, s40, 1152
    s_add_u32 s22, s22, s7
    s_add_u32 s22, s22, 41156608
    s_lshl_b32 s7, s3, 8
    s_add_u32 s23, s22, s7
    s_add_u32 s24, s23, 36864
    buffer_store_dwordx4 v[212:215], v9, s[8:11], s23 offen sc1
    buffer_store_dwordx4 v[216:219], v9, s[8:11], s24 offen sc1
    v_and_b32 v11, 7, v0
    v_lshl_add_u32 v10, v11, 4, v10
    s_cmp_eq_u32 s3, 3
    s_cselect_b32 s7, 0, 1073741824
    v_add_u32 v10, s7, v10
    v_add_u32 v11, 94208, v253
    s_waitcnt lgkmcnt(0)
    s_barrier
    ds_read_b128 v[220:223], v11
    s_waitcnt lgkmcnt(0)
    buffer_store_dwordx4 v[220:223], v10, s[8:11], s22 offen offset:1024 sc1
    v_lshlrev_b32 v15, 7, v0
    s_lshl_b32 s6, s40, 2
    s_add_u32 s6, s6, s44
    v_mov_b32 v1, s76
    s_mov_b64 vcc, 0xff
    s_waitcnt vmcnt(0)
    s_barrier
    s_cmp_lg_u32 s3, 0
    s_cbranch_scc1 L_pub_17
    s_mov_b64 exec, vcc
    buffer_store_dword v1, v15, s[8:11], s6 offen sc1
L_pub_17:
    s_mov_b64 exec, -1
    buffer_load_dwordx4 a[56:59], v253, s[8:11], s33 offen offset:3072 sc1
    s_add_u32 s33, s33, 4096
    buffer_load_dwordx4 a[60:63], v5, s[8:11], s34 offen offset:3072 sc1
    s_add_u32 s34, s34, 4096
    buffer_load_dwordx4 a[64:67], v253, s[8:11], s32 offen offset:0 sc1
    buffer_load_dwordx4 a[68:71], v253, s[8:11], s33 offen offset:0 sc1
    buffer_load_dwordx4 a[72:75], v5, s[8:11], s34 offen offset:0 sc1
    buffer_load_dwordx4 a[76:79], v253, s[8:11], s32 offen offset:1024 sc1
    buffer_load_dwordx4 a[80:83], v253, s[8:11], s33 offen offset:1024 sc1
    buffer_load_dwordx4 a[84:87], v5, s[8:11], s34 offen offset:1024 sc1
    s_cmp_lg_u32 s42, 0
    s_cbranch_scc1 L_swz_18
    s_cmp_eq_u32 s93, 2
    s_cselect_b32 s6, 2, 3
    s_mov_b32 s7, 512
    s_cmov_b32 s7, 2048
    v_lshrrev_b32 v14, 4, v0
    v_lshlrev_b32 v14, s6, v14
    v_bfe_u32 v15, v0, 2, 2
    v_add_u32 v14, v14, v15
    v_mul_u32_u24 v14, 128, v14
    v_and_b32 v15, 3, v0
    v_lshl_add_u32 v14, v15, 3, v14
    v_add_u32 v14, s79, v14
    v_add_u32 v15, s7, v14
    ds_read_b64_tr_b16 v[76:77], v14 offset:0
    ds_read_b64_tr_b16 v[78:79], v15 offset:0
    ds_read_b64_tr_b16 v[80:81], v14 offset:32
    ds_read_b64_tr_b16 v[82:83], v15 offset:32
    ds_read_b64_tr_b16 v[84:85], v14 offset:64
    ds_read_b64_tr_b16 v[86:87], v15 offset:64
    ds_read_b64_tr_b16 v[88:89], v14 offset:96
    ds_read_b64_tr_b16 v[90:91], v15 offset:96
    ds_read_b64_tr_b16 v[92:93], v14 offset:4096
    ds_read_b64_tr_b16 v[94:95], v15 offset:4096
    ds_read_b64_tr_b16 v[96:97], v14 offset:4128
    ds_read_b64_tr_b16 v[98:99], v15 offset:4128
    ds_read_b64_tr_b16 v[176:177], v14 offset:4160
    ds_read_b64_tr_b16 v[178:179], v15 offset:4160
    ds_read_b64_tr_b16 v[180:181], v14 offset:4192
    ds_read_b64_tr_b16 v[182:183], v15 offset:4192
    ds_read_b64_tr_b16 v[196:197], v14 offset:8192
    ds_read_b64_tr_b16 v[198:199], v15 offset:8192
    ds_read_b64_tr_b16 v[200:201], v14 offset:8224
    ds_read_b64_tr_b16 v[202:203], v15 offset:8224
    ds_read_b64_tr_b16 v[204:205], v14 offset:8256
    ds_read_b64_tr_b16 v[206:207], v15 offset:8256
    ds_read_b64_tr_b16 v[208:209], v14 offset:8288
    ds_read_b64_tr_b16 v[210:211], v15 offset:8288
    ds_read_b64_tr_b16 v[212:213], v14 offset:12288
    ds_read_b64_tr_b16 v[214:215], v15 offset:12288
    ds_read_b64_tr_b16 v[216:217], v14 offset:12320
    ds_read_b64_tr_b16 v[218:219], v15 offset:12320
    ds_read_b64_tr_b16 v[220:221], v14 offset:12352
    ds_read_b64_tr_b16 v[222:223], v15 offset:12352
    ds_read_b64_tr_b16 v[228:229], v14 offset:12384
    ds_read_b64_tr_b16 v[230:231], v15 offset:12384
    s_mul_i32 s68, s40, 1990656
    s_add_u32 s68, s68, 3145728
    s_cmp_eq_u32 s93, 2
    s_cbranch_scc1 L_swz_down_19
    s_mul_i32 s6, s84, 349526
    s_lshr_b32 s6, s6, 20
    s_mul_i32 s7, s6, 3
    s_sub_u32 s7, s84, s7
    s_mul_i32 s6, s6, 6
    s_add_u32 s7, s7, s6
    s_mul_i32 s6, s88, 36
    s_add_u32 s7, s7, s6
    s_mul_i32 s6, s93, 3
    s_add_u32 s7, s7, s6
    s_lshl_b32 s7, s7, 10
    s_add_u32 s7, s7, s68
    s_add_u32 s80, s7, 0
    s_add_u32 s81, s7, 497664
    s_add_u32 s82, s7, 995328
    s_add_u32 s83, s7, 1492992
    s_mul_i32 s6, s85, 349526
    s_lshr_b32 s6, s6, 20
    s_mul_i32 s7, s6, 3
    s_sub_u32 s7, s85, s7
    s_mul_i32 s6, s6, 6
    s_add_u32 s7, s7, s6
    s_mul_i32 s6, s89, 36
    s_add_u32 s7, s7, s6
    s_mul_i32 s6, s93, 3
    s_add_u32 s7, s7, s6
    s_lshl_b32 s7, s7, 10
    s_add_u32 s7, s7, s68
    s_add_u32 s64, s7, 0
    s_add_u32 s65, s7, 497664
    s_add_u32 s18, s7, 995328
    s_add_u32 s19, s7, 1492992
    s_mul_i32 s6, s86, 349526
    s_lshr_b32 s6, s6, 20
    s_mul_i32 s7, s6, 3
    s_sub_u32 s7, s86, s7
    s_mul_i32 s6, s6, 6
    s_add_u32 s7, s7, s6
    s_mul_i32 s6, s90, 36
    s_add_u32 s7, s7, s6
    s_mul_i32 s6, s93, 3
    s_add_u32 s7, s7, s6
    s_lshl_b32 s7, s7, 10
    s_add_u32 s7, s7, s68
    s_add_u32 s20, s7, 0
    s_add_u32 s21, s7, 497664
    s_add_u32 s22, s7, 995328
    s_add_u32 s25, s7, 1492992
    s_mul_i32 s6, s87, 349526
    s_lshr_b32 s6, s6, 20
    s_mul_i32 s7, s6, 3
    s_sub_u32 s7, s87, s7
    s_mul_i32 s6, s6, 6
    s_add_u32 s7, s7, s6
    s_mul_i32 s6, s91, 36
    s_add_u32 s7, s7, s6
    s_mul_i32 s6, s93, 3
    s_add_u32 s7, s7, s6
    s_lshl_b32 s7, s7, 10
    s_add_u32 s7, s7, s68
    s_add_u32 s26, s7, 0
    s_add_u32 s27, s7, 497664
    s_add_u32 s28, s7, 995328
    s_add_u32 s29, s7, 1492992
    s_branch L_swz_dest_20
L_swz_down_19:
    s_mul_i32 s7, s88, 18
    s_add_u32 s7, s7, s84
    s_add_u32 s7, s7, 324
    s_lshl_b32 s7, s7, 10
    s_add_u32 s7, s7, s68
    s_add_u32 s80, s7, 0
    s_add_u32 s81, s7, 497664
    s_add_u32 s82, s7, 995328
    s_add_u32 s83, s7, 1492992
    s_mul_i32 s7, s89, 18
    s_add_u32 s7, s7, s85
    s_add_u32 s7, s7, 324
    s_lshl_b32 s7, s7, 10
    s_add_u32 s7, s7, s68
    s_add_u32 s64, s7, 0
    s_add_u32 s65, s7, 497664
    s_add_u32 s18, s7, 995328
    s_add_u32 s19, s7, 1492992
    s_mul_i32 s7, s90, 18
    s_add_u32 s7, s7, s86
    s_add_u32 s7, s7, 324
    s_lshl_b32 s7, s7, 10
    s_add_u32 s7, s7, s68
    s_add_u32 s20, s7, 0
    s_add_u32 s21, s7, 497664
    s_add_u32 s22, s7, 995328
    s_add_u32 s25, s7, 1492992
    s_mul_i32 s7, s91, 18
    s_add_u32 s7, s7, s87
    s_add_u32 s7, s7, 324
    s_lshl_b32 s7, s7, 10
    s_add_u32 s7, s7, s68
    s_add_u32 s26, s7, 0
    s_add_u32 s27, s7, 497664
    s_add_u32 s28, s7, 995328
    s_add_u32 s29, s7, 1492992
L_swz_dest_20:
    s_mov_b32 s72, s8
    s_mov_b32 s73, s9
    s_mov_b32 s74, 268435456
    s_waitcnt lgkmcnt(0)
    buffer_store_dwordx4 v[76:79], v253, s[72:75], s80 offen sc1
    buffer_store_dwordx4 v[80:83], v253, s[72:75], s81 offen sc1
    buffer_store_dwordx4 v[84:87], v253, s[72:75], s82 offen sc1
    buffer_store_dwordx4 v[88:91], v253, s[72:75], s83 offen sc1
    buffer_store_dwordx4 v[92:95], v253, s[72:75], s64 offen sc1
    buffer_store_dwordx4 v[96:99], v253, s[72:75], s65 offen sc1
    buffer_store_dwordx4 v[176:179], v253, s[72:75], s18 offen sc1
    buffer_store_dwordx4 v[180:183], v253, s[72:75], s19 offen sc1
    buffer_store_dwordx4 v[196:199], v253, s[72:75], s20 offen sc1
    buffer_store_dwordx4 v[200:203], v253, s[72:75], s21 offen sc1
    buffer_store_dwordx4 v[204:207], v253, s[72:75], s22 offen sc1
    buffer_store_dwordx4 v[208:211], v253, s[72:75], s25 offen sc1
    buffer_store_dwordx4 v[212:215], v253, s[72:75], s26 offen sc1
    buffer_store_dwordx4 v[216:219], v253, s[72:75], s27 offen sc1
    buffer_store_dwordx4 v[220:223], v253, s[72:75], s28 offen sc1
    buffer_store_dwordx4 v[228:231], v253, s[72:75], s29 offen sc1
    s_lshr_b32 s7, s2, 3
    s_lshl_b32 s7, s7, 2
    s_add_u32 s7, s7, s3
    s_lshl_b32 s7, s7, 9
    v_lshrrev_b32 v1, 1, v253
    v_add_u32 v1, s7, v1
    buffer_load_dwordx2 v[14:15], v1, s[96:99], 0 offen
L_swz_18:
    s_and_b32 s7, s3, 1
    s_mul_i32 s7, s7, 18432
    s_add_u32 s24, s30, s7
    s_lshr_b32 s7, s3, 1
    s_lshl_b32 s7, s7, 9
    s_add_u32 s24, s24, s7
    s_add_u32 s24, s24, 41156608
    s_mov_b32 s16, 0xffff0000
    v_lshlrev_b32 v124, 16, v240
    v_and_b32 v125, s16, v240
    v_lshlrev_b32 v126, 16, v241
    v_and_b32 v127, s16, v241
    v_lshlrev_b32 v128, 16, v242
    v_and_b32 v129, s16, v242
    v_lshlrev_b32 v130, 16, v243
    v_and_b32 v131, s16, v243
    v_lshlrev_b32 v132, 16, v244
    v_and_b32 v133, s16, v244
    v_lshlrev_b32 v134, 16, v245
    v_and_b32 v135, s16, v245
    v_lshlrev_b32 v136, 16, v246
    v_and_b32 v137, s16, v246
    v_lshlrev_b32 v138, 16, v247
    v_and_b32 v139, s16, v247
    v_lshlrev_b32 v140, 16, v248
    v_and_b32 v141, s16, v248
    v_lshlrev_b32 v142, 16, v249
    v_and_b32 v143, s16, v249
    v_lshlrev_b32 v144, 16, v250
    v_and_b32 v145, s16, v250
    v_lshlrev_b32 v146, 16, v251
    v_and_b32 v147, s16, v251
    s_cmp_eq_u32 s3, 1
    s_cselect_b32 s7, 16, 0
    v_lshlrev_b32 v12, 2, v0
    v_cmp_gt_u32 vcc, s7, v0
    v_add_u32 v10, 40960, v12
    v_add_u32 v11, 41472, v12
    v_cndmask_b32 v10, v11, v10, vcc
    v_and_b32 v11, 0x7c, v12
    v_cmp_gt_u32 vcc, 32, v0
    v_mov_b32 v13, 1073741824
    s_and_b32 s7, s40, 3
    s_lshl_b32 s45, s45, 2
    v_cndmask_b32 v8, v13, v12, vcc
    s_add_u32 s6, s7, s3
    s_cmp_eq_u32 s6, 0
    s_cselect_b32 s6, 0, 1073741824
    v_add_u32 v6, s6, v8
    s_add_u32 s45, s45, s7
    s_lshl_b32 s45, s45, 2
    s_add_u32 s45, s45, s3
    s_lshl_b32 s45, s45, 7
    s_add_u32 s45, s45, s43
    s_add_u32 s45, s45, 48300032
    s_cmp_eq_u32 s3, 0
    s_cselect_b32 s35, 1.0, 0
    s_lshl_b32 s7, s40, 2
    s_add_u32 s7, s7, s3
    s_mul_i32 s23, s7, 497664
    s_add_u32 s23, s23, 3145728
    s_add_u32 s50, s23, 497664
    s_mul_i32 s50, s50, s42
    v_mov_b32 v184, v253
    v_add_u32 v185, 4096, v253
    v_add_u32 v186, 8192, v253
    v_add_u32 v187, 12288, v253
    v_add_u32 v188, 16384, v253
    v_add_u32 v189, 20480, v253
    v_add_u32 v190, 24576, v253
    v_add_u32 v191, 28672, v253
    v_add_u32 v192, 32768, v253
    s_cmp_lg_u32 s3, 3
    s_cbranch_scc1 L_pollout_23
    s_lshl_b32 s7, s40, 7
    s_add_u32 s7, s7, s44
    s_add_u32 s52, s4, s7
    s_addc_u32 s53, s5, 0
    s_mov_b32 s6, 0
L_poll_21:
    s_load_dwordx8 s[56:63], s[52:53], 0 glc
    s_add_u32 s6, s6, 1
    s_waitcnt lgkmcnt(0)
    s_xor_b64 s[56:57], s[56:57], s[76:77]
    s_xor_b64 s[58:59], s[58:59], s[76:77]
    s_xor_b64 s[60:61], s[60:61], s[76:77]
    s_xor_b64 s[62:63], s[62:63], s[76:77]
    s_or_b64 s[56:57], s[56:57], s[58:59]
    s_or_b64 s[60:61], s[60:61], s[62:63]
    s_or_b64 s[56:57], s[56:57], s[60:61]
    s_cbranch_scc0 L_polled_22
    s_cmp_lt_u32 s6, 1048576
    s_cbranch_scc1 L_poll_21
    s_branch L_main_end
L_polled_22:
L_pollout_23:
    s_barrier
    s_lshl_b32 m0, s3, 10
    s_nop 0
    buffer_load_dwordx4 v2, s[8:11], s24 offen sc1 lds
    s_add_u32 m0, m0, 4096
    s_add_u32 s24, s24, 1024
    buffer_load_dwordx4 v2, s[8:11], s24 offen sc1 lds
    s_add_u32 m0, m0, 4096
    s_add_u32 s24, s24, 1024
    buffer_load_dwordx4 v2, s[8:11], s24 offen sc1 lds
    s_add_u32 m0, m0, 4096
    s_add_u32 s24, s24, 1024
    buffer_load_dwordx4 v2, s[8:11], s24 offen sc1 lds
    s_add_u32 m0, m0, 4096
    s_add_u32 s24, s24, 1024
    buffer_load_dwordx4 v2, s[8:11], s24 offen sc1 lds
    s_add_u32 m0, m0, 4096
    s_add_u32 s24, s24, 1024
    buffer_load_dwordx4 v2, s[8:11], s24 offen sc1 lds
    s_add_u32 m0, m0, 4096
    s_add_u32 s24, s24, 1024
    buffer_load_dwordx4 v2, s[8:11], s24 offen sc1 lds
    s_add_u32 m0, m0, 4096
    s_add_u32 s24, s24, 1024
    buffer_load_dwordx4 v2, s[8:11], s24 offen sc1 lds
    s_add_u32 m0, m0, 4096
    s_add_u32 s24, s24, 1024
    buffer_load_dwordx4 v2, s[8:11], s24 offen sc1 lds
    s_waitcnt vmcnt(4)
    s_barrier
    ds_read_b128 v[160:163], v253 offset:0
    ds_read_b128 v[164:167], v253 offset:1024
    s_waitcnt lgkmcnt(0)
    v_mfma_f32_16x16x32_bf16 v[100:103], a[160:163], v[160:163], 0
    ds_read_b128 v[168:171], v253 offset:2048
    v_mfma_f32_16x16x32_bf16 v[104:107], a[160:163], v[164:167], 0
    ds_read_b128 v[172:175], v253 offset:3072
    v_mfma_f32_16x16x32_bf16 v[108:111], a[164:167], v[160:163], 0
    v_mfma_f32_16x16x32_bf16 v[112:115], a[164:167], v[164:167], 0
    buffer_load_dwordx4 v[16:19], v184, s[48:51], s23 offen offset:0 sc1
    v_mfma_f32_16x16x32_bf16 v[116:119], a[168:171], v[160:163], 0
    v_mfma_f32_16x16x32_bf16 v[120:123], a[168:171], v[164:167], 0
    s_waitcnt lgkmcnt(0)
    v_mfma_f32_16x16x32_bf16 v[100:103], a[172:175], v[168:171], v[100:103]
    ds_read_b128 v[160:163], v253 offset:4096
    v_mfma_f32_16x16x32_bf16 v[104:107], a[172:175], v[172:175], v[104:107]
    ds_read_b128 v[164:167], v253 offset:5120
    v_mfma_f32_16x16x32_bf16 v[108:111], a[176:179], v[168:171], v[108:111]
    v_mfma_f32_16x16x32_bf16 v[112:115], a[176:179], v[172:175], v[112:115]
    buffer_load_dwordx4 v[20:23], v184, s[48:51], s23 offen offset:1024 sc1
    v_mfma_f32_16x16x32_bf16 v[116:119], a[180:183], v[168:171], v[116:119]
    v_mfma_f32_16x16x32_bf16 v[120:123], a[180:183], v[172:175], v[120:123]
    s_waitcnt lgkmcnt(0)
    v_mfma_f32_16x16x32_bf16 v[100:103], a[184:187], v[160:163], v[100:103]
    ds_read_b128 v[168:171], v253 offset:6144
    v_mfma_f32_16x16x32_bf16 v[104:107], a[184:187], v[164:167], v[104:107]
    ds_read_b128 v[172:175], v253 offset:7168
    v_mfma_f32_16x16x32_bf16 v[108:111], a[188:191], v[160:163], v[108:111]
    v_mfma_f32_16x16x32_bf16 v[112:115], a[188:191], v[164:167], v[112:115]
    buffer_load_dwordx4 v[24:27], v184, s[48:51], s23 offen offset:2048 sc1
    v_mfma_f32_16x16x32_bf16 v[116:119], a[192:195], v[160:163], v[116:119]
    v_mfma_f32_16x16x32_bf16 v[120:123], a[192:195], v[164:167], v[120:123]
    s_waitcnt lgkmcnt(0)
    v_mfma_f32_16x16x32_bf16 v[100:103], a[196:199], v[168:171], v[100:103]
    ds_read_b128 v[160:163], v253 offset:8192
    v_mfma_f32_16x16x32_bf16 v[104:107], a[196:199], v[172:175], v[104:107]
    ds_read_b128 v[164:167], v253 offset:9216
    v_mfma_f32_16x16x32_bf16 v[108:111], a[200:203], v[168:171], v[108:111]
    v_mfma_f32_16x16x32_bf16 v[112:115], a[200:203], v[172:175], v[112:115]
    buffer_load_dwordx4 v[28:31], v184, s[48:51], s23 offen offset:3072 sc1
    v_mfma_f32_16x16x32_bf16 v[116:119], a[204:207], v[168:171], v[116:119]
    v_mfma_f32_16x16x32_bf16 v[120:123], a[204:207], v[172:175], v[120:123]
    s_waitcnt lgkmcnt(0)
    v_mfma_f32_16x16x32_bf16 v[100:103], a[208:211], v[160:163], v[100:103]
    ds_read_b128 v[168:171], v253 offset:10240
    v_mfma_f32_16x16x32_bf16 v[104:107], a[208:211], v[164:167], v[104:107]
    ds_read_b128 v[172:175], v253 offset:11264
    v_mfma_f32_16x16x32_bf16 v[108:111], a[212:215], v[160:163], v[108:111]
    v_mfma_f32_16x16x32_bf16 v[112:115], a[212:215], v[164:167], v[112:115]
    buffer_load_dwordx4 v[32:35], v185, s[48:51], s23 offen offset:0 sc1
    v_mfma_f32_16x16x32_bf16 v[116:119], a[216:219], v[160:163], v[116:119]
    v_mfma_f32_16x16x32_bf16 v[120:123], a[216:219], v[164:167], v[120:123]
    s_waitcnt lgkmcnt(0)
    v_mfma_f32_16x16x32_bf16 v[100:103], a[220:223], v[168:171], v[100:103]
    ds_read_b128 v[160:163], v253 offset:12288
    v_mfma_f32_16x16x32_bf16 v[104:107], a[220:223], v[172:175], v[104:107]
    ds_read_b128 v[164:167], v253 offset:13312
    v_mfma_f32_16x16x32_bf16 v[108:111], a[224:227], v[168:171], v[108:111]
    v_mfma_f32_16x16x32_bf16 v[112:115], a[224:227], v[172:175], v[112:115]
    buffer_load_dwordx4 v[36:39], v185, s[48:51], s23 offen offset:1024 sc1
    v_mfma_f32_16x16x32_bf16 v[116:119], a[228:231], v[168:171], v[116:119]
    v_mfma_f32_16x16x32_bf16 v[120:123], a[228:231], v[172:175], v[120:123]
    s_waitcnt lgkmcnt(0)
    v_mfma_f32_16x16x32_bf16 v[100:103], a[232:235], v[160:163], v[100:103]
    ds_read_b128 v[168:171], v253 offset:14336
    v_mfma_f32_16x16x32_bf16 v[104:107], a[232:235], v[164:167], v[104:107]
    ds_read_b128 v[172:175], v253 offset:15360
    v_mfma_f32_16x16x32_bf16 v[108:111], a[236:239], v[160:163], v[108:111]
    v_mfma_f32_16x16x32_bf16 v[112:115], a[236:239], v[164:167], v[112:115]
    buffer_load_dwordx4 v[40:43], v185, s[48:51], s23 offen offset:2048 sc1
    v_mfma_f32_16x16x32_bf16 v[116:119], a[240:243], v[160:163], v[116:119]
    v_mfma_f32_16x16x32_bf16 v[120:123], a[240:243], v[164:167], v[120:123]
    s_waitcnt lgkmcnt(0)
    v_mfma_f32_16x16x32_bf16 v[100:103], a[244:247], v[168:171], v[100:103]
    ds_read_b128 v[160:163], v253 offset:16384
    v_mfma_f32_16x16x32_bf16 v[104:107], a[244:247], v[172:175], v[104:107]
    ds_read_b128 v[164:167], v253 offset:17408
    v_mfma_f32_16x16x32_bf16 v[108:111], a[248:251], v[168:171], v[108:111]
    v_mfma_f32_16x16x32_bf16 v[112:115], a[248:251], v[172:175], v[112:115]
    buffer_load_dwordx4 v[44:47], v185, s[48:51], s23 offen offset:3072 sc1
    v_mfma_f32_16x16x32_bf16 v[116:119], a[252:255], v[168:171], v[116:119]
    v_mfma_f32_16x16x32_bf16 v[120:123], a[252:255], v[172:175], v[120:123]
    s_waitcnt lgkmcnt(0)
    v_mfma_f32_16x16x32_bf16 v[100:103], a[128:131], v[160:163], v[100:103]
    ds_read_b128 v[168:171], v253 offset:18432
    v_mfma_f32_16x16x32_bf16 v[104:107], a[128:131], v[164:167], v[104:107]
    ds_read_b128 v[172:175], v253 offset:19456
    v_mfma_f32_16x16x32_bf16 v[108:111], a[132:135], v[160:163], v[108:111]
    v_mfma_f32_16x16x32_bf16 v[112:115], a[132:135], v[164:167], v[112:115]
    buffer_load_dwordx4 v[48:51], v186, s[48:51], s23 offen offset:0 sc1
    v_mfma_f32_16x16x32_bf16 v[116:119], a[136:139], v[160:163], v[116:119]
    v_mfma_f32_16x16x32_bf16 v[120:123], a[136:139], v[164:167], v[120:123]
    s_waitcnt vmcnt(9) lgkmcnt(0)
    s_barrier
    s_xor_b32 s7, s3, 0
    s_or_b32 s7, s7, s42
    s_cbranch_scc1 L_swz_24
    s_lshl_b32 s6, s40, 7
    s_lshl_b32 s7, s41, 2
    s_add_u32 s6, s6, s7
    s_add_u32 s6, s6, 19464192
    s_mov_b64 exec, 0xffffffff
    v_lshlrev_b32 v15, 10, v0
    v_mov_b32 v1, s76
    buffer_store_dword v1, v15, s[8:11], s6 offen sc1
    s_mov_b64 exec, -1
L_swz_24:
    v_mfma_f32_16x16x32_bf16 v[100:103], a[140:143], v[168:171], v[100:103]
    ds_read_b128 v[160:163], v253 offset:20480
    v_mfma_f32_16x16x32_bf16 v[104:107], a[140:143], v[172:175], v[104:107]
    ds_read_b128 v[164:167], v253 offset:21504
    v_mfma_f32_16x16x32_bf16 v[108:111], a[144:147], v[168:171], v[108:111]
    v_mfma_f32_16x16x32_bf16 v[112:115], a[144:147], v[172:175], v[112:115]
    buffer_load_dwordx4 v[52:55], v186, s[48:51], s23 offen offset:1024 sc1
    v_mfma_f32_16x16x32_bf16 v[116:119], a[148:151], v[168:171], v[116:119]
    v_mfma_f32_16x16x32_bf16 v[120:123], a[148:151], v[172:175], v[120:123]
    s_waitcnt lgkmcnt(0)
    v_mfma_f32_16x16x32_bf16 v[100:103], a[152:155], v[160:163], v[100:103]
    ds_read_b128 v[168:171], v253 offset:22528
    v_mfma_f32_16x16x32_bf16 v[104:107], a[152:155], v[164:167], v[104:107]
    ds_read_b128 v[172:175], v253 offset:23552
    v_mfma_f32_16x16x32_bf16 v[108:111], a[156:159], v[160:163], v[108:111]
    v_mfma_f32_16x16x32_bf16 v[112:115], a[156:159], v[164:167], v[112:115]
    buffer_load_dwordx4 v[56:59], v186, s[48:51], s23 offen offset:2048 sc1
    v_mfma_f32_16x16x32_bf16 v[116:119], a[0:3], v[160:163], v[116:119]
    v_mfma_f32_16x16x32_bf16 v[120:123], a[0:3], v[164:167], v[120:123]
    s_waitcnt lgkmcnt(0)
    v_mfma_f32_16x16x32_bf16 v[100:103], a[4:7], v[168:171], v[100:103]
    ds_read_b128 v[160:163], v253 offset:24576
    v_mfma_f32_16x16x32_bf16 v[104:107], a[4:7], v[172:175], v[104:107]
    ds_read_b128 v[164:167], v253 offset:25600
    v_mfma_f32_16x16x32_bf16 v[108:111], a[8:11], v[168:171], v[108:111]
    v_mfma_f32_16x16x32_bf16 v[112:115], a[8:11], v[172:175], v[112:115]
    buffer_load_dwordx4 v[60:63], v186, s[48:51], s23 offen offset:3072 sc1
    v_mfma_f32_16x16x32_bf16 v[116:119], a[12:15], v[168:171], v[116:119]
    v_mfma_f32_16x16x32_bf16 v[120:123], a[12:15], v[172:175], v[120:123]
    s_waitcnt lgkmcnt(0)
    v_mfma_f32_16x16x32_bf16 v[100:103], a[16:19], v[160:163], v[100:103]
    ds_read_b128 v[168:171], v253 offset:26624
    v_mfma_f32_16x16x32_bf16 v[104:107], a[16:19], v[164:167], v[104:107]
    ds_read_b128 v[172:175], v253 offset:27648
    v_mfma_f32_16x16x32_bf16 v[108:111], a[20:23], v[160:163], v[108:111]
    v_mfma_f32_16x16x32_bf16 v[112:115], a[20:23], v[164:167], v[112:115]
    buffer_load_dwordx4 v[64:67], v187, s[48:51], s23 offen offset:0 sc1
    v_mfma_f32_16x16x32_bf16 v[116:119], a[24:27], v[160:163], v[116:119]
    v_mfma_f32_16x16x32_bf16 v[120:123], a[24:27], v[164:167], v[120:123]
    s_waitcnt lgkmcnt(0)
    v_mfma_f32_16x16x32_bf16 v[100:103], a[28:31], v[168:171], v[100:103]
    ds_read_b128 v[160:163], v253 offset:28672
    v_mfma_f32_16x16x32_bf16 v[104:107], a[28:31], v[172:175], v[104:107]
    ds_read_b128 v[164:167], v253 offset:29696
    v_mfma_f32_16x16x32_bf16 v[108:111], a[32:35], v[168:171], v[108:111]
    v_mfma_f32_16x16x32_bf16 v[112:115], a[32:35], v[172:175], v[112:115]
    buffer_load_dwordx4 v[68:71], v187, s[48:51], s23 offen offset:1024 sc1
    v_mfma_f32_16x16x32_bf16 v[116:119], a[36:39], v[168:171], v[116:119]
    v_mfma_f32_16x16x32_bf16 v[120:123], a[36:39], v[172:175], v[120:123]
    s_waitcnt lgkmcnt(0)
    v_mfma_f32_16x16x32_bf16 v[100:103], a[40:43], v[160:163], v[100:103]
    ds_read_b128 v[168:171], v253 offset:30720
    v_mfma_f32_16x16x32_bf16 v[104:107], a[40:43], v[164:167], v[104:107]
    ds_read_b128 v[172:175], v253 offset:31744
    v_mfma_f32_16x16x32_bf16 v[108:111], a[44:47], v[160:163], v[108:111]
    v_mfma_f32_16x16x32_bf16 v[112:115], a[44:47], v[164:167], v[112:115]
    buffer_load_dwordx4 v[72:75], v187, s[48:51], s23 offen offset:2048 sc1
    v_mfma_f32_16x16x32_bf16 v[116:119], a[48:51], v[160:163], v[116:119]
    v_mfma_f32_16x16x32_bf16 v[120:123], a[48:51], v[164:167], v[120:123]
    s_waitcnt lgkmcnt(0)
    v_mfma_f32_16x16x32_bf16 v[100:103], a[52:55], v[168:171], v[100:103]
    ds_read_b128 v[160:163], v253 offset:32768
    v_mfma_f32_16x16x32_bf16 v[104:107], a[52:55], v[172:175], v[104:107]
    ds_read_b128 v[164:167], v253 offset:33792
    v_mfma_f32_16x16x32_bf16 v[108:111], a[56:59], v[168:171], v[108:111]
    v_mfma_f32_16x16x32_bf16 v[112:115], a[56:59], v[172:175], v[112:115]
    v_mfma_f32_16x16x32_bf16 v[116:119], a[60:63], v[168:171], v[116:119]
    v_mfma_f32_16x16x32_bf16 v[120:123], a[60:63], v[172:175], v[120:123]
    s_waitcnt lgkmcnt(0)
    v_mfma_f32_16x16x32_bf16 v[100:103], a[64:67], v[160:163], v[100:103]
    ds_read_b128 v[168:171], v253 offset:34816
    v_mfma_f32_16x16x32_bf16 v[104:107], a[64:67], v[164:167], v[104:107]
    ds_read_b128 v[172:175], v253 offset:35840
    v_mfma_f32_16x16x32_bf16 v[108:111], a[68:71], v[160:163], v[108:111]
    v_mfma_f32_16x16x32_bf16 v[112:115], a[68:71], v[164:167], v[112:115]
    v_mfma_f32_16x16x32_bf16 v[116:119], a[72:75], v[160:163], v[116:119]
    v_mfma_f32_16x16x32_bf16 v[120:123], a[72:75], v[164:167], v[120:123]
    s_waitcnt lgkmcnt(0)
    v_mfma_f32_16x16x32_bf16 v[100:103], a[76:79], v[168:171], v[100:103]
    v_mfma_f32_16x16x32_bf16 v[104:107], a[76:79], v[172:175], v[104:107]
    v_mfma_f32_16x16x32_bf16 v[108:111], a[80:83], v[168:171], v[108:111]
    v_mfma_f32_16x16x32_bf16 v[112:115], a[80:83], v[172:175], v[112:115]
    v_mfma_f32_16x16x32_bf16 v[116:119], a[84:87], v[168:171], v[116:119]
    v_mfma_f32_16x16x32_bf16 v[120:123], a[84:87], v[172:175], v[120:123]
    s_nop 3
    v_permlane16_swap_b32 v100, v104
    v_permlane16_swap_b32 v101, v105
    v_permlane16_swap_b32 v102, v106
    v_permlane16_swap_b32 v103, v107
    v_add_f32 v12, v116, v117
    v_add_f32 v13, v120, v121
    ds_write_b32 v10, v12
    ds_write_b32 v10, v13 offset:64
    v_permlane16_swap_b32 v108, v112
    v_permlane16_swap_b32 v109, v113
    v_permlane16_swap_b32 v110, v114
    v_permlane16_swap_b32 v111, v115
    v_permlane16_swap_b32 v116, v120
    v_permlane16_swap_b32 v117, v121
    v_permlane16_swap_b32 v118, v122
    v_permlane16_swap_b32 v119, v123
    s_waitcnt lgkmcnt(0)
    s_barrier
    ds_read_b32 v12, v11 offset:40960
    v_pk_add_f32 v[124:125], v[124:125], v[100:101]
    v_pk_add_f32 v[126:127], v[126:127], v[102:103]
    v_pk_add_f32 v[128:129], v[128:129], v[104:105]
    v_pk_add_f32 v[130:131], v[130:131], v[106:107]
    v_pk_add_f32 v[132:133], v[132:133], v[108:109]
    v_pk_add_f32 v[134:135], v[134:135], v[110:111]
    v_pk_add_f32 v[136:137], v[136:137], v[112:113]
    v_pk_add_f32 v[138:139], v[138:139], v[114:115]
    v_pk_add_f32 v[140:141], v[140:141], v[116:117]
    v_pk_add_f32 v[142:143], v[142:143], v[118:119]
    v_pk_add_f32 v[144:145], v[144:145], v[120:121]
    v_pk_add_f32 v[146:147], v[146:147], v[122:123]
    v_mov_b32 v14, 0
    v_mov_b32 v15, 0
    s_waitcnt lgkmcnt(0)
    v_add_f32 v12, v12, v252
    v_pk_add_f32 v[100:101], v[124:125], v[12:13] op_sel_hi:[1,0] neg_lo:[0,1] neg_hi:[0,1]
    v_pk_add_f32 v[102:103], v[126:127], v[12:13] op_sel_hi:[1,0] neg_lo:[0,1] neg_hi:[0,1]
    v_pk_add_f32 v[104:105], v[128:129], v[12:13] op_sel_hi:[1,0] neg_lo:[0,1] neg_hi:[0,1]
    v_pk_add_f32 v[106:107], v[130:131], v[12:13] op_sel_hi:[1,0] neg_lo:[0,1] neg_hi:[0,1]
    v_cvt_pk_bf16_f32 v148, v100, v101
    v_cvt_pk_bf16_f32 v149, v102, v103
    v_cvt_pk_bf16_f32 v150, v104, v105
    v_cvt_pk_bf16_f32 v151, v106, v107
    buffer_store_dwordx4 v[148:151], v9, s[8:11], s46 offen offset:0 sc1
    v_pk_add_f32 v[108:109], v[132:133], v[12:13] op_sel_hi:[1,0] neg_lo:[0,1] neg_hi:[0,1]
    v_pk_add_f32 v[110:111], v[134:135], v[12:13] op_sel_hi:[1,0] neg_lo:[0,1] neg_hi:[0,1]
    v_pk_add_f32 v[112:113], v[136:137], v[12:13] op_sel_hi:[1,0] neg_lo:[0,1] neg_hi:[0,1]
    v_pk_add_f32 v[114:115], v[138:139], v[12:13] op_sel_hi:[1,0] neg_lo:[0,1] neg_hi:[0,1]
    v_cvt_pk_bf16_f32 v152, v108, v109
    v_cvt_pk_bf16_f32 v153, v110, v111
    v_cvt_pk_bf16_f32 v154, v112, v113
    v_cvt_pk_bf16_f32 v155, v114, v115
    buffer_store_dwordx4 v[152:155], v9, s[8:11], s46 offen offset:1024 sc1
    v_pk_add_f32 v[116:117], v[140:141], v[12:13] op_sel_hi:[1,0] neg_lo:[0,1] neg_hi:[0,1]
    v_pk_add_f32 v[118:119], v[142:143], v[12:13] op_sel_hi:[1,0] neg_lo:[0,1] neg_hi:[0,1]
    v_pk_add_f32 v[120:121], v[144:145], v[12:13] op_sel_hi:[1,0] neg_lo:[0,1] neg_hi:[0,1]
    v_pk_add_f32 v[122:123], v[146:147], v[12:13] op_sel_hi:[1,0] neg_lo:[0,1] neg_hi:[0,1]
    v_cvt_pk_bf16_f32 v156, v116, v117
    v_cvt_pk_bf16_f32 v157, v118, v119
    v_cvt_pk_bf16_f32 v158, v120, v121
    v_cvt_pk_bf16_f32 v159, v122, v123
    buffer_store_dwordx4 v[156:159], v7, s[8:11], s46 offen offset:2048 sc1
    v_dot2c_f32_bf16 v14, v148, v148
    v_dot2c_f32_bf16 v14, v149, v149
    v_dot2c_f32_bf16 v14, v150, v150
    v_dot2c_f32_bf16 v14, v151, v151
    v_dot2c_f32_bf16 v14, v152, v152
    v_dot2c_f32_bf16 v14, v153, v153
    v_dot2c_f32_bf16 v14, v154, v154
    v_dot2c_f32_bf16 v14, v155, v155
    v_dot2c_f32_bf16 v15, v156, v156
    v_dot2c_f32_bf16 v15, v157, v157
    v_dot2c_f32_bf16 v15, v158, v158
    v_dot2c_f32_bf16 v15, v159, v159
    buffer_store_dword v12, v6, s[8:11], s36 offen sc1
    s_nop 1
    v_fma_f32 v14, v15, s35, v14
    v_mov_b32 v15, v14
    s_nop 1
    v_permlane32_swap_b32 v14, v15
    v_add_f32 v14, v14, v15
    buffer_store_dword v14, v8, s[8:11], s45 offen sc1
    v_lshlrev_b32 v15, 7, v0
    s_lshl_b32 s6, s40, 2
    s_add_u32 s6, s6, s44
    s_add_u32 s6, s6, 32768
    v_mov_b32 v1, s76
    s_mov_b64 vcc, 0xff
    s_waitcnt vmcnt(0)
    s_barrier
    s_cmp_lg_u32 s3, 0
    s_cbranch_scc1 L_pub_25
    s_mov_b64 exec, vcc
    buffer_store_dword v1, v15, s[8:11], s6 offen sc1
L_pub_25:
    s_mov_b64 exec, -1
    s_lshl_b32 s7, s41, 2
    s_add_u32 s7, s7, s3
    s_mul_i32 s22, s7, 18432
    s_add_u32 s22, s22, s43
    s_add_u32 s22, s22, 45875200
    s_mul_i32 s24, s3, 18432
    s_lshl_b32 s25, s41, 12
    s_add_u32 s25, s25, s43
    s_add_u32 s25, s25, 48300032
    v_lshrrev_b32 v3, 5, v0
    v_and_b32 v10, 31, v0
    v_lshlrev_b32 v10, 2, v10
    v_lshl_add_u32 v3, v3, 11, v10
    v_add_u32 v11, 36864, v184
    s_mov_b32 s16, 0xffff0000
    s_lshl_b32 s7, s3, 10
    v_add_u32 v172, s7, v253
    v_add_u32 v174, 5120, v172
    v_and_b32 v178, 7, v0
    v_mul_u32_u24 v178, 1152, v178
    v_lshrrev_b32 v179, 3, v0
    v_lshl_add_u32 v178, v179, 4, v178
    s_lshl_b32 s7, s3, 7
    v_add_u32 v175, s7, v178
    v_add_u32 v177, 640, v175
    s_cmp_eq_u32 s3, 0
    s_mov_b32 s17, 1073741824
    s_cmov_b32 s17, 4096
    v_add_u32 v173, s17, v172
    s_mov_b32 s17, 1073741824
    s_cmov_b32 s17, 512
    v_add_u32 v176, s17, v175
    s_lshl_b32 s21, s41, 3
    s_add_u32 s21, s21, s40
    s_mul_i32 s18, s21, 9216
    s_mul_i32 s20, s21, 73728
    s_add_u32 s20, s20, 19922944
    v_bfe_u32 v1, v0, 3, 2
    s_mov_b32 s7, 73728
    v_mul_lo_u32 v178, v1, s7
    v_lshrrev_b32 v1, 5, v0
    v_lshl_add_u32 v178, v1, 7, v178
    v_and_b32 v1, 7, v0
    v_lshl_add_u32 v178, v1, 4, v178
    v_add_u32 v179, 294912, v178
    v_lshrrev_b32 v1, 5, v0
    v_and_b32 v15, 7, v0
    v_lshlrev_b32 v15, 4, v15
    v_lshl_add_u32 v15, v1, 7, v15
    s_lshl_b32 s7, s3, 8
    s_add_u32 s7, s7, 3072
    v_add_u32 v15, s7, v15
    v_bfe_u32 v1, v0, 3, 2
    v_mov_b32 v182, 1073741824
    v_add_u32 v183, 14336, v253
    s_sub_u32 s7, s40, 0
    v_cmp_eq_u32 vcc, s7, v1
    s_nop 1
    v_cndmask_b32 v178, v178, v182, vcc
    v_cndmask_b32 v216, v183, v15, vcc
    v_cndmask_b32 v218, 0, 1, vcc
    v_lshlrev_b32 v218, 10, v218
    s_sub_u32 s7, s40, 4
    v_cmp_eq_u32 vcc, s7, v1
    s_nop 1
    v_cndmask_b32 v179, v179, v182, vcc
    v_cndmask_b32 v217, v183, v15, vcc
    v_cndmask_b32 v219, 0, 1, vcc
    v_lshlrev_b32 v219, 10, v219
    s_mul_i32 s26, s41, 589824
    s_mul_i32 s7, s40, 9216
    s_add_u32 s26, s26, s7
    s_lshl_b32 s7, s3, 8
    s_add_u32 s27, s26, s7
    s_add_u32 s27, s27, 19921920
    s_mov_b32 s74, 0
    s_mul_i32 s7, s42, 98304
    s_sub_u32 s29, s44, s7
    s_add_u32 s29, s29, 360448
    s_lshl_b32 s7, s40, 7
    s_add_u32 s7, s7, s29
    s_add_u32 s38, s4, s7
    s_addc_u32 s39, s5, 0
    s_lshl_b32 s7, s40, 2
    s_add_u32 s29, s29, s7
    s_add_u32 s50, s23, 497664
    s_cmp_lg_u32 s42, 0
    s_cbranch_scc1 L_ring_26
    s_cmp_lg_u32 s3, 0
    s_cbranch_scc1 L_ring_27
    s_lshl_b32 s7, s41, 3
    s_add_u32 s7, s7, s40
    s_lshl_b32 s7, s7, 7
    s_add_u32 s7, s7, 19464192
    s_add_u32 s68, s4, s7
    s_addc_u32 s69, s5, 0
    s_mov_b32 s6, 0
    s_mov_b32 s7, 0
L_cpoll_28:
    s_load_dwordx16 s[52:67], s[68:69], s7 glc
    s_add_u32 s6, s6, 1
    s_waitcnt lgkmcnt(0)
    s_xor_b64 s[52:53], s[52:53], s[76:77]
    s_xor_b64 s[54:55], s[54:55], s[76:77]
    s_xor_b64 s[56:57], s[56:57], s[76:77]
    s_xor_b64 s[58:59], s[58:59], s[76:77]
    s_xor_b64 s[60:61], s[60:61], s[76:77]
    s_xor_b64 s[62:63], s[62:63], s[76:77]
    s_xor_b64 s[64:65], s[64:65], s[76:77]
    s_xor_b64 s[66:67], s[66:67], s[76:77]
    s_or_b64 s[52:53], s[52:53], s[60:61]
    s_or_b64 s[54:55], s[54:55], s[62:63]
    s_or_b64 s[56:57], s[56:57], s[64:65]
    s_or_b64 s[58:59], s[58:59], s[66:67]
    s_or_b64 s[52:53], s[52:53], s[56:57]
    s_or_b64 s[54:55], s[54:55], s[58:59]
    s_or_b64 s[52:53], s[52:53], s[54:55]
    s_cbranch_scc1 L_cpoll_29
    s_add_u32 s7, s7, 64
    s_cmp_eq_u32 s7, 128
    s_cbranch_scc1 L_cpolled_30
L_cpoll_29:
    s_cmp_lt_u32 s6, 1048576
    s_cbranch_scc1 L_cpoll_28
    s_branch L_main_end
L_cpolled_30:
L_ring_27:
    s_barrier
    buffer_load_dwordx4 v[16:19], v184, s[48:51], s23 offen offset:0 sc1
    buffer_load_dwordx4 v[20:23], v184, s[48:51], s23 offen offset:1024 sc1
    buffer_load_dwordx4 v[24:27], v184, s[48:51], s23 offen offset:2048 sc1
    buffer_load_dwordx4 v[28:31], v184, s[48:51], s23 offen offset:3072 sc1
    buffer_load_dwordx4 v[32:35], v185, s[48:51], s23 offen offset:0 sc1
    buffer_load_dwordx4 v[36:39], v185, s[48:51], s23 offen offset:1024 sc1
    buffer_load_dwordx4 v[40:43], v185, s[48:51], s23 offen offset:2048 sc1
    buffer_load_dwordx4 v[44:47], v185, s[48:51], s23 offen offset:3072 sc1
    buffer_load_dwordx4 v[48:51], v186, s[48:51], s23 offen offset:0 sc1
    buffer_load_dwordx4 v[52:55], v186, s[48:51], s23 offen offset:1024 sc1
    buffer_load_dwordx4 v[56:59], v186, s[48:51], s23 offen offset:2048 sc1
    buffer_load_dwordx4 v[60:63], v186, s[48:51], s23 offen offset:3072 sc1
    buffer_load_dwordx4 v[64:67], v187, s[48:51], s23 offen offset:0 sc1
    buffer_load_dwordx4 v[68:71], v187, s[48:51], s23 offen offset:1024 sc1
    buffer_load_dwordx4 v[72:75], v187, s[48:51], s23 offen offset:2048 sc1
L_ring_26:
    s_cmp_lg_u32 s3, 3
    s_cbranch_scc1 L_pollout_33
    s_lshl_b32 s7, s40, 7
    s_add_u32 s7, s7, s44
    s_add_u32 s7, s7, 32768
    s_add_u32 s52, s4, s7
    s_addc_u32 s53, s5, 0
    s_mov_b32 s6, 0
L_poll_31:
    s_load_dwordx8 s[56:63], s[52:53], 0 glc
    s_add_u32 s6, s6, 1
    s_waitcnt lgkmcnt(0)
    s_xor_b64 s[56:57], s[56:57], s[76:77]
    s_xor_b64 s[58:59], s[58:59], s[76:77]
    s_xor_b64 s[60:61], s[60:61], s[76:77]
    s_xor_b64 s[62:63], s[62:63], s[76:77]
    s_or_b64 s[56:57], s[56:57], s[58:59]
    s_or_b64 s[60:61], s[60:61], s[62:63]
    s_or_b64 s[56:57], s[56:57], s[60:61]
    s_cbranch_scc0 L_polled_32
    s_cmp_lt_u32 s6, 1048576
    s_cbranch_scc1 L_poll_31
    s_branch L_main_end
L_polled_32:
L_pollout_33:
    s_barrier
    s_add_u32 m0, s24, 0
    s_nop 0
    buffer_load_dwordx4 v2, s[8:11], s22 offen offset:0 sc1 lds
    s_add_u32 m0, s24, 512
    s_nop 0
    buffer_load_dwordx4 v2, s[8:11], s22 offen offset:512 sc1 lds
    s_add_u32 m0, s24, 1024
    s_nop 0
    buffer_load_dwordx4 v2, s[8:11], s22 offen offset:1024 sc1 lds
    s_add_u32 m0, s24, 1536
    s_nop 0
    buffer_load_dwordx4 v2, s[8:11], s22 offen offset:1536 sc1 lds
    s_add_u32 m0, s24, 2048
    s_nop 0
    buffer_load_dwordx4 v2, s[8:11], s22 offen offset:2048 sc1 lds
    s_add_u32 m0, s24, 2560
    s_nop 0
    buffer_load_dwordx4 v2, s[8:11], s22 offen offset:2560 sc1 lds
    s_add_u32 m0, s24, 3072
    s_nop 0
    buffer_load_dwordx4 v2, s[8:11], s22 offen offset:3072 sc1 lds
    s_add_u32 m0, s24, 3584
    s_nop 0
    buffer_load_dwordx4 v2, s[8:11], s22 offen offset:3584 sc1 lds
    s_add_u32 m0, s24, 8192
    s_add_u32 s22, s22, 4096
    buffer_load_dwordx4 v2, s[8:11], s22 offen offset:0 sc1 lds
    s_add_u32 m0, s24, 8704
    s_nop 0
    buffer_load_dwordx4 v2, s[8:11], s22 offen offset:512 sc1 lds
    s_add_u32 m0, s24, 9216
    s_nop 0
    buffer_load_dwordx4 v2, s[8:11], s22 offen offset:1024 sc1 lds
    s_add_u32 m0, s24, 9728
    s_nop 0
    buffer_load_dwordx4 v2, s[8:11], s22 offen offset:1536 sc1 lds
    s_add_u32 s23, s23, 15360
    s_lshr_b32 s7, s3, 1
    s_lshl_b32 s7, s7, 10
    s_and_b32 s6, s3, 1
    s_lshl_b32 s6, s6, 3
    s_add_u32 s28, s7, s6
    s_add_u32 s28, s28, 73728
    s_waitcnt vmcnt(6)
    s_barrier
    ds_read_b128 a[0:3], v184 offset:0
    ds_read_b128 a[72:75], v184 offset:18432
    ds_read_b128 a[144:147], v11 offset:0
    ds_read_b128 a[216:219], v11 offset:18432
    ds_read_b128 a[4:7], v184 offset:1024
    ds_read_b128 a[76:79], v184 offset:19456
    ds_read_b128 a[148:151], v11 offset:1024
    ds_read_b128 a[220:223], v11 offset:19456
    ds_read_b128 a[8:11], v184 offset:2048
    ds_read_b128 a[80:83], v184 offset:20480
    ds_read_b128 a[152:155], v11 offset:2048
    ds_read_b128 a[224:227], v11 offset:20480
    s_waitcnt vmcnt(24) lgkmcnt(0)
    v_mfma_f32_16x16x32_bf16 v[88:91], v[16:19], a[0:3], 0
    ds_read_b128 a[12:15], v184 offset:3072
    v_mfma_f32_16x16x32_bf16 v[88:91], v[20:23], a[4:7], v[88:91]
    buffer_load_dwordx4 v[76:79], v184, s[48:51], s23 offen offset:0 sc1
    v_mfma_f32_16x16x32_bf16 v[88:91], v[24:27], a[8:11], v[88:91]
    ds_read_b128 a[84:87], v184 offset:21504
    v_mfma_f32_16x16x32_bf16 v[92:95], v[16:19], a[72:75], 0
    s_add_u32 m0, s24, 10240
    s_nop 0
    buffer_load_dwordx4 v2, s[8:11], s22 offen offset:2048 sc1 lds
    v_mfma_f32_16x16x32_bf16 v[92:95], v[20:23], a[76:79], v[92:95]
    ds_read_b128 a[156:159], v11 offset:3072
    ds_read_b128 a[228:231], v11 offset:21504
    v_mfma_f32_16x16x32_bf16 v[92:95], v[24:27], a[80:83], v[92:95]
    buffer_load_dwordx4 v[80:83], v184, s[48:51], s23 offen offset:1024 sc1
    v_mfma_f32_16x16x32_bf16 v[96:99], v[16:19], a[144:147], 0
    ds_read_b128 a[16:19], v184 offset:4096
    v_mfma_f32_16x16x32_bf16 v[96:99], v[20:23], a[148:151], v[96:99]
    s_add_u32 m0, s24, 10752
    s_nop 0
    buffer_load_dwordx4 v2, s[8:11], s22 offen offset:2560 sc1 lds
    v_mfma_f32_16x16x32_bf16 v[96:99], v[24:27], a[152:155], v[96:99]
    ds_read_b128 a[88:91], v184 offset:22528
    v_mfma_f32_16x16x32_bf16 v[100:103], v[16:19], a[216:219], 0
    buffer_load_dwordx4 v[84:87], v184, s[48:51], s23 offen offset:2048 sc1
    v_mfma_f32_16x16x32_bf16 v[100:103], v[20:23], a[220:223], v[100:103]
    ds_read_b128 a[160:163], v11 offset:4096
    ds_read_b128 a[232:235], v11 offset:22528
    v_mfma_f32_16x16x32_bf16 v[100:103], v[24:27], a[224:227], v[100:103]
    s_add_u32 m0, s24, 11264
    s_nop 0
    buffer_load_dwordx4 v2, s[8:11], s22 offen offset:3072 sc1 lds
    s_waitcnt vmcnt(27) lgkmcnt(8)
    v_mfma_f32_16x16x32_bf16 v[104:107], v[28:31], a[0:3], 0
    ds_read_b128 a[20:23], v184 offset:5120
    v_mfma_f32_16x16x32_bf16 v[104:107], v[32:35], a[4:7], v[104:107]
    buffer_load_dwordx4 v[16:19], v184, s[48:51], s23 offen offset:3072 sc1
    v_mfma_f32_16x16x32_bf16 v[104:107], v[36:39], a[8:11], v[104:107]
    ds_read_b128 a[92:95], v184 offset:23552
    v_mfma_f32_16x16x32_bf16 v[108:111], v[28:31], a[72:75], 0
    s_add_u32 m0, s24, 11776
    s_nop 0
    buffer_load_dwordx4 v2, s[8:11], s22 offen offset:3584 sc1 lds
    v_mfma_f32_16x16x32_bf16 v[108:111], v[32:35], a[76:79], v[108:111]
    ds_read_b128 a[164:167], v11 offset:5120
    ds_read_b128 a[236:239], v11 offset:23552
    v_mfma_f32_16x16x32_bf16 v[108:111], v[36:39], a[80:83], v[108:111]
    buffer_load_dwordx4 v[20:23], v185, s[48:51], s23 offen offset:0 sc1
    v_mfma_f32_16x16x32_bf16 v[112:115], v[28:31], a[144:147], 0
    v_mfma_f32_16x16x32_bf16 v[112:115], v[32:35], a[148:151], v[112:115]
    s_add_u32 m0, s24, 16384
    s_add_u32 s22, s22, 4096
    buffer_load_dwordx4 v2, s[8:11], s22 offen offset:0 sc1 lds
    v_mfma_f32_16x16x32_bf16 v[112:115], v[36:39], a[152:155], v[112:115]
    v_mfma_f32_16x16x32_bf16 v[116:119], v[28:31], a[216:219], 0
    buffer_load_dwordx4 v[24:27], v185, s[48:51], s23 offen offset:1024 sc1
    v_mfma_f32_16x16x32_bf16 v[116:119], v[32:35], a[220:223], v[116:119]
    v_mfma_f32_16x16x32_bf16 v[116:119], v[36:39], a[224:227], v[116:119]
    s_add_u32 m0, s24, 16896
    s_nop 0
    buffer_load_dwordx4 v2, s[8:11], s22 offen offset:512 sc1 lds
    s_waitcnt vmcnt(12) lgkmcnt(0)
    s_barrier
    v_mfma_f32_16x16x32_bf16 v[88:91], v[40:43], a[12:15], v[88:91]
    ds_read_b128 a[24:27], v184 offset:6144
    v_mfma_f32_16x16x32_bf16 v[88:91], v[44:47], a[16:19], v[88:91]
    buffer_load_dwordx4 v[28:31], v185, s[48:51], s23 offen offset:2048 sc1
    v_mfma_f32_16x16x32_bf16 v[88:91], v[48:51], a[20:23], v[88:91]
    ds_read_b128 a[96:99], v184 offset:24576
    v_mfma_f32_16x16x32_bf16 v[92:95], v[40:43], a[84:87], v[92:95]
    buffer_load_dword v136, v3, s[8:11], s25 offen offset:0 sc1
    v_mfma_f32_16x16x32_bf16 v[92:95], v[44:47], a[88:91], v[92:95]
    ds_read_b128 a[168:171], v11 offset:6144
    ds_read_b128 a[240:243], v11 offset:24576
    v_mfma_f32_16x16x32_bf16 v[92:95], v[48:51], a[92:95], v[92:95]
    buffer_load_dwordx4 v[32:35], v185, s[48:51], s23 offen offset:3072 sc1
    v_mfma_f32_16x16x32_bf16 v[96:99], v[40:43], a[156:159], v[96:99]
    buffer_load_dword v137, v3, s[8:11], s25 offen offset:128 sc1
    v_mfma_f32_16x16x32_bf16 v[96:99], v[44:47], a[160:163], v[96:99]
    buffer_load_dword v138, v3, s[8:11], s25 offen offset:256 sc1
    v_mfma_f32_16x16x32_bf16 v[96:99], v[48:51], a[164:167], v[96:99]
    ds_read_b128 a[28:31], v184 offset:7168
    ds_read_b128 a[100:103], v184 offset:25600
    v_mfma_f32_16x16x32_bf16 v[100:103], v[40:43], a[228:231], v[100:103]
    buffer_load_dwordx4 v[36:39], v186, s[48:51], s23 offen offset:0 sc1
    v_mfma_f32_16x16x32_bf16 v[100:103], v[44:47], a[232:235], v[100:103]
    buffer_load_dword v139, v3, s[8:11], s25 offen offset:384 sc1
    v_mfma_f32_16x16x32_bf16 v[100:103], v[48:51], a[236:239], v[100:103]
    buffer_load_dword v140, v3, s[8:11], s25 offen offset:512 sc1
    s_waitcnt vmcnt(35) lgkmcnt(6)
    v_mfma_f32_16x16x32_bf16 v[104:107], v[52:55], a[12:15], v[104:107]
    ds_read_b128 a[172:175], v11 offset:7168
    ds_read_b128 a[244:247], v11 offset:25600
    v_mfma_f32_16x16x32_bf16 v[104:107], v[56:59], a[16:19], v[104:107]
    buffer_load_dwordx4 v[40:43], v186, s[48:51], s23 offen offset:1024 sc1
    v_mfma_f32_16x16x32_bf16 v[104:107], v[60:63], a[20:23], v[104:107]
    ds_read_b128 a[32:35], v184 offset:8192
    ds_read_b128 a[104:107], v184 offset:26624
    v_mfma_f32_16x16x32_bf16 v[108:111], v[52:55], a[84:87], v[108:111]
    buffer_load_dword v141, v3, s[8:11], s25 offen offset:640 sc1
    v_mfma_f32_16x16x32_bf16 v[108:111], v[56:59], a[88:91], v[108:111]
    ds_read_b128 a[176:179], v11 offset:8192
    ds_read_b128 a[248:251], v11 offset:26624
    v_mfma_f32_16x16x32_bf16 v[108:111], v[60:63], a[92:95], v[108:111]
    buffer_load_dwordx4 v[44:47], v186, s[48:51], s23 offen offset:2048 sc1
    v_mfma_f32_16x16x32_bf16 v[112:115], v[52:55], a[156:159], v[112:115]
    buffer_load_dword v142, v3, s[8:11], s25 offen offset:768 sc1
    v_mfma_f32_16x16x32_bf16 v[112:115], v[56:59], a[160:163], v[112:115]
    buffer_load_dword v143, v3, s[8:11], s25 offen offset:896 sc1
    v_mfma_f32_16x16x32_bf16 v[112:115], v[60:63], a[164:167], v[112:115]
    v_mfma_f32_16x16x32_bf16 v[116:119], v[52:55], a[228:231], v[116:119]
    buffer_load_dwordx4 v[48:51], v186, s[48:51], s23 offen offset:3072 sc1
    v_mfma_f32_16x16x32_bf16 v[116:119], v[56:59], a[232:235], v[116:119]
    buffer_load_dword v144, v3, s[8:11], s25 offen offset:1024 sc1
    v_mfma_f32_16x16x32_bf16 v[116:119], v[60:63], a[236:239], v[116:119]
    buffer_load_dword v145, v3, s[8:11], s25 offen offset:1152 sc1
    s_waitcnt vmcnt(40) lgkmcnt(0)
    v_mfma_f32_16x16x32_bf16 v[88:91], v[64:67], a[24:27], v[88:91]
    ds_read_b128 a[36:39], v184 offset:9216
    v_mfma_f32_16x16x32_bf16 v[88:91], v[68:71], a[28:31], v[88:91]
    buffer_load_dwordx4 v[52:55], v187, s[48:51], s23 offen offset:0 sc1
    v_mfma_f32_16x16x32_bf16 v[88:91], v[72:75], a[32:35], v[88:91]
    ds_read_b128 a[108:111], v184 offset:27648
    v_mfma_f32_16x16x32_bf16 v[92:95], v[64:67], a[96:99], v[92:95]
    buffer_load_dword v146, v3, s[8:11], s25 offen offset:1280 sc1
    v_mfma_f32_16x16x32_bf16 v[92:95], v[68:71], a[100:103], v[92:95]
    ds_read_b128 a[180:183], v11 offset:9216
    ds_read_b128 a[252:255], v11 offset:27648
    v_mfma_f32_16x16x32_bf16 v[92:95], v[72:75], a[104:107], v[92:95]
    buffer_load_dwordx4 v[56:59], v187, s[48:51], s23 offen offset:1024 sc1
    v_mfma_f32_16x16x32_bf16 v[96:99], v[64:67], a[168:171], v[96:99]
    buffer_load_dword v147, v3, s[8:11], s25 offen offset:1408 sc1
    v_mfma_f32_16x16x32_bf16 v[96:99], v[68:71], a[172:175], v[96:99]
    buffer_load_dword v148, v3, s[8:11], s25 offen offset:1536 sc1
    v_mfma_f32_16x16x32_bf16 v[96:99], v[72:75], a[176:179], v[96:99]
    ds_read_b128 a[40:43], v184 offset:10240
    ds_read_b128 a[112:115], v184 offset:28672
    v_mfma_f32_16x16x32_bf16 v[100:103], v[64:67], a[240:243], v[100:103]
    buffer_load_dwordx4 v[60:63], v187, s[48:51], s23 offen offset:2048 sc1
    v_mfma_f32_16x16x32_bf16 v[100:103], v[68:71], a[244:247], v[100:103]
    buffer_load_dword v149, v3, s[8:11], s25 offen offset:1664 sc1
    v_mfma_f32_16x16x32_bf16 v[100:103], v[72:75], a[248:251], v[100:103]
    buffer_load_dword v150, v3, s[8:11], s25 offen offset:1792 sc1
    s_waitcnt vmcnt(31) lgkmcnt(6)
    v_mfma_f32_16x16x32_bf16 v[104:107], v[76:79], a[24:27], v[104:107]
    ds_read_b128 a[184:187], v11 offset:10240
    ds_read_b128 v[220:223], v11 offset:28672
    v_mfma_f32_16x16x32_bf16 v[104:107], v[80:83], a[28:31], v[104:107]
    buffer_load_dwordx4 v[64:67], v187, s[48:51], s23 offen offset:3072 sc1
    v_mfma_f32_16x16x32_bf16 v[104:107], v[84:87], a[32:35], v[104:107]
    ds_read_b128 a[44:47], v184 offset:11264
    ds_read_b128 a[116:119], v184 offset:29696
    v_mfma_f32_16x16x32_bf16 v[108:111], v[76:79], a[96:99], v[108:111]
    buffer_load_dword v151, v3, s[8:11], s25 offen offset:1920 sc1
    v_mfma_f32_16x16x32_bf16 v[108:111], v[80:83], a[100:103], v[108:111]
    ds_read_b128 a[188:191], v11 offset:11264
    ds_read_b128 v[224:227], v11 offset:29696
    v_mfma_f32_16x16x32_bf16 v[108:111], v[84:87], a[104:107], v[108:111]
    buffer_load_dwordx4 v[68:71], v188, s[48:51], s23 offen offset:0 sc1
    v_mfma_f32_16x16x32_bf16 v[112:115], v[76:79], a[168:171], v[112:115]
    v_mfma_f32_16x16x32_bf16 v[112:115], v[80:83], a[172:175], v[112:115]
    v_mfma_f32_16x16x32_bf16 v[112:115], v[84:87], a[176:179], v[112:115]
    v_mfma_f32_16x16x32_bf16 v[116:119], v[76:79], a[240:243], v[116:119]
    buffer_load_dwordx4 v[72:75], v188, s[48:51], s23 offen offset:1024 sc1
    v_mfma_f32_16x16x32_bf16 v[116:119], v[80:83], a[244:247], v[116:119]
    v_mfma_f32_16x16x32_bf16 v[116:119], v[84:87], a[248:251], v[116:119]
    s_waitcnt vmcnt(28) lgkmcnt(0)
    s_barrier
    v_mfma_f32_16x16x32_bf16 v[88:91], v[16:19], a[36:39], v[88:91]
    ds_read_b128 a[48:51], v184 offset:12288
    v_mfma_f32_16x16x32_bf16 v[88:91], v[20:23], a[40:43], v[88:91]
    buffer_load_dwordx4 v[76:79], v188, s[48:51], s23 offen offset:2048 sc1
    v_mfma_f32_16x16x32_bf16 v[88:91], v[24:27], a[44:47], v[88:91]
    ds_read_b128 a[120:123], v184 offset:30720
    v_mfma_f32_16x16x32_bf16 v[92:95], v[16:19], a[108:111], v[92:95]
    ds_read_b128 a[192:195], v11 offset:12288
    v_mfma_f32_16x16x32_bf16 v[92:95], v[20:23], a[112:115], v[92:95]
    ds_read_b128 v[228:231], v11 offset:30720
    v_mfma_f32_16x16x32_bf16 v[92:95], v[24:27], a[116:119], v[92:95]
    buffer_load_dwordx4 v[80:83], v188, s[48:51], s23 offen offset:3072 sc1
    v_mfma_f32_16x16x32_bf16 v[96:99], v[16:19], a[180:183], v[96:99]
    ds_read_b128 a[52:55], v184 offset:13312
    v_mfma_f32_16x16x32_bf16 v[96:99], v[20:23], a[184:187], v[96:99]
    ds_read_b128 a[124:127], v184 offset:31744
    v_mfma_f32_16x16x32_bf16 v[96:99], v[24:27], a[188:191], v[96:99]
    v_mfma_f32_16x16x32_bf16 v[100:103], v[16:19], a[252:255], v[100:103]
    buffer_load_dwordx4 v[84:87], v189, s[48:51], s23 offen offset:0 sc1
    v_mfma_f32_16x16x32_bf16 v[100:103], v[20:23], v[220:223], v[100:103]
    ds_read_b128 a[196:199], v11 offset:13312
    ds_read_b128 v[232:235], v11 offset:31744
    v_mfma_f32_16x16x32_bf16 v[100:103], v[24:27], v[224:227], v[100:103]
    s_waitcnt vmcnt(25) lgkmcnt(8)
    v_mfma_f32_16x16x32_bf16 v[104:107], v[28:31], a[36:39], v[104:107]
    ds_read_b128 a[56:59], v184 offset:14336
    v_mfma_f32_16x16x32_bf16 v[104:107], v[32:35], a[40:43], v[104:107]
    buffer_load_dwordx4 v[16:19], v189, s[48:51], s23 offen offset:1024 sc1
    v_mfma_f32_16x16x32_bf16 v[104:107], v[36:39], a[44:47], v[104:107]
    ds_read_b128 a[128:131], v184 offset:32768
    v_mfma_f32_16x16x32_bf16 v[108:111], v[28:31], a[108:111], v[108:111]
    ds_read_b128 a[200:203], v11 offset:14336
    v_mfma_f32_16x16x32_bf16 v[108:111], v[32:35], a[112:115], v[108:111]
    ds_read_b128 v[236:239], v11 offset:32768
    v_mfma_f32_16x16x32_bf16 v[108:111], v[36:39], a[116:119], v[108:111]
    buffer_load_dwordx4 v[20:23], v189, s[48:51], s23 offen offset:2048 sc1
    v_mfma_f32_16x16x32_bf16 v[112:115], v[28:31], a[180:183], v[112:115]
    v_mfma_f32_16x16x32_bf16 v[112:115], v[32:35], a[184:187], v[112:115]
    v_mfma_f32_16x16x32_bf16 v[112:115], v[36:39], a[188:191], v[112:115]
    v_mfma_f32_16x16x32_bf16 v[116:119], v[28:31], a[252:255], v[116:119]
    buffer_load_dwordx4 v[24:27], v189, s[48:51], s23 offen offset:3072 sc1
    v_mfma_f32_16x16x32_bf16 v[116:119], v[32:35], v[220:223], v[116:119]
    v_mfma_f32_16x16x32_bf16 v[116:119], v[36:39], v[224:227], v[116:119]
    s_waitcnt vmcnt(8) lgkmcnt(0)
    v_mfma_f32_16x16x32_bf16 v[88:91], v[40:43], a[48:51], v[88:91]
    ds_read_b128 a[60:63], v184 offset:15360
    v_add_f32 v136, v136, v144
    v_mfma_f32_16x16x32_bf16 v[88:91], v[44:47], a[52:55], v[88:91]
    buffer_load_dwordx4 v[28:31], v190, s[48:51], s23 offen offset:0 sc1
    v_mfma_f32_16x16x32_bf16 v[88:91], v[48:51], a[56:59], v[88:91]
    ds_read_b128 a[132:135], v184 offset:33792
    v_add_f32 v137, v137, v145
    v_mfma_f32_16x16x32_bf16 v[92:95], v[40:43], a[120:123], v[92:95]
    ds_read_b128 a[204:207], v11 offset:15360
    v_add_f32 v138, v138, v146
    v_mfma_f32_16x16x32_bf16 v[92:95], v[44:47], a[124:127], v[92:95]
    ds_read_b128 v[240:243], v11 offset:33792
    v_add_f32 v139, v139, v147
    v_mfma_f32_16x16x32_bf16 v[92:95], v[48:51], a[128:131], v[92:95]
    buffer_load_dwordx4 v[32:35], v190, s[48:51], s23 offen offset:1024 sc1
    v_mfma_f32_16x16x32_bf16 v[96:99], v[40:43], a[192:195], v[96:99]
    ds_read_b128 a[64:67], v184 offset:16384
    v_add_f32 v140, v140, v148
    v_mfma_f32_16x16x32_bf16 v[96:99], v[44:47], a[196:199], v[96:99]
    ds_read_b128 a[136:139], v184 offset:34816
    v_add_f32 v141, v141, v149
    v_mfma_f32_16x16x32_bf16 v[96:99], v[48:51], a[200:203], v[96:99]
    v_add_f32 v142, v142, v150
    v_add_f32 v143, v143, v151
    v_mfma_f32_16x16x32_bf16 v[100:103], v[40:43], v[228:231], v[100:103]
    buffer_load_dwordx4 v[36:39], v190, s[48:51], s23 offen offset:2048 sc1
    v_mfma_f32_16x16x32_bf16 v[100:103], v[44:47], v[232:235], v[100:103]
    ds_read_b128 a[208:211], v11 offset:16384
    ds_read_b128 v[244:247], v11 offset:34816
    v_mfma_f32_16x16x32_bf16 v[100:103], v[48:51], v[236:239], v[100:103]
    v_add_f32 v136, v136, v140
    v_add_f32 v137, v137, v141
    s_waitcnt vmcnt(15) lgkmcnt(8)
    v_mfma_f32_16x16x32_bf16 v[104:107], v[52:55], a[48:51], v[104:107]
    ds_read_b128 a[68:71], v184 offset:17408
    v_add_f32 v138, v138, v142
    v_mfma_f32_16x16x32_bf16 v[104:107], v[56:59], a[52:55], v[104:107]
    buffer_load_dwordx4 v[40:43], v190, s[48:51], s23 offen offset:3072 sc1
    v_mfma_f32_16x16x32_bf16 v[104:107], v[60:63], a[56:59], v[104:107]
    ds_read_b128 a[140:143], v184 offset:35840
    v_add_f32 v139, v139, v143
    v_mfma_f32_16x16x32_bf16 v[108:111], v[52:55], a[120:123], v[108:111]
    ds_read_b128 a[212:215], v11 offset:17408
    v_add_f32 v136, v136, v138
    v_mfma_f32_16x16x32_bf16 v[108:111], v[56:59], a[124:127], v[108:111]
    ds_read_b128 v[248:251], v11 offset:35840
    v_add_f32 v137, v137, v139
    v_mfma_f32_16x16x32_bf16 v[108:111], v[60:63], a[128:131], v[108:111]
    buffer_load_dwordx4 v[44:47], v191, s[48:51], s23 offen offset:0 sc1
    v_mfma_f32_16x16x32_bf16 v[112:115], v[52:55], a[192:195], v[112:115]
    v_add_f32 v136, v136, v137
    v_mov_b32 v137, 0x3727c5ac
    v_mfma_f32_16x16x32_bf16 v[112:115], v[56:59], a[196:199], v[112:115]
    v_fmac_f32 v137, 0x3ae38e39, v136
    v_mov_b32 v193, v137
    v_mfma_f32_16x16x32_bf16 v[112:115], v[60:63], a[200:203], v[112:115]
    s_nop 0
    v_permlane16_swap_b32 v193, v137
    v_mfma_f32_16x16x32_bf16 v[116:119], v[52:55], v[228:231], v[116:119]
    buffer_load_dwordx4 v[48:51], v191, s[48:51], s23 offen offset:1024 sc1
    v_mfma_f32_16x16x32_bf16 v[116:119], v[56:59], v[232:235], v[116:119]
    v_mov_b32 v195, v193
    v_mov_b32 v194, v137
    v_mfma_f32_16x16x32_bf16 v[116:119], v[60:63], v[236:239], v[116:119]
    v_mov_b32 v252, v137
    s_waitcnt vmcnt(12) lgkmcnt(0)
    v_mfma_f32_16x16x32_bf16 v[88:91], v[64:67], a[60:63], v[88:91]
    s_nop 0
    v_permlane32_swap_b32 v193, v195
    v_mfma_f32_16x16x32_bf16 v[88:91], v[68:71], a[64:67], v[88:91]
    buffer_load_dwordx4 v[52:55], v191, s[48:51], s23 offen offset:2048 sc1
    v_mfma_f32_16x16x32_bf16 v[120:123], v[72:75], a[68:71], v[88:91]
    v_permlane32_swap_b32 v194, v252
    v_mfma_f32_16x16x32_bf16 v[92:95], v[64:67], a[132:135], v[92:95]
    v_rsq_f32 v4, v193
    v_mfma_f32_16x16x32_bf16 v[92:95], v[68:71], a[136:139], v[92:95]
    v_rsq_f32 v5, v194
    v_mfma_f32_16x16x32_bf16 v[124:127], v[72:75], a[140:143], v[92:95]
    buffer_load_dwordx4 v[56:59], v191, s[48:51], s23 offen offset:3072 sc1
    v_mfma_f32_16x16x32_bf16 v[96:99], v[64:67], a[204:207], v[96:99]
    v_rsq_f32 v6, v195
    v_mfma_f32_16x16x32_bf16 v[96:99], v[68:71], a[208:211], v[96:99]
    v_rsq_f32 v7, v252
    v_mfma_f32_16x16x32_bf16 v[128:131], v[72:75], a[212:215], v[96:99]
    v_mul_f32 v8, v4, v4
    v_mul_f32 v9, v5, v5
    v_mfma_f32_16x16x32_bf16 v[100:103], v[64:67], v[240:243], v[100:103]
    buffer_load_dwordx4 v[60:63], v192, s[48:51], s23 offen offset:0 sc1
    v_mfma_f32_16x16x32_bf16 v[100:103], v[68:71], v[244:247], v[100:103]
    v_mul_f32 v13, v6, v6
    v_mul_f32 v14, v7, v7
    v_mfma_f32_16x16x32_bf16 v[132:135], v[72:75], v[248:251], v[100:103]
    v_mul_f32 v4, 0xc0135761, v4
    v_mul_f32 v5, 0xc0135761, v5
    s_waitcnt vmcnt(12) lgkmcnt(0)
    v_mfma_f32_16x16x32_bf16 v[104:107], v[76:79], a[60:63], v[104:107]
    v_mul_f32 v6, 0xc0135761, v6
    v_mul_f32 v7, 0xc0135761, v7
    v_mfma_f32_16x16x32_bf16 v[104:107], v[80:83], a[64:67], v[104:107]
    buffer_load_dwordx4 v[64:67], v192, s[48:51], s23 offen offset:1024 sc1
    v_mfma_f32_16x16x32_bf16 v[136:139], v[84:87], a[68:71], v[104:107]
    v_mul_f32 v8, 0x3d372713, v8
    v_mul_f32 v9, 0x3d372713, v9
    v_mfma_f32_16x16x32_bf16 v[108:111], v[76:79], a[132:135], v[108:111]
    v_mul_f32 v13, 0x3d372713, v13
    v_mul_f32 v14, 0x3d372713, v14
    v_mfma_f32_16x16x32_bf16 v[108:111], v[80:83], a[136:139], v[108:111]
    v_mul_f32 v8, v8, v4
    v_mul_f32 v9, v9, v5
    v_mfma_f32_16x16x32_bf16 v[140:143], v[84:87], a[140:143], v[108:111]
    buffer_load_dwordx4 v[68:71], v192, s[48:51], s23 offen offset:2048 sc1
    v_mfma_f32_16x16x32_bf16 v[112:115], v[76:79], a[204:207], v[112:115]
    v_mul_f32 v13, v13, v6
    v_mul_f32 v14, v14, v7
    v_mfma_f32_16x16x32_bf16 v[112:115], v[80:83], a[208:211], v[112:115]
    s_mov_b32 s25, 0
    v_mfma_f32_16x16x32_bf16 v[144:147], v[84:87], a[212:215], v[112:115]
    s_mov_b32 s7, s28
    v_mfma_f32_16x16x32_bf16 v[116:119], v[76:79], v[240:243], v[116:119]
    buffer_load_dwordx4 v[72:75], v192, s[48:51], s23 offen offset:3072 sc1
    v_mfma_f32_16x16x32_bf16 v[116:119], v[80:83], v[244:247], v[116:119]
    s_add_u32 s23, s23, 36864
    v_mfma_f32_16x16x32_bf16 v[148:151], v[84:87], v[248:251], v[116:119]
    v_add_u32 v12, s7, v184
    s_add_u32 s25, s25, 1
L_ffn_gu_34:
    s_waitcnt vmcnt(12)
    v_mfma_f32_16x16x32_bf16 v[88:91], v[16:19], a[0:3], 0
    v_mfma_f32_16x16x32_bf16 v[88:91], v[20:23], a[4:7], v[88:91]
    buffer_load_dwordx4 v[76:79], v184, s[48:51], s23 offen offset:0 sc1
    v_mfma_f32_16x16x32_bf16 v[88:91], v[24:27], a[8:11], v[88:91]
    v_mul_f32 v152, v120, v120
    v_mul_f32 v153, v121, v121
    v_mfma_f32_16x16x32_bf16 v[92:95], v[16:19], a[72:75], 0
    v_mul_f32 v154, v122, v122
    v_mul_f32 v155, v123, v123
    v_mfma_f32_16x16x32_bf16 v[92:95], v[20:23], a[76:79], v[92:95]
    v_fma_f32 v152, v152, v8, v4
    v_fma_f32 v153, v153, v8, v4
    v_mfma_f32_16x16x32_bf16 v[92:95], v[24:27], a[80:83], v[92:95]
    buffer_load_dwordx4 v[80:83], v184, s[48:51], s23 offen offset:1024 sc1
    v_mfma_f32_16x16x32_bf16 v[96:99], v[16:19], a[144:147], 0
    v_fma_f32 v154, v154, v8, v4
    v_fma_f32 v155, v155, v8, v4
    v_mfma_f32_16x16x32_bf16 v[96:99], v[20:23], a[148:151], v[96:99]
    v_mul_f32 v152, v120, v152
    v_mul_f32 v153, v121, v153
    v_mfma_f32_16x16x32_bf16 v[96:99], v[24:27], a[152:155], v[96:99]
    v_mul_f32 v154, v122, v154
    v_mul_f32 v155, v123, v155
    v_mfma_f32_16x16x32_bf16 v[100:103], v[16:19], a[216:219], 0
    buffer_load_dwordx4 v[84:87], v184, s[48:51], s23 offen offset:2048 sc1
    v_mfma_f32_16x16x32_bf16 v[100:103], v[20:23], a[220:223], v[100:103]
    v_exp_f32 v152, v152
    v_mfma_f32_16x16x32_bf16 v[100:103], v[24:27], a[224:227], v[100:103]
    v_exp_f32 v153, v153
    s_waitcnt vmcnt(12)
    v_mfma_f32_16x16x32_bf16 v[104:107], v[28:31], a[0:3], 0
    v_exp_f32 v154, v154
    v_mfma_f32_16x16x32_bf16 v[104:107], v[32:35], a[4:7], v[104:107]
    buffer_load_dwordx4 v[16:19], v184, s[48:51], s23 offen offset:3072 sc1
    v_mfma_f32_16x16x32_bf16 v[104:107], v[36:39], a[8:11], v[104:107]
    v_exp_f32 v155, v155
    v_mfma_f32_16x16x32_bf16 v[108:111], v[28:31], a[72:75], 0
    v_mul_f32 v156, v120, v136
    v_mul_f32 v157, v121, v137
    v_mfma_f32_16x16x32_bf16 v[108:111], v[32:35], a[76:79], v[108:111]
    v_mul_f32 v158, v122, v138
    v_mul_f32 v159, v123, v139
    v_mfma_f32_16x16x32_bf16 v[108:111], v[36:39], a[80:83], v[108:111]
    buffer_load_dwordx4 v[20:23], v185, s[48:51], s23 offen offset:0 sc1
    v_mfma_f32_16x16x32_bf16 v[112:115], v[28:31], a[144:147], 0
    v_fma_f32 v152, v152, v193, v193
    v_fma_f32 v153, v153, v193, v193
    v_mfma_f32_16x16x32_bf16 v[112:115], v[32:35], a[148:151], v[112:115]
    v_fma_f32 v154, v154, v193, v193
    v_fma_f32 v155, v155, v193, v193
    v_mfma_f32_16x16x32_bf16 v[112:115], v[36:39], a[152:155], v[112:115]
    v_rcp_f32 v152, v152
    v_mfma_f32_16x16x32_bf16 v[116:119], v[28:31], a[216:219], 0
    buffer_load_dwordx4 v[24:27], v185, s[48:51], s23 offen offset:1024 sc1
    v_mfma_f32_16x16x32_bf16 v[116:119], v[32:35], a[220:223], v[116:119]
    v_rcp_f32 v153, v153
    v_mfma_f32_16x16x32_bf16 v[116:119], v[36:39], a[224:227], v[116:119]
    v_rcp_f32 v154, v154
    s_waitcnt vmcnt(12)
    v_mfma_f32_16x16x32_bf16 v[88:91], v[40:43], a[12:15], v[88:91]
    v_rcp_f32 v155, v155
    v_mfma_f32_16x16x32_bf16 v[88:91], v[44:47], a[16:19], v[88:91]
    buffer_load_dwordx4 v[28:31], v185, s[48:51], s23 offen offset:2048 sc1
    v_mfma_f32_16x16x32_bf16 v[88:91], v[48:51], a[20:23], v[88:91]
    v_mul_f32 v156, v156, v152
    v_mul_f32 v157, v157, v153
    v_mfma_f32_16x16x32_bf16 v[92:95], v[40:43], a[84:87], v[92:95]
    v_mul_f32 v158, v158, v154
    v_mul_f32 v159, v159, v155
    v_mfma_f32_16x16x32_bf16 v[92:95], v[44:47], a[88:91], v[92:95]
    v_cvt_pk_bf16_f32 v160, v156, v157
    v_cvt_pk_bf16_f32 v161, v158, v159
    v_mfma_f32_16x16x32_bf16 v[92:95], v[48:51], a[92:95], v[92:95]
    buffer_load_dwordx4 v[32:35], v185, s[48:51], s23 offen offset:3072 sc1
    v_mfma_f32_16x16x32_bf16 v[96:99], v[40:43], a[156:159], v[96:99]
    ds_write_b64 v12, v[160:161] offset:0
    v_mfma_f32_16x16x32_bf16 v[96:99], v[44:47], a[160:163], v[96:99]
    v_mul_f32 v162, v124, v124
    v_mul_f32 v163, v125, v125
    v_mfma_f32_16x16x32_bf16 v[96:99], v[48:51], a[164:167], v[96:99]
    v_mul_f32 v164, v126, v126
    v_mul_f32 v165, v127, v127
    v_mfma_f32_16x16x32_bf16 v[100:103], v[40:43], a[228:231], v[100:103]
    buffer_load_dwordx4 v[36:39], v186, s[48:51], s23 offen offset:0 sc1
    v_mfma_f32_16x16x32_bf16 v[100:103], v[44:47], a[232:235], v[100:103]
    v_fma_f32 v162, v162, v9, v5
    v_fma_f32 v163, v163, v9, v5
    v_mfma_f32_16x16x32_bf16 v[100:103], v[48:51], a[236:239], v[100:103]
    v_fma_f32 v164, v164, v9, v5
    v_fma_f32 v165, v165, v9, v5
    s_waitcnt vmcnt(12)
    v_mfma_f32_16x16x32_bf16 v[104:107], v[52:55], a[12:15], v[104:107]
    v_mul_f32 v162, v124, v162
    v_mul_f32 v163, v125, v163
    v_mfma_f32_16x16x32_bf16 v[104:107], v[56:59], a[16:19], v[104:107]
    buffer_load_dwordx4 v[40:43], v186, s[48:51], s23 offen offset:1024 sc1
    v_mfma_f32_16x16x32_bf16 v[104:107], v[60:63], a[20:23], v[104:107]
    v_mul_f32 v164, v126, v164
    v_mul_f32 v165, v127, v165
    v_mfma_f32_16x16x32_bf16 v[108:111], v[52:55], a[84:87], v[108:111]
    v_exp_f32 v162, v162
    v_mfma_f32_16x16x32_bf16 v[108:111], v[56:59], a[88:91], v[108:111]
    v_exp_f32 v163, v163
    v_mfma_f32_16x16x32_bf16 v[108:111], v[60:63], a[92:95], v[108:111]
    buffer_load_dwordx4 v[44:47], v186, s[48:51], s23 offen offset:2048 sc1
    v_mfma_f32_16x16x32_bf16 v[112:115], v[52:55], a[156:159], v[112:115]
    v_exp_f32 v164, v164
    v_mfma_f32_16x16x32_bf16 v[112:115], v[56:59], a[160:163], v[112:115]
    v_exp_f32 v165, v165
    v_mfma_f32_16x16x32_bf16 v[112:115], v[60:63], a[164:167], v[112:115]
    v_mul_f32 v166, v124, v140
    v_mul_f32 v167, v125, v141
    v_mfma_f32_16x16x32_bf16 v[116:119], v[52:55], a[228:231], v[116:119]
    buffer_load_dwordx4 v[48:51], v186, s[48:51], s23 offen offset:3072 sc1
    v_mfma_f32_16x16x32_bf16 v[116:119], v[56:59], a[232:235], v[116:119]
    v_mul_f32 v168, v126, v142
    v_mul_f32 v169, v127, v143
    v_mfma_f32_16x16x32_bf16 v[116:119], v[60:63], a[236:239], v[116:119]
    v_fma_f32 v162, v162, v194, v194
    v_fma_f32 v163, v163, v194, v194
    s_waitcnt vmcnt(12)
    v_mfma_f32_16x16x32_bf16 v[88:91], v[64:67], a[24:27], v[88:91]
    v_fma_f32 v164, v164, v194, v194
    v_fma_f32 v165, v165, v194, v194
    v_mfma_f32_16x16x32_bf16 v[88:91], v[68:71], a[28:31], v[88:91]
    buffer_load_dwordx4 v[52:55], v187, s[48:51], s23 offen offset:0 sc1
    v_mfma_f32_16x16x32_bf16 v[88:91], v[72:75], a[32:35], v[88:91]
    v_rcp_f32 v162, v162
    v_mfma_f32_16x16x32_bf16 v[92:95], v[64:67], a[96:99], v[92:95]
    v_rcp_f32 v163, v163
    v_mfma_f32_16x16x32_bf16 v[92:95], v[68:71], a[100:103], v[92:95]
    v_rcp_f32 v164, v164
    v_mfma_f32_16x16x32_bf16 v[92:95], v[72:75], a[104:107], v[92:95]
    buffer_load_dwordx4 v[56:59], v187, s[48:51], s23 offen offset:1024 sc1
    v_mfma_f32_16x16x32_bf16 v[96:99], v[64:67], a[168:171], v[96:99]
    v_rcp_f32 v165, v165
    v_mfma_f32_16x16x32_bf16 v[96:99], v[68:71], a[172:175], v[96:99]
    v_mul_f32 v166, v166, v162
    v_mul_f32 v167, v167, v163
    v_mfma_f32_16x16x32_bf16 v[96:99], v[72:75], a[176:179], v[96:99]
    v_mul_f32 v168, v168, v164
    v_mul_f32 v169, v169, v165
    v_mfma_f32_16x16x32_bf16 v[100:103], v[64:67], a[240:243], v[100:103]
    buffer_load_dwordx4 v[60:63], v187, s[48:51], s23 offen offset:2048 sc1
    v_mfma_f32_16x16x32_bf16 v[100:103], v[68:71], a[244:247], v[100:103]
    v_cvt_pk_bf16_f32 v170, v166, v167
    v_cvt_pk_bf16_f32 v171, v168, v169
    v_mfma_f32_16x16x32_bf16 v[100:103], v[72:75], a[248:251], v[100:103]
    ds_write_b64 v12, v[170:171] offset:18432
    s_waitcnt vmcnt(12)
    v_mfma_f32_16x16x32_bf16 v[104:107], v[76:79], a[24:27], v[104:107]
    v_mul_f32 v152, v128, v128
    v_mul_f32 v153, v129, v129
    v_mfma_f32_16x16x32_bf16 v[104:107], v[80:83], a[28:31], v[104:107]
    buffer_load_dwordx4 v[64:67], v187, s[48:51], s23 offen offset:3072 sc1
    v_mfma_f32_16x16x32_bf16 v[104:107], v[84:87], a[32:35], v[104:107]
    v_mul_f32 v154, v130, v130
    v_mul_f32 v155, v131, v131
    v_mfma_f32_16x16x32_bf16 v[108:111], v[76:79], a[96:99], v[108:111]
    v_fma_f32 v152, v152, v13, v6
    v_fma_f32 v153, v153, v13, v6
    v_mfma_f32_16x16x32_bf16 v[108:111], v[80:83], a[100:103], v[108:111]
    v_fma_f32 v154, v154, v13, v6
    v_fma_f32 v155, v155, v13, v6
    v_mfma_f32_16x16x32_bf16 v[108:111], v[84:87], a[104:107], v[108:111]
    buffer_load_dwordx4 v[68:71], v188, s[48:51], s23 offen offset:0 sc1
    v_mfma_f32_16x16x32_bf16 v[112:115], v[76:79], a[168:171], v[112:115]
    v_mul_f32 v152, v128, v152
    v_mul_f32 v153, v129, v153
    v_mfma_f32_16x16x32_bf16 v[112:115], v[80:83], a[172:175], v[112:115]
    v_mul_f32 v154, v130, v154
    v_mul_f32 v155, v131, v155
    v_mfma_f32_16x16x32_bf16 v[112:115], v[84:87], a[176:179], v[112:115]
    v_exp_f32 v152, v152
    v_mfma_f32_16x16x32_bf16 v[116:119], v[76:79], a[240:243], v[116:119]
    buffer_load_dwordx4 v[72:75], v188, s[48:51], s23 offen offset:1024 sc1
    v_mfma_f32_16x16x32_bf16 v[116:119], v[80:83], a[244:247], v[116:119]
    v_exp_f32 v153, v153
    v_mfma_f32_16x16x32_bf16 v[116:119], v[84:87], a[248:251], v[116:119]
    v_exp_f32 v154, v154
    s_waitcnt vmcnt(12)
    v_mfma_f32_16x16x32_bf16 v[88:91], v[16:19], a[36:39], v[88:91]
    v_exp_f32 v155, v155
    v_mfma_f32_16x16x32_bf16 v[88:91], v[20:23], a[40:43], v[88:91]
    buffer_load_dwordx4 v[76:79], v188, s[48:51], s23 offen offset:2048 sc1
    v_mfma_f32_16x16x32_bf16 v[88:91], v[24:27], a[44:47], v[88:91]
    v_mul_f32 v156, v128, v144
    v_mul_f32 v157, v129, v145
    v_mfma_f32_16x16x32_bf16 v[92:95], v[16:19], a[108:111], v[92:95]
    v_mul_f32 v158, v130, v146
    v_mul_f32 v159, v131, v147
    v_mfma_f32_16x16x32_bf16 v[92:95], v[20:23], a[112:115], v[92:95]
    v_fma_f32 v152, v152, v195, v195
    v_fma_f32 v153, v153, v195, v195
    v_mfma_f32_16x16x32_bf16 v[92:95], v[24:27], a[116:119], v[92:95]
    buffer_load_dwordx4 v[80:83], v188, s[48:51], s23 offen offset:3072 sc1
    v_mfma_f32_16x16x32_bf16 v[96:99], v[16:19], a[180:183], v[96:99]
    v_fma_f32 v154, v154, v195, v195
    v_fma_f32 v155, v155, v195, v195
    v_mfma_f32_16x16x32_bf16 v[96:99], v[20:23], a[184:187], v[96:99]
    v_rcp_f32 v152, v152
    v_mfma_f32_16x16x32_bf16 v[96:99], v[24:27], a[188:191], v[96:99]
    v_rcp_f32 v153, v153
    v_mfma_f32_16x16x32_bf16 v[100:103], v[16:19], a[252:255], v[100:103]
    buffer_load_dwordx4 v[84:87], v189, s[48:51], s23 offen offset:0 sc1
    v_mfma_f32_16x16x32_bf16 v[100:103], v[20:23], v[220:223], v[100:103]
    v_rcp_f32 v154, v154
    v_mfma_f32_16x16x32_bf16 v[100:103], v[24:27], v[224:227], v[100:103]
    v_rcp_f32 v155, v155
    s_waitcnt vmcnt(12)
    v_mfma_f32_16x16x32_bf16 v[104:107], v[28:31], a[36:39], v[104:107]
    v_mul_f32 v156, v156, v152
    v_mul_f32 v157, v157, v153
    v_mfma_f32_16x16x32_bf16 v[104:107], v[32:35], a[40:43], v[104:107]
    buffer_load_dwordx4 v[16:19], v189, s[48:51], s23 offen offset:1024 sc1
    v_mfma_f32_16x16x32_bf16 v[104:107], v[36:39], a[44:47], v[104:107]
    v_mul_f32 v158, v158, v154
    v_mul_f32 v159, v159, v155
    v_mfma_f32_16x16x32_bf16 v[108:111], v[28:31], a[108:111], v[108:111]
    v_cvt_pk_bf16_f32 v160, v156, v157
    v_cvt_pk_bf16_f32 v161, v158, v159
    v_mfma_f32_16x16x32_bf16 v[108:111], v[32:35], a[112:115], v[108:111]
    ds_write_b64 v12, v[160:161] offset:36864
    v_mfma_f32_16x16x32_bf16 v[108:111], v[36:39], a[116:119], v[108:111]
    buffer_load_dwordx4 v[20:23], v189, s[48:51], s23 offen offset:2048 sc1
    v_mfma_f32_16x16x32_bf16 v[112:115], v[28:31], a[180:183], v[112:115]
    v_mul_f32 v162, v132, v132
    v_mul_f32 v163, v133, v133
    v_mfma_f32_16x16x32_bf16 v[112:115], v[32:35], a[184:187], v[112:115]
    v_mul_f32 v164, v134, v134
    v_mul_f32 v165, v135, v135
    v_mfma_f32_16x16x32_bf16 v[112:115], v[36:39], a[188:191], v[112:115]
    v_fma_f32 v162, v162, v14, v7
    v_fma_f32 v163, v163, v14, v7
    v_mfma_f32_16x16x32_bf16 v[116:119], v[28:31], a[252:255], v[116:119]
    buffer_load_dwordx4 v[24:27], v189, s[48:51], s23 offen offset:3072 sc1
    v_mfma_f32_16x16x32_bf16 v[116:119], v[32:35], v[220:223], v[116:119]
    v_fma_f32 v164, v164, v14, v7
    v_fma_f32 v165, v165, v14, v7
    v_mfma_f32_16x16x32_bf16 v[116:119], v[36:39], v[224:227], v[116:119]
    v_mul_f32 v162, v132, v162
    v_mul_f32 v163, v133, v163
    s_waitcnt vmcnt(12)
    v_mfma_f32_16x16x32_bf16 v[88:91], v[40:43], a[48:51], v[88:91]
    v_mul_f32 v164, v134, v164
    v_mul_f32 v165, v135, v165
    v_mfma_f32_16x16x32_bf16 v[88:91], v[44:47], a[52:55], v[88:91]
    buffer_load_dwordx4 v[28:31], v190, s[48:51], s23 offen offset:0 sc1
    v_mfma_f32_16x16x32_bf16 v[88:91], v[48:51], a[56:59], v[88:91]
    v_exp_f32 v162, v162
    v_mfma_f32_16x16x32_bf16 v[92:95], v[40:43], a[120:123], v[92:95]
    v_exp_f32 v163, v163
    v_mfma_f32_16x16x32_bf16 v[92:95], v[44:47], a[124:127], v[92:95]
    v_exp_f32 v164, v164
    v_mfma_f32_16x16x32_bf16 v[92:95], v[48:51], a[128:131], v[92:95]
    buffer_load_dwordx4 v[32:35], v190, s[48:51], s23 offen offset:1024 sc1
    v_mfma_f32_16x16x32_bf16 v[96:99], v[40:43], a[192:195], v[96:99]
    v_exp_f32 v165, v165
    v_mfma_f32_16x16x32_bf16 v[96:99], v[44:47], a[196:199], v[96:99]
    v_mul_f32 v166, v132, v148
    v_mul_f32 v167, v133, v149
    v_mfma_f32_16x16x32_bf16 v[96:99], v[48:51], a[200:203], v[96:99]
    v_mul_f32 v168, v134, v150
    v_mul_f32 v169, v135, v151
    v_mfma_f32_16x16x32_bf16 v[100:103], v[40:43], v[228:231], v[100:103]
    buffer_load_dwordx4 v[36:39], v190, s[48:51], s23 offen offset:2048 sc1
    v_mfma_f32_16x16x32_bf16 v[100:103], v[44:47], v[232:235], v[100:103]
    v_fma_f32 v162, v162, v252, v252
    v_fma_f32 v163, v163, v252, v252
    v_mfma_f32_16x16x32_bf16 v[100:103], v[48:51], v[236:239], v[100:103]
    v_fma_f32 v164, v164, v252, v252
    v_fma_f32 v165, v165, v252, v252
    s_waitcnt vmcnt(12)
    v_mfma_f32_16x16x32_bf16 v[104:107], v[52:55], a[48:51], v[104:107]
    v_rcp_f32 v162, v162
    v_mfma_f32_16x16x32_bf16 v[104:107], v[56:59], a[52:55], v[104:107]
    buffer_load_dwordx4 v[40:43], v190, s[48:51], s23 offen offset:3072 sc1
    v_mfma_f32_16x16x32_bf16 v[104:107], v[60:63], a[56:59], v[104:107]
    v_rcp_f32 v163, v163
    v_mfma_f32_16x16x32_bf16 v[108:111], v[52:55], a[120:123], v[108:111]
    v_rcp_f32 v164, v164
    v_mfma_f32_16x16x32_bf16 v[108:111], v[56:59], a[124:127], v[108:111]
    v_rcp_f32 v165, v165
    v_mfma_f32_16x16x32_bf16 v[108:111], v[60:63], a[128:131], v[108:111]
    buffer_load_dwordx4 v[44:47], v191, s[48:51], s23 offen offset:0 sc1
    v_mfma_f32_16x16x32_bf16 v[112:115], v[52:55], a[192:195], v[112:115]
    v_mul_f32 v166, v166, v162
    v_mul_f32 v167, v167, v163
    v_mfma_f32_16x16x32_bf16 v[112:115], v[56:59], a[196:199], v[112:115]
    v_mul_f32 v168, v168, v164
    v_mul_f32 v169, v169, v165
    v_mfma_f32_16x16x32_bf16 v[112:115], v[60:63], a[200:203], v[112:115]
    v_cvt_pk_bf16_f32 v170, v166, v167
    v_cvt_pk_bf16_f32 v171, v168, v169
    v_mfma_f32_16x16x32_bf16 v[116:119], v[52:55], v[228:231], v[116:119]
    buffer_load_dwordx4 v[48:51], v191, s[48:51], s23 offen offset:1024 sc1
    v_mfma_f32_16x16x32_bf16 v[116:119], v[56:59], v[232:235], v[116:119]
    ds_write_b64 v12, v[170:171] offset:55296
    v_mfma_f32_16x16x32_bf16 v[116:119], v[60:63], v[236:239], v[116:119]
    s_waitcnt vmcnt(12)
    v_mfma_f32_16x16x32_bf16 v[88:91], v[64:67], a[60:63], v[88:91]
    v_mfma_f32_16x16x32_bf16 v[88:91], v[68:71], a[64:67], v[88:91]
    buffer_load_dwordx4 v[52:55], v191, s[48:51], s23 offen offset:2048 sc1
    v_mfma_f32_16x16x32_bf16 v[120:123], v[72:75], a[68:71], v[88:91]
    v_mfma_f32_16x16x32_bf16 v[92:95], v[64:67], a[132:135], v[92:95]
    v_mfma_f32_16x16x32_bf16 v[92:95], v[68:71], a[136:139], v[92:95]
    v_mfma_f32_16x16x32_bf16 v[124:127], v[72:75], a[140:143], v[92:95]
    buffer_load_dwordx4 v[56:59], v191, s[48:51], s23 offen offset:3072 sc1
    v_mfma_f32_16x16x32_bf16 v[96:99], v[64:67], a[204:207], v[96:99]
    v_mfma_f32_16x16x32_bf16 v[96:99], v[68:71], a[208:211], v[96:99]
    v_mfma_f32_16x16x32_bf16 v[128:131], v[72:75], a[212:215], v[96:99]
    v_mfma_f32_16x16x32_bf16 v[100:103], v[64:67], v[240:243], v[100:103]
    buffer_load_dwordx4 v[60:63], v192, s[48:51], s23 offen offset:0 sc1
    v_mfma_f32_16x16x32_bf16 v[100:103], v[68:71], v[244:247], v[100:103]
    v_mfma_f32_16x16x32_bf16 v[132:135], v[72:75], v[248:251], v[100:103]
    s_waitcnt vmcnt(12)
    v_mfma_f32_16x16x32_bf16 v[104:107], v[76:79], a[60:63], v[104:107]
    v_mfma_f32_16x16x32_bf16 v[104:107], v[80:83], a[64:67], v[104:107]
    buffer_load_dwordx4 v[64:67], v192, s[48:51], s23 offen offset:1024 sc1
    v_mfma_f32_16x16x32_bf16 v[136:139], v[84:87], a[68:71], v[104:107]
    v_mfma_f32_16x16x32_bf16 v[108:111], v[76:79], a[132:135], v[108:111]
    v_mfma_f32_16x16x32_bf16 v[108:111], v[80:83], a[136:139], v[108:111]
    v_mfma_f32_16x16x32_bf16 v[140:143], v[84:87], a[140:143], v[108:111]
    buffer_load_dwordx4 v[68:71], v192, s[48:51], s23 offen offset:2048 sc1
    v_mfma_f32_16x16x32_bf16 v[112:115], v[76:79], a[204:207], v[112:115]
    v_mfma_f32_16x16x32_bf16 v[112:115], v[80:83], a[208:211], v[112:115]
    s_lshl_b32 s7, s25, 11
    v_mfma_f32_16x16x32_bf16 v[144:147], v[84:87], a[212:215], v[112:115]
    s_add_u32 s7, s7, s28
    v_mfma_f32_16x16x32_bf16 v[116:119], v[76:79], v[240:243], v[116:119]
    buffer_load_dwordx4 v[72:75], v192, s[48:51], s23 offen offset:3072 sc1
    v_mfma_f32_16x16x32_bf16 v[116:119], v[80:83], v[244:247], v[116:119]
    s_add_u32 s23, s23, 36864
    v_mfma_f32_16x16x32_bf16 v[148:151], v[84:87], v[248:251], v[116:119]
    v_add_u32 v12, s7, v184
    s_add_u32 s25, s25, 1
    s_cmp_lt_u32 s25, 8
    s_cbranch_scc1 L_ffn_gu_34
    v_add_u32 v10, 73728, v184
    v_add_u32 v11, 110592, v184
    s_lshr_b32 s7, s2, 3
    s_lshl_b32 s7, s7, 2
    s_add_u32 s7, s7, s3
    s_lshl_b32 s7, s7, 9
    v_lshrrev_b32 v1, 1, v253
    v_add_u32 v1, s7, v1
    buffer_load_dwordx2 v[2:3], v1, s[96:99], 0 offen
    s_waitcnt lgkmcnt(0)
    s_barrier
    s_waitcnt vmcnt(12)
    v_mfma_f32_16x16x32_bf16 v[88:91], v[16:19], a[0:3], 0
    v_mfma_f32_16x16x32_bf16 v[88:91], v[20:23], a[4:7], v[88:91]
    buffer_load_dwordx4 v[76:79], v184, s[48:51], s23 offen offset:0 sc1
    v_mfma_f32_16x16x32_bf16 v[88:91], v[24:27], a[8:11], v[88:91]
    v_mul_f32 v152, v120, v120
    v_mul_f32 v153, v121, v121
    v_mfma_f32_16x16x32_bf16 v[92:95], v[16:19], a[72:75], 0
    v_mul_f32 v154, v122, v122
    v_mul_f32 v155, v123, v123
    v_mfma_f32_16x16x32_bf16 v[92:95], v[20:23], a[76:79], v[92:95]
    v_fma_f32 v152, v152, v8, v4
    v_fma_f32 v153, v153, v8, v4
    v_mfma_f32_16x16x32_bf16 v[92:95], v[24:27], a[80:83], v[92:95]
    buffer_load_dwordx4 v[80:83], v184, s[48:51], s23 offen offset:1024 sc1
    v_mfma_f32_16x16x32_bf16 v[96:99], v[16:19], a[144:147], 0
    v_fma_f32 v154, v154, v8, v4
    v_fma_f32 v155, v155, v8, v4
    v_mfma_f32_16x16x32_bf16 v[96:99], v[20:23], a[148:151], v[96:99]
    v_mul_f32 v152, v120, v152
    v_mul_f32 v153, v121, v153
    v_mfma_f32_16x16x32_bf16 v[96:99], v[24:27], a[152:155], v[96:99]
    v_mul_f32 v154, v122, v154
    v_mul_f32 v155, v123, v155
    v_mfma_f32_16x16x32_bf16 v[100:103], v[16:19], a[216:219], 0
    buffer_load_dwordx4 v[84:87], v184, s[48:51], s23 offen offset:2048 sc1
    v_mfma_f32_16x16x32_bf16 v[100:103], v[20:23], a[220:223], v[100:103]
    v_exp_f32 v152, v152
    v_mfma_f32_16x16x32_bf16 v[100:103], v[24:27], a[224:227], v[100:103]
    v_exp_f32 v153, v153
    s_waitcnt vmcnt(12)
    v_mfma_f32_16x16x32_bf16 v[104:107], v[28:31], a[0:3], 0
    v_exp_f32 v154, v154
    ds_read_b128 a[0:3], v10 offset:0
    v_mfma_f32_16x16x32_bf16 v[104:107], v[32:35], a[4:7], v[104:107]
    buffer_load_dwordx4 v[16:19], v184, s[48:51], s23 offen offset:3072 sc1
    v_mfma_f32_16x16x32_bf16 v[104:107], v[36:39], a[8:11], v[104:107]
    v_exp_f32 v155, v155
    v_mfma_f32_16x16x32_bf16 v[108:111], v[28:31], a[72:75], 0
    v_mul_f32 v156, v120, v136
    v_mul_f32 v157, v121, v137
    ds_read_b128 a[72:75], v10 offset:18432
    v_mfma_f32_16x16x32_bf16 v[108:111], v[32:35], a[76:79], v[108:111]
    v_mul_f32 v158, v122, v138
    v_mul_f32 v159, v123, v139
    v_mfma_f32_16x16x32_bf16 v[108:111], v[36:39], a[80:83], v[108:111]
    buffer_load_dwordx4 v[20:23], v185, s[48:51], s23 offen offset:0 sc1
    v_mfma_f32_16x16x32_bf16 v[112:115], v[28:31], a[144:147], 0
    v_fma_f32 v152, v152, v193, v193
    v_fma_f32 v153, v153, v193, v193
    ds_read_b128 a[144:147], v11 offset:0
    v_mfma_f32_16x16x32_bf16 v[112:115], v[32:35], a[148:151], v[112:115]
    v_fma_f32 v154, v154, v193, v193
    v_fma_f32 v155, v155, v193, v193
    v_mfma_f32_16x16x32_bf16 v[112:115], v[36:39], a[152:155], v[112:115]
    v_rcp_f32 v152, v152
    v_mfma_f32_16x16x32_bf16 v[116:119], v[28:31], a[216:219], 0
    buffer_load_dwordx4 v[24:27], v185, s[48:51], s23 offen offset:1024 sc1
    v_mfma_f32_16x16x32_bf16 v[116:119], v[32:35], a[220:223], v[116:119]
    v_rcp_f32 v153, v153
    ds_read_b128 a[216:219], v11 offset:18432
    v_mfma_f32_16x16x32_bf16 v[116:119], v[36:39], a[224:227], v[116:119]
    v_rcp_f32 v154, v154
    ds_read_b128 a[4:7], v10 offset:1024
    s_waitcnt vmcnt(12)
    v_mfma_f32_16x16x32_bf16 v[88:91], v[40:43], a[12:15], v[88:91]
    v_rcp_f32 v155, v155
    ds_read_b128 a[76:79], v10 offset:19456
    v_mfma_f32_16x16x32_bf16 v[88:91], v[44:47], a[16:19], v[88:91]
    buffer_load_dwordx4 v[28:31], v185, s[48:51], s23 offen offset:2048 sc1
    v_mfma_f32_16x16x32_bf16 v[88:91], v[48:51], a[20:23], v[88:91]
    v_mul_f32 v156, v156, v152
    v_mul_f32 v157, v157, v153
    ds_read_b128 a[148:151], v11 offset:1024
    v_mfma_f32_16x16x32_bf16 v[92:95], v[40:43], a[84:87], v[92:95]
    v_mul_f32 v158, v158, v154
    v_mul_f32 v159, v159, v155
    ds_read_b128 a[220:223], v11 offset:19456
    v_mfma_f32_16x16x32_bf16 v[92:95], v[44:47], a[88:91], v[92:95]
    v_cvt_pk_bf16_f32 v160, v156, v157
    v_cvt_pk_bf16_f32 v161, v158, v159
    ds_read_b128 a[8:11], v10 offset:2048
    v_mfma_f32_16x16x32_bf16 v[92:95], v[48:51], a[92:95], v[92:95]
    buffer_load_dwordx4 v[32:35], v185, s[48:51], s23 offen offset:3072 sc1
    v_mfma_f32_16x16x32_bf16 v[96:99], v[40:43], a[156:159], v[96:99]
    ds_write_b64 v12, v[160:161] offset:0
    v_mfma_f32_16x16x32_bf16 v[96:99], v[44:47], a[160:163], v[96:99]
    v_mul_f32 v162, v124, v124
    v_mul_f32 v163, v125, v125
    ds_read_b128 a[80:83], v10 offset:20480
    v_mfma_f32_16x16x32_bf16 v[96:99], v[48:51], a[164:167], v[96:99]
    v_mul_f32 v164, v126, v126
    v_mul_f32 v165, v127, v127
    ds_read_b128 a[152:155], v11 offset:2048
    v_mfma_f32_16x16x32_bf16 v[100:103], v[40:43], a[228:231], v[100:103]
    buffer_load_dwordx4 v[36:39], v186, s[48:51], s23 offen offset:0 sc1
    v_mfma_f32_16x16x32_bf16 v[100:103], v[44:47], a[232:235], v[100:103]
    v_fma_f32 v162, v162, v9, v5
    v_fma_f32 v163, v163, v9, v5
    ds_read_b128 a[224:227], v11 offset:20480
    v_mfma_f32_16x16x32_bf16 v[100:103], v[48:51], a[236:239], v[100:103]
    v_fma_f32 v164, v164, v9, v5
    v_fma_f32 v165, v165, v9, v5
    s_waitcnt vmcnt(12)
    v_mfma_f32_16x16x32_bf16 v[104:107], v[52:55], a[12:15], v[104:107]
    v_mul_f32 v162, v124, v162
    v_mul_f32 v163, v125, v163
    ds_read_b128 a[12:15], v10 offset:3072
    v_mfma_f32_16x16x32_bf16 v[104:107], v[56:59], a[16:19], v[104:107]
    buffer_load_dwordx4 v[40:43], v186, s[48:51], s23 offen offset:1024 sc1
    v_mfma_f32_16x16x32_bf16 v[104:107], v[60:63], a[20:23], v[104:107]
    v_mul_f32 v164, v126, v164
    v_mul_f32 v165, v127, v165
    v_mfma_f32_16x16x32_bf16 v[108:111], v[52:55], a[84:87], v[108:111]
    v_exp_f32 v162, v162
    ds_read_b128 a[84:87], v10 offset:21504
    v_mfma_f32_16x16x32_bf16 v[108:111], v[56:59], a[88:91], v[108:111]
    v_exp_f32 v163, v163
    v_mfma_f32_16x16x32_bf16 v[108:111], v[60:63], a[92:95], v[108:111]
    buffer_load_dwordx4 v[44:47], v186, s[48:51], s23 offen offset:2048 sc1
    v_mfma_f32_16x16x32_bf16 v[112:115], v[52:55], a[156:159], v[112:115]
    v_exp_f32 v164, v164
    ds_read_b128 a[156:159], v11 offset:3072
    v_mfma_f32_16x16x32_bf16 v[112:115], v[56:59], a[160:163], v[112:115]
    v_exp_f32 v165, v165
    v_mfma_f32_16x16x32_bf16 v[112:115], v[60:63], a[164:167], v[112:115]
    v_mul_f32 v166, v124, v140
    v_mul_f32 v167, v125, v141
    v_mfma_f32_16x16x32_bf16 v[116:119], v[52:55], a[228:231], v[116:119]
    buffer_load_dwordx4 v[48:51], v186, s[48:51], s23 offen offset:3072 sc1
    v_mfma_f32_16x16x32_bf16 v[116:119], v[56:59], a[232:235], v[116:119]
    v_mul_f32 v168, v126, v142
    v_mul_f32 v169, v127, v143
    ds_read_b128 a[228:231], v11 offset:21504
    v_mfma_f32_16x16x32_bf16 v[116:119], v[60:63], a[236:239], v[116:119]
    v_fma_f32 v162, v162, v194, v194
    v_fma_f32 v163, v163, v194, v194
    ds_read_b128 a[16:19], v10 offset:4096
    s_waitcnt vmcnt(12)
    v_mfma_f32_16x16x32_bf16 v[88:91], v[64:67], a[24:27], v[88:91]
    v_fma_f32 v164, v164, v194, v194
    v_fma_f32 v165, v165, v194, v194
    ds_read_b128 a[88:91], v10 offset:22528
    v_mfma_f32_16x16x32_bf16 v[88:91], v[68:71], a[28:31], v[88:91]
    buffer_load_dwordx4 v[52:55], v187, s[48:51], s23 offen offset:0 sc1
    v_mfma_f32_16x16x32_bf16 v[88:91], v[72:75], a[32:35], v[88:91]
    v_rcp_f32 v162, v162
    ds_read_b128 a[160:163], v11 offset:4096
    v_mfma_f32_16x16x32_bf16 v[92:95], v[64:67], a[96:99], v[92:95]
    v_rcp_f32 v163, v163
    ds_read_b128 a[232:235], v11 offset:22528
    v_mfma_f32_16x16x32_bf16 v[92:95], v[68:71], a[100:103], v[92:95]
    v_rcp_f32 v164, v164
    ds_read_b128 a[20:23], v10 offset:5120
    v_mfma_f32_16x16x32_bf16 v[92:95], v[72:75], a[104:107], v[92:95]
    buffer_load_dwordx4 v[56:59], v187, s[48:51], s23 offen offset:1024 sc1
    v_mfma_f32_16x16x32_bf16 v[96:99], v[64:67], a[168:171], v[96:99]
    v_rcp_f32 v165, v165
    ds_read_b128 a[92:95], v10 offset:23552
    v_mfma_f32_16x16x32_bf16 v[96:99], v[68:71], a[172:175], v[96:99]
    v_mul_f32 v166, v166, v162
    v_mul_f32 v167, v167, v163
    ds_read_b128 a[164:167], v11 offset:5120
    v_mfma_f32_16x16x32_bf16 v[96:99], v[72:75], a[176:179], v[96:99]
    v_mul_f32 v168, v168, v164
    v_mul_f32 v169, v169, v165
    ds_read_b128 a[236:239], v11 offset:23552
    v_mfma_f32_16x16x32_bf16 v[100:103], v[64:67], a[240:243], v[100:103]
    buffer_load_dwordx4 v[60:63], v187, s[48:51], s23 offen offset:2048 sc1
    v_mfma_f32_16x16x32_bf16 v[100:103], v[68:71], a[244:247], v[100:103]
    v_cvt_pk_bf16_f32 v170, v166, v167
    v_cvt_pk_bf16_f32 v171, v168, v169
    v_mfma_f32_16x16x32_bf16 v[100:103], v[72:75], a[248:251], v[100:103]
    ds_write_b64 v12, v[170:171] offset:18432
    s_waitcnt vmcnt(12)
    v_mfma_f32_16x16x32_bf16 v[104:107], v[76:79], a[24:27], v[104:107]
    v_mul_f32 v152, v128, v128
    v_mul_f32 v153, v129, v129
    ds_read_b128 a[24:27], v10 offset:6144
    v_mfma_f32_16x16x32_bf16 v[104:107], v[80:83], a[28:31], v[104:107]
    buffer_load_dwordx4 v[64:67], v187, s[48:51], s23 offen offset:3072 sc1
    v_mfma_f32_16x16x32_bf16 v[104:107], v[84:87], a[32:35], v[104:107]
    v_mul_f32 v154, v130, v130
    v_mul_f32 v155, v131, v131
    v_mfma_f32_16x16x32_bf16 v[108:111], v[76:79], a[96:99], v[108:111]
    v_fma_f32 v152, v152, v13, v6
    v_fma_f32 v153, v153, v13, v6
    ds_read_b128 a[96:99], v10 offset:24576
    v_mfma_f32_16x16x32_bf16 v[108:111], v[80:83], a[100:103], v[108:111]
    v_fma_f32 v154, v154, v13, v6
    v_fma_f32 v155, v155, v13, v6
    v_mfma_f32_16x16x32_bf16 v[108:111], v[84:87], a[104:107], v[108:111]
    buffer_load_dwordx4 v[68:71], v188, s[48:51], s23 offen offset:0 sc1
    v_mfma_f32_16x16x32_bf16 v[112:115], v[76:79], a[168:171], v[112:115]
    v_mul_f32 v152, v128, v152
    v_mul_f32 v153, v129, v153
    ds_read_b128 a[168:171], v11 offset:6144
    v_mfma_f32_16x16x32_bf16 v[112:115], v[80:83], a[172:175], v[112:115]
    v_mul_f32 v154, v130, v154
    v_mul_f32 v155, v131, v155
    v_mfma_f32_16x16x32_bf16 v[112:115], v[84:87], a[176:179], v[112:115]
    v_exp_f32 v152, v152
    v_mfma_f32_16x16x32_bf16 v[116:119], v[76:79], a[240:243], v[116:119]
    buffer_load_dwordx4 v[72:75], v188, s[48:51], s23 offen offset:1024 sc1
    v_mfma_f32_16x16x32_bf16 v[116:119], v[80:83], a[244:247], v[116:119]
    v_exp_f32 v153, v153
    ds_read_b128 a[240:243], v11 offset:24576
    v_mfma_f32_16x16x32_bf16 v[116:119], v[84:87], a[248:251], v[116:119]
    v_exp_f32 v154, v154
    ds_read_b128 a[28:31], v10 offset:7168
    s_waitcnt vmcnt(12)
    v_mfma_f32_16x16x32_bf16 v[88:91], v[16:19], a[36:39], v[88:91]
    v_exp_f32 v155, v155
    ds_read_b128 a[100:103], v10 offset:25600
    v_mfma_f32_16x16x32_bf16 v[88:91], v[20:23], a[40:43], v[88:91]
    buffer_load_dwordx4 v[76:79], v188, s[48:51], s23 offen offset:2048 sc1
    v_mfma_f32_16x16x32_bf16 v[88:91], v[24:27], a[44:47], v[88:91]
    v_mul_f32 v156, v128, v144
    v_mul_f32 v157, v129, v145
    ds_read_b128 a[172:175], v11 offset:7168
    v_mfma_f32_16x16x32_bf16 v[92:95], v[16:19], a[108:111], v[92:95]
    v_mul_f32 v158, v130, v146
    v_mul_f32 v159, v131, v147
    ds_read_b128 a[244:247], v11 offset:25600
    v_mfma_f32_16x16x32_bf16 v[92:95], v[20:23], a[112:115], v[92:95]
    v_fma_f32 v152, v152, v195, v195
    v_fma_f32 v153, v153, v195, v195
    ds_read_b128 a[32:35], v10 offset:8192
    v_mfma_f32_16x16x32_bf16 v[92:95], v[24:27], a[116:119], v[92:95]
    buffer_load_dwordx4 v[80:83], v188, s[48:51], s23 offen offset:3072 sc1
    v_mfma_f32_16x16x32_bf16 v[96:99], v[16:19], a[180:183], v[96:99]
    v_fma_f32 v154, v154, v195, v195
    v_fma_f32 v155, v155, v195, v195
    ds_read_b128 a[104:107], v10 offset:26624
    v_mfma_f32_16x16x32_bf16 v[96:99], v[20:23], a[184:187], v[96:99]
    v_rcp_f32 v152, v152
    ds_read_b128 a[176:179], v11 offset:8192
    v_mfma_f32_16x16x32_bf16 v[96:99], v[24:27], a[188:191], v[96:99]
    v_rcp_f32 v153, v153
    ds_read_b128 a[248:251], v11 offset:26624
    v_mfma_f32_16x16x32_bf16 v[100:103], v[16:19], a[252:255], v[100:103]
    buffer_load_dwordx4 v[84:87], v189, s[48:51], s23 offen offset:0 sc1
    v_mfma_f32_16x16x32_bf16 v[100:103], v[20:23], v[220:223], v[100:103]
    v_rcp_f32 v154, v154
    v_mfma_f32_16x16x32_bf16 v[100:103], v[24:27], v[224:227], v[100:103]
    v_rcp_f32 v155, v155
    s_waitcnt vmcnt(12)
    v_mfma_f32_16x16x32_bf16 v[104:107], v[28:31], a[36:39], v[104:107]
    v_mul_f32 v156, v156, v152
    v_mul_f32 v157, v157, v153
    ds_read_b128 a[36:39], v10 offset:9216
    v_mfma_f32_16x16x32_bf16 v[104:107], v[32:35], a[40:43], v[104:107]
    buffer_load_dwordx4 v[16:19], v189, s[48:51], s23 offen offset:1024 sc1
    v_mfma_f32_16x16x32_bf16 v[104:107], v[36:39], a[44:47], v[104:107]
    v_mul_f32 v158, v158, v154
    v_mul_f32 v159, v159, v155
    v_mfma_f32_16x16x32_bf16 v[108:111], v[28:31], a[108:111], v[108:111]
    v_cvt_pk_bf16_f32 v160, v156, v157
    v_cvt_pk_bf16_f32 v161, v158, v159
    ds_read_b128 a[108:111], v10 offset:27648
    v_mfma_f32_16x16x32_bf16 v[108:111], v[32:35], a[112:115], v[108:111]
    ds_write_b64 v12, v[160:161] offset:36864
    v_mfma_f32_16x16x32_bf16 v[108:111], v[36:39], a[116:119], v[108:111]
    buffer_load_dwordx4 v[20:23], v189, s[48:51], s23 offen offset:2048 sc1
    v_mfma_f32_16x16x32_bf16 v[112:115], v[28:31], a[180:183], v[112:115]
    v_mul_f32 v162, v132, v132
    v_mul_f32 v163, v133, v133
    ds_read_b128 a[180:183], v11 offset:9216
    v_mfma_f32_16x16x32_bf16 v[112:115], v[32:35], a[184:187], v[112:115]
    v_mul_f32 v164, v134, v134
    v_mul_f32 v165, v135, v135
    v_mfma_f32_16x16x32_bf16 v[112:115], v[36:39], a[188:191], v[112:115]
    v_fma_f32 v162, v162, v14, v7
    v_fma_f32 v163, v163, v14, v7
    v_mfma_f32_16x16x32_bf16 v[116:119], v[28:31], a[252:255], v[116:119]
    buffer_load_dwordx4 v[24:27], v189, s[48:51], s23 offen offset:3072 sc1
    v_mfma_f32_16x16x32_bf16 v[116:119], v[32:35], v[220:223], v[116:119]
    v_fma_f32 v164, v164, v14, v7
    v_fma_f32 v165, v165, v14, v7
    ds_read_b128 a[252:255], v11 offset:27648
    v_mfma_f32_16x16x32_bf16 v[116:119], v[36:39], v[224:227], v[116:119]
    v_mul_f32 v162, v132, v162
    v_mul_f32 v163, v133, v163
    ds_read_b128 a[40:43], v10 offset:10240
    s_waitcnt vmcnt(12)
    v_mfma_f32_16x16x32_bf16 v[88:91], v[40:43], a[48:51], v[88:91]
    v_mul_f32 v164, v134, v164
    v_mul_f32 v165, v135, v165
    ds_read_b128 a[112:115], v10 offset:28672
    v_mfma_f32_16x16x32_bf16 v[88:91], v[44:47], a[52:55], v[88:91]
    buffer_load_dwordx4 v[28:31], v190, s[48:51], s23 offen offset:0 sc1
    v_mfma_f32_16x16x32_bf16 v[88:91], v[48:51], a[56:59], v[88:91]
    v_exp_f32 v162, v162
    ds_read_b128 a[184:187], v11 offset:10240
    v_mfma_f32_16x16x32_bf16 v[92:95], v[40:43], a[120:123], v[92:95]
    v_exp_f32 v163, v163
    ds_read_b128 v[220:223], v11 offset:28672
    v_mfma_f32_16x16x32_bf16 v[92:95], v[44:47], a[124:127], v[92:95]
    v_exp_f32 v164, v164
    ds_read_b128 a[44:47], v10 offset:11264
    v_mfma_f32_16x16x32_bf16 v[92:95], v[48:51], a[128:131], v[92:95]
    buffer_load_dwordx4 v[32:35], v190, s[48:51], s23 offen offset:1024 sc1
    v_mfma_f32_16x16x32_bf16 v[96:99], v[40:43], a[192:195], v[96:99]
    v_exp_f32 v165, v165
    ds_read_b128 a[116:119], v10 offset:29696
    v_mfma_f32_16x16x32_bf16 v[96:99], v[44:47], a[196:199], v[96:99]
    v_mul_f32 v166, v132, v148
    v_mul_f32 v167, v133, v149
    ds_read_b128 a[188:191], v11 offset:11264
    v_mfma_f32_16x16x32_bf16 v[96:99], v[48:51], a[200:203], v[96:99]
    v_mul_f32 v168, v134, v150
    v_mul_f32 v169, v135, v151
    ds_read_b128 v[224:227], v11 offset:29696
    v_mfma_f32_16x16x32_bf16 v[100:103], v[40:43], v[228:231], v[100:103]
    buffer_load_dwordx4 v[36:39], v190, s[48:51], s23 offen offset:2048 sc1
    v_mfma_f32_16x16x32_bf16 v[100:103], v[44:47], v[232:235], v[100:103]
    v_fma_f32 v162, v162, v252, v252
    v_fma_f32 v163, v163, v252, v252
    v_mfma_f32_16x16x32_bf16 v[100:103], v[48:51], v[236:239], v[100:103]
    v_fma_f32 v164, v164, v252, v252
    v_fma_f32 v165, v165, v252, v252
    s_waitcnt vmcnt(12)
    v_mfma_f32_16x16x32_bf16 v[104:107], v[52:55], a[48:51], v[104:107]
    v_rcp_f32 v162, v162
    ds_read_b128 a[48:51], v10 offset:12288
    v_mfma_f32_16x16x32_bf16 v[104:107], v[56:59], a[52:55], v[104:107]
    buffer_load_dwordx4 v[40:43], v190, s[48:51], s23 offen offset:3072 sc1
    v_mfma_f32_16x16x32_bf16 v[104:107], v[60:63], a[56:59], v[104:107]
    v_rcp_f32 v163, v163
    v_mfma_f32_16x16x32_bf16 v[108:111], v[52:55], a[120:123], v[108:111]
    v_rcp_f32 v164, v164
    ds_read_b128 a[120:123], v10 offset:30720
    v_mfma_f32_16x16x32_bf16 v[108:111], v[56:59], a[124:127], v[108:111]
    v_rcp_f32 v165, v165
    v_mfma_f32_16x16x32_bf16 v[108:111], v[60:63], a[128:131], v[108:111]
    buffer_load_dwordx4 v[44:47], v191, s[48:51], s23 offen offset:0 sc1
    v_mfma_f32_16x16x32_bf16 v[112:115], v[52:55], a[192:195], v[112:115]
    v_mul_f32 v166, v166, v162
    v_mul_f32 v167, v167, v163
    ds_read_b128 a[192:195], v11 offset:12288
    v_mfma_f32_16x16x32_bf16 v[112:115], v[56:59], a[196:199], v[112:115]
    v_mul_f32 v168, v168, v164
    v_mul_f32 v169, v169, v165
    v_mfma_f32_16x16x32_bf16 v[112:115], v[60:63], a[200:203], v[112:115]
    v_cvt_pk_bf16_f32 v170, v166, v167
    v_cvt_pk_bf16_f32 v171, v168, v169
    v_mfma_f32_16x16x32_bf16 v[116:119], v[52:55], v[228:231], v[116:119]
    buffer_load_dwordx4 v[48:51], v191, s[48:51], s23 offen offset:1024 sc1
    v_mfma_f32_16x16x32_bf16 v[116:119], v[56:59], v[232:235], v[116:119]
    ds_write_b64 v12, v[170:171] offset:55296
    v_mfma_f32_16x16x32_bf16 v[116:119], v[60:63], v[236:239], v[116:119]
    ds_read_b128 v[228:231], v11 offset:30720
    s_waitcnt vmcnt(12)
    v_mfma_f32_16x16x32_bf16 v[88:91], v[64:67], a[60:63], v[88:91]
    ds_read_b128 a[52:55], v10 offset:13312
    v_mfma_f32_16x16x32_bf16 v[88:91], v[68:71], a[64:67], v[88:91]
    buffer_load_dwordx4 v[52:55], v191, s[48:51], s23 offen offset:2048 sc1
    v_mfma_f32_16x16x32_bf16 v[120:123], v[72:75], a[68:71], v[88:91]
    ds_read_b128 a[124:127], v10 offset:31744
    v_mfma_f32_16x16x32_bf16 v[92:95], v[64:67], a[132:135], v[92:95]
    ds_read_b128 a[196:199], v11 offset:13312
    v_mfma_f32_16x16x32_bf16 v[92:95], v[68:71], a[136:139], v[92:95]
    ds_read_b128 v[232:235], v11 offset:31744
    v_mfma_f32_16x16x32_bf16 v[124:127], v[72:75], a[140:143], v[92:95]
    buffer_load_dwordx4 v[56:59], v191, s[48:51], s23 offen offset:3072 sc1
    v_mfma_f32_16x16x32_bf16 v[96:99], v[64:67], a[204:207], v[96:99]
    v_mfma_f32_16x16x32_bf16 v[96:99], v[68:71], a[208:211], v[96:99]
    v_mfma_f32_16x16x32_bf16 v[128:131], v[72:75], a[212:215], v[96:99]
    v_mfma_f32_16x16x32_bf16 v[100:103], v[64:67], v[240:243], v[100:103]
    buffer_load_dwordx4 v[60:63], v192, s[48:51], s23 offen offset:0 sc1
    v_mfma_f32_16x16x32_bf16 v[100:103], v[68:71], v[244:247], v[100:103]
    v_mfma_f32_16x16x32_bf16 v[132:135], v[72:75], v[248:251], v[100:103]
    s_waitcnt vmcnt(12)
    v_mfma_f32_16x16x32_bf16 v[104:107], v[76:79], a[60:63], v[104:107]
    v_mfma_f32_16x16x32_bf16 v[104:107], v[80:83], a[64:67], v[104:107]
    buffer_load_dwordx4 v[64:67], v192, s[48:51], s23 offen offset:1024 sc1
    v_mfma_f32_16x16x32_bf16 v[136:139], v[84:87], a[68:71], v[104:107]
    v_mfma_f32_16x16x32_bf16 v[108:111], v[76:79], a[132:135], v[108:111]
    v_mfma_f32_16x16x32_bf16 v[108:111], v[80:83], a[136:139], v[108:111]
    v_mfma_f32_16x16x32_bf16 v[140:143], v[84:87], a[140:143], v[108:111]
    buffer_load_dwordx4 v[68:71], v192, s[48:51], s23 offen offset:2048 sc1
    v_mfma_f32_16x16x32_bf16 v[112:115], v[76:79], a[204:207], v[112:115]
    v_mfma_f32_16x16x32_bf16 v[112:115], v[80:83], a[208:211], v[112:115]
    s_lshl_b32 s7, s25, 11
    v_mfma_f32_16x16x32_bf16 v[144:147], v[84:87], a[212:215], v[112:115]
    s_add_u32 s7, s7, s28
    v_mfma_f32_16x16x32_bf16 v[116:119], v[76:79], v[240:243], v[116:119]
    buffer_load_dwordx4 v[72:75], v192, s[48:51], s23 offen offset:3072 sc1
    v_mfma_f32_16x16x32_bf16 v[116:119], v[80:83], v[244:247], v[116:119]
    s_add_u32 s23, s23, 36864
    v_mfma_f32_16x16x32_bf16 v[148:151], v[84:87], v[248:251], v[116:119]
    v_add_u32 v12, s7, v184
    s_add_u32 s25, s25, 1
    s_waitcnt lgkmcnt(0)
    s_barrier
    v_pk_mul_f32 v[152:153], v[120:121], v[120:121]
    ds_read_b128 a[56:59], v10 offset:14336
    v_pk_mul_f32 v[154:155], v[122:123], v[122:123]
    ds_read_b128 a[128:131], v10 offset:32768
    v_pk_fma_f32 v[152:153], v[152:153], v[8:9], v[4:5] op_sel:[0,0,0] op_sel_hi:[1,0,0]
    ds_read_b128 a[200:203], v11 offset:14336
    v_pk_fma_f32 v[154:155], v[154:155], v[8:9], v[4:5] op_sel:[0,0,0] op_sel_hi:[1,0,0]
    v_pk_mul_f32 v[152:153], v[120:121], v[152:153]
    ds_read_b128 v[236:239], v11 offset:32768
    v_pk_mul_f32 v[154:155], v[122:123], v[154:155]
    ds_read_b128 a[60:63], v10 offset:15360
    buffer_load_dwordx4 v[76:79], v184, s[48:51], s23 offen offset:0 sc1
    v_exp_f32 v152, v152
    ds_read_b128 a[132:135], v10 offset:33792
    v_exp_f32 v153, v153
    v_exp_f32 v154, v154
    ds_read_b128 a[204:207], v11 offset:15360
    v_exp_f32 v155, v155
    ds_read_b128 v[240:243], v11 offset:33792
    v_pk_mul_f32 v[156:157], v[120:121], v[136:137]
    v_pk_mul_f32 v[158:159], v[122:123], v[138:139]
    buffer_load_dwordx4 v[80:83], v184, s[48:51], s23 offen offset:1024 sc1
    v_pk_fma_f32 v[152:153], v[152:153], v[192:193], v[192:193] op_sel:[0,1,1] op_sel_hi:[1,1,1]
    v_pk_fma_f32 v[154:155], v[154:155], v[192:193], v[192:193] op_sel:[0,1,1] op_sel_hi:[1,1,1]
    v_rcp_f32 v152, v152
    v_rcp_f32 v153, v153
    v_rcp_f32 v154, v154
    v_rcp_f32 v155, v155
    buffer_load_dwordx4 v[84:87], v184, s[48:51], s23 offen offset:2048 sc1
    s_nop 0
    v_pk_mul_f32 v[156:157], v[156:157], v[152:153]
    v_pk_mul_f32 v[158:159], v[158:159], v[154:155]
    v_cvt_pk_bf16_f32 v160, v156, v157
    v_cvt_pk_bf16_f32 v161, v158, v159
    ds_write_b64 v12, v[160:161] offset:0
    buffer_load_dwordx4 v[104:107], v184, s[48:51], s23 offen offset:3072 sc1
    v_pk_mul_f32 v[162:163], v[124:125], v[124:125]
    v_pk_mul_f32 v[164:165], v[126:127], v[126:127]
    v_pk_fma_f32 v[162:163], v[162:163], v[8:9], v[4:5] op_sel:[0,1,1] op_sel_hi:[1,1,1]
    v_pk_fma_f32 v[164:165], v[164:165], v[8:9], v[4:5] op_sel:[0,1,1] op_sel_hi:[1,1,1]
    v_pk_mul_f32 v[162:163], v[124:125], v[162:163]
    v_pk_mul_f32 v[164:165], v[126:127], v[164:165]
    buffer_load_dwordx4 v[108:111], v185, s[48:51], s23 offen offset:0 sc1
    v_exp_f32 v162, v162
    v_exp_f32 v163, v163
    v_exp_f32 v164, v164
    v_exp_f32 v165, v165
    v_pk_mul_f32 v[166:167], v[124:125], v[140:141]
    v_pk_mul_f32 v[168:169], v[126:127], v[142:143]
    buffer_load_dwordx4 v[112:115], v185, s[48:51], s23 offen offset:1024 sc1
    v_pk_fma_f32 v[162:163], v[162:163], v[194:195], v[194:195] op_sel:[0,0,0] op_sel_hi:[1,0,0]
    v_pk_fma_f32 v[164:165], v[164:165], v[194:195], v[194:195] op_sel:[0,0,0] op_sel_hi:[1,0,0]
    v_rcp_f32 v162, v162
    v_rcp_f32 v163, v163
    v_rcp_f32 v164, v164
    v_rcp_f32 v165, v165
    buffer_load_dwordx4 v[116:119], v185, s[48:51], s23 offen offset:2048 sc1
    s_nop 0
    v_pk_mul_f32 v[166:167], v[166:167], v[162:163]
    v_pk_mul_f32 v[168:169], v[168:169], v[164:165]
    v_cvt_pk_bf16_f32 v170, v166, v167
    v_cvt_pk_bf16_f32 v171, v168, v169
    ds_write_b64 v12, v[170:171] offset:18432
    buffer_load_dwordx4 v[180:183], v185, s[48:51], s23 offen offset:3072 sc1
    v_pk_mul_f32 v[152:153], v[128:129], v[128:129]
    v_pk_mul_f32 v[154:155], v[130:131], v[130:131]
    v_pk_fma_f32 v[152:153], v[152:153], v[12:13], v[6:7] op_sel:[0,1,0] op_sel_hi:[1,1,0]
    v_pk_fma_f32 v[154:155], v[154:155], v[12:13], v[6:7] op_sel:[0,1,0] op_sel_hi:[1,1,0]
    v_pk_mul_f32 v[152:153], v[128:129], v[152:153]
    v_pk_mul_f32 v[154:155], v[130:131], v[154:155]
    buffer_load_dwordx4 v[196:199], v186, s[48:51], s23 offen offset:0 sc1
    v_exp_f32 v152, v152
    v_exp_f32 v153, v153
    v_exp_f32 v154, v154
    v_exp_f32 v155, v155
    v_pk_mul_f32 v[156:157], v[128:129], v[144:145]
    v_pk_mul_f32 v[158:159], v[130:131], v[146:147]
    buffer_load_dwordx4 v[200:203], v186, s[48:51], s23 offen offset:1024 sc1
    v_pk_fma_f32 v[152:153], v[152:153], v[194:195], v[194:195] op_sel:[0,1,1] op_sel_hi:[1,1,1]
    v_pk_fma_f32 v[154:155], v[154:155], v[194:195], v[194:195] op_sel:[0,1,1] op_sel_hi:[1,1,1]
    v_rcp_f32 v152, v152
    v_rcp_f32 v153, v153
    v_rcp_f32 v154, v154
    v_rcp_f32 v155, v155
    buffer_load_dwordx4 v[204:207], v186, s[48:51], s23 offen offset:2048 sc1
    s_nop 0
    v_pk_mul_f32 v[156:157], v[156:157], v[152:153]
    v_pk_mul_f32 v[158:159], v[158:159], v[154:155]
    v_cvt_pk_bf16_f32 v160, v156, v157
    v_cvt_pk_bf16_f32 v161, v158, v159
    ds_write_b64 v12, v[160:161] offset:36864
    buffer_load_dwordx4 v[208:211], v186, s[48:51], s23 offen offset:3072 sc1
    v_pk_mul_f32 v[162:163], v[132:133], v[132:133]
    v_pk_mul_f32 v[164:165], v[134:135], v[134:135]
    v_pk_fma_f32 v[162:163], v[162:163], v[14:15], v[6:7] op_sel:[0,0,1] op_sel_hi:[1,0,1]
    v_pk_fma_f32 v[164:165], v[164:165], v[14:15], v[6:7] op_sel:[0,0,1] op_sel_hi:[1,0,1]
    v_pk_mul_f32 v[162:163], v[132:133], v[162:163]
    v_pk_mul_f32 v[164:165], v[134:135], v[164:165]
    buffer_load_dwordx4 v[212:215], v187, s[48:51], s23 offen offset:0 sc1
    v_exp_f32 v162, v162
    v_exp_f32 v163, v163
    v_exp_f32 v164, v164
    v_exp_f32 v165, v165
    v_pk_mul_f32 v[166:167], v[132:133], v[148:149]
    v_pk_mul_f32 v[168:169], v[134:135], v[150:151]
    v_pk_fma_f32 v[162:163], v[162:163], v[252:253], v[252:253] op_sel:[0,0,0] op_sel_hi:[1,0,0]
    v_pk_fma_f32 v[164:165], v[164:165], v[252:253], v[252:253] op_sel:[0,0,0] op_sel_hi:[1,0,0]
    v_rcp_f32 v162, v162
    v_rcp_f32 v163, v163
    v_rcp_f32 v164, v164
    v_rcp_f32 v165, v165
    s_nop 0
    v_pk_mul_f32 v[166:167], v[166:167], v[162:163]
    v_pk_mul_f32 v[168:169], v[168:169], v[164:165]
    v_cvt_pk_bf16_f32 v170, v166, v167
    v_cvt_pk_bf16_f32 v171, v168, v169
    ds_write_b64 v12, v[170:171] offset:55296
    buffer_load_dwordx4 v[136:139], v187, s[48:51], s23 offen offset:1024 sc1
    buffer_load_dwordx4 v[140:143], v187, s[48:51], s23 offen offset:2048 sc1
    buffer_load_dwordx4 v[144:147], v187, s[48:51], s23 offen offset:3072 sc1
    buffer_load_dwordx4 v[160:163], v188, s[48:51], s23 offen offset:0 sc1
    buffer_load_dwordx4 v[164:167], v188, s[48:51], s23 offen offset:1024 sc1
    s_add_u32 s23, s23, 18432
    s_waitcnt lgkmcnt(0)
    s_barrier
    ds_read_b128 a[64:67], v10 offset:16384
    ds_read_b128 a[136:139], v10 offset:34816
    ds_read_b128 a[208:211], v11 offset:16384
    ds_read_b128 v[244:247], v11 offset:34816
    ds_read_b128 a[68:71], v10 offset:17408
    ds_read_b128 a[140:143], v10 offset:35840
    ds_read_b128 a[212:215], v11 offset:17408
    ds_read_b128 v[248:251], v11 offset:35840
    s_mov_b32 s25, 0
    s_waitcnt lgkmcnt(0)
    s_branch L_ffn_dn_mid_36
L_ffn_dn_35:
    s_waitcnt vmcnt(32)
    v_mfma_f32_16x16x32_bf16 v[88:91], v[104:107], a[0:3], 0
    v_mfma_f32_16x16x32_bf16 v[88:91], v[108:111], a[4:7], v[88:91]
    buffer_load_dwordx4 v[76:79], v184, s[48:51], s23 offen offset:0 sc1
    v_mfma_f32_16x16x32_bf16 v[88:91], v[112:115], a[8:11], v[88:91]
    v_mfma_f32_16x16x32_bf16 v[92:95], v[104:107], a[72:75], 0
    v_mfma_f32_16x16x32_bf16 v[92:95], v[108:111], a[76:79], v[92:95]
    v_mfma_f32_16x16x32_bf16 v[92:95], v[112:115], a[80:83], v[92:95]
    buffer_load_dwordx4 v[80:83], v184, s[48:51], s23 offen offset:1024 sc1
    v_mfma_f32_16x16x32_bf16 v[96:99], v[104:107], a[144:147], 0
    v_cvt_pk_bf16_f32 v152, v120, v121
    v_cvt_pk_bf16_f32 v153, v122, v123
    v_mfma_f32_16x16x32_bf16 v[96:99], v[108:111], a[148:151], v[96:99]
    v_cvt_pk_bf16_f32 v154, v124, v125
    v_cvt_pk_bf16_f32 v155, v126, v127
    v_mfma_f32_16x16x32_bf16 v[96:99], v[112:115], a[152:155], v[96:99]
    s_nop 0
    v_permlane16_swap_b32 v152, v154
    v_mfma_f32_16x16x32_bf16 v[100:103], v[104:107], a[216:219], 0
    buffer_load_dwordx4 v[84:87], v184, s[48:51], s23 offen offset:2048 sc1
    v_mfma_f32_16x16x32_bf16 v[100:103], v[108:111], a[220:223], v[100:103]
    v_permlane16_swap_b32 v153, v155
    v_mfma_f32_16x16x32_bf16 v[100:103], v[112:115], a[224:227], v[100:103]
    buffer_store_dwordx4 v[152:155], v178, s[72:75], s27 offen sc1
    s_waitcnt vmcnt(33)
    v_mfma_f32_16x16x32_bf16 v[88:91], v[116:119], a[12:15], v[88:91]
    ds_write_b128 v216, v[152:155]
    v_mfma_f32_16x16x32_bf16 v[88:91], v[180:183], a[16:19], v[88:91]
    buffer_load_dwordx4 v[104:107], v184, s[48:51], s23 offen offset:3072 sc1
    v_mfma_f32_16x16x32_bf16 v[88:91], v[196:199], a[20:23], v[88:91]
    v_add_u32 v216, v216, v218
    v_mfma_f32_16x16x32_bf16 v[92:95], v[116:119], a[84:87], v[92:95]
    v_mfma_f32_16x16x32_bf16 v[92:95], v[180:183], a[88:91], v[92:95]
    v_mfma_f32_16x16x32_bf16 v[92:95], v[196:199], a[92:95], v[92:95]
    buffer_load_dwordx4 v[108:111], v185, s[48:51], s23 offen offset:0 sc1
    v_mfma_f32_16x16x32_bf16 v[96:99], v[116:119], a[156:159], v[96:99]
    v_mfma_f32_16x16x32_bf16 v[96:99], v[180:183], a[160:163], v[96:99]
    v_mfma_f32_16x16x32_bf16 v[96:99], v[196:199], a[164:167], v[96:99]
    v_mfma_f32_16x16x32_bf16 v[100:103], v[116:119], a[228:231], v[100:103]
    buffer_load_dwordx4 v[112:115], v185, s[48:51], s23 offen offset:1024 sc1
    v_mfma_f32_16x16x32_bf16 v[100:103], v[180:183], a[232:235], v[100:103]
    v_mfma_f32_16x16x32_bf16 v[100:103], v[196:199], a[236:239], v[100:103]
    s_waitcnt vmcnt(33)
    v_mfma_f32_16x16x32_bf16 v[88:91], v[200:203], a[24:27], v[88:91]
    v_mfma_f32_16x16x32_bf16 v[88:91], v[204:207], a[28:31], v[88:91]
    buffer_load_dwordx4 v[116:119], v185, s[48:51], s23 offen offset:2048 sc1
    v_mfma_f32_16x16x32_bf16 v[88:91], v[208:211], a[32:35], v[88:91]
    v_mfma_f32_16x16x32_bf16 v[92:95], v[200:203], a[96:99], v[92:95]
    v_mfma_f32_16x16x32_bf16 v[92:95], v[204:207], a[100:103], v[92:95]
    v_mfma_f32_16x16x32_bf16 v[92:95], v[208:211], a[104:107], v[92:95]
    buffer_load_dwordx4 v[180:183], v185, s[48:51], s23 offen offset:3072 sc1
    v_mfma_f32_16x16x32_bf16 v[96:99], v[200:203], a[168:171], v[96:99]
    v_mfma_f32_16x16x32_bf16 v[96:99], v[204:207], a[172:175], v[96:99]
    v_mfma_f32_16x16x32_bf16 v[96:99], v[208:211], a[176:179], v[96:99]
    v_mfma_f32_16x16x32_bf16 v[100:103], v[200:203], a[240:243], v[100:103]
    buffer_load_dwordx4 v[196:199], v186, s[48:51], s23 offen offset:0 sc1
    v_mfma_f32_16x16x32_bf16 v[100:103], v[204:207], a[244:247], v[100:103]
    v_mfma_f32_16x16x32_bf16 v[100:103], v[208:211], a[248:251], v[100:103]
    s_waitcnt vmcnt(33)
    v_mfma_f32_16x16x32_bf16 v[88:91], v[212:215], a[36:39], v[88:91]
    v_mfma_f32_16x16x32_bf16 v[88:91], v[136:139], a[40:43], v[88:91]
    buffer_load_dwordx4 v[200:203], v186, s[48:51], s23 offen offset:1024 sc1
    v_mfma_f32_16x16x32_bf16 v[88:91], v[140:143], a[44:47], v[88:91]
    v_mfma_f32_16x16x32_bf16 v[92:95], v[212:215], a[108:111], v[92:95]
    v_mfma_f32_16x16x32_bf16 v[92:95], v[136:139], a[112:115], v[92:95]
    v_cvt_pk_bf16_f32 v156, v128, v129
    v_cvt_pk_bf16_f32 v157, v130, v131
    v_mfma_f32_16x16x32_bf16 v[92:95], v[140:143], a[116:119], v[92:95]
    buffer_load_dwordx4 v[204:207], v186, s[48:51], s23 offen offset:2048 sc1
    v_mfma_f32_16x16x32_bf16 v[96:99], v[212:215], a[180:183], v[96:99]
    v_cvt_pk_bf16_f32 v158, v132, v133
    v_cvt_pk_bf16_f32 v159, v134, v135
    v_mfma_f32_16x16x32_bf16 v[96:99], v[136:139], a[184:187], v[96:99]
    s_nop 0
    v_permlane16_swap_b32 v156, v158
    v_mfma_f32_16x16x32_bf16 v[96:99], v[140:143], a[188:191], v[96:99]
    v_permlane16_swap_b32 v157, v159
    v_mfma_f32_16x16x32_bf16 v[100:103], v[212:215], a[252:255], v[100:103]
    buffer_load_dwordx4 v[208:211], v186, s[48:51], s23 offen offset:3072 sc1
    v_mfma_f32_16x16x32_bf16 v[100:103], v[136:139], v[220:223], v[100:103]
    buffer_store_dwordx4 v[156:159], v179, s[72:75], s27 offen sc1
    v_mfma_f32_16x16x32_bf16 v[100:103], v[140:143], v[224:227], v[100:103]
    ds_write_b128 v217, v[156:159]
    s_waitcnt vmcnt(34)
    v_mfma_f32_16x16x32_bf16 v[88:91], v[144:147], a[48:51], v[88:91]
    v_add_u32 v217, v217, v219
    v_mfma_f32_16x16x32_bf16 v[88:91], v[160:163], a[52:55], v[88:91]
    buffer_load_dwordx4 v[212:215], v187, s[48:51], s23 offen offset:0 sc1
    v_mfma_f32_16x16x32_bf16 v[88:91], v[164:167], a[56:59], v[88:91]
    v_mfma_f32_16x16x32_bf16 v[92:95], v[144:147], a[120:123], v[92:95]
    v_mfma_f32_16x16x32_bf16 v[92:95], v[160:163], a[124:127], v[92:95]
    v_mfma_f32_16x16x32_bf16 v[92:95], v[164:167], a[128:131], v[92:95]
    buffer_load_dwordx4 v[136:139], v187, s[48:51], s23 offen offset:1024 sc1
    v_mfma_f32_16x16x32_bf16 v[96:99], v[144:147], a[192:195], v[96:99]
    v_mfma_f32_16x16x32_bf16 v[96:99], v[160:163], a[196:199], v[96:99]
    v_mfma_f32_16x16x32_bf16 v[96:99], v[164:167], a[200:203], v[96:99]
    v_mfma_f32_16x16x32_bf16 v[100:103], v[144:147], v[228:231], v[100:103]
    buffer_load_dwordx4 v[140:143], v187, s[48:51], s23 offen offset:2048 sc1
    v_mfma_f32_16x16x32_bf16 v[100:103], v[160:163], v[232:235], v[100:103]
    v_mfma_f32_16x16x32_bf16 v[100:103], v[164:167], v[236:239], v[100:103]
    s_waitcnt vmcnt(34)
    v_mfma_f32_16x16x32_bf16 v[88:91], v[168:171], a[60:63], v[88:91]
    v_mfma_f32_16x16x32_bf16 v[88:91], v[148:151], a[64:67], v[88:91]
    buffer_load_dwordx4 v[144:147], v187, s[48:51], s23 offen offset:3072 sc1
    v_mfma_f32_16x16x32_bf16 v[120:123], v[4:7], a[68:71], v[88:91]
    v_mfma_f32_16x16x32_bf16 v[92:95], v[168:171], a[132:135], v[92:95]
    v_mfma_f32_16x16x32_bf16 v[92:95], v[148:151], a[136:139], v[92:95]
    v_mfma_f32_16x16x32_bf16 v[124:127], v[4:7], a[140:143], v[92:95]
    buffer_load_dwordx4 v[160:163], v188, s[48:51], s23 offen offset:0 sc1
    v_mfma_f32_16x16x32_bf16 v[96:99], v[168:171], a[204:207], v[96:99]
    s_mov_b32 s74, 268435456
    v_mfma_f32_16x16x32_bf16 v[96:99], v[148:151], a[208:211], v[96:99]
    s_add_u32 s27, s27, 1024
    v_mfma_f32_16x16x32_bf16 v[128:131], v[4:7], a[212:215], v[96:99]
    s_add_u32 s25, s25, 1
    v_mfma_f32_16x16x32_bf16 v[100:103], v[168:171], v[240:243], v[100:103]
    buffer_load_dwordx4 v[164:167], v188, s[48:51], s23 offen offset:1024 sc1
    v_mfma_f32_16x16x32_bf16 v[100:103], v[148:151], v[244:247], v[100:103]
    s_add_u32 s23, s23, 18432
    v_mfma_f32_16x16x32_bf16 v[132:135], v[4:7], v[248:251], v[100:103]
L_ffn_dn_mid_36:
    s_waitcnt vmcnt(30)
    v_mfma_f32_16x16x32_bf16 v[88:91], v[16:19], a[0:3], 0
    v_mfma_f32_16x16x32_bf16 v[88:91], v[20:23], a[4:7], v[88:91]
    buffer_load_dwordx4 v[168:171], v184, s[48:51], s23 offen offset:0 sc1
    v_mfma_f32_16x16x32_bf16 v[88:91], v[24:27], a[8:11], v[88:91]
    v_mfma_f32_16x16x32_bf16 v[92:95], v[16:19], a[72:75], 0
    v_mfma_f32_16x16x32_bf16 v[92:95], v[20:23], a[76:79], v[92:95]
    v_mfma_f32_16x16x32_bf16 v[92:95], v[24:27], a[80:83], v[92:95]
    buffer_load_dwordx4 v[148:151], v184, s[48:51], s23 offen offset:1024 sc1
    v_mfma_f32_16x16x32_bf16 v[96:99], v[16:19], a[144:147], 0
    v_cvt_pk_bf16_f32 v152, v120, v121
    v_cvt_pk_bf16_f32 v153, v122, v123
    v_mfma_f32_16x16x32_bf16 v[96:99], v[20:23], a[148:151], v[96:99]
    v_cvt_pk_bf16_f32 v154, v124, v125
    v_cvt_pk_bf16_f32 v155, v126, v127
    v_mfma_f32_16x16x32_bf16 v[96:99], v[24:27], a[152:155], v[96:99]
    s_nop 0
    v_permlane16_swap_b32 v152, v154
    v_mfma_f32_16x16x32_bf16 v[100:103], v[16:19], a[216:219], 0
    buffer_load_dwordx4 v[4:7], v184, s[48:51], s23 offen offset:2048 sc1
    v_mfma_f32_16x16x32_bf16 v[100:103], v[20:23], a[220:223], v[100:103]
    v_permlane16_swap_b32 v153, v155
    v_mfma_f32_16x16x32_bf16 v[100:103], v[24:27], a[224:227], v[100:103]
    buffer_store_dwordx4 v[152:155], v178, s[72:75], s27 offen sc1
    s_waitcnt vmcnt(31)
    v_mfma_f32_16x16x32_bf16 v[88:91], v[28:31], a[12:15], v[88:91]
    ds_write_b128 v216, v[152:155]
    v_mfma_f32_16x16x32_bf16 v[88:91], v[32:35], a[16:19], v[88:91]
    buffer_load_dwordx4 v[16:19], v184, s[48:51], s23 offen offset:3072 sc1
    v_mfma_f32_16x16x32_bf16 v[88:91], v[36:39], a[20:23], v[88:91]
    v_add_u32 v216, v216, v218
    v_mfma_f32_16x16x32_bf16 v[92:95], v[28:31], a[84:87], v[92:95]
    v_mfma_f32_16x16x32_bf16 v[92:95], v[32:35], a[88:91], v[92:95]
    v_mfma_f32_16x16x32_bf16 v[92:95], v[36:39], a[92:95], v[92:95]
    buffer_load_dwordx4 v[20:23], v185, s[48:51], s23 offen offset:0 sc1
    v_mfma_f32_16x16x32_bf16 v[96:99], v[28:31], a[156:159], v[96:99]
    v_mfma_f32_16x16x32_bf16 v[96:99], v[32:35], a[160:163], v[96:99]
    v_mfma_f32_16x16x32_bf16 v[96:99], v[36:39], a[164:167], v[96:99]
    v_mfma_f32_16x16x32_bf16 v[100:103], v[28:31], a[228:231], v[100:103]
    buffer_load_dwordx4 v[24:27], v185, s[48:51], s23 offen offset:1024 sc1
    v_mfma_f32_16x16x32_bf16 v[100:103], v[32:35], a[232:235], v[100:103]
    v_mfma_f32_16x16x32_bf16 v[100:103], v[36:39], a[236:239], v[100:103]
    s_waitcnt vmcnt(31)
    v_mfma_f32_16x16x32_bf16 v[88:91], v[40:43], a[24:27], v[88:91]
    v_mfma_f32_16x16x32_bf16 v[88:91], v[44:47], a[28:31], v[88:91]
    buffer_load_dwordx4 v[28:31], v185, s[48:51], s23 offen offset:2048 sc1
    v_mfma_f32_16x16x32_bf16 v[88:91], v[48:51], a[32:35], v[88:91]
    v_mfma_f32_16x16x32_bf16 v[92:95], v[40:43], a[96:99], v[92:95]
    v_mfma_f32_16x16x32_bf16 v[92:95], v[44:47], a[100:103], v[92:95]
    v_mfma_f32_16x16x32_bf16 v[92:95], v[48:51], a[104:107], v[92:95]
    buffer_load_dwordx4 v[32:35], v185, s[48:51], s23 offen offset:3072 sc1
    v_mfma_f32_16x16x32_bf16 v[96:99], v[40:43], a[168:171], v[96:99]
    v_mfma_f32_16x16x32_bf16 v[96:99], v[44:47], a[172:175], v[96:99]
    v_mfma_f32_16x16x32_bf16 v[96:99], v[48:51], a[176:179], v[96:99]
    v_mfma_f32_16x16x32_bf16 v[100:103], v[40:43], a[240:243], v[100:103]
    buffer_load_dwordx4 v[36:39], v186, s[48:51], s23 offen offset:0 sc1
    v_mfma_f32_16x16x32_bf16 v[100:103], v[44:47], a[244:247], v[100:103]
    v_mfma_f32_16x16x32_bf16 v[100:103], v[48:51], a[248:251], v[100:103]
    s_waitcnt vmcnt(31)
    s_cmp_lg_u32 s25, 6
    s_cbranch_scc1 L_early_37
    s_waitcnt vmcnt(16)
    s_barrier
    s_cmp_lg_u32 s3, 0
    s_cbranch_scc1 L_early_37
    v_lshlrev_b32 v15, 7, v0
    v_mov_b32 v1, s76
    s_mov_b64 exec, 0xff
    buffer_store_dword v1, v15, s[8:11], s29 offen sc1
    s_mov_b64 exec, -1
L_early_37:
    v_mfma_f32_16x16x32_bf16 v[88:91], v[52:55], a[36:39], v[88:91]
    v_mfma_f32_16x16x32_bf16 v[88:91], v[56:59], a[40:43], v[88:91]
    buffer_load_dwordx4 v[40:43], v186, s[48:51], s23 offen offset:1024 sc1
    v_mfma_f32_16x16x32_bf16 v[88:91], v[60:63], a[44:47], v[88:91]
    v_mfma_f32_16x16x32_bf16 v[92:95], v[52:55], a[108:111], v[92:95]
    v_mfma_f32_16x16x32_bf16 v[92:95], v[56:59], a[112:115], v[92:95]
    v_cvt_pk_bf16_f32 v156, v128, v129
    v_cvt_pk_bf16_f32 v157, v130, v131
    v_mfma_f32_16x16x32_bf16 v[92:95], v[60:63], a[116:119], v[92:95]
    buffer_load_dwordx4 v[44:47], v186, s[48:51], s23 offen offset:2048 sc1
    v_mfma_f32_16x16x32_bf16 v[96:99], v[52:55], a[180:183], v[96:99]
    v_cvt_pk_bf16_f32 v158, v132, v133
    v_cvt_pk_bf16_f32 v159, v134, v135
    v_mfma_f32_16x16x32_bf16 v[96:99], v[56:59], a[184:187], v[96:99]
    s_nop 0
    v_permlane16_swap_b32 v156, v158
    v_mfma_f32_16x16x32_bf16 v[96:99], v[60:63], a[188:191], v[96:99]
    v_permlane16_swap_b32 v157, v159
    v_mfma_f32_16x16x32_bf16 v[100:103], v[52:55], a[252:255], v[100:103]
    buffer_load_dwordx4 v[48:51], v186, s[48:51], s23 offen offset:3072 sc1
    v_mfma_f32_16x16x32_bf16 v[100:103], v[56:59], v[220:223], v[100:103]
    buffer_store_dwordx4 v[156:159], v179, s[72:75], s27 offen sc1
    v_mfma_f32_16x16x32_bf16 v[100:103], v[60:63], v[224:227], v[100:103]
    ds_write_b128 v217, v[156:159]
    s_waitcnt vmcnt(32)
    v_mfma_f32_16x16x32_bf16 v[88:91], v[64:67], a[48:51], v[88:91]
    v_add_u32 v217, v217, v219
    v_mfma_f32_16x16x32_bf16 v[88:91], v[68:71], a[52:55], v[88:91]
    buffer_load_dwordx4 v[52:55], v187, s[48:51], s23 offen offset:0 sc1
    v_mfma_f32_16x16x32_bf16 v[88:91], v[72:75], a[56:59], v[88:91]
    v_mfma_f32_16x16x32_bf16 v[92:95], v[64:67], a[120:123], v[92:95]
    v_mfma_f32_16x16x32_bf16 v[92:95], v[68:71], a[124:127], v[92:95]
    v_mfma_f32_16x16x32_bf16 v[92:95], v[72:75], a[128:131], v[92:95]
    buffer_load_dwordx4 v[56:59], v187, s[48:51], s23 offen offset:1024 sc1
    v_mfma_f32_16x16x32_bf16 v[96:99], v[64:67], a[192:195], v[96:99]
    v_mfma_f32_16x16x32_bf16 v[96:99], v[68:71], a[196:199], v[96:99]
    v_mfma_f32_16x16x32_bf16 v[96:99], v[72:75], a[200:203], v[96:99]
    v_mfma_f32_16x16x32_bf16 v[100:103], v[64:67], v[228:231], v[100:103]
    buffer_load_dwordx4 v[60:63], v187, s[48:51], s23 offen offset:2048 sc1
    v_mfma_f32_16x16x32_bf16 v[100:103], v[68:71], v[232:235], v[100:103]
    v_mfma_f32_16x16x32_bf16 v[100:103], v[72:75], v[236:239], v[100:103]
    s_waitcnt vmcnt(32)
    v_mfma_f32_16x16x32_bf16 v[88:91], v[76:79], a[60:63], v[88:91]
    v_mfma_f32_16x16x32_bf16 v[88:91], v[80:83], a[64:67], v[88:91]
    buffer_load_dwordx4 v[64:67], v187, s[48:51], s23 offen offset:3072 sc1
    v_mfma_f32_16x16x32_bf16 v[120:123], v[84:87], a[68:71], v[88:91]
    v_mfma_f32_16x16x32_bf16 v[92:95], v[76:79], a[132:135], v[92:95]
    v_mfma_f32_16x16x32_bf16 v[92:95], v[80:83], a[136:139], v[92:95]
    v_mfma_f32_16x16x32_bf16 v[124:127], v[84:87], a[140:143], v[92:95]
    buffer_load_dwordx4 v[68:71], v188, s[48:51], s23 offen offset:0 sc1
    v_mfma_f32_16x16x32_bf16 v[96:99], v[76:79], a[204:207], v[96:99]
    s_mov_b32 s74, 268435456
    v_mfma_f32_16x16x32_bf16 v[96:99], v[80:83], a[208:211], v[96:99]
    s_add_u32 s27, s27, 1024
    v_mfma_f32_16x16x32_bf16 v[128:131], v[84:87], a[212:215], v[96:99]
    s_add_u32 s25, s25, 1
    v_mfma_f32_16x16x32_bf16 v[100:103], v[76:79], v[240:243], v[100:103]
    buffer_load_dwordx4 v[72:75], v188, s[48:51], s23 offen offset:1024 sc1
    v_mfma_f32_16x16x32_bf16 v[100:103], v[80:83], v[244:247], v[100:103]
    s_add_u32 s23, s23, 18432
    v_mfma_f32_16x16x32_bf16 v[132:135], v[84:87], v[248:251], v[100:103]
    s_cmp_lt_u32 s25, 7
    s_cbranch_scc1 L_ffn_dn_35
    s_waitcnt vmcnt(33)
    v_mfma_f32_16x16x32_bf16 v[88:91], v[104:107], a[0:3], 0
    v_mfma_f32_16x16x32_bf16 v[88:91], v[108:111], a[4:7], v[88:91]
    buffer_load_dwordx4 v[76:79], v184, s[48:51], s23 offen offset:0 sc1
    v_mfma_f32_16x16x32_bf16 v[88:91], v[112:115], a[8:11], v[88:91]
    v_mfma_f32_16x16x32_bf16 v[92:95], v[104:107], a[72:75], 0
    v_mfma_f32_16x16x32_bf16 v[92:95], v[108:111], a[76:79], v[92:95]
    v_mfma_f32_16x16x32_bf16 v[92:95], v[112:115], a[80:83], v[92:95]
    buffer_load_dwordx4 v[80:83], v184, s[48:51], s23 offen offset:1024 sc1
    v_mfma_f32_16x16x32_bf16 v[96:99], v[104:107], a[144:147], 0
    v_cvt_pk_bf16_f32 v152, v120, v121
    v_cvt_pk_bf16_f32 v153, v122, v123
    v_mfma_f32_16x16x32_bf16 v[96:99], v[108:111], a[148:151], v[96:99]
    v_cvt_pk_bf16_f32 v154, v124, v125
    v_cvt_pk_bf16_f32 v155, v126, v127
    v_mfma_f32_16x16x32_bf16 v[96:99], v[112:115], a[152:155], v[96:99]
    s_nop 0
    v_permlane16_swap_b32 v152, v154
    v_mfma_f32_16x16x32_bf16 v[100:103], v[104:107], a[216:219], 0
    buffer_load_dwordx4 v[84:87], v184, s[48:51], s23 offen offset:2048 sc1
    v_mfma_f32_16x16x32_bf16 v[100:103], v[108:111], a[220:223], v[100:103]
    v_permlane16_swap_b32 v153, v155
    v_mfma_f32_16x16x32_bf16 v[100:103], v[112:115], a[224:227], v[100:103]
    buffer_store_dwordx4 v[152:155], v178, s[72:75], s27 offen sc1
    s_waitcnt vmcnt(34)
    v_mfma_f32_16x16x32_bf16 v[88:91], v[116:119], a[12:15], v[88:91]
    ds_write_b128 v216, v[152:155]
    v_mfma_f32_16x16x32_bf16 v[88:91], v[180:183], a[16:19], v[88:91]
    v_add_u32 v216, v216, v218
    v_cvt_pk_bf16_f32 v156, v128, v129
    v_mfma_f32_16x16x32_bf16 v[88:91], v[196:199], a[20:23], v[88:91]
    v_cvt_pk_bf16_f32 v157, v130, v131
    v_cvt_pk_bf16_f32 v158, v132, v133
    s_load_dwordx8 s[56:63], s[38:39], 0 glc
    v_mfma_f32_16x16x32_bf16 v[92:95], v[116:119], a[84:87], v[92:95]
    v_cvt_pk_bf16_f32 v159, v134, v135
    v_mfma_f32_16x16x32_bf16 v[92:95], v[180:183], a[88:91], v[92:95]
    s_nop 0
    v_permlane16_swap_b32 v156, v158
    v_mfma_f32_16x16x32_bf16 v[92:95], v[196:199], a[92:95], v[92:95]
    v_permlane16_swap_b32 v157, v159
    v_mfma_f32_16x16x32_bf16 v[96:99], v[116:119], a[156:159], v[96:99]
    buffer_store_dwordx4 v[156:159], v179, s[72:75], s27 offen sc1
    v_mfma_f32_16x16x32_bf16 v[96:99], v[180:183], a[160:163], v[96:99]
    ds_write_b128 v217, v[156:159]
    v_mfma_f32_16x16x32_bf16 v[96:99], v[196:199], a[164:167], v[96:99]
    v_add_u32 v217, v217, v219
    v_mfma_f32_16x16x32_bf16 v[100:103], v[116:119], a[228:231], v[100:103]
    v_mfma_f32_16x16x32_bf16 v[100:103], v[180:183], a[232:235], v[100:103]
    v_mfma_f32_16x16x32_bf16 v[100:103], v[196:199], a[236:239], v[100:103]
    s_waitcnt vmcnt(32)
    s_mov_b32 s6, 0
L_epoll_38:
    s_waitcnt lgkmcnt(0)
    s_xor_b64 s[56:57], s[56:57], s[76:77]
    s_xor_b64 s[58:59], s[58:59], s[76:77]
    s_xor_b64 s[60:61], s[60:61], s[76:77]
    s_xor_b64 s[62:63], s[62:63], s[76:77]
    s_or_b64 s[56:57], s[56:57], s[58:59]
    s_or_b64 s[60:61], s[60:61], s[62:63]
    s_or_b64 s[56:57], s[56:57], s[60:61]
    s_cbranch_scc0 L_epolled_39
    s_load_dwordx8 s[56:63], s[38:39], 0 glc
    s_add_u32 s6, s6, 1
    s_cmp_lt_u32 s6, 1048576
    s_cbranch_scc1 L_epoll_38
    s_branch L_main_end
L_epolled_39:
    v_mfma_f32_16x16x32_bf16 v[88:91], v[200:203], a[24:27], v[88:91]
    v_mfma_f32_16x16x32_bf16 v[88:91], v[204:207], a[28:31], v[88:91]
    s_add_u32 s7, s40, 1
    s_and_b32 s7, s7, 7
    s_mul_i32 s7, s7, 9216
    s_add_u32 s19, s7, s20
    buffer_load_dwordx4 v[104:107], v172, s[8:11], s19 offen sc1
    v_mfma_f32_16x16x32_bf16 v[88:91], v[208:211], a[32:35], v[88:91]
    v_mfma_f32_16x16x32_bf16 v[92:95], v[200:203], a[96:99], v[92:95]
    v_mfma_f32_16x16x32_bf16 v[92:95], v[204:207], a[100:103], v[92:95]
    v_mfma_f32_16x16x32_bf16 v[92:95], v[208:211], a[104:107], v[92:95]
    buffer_load_dwordx4 v[108:111], v173, s[8:11], s19 offen sc1
    v_mfma_f32_16x16x32_bf16 v[96:99], v[200:203], a[168:171], v[96:99]
    v_mfma_f32_16x16x32_bf16 v[96:99], v[204:207], a[172:175], v[96:99]
    v_mfma_f32_16x16x32_bf16 v[96:99], v[208:211], a[176:179], v[96:99]
    v_mfma_f32_16x16x32_bf16 v[100:103], v[200:203], a[240:243], v[100:103]
    s_add_u32 s7, s40, 2
    s_and_b32 s7, s7, 7
    s_mul_i32 s7, s7, 9216
    s_add_u32 s19, s7, s20
    buffer_load_dwordx4 v[112:115], v172, s[8:11], s19 offen sc1
    v_mfma_f32_16x16x32_bf16 v[100:103], v[204:207], a[244:247], v[100:103]
    v_mfma_f32_16x16x32_bf16 v[100:103], v[208:211], a[248:251], v[100:103]
    s_waitcnt vmcnt(31)
    v_mfma_f32_16x16x32_bf16 v[88:91], v[212:215], a[36:39], v[88:91]
    v_mfma_f32_16x16x32_bf16 v[88:91], v[136:139], a[40:43], v[88:91]
    buffer_load_dwordx4 v[116:119], v173, s[8:11], s19 offen sc1
    v_mfma_f32_16x16x32_bf16 v[88:91], v[140:143], a[44:47], v[88:91]
    v_mfma_f32_16x16x32_bf16 v[92:95], v[212:215], a[108:111], v[92:95]
    v_mfma_f32_16x16x32_bf16 v[92:95], v[136:139], a[112:115], v[92:95]
    v_mfma_f32_16x16x32_bf16 v[92:95], v[140:143], a[116:119], v[92:95]
    s_add_u32 s7, s40, 3
    s_and_b32 s7, s7, 7
    s_mul_i32 s7, s7, 9216
    s_add_u32 s19, s7, s20
    buffer_load_dwordx4 v[180:183], v172, s[8:11], s19 offen sc1
    v_mfma_f32_16x16x32_bf16 v[96:99], v[212:215], a[180:183], v[96:99]
    v_mfma_f32_16x16x32_bf16 v[96:99], v[136:139], a[184:187], v[96:99]
    v_mfma_f32_16x16x32_bf16 v[96:99], v[140:143], a[188:191], v[96:99]
    v_mfma_f32_16x16x32_bf16 v[100:103], v[212:215], a[252:255], v[100:103]
    buffer_load_dwordx4 v[196:199], v173, s[8:11], s19 offen sc1
    v_mfma_f32_16x16x32_bf16 v[100:103], v[136:139], v[220:223], v[100:103]
    v_mfma_f32_16x16x32_bf16 v[100:103], v[140:143], v[224:227], v[100:103]
    s_waitcnt vmcnt(31)
    v_mfma_f32_16x16x32_bf16 v[88:91], v[144:147], a[48:51], v[88:91]
    v_mfma_f32_16x16x32_bf16 v[88:91], v[160:163], a[52:55], v[88:91]
    s_add_u32 s7, s40, 4
    s_and_b32 s7, s7, 7
    s_mul_i32 s7, s7, 9216
    s_add_u32 s19, s7, s20
    buffer_load_dwordx4 v[200:203], v172, s[8:11], s19 offen sc1
    v_mfma_f32_16x16x32_bf16 v[88:91], v[164:167], a[56:59], v[88:91]
    v_mfma_f32_16x16x32_bf16 v[92:95], v[144:147], a[120:123], v[92:95]
    v_mfma_f32_16x16x32_bf16 v[92:95], v[160:163], a[124:127], v[92:95]
    v_mfma_f32_16x16x32_bf16 v[92:95], v[164:167], a[128:131], v[92:95]
    buffer_load_dwordx4 v[204:207], v173, s[8:11], s19 offen sc1
    v_mfma_f32_16x16x32_bf16 v[96:99], v[144:147], a[192:195], v[96:99]
    v_mfma_f32_16x16x32_bf16 v[96:99], v[160:163], a[196:199], v[96:99]
    v_mfma_f32_16x16x32_bf16 v[96:99], v[164:167], a[200:203], v[96:99]
    v_mfma_f32_16x16x32_bf16 v[100:103], v[144:147], v[228:231], v[100:103]
    s_add_u32 s7, s40, 5
    s_and_b32 s7, s7, 7
    s_mul_i32 s7, s7, 9216
    s_add_u32 s19, s7, s20
    buffer_load_dwordx4 v[208:211], v172, s[8:11], s19 offen sc1
    v_mfma_f32_16x16x32_bf16 v[100:103], v[160:163], v[232:235], v[100:103]
    v_mfma_f32_16x16x32_bf16 v[100:103], v[164:167], v[236:239], v[100:103]
    s_waitcnt vmcnt(31)
    v_mfma_f32_16x16x32_bf16 v[88:91], v[168:171], a[60:63], v[88:91]
    v_mfma_f32_16x16x32_bf16 v[88:91], v[148:151], a[64:67], v[88:91]
    buffer_load_dwordx4 v[212:215], v173, s[8:11], s19 offen sc1
    v_mfma_f32_16x16x32_bf16 v[120:123], v[4:7], a[68:71], v[88:91]
    v_mfma_f32_16x16x32_bf16 v[92:95], v[168:171], a[132:135], v[92:95]
    v_mfma_f32_16x16x32_bf16 v[92:95], v[148:151], a[136:139], v[92:95]
    v_mfma_f32_16x16x32_bf16 v[124:127], v[4:7], a[140:143], v[92:95]
    s_add_u32 s7, s40, 6
    s_and_b32 s7, s7, 7
    s_mul_i32 s7, s7, 9216
    s_add_u32 s19, s7, s20
    buffer_load_dwordx4 v[136:139], v172, s[8:11], s19 offen sc1
    v_mfma_f32_16x16x32_bf16 v[96:99], v[168:171], a[204:207], v[96:99]
    s_mov_b32 s74, 268435456
    v_mfma_f32_16x16x32_bf16 v[96:99], v[148:151], a[208:211], v[96:99]
    s_add_u32 s27, s27, 1024
    v_mfma_f32_16x16x32_bf16 v[128:131], v[4:7], a[212:215], v[96:99]
    s_add_u32 s25, s25, 1
    v_mfma_f32_16x16x32_bf16 v[100:103], v[168:171], v[240:243], v[100:103]
    buffer_load_dwordx4 v[140:143], v173, s[8:11], s19 offen sc1
    v_mfma_f32_16x16x32_bf16 v[100:103], v[148:151], v[244:247], v[100:103]
    s_add_u32 s23, s23, 18432
    v_mfma_f32_16x16x32_bf16 v[132:135], v[4:7], v[248:251], v[100:103]
    s_waitcnt vmcnt(30)
    v_mfma_f32_16x16x32_bf16 v[88:91], v[16:19], a[0:3], 0
    v_mfma_f32_16x16x32_bf16 v[88:91], v[20:23], a[4:7], v[88:91]
    s_add_u32 s7, s40, 7
    s_and_b32 s7, s7, 7
    s_mul_i32 s7, s7, 9216
    s_add_u32 s19, s7, s20
    buffer_load_dwordx4 v[144:147], v172, s[8:11], s19 offen sc1
    v_mfma_f32_16x16x32_bf16 v[88:91], v[24:27], a[8:11], v[88:91]
    v_mfma_f32_16x16x32_bf16 v[92:95], v[16:19], a[72:75], 0
    v_mfma_f32_16x16x32_bf16 v[92:95], v[20:23], a[76:79], v[92:95]
    v_mfma_f32_16x16x32_bf16 v[92:95], v[24:27], a[80:83], v[92:95]
    buffer_load_dwordx4 v[160:163], v173, s[8:11], s19 offen sc1
    v_mfma_f32_16x16x32_bf16 v[96:99], v[16:19], a[144:147], 0
    v_cvt_pk_bf16_f32 v152, v120, v121
    v_cvt_pk_bf16_f32 v153, v122, v123
    v_mfma_f32_16x16x32_bf16 v[96:99], v[20:23], a[148:151], v[96:99]
    v_cvt_pk_bf16_f32 v154, v124, v125
    v_cvt_pk_bf16_f32 v155, v126, v127
    v_mfma_f32_16x16x32_bf16 v[96:99], v[24:27], a[152:155], v[96:99]
    s_nop 0
    v_permlane16_swap_b32 v152, v154
    v_mfma_f32_16x16x32_bf16 v[100:103], v[16:19], a[216:219], 0
    v_permlane16_swap_b32 v153, v155
    v_mfma_f32_16x16x32_bf16 v[100:103], v[20:23], a[220:223], v[100:103]
    buffer_store_dwordx4 v[152:155], v178, s[72:75], s27 offen sc1
    v_mfma_f32_16x16x32_bf16 v[100:103], v[24:27], a[224:227], v[100:103]
    ds_write_b128 v216, v[152:155]
    s_waitcnt vmcnt(30)
    v_mfma_f32_16x16x32_bf16 v[88:91], v[28:31], a[12:15], v[88:91]
    v_add_u32 v216, v216, v218
    v_cvt_pk_bf16_f32 v156, v128, v129
    v_mfma_f32_16x16x32_bf16 v[88:91], v[32:35], a[16:19], v[88:91]
    v_cvt_pk_bf16_f32 v157, v130, v131
    v_cvt_pk_bf16_f32 v158, v132, v133
    v_mfma_f32_16x16x32_bf16 v[88:91], v[36:39], a[20:23], v[88:91]
    v_cvt_pk_bf16_f32 v159, v134, v135
    v_mfma_f32_16x16x32_bf16 v[92:95], v[28:31], a[84:87], v[92:95]
    s_nop 0
    v_permlane16_swap_b32 v156, v158
    v_mfma_f32_16x16x32_bf16 v[92:95], v[32:35], a[88:91], v[92:95]
    v_permlane16_swap_b32 v157, v159
    v_mfma_f32_16x16x32_bf16 v[92:95], v[36:39], a[92:95], v[92:95]
    buffer_store_dwordx4 v[156:159], v179, s[72:75], s27 offen sc1
    v_mfma_f32_16x16x32_bf16 v[96:99], v[28:31], a[156:159], v[96:99]
    ds_write_b128 v217, v[156:159]
    v_mfma_f32_16x16x32_bf16 v[96:99], v[32:35], a[160:163], v[96:99]
    v_add_u32 v217, v217, v219
    v_mfma_f32_16x16x32_bf16 v[96:99], v[36:39], a[164:167], v[96:99]
    v_mfma_f32_16x16x32_bf16 v[100:103], v[28:31], a[228:231], v[100:103]
    v_mfma_f32_16x16x32_bf16 v[100:103], v[32:35], a[232:235], v[100:103]
    v_mfma_f32_16x16x32_bf16 v[100:103], v[36:39], a[236:239], v[100:103]
    s_waitcnt vmcnt(28)
    s_waitcnt vmcnt(16)
    s_barrier
    s_cmp_lg_u32 s3, 0
    s_cbranch_scc1 L_early_40
    s_mov_b64 exec, 0xff
    buffer_store_dword v1, v15, s[8:11], s29 offen offset:32 sc1
    s_mov_b64 exec, -1
L_early_40:
    v_mfma_f32_16x16x32_bf16 v[88:91], v[40:43], a[24:27], v[88:91]
    v_mfma_f32_16x16x32_bf16 v[88:91], v[44:47], a[28:31], v[88:91]
    v_mfma_f32_16x16x32_bf16 v[88:91], v[48:51], a[32:35], v[88:91]
    v_mfma_f32_16x16x32_bf16 v[92:95], v[40:43], a[96:99], v[92:95]
    v_mfma_f32_16x16x32_bf16 v[92:95], v[44:47], a[100:103], v[92:95]
    v_mfma_f32_16x16x32_bf16 v[92:95], v[48:51], a[104:107], v[92:95]
    v_mfma_f32_16x16x32_bf16 v[96:99], v[40:43], a[168:171], v[96:99]
    v_mfma_f32_16x16x32_bf16 v[96:99], v[44:47], a[172:175], v[96:99]
    v_mfma_f32_16x16x32_bf16 v[96:99], v[48:51], a[176:179], v[96:99]
    v_mfma_f32_16x16x32_bf16 v[100:103], v[40:43], a[240:243], v[100:103]
    v_mfma_f32_16x16x32_bf16 v[100:103], v[44:47], a[244:247], v[100:103]
    v_mfma_f32_16x16x32_bf16 v[100:103], v[48:51], a[248:251], v[100:103]
    s_waitcnt vmcnt(24)
    v_mfma_f32_16x16x32_bf16 v[88:91], v[52:55], a[36:39], v[88:91]
    v_mfma_f32_16x16x32_bf16 v[88:91], v[56:59], a[40:43], v[88:91]
    v_mfma_f32_16x16x32_bf16 v[88:91], v[60:63], a[44:47], v[88:91]
    v_mfma_f32_16x16x32_bf16 v[92:95], v[52:55], a[108:111], v[92:95]
    v_mfma_f32_16x16x32_bf16 v[92:95], v[56:59], a[112:115], v[92:95]
    v_mfma_f32_16x16x32_bf16 v[92:95], v[60:63], a[116:119], v[92:95]
    v_mfma_f32_16x16x32_bf16 v[96:99], v[52:55], a[180:183], v[96:99]
    v_mfma_f32_16x16x32_bf16 v[96:99], v[56:59], a[184:187], v[96:99]
    v_mfma_f32_16x16x32_bf16 v[96:99], v[60:63], a[188:191], v[96:99]
    v_mfma_f32_16x16x32_bf16 v[100:103], v[52:55], a[252:255], v[100:103]
    v_mfma_f32_16x16x32_bf16 v[100:103], v[56:59], v[220:223], v[100:103]
    v_mfma_f32_16x16x32_bf16 v[100:103], v[60:63], v[224:227], v[100:103]
    s_waitcnt vmcnt(21)
    v_mfma_f32_16x16x32_bf16 v[88:91], v[64:67], a[48:51], v[88:91]
    v_mfma_f32_16x16x32_bf16 v[88:91], v[68:71], a[52:55], v[88:91]
    v_mfma_f32_16x16x32_bf16 v[88:91], v[72:75], a[56:59], v[88:91]
    v_mfma_f32_16x16x32_bf16 v[92:95], v[64:67], a[120:123], v[92:95]
    v_mfma_f32_16x16x32_bf16 v[92:95], v[68:71], a[124:127], v[92:95]
    v_mfma_f32_16x16x32_bf16 v[92:95], v[72:75], a[128:131], v[92:95]
    v_mfma_f32_16x16x32_bf16 v[96:99], v[64:67], a[192:195], v[96:99]
    v_mfma_f32_16x16x32_bf16 v[96:99], v[68:71], a[196:199], v[96:99]
    v_mfma_f32_16x16x32_bf16 v[96:99], v[72:75], a[200:203], v[96:99]
    v_mfma_f32_16x16x32_bf16 v[100:103], v[64:67], v[228:231], v[100:103]
    v_mfma_f32_16x16x32_bf16 v[100:103], v[68:71], v[232:235], v[100:103]
    v_mfma_f32_16x16x32_bf16 v[100:103], v[72:75], v[236:239], v[100:103]
    s_waitcnt vmcnt(18)
    v_mfma_f32_16x16x32_bf16 v[88:91], v[76:79], a[60:63], v[88:91]
    v_mfma_f32_16x16x32_bf16 v[88:91], v[80:83], a[64:67], v[88:91]
    v_mfma_f32_16x16x32_bf16 v[120:123], v[84:87], a[68:71], v[88:91]
    v_mfma_f32_16x16x32_bf16 v[92:95], v[76:79], a[132:135], v[92:95]
    v_mfma_f32_16x16x32_bf16 v[92:95], v[80:83], a[136:139], v[92:95]
    v_mfma_f32_16x16x32_bf16 v[124:127], v[84:87], a[140:143], v[92:95]
    v_mfma_f32_16x16x32_bf16 v[96:99], v[76:79], a[204:207], v[96:99]
    s_mov_b32 s74, 268435456
    v_mfma_f32_16x16x32_bf16 v[96:99], v[80:83], a[208:211], v[96:99]
    s_add_u32 s27, s27, 1024
    v_mfma_f32_16x16x32_bf16 v[128:131], v[84:87], a[212:215], v[96:99]
    s_add_u32 s25, s25, 1
    v_mfma_f32_16x16x32_bf16 v[100:103], v[76:79], v[240:243], v[100:103]
    v_mfma_f32_16x16x32_bf16 v[100:103], v[80:83], v[244:247], v[100:103]
    s_add_u32 s23, s23, 18432
    v_mfma_f32_16x16x32_bf16 v[132:135], v[84:87], v[248:251], v[100:103]
    s_nop 7
    v_cvt_pk_bf16_f32 v152, v120, v121
    v_cvt_pk_bf16_f32 v153, v122, v123
    v_cvt_pk_bf16_f32 v154, v124, v125
    v_cvt_pk_bf16_f32 v155, v126, v127
    v_cvt_pk_bf16_f32 v156, v128, v129
    v_cvt_pk_bf16_f32 v157, v130, v131
    v_cvt_pk_bf16_f32 v158, v132, v133
    v_cvt_pk_bf16_f32 v159, v134, v135
    s_nop 0
    v_permlane16_swap_b32 v152, v154
    v_permlane16_swap_b32 v153, v155
    buffer_store_dwordx4 v[152:155], v178, s[72:75], s27 offen sc1
    s_nop 0
    v_permlane16_swap_b32 v156, v158
    v_permlane16_swap_b32 v157, v159
    buffer_store_dwordx4 v[156:159], v179, s[72:75], s27 offen sc1
    ds_write_b128 v216, v[152:155]
    ds_write_b128 v217, v[156:159]
    s_waitcnt lgkmcnt(0)
    v_lshlrev_b32 v15, 7, v0
    s_lshl_b32 s6, s40, 2
    s_add_u32 s6, s6, s44
    s_add_u32 s6, s6, 65536
    v_mov_b32 v1, s76
    s_mov_b64 vcc, 0xff
    s_waitcnt vmcnt(0)
    s_barrier
    s_cmp_lg_u32 s3, 0
    s_cbranch_scc1 L_pub_41
    s_mov_b64 exec, vcc
    buffer_store_dword v1, v15, s[8:11], s6 offen sc1
L_pub_41:
    s_mov_b64 exec, -1
    s_add_u32 s19, s18, s43
    s_add_u32 s22, s19, 45875200
    s_lshl_b32 s23, s21, 5
    s_add_u32 s23, s23, s43
    s_add_u32 s23, s23, 48431104
    s_cmp_ge_u32 s3, 2
    s_cbranch_scc1 L_late_42
    s_load_dwordx8 s[56:63], s[38:39], 32 glc
L_late_42:
    v_and_b32 v12, 7, v0
    v_lshlrev_b32 v12, 2, v12
    buffer_load_dword v10, v12, s[8:11], s23 offen sc1
    buffer_load_dwordx4 v[92:95], v172, s[8:11], s22 offen sc1
    buffer_load_dwordx4 v[96:99], v173, s[8:11], s22 offen sc1
    buffer_load_dwordx4 v[100:103], v174, s[8:11], s22 offen sc1
    v_min_u32 v13, 9216, v173
    ds_read_b128 v[148:151], v172 offset:4096
    ds_read_b128 v[152:155], v13 offset:4096
    ds_read_b128 v[156:159], v174 offset:4096
    s_lshl_b32 s28, s40, 2
    s_add_u32 s28, s28, s3
    s_mul_i32 s28, s28, 73728
    v_and_b32 v229, 8, v0
    v_lshl_add_u32 v229, v229, 27, v253
    s_mul_i32 s7, s42, 1073741824
    v_add_u32 v3, s7, v253
    v_or_b32 v229, s7, v229
    v_lshlrev_b32 v16, 16, v104
    v_and_b32 v17, s16, v104
    v_lshlrev_b32 v18, 16, v105
    v_and_b32 v19, s16, v105
    v_lshlrev_b32 v20, 16, v106
    v_and_b32 v21, s16, v106
    v_lshlrev_b32 v22, 16, v107
    v_and_b32 v23, s16, v107
    v_lshlrev_b32 v24, 16, v108
    v_and_b32 v25, s16, v108
    v_lshlrev_b32 v26, 16, v109
    v_and_b32 v27, s16, v109
    v_lshlrev_b32 v28, 16, v110
    v_and_b32 v29, s16, v110
    v_lshlrev_b32 v30, 16, v111
    v_and_b32 v31, s16, v111
    s_cmp_ge_u32 s3, 2
    s_cbranch_scc1 L_late_43
    s_mov_b32 s6, 0
L_epoll_45:
    s_waitcnt lgkmcnt(0)
    s_xor_b64 s[56:57], s[56:57], s[76:77]
    s_xor_b64 s[58:59], s[58:59], s[76:77]
    s_xor_b64 s[60:61], s[60:61], s[76:77]
    s_xor_b64 s[62:63], s[62:63], s[76:77]
    s_or_b64 s[56:57], s[56:57], s[58:59]
    s_or_b64 s[60:61], s[60:61], s[62:63]
    s_or_b64 s[56:57], s[56:57], s[60:61]
    s_cbranch_scc0 L_epolled_46
    s_load_dwordx8 s[56:63], s[38:39], 32 glc
    s_add_u32 s6, s6, 1
    s_cmp_lt_u32 s6, 1048576
    s_cbranch_scc1 L_epoll_45
    s_branch L_main_end
L_epolled_46:
    s_add_u32 s7, s40, 1
    s_and_b32 s7, s7, 7
    s_mul_i32 s7, s7, 9216
    s_add_u32 s19, s7, s20
    buffer_load_dwordx4 v[60:63], v174, s[8:11], s19 offen sc1
    s_add_u32 s7, s40, 2
    s_and_b32 s7, s7, 7
    s_mul_i32 s7, s7, 9216
    s_add_u32 s19, s7, s20
    buffer_load_dwordx4 v[64:67], v174, s[8:11], s19 offen sc1
    s_add_u32 s7, s40, 3
    s_and_b32 s7, s7, 7
    s_mul_i32 s7, s7, 9216
    s_add_u32 s19, s7, s20
    buffer_load_dwordx4 v[68:71], v174, s[8:11], s19 offen sc1
    s_add_u32 s7, s40, 4
    s_and_b32 s7, s7, 7
    s_mul_i32 s7, s7, 9216
    s_add_u32 s19, s7, s20
    buffer_load_dwordx4 v[72:75], v174, s[8:11], s19 offen sc1
    s_add_u32 s7, s40, 5
    s_and_b32 s7, s7, 7
    s_mul_i32 s7, s7, 9216
    s_add_u32 s19, s7, s20
    buffer_load_dwordx4 v[76:79], v174, s[8:11], s19 offen sc1
    s_add_u32 s7, s40, 6
    s_and_b32 s7, s7, 7
    s_mul_i32 s7, s7, 9216
    s_add_u32 s19, s7, s20
    buffer_load_dwordx4 v[80:83], v174, s[8:11], s19 offen sc1
    s_add_u32 s7, s40, 7
    s_and_b32 s7, s7, 7
    s_mul_i32 s7, s7, 9216
    s_add_u32 s19, s7, s20
    buffer_load_dwordx4 v[84:87], v174, s[8:11], s19 offen sc1
L_late_43:
    s_cmp_lg_u32 s42, 0
    s_cbranch_scc1 L_nopf_47
    buffer_load_dwordx4 a[0:3], v3, s[8:11], s28 offen offset:0 sc1
    buffer_load_dwordx4 a[4:7], v3, s[8:11], s28 offen offset:1024 sc1
    buffer_load_dwordx4 a[8:11], v3, s[8:11], s28 offen offset:2048 sc1
    buffer_load_dwordx4 a[12:15], v229, s[8:11], s28 offen offset:3072 sc1
    s_add_u32 s28, s28, 4096
    buffer_load_dwordx4 a[16:19], v3, s[8:11], s28 offen offset:0 sc1
    buffer_load_dwordx4 a[20:23], v3, s[8:11], s28 offen offset:1024 sc1
    buffer_load_dwordx4 a[24:27], v3, s[8:11], s28 offen offset:2048 sc1
    buffer_load_dwordx4 a[28:31], v229, s[8:11], s28 offen offset:3072 sc1
L_nopf_47:
    v_lshlrev_b32 v40, 16, v112
    v_and_b32 v41, s16, v112
    v_lshlrev_b32 v42, 16, v113
    v_and_b32 v43, s16, v113
    v_lshlrev_b32 v44, 16, v114
    v_and_b32 v45, s16, v114
    v_lshlrev_b32 v46, 16, v115
    v_and_b32 v47, s16, v115
    v_pk_add_f32 v[16:17], v[16:17], v[40:41]
    v_pk_add_f32 v[18:19], v[18:19], v[42:43]
    v_pk_add_f32 v[20:21], v[20:21], v[44:45]
    v_pk_add_f32 v[22:23], v[22:23], v[46:47]
    v_lshlrev_b32 v40, 16, v116
    v_and_b32 v41, s16, v116
    v_lshlrev_b32 v42, 16, v117
    v_and_b32 v43, s16, v117
    v_lshlrev_b32 v44, 16, v118
    v_and_b32 v45, s16, v118
    v_lshlrev_b32 v46, 16, v119
    v_and_b32 v47, s16, v119
    v_pk_add_f32 v[24:25], v[24:25], v[40:41]
    v_pk_add_f32 v[26:27], v[26:27], v[42:43]
    v_pk_add_f32 v[28:29], v[28:29], v[44:45]
    v_pk_add_f32 v[30:31], v[30:31], v[46:47]
    s_cmp_lg_u32 s42, 0
    s_cbranch_scc1 L_nopf_48
    s_add_u32 s28, s28, 4096
    buffer_load_dwordx4 a[32:35], v3, s[8:11], s28 offen offset:0 sc1
    buffer_load_dwordx4 a[36:39], v3, s[8:11], s28 offen offset:1024 sc1
    buffer_load_dwordx4 a[40:43], v3, s[8:11], s28 offen offset:2048 sc1
    buffer_load_dwordx4 a[44:47], v229, s[8:11], s28 offen offset:3072 sc1
    s_add_u32 s28, s28, 4096
    buffer_load_dwordx4 a[48:51], v3, s[8:11], s28 offen offset:0 sc1
    buffer_load_dwordx4 a[52:55], v3, s[8:11], s28 offen offset:1024 sc1
    buffer_load_dwordx4 a[56:59], v3, s[8:11], s28 offen offset:2048 sc1
    buffer_load_dwordx4 a[60:63], v229, s[8:11], s28 offen offset:3072 sc1
L_nopf_48:
    v_lshlrev_b32 v40, 16, v180
    v_and_b32 v41, s16, v180
    v_lshlrev_b32 v42, 16, v181
    v_and_b32 v43, s16, v181
    v_lshlrev_b32 v44, 16, v182
    v_and_b32 v45, s16, v182
    v_lshlrev_b32 v46, 16, v183
    v_and_b32 v47, s16, v183
    v_pk_add_f32 v[16:17], v[16:17], v[40:41]
    v_pk_add_f32 v[18:19], v[18:19], v[42:43]
    v_pk_add_f32 v[20:21], v[20:21], v[44:45]
    v_pk_add_f32 v[22:23], v[22:23], v[46:47]
    v_lshlrev_b32 v40, 16, v196
    v_and_b32 v41, s16, v196
    v_lshlrev_b32 v42, 16, v197
    v_and_b32 v43, s16, v197
    v_lshlrev_b32 v44, 16, v198
    v_and_b32 v45, s16, v198
    v_lshlrev_b32 v46, 16, v199
    v_and_b32 v47, s16, v199
    v_pk_add_f32 v[24:25], v[24:25], v[40:41]
    v_pk_add_f32 v[26:27], v[26:27], v[42:43]
    v_pk_add_f32 v[28:29], v[28:29], v[44:45]
    v_pk_add_f32 v[30:31], v[30:31], v[46:47]
    v_lshlrev_b32 v40, 16, v200
    v_and_b32 v41, s16, v200
    v_lshlrev_b32 v42, 16, v201
    v_and_b32 v43, s16, v201
    v_lshlrev_b32 v44, 16, v202
    v_and_b32 v45, s16, v202
    v_lshlrev_b32 v46, 16, v203
    v_and_b32 v47, s16, v203
    v_pk_add_f32 v[16:17], v[16:17], v[40:41]
    v_pk_add_f32 v[18:19], v[18:19], v[42:43]
    v_pk_add_f32 v[20:21], v[20:21], v[44:45]
    v_pk_add_f32 v[22:23], v[22:23], v[46:47]
    v_lshlrev_b32 v40, 16, v204
    v_and_b32 v41, s16, v204
    v_lshlrev_b32 v42, 16, v205
    v_and_b32 v43, s16, v205
    v_lshlrev_b32 v44, 16, v206
    v_and_b32 v45, s16, v206
    v_lshlrev_b32 v46, 16, v207
    v_and_b32 v47, s16, v207
    v_pk_add_f32 v[24:25], v[24:25], v[40:41]
    v_pk_add_f32 v[26:27], v[26:27], v[42:43]
    v_pk_add_f32 v[28:29], v[28:29], v[44:45]
    v_pk_add_f32 v[30:31], v[30:31], v[46:47]
    v_lshlrev_b32 v40, 16, v208
    v_and_b32 v41, s16, v208
    v_lshlrev_b32 v42, 16, v209
    v_and_b32 v43, s16, v209
    v_lshlrev_b32 v44, 16, v210
    v_and_b32 v45, s16, v210
    v_lshlrev_b32 v46, 16, v211
    v_and_b32 v47, s16, v211
    v_pk_add_f32 v[16:17], v[16:17], v[40:41]
    v_pk_add_f32 v[18:19], v[18:19], v[42:43]
    v_pk_add_f32 v[20:21], v[20:21], v[44:45]
    v_pk_add_f32 v[22:23], v[22:23], v[46:47]
    v_lshlrev_b32 v40, 16, v212
    v_and_b32 v41, s16, v212
    v_lshlrev_b32 v42, 16, v213
    v_and_b32 v43, s16, v213
    v_lshlrev_b32 v44, 16, v214
    v_and_b32 v45, s16, v214
    v_lshlrev_b32 v46, 16, v215
    v_and_b32 v47, s16, v215
    v_pk_add_f32 v[24:25], v[24:25], v[40:41]
    v_pk_add_f32 v[26:27], v[26:27], v[42:43]
    v_pk_add_f32 v[28:29], v[28:29], v[44:45]
    v_pk_add_f32 v[30:31], v[30:31], v[46:47]
    v_lshlrev_b32 v40, 16, v136
    v_and_b32 v41, s16, v136
    v_lshlrev_b32 v42, 16, v137
    v_and_b32 v43, s16, v137
    v_lshlrev_b32 v44, 16, v138
    v_and_b32 v45, s16, v138
    v_lshlrev_b32 v46, 16, v139
    v_and_b32 v47, s16, v139
    v_pk_add_f32 v[16:17], v[16:17], v[40:41]
    v_pk_add_f32 v[18:19], v[18:19], v[42:43]
    v_pk_add_f32 v[20:21], v[20:21], v[44:45]
    v_pk_add_f32 v[22:23], v[22:23], v[46:47]
    v_lshlrev_b32 v40, 16, v140
    v_and_b32 v41, s16, v140
    v_lshlrev_b32 v42, 16, v141
    v_and_b32 v43, s16, v141
    v_lshlrev_b32 v44, 16, v142
    v_and_b32 v45, s16, v142
    v_lshlrev_b32 v46, 16, v143
    v_and_b32 v47, s16, v143
    v_pk_add_f32 v[24:25], v[24:25], v[40:41]
    v_pk_add_f32 v[26:27], v[26:27], v[42:43]
    v_pk_add_f32 v[28:29], v[28:29], v[44:45]
    v_pk_add_f32 v[30:31], v[30:31], v[46:47]
    v_lshlrev_b32 v40, 16, v144
    v_and_b32 v41, s16, v144
    v_lshlrev_b32 v42, 16, v145
    v_and_b32 v43, s16, v145
    v_lshlrev_b32 v44, 16, v146
    v_and_b32 v45, s16, v146
    v_lshlrev_b32 v46, 16, v147
    v_and_b32 v47, s16, v147
    v_pk_add_f32 v[16:17], v[16:17], v[40:41]
    v_pk_add_f32 v[18:19], v[18:19], v[42:43]
    v_pk_add_f32 v[20:21], v[20:21], v[44:45]
    v_pk_add_f32 v[22:23], v[22:23], v[46:47]
    v_lshlrev_b32 v40, 16, v160
    v_and_b32 v41, s16, v160
    v_lshlrev_b32 v42, 16, v161
    v_and_b32 v43, s16, v161
    v_lshlrev_b32 v44, 16, v162
    v_and_b32 v45, s16, v162
    v_lshlrev_b32 v46, 16, v163
    v_and_b32 v47, s16, v163
    v_pk_add_f32 v[24:25], v[24:25], v[40:41]
    v_pk_add_f32 v[26:27], v[26:27], v[42:43]
    v_pk_add_f32 v[28:29], v[28:29], v[44:45]
    v_pk_add_f32 v[30:31], v[30:31], v[46:47]
    s_cmp_lg_u32 s3, 3
    s_cbranch_scc1 L_pollout_51
    s_lshl_b32 s7, s40, 7
    s_add_u32 s7, s7, s44
    s_add_u32 s7, s7, 65536
    s_add_u32 s52, s4, s7
    s_addc_u32 s53, s5, 0
    s_mov_b32 s6, 0
L_poll_49:
    s_load_dwordx8 s[56:63], s[52:53], 0 glc
    s_add_u32 s6, s6, 1
    s_waitcnt lgkmcnt(0)
    s_xor_b64 s[56:57], s[56:57], s[76:77]
    s_xor_b64 s[58:59], s[58:59], s[76:77]
    s_xor_b64 s[60:61], s[60:61], s[76:77]
    s_xor_b64 s[62:63], s[62:63], s[76:77]
    s_or_b64 s[56:57], s[56:57], s[58:59]
    s_or_b64 s[60:61], s[60:61], s[62:63]
    s_or_b64 s[56:57], s[56:57], s[60:61]
    s_cbranch_scc0 L_polled_50
    s_cmp_lt_u32 s6, 1048576
    s_cbranch_scc1 L_poll_49
    s_branch L_main_end
L_polled_50:
L_pollout_51:
    s_barrier
    s_cmp_lt_u32 s3, 2
    s_cbranch_scc1 L_late_44
    s_add_u32 s7, s40, 1
    s_and_b32 s7, s7, 7
    s_mul_i32 s7, s7, 9216
    s_add_u32 s19, s7, s20
    buffer_load_dwordx4 v[60:63], v174, s[8:11], s19 offen sc1
    s_add_u32 s7, s40, 2
    s_and_b32 s7, s7, 7
    s_mul_i32 s7, s7, 9216
    s_add_u32 s19, s7, s20
    buffer_load_dwordx4 v[64:67], v174, s[8:11], s19 offen sc1
    s_add_u32 s7, s40, 3
    s_and_b32 s7, s7, 7
    s_mul_i32 s7, s7, 9216
    s_add_u32 s19, s7, s20
    buffer_load_dwordx4 v[68:71], v174, s[8:11], s19 offen sc1
    s_add_u32 s7, s40, 4
    s_and_b32 s7, s7, 7
    s_mul_i32 s7, s7, 9216
    s_add_u32 s19, s7, s20
    buffer_load_dwordx4 v[72:75], v174, s[8:11], s19 offen sc1
    s_add_u32 s7, s40, 5
    s_and_b32 s7, s7, 7
    s_mul_i32 s7, s7, 9216
    s_add_u32 s19, s7, s20
    buffer_load_dwordx4 v[76:79], v174, s[8:11], s19 offen sc1
    s_add_u32 s7, s40, 6
    s_and_b32 s7, s7, 7
    s_mul_i32 s7, s7, 9216
    s_add_u32 s19, s7, s20
    buffer_load_dwordx4 v[80:83], v174, s[8:11], s19 offen sc1
    s_add_u32 s7, s40, 7
    s_and_b32 s7, s7, 7
    s_mul_i32 s7, s7, 9216
    s_add_u32 s19, s7, s20
    buffer_load_dwordx4 v[84:87], v174, s[8:11], s19 offen sc1
L_late_44:
    s_cmp_eq_u32 s3, 0
    s_cselect_b32 s7, 1.0, 0
    s_cselect_b32 s6, -1, 0
    s_waitcnt vmcnt(7) lgkmcnt(0)
    v_and_b32 v152, s6, v152
    v_and_b32 v153, s6, v153
    v_and_b32 v154, s6, v154
    v_and_b32 v155, s6, v155
    v_mul_f32 v11, s7, v10
    v_lshlrev_b32 v40, 16, v92
    v_and_b32 v41, s16, v92
    v_lshlrev_b32 v42, 16, v93
    v_and_b32 v43, s16, v93
    v_lshlrev_b32 v44, 16, v94
    v_and_b32 v45, s16, v94
    v_lshlrev_b32 v46, 16, v95
    v_and_b32 v47, s16, v95
    v_pk_add_f32 v[16:17], v[16:17], v[40:41]
    v_pk_add_f32 v[18:19], v[18:19], v[42:43]
    v_pk_add_f32 v[20:21], v[20:21], v[44:45]
    v_pk_add_f32 v[22:23], v[22:23], v[46:47]
    v_lshlrev_b32 v40, 16, v96
    v_and_b32 v41, s16, v96
    v_lshlrev_b32 v42, 16, v97
    v_and_b32 v43, s16, v97
    v_lshlrev_b32 v44, 16, v98
    v_and_b32 v45, s16, v98
    v_lshlrev_b32 v46, 16, v99
    v_and_b32 v47, s16, v99
    v_pk_add_f32 v[24:25], v[24:25], v[40:41]
    v_pk_add_f32 v[26:27], v[26:27], v[42:43]
    v_pk_add_f32 v[28:29], v[28:29], v[44:45]
    v_pk_add_f32 v[30:31], v[30:31], v[46:47]
    v_lshlrev_b32 v32, 16, v100
    v_and_b32 v33, s16, v100
    v_lshlrev_b32 v34, 16, v101
    v_and_b32 v35, s16, v101
    v_lshlrev_b32 v36, 16, v102
    v_and_b32 v37, s16, v102
    v_lshlrev_b32 v38, 16, v103
    v_and_b32 v39, s16, v103
    v_lshlrev_b32 v40, 16, v148
    v_and_b32 v41, s16, v148
    v_lshlrev_b32 v42, 16, v149
    v_and_b32 v43, s16, v149
    v_lshlrev_b32 v44, 16, v150
    v_and_b32 v45, s16, v150
    v_lshlrev_b32 v46, 16, v151
    v_and_b32 v47, s16, v151
    v_pk_add_f32 v[16:17], v[16:17], v[40:41]
    v_pk_add_f32 v[18:19], v[18:19], v[42:43]
    v_pk_add_f32 v[20:21], v[20:21], v[44:45]
    v_pk_add_f32 v[22:23], v[22:23], v[46:47]
    v_lshlrev_b32 v40, 16, v152
    v_and_b32 v41, s16, v152
    v_lshlrev_b32 v42, 16, v153
    v_and_b32 v43, s16, v153
    v_lshlrev_b32 v44, 16, v154
    v_and_b32 v45, s16, v154
    v_lshlrev_b32 v46, 16, v155
    v_and_b32 v47, s16, v155
    v_pk_add_f32 v[24:25], v[24:25], v[40:41]
    v_pk_add_f32 v[26:27], v[26:27], v[42:43]
    v_pk_add_f32 v[28:29], v[28:29], v[44:45]
    v_pk_add_f32 v[30:31], v[30:31], v[46:47]
    v_lshlrev_b32 v40, 16, v156
    v_and_b32 v41, s16, v156
    v_lshlrev_b32 v42, 16, v157
    v_and_b32 v43, s16, v157
    v_lshlrev_b32 v44, 16, v158
    v_and_b32 v45, s16, v158
    v_lshlrev_b32 v46, 16, v159
    v_and_b32 v47, s16, v159
    v_pk_add_f32 v[32:33], v[32:33], v[40:41]
    v_pk_add_f32 v[34:35], v[34:35], v[42:43]
    v_pk_add_f32 v[36:37], v[36:37], v[44:45]
    v_pk_add_f32 v[38:39], v[38:39], v[46:47]
    v_pk_add_f32 v[16:17], v[16:17], v[10:11] op_sel_hi:[1,0]
    v_pk_add_f32 v[18:19], v[18:19], v[10:11] op_sel_hi:[1,0]
    v_pk_add_f32 v[20:21], v[20:21], v[10:11] op_sel_hi:[1,0]
    v_pk_add_f32 v[22:23], v[22:23], v[10:11] op_sel_hi:[1,0]
    v_pk_add_f32 v[24:25], v[24:25], v[10:11] op_sel:[0,1] op_sel_hi:[1,1]
    v_pk_add_f32 v[26:27], v[26:27], v[10:11] op_sel:[0,1] op_sel_hi:[1,1]
    v_pk_add_f32 v[28:29], v[28:29], v[10:11] op_sel:[0,1] op_sel_hi:[1,1]
    v_pk_add_f32 v[30:31], v[30:31], v[10:11] op_sel:[0,1] op_sel_hi:[1,1]
    v_pk_add_f32 v[32:33], v[32:33], v[10:11] op_sel_hi:[1,0]
    v_pk_add_f32 v[34:35], v[34:35], v[10:11] op_sel_hi:[1,0]
    v_pk_add_f32 v[36:37], v[36:37], v[10:11] op_sel_hi:[1,0]
    v_pk_add_f32 v[38:39], v[38:39], v[10:11] op_sel_hi:[1,0]
    s_waitcnt vmcnt(6)
    s_add_u32 s28, s28, 4096
    buffer_load_dwordx4 a[64:67], v3, s[8:11], s28 offen offset:0 sc1
    v_lshlrev_b32 v40, 16, v60
    v_and_b32 v41, s16, v60
    v_lshlrev_b32 v42, 16, v61
    v_and_b32 v43, s16, v61
    v_lshlrev_b32 v44, 16, v62
    v_and_b32 v45, s16, v62
    v_lshlrev_b32 v46, 16, v63
    v_and_b32 v47, s16, v63
    v_pk_add_f32 v[32:33], v[32:33], v[40:41]
    v_pk_add_f32 v[34:35], v[34:35], v[42:43]
    v_pk_add_f32 v[36:37], v[36:37], v[44:45]
    v_pk_add_f32 v[38:39], v[38:39], v[46:47]
    s_waitcnt vmcnt(6)
    buffer_load_dwordx4 a[68:71], v3, s[8:11], s28 offen offset:1024 sc1
    v_lshlrev_b32 v40, 16, v64
    v_and_b32 v41, s16, v64
    v_lshlrev_b32 v42, 16, v65
    v_and_b32 v43, s16, v65
    v_lshlrev_b32 v44, 16, v66
    v_and_b32 v45, s16, v66
    v_lshlrev_b32 v46, 16, v67
    v_and_b32 v47, s16, v67
    v_pk_add_f32 v[32:33], v[32:33], v[40:41]
    v_pk_add_f32 v[34:35], v[34:35], v[42:43]
    v_pk_add_f32 v[36:37], v[36:37], v[44:45]
    v_pk_add_f32 v[38:39], v[38:39], v[46:47]
    s_waitcnt vmcnt(6)
    buffer_load_dwordx4 a[72:75], v3, s[8:11], s28 offen offset:2048 sc1
    v_lshlrev_b32 v40, 16, v68
    v_and_b32 v41, s16, v68
    v_lshlrev_b32 v42, 16, v69
    v_and_b32 v43, s16, v69
    v_lshlrev_b32 v44, 16, v70
    v_and_b32 v45, s16, v70
    v_lshlrev_b32 v46, 16, v71
    v_and_b32 v47, s16, v71
    v_pk_add_f32 v[32:33], v[32:33], v[40:41]
    v_pk_add_f32 v[34:35], v[34:35], v[42:43]
    v_pk_add_f32 v[36:37], v[36:37], v[44:45]
    v_pk_add_f32 v[38:39], v[38:39], v[46:47]
    s_waitcnt vmcnt(6)
    buffer_load_dwordx4 a[76:79], v229, s[8:11], s28 offen offset:3072 sc1
    v_lshlrev_b32 v40, 16, v72
    v_and_b32 v41, s16, v72
    v_lshlrev_b32 v42, 16, v73
    v_and_b32 v43, s16, v73
    v_lshlrev_b32 v44, 16, v74
    v_and_b32 v45, s16, v74
    v_lshlrev_b32 v46, 16, v75
    v_and_b32 v47, s16, v75
    v_pk_add_f32 v[32:33], v[32:33], v[40:41]
    v_pk_add_f32 v[34:35], v[34:35], v[42:43]
    v_pk_add_f32 v[36:37], v[36:37], v[44:45]
    v_pk_add_f32 v[38:39], v[38:39], v[46:47]
    s_waitcnt vmcnt(6)
    s_add_u32 s28, s28, 4096
    buffer_load_dwordx4 a[80:83], v3, s[8:11], s28 offen offset:0 sc1
    v_lshlrev_b32 v40, 16, v76
    v_and_b32 v41, s16, v76
    v_lshlrev_b32 v42, 16, v77
    v_and_b32 v43, s16, v77
    v_lshlrev_b32 v44, 16, v78
    v_and_b32 v45, s16, v78
    v_lshlrev_b32 v46, 16, v79
    v_and_b32 v47, s16, v79
    v_pk_add_f32 v[32:33], v[32:33], v[40:41]
    v_pk_add_f32 v[34:35], v[34:35], v[42:43]
    v_pk_add_f32 v[36:37], v[36:37], v[44:45]
    v_pk_add_f32 v[38:39], v[38:39], v[46:47]
    s_waitcnt vmcnt(6)
    buffer_load_dwordx4 a[84:87], v3, s[8:11], s28 offen offset:1024 sc1
    v_lshlrev_b32 v40, 16, v80
    v_and_b32 v41, s16, v80
    v_lshlrev_b32 v42, 16, v81
    v_and_b32 v43, s16, v81
    v_lshlrev_b32 v44, 16, v82
    v_and_b32 v45, s16, v82
    v_lshlrev_b32 v46, 16, v83
    v_and_b32 v47, s16, v83
    v_pk_add_f32 v[32:33], v[32:33], v[40:41]
    v_pk_add_f32 v[34:35], v[34:35], v[42:43]
    v_pk_add_f32 v[36:37], v[36:37], v[44:45]
    v_pk_add_f32 v[38:39], v[38:39], v[46:47]
    s_waitcnt vmcnt(6)
    buffer_load_dwordx4 a[88:91], v3, s[8:11], s28 offen offset:2048 sc1
    v_lshlrev_b32 v40, 16, v84
    v_and_b32 v41, s16, v84
    v_lshlrev_b32 v42, 16, v85
    v_and_b32 v43, s16, v85
    v_lshlrev_b32 v44, 16, v86
    v_and_b32 v45, s16, v86
    v_lshlrev_b32 v46, 16, v87
    v_and_b32 v47, s16, v87
    v_pk_add_f32 v[32:33], v[32:33], v[40:41]
    v_pk_add_f32 v[34:35], v[34:35], v[42:43]
    v_pk_add_f32 v[36:37], v[36:37], v[44:45]
    v_pk_add_f32 v[38:39], v[38:39], v[46:47]
    buffer_load_dwordx4 a[92:95], v229, s[8:11], s28 offen offset:3072 sc1
    v_cvt_pk_bf16_f32 v120, v16, v17
    v_cvt_pk_bf16_f32 v121, v18, v19
    v_cvt_pk_bf16_f32 v122, v20, v21
    v_cvt_pk_bf16_f32 v123, v22, v23
    v_cvt_pk_bf16_f32 v124, v24, v25
    v_cvt_pk_bf16_f32 v125, v26, v27
    v_cvt_pk_bf16_f32 v126, v28, v29
    v_cvt_pk_bf16_f32 v127, v30, v31
    v_cvt_pk_bf16_f32 v128, v32, v33
    v_cvt_pk_bf16_f32 v129, v34, v35
    v_cvt_pk_bf16_f32 v130, v36, v37
    v_cvt_pk_bf16_f32 v131, v38, v39
    s_cmp_lg_u32 s42, 0
    s_cbranch_scc1 L_main_last
    s_add_u32 s19, s18, 53215232
    s_add_u32 s20, s18, 48496640
    s_lshl_b32 s22, s21, 7
    s_add_u32 s22, s22, 57933824
    buffer_store_dwordx4 v[120:123], v172, s[8:11], s19 offen sc1
    buffer_store_dwordx4 v[124:127], v173, s[8:11], s19 offen sc1
    buffer_store_dwordx4 v[128:131], v174, s[8:11], s19 offen sc1
    s_mov_b32 s17, 0x3f803f80
    v_mov_b32 v8, 0
    v_mov_b32 v9, 0
    v_mov_b32 v10, 0
    v_mov_b32 v11, 0
    v_dot2c_f32_bf16 v8, s17, v120
    v_dot2c_f32_bf16 v9, v120, v120
    v_dot2c_f32_bf16 v10, s17, v121
    v_dot2c_f32_bf16 v11, v121, v121
    v_dot2c_f32_bf16 v8, s17, v122
    v_dot2c_f32_bf16 v9, v122, v122
    v_dot2c_f32_bf16 v10, s17, v123
    v_dot2c_f32_bf16 v11, v123, v123
    v_dot2c_f32_bf16 v8, s17, v124
    v_dot2c_f32_bf16 v9, v124, v124
    v_dot2c_f32_bf16 v10, s17, v125
    v_dot2c_f32_bf16 v11, v125, v125
    v_dot2c_f32_bf16 v8, s17, v126
    v_dot2c_f32_bf16 v9, v126, v126
    v_dot2c_f32_bf16 v10, s17, v127
    v_dot2c_f32_bf16 v11, v127, v127
    v_dot2c_f32_bf16 v8, s17, v128
    v_dot2c_f32_bf16 v9, v128, v128
    v_dot2c_f32_bf16 v10, s17, v129
    v_dot2c_f32_bf16 v11, v129, v129
    v_dot2c_f32_bf16 v8, s17, v130
    v_dot2c_f32_bf16 v9, v130, v130
    v_dot2c_f32_bf16 v10, s17, v131
    v_dot2c_f32_bf16 v11, v131, v131
    v_and_b32 v12, 7, v0
    v_lshlrev_b32 v12, 3, v12
    s_lshl_b32 s7, s3, 6
    v_add_u32 v13, s7, v12
    v_pk_add_f32 v[8:9], v[8:9], v[10:11]
    s_nop 1
    v_add_f32_dpp v8, v8, v8 row_ror:8 row_mask:0xf bank_mask:0xf
    v_add_f32_dpp v9, v9, v9 row_ror:8 row_mask:0xf bank_mask:0xf
    v_mov_b32 v10, v8
    v_mov_b32 v11, v9
    s_nop 1
    v_permlane32_swap_b32 v10, v8
    v_permlane32_swap_b32 v11, v9
    v_add_f32 v8, v8, v10
    v_add_f32 v9, v9, v11
    v_mov_b32 v10, v8
    v_mov_b32 v11, v9
    s_nop 1
    v_permlane16_swap_b32 v10, v8
    v_permlane16_swap_b32 v11, v9
    v_add_f32 v8, v8, v10
    v_add_f32 v9, v9, v11
    ds_write_b64 v13, v[8:9]
    s_waitcnt lgkmcnt(0)
    s_barrier
    ds_read_b64 v[40:41], v12 offset:0
    ds_read_b64 v[42:43], v12 offset:64
    ds_read_b64 v[44:45], v12 offset:128
    ds_read_b64 v[46:47], v12 offset:192
    s_waitcnt lgkmcnt(0)
    v_pk_add_f32 v[40:41], v[40:41], v[42:43]
    v_pk_add_f32 v[44:45], v[44:45], v[46:47]
    v_pk_add_f32 v[8:9], v[40:41], v[44:45]
    v_mul_f32 v8, 0x3ae38e39, v8
    v_mul_f32 v9, 0x3ae38e39, v9
    v_fma_f32 v9, -v8, v8, v9
    v_max_f32 v9, 0, v9
    v_add_f32 v9, 0x3727c5ac, v9
    v_rsq_f32 v10, v9
    s_nop 0
    v_mul_f32 v12, v8, v10
    v_mov_b32 v11, v10
    v_sub_f32 v12, 0, v12
    v_mov_b32 v13, v12
    s_cmp_eq_u32 s3, 0
    s_cselect_b32 s7, 32, 0
    v_lshlrev_b32 v14, 2, v0
    v_cmp_gt_u32 vcc, s7, v0
    v_mov_b32 v9, 1073741824
    s_nop 0
    v_cndmask_b32 v14, v9, v14, vcc
    buffer_store_dword v8, v14, s[8:11], s22 offen sc1
    v_lshlrev_b32 v40, 16, v120
    v_and_b32 v41, s16, v120
    v_lshlrev_b32 v42, 16, v121
    v_and_b32 v43, s16, v121
    v_lshlrev_b32 v44, 16, v122
    v_and_b32 v45, s16, v122
    v_lshlrev_b32 v46, 16, v123
    v_and_b32 v47, s16, v123
    v_pk_fma_f32 v[40:41], v[40:41], v[10:11], v[12:13]
    v_pk_fma_f32 v[42:43], v[42:43], v[10:11], v[12:13]
    v_pk_fma_f32 v[44:45], v[44:45], v[10:11], v[12:13]
    v_pk_fma_f32 v[46:47], v[46:47], v[10:11], v[12:13]
    v_cvt_pk_bf16_f32 v48, v40, v41
    v_cvt_pk_bf16_f32 v49, v42, v43
    v_cvt_pk_bf16_f32 v50, v44, v45
    v_cvt_pk_bf16_f32 v51, v46, v47
    v_lshlrev_b32 v40, 16, v124
    v_and_b32 v41, s16, v124
    v_lshlrev_b32 v42, 16, v125
    v_and_b32 v43, s16, v125
    v_lshlrev_b32 v44, 16, v126
    v_and_b32 v45, s16, v126
    v_lshlrev_b32 v46, 16, v127
    v_and_b32 v47, s16, v127
    v_pk_fma_f32 v[40:41], v[40:41], v[10:11], v[12:13]
    v_pk_fma_f32 v[42:43], v[42:43], v[10:11], v[12:13]
    v_pk_fma_f32 v[44:45], v[44:45], v[10:11], v[12:13]
    v_pk_fma_f32 v[46:47], v[46:47], v[10:11], v[12:13]
    v_cvt_pk_bf16_f32 v52, v40, v41
    v_cvt_pk_bf16_f32 v53, v42, v43
    v_cvt_pk_bf16_f32 v54, v44, v45
    v_cvt_pk_bf16_f32 v55, v46, v47
    v_lshlrev_b32 v40, 16, v128
    v_and_b32 v41, s16, v128
    v_lshlrev_b32 v42, 16, v129
    v_and_b32 v43, s16, v129
    v_lshlrev_b32 v44, 16, v130
    v_and_b32 v45, s16, v130
    v_lshlrev_b32 v46, 16, v131
    v_and_b32 v47, s16, v131
    v_pk_fma_f32 v[40:41], v[40:41], v[10:11], v[12:13]
    v_pk_fma_f32 v[42:43], v[42:43], v[10:11], v[12:13]
    v_pk_fma_f32 v[44:45], v[44:45], v[10:11], v[12:13]
    v_pk_fma_f32 v[46:47], v[46:47], v[10:11], v[12:13]
    v_cvt_pk_bf16_f32 v56, v40, v41
    v_cvt_pk_bf16_f32 v57, v42, v43
    v_cvt_pk_bf16_f32 v58, v44, v45
    v_cvt_pk_bf16_f32 v59, v46, v47
    buffer_store_dwordx4 v[48:51], v172, s[8:11], s20 offen sc1
    buffer_store_dwordx4 v[52:55], v173, s[8:11], s20 offen sc1
    buffer_store_dwordx4 v[56:59], v174, s[8:11], s20 offen sc1
    v_lshlrev_b32 v15, 7, v0
    s_lshl_b32 s6, s40, 2
    s_add_u32 s6, s6, s44
    s_add_u32 s6, s6, 98304
    v_mov_b32 v1, s76
    s_mov_b64 vcc, 0xff
    v_lshrrev_b32 v14, 3, v0
    v_lshl_add_u32 v15, v14, 3, v15
    s_cmp_ge_u32 s40, 6
    s_cselect_b32 s7, s41, 31
    s_cmp_lt_u32 s7, 31
    s_cmov_b64 vcc, 0xffff
    s_waitcnt vmcnt(0)
    s_barrier
    s_cmp_lg_u32 s3, 0
    s_cbranch_scc1 L_pub_52
    s_mov_b64 exec, vcc
    buffer_store_dword v1, v15, s[8:11], s6 offen sc1
L_pub_52:
    s_mov_b64 exec, -1
    s_add_u32 s28, s28, 4096
    buffer_load_dwordx4 a[96:99], v3, s[8:11], s28 offen offset:0 sc1
    buffer_load_dwordx4 a[100:103], v3, s[8:11], s28 offen offset:1024 sc1
    buffer_load_dwordx4 a[104:107], v3, s[8:11], s28 offen offset:2048 sc1
    buffer_load_dwordx4 a[108:111], v229, s[8:11], s28 offen offset:3072 sc1
    s_add_u32 s28, s28, 4096
    buffer_load_dwordx4 a[112:115], v3, s[8:11], s28 offen offset:0 sc1
    buffer_load_dwordx4 a[116:119], v3, s[8:11], s28 offen offset:1024 sc1
    buffer_load_dwordx4 a[120:123], v3, s[8:11], s28 offen offset:2048 sc1
    buffer_load_dwordx4 a[124:127], v229, s[8:11], s28 offen offset:3072 sc1
    s_add_u32 s28, s28, 4096
    buffer_load_dwordx4 a[128:131], v3, s[8:11], s28 offen offset:0 sc1
    buffer_load_dwordx4 a[132:135], v3, s[8:11], s28 offen offset:1024 sc1
    buffer_load_dwordx4 a[136:139], v3, s[8:11], s28 offen offset:2048 sc1
    buffer_load_dwordx4 a[140:143], v229, s[8:11], s28 offen offset:3072 sc1
    s_add_u32 s28, s28, 4096
    s_mov_b32 s42, 1
    s_mov_b32 s43, 9699328
    s_add_u32 s44, s44, 131072
    s_branch L_main_layer
L_main_last:
    buffer_store_dwordx4 v[120:123], v175, s[12:15], s18 offen sc0 sc1
    buffer_store_dwordx4 v[124:127], v176, s[12:15], s18 offen sc0 sc1
    buffer_store_dwordx4 v[128:131], v177, s[12:15], s18 offen sc0 sc1
    s_or_b32 s7, s40, s41
    s_or_b32 s7, s7, s3
    s_cbranch_scc1 L_done_53
    v_mov_b32 v1, s76
    s_mov_b32 s7, 19660800
    s_mov_b64 exec, 1
    buffer_store_dword v1, off, s[8:11], s7 sc1
    s_mov_b64 exec, -1
L_done_53:
L_main_end:
    s_endpgm
L_main_code_end:
.section .rodata,"a"
.p2align 6
.amdhsa_kernel interleave_layers__sliding_local_dilated__glu_gated_geglu__prompt_kernel
.amdhsa_next_free_vgpr 512
.amdhsa_next_free_sgpr 102
.amdhsa_accum_offset 256
.amdhsa_group_segment_fixed_size 0
.amdhsa_kernarg_size 80
.amdhsa_user_sgpr_count 2
.amdhsa_user_sgpr_kernarg_segment_ptr 1
.amdhsa_system_sgpr_workgroup_id_x 1
.amdhsa_float_denorm_mode_32 3
.amdhsa_float_denorm_mode_16_64 3
.end_amdhsa_kernel
```

```asm
; @launch grid=(256,1,1) block=(256,1,1) lds=163840
.amdgcn_target "amdgcn-amd-amdhsa--gfx950"
.text
.globl interleave_layers__sliding_local_dilated__glu_gated_geglu__prompt_kernel
.p2align 8
.type interleave_layers__sliding_local_dilated__glu_gated_geglu__prompt_kernel,@function
interleave_layers__sliding_local_dilated__glu_gated_geglu__prompt_kernel:
    s_cmp_ge_u32 s2, 256
    s_cbranch_scc1 L_main_end
    s_load_dwordx2 s[4:5], s[0:1], 72
    s_load_dwordx4 s[16:19], s[0:1], 0
    s_load_dwordx2 s[22:23], s[0:1], 16
    s_load_dwordx8 s[24:31], s[0:1], 32
    s_getpc_b64 s[96:97]
L_main_pc:
    s_sub_u32 s96, s96, L_main_pc-interleave_layers__sliding_local_dilated__glu_gated_geglu__prompt_kernel
    s_subb_u32 s97, s97, 0
    s_and_b32 s97, s97, 0xffff
    s_mov_b32 s98, L_main_code_end-interleave_layers__sliding_local_dilated__glu_gated_geglu__prompt_kernel
    s_mov_b32 s99, 0x20000
    s_lshr_b32 s7, s2, 3
    s_lshl_b32 s7, s7, 11
    v_lshl_add_u32 v253, v0, 3, s7
    buffer_load_dwordx2 v[2:3], v253, s[96:99], 0 offen
    v_lshrrev_b32 v1, 6, v0
    v_and_b32 v0, 63, v0
    v_readfirstlane_b32 s3, v1
    s_waitcnt lgkmcnt(0)
    s_mov_b32 s8, s4
    s_and_b32 s9, s5, 0xffff
    s_mov_b32 s10, 268435456
    s_mov_b32 s11, 0x20000
    s_mov_b32 s7, 19660800
    s_load_dword s76, s[4:5], s7
    s_mov_b64 s[20:21], s[18:19]
    s_mov_b64 s[18:19], s[16:17]
    s_mov_b32 s48, s4
    s_and_b32 s49, s5, 0xffff
    s_mov_b32 s50, 268435456
    s_mov_b32 s51, 0x20000
    s_and_b32 s40, s2, 3
    s_lshl_b32 s40, s40, 1
    s_bfe_u32 s7, s2, 65539
    s_add_u32 s40, s40, s7
    s_bfe_u32 s41, s2, 65538
    s_lshl_b32 s41, s41, 4
    s_lshr_b32 s7, s2, 4
    s_add_u32 s41, s41, s7
    s_mov_b32 s42, 0
    s_mov_b32 s43, 0
    s_lshl_b32 s44, s41, 10
    s_add_u32 s44, s44, 19169280
    v_lshlrev_b32 v253, 4, v0
    s_mov_b32 s12, s18
    s_and_b32 s13, s19, 0xffff
    s_mov_b32 s14, 2359296
    s_mov_b32 s15, 0x20000
    s_mov_b32 s64, s20
    s_and_b32 s65, s21, 0xffff
    s_mov_b32 s66, 1990656
    s_mov_b32 s67, 0x20000
    s_mov_b32 s68, s22
    s_and_b32 s69, s23, 0xffff
    s_mov_b32 s70, 663552
    s_mov_b32 s71, 0x20000
    s_mov_b32 s16, 0xffff0000
    s_lshl_b32 s7, s3, 10
    v_add_u32 v172, s7, v253
    v_add_u32 v174, 5120, v172
    v_and_b32 v178, 7, v0
    v_mul_u32_u24 v178, 1152, v178
    v_lshrrev_b32 v179, 3, v0
    v_lshl_add_u32 v178, v179, 4, v178
    s_lshl_b32 s7, s3, 7
    v_add_u32 v175, s7, v178
    v_add_u32 v177, 640, v175
    s_cmp_eq_u32 s3, 0
    s_mov_b32 s17, 1073741824
    s_cmov_b32 s17, 4096
    v_add_u32 v173, s17, v172
    s_mov_b32 s17, 1073741824
    s_cmov_b32 s17, 512
    v_add_u32 v176, s17, v175
    s_lshl_b32 s21, s41, 3
    s_add_u32 s21, s21, s40
    s_mul_i32 s18, s21, 9216
    buffer_load_dwordx4 v[16:19], v175, s[12:15], s18 offen nt
    buffer_load_dwordx4 v[20:23], v176, s[12:15], s18 offen nt
    buffer_load_dwordx4 v[24:27], v177, s[12:15], s18 offen nt
    s_mov_b32 s12, s30
    s_and_b32 s13, s31, 0xffff
    s_mov_b32 s14, 2359296
    s_mov_b32 s15, 0x20000
    s_lshl_b32 s79, s3, 14
    s_add_u32 s79, s79, 98304
    s_and_b32 s32, s41, 15
    s_lshl_b32 s32, s32, 1
    s_lshr_b32 s7, s41, 4
    s_add_u32 s32, s32, s7
    s_lshl_b32 s36, s32, 3
    s_add_u32 s36, s36, s40
    s_sub_u32 s36, s36, 144
    s_cmp_ge_u32 s32, 18
    s_cbranch_scc1 L_prep_o_1
    s_mul_i32 s35, s32, 110592
    s_mul_i32 s7, s40, 144
    s_and_b32 s46, s7, 127
    s_sub_u32 s7, s7, s46
    s_add_u32 s35, s35, s7
    s_mul_i32 s7, s3, 13824
    s_add_u32 s35, s35, s7
    v_lshrrev_b32 v8, 4, v0
    v_mul_u32_u24 v8, 3456, v8
    v_and_b32 v9, 15, v0
    v_lshl_add_u32 v8, v9, 4, v8
    s_lshl_b32 s34, s3, 10
    s_add_u32 m0, s34, 8192
    s_add_u32 s7, s35, 0
    buffer_load_dwordx4 v8, s[64:67], s7 offen nt lds
    s_add_u32 m0, s34, 12288
    s_add_u32 s7, s35, 55296
    buffer_load_dwordx4 v8, s[64:67], s7 offen nt lds
    s_add_u32 m0, s34, 16384
    s_add_u32 s7, s35, 1152
    buffer_load_dwordx4 v8, s[64:67], s7 offen nt lds
    s_add_u32 m0, s34, 20480
    s_add_u32 s7, s35, 56448
    buffer_load_dwordx4 v8, s[64:67], s7 offen nt lds
    s_add_u32 m0, s34, 24576
    s_add_u32 s7, s35, 2304
    buffer_load_dwordx4 v8, s[64:67], s7 offen nt lds
    s_add_u32 m0, s34, 28672
    s_add_u32 s7, s35, 57600
    buffer_load_dwordx4 v8, s[64:67], s7 offen nt lds
    s_branch L_prep_go_3
L_prep_o_1:
    s_cmp_ge_u32 s36, 54
    s_cbranch_scc1 L_prep_m_2
    s_mul_i32 s33, s36, 349526
    s_lshr_b32 s33, s33, 20
    s_mul_i32 s34, s33, 3
    s_sub_u32 s34, s36, s34
    s_lshl_b32 s7, s33, 2
    s_add_u32 s7, s7, s3
    v_mov_b32 v8, s7
    v_lshrrev_b32 v9, 3, v0
    v_mul_u32_u24 v11, 7282, v8
    v_lshrrev_b32 v11, 16, v11
    v_mul_u32_u24 v12, 9, v11
    v_sub_u32 v12, v8, v12
    v_mul_u32_u24 v11, 72, v11
    v_cmp_eq_u32 vcc, 8, v12
    v_lshrrev_b32 v10, 1, v12
    v_mad_u32_u24 v10, v10, 18, v11
    v_and_b32 v12, 1, v12
    v_lshl_add_u32 v10, v12, 3, v10
    v_add_u32 v10, v10, v9
    v_lshrrev_b32 v12, 1, v9
    v_mad_u32_u24 v11, v12, 18, v11
    v_and_b32 v12, 1, v9
    v_add3_u32 v11, v11, v12, 16
    v_cndmask_b32 v10, v10, v11, vcc
    v_mul_u32_u24 v10, 1152, v10
    v_and_b32 v9, 7, v0
    v_lshl_add_u32 v10, v9, 4, v10
    s_mul_i32 s35, s34, 384
    s_lshl_b32 s6, s3, 10
    s_add_u32 m0, s6, 8192
    s_add_u32 s7, s35, 0
    buffer_load_dwordx4 v10, s[68:71], s7 offen nt lds
    s_add_u32 m0, s6, 12288
    s_add_u32 s7, s35, 128
    buffer_load_dwordx4 v10, s[68:71], s7 offen nt lds
    s_add_u32 m0, s6, 16384
    s_add_u32 s7, s35, 256
    buffer_load_dwordx4 v10, s[68:71], s7 offen nt lds
    s_branch L_prep_go_3
L_prep_m_2:
    s_sub_u32 s37, s36, 54
    s_lshl_b32 s7, s3, 6
    s_add_u32 s37, s37, s7
    s_cmp_ge_u32 s37, 36
    s_cbranch_scc1 L_prep_go_3
    s_lshl_b32 s7, s37, 1
    v_bfe_u32 v8, v0, 3, 1
    v_add_u32 v8, s7, v8
    v_and_b32 v9, 7, v0
    v_mul_u32_u24 v11, 7282, v8
    v_lshrrev_b32 v11, 16, v11
    v_mul_u32_u24 v12, 9, v11
    v_sub_u32 v12, v8, v12
    v_mul_u32_u24 v11, 72, v11
    v_cmp_eq_u32 vcc, 8, v12
    v_lshrrev_b32 v10, 1, v12
    v_mad_u32_u24 v10, v10, 18, v11
    v_and_b32 v12, 1, v12
    v_lshl_add_u32 v10, v12, 3, v10
    v_add_u32 v10, v10, v9
    v_lshrrev_b32 v12, 1, v9
    v_mad_u32_u24 v11, v12, 18, v11
    v_and_b32 v12, 1, v9
    v_add3_u32 v11, v11, v12, 16
    v_cndmask_b32 v10, v10, v11, vcc
    v_mul_u32_u24 v10, 1152, v10
    v_lshrrev_b32 v9, 4, v0
    v_lshl_add_u32 v10, v9, 4, v10
    buffer_load_dwordx4 v[64:67], v10, s[68:71], 0 offen offset:0
    buffer_load_dwordx4 v[68:71], v10, s[68:71], 0 offen offset:64
    buffer_load_dwordx4 v[72:75], v10, s[68:71], 0 offen offset:128
    buffer_load_dwordx4 v[76:79], v10, s[68:71], 0 offen offset:192
    buffer_load_dwordx4 v[80:83], v10, s[68:71], 0 offen offset:256
    buffer_load_dwordx4 v[84:87], v10, s[68:71], 0 offen offset:320
    buffer_load_dwordx4 v[88:91], v10, s[68:71], 0 offen offset:384
    buffer_load_dwordx4 v[92:95], v10, s[68:71], 0 offen offset:448
    buffer_load_dwordx4 v[96:99], v10, s[68:71], 0 offen offset:512
    buffer_load_dwordx4 v[100:103], v10, s[68:71], 0 offen offset:576
    buffer_load_dwordx4 v[104:107], v10, s[68:71], 0 offen offset:640
    buffer_load_dwordx4 v[108:111], v10, s[68:71], 0 offen offset:704
    buffer_load_dwordx4 v[112:115], v10, s[68:71], 0 offen offset:768
    buffer_load_dwordx4 v[116:119], v10, s[68:71], 0 offen offset:832
    buffer_load_dwordx4 v[120:123], v10, s[68:71], 0 offen offset:896
    buffer_load_dwordx4 v[124:127], v10, s[68:71], 0 offen offset:960
    buffer_load_dwordx4 v[128:131], v10, s[68:71], 0 offen offset:1024
    buffer_load_dwordx4 v[132:135], v10, s[68:71], 0 offen offset:1088
L_prep_go_3:
    s_lshl_b32 s7, s41, 2
    s_add_u32 s7, s7, s3
    s_mul_i32 s93, s7, 25576
    s_lshr_b32 s93, s93, 20
    s_min_u32 s93, s93, 2
    s_mul_i32 s6, s93, 41
    s_sub_u32 s7, s7, s6
    s_lshl_b32 s17, s7, 2
    s_cmp_eq_u32 s93, 1
    s_cselect_b32 s72, s26, s24
    s_cselect_b32 s73, s27, s25
    s_cmp_eq_u32 s93, 2
    s_cselect_b32 s72, s28, s72
    s_cselect_b32 s73, s29, s73
    s_mov_b32 s92, 73728
    s_cmov_b32 s92, 9216
    s_mov_b32 s47, 1152
    s_cmov_b32 s47, 663552
    s_and_b32 s73, s73, 0xffff
    s_mov_b32 s74, 5308416
    s_mov_b32 s75, 0x20000
    s_mul_i32 s47, s47, s40
    s_add_u32 s7, s17, 0
    s_min_u32 s7, s7, 161
    s_mul_i32 s84, s7, 116509
    s_lshr_b32 s84, s84, 20
    s_mul_i32 s88, s84, 9
    s_sub_u32 s88, s7, s88
    s_mul_i32 s7, s84, s92
    s_lshl_b32 s7, s7, 2
    s_add_u32 s7, s7, s47
    s_lshl_b32 s6, s88, 7
    s_add_u32 s80, s7, s6
    s_add_u32 s7, s17, 1
    s_min_u32 s7, s7, 161
    s_mul_i32 s85, s7, 116509
    s_lshr_b32 s85, s85, 20
    s_mul_i32 s89, s85, 9
    s_sub_u32 s89, s7, s89
    s_mul_i32 s7, s85, s92
    s_lshl_b32 s7, s7, 2
    s_add_u32 s7, s7, s47
    s_lshl_b32 s6, s89, 7
    s_add_u32 s81, s7, s6
    s_add_u32 s7, s17, 2
    s_min_u32 s7, s7, 161
    s_mul_i32 s86, s7, 116509
    s_lshr_b32 s86, s86, 20
    s_mul_i32 s90, s86, 9
    s_sub_u32 s90, s7, s90
    s_mul_i32 s7, s86, s92
    s_lshl_b32 s7, s7, 2
    s_add_u32 s7, s7, s47
    s_lshl_b32 s6, s90, 7
    s_add_u32 s82, s7, s6
    s_add_u32 s7, s17, 3
    s_min_u32 s7, s7, 161
    s_mul_i32 s87, s7, 116509
    s_lshr_b32 s87, s87, 20
    s_mul_i32 s91, s87, 9
    s_sub_u32 s91, s7, s91
    s_mul_i32 s7, s87, s92
    s_lshl_b32 s7, s7, 2
    s_add_u32 s7, s7, s47
    s_lshl_b32 s6, s91, 7
    s_add_u32 s83, s7, s6
    s_lshr_b32 s7, s92, 3
    v_lshrrev_b32 v224, 3, v0
    v_mul_lo_u32 v224, v224, s7
    v_and_b32 v8, 7, v0
    v_lshl_add_u32 v224, v8, 4, v224
    s_waitcnt lgkmcnt(0)
    s_mul_i32 s76, s76, 0x9e3779b1
    s_add_u32 s76, s76, 0x7f4a7c15
    s_mov_b32 s77, s76
    s_add_u32 m0, s79, 0
    s_mov_b32 s71, s80
    buffer_load_dwordx4 v224, s[72:75], s71 offen nt lds
    s_add_u32 m0, s79, 1024
    s_add_u32 s71, s71, s92
    buffer_load_dwordx4 v224, s[72:75], s71 offen nt lds
    s_add_u32 m0, s79, 2048
    s_add_u32 s71, s71, s92
    buffer_load_dwordx4 v224, s[72:75], s71 offen nt lds
    s_add_u32 m0, s79, 3072
    s_add_u32 s71, s71, s92
    buffer_load_dwordx4 v224, s[72:75], s71 offen nt lds
    s_mul_i32 s68, s40, 1990656
    s_add_u32 s68, s68, 3145728
    s_mul_i32 s6, s84, 349526
    s_lshr_b32 s6, s6, 20
    s_mul_i32 s7, s6, 3
    s_sub_u32 s7, s84, s7
    s_mul_i32 s6, s6, 6
    s_add_u32 s7, s7, s6
    s_mul_i32 s6, s88, 36
    s_add_u32 s7, s7, s6
    s_mul_i32 s6, s93, 3
    s_add_u32 s7, s7, s6
    s_mul_i32 s6, s88, 18
    s_add_u32 s6, s6, s84
    s_add_u32 s6, s6, 324
    s_cmp_eq_u32 s93, 2
    s_cselect_b32 s7, s6, s7
    s_lshl_b32 s7, s7, 10
    s_add_u32 s94, s7, s68
    s_mul_i32 s6, s85, 349526
    s_lshr_b32 s6, s6, 20
    s_mul_i32 s7, s6, 3
    s_sub_u32 s7, s85, s7
    s_mul_i32 s6, s6, 6
    s_add_u32 s7, s7, s6
    s_mul_i32 s6, s89, 36
    s_add_u32 s7, s7, s6
    s_mul_i32 s6, s93, 3
    s_add_u32 s7, s7, s6
    s_mul_i32 s6, s89, 18
    s_add_u32 s6, s6, s85
    s_add_u32 s6, s6, 324
    s_cmp_eq_u32 s93, 2
    s_cselect_b32 s7, s6, s7
    s_lshl_b32 s7, s7, 10
    s_add_u32 s95, s7, s68
    s_mul_i32 s6, s86, 349526
    s_lshr_b32 s6, s6, 20
    s_mul_i32 s7, s6, 3
    s_sub_u32 s7, s86, s7
    s_mul_i32 s6, s6, 6
    s_add_u32 s7, s7, s6
    s_mul_i32 s6, s90, 36
    s_add_u32 s7, s7, s6
    s_mul_i32 s6, s93, 3
    s_add_u32 s7, s7, s6
    s_mul_i32 s6, s90, 18
    s_add_u32 s6, s6, s86
    s_add_u32 s6, s6, 324
    s_cmp_eq_u32 s93, 2
    s_cselect_b32 s7, s6, s7
    s_lshl_b32 s7, s7, 10
    s_add_u32 s78, s7, s68
    s_mul_i32 s6, s87, 349526
    s_lshr_b32 s6, s6, 20
    s_mul_i32 s7, s6, 3
    s_sub_u32 s7, s87, s7
    s_mul_i32 s6, s6, 6
    s_add_u32 s7, s7, s6
    s_mul_i32 s6, s91, 36
    s_add_u32 s7, s7, s6
    s_mul_i32 s6, s93, 3
    s_add_u32 s7, s7, s6
    s_mul_i32 s6, s91, 18
    s_add_u32 s6, s6, s87
    s_add_u32 s6, s6, 324
    s_cmp_eq_u32 s93, 2
    s_cselect_b32 s7, s6, s7
    s_lshl_b32 s7, s7, 10
    s_add_u32 s70, s7, s68
    s_waitcnt vmcnt(4)
    s_barrier
    s_cmp_ge_u32 s32, 18
    s_cbranch_scc1 L_prep_o_4
    s_mul_i32 s7, s3, 36
    s_add_u32 s7, s7, s46
    v_lshrrev_b32 v8, 4, v0
    v_lshlrev_b32 v8, 11, v8
    v_add_u32 v8, s7, v8
    v_and_b32 v9, 15, v0
    v_cmp_gt_u32 s[22:23], 6, v9
    v_lshrrev_b32 v10, 1, v9
    v_min_u32 v10, 2, v10
    v_lshl_add_u32 v10, v10, 13, v8
    v_and_b32 v11, 1, v0
    v_lshl_add_u32 v10, v11, 1, v10
    v_lshl_add_u32 v8, v9, 1, v8
    ds_read_u16 v136, v8 offset:8192
    ds_read_u16 v137, v8 offset:8448
    ds_read_u16 v138, v8 offset:8704
    ds_read_u16 v139, v8 offset:8960
    ds_read_u16 v140, v8 offset:9216
    ds_read_u16 v141, v8 offset:9472
    ds_read_u16 v142, v8 offset:9728
    ds_read_u16 v143, v8 offset:9984
    s_lshl_b32 s33, s40, 2
    s_add_u32 s33, s33, s3
    s_mul_i32 s33, s33, 18
    s_add_u32 s33, s33, s32
    s_lshl_b32 s33, s33, 12
    ds_read_u16 v144, v8 offset:16384
    ds_read_u16 v145, v8 offset:16640
    ds_read_u16 v146, v8 offset:16896
    ds_read_u16 v147, v8 offset:17152
    ds_read_u16 v148, v8 offset:17408
    ds_read_u16 v149, v8 offset:17664
    ds_read_u16 v150, v8 offset:17920
    ds_read_u16 v151, v8 offset:18176
    s_waitcnt lgkmcnt(8)
    v_lshl_or_b32 v32, v137, 16, v136
    v_lshl_or_b32 v33, v139, 16, v138
    v_lshl_or_b32 v34, v141, 16, v140
    v_lshl_or_b32 v35, v143, 16, v142
    buffer_store_dwordx4 v[32:35], v253, s[8:11], s33 offen offset:0 sc1
    ds_read_u16 v152, v8 offset:24576
    ds_read_u16 v153, v8 offset:24832
    ds_read_u16 v154, v8 offset:25088
    ds_read_u16 v155, v8 offset:25344
    ds_read_u16 v156, v8 offset:25600
    ds_read_u16 v157, v8 offset:25856
    ds_read_u16 v158, v8 offset:26112
    ds_read_u16 v159, v8 offset:26368
    s_waitcnt lgkmcnt(8)
    v_lshl_or_b32 v36, v145, 16, v144
    v_lshl_or_b32 v37, v147, 16, v146
    v_lshl_or_b32 v38, v149, 16, v148
    v_lshl_or_b32 v39, v151, 16, v150
    buffer_store_dwordx4 v[36:39], v253, s[8:11], s33 offen offset:1024 sc1
    ds_read_u16 v160, v10 offset:8224
    ds_read_u16 v161, v10 offset:8480
    ds_read_u16 v162, v10 offset:8736
    ds_read_u16 v163, v10 offset:8992
    ds_read_u16 v164, v10 offset:9248
    ds_read_u16 v165, v10 offset:9504
    ds_read_u16 v166, v10 offset:9760
    ds_read_u16 v167, v10 offset:10016
    s_waitcnt lgkmcnt(8)
    v_lshl_or_b32 v40, v153, 16, v152
    v_lshl_or_b32 v41, v155, 16, v154
    v_lshl_or_b32 v42, v157, 16, v156
    v_lshl_or_b32 v43, v159, 16, v158
    buffer_store_dwordx4 v[40:43], v253, s[8:11], s33 offen offset:2048 sc1
    s_waitcnt lgkmcnt(0)
    v_lshl_or_b32 v44, v161, 16, v160
    v_cndmask_b32 v44, 0, v44, s[22:23]
    v_lshl_or_b32 v45, v163, 16, v162
    v_cndmask_b32 v45, 0, v45, s[22:23]
    v_lshl_or_b32 v46, v165, 16, v164
    v_cndmask_b32 v46, 0, v46, s[22:23]
    v_lshl_or_b32 v47, v167, 16, v166
    v_cndmask_b32 v47, 0, v47, s[22:23]
    buffer_store_dwordx4 v[44:47], v253, s[8:11], s33 offen offset:3072 sc1
    s_branch L_prep_done_6
L_prep_o_4:
    s_cmp_ge_u32 s36, 54
    s_cbranch_scc1 L_prep_m_5
    v_lshrrev_b32 v8, 4, v0
    v_lshlrev_b32 v8, 3, v8
    v_bfe_u32 v9, v0, 2, 2
    v_add_u32 v8, v8, v9
    v_mul_u32_u24 v8, 128, v8
    v_and_b32 v9, 3, v0
    v_lshl_add_u32 v8, v9, 3, v8
    s_lshl_b32 s7, s3, 5
    v_add_u32 v8, s7, v8
    ds_read_b64_tr_b16 v[32:33], v8 offset:8192
    ds_read_b64_tr_b16 v[34:35], v8 offset:8704
    ds_read_b64_tr_b16 v[36:37], v8 offset:12288
    ds_read_b64_tr_b16 v[38:39], v8 offset:12800
    ds_read_b64_tr_b16 v[40:41], v8 offset:16384
    ds_read_b64_tr_b16 v[42:43], v8 offset:16896
    s_mul_i32 s34, s34, 12
    s_add_u32 s34, s34, s3
    s_mul_i32 s34, s34, 18
    s_add_u32 s34, s34, s33
    s_lshl_b32 s34, s34, 10
    s_add_u32 s7, s34, 2359296
    s_waitcnt lgkmcnt(4)
    buffer_store_dwordx4 v[32:35], v253, s[8:11], s7 offen sc1
    s_add_u32 s7, s34, 2433024
    s_waitcnt lgkmcnt(2)
    buffer_store_dwordx4 v[36:39], v253, s[8:11], s7 offen sc1
    s_add_u32 s7, s34, 2506752
    s_waitcnt lgkmcnt(0)
    buffer_store_dwordx4 v[40:43], v253, s[8:11], s7 offen sc1
    s_branch L_prep_done_6
L_prep_m_5:
    s_cmp_ge_u32 s37, 36
    s_cbranch_scc1 L_prep_done_6
    v_mov_b32 v28, 0x3f803f80
    v_mov_b32 v29, 0x3f803f80
    v_mov_b32 v30, 0x3f803f80
    v_mov_b32 v31, 0x3f803f80
    v_and_b32 v9, 15, v0
    v_cmp_eq_u32 vcc, 0, v9
    v_cmp_eq_u32 s[22:23], 1, v9
    v_mfma_f32_16x16x32_bf16 v[32:35], v[64:67], v[28:31], 0
    v_mfma_f32_16x16x32_bf16 v[32:35], v[68:71], v[28:31], v[32:35]
    v_mfma_f32_16x16x32_bf16 v[32:35], v[72:75], v[28:31], v[32:35]
    v_mfma_f32_16x16x32_bf16 v[32:35], v[76:79], v[28:31], v[32:35]
    v_mfma_f32_16x16x32_bf16 v[32:35], v[80:83], v[28:31], v[32:35]
    v_mfma_f32_16x16x32_bf16 v[32:35], v[84:87], v[28:31], v[32:35]
    v_mfma_f32_16x16x32_bf16 v[32:35], v[88:91], v[28:31], v[32:35]
    v_mfma_f32_16x16x32_bf16 v[32:35], v[92:95], v[28:31], v[32:35]
    v_mfma_f32_16x16x32_bf16 v[32:35], v[96:99], v[28:31], v[32:35]
    v_mfma_f32_16x16x32_bf16 v[32:35], v[100:103], v[28:31], v[32:35]
    v_mfma_f32_16x16x32_bf16 v[32:35], v[104:107], v[28:31], v[32:35]
    v_mfma_f32_16x16x32_bf16 v[32:35], v[108:111], v[28:31], v[32:35]
    v_mfma_f32_16x16x32_bf16 v[32:35], v[112:115], v[28:31], v[32:35]
    v_mfma_f32_16x16x32_bf16 v[32:35], v[116:119], v[28:31], v[32:35]
    v_mfma_f32_16x16x32_bf16 v[32:35], v[120:123], v[28:31], v[32:35]
    v_mfma_f32_16x16x32_bf16 v[32:35], v[124:127], v[28:31], v[32:35]
    v_mfma_f32_16x16x32_bf16 v[32:35], v[128:131], v[28:31], v[32:35]
    v_mfma_f32_16x16x32_bf16 v[32:35], v[132:135], v[28:31], v[32:35]
    v_lshrrev_b32 v10, 5, v0
    v_lshlrev_b32 v10, 8, v10
    v_lshl_add_u32 v10, v9, 4, v10
    v_bfe_u32 v9, v0, 4, 1
    v_lshl_add_u32 v10, v9, 3, v10
    s_lshl_b32 s7, s37, 9
    s_add_u32 s7, s7, 3022848
    s_nop 0
    v_mul_f32 v32, 0x3ae38e39, v32
    v_mul_f32 v33, 0x3ae38e39, v33
    v_mul_f32 v34, 0x3ae38e39, v34
    v_mul_f32 v35, 0x3ae38e39, v35
    v_cvt_pk_bf16_f32 v36, v32, v33
    v_cvt_pk_bf16_f32 v37, v34, v35
    v_lshlrev_b32 v38, 16, v36
    v_and_b32 v39, s16, v36
    v_sub_f32 v38, v32, v38
    v_sub_f32 v39, v33, v39
    v_cvt_pk_bf16_f32 v28, v38, v39
    v_cndmask_b32 v28, 0, v28, s[22:23]
    v_cndmask_b32 v28, v28, v36, vcc
    v_lshlrev_b32 v38, 16, v37
    v_and_b32 v39, s16, v37
    v_sub_f32 v38, v34, v38
    v_sub_f32 v39, v35, v39
    v_cvt_pk_bf16_f32 v29, v38, v39
    v_cndmask_b32 v29, 0, v29, s[22:23]
    v_cndmask_b32 v29, v29, v37, vcc
    buffer_store_dwordx2 v[28:29], v10, s[8:11], s7 offen sc1
L_prep_done_6:
    s_add_u32 s19, s18, 43515904
    s_add_u32 s20, s18, 38797312
    s_lshl_b32 s22, s21, 7
    s_add_u32 s22, s22, 48234496
    buffer_store_dwordx4 v[16:19], v172, s[8:11], s19 offen sc1
    buffer_store_dwordx4 v[20:23], v173, s[8:11], s19 offen sc1
    buffer_store_dwordx4 v[24:27], v174, s[8:11], s19 offen sc1
    s_mov_b32 s17, 0x3f803f80
    v_mov_b32 v8, 0
    v_mov_b32 v9, 0
    v_mov_b32 v10, 0
    v_mov_b32 v11, 0
    v_dot2c_f32_bf16 v8, s17, v16
    v_dot2c_f32_bf16 v9, v16, v16
    v_dot2c_f32_bf16 v10, s17, v17
    v_dot2c_f32_bf16 v11, v17, v17
    v_dot2c_f32_bf16 v8, s17, v18
    v_dot2c_f32_bf16 v9, v18, v18
    v_dot2c_f32_bf16 v10, s17, v19
    v_dot2c_f32_bf16 v11, v19, v19
    v_dot2c_f32_bf16 v8, s17, v20
    v_dot2c_f32_bf16 v9, v20, v20
    v_dot2c_f32_bf16 v10, s17, v21
    v_dot2c_f32_bf16 v11, v21, v21
    v_dot2c_f32_bf16 v8, s17, v22
    v_dot2c_f32_bf16 v9, v22, v22
    v_dot2c_f32_bf16 v10, s17, v23
    v_dot2c_f32_bf16 v11, v23, v23
    v_dot2c_f32_bf16 v8, s17, v24
    v_dot2c_f32_bf16 v9, v24, v24
    v_dot2c_f32_bf16 v10, s17, v25
    v_dot2c_f32_bf16 v11, v25, v25
    v_dot2c_f32_bf16 v8, s17, v26
    v_dot2c_f32_bf16 v9, v26, v26
    v_dot2c_f32_bf16 v10, s17, v27
    v_dot2c_f32_bf16 v11, v27, v27
    v_and_b32 v12, 7, v0
    v_lshlrev_b32 v12, 3, v12
    s_lshl_b32 s7, s3, 6
    v_add_u32 v13, s7, v12
    v_pk_add_f32 v[8:9], v[8:9], v[10:11]
    s_nop 1
    v_add_f32_dpp v8, v8, v8 row_ror:8 row_mask:0xf bank_mask:0xf
    v_add_f32_dpp v9, v9, v9 row_ror:8 row_mask:0xf bank_mask:0xf
    v_mov_b32 v10, v8
    v_mov_b32 v11, v9
    s_nop 1
    v_permlane32_swap_b32 v10, v8
    v_permlane32_swap_b32 v11, v9
    v_add_f32 v8, v8, v10
    v_add_f32 v9, v9, v11
    v_mov_b32 v10, v8
    v_mov_b32 v11, v9
    s_nop 1
    v_permlane16_swap_b32 v10, v8
    v_permlane16_swap_b32 v11, v9
    v_add_f32 v8, v8, v10
    v_add_f32 v9, v9, v11
    ds_write_b64 v13, v[8:9]
    s_waitcnt lgkmcnt(0)
    s_barrier
    ds_read_b64 v[40:41], v12 offset:0
    ds_read_b64 v[42:43], v12 offset:64
    ds_read_b64 v[44:45], v12 offset:128
    ds_read_b64 v[46:47], v12 offset:192
    s_waitcnt lgkmcnt(0)
    v_pk_add_f32 v[40:41], v[40:41], v[42:43]
    v_pk_add_f32 v[44:45], v[44:45], v[46:47]
    v_pk_add_f32 v[8:9], v[40:41], v[44:45]
    v_mul_f32 v8, 0x3ae38e39, v8
    v_mul_f32 v9, 0x3ae38e39, v9
    v_fma_f32 v9, -v8, v8, v9
    v_max_f32 v9, 0, v9
    v_add_f32 v9, 0x3727c5ac, v9
    v_rsq_f32 v10, v9
    s_nop 0
    v_mul_f32 v12, v8, v10
    v_mov_b32 v11, v10
    v_sub_f32 v12, 0, v12
    v_mov_b32 v13, v12
    s_cmp_eq_u32 s3, 0
    s_cselect_b32 s7, 32, 0
    v_lshlrev_b32 v14, 2, v0
    v_cmp_gt_u32 vcc, s7, v0
    v_mov_b32 v9, 1073741824
    s_nop 0
    v_cndmask_b32 v14, v9, v14, vcc
    buffer_store_dword v8, v14, s[8:11], s22 offen sc1
    v_lshlrev_b32 v40, 16, v16
    v_and_b32 v41, s16, v16
    v_lshlrev_b32 v42, 16, v17
    v_and_b32 v43, s16, v17
    v_lshlrev_b32 v44, 16, v18
    v_and_b32 v45, s16, v18
    v_lshlrev_b32 v46, 16, v19
    v_and_b32 v47, s16, v19
    v_pk_fma_f32 v[40:41], v[40:41], v[10:11], v[12:13]
    v_pk_fma_f32 v[42:43], v[42:43], v[10:11], v[12:13]
    v_pk_fma_f32 v[44:45], v[44:45], v[10:11], v[12:13]
    v_pk_fma_f32 v[46:47], v[46:47], v[10:11], v[12:13]
    v_cvt_pk_bf16_f32 v48, v40, v41
    v_cvt_pk_bf16_f32 v49, v42, v43
    v_cvt_pk_bf16_f32 v50, v44, v45
    v_cvt_pk_bf16_f32 v51, v46, v47
    v_lshlrev_b32 v40, 16, v20
    v_and_b32 v41, s16, v20
    v_lshlrev_b32 v42, 16, v21
    v_and_b32 v43, s16, v21
    v_lshlrev_b32 v44, 16, v22
    v_and_b32 v45, s16, v22
    v_lshlrev_b32 v46, 16, v23
    v_and_b32 v47, s16, v23
    v_pk_fma_f32 v[40:41], v[40:41], v[10:11], v[12:13]
    v_pk_fma_f32 v[42:43], v[42:43], v[10:11], v[12:13]
    v_pk_fma_f32 v[44:45], v[44:45], v[10:11], v[12:13]
    v_pk_fma_f32 v[46:47], v[46:47], v[10:11], v[12:13]
    v_cvt_pk_bf16_f32 v52, v40, v41
    v_cvt_pk_bf16_f32 v53, v42, v43
    v_cvt_pk_bf16_f32 v54, v44, v45
    v_cvt_pk_bf16_f32 v55, v46, v47
    v_lshlrev_b32 v40, 16, v24
    v_and_b32 v41, s16, v24
    v_lshlrev_b32 v42, 16, v25
    v_and_b32 v43, s16, v25
    v_lshlrev_b32 v44, 16, v26
    v_and_b32 v45, s16, v26
    v_lshlrev_b32 v46, 16, v27
    v_and_b32 v47, s16, v27
    v_pk_fma_f32 v[40:41], v[40:41], v[10:11], v[12:13]
    v_pk_fma_f32 v[42:43], v[42:43], v[10:11], v[12:13]
    v_pk_fma_f32 v[44:45], v[44:45], v[10:11], v[12:13]
    v_pk_fma_f32 v[46:47], v[46:47], v[10:11], v[12:13]
    v_cvt_pk_bf16_f32 v56, v40, v41
    v_cvt_pk_bf16_f32 v57, v42, v43
    v_cvt_pk_bf16_f32 v58, v44, v45
    v_cvt_pk_bf16_f32 v59, v46, v47
    buffer_store_dwordx4 v[48:51], v172, s[8:11], s20 offen sc1
    buffer_store_dwordx4 v[52:55], v173, s[8:11], s20 offen sc1
    buffer_store_dwordx4 v[56:59], v174, s[8:11], s20 offen sc1
    v_lshlrev_b32 v15, 7, v0
    s_lshl_b32 s6, s40, 2
    s_add_u32 s6, s6, s44
    s_sub_u32 s6, s6, 32768
    v_mov_b32 v1, s76
    s_mov_b64 vcc, 0xff
    v_lshrrev_b32 v14, 3, v0
    v_lshl_add_u32 v15, v14, 3, v15
    s_cmp_ge_u32 s40, 6
    s_cselect_b32 s7, s41, 31
    s_cmp_lt_u32 s7, 31
    s_cmov_b64 vcc, 0xffff
    s_waitcnt vmcnt(0)
    s_barrier
    s_cmp_lg_u32 s3, 0
    s_cbranch_scc1 L_pub_7
    s_mov_b64 exec, vcc
    buffer_store_dword v1, v15, s[8:11], s6 offen sc1
    s_lshl_b32 s6, s40, 7
    s_lshl_b32 s7, s32, 2
    s_add_u32 s6, s6, s7
    s_add_u32 s6, s6, 19431424
    s_mov_b64 exec, 0xffffffff
    v_lshlrev_b32 v15, 10, v0
    v_mov_b32 v1, s76
    buffer_store_dword v1, v15, s[8:11], s6 offen sc1
    s_cmp_lt_u32 s32, 18
    s_cbranch_scc1 L_pub_7
    s_lshl_b32 s6, s36, 2
    s_add_u32 s6, s6, 19496960
    s_mov_b64 exec, 1
    buffer_store_dword v1, off, s[8:11], s6 sc1
L_pub_7:
    s_mov_b64 exec, -1
    s_cmp_eq_u32 s93, 2
    s_cselect_b32 s6, 2, 3
    s_mov_b32 s7, 512
    s_cmov_b32 s7, 2048
    v_lshrrev_b32 v14, 4, v0
    v_lshlrev_b32 v14, s6, v14
    v_bfe_u32 v15, v0, 2, 2
    v_add_u32 v14, v14, v15
    v_mul_u32_u24 v14, 128, v14
    v_and_b32 v15, 3, v0
    v_lshl_add_u32 v14, v15, 3, v14
    v_add_u32 v14, s79, v14
    v_add_u32 v15, s7, v14
    ds_read_b64_tr_b16 v[64:65], v14 offset:0
    ds_read_b64_tr_b16 v[66:67], v15 offset:0
    ds_read_b64_tr_b16 v[68:69], v14 offset:32
    ds_read_b64_tr_b16 v[70:71], v15 offset:32
    ds_read_b64_tr_b16 v[72:73], v14 offset:64
    ds_read_b64_tr_b16 v[74:75], v15 offset:64
    ds_read_b64_tr_b16 v[76:77], v14 offset:96
    ds_read_b64_tr_b16 v[78:79], v15 offset:96
    s_add_u32 m0, s79, 4096
    s_mov_b32 s71, s81
    buffer_load_dwordx4 v224, s[72:75], s71 offen nt lds
    s_add_u32 m0, s79, 5120
    s_add_u32 s71, s71, s92
    buffer_load_dwordx4 v224, s[72:75], s71 offen nt lds
    s_add_u32 m0, s79, 6144
    s_add_u32 s71, s71, s92
    buffer_load_dwordx4 v224, s[72:75], s71 offen nt lds
    s_add_u32 m0, s79, 7168
    s_add_u32 s71, s71, s92
    buffer_load_dwordx4 v224, s[72:75], s71 offen nt lds
    s_add_u32 m0, s79, 8192
    s_mov_b32 s71, s82
    buffer_load_dwordx4 v224, s[72:75], s71 offen nt lds
    s_add_u32 m0, s79, 9216
    s_add_u32 s71, s71, s92
    buffer_load_dwordx4 v224, s[72:75], s71 offen nt lds
    s_waitcnt lgkmcnt(0)
    s_add_u32 s7, s94, 0
    buffer_store_dwordx4 v[64:67], v253, s[8:11], s7 offen sc1
    s_add_u32 m0, s79, 10240
    s_add_u32 s71, s71, s92
    buffer_load_dwordx4 v224, s[72:75], s71 offen nt lds
    s_add_u32 s7, s94, 497664
    buffer_store_dwordx4 v[68:71], v253, s[8:11], s7 offen sc1
    s_add_u32 m0, s79, 11264
    s_add_u32 s71, s71, s92
    buffer_load_dwordx4 v224, s[72:75], s71 offen nt lds
    s_add_u32 s7, s94, 995328
    buffer_store_dwordx4 v[72:75], v253, s[8:11], s7 offen sc1
    s_add_u32 m0, s79, 12288
    s_mov_b32 s71, s83
    buffer_load_dwordx4 v224, s[72:75], s71 offen nt lds
    s_add_u32 s7, s94, 1492992
    buffer_store_dwordx4 v[76:79], v253, s[8:11], s7 offen sc1
    s_add_u32 m0, s79, 13312
    s_add_u32 s71, s71, s92
    buffer_load_dwordx4 v224, s[72:75], s71 offen nt lds
    s_add_u32 m0, s79, 14336
    s_add_u32 s71, s71, s92
    buffer_load_dwordx4 v224, s[72:75], s71 offen nt lds
    s_add_u32 m0, s79, 15360
    s_add_u32 s71, s71, s92
    buffer_load_dwordx4 v224, s[72:75], s71 offen nt lds
    s_cmp_lg_u32 s3, 0
    s_cbranch_scc1 L_wq_ready_8
    s_lshl_b32 s7, s41, 3
    s_add_u32 s7, s7, s40
    s_lshl_b32 s7, s7, 7
    s_add_u32 s7, s7, 19431424
    s_add_u32 s68, s4, s7
    s_addc_u32 s69, s5, 0
    s_mov_b32 s6, 0
    s_mov_b32 s7, 0
L_cpoll_9:
    s_load_dwordx16 s[52:67], s[68:69], s7 glc
    s_add_u32 s6, s6, 1
    s_waitcnt lgkmcnt(0)
    s_xor_b64 s[52:53], s[52:53], s[76:77]
    s_xor_b64 s[54:55], s[54:55], s[76:77]
    s_xor_b64 s[56:57], s[56:57], s[76:77]
    s_xor_b64 s[58:59], s[58:59], s[76:77]
    s_xor_b64 s[60:61], s[60:61], s[76:77]
    s_xor_b64 s[62:63], s[62:63], s[76:77]
    s_xor_b64 s[64:65], s[64:65], s[76:77]
    s_xor_b64 s[66:67], s[66:67], s[76:77]
    s_or_b64 s[52:53], s[52:53], s[60:61]
    s_or_b64 s[54:55], s[54:55], s[62:63]
    s_or_b64 s[56:57], s[56:57], s[64:65]
    s_or_b64 s[58:59], s[58:59], s[66:67]
    s_or_b64 s[52:53], s[52:53], s[56:57]
    s_or_b64 s[54:55], s[54:55], s[58:59]
    s_or_b64 s[52:53], s[52:53], s[54:55]
    s_cbranch_scc1 L_cpoll_10
    s_add_u32 s7, s7, 8
    s_cmp_eq_u32 s7, 16
    s_cbranch_scc1 L_cpolled_11
L_cpoll_10:
    s_cmp_lt_u32 s6, 1048576
    s_cbranch_scc1 L_cpoll_9
    s_branch L_main_end
L_cpolled_11:
L_wq_ready_8:
    s_barrier
    s_lshl_b32 s28, s40, 2
    s_add_u32 s28, s28, s3
    s_mul_i32 s28, s28, 73728
    v_and_b32 v229, 8, v0
    v_lshl_add_u32 v229, v229, 27, v253
    buffer_load_dwordx4 a[0:3], v253, s[8:11], s28 offen offset:0 sc1
    buffer_load_dwordx4 a[4:7], v253, s[8:11], s28 offen offset:1024 sc1
    buffer_load_dwordx4 a[8:11], v253, s[8:11], s28 offen offset:2048 sc1
    buffer_load_dwordx4 a[12:15], v229, s[8:11], s28 offen offset:3072 sc1
    s_add_u32 s28, s28, 4096
    buffer_load_dwordx4 a[16:19], v253, s[8:11], s28 offen offset:0 sc1
    buffer_load_dwordx4 a[20:23], v253, s[8:11], s28 offen offset:1024 sc1
    buffer_load_dwordx4 a[24:27], v253, s[8:11], s28 offen offset:2048 sc1
    buffer_load_dwordx4 a[28:31], v229, s[8:11], s28 offen offset:3072 sc1
    s_add_u32 s28, s28, 4096
    buffer_load_dwordx4 a[32:35], v253, s[8:11], s28 offen offset:0 sc1
    buffer_load_dwordx4 a[36:39], v253, s[8:11], s28 offen offset:1024 sc1
    buffer_load_dwordx4 a[40:43], v253, s[8:11], s28 offen offset:2048 sc1
    buffer_load_dwordx4 a[44:47], v229, s[8:11], s28 offen offset:3072 sc1
    s_add_u32 s28, s28, 4096
    buffer_load_dwordx4 a[48:51], v253, s[8:11], s28 offen offset:0 sc1
    buffer_load_dwordx4 a[52:55], v253, s[8:11], s28 offen offset:1024 sc1
    buffer_load_dwordx4 a[56:59], v253, s[8:11], s28 offen offset:2048 sc1
    buffer_load_dwordx4 a[60:63], v229, s[8:11], s28 offen offset:3072 sc1
    s_add_u32 s28, s28, 4096
    buffer_load_dwordx4 a[64:67], v253, s[8:11], s28 offen offset:0 sc1
    buffer_load_dwordx4 a[68:71], v253, s[8:11], s28 offen offset:1024 sc1
    buffer_load_dwordx4 a[72:75], v253, s[8:11], s28 offen offset:2048 sc1
    buffer_load_dwordx4 a[76:79], v229, s[8:11], s28 offen offset:3072 sc1
    s_add_u32 s28, s28, 4096
    buffer_load_dwordx4 a[80:83], v253, s[8:11], s28 offen offset:0 sc1
    buffer_load_dwordx4 a[84:87], v253, s[8:11], s28 offen offset:1024 sc1
    buffer_load_dwordx4 a[88:91], v253, s[8:11], s28 offen offset:2048 sc1
    buffer_load_dwordx4 a[92:95], v229, s[8:11], s28 offen offset:3072 sc1
    s_add_u32 s28, s28, 4096
    buffer_load_dwordx4 a[96:99], v253, s[8:11], s28 offen offset:0 sc1
    buffer_load_dwordx4 a[100:103], v253, s[8:11], s28 offen offset:1024 sc1
    buffer_load_dwordx4 a[104:107], v253, s[8:11], s28 offen offset:2048 sc1
    buffer_load_dwordx4 a[108:111], v229, s[8:11], s28 offen offset:3072 sc1
    s_add_u32 s28, s28, 4096
    buffer_load_dwordx4 a[112:115], v253, s[8:11], s28 offen offset:0 sc1
    buffer_load_dwordx4 a[116:119], v253, s[8:11], s28 offen offset:1024 sc1
    buffer_load_dwordx4 a[120:123], v253, s[8:11], s28 offen offset:2048 sc1
    buffer_load_dwordx4 a[124:127], v229, s[8:11], s28 offen offset:3072 sc1
    s_add_u32 s28, s28, 4096
    buffer_load_dwordx4 a[128:131], v253, s[8:11], s28 offen offset:0 sc1
    buffer_load_dwordx4 a[132:135], v253, s[8:11], s28 offen offset:1024 sc1
    buffer_load_dwordx4 a[136:139], v253, s[8:11], s28 offen offset:2048 sc1
    buffer_load_dwordx4 a[140:143], v229, s[8:11], s28 offen offset:3072 sc1
    s_add_u32 s28, s28, 4096
L_main_layer:
    v_bfe_u32 v3, v0, 3, 1
    v_mul_u32_u24 v2, 9216, v3
    v_lshrrev_b32 v3, 4, v0
    v_lshl_add_u32 v2, v3, 7, v2
    v_and_b32 v3, 7, v0
    v_lshl_add_u32 v2, v3, 4, v2
    v_bfe_u32 v3, v0, 3, 2
    s_mov_b32 s7, 9216
    v_mul_lo_u32 v9, v3, s7
    v_lshrrev_b32 v3, 5, v0
    v_lshl_add_u32 v9, v3, 7, v9
    v_and_b32 v3, 7, v0
    v_lshl_add_u32 v9, v3, 4, v9
    s_mul_i32 s22, s41, 73728
    s_add_u32 s22, s22, s43
    s_add_u32 s23, s22, 38797312
    s_mul_i32 s7, s3, 18432
    s_add_u32 s24, s23, s7
    s_cmp_eq_u32 s41, 0
    s_cselect_b32 s7, 0, 18432
    s_sub_u32 s23, s23, s7
    s_lshl_b32 s25, s3, 10
    s_add_u32 s25, s25, 1024
    s_mul_i32 s26, s3, 5120
    s_lshl_b32 s7, s3, 9
    s_add_u32 s27, s23, s7
    s_and_b32 s7, s3, 1
    s_add_u32 s7, s7, 4
    s_mul_i32 s29, s7, 5120
    s_lshl_b32 s7, s7, 9
    s_add_u32 s23, s23, s7
    s_cmp_lg_u32 s3, 3
    s_cbranch_scc1 L_pollout_14
    s_lshl_b32 s7, s40, 7
    s_add_u32 s7, s7, s44
    s_sub_u32 s7, s7, 32768
    s_add_u32 s52, s4, s7
    s_addc_u32 s53, s5, 0
    s_cmp_eq_u32 s41, 0
    s_cselect_b32 s7, 0, 32
    s_mov_b32 s6, 0
L_poll_12:
    s_load_dwordx8 s[56:63], s[52:53], 0 glc
    s_load_dwordx2 s[54:55], s[52:53], s7 glc
    s_add_u32 s6, s6, 1
    s_waitcnt lgkmcnt(0)
    s_xor_b64 s[54:55], s[54:55], s[76:77]
    s_xor_b64 s[56:57], s[56:57], s[76:77]
    s_xor_b64 s[58:59], s[58:59], s[76:77]
    s_xor_b64 s[60:61], s[60:61], s[76:77]
    s_xor_b64 s[62:63], s[62:63], s[76:77]
    s_or_b64 s[56:57], s[56:57], s[58:59]
    s_or_b64 s[60:61], s[60:61], s[62:63]
    s_or_b64 s[56:57], s[56:57], s[54:55]
    s_or_b64 s[56:57], s[56:57], s[60:61]
    s_cbranch_scc0 L_polled_13
    s_cmp_lt_u32 s6, 1048576
    s_cbranch_scc1 L_poll_12
    s_branch L_main_end
L_polled_13:
L_pollout_14:
    s_barrier
    s_add_u32 m0, s25, 0
    s_nop 0
    buffer_load_dwordx4 v2, s[8:11], s24 offen offset:0 sc1 lds
    s_add_u32 m0, s25, 4608
    s_nop 0
    buffer_load_dwordx4 v2, s[8:11], s24 offen offset:512 sc1 lds
    s_add_u32 m0, s25, 9216
    s_nop 0
    buffer_load_dwordx4 v2, s[8:11], s24 offen offset:1024 sc1 lds
    s_add_u32 m0, s25, 13824
    s_nop 0
    buffer_load_dwordx4 v2, s[8:11], s24 offen offset:1536 sc1 lds
    s_add_u32 m0, s25, 18432
    s_nop 0
    buffer_load_dwordx4 v2, s[8:11], s24 offen offset:2048 sc1 lds
    s_add_u32 m0, s25, 23040
    s_nop 0
    buffer_load_dwordx4 v2, s[8:11], s24 offen offset:2560 sc1 lds
    s_add_u32 m0, s26, 0
    s_add_u32 s7, s27, 0
    buffer_load_dwordx4 v2, s[8:11], s7 offen sc1 lds
    s_add_u32 m0, s29, 0
    s_add_u32 s7, s23, 0
    buffer_load_dwordx4 v2, s[8:11], s7 offen sc1 lds
    v_add_u32 v6, 46080, v253
    s_waitcnt vmcnt(0)
    s_barrier
    ds_read_b128 v[16:19], v253 offset:0
    ds_read_b128 v[20:23], v253 offset:1024
    ds_read_b128 v[24:27], v253 offset:2048
    ds_read_b128 v[28:31], v253 offset:3072
    ds_read_b128 v[32:35], v253 offset:4096
    s_waitcnt lgkmcnt(0)
    v_mfma_f32_16x16x32_bf16 v[56:59], a[0:3], v[20:23], 0
    ds_read_b128 v[36:39], v253 offset:5120
    v_mfma_f32_16x16x32_bf16 v[60:63], a[0:3], v[24:27], 0
    ds_read_b128 v[40:43], v253 offset:6144
    v_mfma_f32_16x16x32_bf16 v[64:67], a[0:3], v[28:31], 0
    ds_read_b128 v[44:47], v253 offset:7168
    v_mfma_f32_16x16x32_bf16 v[68:71], a[0:3], v[32:35], 0
    ds_read_b128 v[48:51], v253 offset:8192
    v_mfma_f32_16x16x32_bf16 v[72:75], a[4:7], v[16:19], 0
    ds_read_b128 v[52:55], v253 offset:9216
    v_mfma_f32_16x16x32_bf16 v[76:79], a[4:7], v[20:23], 0
    s_add_u32 m0, s25, 27648
    s_nop 0
    buffer_load_dwordx4 v2, s[8:11], s24 offen offset:3072 sc1 lds
    v_mfma_f32_16x16x32_bf16 v[80:83], a[4:7], v[24:27], 0
    v_mov_b32 v132, 0
    v_mov_b32 v133, 0
    v_mfma_f32_16x16x32_bf16 v[84:87], a[4:7], v[28:31], 0
    s_add_u32 m0, s25, 32256
    s_nop 0
    buffer_load_dwordx4 v2, s[8:11], s24 offen offset:3584 sc1 lds
    v_mfma_f32_16x16x32_bf16 v[88:91], a[4:7], v[32:35], 0
    v_mov_b32 v192, 0
    v_mov_b32 v193, 0
    v_mfma_f32_16x16x32_bf16 v[92:95], v[16:19], a[8:11], 0
    buffer_load_dwordx4 a[144:147], v253, s[8:11], s28 offen offset:0 sc1
    v_mfma_f32_16x16x32_bf16 v[96:99], v[20:23], a[8:11], 0
    v_mov_b32 v195, 0
    v_mov_b32 v135, 0
    v_mfma_f32_16x16x32_bf16 v[100:103], v[24:27], a[8:11], 0
    buffer_load_dwordx4 a[148:151], v253, s[8:11], s28 offen offset:1024 sc1
    v_mfma_f32_16x16x32_bf16 v[104:107], v[28:31], a[8:11], 0
    v_mov_b32 v139, 0
    v_mov_b32 v143, 0
    v_mfma_f32_16x16x32_bf16 v[108:111], v[32:35], a[8:11], 0
    buffer_load_dwordx4 a[152:155], v253, s[8:11], s28 offen offset:2048 sc1
    v_mfma_f32_16x16x32_bf16 v[112:115], a[12:15], v[16:19], 0
    v_mov_b32 v147, 0
    v_mov_b32 v151, 0
    v_mfma_f32_16x16x32_bf16 v[116:119], a[12:15], v[20:23], 0
    v_mov_b32 v155, 0
    v_mov_b32 v159, 0
    v_mfma_f32_16x16x32_bf16 v[120:123], a[12:15], v[24:27], 0
    v_mov_b32 v163, 0
    v_mov_b32 v167, 0
    v_mfma_f32_16x16x32_bf16 v[124:127], a[12:15], v[28:31], 0
    v_mov_b32 v171, 0
    v_cmp_eq_u32 vcc, 16, v0
    v_mov_b32 v10, 0x3f80
    v_mfma_f32_16x16x32_bf16 v[128:131], a[12:15], v[32:35], 0
    v_cmp_eq_u32 s[20:21], 17, v0
    v_cndmask_b32 v194, 0, v10, vcc
    v_and_b32 v11, 3, v0
    s_waitcnt lgkmcnt(0)
    v_mfma_f32_16x16x32_bf16 v[56:59], a[16:19], v[40:43], v[56:59]
    ds_read_b128 v[16:19], v253 offset:10240
    v_mfma_f32_16x16x32_bf16 v[60:63], a[16:19], v[44:47], v[60:63]
    ds_read_b128 v[20:23], v253 offset:11264
    v_mfma_f32_16x16x32_bf16 v[64:67], a[16:19], v[48:51], v[64:67]
    ds_read_b128 v[24:27], v253 offset:12288
    v_mfma_f32_16x16x32_bf16 v[68:71], a[16:19], v[52:55], v[68:71]
    ds_read_b128 v[28:31], v253 offset:13312
    v_mfma_f32_16x16x32_bf16 v[72:75], a[20:23], v[36:39], v[72:75]
    ds_read_b128 v[32:35], v253 offset:14336
    v_mfma_f32_16x16x32_bf16 v[76:79], a[20:23], v[40:43], v[76:79]
    s_add_u32 m0, s25, 40960
    s_add_u32 s24, s24, 4096
    buffer_load_dwordx4 v2, s[8:11], s24 offen offset:0 sc1 lds
    v_mfma_f32_16x16x32_bf16 v[80:83], a[20:23], v[44:47], v[80:83]
    v_cndmask_b32 v194, v194, 1.0, s[20:21]
    v_cmp_eq_u32 vcc, 2, v11
    v_and_b32 v10, 15, v0
    v_mfma_f32_16x16x32_bf16 v[84:87], a[20:23], v[48:51], v[84:87]
    s_add_u32 m0, s25, 45568
    s_nop 0
    buffer_load_dwordx4 v2, s[8:11], s24 offen offset:512 sc1 lds
    v_mfma_f32_16x16x32_bf16 v[88:91], a[20:23], v[52:55], v[88:91]
    v_lshrrev_b32 v11, 4, v0
    v_cndmask_b32 v196, 0, 1.0, vcc
    v_mfma_f32_16x16x32_bf16 v[92:95], v[36:39], a[24:27], v[92:95]
    buffer_load_dwordx4 a[156:159], v229, s[8:11], s28 offen offset:3072 sc1
    s_add_u32 s28, s28, 4096
    v_mfma_f32_16x16x32_bf16 v[96:99], v[40:43], a[24:27], v[96:99]
    v_cndmask_b32 v197, 0, 1.0, vcc
    v_cndmask_b32 v198, 0, 1.0, vcc
    v_mfma_f32_16x16x32_bf16 v[100:103], v[44:47], a[24:27], v[100:103]
    buffer_load_dwordx4 a[0:3], v253, s[8:11], s28 offen offset:0 sc1
    v_mfma_f32_16x16x32_bf16 v[104:107], v[48:51], a[24:27], v[104:107]
    v_cndmask_b32 v199, 0, 1.0, vcc
    v_lshlrev_b32 v11, 2, v11
    v_mfma_f32_16x16x32_bf16 v[108:111], v[52:55], a[24:27], v[108:111]
    buffer_load_dwordx4 a[4:7], v253, s[8:11], s28 offen offset:1024 sc1
    v_mfma_f32_16x16x32_bf16 v[112:115], a[28:31], v[36:39], v[112:115]
    v_sub_u32 v10, v11, v10
    v_mov_b32 v12, 0xf149f2ca
    v_mfma_f32_16x16x32_bf16 v[116:119], a[28:31], v[40:43], v[116:119]
    s_cmp_eq_u32 s41, 0
    s_cselect_b64 s[38:39], 0, -1
    v_add_u32 v11, 0, v10
    v_and_b32 v13, 1, v11
    v_mfma_f32_16x16x32_bf16 v[120:123], a[28:31], v[44:47], v[120:123]
    v_cmp_eq_u32 s[20:21], 0, v13
    v_cmp_lt_i32 vcc, 1, v11
    v_cmp_gt_i32 s[18:19], 1, v11
    s_and_b64 vcc, vcc, s[20:21]
    s_and_b64 s[18:19], s[18:19], s[20:21]
    s_and_b64 s[20:21], vcc, s[38:39]
    v_cndmask_b32 v200, v12, 0, vcc
    v_cndmask_b32 v204, v12, 0, s[18:19]
    v_mfma_f32_16x16x32_bf16 v[124:127], a[28:31], v[48:51], v[124:127]
    v_cndmask_b32 v208, v12, 0, s[20:21]
    v_add_u32 v11, 1, v10
    v_mfma_f32_16x16x32_bf16 v[128:131], a[28:31], v[52:55], v[128:131]
    v_and_b32 v13, 1, v11
    v_cmp_eq_u32 s[20:21], 0, v13
    v_cmp_lt_i32 vcc, 1, v11
    v_cmp_gt_i32 s[18:19], 1, v11
    s_and_b64 vcc, vcc, s[20:21]
    s_and_b64 s[18:19], s[18:19], s[20:21]
    s_and_b64 s[20:21], vcc, s[38:39]
    v_cndmask_b32 v201, v12, 0, vcc
    s_waitcnt lgkmcnt(0)
    v_mfma_f32_16x16x32_bf16 v[56:59], a[32:35], v[20:23], v[56:59]
    ds_read_b128 v[36:39], v253 offset:15360
    v_mfma_f32_16x16x32_bf16 v[60:63], a[32:35], v[24:27], v[60:63]
    ds_read_b128 v[40:43], v253 offset:16384
    v_mfma_f32_16x16x32_bf16 v[64:67], a[32:35], v[28:31], v[64:67]
    ds_read_b128 v[44:47], v253 offset:17408
    v_mfma_f32_16x16x32_bf16 v[68:71], a[32:35], v[32:35], v[68:71]
    ds_read_b128 v[48:51], v253 offset:18432
    v_mfma_f32_16x16x32_bf16 v[72:75], a[36:39], v[16:19], v[72:75]
    ds_read_b128 v[52:55], v253 offset:19456
    v_mfma_f32_16x16x32_bf16 v[76:79], a[36:39], v[20:23], v[76:79]
    s_add_u32 m0, s25, 50176
    s_nop 0
    buffer_load_dwordx4 v2, s[8:11], s24 offen offset:1024 sc1 lds
    v_mfma_f32_16x16x32_bf16 v[80:83], a[36:39], v[24:27], v[80:83]
    v_cndmask_b32 v205, v12, 0, s[18:19]
    v_cndmask_b32 v209, v12, 0, s[20:21]
    v_mfma_f32_16x16x32_bf16 v[84:87], a[36:39], v[28:31], v[84:87]
    s_add_u32 m0, s25, 54784
    s_nop 0
    buffer_load_dwordx4 v2, s[8:11], s24 offen offset:1536 sc1 lds
    v_mfma_f32_16x16x32_bf16 v[88:91], a[36:39], v[32:35], v[88:91]
    v_add_u32 v11, 2, v10
    v_and_b32 v13, 1, v11
    v_mfma_f32_16x16x32_bf16 v[92:95], v[16:19], a[40:43], v[92:95]
    buffer_load_dwordx4 a[8:11], v253, s[8:11], s28 offen offset:2048 sc1
    v_mfma_f32_16x16x32_bf16 v[96:99], v[20:23], a[40:43], v[96:99]
    v_cmp_eq_u32 s[20:21], 0, v13
    v_cmp_lt_i32 vcc, 1, v11
    v_cmp_gt_i32 s[18:19], 1, v11
    s_and_b64 vcc, vcc, s[20:21]
    s_and_b64 s[18:19], s[18:19], s[20:21]
    s_and_b64 s[20:21], vcc, s[38:39]
    v_cndmask_b32 v202, v12, 0, vcc
    v_cndmask_b32 v206, v12, 0, s[18:19]
    v_mfma_f32_16x16x32_bf16 v[100:103], v[24:27], a[40:43], v[100:103]
    buffer_load_dwordx4 a[12:15], v229, s[8:11], s28 offen offset:3072 sc1
    s_add_u32 s28, s28, 4096
    v_mfma_f32_16x16x32_bf16 v[104:107], v[28:31], a[40:43], v[104:107]
    v_cndmask_b32 v210, v12, 0, s[20:21]
    v_add_u32 v11, 3, v10
    v_mfma_f32_16x16x32_bf16 v[108:111], v[32:35], a[40:43], v[108:111]
    buffer_load_dwordx4 a[16:19], v253, s[8:11], s28 offen offset:0 sc1
    v_mfma_f32_16x16x32_bf16 v[112:115], a[44:47], v[16:19], v[112:115]
    v_and_b32 v13, 1, v11
    v_cmp_eq_u32 s[20:21], 0, v13
    v_cmp_lt_i32 vcc, 1, v11
    v_cmp_gt_i32 s[18:19], 1, v11
    s_and_b64 vcc, vcc, s[20:21]
    s_and_b64 s[18:19], s[18:19], s[20:21]
    s_and_b64 s[20:21], vcc, s[38:39]
    v_cndmask_b32 v203, v12, 0, vcc
    v_mfma_f32_16x16x32_bf16 v[116:119], a[44:47], v[20:23], v[116:119]
    v_cndmask_b32 v207, v12, 0, s[18:19]
    v_cndmask_b32 v211, v12, 0, s[20:21]
    v_mfma_f32_16x16x32_bf16 v[120:123], a[44:47], v[24:27], v[120:123]
    s_lshl_b32 s45, s41, 1
    s_lshr_b32 s7, s40, 2
    s_add_u32 s45, s45, s7
    s_mul_i32 s30, s45, 36864
    s_add_u32 s30, s30, s43
    s_and_b32 s31, s40, 3
    s_mul_i32 s31, s31, 9
    s_add_u32 s31, s31, s3
    s_mul_i32 s32, s31, 18432
    s_add_u32 s32, s32, 2359296
    s_add_u32 s33, s32, 73728
    s_add_u32 s34, s32, 147456
    s_mov_b32 s39, 19496960
    v_min_u32 v228, 44, v0
    v_lshlrev_b32 v228, 3, v228
    v_mfma_f32_16x16x32_bf16 v[124:127], a[44:47], v[28:31], v[124:127]
    s_cmp_eq_u32 s3, 1
    s_cmov_b32 s34, 3022848
    s_cmp_lt_u32 s3, 2
    s_cselect_b32 s35, 0, 1073741824
    v_add_u32 v5, s35, v253
    s_cmp_eq_u32 s3, 1
    s_cselect_b32 s7, 8, 0
    v_and_b32 v10, s7, v0
    v_mfma_f32_16x16x32_bf16 v[128:131], a[44:47], v[32:35], v[128:131]
    v_lshl_add_u32 v5, v10, 27, v5
    s_cmp_eq_u32 s3, 0
    s_cselect_b32 s35, 0, 1073741824
    v_add_u32 v7, s35, v9
    s_waitcnt lgkmcnt(0)
    v_mfma_f32_16x16x32_bf16 v[56:59], a[48:51], v[40:43], v[56:59]
    ds_read_b128 v[16:19], v253 offset:20480
    v_mfma_f32_16x16x32_bf16 v[60:63], a[48:51], v[44:47], v[60:63]
    ds_read_b128 v[20:23], v253 offset:21504
    v_mfma_f32_16x16x32_bf16 v[64:67], a[48:51], v[48:51], v[64:67]
    ds_read_b128 v[24:27], v253 offset:22528
    v_mfma_f32_16x16x32_bf16 v[68:71], a[48:51], v[52:55], v[68:71]
    ds_read_b128 v[28:31], v253 offset:23552
    v_mfma_f32_16x16x32_bf16 v[72:75], a[52:55], v[36:39], v[72:75]
    ds_read_b128 v[32:35], v253 offset:24576
    v_mfma_f32_16x16x32_bf16 v[76:79], a[52:55], v[40:43], v[76:79]
    s_add_u32 m0, s26, 30720
    s_add_u32 s7, s27, 3072
    buffer_load_dwordx4 v2, s[8:11], s7 offen sc1 lds
    v_mfma_f32_16x16x32_bf16 v[80:83], a[52:55], v[44:47], v[80:83]
    s_lshl_b32 s7, s31, 8
    s_add_u32 s36, s30, s7
    s_add_u32 s37, s36, 43515904
    s_add_u32 s46, s36, 45875200
    s_lshl_b32 s36, s45, 7
    s_add_u32 s36, s36, s43
    s_add_u32 s36, s36, 48431104
    s_lshl_b32 s47, s45, 9
    s_add_u32 s47, s47, s43
    s_add_u32 s47, s47, 48234496
    v_bfe_u32 v10, v0, 3, 2
    v_and_b32 v8, 7, v0
    v_mfma_f32_16x16x32_bf16 v[84:87], a[52:55], v[48:51], v[84:87]
    s_add_u32 m0, s29, 30720
    s_add_u32 s7, s23, 3072
    buffer_load_dwordx4 v2, s[8:11], s7 offen sc1 lds
    v_mfma_f32_16x16x32_bf16 v[88:91], a[52:55], v[52:55], v[88:91]
    v_lshlrev_b32 v8, 2, v8
    v_lshl_add_u32 v8, v10, 7, v8
    v_mfma_f32_16x16x32_bf16 v[92:95], v[36:39], a[56:59], v[92:95]
    buffer_load_dwordx4 a[20:23], v253, s[8:11], s28 offen offset:1024 sc1
    v_mfma_f32_16x16x32_bf16 v[96:99], v[40:43], a[56:59], v[96:99]
    v_mfma_f32_16x16x32_bf16 v[100:103], v[44:47], a[56:59], v[100:103]
    buffer_load_dwordx4 a[24:27], v253, s[8:11], s28 offen offset:2048 sc1
    v_mfma_f32_16x16x32_bf16 v[104:107], v[48:51], a[56:59], v[104:107]
    v_mfma_f32_16x16x32_bf16 v[108:111], v[52:55], a[56:59], v[108:111]
    buffer_load_dwordx4 a[28:31], v229, s[8:11], s28 offen offset:3072 sc1
    s_add_u32 s28, s28, 4096
    v_mfma_f32_16x16x32_bf16 v[112:115], a[60:63], v[36:39], v[112:115]
    v_mfma_f32_16x16x32_bf16 v[116:119], a[60:63], v[40:43], v[116:119]
    v_mfma_f32_16x16x32_bf16 v[120:123], a[60:63], v[44:47], v[120:123]
    v_mfma_f32_16x16x32_bf16 v[124:127], a[60:63], v[48:51], v[124:127]
    v_mfma_f32_16x16x32_bf16 v[128:131], a[60:63], v[52:55], v[128:131]
    s_waitcnt lgkmcnt(0)
    v_mfma_f32_16x16x32_bf16 v[56:59], a[64:67], v[20:23], v[56:59]
    ds_read_b128 v[36:39], v253 offset:25600
    v_mfma_f32_16x16x32_bf16 v[60:63], a[64:67], v[24:27], v[60:63]
    ds_read_b128 v[40:43], v253 offset:26624
    v_mfma_f32_16x16x32_bf16 v[64:67], a[64:67], v[28:31], v[64:67]
    ds_read_b128 v[44:47], v253 offset:27648
    v_mfma_f32_16x16x32_bf16 v[68:71], a[64:67], v[32:35], v[68:71]
    ds_read_b128 v[48:51], v253 offset:28672
    v_mfma_f32_16x16x32_bf16 v[72:75], a[68:71], v[16:19], v[72:75]
    ds_read_b128 v[52:55], v253 offset:29696
    v_mfma_f32_16x16x32_bf16 v[76:79], a[68:71], v[20:23], v[76:79]
    buffer_load_dwordx4 a[32:35], v253, s[8:11], s28 offen offset:0 sc1
    v_mfma_f32_16x16x32_bf16 v[80:83], a[68:71], v[24:27], v[80:83]
    v_mfma_f32_16x16x32_bf16 v[84:87], a[68:71], v[28:31], v[84:87]
    buffer_load_dwordx4 a[36:39], v253, s[8:11], s28 offen offset:1024 sc1
    v_mfma_f32_16x16x32_bf16 v[88:91], a[68:71], v[32:35], v[88:91]
    v_mfma_f32_16x16x32_bf16 v[92:95], v[16:19], a[72:75], v[92:95]
    buffer_load_dwordx4 a[40:43], v253, s[8:11], s28 offen offset:2048 sc1
    v_mfma_f32_16x16x32_bf16 v[96:99], v[20:23], a[72:75], v[96:99]
    v_mfma_f32_16x16x32_bf16 v[100:103], v[24:27], a[72:75], v[100:103]
    v_mfma_f32_16x16x32_bf16 v[104:107], v[28:31], a[72:75], v[104:107]
    v_mfma_f32_16x16x32_bf16 v[108:111], v[32:35], a[72:75], v[108:111]
    v_mfma_f32_16x16x32_bf16 v[112:115], a[76:79], v[16:19], v[112:115]
    v_mfma_f32_16x16x32_bf16 v[116:119], a[76:79], v[20:23], v[116:119]
    v_mfma_f32_16x16x32_bf16 v[120:123], a[76:79], v[24:27], v[120:123]
    v_mfma_f32_16x16x32_bf16 v[124:127], a[76:79], v[28:31], v[124:127]
    v_mfma_f32_16x16x32_bf16 v[128:131], a[76:79], v[32:35], v[128:131]
    s_waitcnt vmcnt(6) lgkmcnt(0)
    s_barrier
    v_mfma_f32_16x16x32_bf16 v[56:59], a[80:83], v[40:43], v[56:59]
    ds_read_b128 v[16:19], v253 offset:30720
    v_mfma_f32_16x16x32_bf16 v[60:63], a[80:83], v[44:47], v[60:63]
    ds_read_b128 v[20:23], v253 offset:31744
    v_mfma_f32_16x16x32_bf16 v[64:67], a[80:83], v[48:51], v[64:67]
    ds_read_b128 v[24:27], v253 offset:32768
    v_mfma_f32_16x16x32_bf16 v[68:71], a[80:83], v[52:55], v[68:71]
    ds_read_b128 v[28:31], v253 offset:33792
    v_mfma_f32_16x16x32_bf16 v[72:75], a[84:87], v[36:39], v[72:75]
    ds_read_b128 v[32:35], v253 offset:34816
    v_mfma_f32_16x16x32_bf16 v[76:79], a[84:87], v[40:43], v[76:79]
    s_add_u32 m0, s25, 59392
    s_nop 0
    buffer_load_dwordx4 v2, s[8:11], s24 offen offset:2048 sc1 lds
    v_mfma_f32_16x16x32_bf16 v[80:83], a[84:87], v[44:47], v[80:83]
    v_mfma_f32_16x16x32_bf16 v[84:87], a[84:87], v[48:51], v[84:87]
    s_add_u32 m0, s25, 64000
    s_nop 0
    buffer_load_dwordx4 v2, s[8:11], s24 offen offset:2560 sc1 lds
    v_mfma_f32_16x16x32_bf16 v[88:91], a[84:87], v[52:55], v[88:91]
    v_mfma_f32_16x16x32_bf16 v[92:95], v[36:39], a[88:91], v[92:95]
    buffer_load_dwordx4 a[44:47], v229, s[8:11], s28 offen offset:3072 sc1
    s_add_u32 s28, s28, 4096
    v_mfma_f32_16x16x32_bf16 v[96:99], v[40:43], a[88:91], v[96:99]
    v_mfma_f32_16x16x32_bf16 v[100:103], v[44:47], a[88:91], v[100:103]
    buffer_load_dwordx4 a[48:51], v253, s[8:11], s28 offen offset:0 sc1
    v_mfma_f32_16x16x32_bf16 v[104:107], v[48:51], a[88:91], v[104:107]
    v_mfma_f32_16x16x32_bf16 v[108:111], v[52:55], a[88:91], v[108:111]
    buffer_load_dwordx4 a[52:55], v253, s[8:11], s28 offen offset:1024 sc1
    v_mfma_f32_16x16x32_bf16 v[112:115], a[92:95], v[36:39], v[112:115]
    v_mfma_f32_16x16x32_bf16 v[116:119], a[92:95], v[40:43], v[116:119]
    v_mfma_f32_16x16x32_bf16 v[120:123], a[92:95], v[44:47], v[120:123]
    v_mfma_f32_16x16x32_bf16 v[124:127], a[92:95], v[48:51], v[124:127]
    v_mfma_f32_16x16x32_bf16 v[128:131], a[92:95], v[52:55], v[128:131]
    s_waitcnt lgkmcnt(0)
    v_mfma_f32_16x16x32_bf16 v[56:59], a[96:99], v[20:23], v[56:59]
    ds_read_b128 v[36:39], v253 offset:35840
    v_mfma_f32_16x16x32_bf16 v[60:63], a[96:99], v[24:27], v[60:63]
    ds_read_b128 v[40:43], v253 offset:36864
    v_mfma_f32_16x16x32_bf16 v[64:67], a[96:99], v[28:31], v[64:67]
    ds_read_b128 v[44:47], v253 offset:37888
    v_mfma_f32_16x16x32_bf16 v[68:71], a[96:99], v[32:35], v[68:71]
    ds_read_b128 v[48:51], v253 offset:38912
    v_mfma_f32_16x16x32_bf16 v[72:75], a[100:103], v[16:19], v[72:75]
    ds_read_b128 v[52:55], v253 offset:39936
    v_mfma_f32_16x16x32_bf16 v[76:79], a[100:103], v[20:23], v[76:79]
    s_add_u32 m0, s25, 68608
    s_nop 0
    buffer_load_dwordx4 v2, s[8:11], s24 offen offset:3072 sc1 lds
    v_mfma_f32_16x16x32_bf16 v[80:83], a[100:103], v[24:27], v[80:83]
    v_mfma_f32_16x16x32_bf16 v[84:87], a[100:103], v[28:31], v[84:87]
    s_add_u32 m0, s25, 73216
    s_nop 0
    buffer_load_dwordx4 v2, s[8:11], s24 offen offset:3584 sc1 lds
    v_mfma_f32_16x16x32_bf16 v[88:91], a[100:103], v[32:35], v[88:91]
    v_mfma_f32_16x16x32_bf16 v[92:95], v[16:19], a[104:107], v[92:95]
    buffer_load_dwordx4 a[56:59], v253, s[8:11], s28 offen offset:2048 sc1
    v_mfma_f32_16x16x32_bf16 v[96:99], v[20:23], a[104:107], v[96:99]
    v_mfma_f32_16x16x32_bf16 v[100:103], v[24:27], a[104:107], v[100:103]
    buffer_load_dwordx4 a[60:63], v229, s[8:11], s28 offen offset:3072 sc1
    s_add_u32 s28, s28, 4096
    v_mfma_f32_16x16x32_bf16 v[104:107], v[28:31], a[104:107], v[104:107]
    v_mfma_f32_16x16x32_bf16 v[108:111], v[32:35], a[104:107], v[108:111]
    buffer_load_dwordx4 a[64:67], v253, s[8:11], s28 offen offset:0 sc1
    v_mfma_f32_16x16x32_bf16 v[112:115], a[108:111], v[16:19], v[112:115]
    v_mfma_f32_16x16x32_bf16 v[116:119], a[108:111], v[20:23], v[116:119]
    buffer_load_dwordx2 v[226:227], v228, s[8:11], s39 offen sc1
    v_mfma_f32_16x16x32_bf16 v[120:123], a[108:111], v[24:27], v[120:123]
    v_mfma_f32_16x16x32_bf16 v[124:127], a[108:111], v[28:31], v[124:127]
    v_mfma_f32_16x16x32_bf16 v[128:131], a[108:111], v[32:35], v[128:131]
    s_waitcnt lgkmcnt(0)
    v_mfma_f32_16x16x32_bf16 v[56:59], a[112:115], v[40:43], v[56:59]
    ds_read_b128 v[16:19], v253 offset:40960
    v_mfma_f32_16x16x32_bf16 v[60:63], a[112:115], v[44:47], v[60:63]
    ds_read_b128 v[20:23], v253 offset:41984
    v_mfma_f32_16x16x32_bf16 v[64:67], a[112:115], v[48:51], v[64:67]
    ds_read_b128 v[24:27], v253 offset:43008
    v_mfma_f32_16x16x32_bf16 v[68:71], a[112:115], v[52:55], v[68:71]
    ds_read_b128 v[28:31], v253 offset:44032
    v_mfma_f32_16x16x32_bf16 v[72:75], a[116:119], v[36:39], v[72:75]
    ds_read_b128 v[32:35], v253 offset:45056
    v_mfma_f32_16x16x32_bf16 v[76:79], a[116:119], v[40:43], v[76:79]
    s_add_u32 m0, s25, 81920
    s_add_u32 s24, s24, 4096
    buffer_load_dwordx4 v2, s[8:11], s24 offen offset:0 sc1 lds
    v_mfma_f32_16x16x32_bf16 v[80:83], a[116:119], v[44:47], v[80:83]
    v_mfma_f32_16x16x32_bf16 v[84:87], a[116:119], v[48:51], v[84:87]
    s_add_u32 m0, s25, 86528
    s_nop 0
    buffer_load_dwordx4 v2, s[8:11], s24 offen offset:512 sc1 lds
    v_mfma_f32_16x16x32_bf16 v[88:91], a[116:119], v[52:55], v[88:91]
    v_mfma_f32_16x16x32_bf16 v[92:95], v[36:39], a[120:123], v[92:95]
    buffer_load_dwordx4 a[68:71], v253, s[8:11], s28 offen offset:1024 sc1
    v_mfma_f32_16x16x32_bf16 v[96:99], v[40:43], a[120:123], v[96:99]
    v_mfma_f32_16x16x32_bf16 v[100:103], v[44:47], a[120:123], v[100:103]
    buffer_load_dwordx4 a[72:75], v253, s[8:11], s28 offen offset:2048 sc1
    v_mfma_f32_16x16x32_bf16 v[104:107], v[48:51], a[120:123], v[104:107]
    v_mfma_f32_16x16x32_bf16 v[108:111], v[52:55], a[120:123], v[108:111]
    buffer_load_dwordx4 a[76:79], v229, s[8:11], s28 offen offset:3072 sc1
    s_add_u32 s28, s28, 4096
    v_mfma_f32_16x16x32_bf16 v[112:115], a[124:127], v[36:39], v[112:115]
    v_mfma_f32_16x16x32_bf16 v[116:119], a[124:127], v[40:43], v[116:119]
    v_mfma_f32_16x16x32_bf16 v[120:123], a[124:127], v[44:47], v[120:123]
    v_mfma_f32_16x16x32_bf16 v[124:127], a[124:127], v[48:51], v[124:127]
    v_mfma_f32_16x16x32_bf16 v[128:131], a[124:127], v[52:55], v[128:131]
    s_waitcnt lgkmcnt(0)
    v_mfma_f32_16x16x32_bf16 v[56:59], a[128:131], v[20:23], v[56:59]
    ds_read_b128 v[36:39], v6 offset:0
    v_mfma_f32_16x16x32_bf16 v[60:63], a[128:131], v[24:27], v[60:63]
    ds_read_b128 v[40:43], v6 offset:1024
    v_mfma_f32_16x16x32_bf16 v[64:67], a[128:131], v[28:31], v[64:67]
    ds_read_b128 v[44:47], v6 offset:2048
    v_mfma_f32_16x16x32_bf16 v[68:71], a[128:131], v[32:35], v[68:71]
    ds_read_b128 v[48:51], v6 offset:3072
    v_mfma_f32_16x16x32_bf16 v[72:75], a[132:135], v[16:19], v[72:75]
    ds_read_b128 v[52:55], v6 offset:4096
    v_mfma_f32_16x16x32_bf16 v[76:79], a[132:135], v[20:23], v[76:79]
    s_add_u32 m0, s26, 61440
    s_add_u32 s7, s27, 6144
    buffer_load_dwordx4 v2, s[8:11], s7 offen sc1 lds
    v_mfma_f32_16x16x32_bf16 v[80:83], a[132:135], v[24:27], v[80:83]
    v_mfma_f32_16x16x32_bf16 v[84:87], a[132:135], v[28:31], v[84:87]
    s_add_u32 m0, s29, 61440
    s_add_u32 s7, s23, 6144
    buffer_load_dwordx4 v2, s[8:11], s7 offen sc1 lds
    v_mfma_f32_16x16x32_bf16 v[88:91], a[132:135], v[32:35], v[88:91]
    v_mfma_f32_16x16x32_bf16 v[92:95], v[16:19], a[136:139], v[92:95]
    buffer_load_dwordx4 a[80:83], v253, s[8:11], s28 offen offset:0 sc1
    v_mfma_f32_16x16x32_bf16 v[96:99], v[20:23], a[136:139], v[96:99]
    v_mfma_f32_16x16x32_bf16 v[100:103], v[24:27], a[136:139], v[100:103]
    buffer_load_dwordx4 a[84:87], v253, s[8:11], s28 offen offset:1024 sc1
    v_mfma_f32_16x16x32_bf16 v[104:107], v[28:31], a[136:139], v[104:107]
    v_mfma_f32_16x16x32_bf16 v[108:111], v[32:35], a[136:139], v[108:111]
    buffer_load_dwordx4 a[88:91], v253, s[8:11], s28 offen offset:2048 sc1
    v_mfma_f32_16x16x32_bf16 v[112:115], a[140:143], v[16:19], v[112:115]
    v_mfma_f32_16x16x32_bf16 v[116:119], a[140:143], v[20:23], v[116:119]
    v_mfma_f32_16x16x32_bf16 v[120:123], a[140:143], v[24:27], v[120:123]
    v_mfma_f32_16x16x32_bf16 v[124:127], a[140:143], v[28:31], v[124:127]
    v_mfma_f32_16x16x32_bf16 v[128:131], a[140:143], v[32:35], v[128:131]
    s_waitcnt vmcnt(10) lgkmcnt(0)
    s_mov_b32 s6, 0
L_wo_poll_15:
    v_cmp_eq_u32 vcc, s76, v226
    v_cmp_eq_u32 s[20:21], s76, v227
    s_and_b64 vcc, vcc, s[20:21]
    s_cmp_eq_u64 vcc, exec
    s_cbranch_scc1 L_wo_ready_16
    buffer_load_dwordx2 v[226:227], v228, s[8:11], s39 offen sc1
    s_add_u32 s6, s6, 1
    s_cmp_lt_u32 s6, 1048576
    s_waitcnt vmcnt(0)
    s_cbranch_scc1 L_wo_poll_15
    s_branch L_main_end
L_wo_ready_16:
    v_mfma_f32_16x16x32_bf16 v[56:59], a[144:147], v[40:43], v[56:59]
    ds_read_b128 v[16:19], v6 offset:5120
    v_mfma_f32_16x16x32_bf16 v[60:63], a[144:147], v[44:47], v[60:63]
    ds_read_b128 v[20:23], v6 offset:6144
    v_mfma_f32_16x16x32_bf16 v[64:67], a[144:147], v[48:51], v[64:67]
    ds_read_b128 v[24:27], v6 offset:7168
    v_mfma_f32_16x16x32_bf16 v[68:71], a[144:147], v[52:55], v[68:71]
    ds_read_b128 v[28:31], v6 offset:8192
    v_mfma_f32_16x16x32_bf16 v[72:75], a[148:151], v[36:39], v[72:75]
    ds_read_b128 v[32:35], v6 offset:9216
    v_mfma_f32_16x16x32_bf16 v[76:79], a[148:151], v[40:43], v[76:79]
    buffer_load_dwordx4 a[92:95], v229, s[8:11], s28 offen offset:3072 sc1
    s_add_u32 s28, s28, 4096
    v_mfma_f32_16x16x32_bf16 v[80:83], a[148:151], v[44:47], v[80:83]
    v_mfma_f32_16x16x32_bf16 v[84:87], a[148:151], v[48:51], v[84:87]
    buffer_load_dwordx4 a[96:99], v253, s[8:11], s28 offen offset:0 sc1
    v_mfma_f32_16x16x32_bf16 v[88:91], a[148:151], v[52:55], v[88:91]
    v_mfma_f32_16x16x32_bf16 v[92:95], v[36:39], a[152:155], v[92:95]
    buffer_load_dwordx4 a[100:103], v253, s[8:11], s28 offen offset:1024 sc1
    v_mfma_f32_16x16x32_bf16 v[96:99], v[40:43], a[152:155], v[96:99]
    v_mfma_f32_16x16x32_bf16 v[100:103], v[44:47], a[152:155], v[100:103]
    buffer_load_dwordx4 a[160:163], v253, s[8:11], s32 offen offset:0 sc1
    v_mfma_f32_16x16x32_bf16 v[104:107], v[48:51], a[152:155], v[104:107]
    v_mfma_f32_16x16x32_bf16 v[108:111], v[52:55], a[152:155], v[108:111]
    v_mfma_f32_16x16x32_bf16 v[112:115], a[156:159], v[36:39], v[112:115]
    v_mfma_f32_16x16x32_bf16 v[116:119], a[156:159], v[40:43], v[116:119]
    v_mfma_f32_16x16x32_bf16 v[120:123], a[156:159], v[44:47], v[120:123]
    v_mfma_f32_16x16x32_bf16 v[124:127], a[156:159], v[48:51], v[124:127]
    v_mfma_f32_16x16x32_bf16 v[128:131], a[156:159], v[52:55], v[128:131]
    s_waitcnt vmcnt(34) lgkmcnt(0)
    v_mfma_f32_16x16x32_bf16 v[56:59], a[0:3], v[20:23], v[56:59]
    ds_read_b128 v[36:39], v6 offset:10240
    v_mfma_f32_16x16x32_bf16 v[60:63], a[0:3], v[24:27], v[60:63]
    ds_read_b128 v[40:43], v6 offset:11264
    v_mfma_f32_16x16x32_bf16 v[64:67], a[0:3], v[28:31], v[64:67]
    ds_read_b128 v[44:47], v6 offset:12288
    v_mfma_f32_16x16x32_bf16 v[68:71], a[0:3], v[32:35], v[68:71]
    ds_read_b128 v[48:51], v6 offset:13312
    v_mfma_f32_16x16x32_bf16 v[72:75], a[4:7], v[16:19], v[72:75]
    ds_read_b128 v[52:55], v6 offset:14336
    v_mfma_f32_16x16x32_bf16 v[76:79], a[4:7], v[20:23], v[76:79]
    buffer_load_dwordx4 a[104:107], v253, s[8:11], s28 offen offset:2048 sc1
    v_mfma_f32_16x16x32_bf16 v[80:83], a[4:7], v[24:27], v[80:83]
    v_mfma_f32_16x16x32_bf16 v[84:87], a[4:7], v[28:31], v[84:87]
    buffer_load_dwordx4 a[108:111], v229, s[8:11], s28 offen offset:3072 sc1
    s_add_u32 s28, s28, 4096
    v_mfma_f32_16x16x32_bf16 v[88:91], a[4:7], v[32:35], v[88:91]
    v_mfma_f32_16x16x32_bf16 v[92:95], v[16:19], a[8:11], v[92:95]
    buffer_load_dwordx4 a[112:115], v253, s[8:11], s28 offen offset:0 sc1
    v_mfma_f32_16x16x32_bf16 v[96:99], v[20:23], a[8:11], v[96:99]
    v_mfma_f32_16x16x32_bf16 v[100:103], v[24:27], a[8:11], v[100:103]
    buffer_load_dwordx4 a[164:167], v253, s[8:11], s33 offen offset:0 sc1
    v_mfma_f32_16x16x32_bf16 v[104:107], v[28:31], a[8:11], v[104:107]
    v_mfma_f32_16x16x32_bf16 v[108:111], v[32:35], a[8:11], v[108:111]
    v_mfma_f32_16x16x32_bf16 v[112:115], a[12:15], v[16:19], v[112:115]
    v_mfma_f32_16x16x32_bf16 v[116:119], a[12:15], v[20:23], v[116:119]
    v_mfma_f32_16x16x32_bf16 v[120:123], a[12:15], v[24:27], v[120:123]
    v_mfma_f32_16x16x32_bf16 v[124:127], a[12:15], v[28:31], v[124:127]
    v_mfma_f32_16x16x32_bf16 v[128:131], a[12:15], v[32:35], v[128:131]
    s_waitcnt vmcnt(11) lgkmcnt(0)
    s_barrier
    v_mfma_f32_16x16x32_bf16 v[56:59], a[16:19], v[40:43], v[56:59]
    ds_read_b128 v[16:19], v6 offset:15360
    v_mfma_f32_16x16x32_bf16 v[60:63], a[16:19], v[44:47], v[60:63]
    ds_read_b128 v[20:23], v6 offset:16384
    v_mfma_f32_16x16x32_bf16 v[64:67], a[16:19], v[48:51], v[64:67]
    ds_read_b128 v[24:27], v6 offset:17408
    v_mfma_f32_16x16x32_bf16 v[68:71], a[16:19], v[52:55], v[68:71]
    ds_read_b128 v[28:31], v6 offset:18432
    v_mfma_f32_16x16x32_bf16 v[72:75], a[20:23], v[36:39], v[72:75]
    ds_read_b128 v[32:35], v6 offset:19456
    v_mfma_f32_16x16x32_bf16 v[76:79], a[20:23], v[40:43], v[76:79]
    buffer_load_dwordx4 a[116:119], v253, s[8:11], s28 offen offset:1024 sc1
    v_mfma_f32_16x16x32_bf16 v[80:83], a[20:23], v[44:47], v[80:83]
    v_mfma_f32_16x16x32_bf16 v[84:87], a[20:23], v[48:51], v[84:87]
    buffer_load_dwordx4 a[120:123], v253, s[8:11], s28 offen offset:2048 sc1
    v_mfma_f32_16x16x32_bf16 v[88:91], a[20:23], v[52:55], v[88:91]
    v_mfma_f32_16x16x32_bf16 v[92:95], v[36:39], a[24:27], v[92:95]
    buffer_load_dwordx4 a[124:127], v229, s[8:11], s28 offen offset:3072 sc1
    s_add_u32 s28, s28, 4096
    v_mfma_f32_16x16x32_bf16 v[96:99], v[40:43], a[24:27], v[96:99]
    v_mfma_f32_16x16x32_bf16 v[100:103], v[44:47], a[24:27], v[100:103]
    buffer_load_dwordx4 a[168:171], v5, s[8:11], s34 offen offset:0 sc1
    v_mfma_f32_16x16x32_bf16 v[104:107], v[48:51], a[24:27], v[104:107]
    v_mfma_f32_16x16x32_bf16 v[108:111], v[52:55], a[24:27], v[108:111]
    v_mfma_f32_16x16x32_bf16 v[112:115], a[28:31], v[36:39], v[112:115]
    v_mfma_f32_16x16x32_bf16 v[116:119], a[28:31], v[40:43], v[116:119]
    v_mfma_f32_16x16x32_bf16 v[120:123], a[28:31], v[44:47], v[120:123]
    v_mfma_f32_16x16x32_bf16 v[124:127], a[28:31], v[48:51], v[124:127]
    v_mfma_f32_16x16x32_bf16 v[128:131], a[28:31], v[52:55], v[128:131]
    s_waitcnt vmcnt(30) lgkmcnt(0)
    v_mfma_f32_16x16x32_bf16 v[56:59], a[32:35], v[20:23], v[56:59]
    ds_read_b128 v[36:39], v6 offset:20480
    v_mfma_f32_16x16x32_bf16 v[60:63], a[32:35], v[24:27], v[60:63]
    ds_read_b128 v[40:43], v6 offset:21504
    v_mfma_f32_16x16x32_bf16 v[64:67], a[32:35], v[28:31], v[64:67]
    ds_read_b128 v[44:47], v6 offset:22528
    v_mfma_f32_16x16x32_bf16 v[68:71], a[32:35], v[32:35], v[68:71]
    ds_read_b128 v[48:51], v6 offset:23552
    v_mfma_f32_16x16x32_bf16 v[72:75], a[36:39], v[16:19], v[72:75]
    ds_read_b128 v[52:55], v6 offset:24576
    v_mfma_f32_16x16x32_bf16 v[76:79], a[36:39], v[20:23], v[76:79]
    buffer_load_dwordx4 a[172:175], v253, s[8:11], s32 offen offset:1024 sc1
    v_mfma_f32_16x16x32_bf16 v[80:83], a[36:39], v[24:27], v[80:83]
    v_mfma_f32_16x16x32_bf16 v[84:87], a[36:39], v[28:31], v[84:87]
    buffer_load_dwordx4 a[176:179], v253, s[8:11], s33 offen offset:1024 sc1
    v_mfma_f32_16x16x32_bf16 v[88:91], a[36:39], v[32:35], v[88:91]
    v_mfma_f32_16x16x32_bf16 v[92:95], v[16:19], a[40:43], v[92:95]
    buffer_load_dwordx4 a[180:183], v5, s[8:11], s34 offen offset:1024 sc1
    v_mfma_f32_16x16x32_bf16 v[96:99], v[20:23], a[40:43], v[96:99]
    v_mfma_f32_16x16x32_bf16 v[100:103], v[24:27], a[40:43], v[100:103]
    buffer_load_dwordx4 a[184:187], v253, s[8:11], s32 offen offset:2048 sc1
    v_mfma_f32_16x16x32_bf16 v[104:107], v[28:31], a[40:43], v[104:107]
    v_mfma_f32_16x16x32_bf16 v[108:111], v[32:35], a[40:43], v[108:111]
    v_mfma_f32_16x16x32_bf16 v[112:115], a[44:47], v[16:19], v[112:115]
    v_mfma_f32_16x16x32_bf16 v[116:119], a[44:47], v[20:23], v[116:119]
    v_mfma_f32_16x16x32_bf16 v[120:123], a[44:47], v[24:27], v[120:123]
    v_mfma_f32_16x16x32_bf16 v[124:127], a[44:47], v[28:31], v[124:127]
    v_mfma_f32_16x16x32_bf16 v[128:131], a[44:47], v[32:35], v[128:131]
    s_waitcnt vmcnt(28) lgkmcnt(0)
    v_mfma_f32_16x16x32_bf16 v[56:59], a[48:51], v[40:43], v[56:59]
    ds_read_b128 v[16:19], v6 offset:25600
    v_mfma_f32_16x16x32_bf16 v[60:63], a[48:51], v[44:47], v[60:63]
    ds_read_b128 v[20:23], v6 offset:26624
    v_mfma_f32_16x16x32_bf16 v[64:67], a[48:51], v[48:51], v[64:67]
    ds_read_b128 v[24:27], v6 offset:27648
    v_mfma_f32_16x16x32_bf16 v[68:71], a[48:51], v[52:55], v[68:71]
    ds_read_b128 v[28:31], v6 offset:28672
    v_mfma_f32_16x16x32_bf16 v[72:75], a[52:55], v[36:39], v[72:75]
    ds_read_b128 v[32:35], v6 offset:29696
    v_mfma_f32_16x16x32_bf16 v[76:79], a[52:55], v[40:43], v[76:79]
    buffer_load_dwordx4 a[188:191], v253, s[8:11], s33 offen offset:2048 sc1
    v_mfma_f32_16x16x32_bf16 v[80:83], a[52:55], v[44:47], v[80:83]
    v_mfma_f32_16x16x32_bf16 v[84:87], a[52:55], v[48:51], v[84:87]
    buffer_load_dwordx4 a[192:195], v5, s[8:11], s34 offen offset:2048 sc1
    v_mfma_f32_16x16x32_bf16 v[88:91], a[52:55], v[52:55], v[88:91]
    v_mfma_f32_16x16x32_bf16 v[92:95], v[36:39], a[56:59], v[92:95]
    buffer_load_dwordx4 a[196:199], v253, s[8:11], s32 offen offset:3072 sc1
    s_add_u32 s32, s32, 4096
    v_mfma_f32_16x16x32_bf16 v[96:99], v[40:43], a[56:59], v[96:99]
    v_mfma_f32_16x16x32_bf16 v[100:103], v[44:47], a[56:59], v[100:103]
    buffer_load_dwordx4 a[200:203], v253, s[8:11], s33 offen offset:3072 sc1
    s_add_u32 s33, s33, 4096
    v_mfma_f32_16x16x32_bf16 v[104:107], v[48:51], a[56:59], v[104:107]
    v_mfma_f32_16x16x32_bf16 v[108:111], v[52:55], a[56:59], v[108:111]
    v_mfma_f32_16x16x32_bf16 v[112:115], a[60:63], v[36:39], v[112:115]
    v_mfma_f32_16x16x32_bf16 v[116:119], a[60:63], v[40:43], v[116:119]
    v_mfma_f32_16x16x32_bf16 v[120:123], a[60:63], v[44:47], v[120:123]
    v_mfma_f32_16x16x32_bf16 v[124:127], a[60:63], v[48:51], v[124:127]
    v_mfma_f32_16x16x32_bf16 v[128:131], a[60:63], v[52:55], v[128:131]
    s_waitcnt vmcnt(25) lgkmcnt(0)
    v_mfma_f32_16x16x32_bf16 v[56:59], a[64:67], v[20:23], v[56:59]
    ds_read_b128 v[36:39], v6 offset:30720
    v_mfma_f32_16x16x32_bf16 v[60:63], a[64:67], v[24:27], v[60:63]
    ds_read_b128 v[40:43], v6 offset:31744
    v_mfma_f32_16x16x32_bf16 v[64:67], a[64:67], v[28:31], v[64:67]
    ds_read_b128 v[44:47], v6 offset:32768
    v_mfma_f32_16x16x32_bf16 v[68:71], a[64:67], v[32:35], v[68:71]
    ds_read_b128 v[48:51], v6 offset:33792
    v_mfma_f32_16x16x32_bf16 v[72:75], a[68:71], v[16:19], v[72:75]
    ds_read_b128 v[52:55], v6 offset:34816
    v_mfma_f32_16x16x32_bf16 v[76:79], a[68:71], v[20:23], v[76:79]
    buffer_load_dwordx4 a[204:207], v5, s[8:11], s34 offen offset:3072 sc1
    s_add_u32 s34, s34, 4096
    v_mfma_f32_16x16x32_bf16 v[80:83], a[68:71], v[24:27], v[80:83]
    v_mfma_f32_16x16x32_bf16 v[84:87], a[68:71], v[28:31], v[84:87]
    buffer_load_dwordx4 a[208:211], v253, s[8:11], s32 offen offset:0 sc1
    v_mfma_f32_16x16x32_bf16 v[88:91], a[68:71], v[32:35], v[88:91]
    v_mfma_f32_16x16x32_bf16 v[92:95], v[16:19], a[72:75], v[92:95]
    buffer_load_dwordx4 a[212:215], v253, s[8:11], s33 offen offset:0 sc1
    v_mfma_f32_16x16x32_bf16 v[96:99], v[20:23], a[72:75], v[96:99]
    v_mfma_f32_16x16x32_bf16 v[100:103], v[24:27], a[72:75], v[100:103]
    buffer_load_dwordx4 a[216:219], v5, s[8:11], s34 offen offset:0 sc1
    v_mfma_f32_16x16x32_bf16 v[104:107], v[28:31], a[72:75], v[104:107]
    v_mfma_f32_16x16x32_bf16 v[108:111], v[32:35], a[72:75], v[108:111]
    v_mfma_f32_16x16x32_bf16 v[112:115], a[76:79], v[16:19], v[112:115]
    v_mfma_f32_16x16x32_bf16 v[116:119], a[76:79], v[20:23], v[116:119]
    v_mfma_f32_16x16x32_bf16 v[120:123], a[76:79], v[24:27], v[120:123]
    v_mfma_f32_16x16x32_bf16 v[124:127], a[76:79], v[28:31], v[124:127]
    v_mfma_f32_16x16x32_bf16 v[128:131], a[76:79], v[32:35], v[128:131]
    s_waitcnt vmcnt(23) lgkmcnt(0)
    v_mfma_f32_16x16x32_bf16 v[56:59], a[80:83], v[40:43], v[56:59]
    ds_read_b128 v[16:19], v6 offset:35840
    v_mfma_f32_16x16x32_bf16 v[60:63], a[80:83], v[44:47], v[60:63]
    ds_read_b128 v[20:23], v6 offset:36864
    v_mfma_f32_16x16x32_bf16 v[64:67], a[80:83], v[48:51], v[64:67]
    ds_read_b128 v[24:27], v6 offset:37888
    v_mfma_f32_16x16x32_bf16 v[68:71], a[80:83], v[52:55], v[68:71]
    ds_read_b128 v[28:31], v6 offset:38912
    v_mfma_f32_16x16x32_bf16 v[72:75], a[84:87], v[36:39], v[72:75]
    ds_read_b128 v[32:35], v6 offset:39936
    v_mfma_f32_16x16x32_bf16 v[76:79], a[84:87], v[40:43], v[76:79]
    buffer_load_dwordx4 a[220:223], v253, s[8:11], s32 offen offset:1024 sc1
    v_mfma_f32_16x16x32_bf16 v[80:83], a[84:87], v[44:47], v[80:83]
    v_mfma_f32_16x16x32_bf16 v[84:87], a[84:87], v[48:51], v[84:87]
    buffer_load_dwordx4 a[224:227], v253, s[8:11], s33 offen offset:1024 sc1
    v_mfma_f32_16x16x32_bf16 v[88:91], a[84:87], v[52:55], v[88:91]
    v_mfma_f32_16x16x32_bf16 v[92:95], v[36:39], a[88:91], v[92:95]
    buffer_load_dwordx4 a[228:231], v5, s[8:11], s34 offen offset:1024 sc1
    v_mfma_f32_16x16x32_bf16 v[96:99], v[40:43], a[88:91], v[96:99]
    v_mfma_f32_16x16x32_bf16 v[100:103], v[44:47], a[88:91], v[100:103]
    buffer_load_dwordx4 a[232:235], v253, s[8:11], s32 offen offset:2048 sc1
    v_mfma_f32_16x16x32_bf16 v[104:107], v[48:51], a[88:91], v[104:107]
    v_mfma_f32_16x16x32_bf16 v[108:111], v[52:55], a[88:91], v[108:111]
    v_mfma_f32_16x16x32_bf16 v[112:115], a[92:95], v[36:39], v[112:115]
    v_mfma_f32_16x16x32_bf16 v[116:119], a[92:95], v[40:43], v[116:119]
    v_mfma_f32_16x16x32_bf16 v[120:123], a[92:95], v[44:47], v[120:123]
    v_mfma_f32_16x16x32_bf16 v[124:127], a[92:95], v[48:51], v[124:127]
    v_mfma_f32_16x16x32_bf16 v[128:131], a[92:95], v[52:55], v[128:131]
    s_waitcnt vmcnt(22) lgkmcnt(0)
    v_mfma_f32_16x16x32_bf16 v[56:59], a[96:99], v[20:23], v[56:59]
    ds_read_b128 v[36:39], v6 offset:40960
    v_mfma_f32_16x16x32_bf16 v[60:63], a[96:99], v[24:27], v[60:63]
    ds_read_b128 v[40:43], v6 offset:41984
    v_mfma_f32_16x16x32_bf16 v[64:67], a[96:99], v[28:31], v[64:67]
    ds_read_b128 v[44:47], v6 offset:43008
    v_mfma_f32_16x16x32_bf16 v[68:71], a[96:99], v[32:35], v[68:71]
    ds_read_b128 v[48:51], v6 offset:44032
    v_mfma_f32_16x16x32_bf16 v[72:75], a[100:103], v[16:19], v[72:75]
    ds_read_b128 v[52:55], v6 offset:45056
    v_mfma_f32_16x16x32_bf16 v[76:79], a[100:103], v[20:23], v[76:79]
    buffer_load_dwordx4 a[236:239], v253, s[8:11], s33 offen offset:2048 sc1
    v_mfma_f32_16x16x32_bf16 v[80:83], a[100:103], v[24:27], v[80:83]
    v_mfma_f32_16x16x32_bf16 v[84:87], a[100:103], v[28:31], v[84:87]
    buffer_load_dwordx4 a[240:243], v5, s[8:11], s34 offen offset:2048 sc1
    v_mfma_f32_16x16x32_bf16 v[88:91], a[100:103], v[32:35], v[88:91]
    v_mfma_f32_16x16x32_bf16 v[92:95], v[16:19], a[104:107], v[92:95]
    buffer_load_dwordx4 a[244:247], v253, s[8:11], s32 offen offset:3072 sc1
    s_add_u32 s32, s32, 4096
    v_mfma_f32_16x16x32_bf16 v[96:99], v[20:23], a[104:107], v[96:99]
    v_mfma_f32_16x16x32_bf16 v[100:103], v[24:27], a[104:107], v[100:103]
    buffer_load_dwordx4 a[248:251], v253, s[8:11], s33 offen offset:3072 sc1
    s_add_u32 s33, s33, 4096
    v_mfma_f32_16x16x32_bf16 v[104:107], v[28:31], a[104:107], v[104:107]
    v_mfma_f32_16x16x32_bf16 v[108:111], v[32:35], a[104:107], v[108:111]
    v_mfma_f32_16x16x32_bf16 v[112:115], a[108:111], v[16:19], v[112:115]
    v_mfma_f32_16x16x32_bf16 v[116:119], a[108:111], v[20:23], v[116:119]
    v_mfma_f32_16x16x32_bf16 v[120:123], a[108:111], v[24:27], v[120:123]
    v_mfma_f32_16x16x32_bf16 v[124:127], a[108:111], v[28:31], v[124:127]
    v_mfma_f32_16x16x32_bf16 v[128:131], a[108:111], v[32:35], v[128:131]
    s_waitcnt vmcnt(21) lgkmcnt(0)
    v_mfma_f32_16x16x32_bf16 v[56:59], a[112:115], v[40:43], v[56:59]
    v_mfma_f32_16x16x32_bf16 v[60:63], a[112:115], v[44:47], v[60:63]
    v_mfma_f32_16x16x32_bf16 v[64:67], a[112:115], v[48:51], v[64:67]
    v_mfma_f32_16x16x32_bf16 v[68:71], a[112:115], v[52:55], v[68:71]
    v_mfma_f32_16x16x32_bf16 v[72:75], a[116:119], v[36:39], v[72:75]
    v_mfma_f32_16x16x32_bf16 v[76:79], a[116:119], v[40:43], v[76:79]
    buffer_load_dwordx4 a[252:255], v5, s[8:11], s34 offen offset:3072 sc1
    s_add_u32 s34, s34, 4096
    v_mfma_f32_16x16x32_bf16 v[80:83], a[116:119], v[44:47], v[80:83]
    v_mfma_f32_16x16x32_bf16 v[84:87], a[116:119], v[48:51], v[84:87]
    buffer_load_dwordx4 a[128:131], v253, s[8:11], s32 offen offset:0 sc1
    v_mfma_f32_16x16x32_bf16 v[88:91], a[116:119], v[52:55], v[88:91]
    v_mfma_f32_16x16x32_bf16 v[92:95], v[36:39], a[120:123], v[92:95]
    buffer_load_dwordx4 a[132:135], v253, s[8:11], s33 offen offset:0 sc1
    v_mfma_f32_16x16x32_bf16 v[96:99], v[40:43], a[120:123], v[96:99]
    v_mfma_f32_16x16x32_bf16 v[100:103], v[44:47], a[120:123], v[100:103]
    buffer_load_dwordx4 a[136:139], v5, s[8:11], s34 offen offset:0 sc1
    v_mfma_f32_16x16x32_bf16 v[104:107], v[48:51], a[120:123], v[104:107]
    v_mfma_f32_16x16x32_bf16 v[108:111], v[52:55], a[120:123], v[108:111]
    v_mfma_f32_16x16x32_bf16 v[112:115], a[124:127], v[36:39], v[112:115]
    v_mfma_f32_16x16x32_bf16 v[116:119], a[124:127], v[40:43], v[116:119]
    v_mfma_f32_16x16x32_bf16 v[120:123], a[124:127], v[44:47], v[120:123]
    v_mfma_f32_16x16x32_bf16 v[124:127], a[124:127], v[48:51], v[124:127]
    v_mfma_f32_16x16x32_bf16 v[128:131], a[124:127], v[52:55], v[128:131]
    v_cvt_pk_bf16_f32 v136, v56, v57
    v_cvt_pk_bf16_f32 v137, v58, v59
    v_cvt_pk_bf16_f32 v140, v60, v61
    v_cvt_pk_bf16_f32 v141, v62, v63
    v_cvt_pk_bf16_f32 v144, v64, v65
    v_cvt_pk_bf16_f32 v145, v66, v67
    v_cvt_pk_bf16_f32 v148, v68, v69
    v_cvt_pk_bf16_f32 v149, v70, v71
    v_cvt_pk_bf16_f32 v152, v72, v73
    buffer_load_dwordx4 a[140:143], v253, s[8:11], s32 offen offset:1024 sc1
    v_cvt_pk_bf16_f32 v153, v74, v75
    v_cvt_pk_bf16_f32 v156, v76, v77
    v_cvt_pk_bf16_f32 v157, v78, v79
    v_cvt_pk_bf16_f32 v160, v80, v81
    v_cvt_pk_bf16_f32 v161, v82, v83
    v_cvt_pk_bf16_f32 v164, v84, v85
    v_cvt_pk_bf16_f32 v165, v86, v87
    v_cvt_pk_bf16_f32 v168, v88, v89
    v_cvt_pk_bf16_f32 v169, v90, v91
    buffer_load_dwordx4 a[144:147], v253, s[8:11], s33 offen offset:1024 sc1
    v_cvt_pk_bf16_f32 v134, v112, v113
    v_cvt_pk_bf16_f32 v154, v114, v115
    v_cvt_pk_bf16_f32 v138, v116, v117
    v_cvt_pk_bf16_f32 v158, v118, v119
    v_cvt_pk_bf16_f32 v142, v120, v121
    v_cvt_pk_bf16_f32 v162, v122, v123
    v_cvt_pk_bf16_f32 v146, v124, v125
    v_cvt_pk_bf16_f32 v166, v126, v127
    v_cvt_pk_bf16_f32 v150, v128, v129
    buffer_load_dwordx4 a[148:151], v5, s[8:11], s34 offen offset:1024 sc1
    v_cvt_pk_bf16_f32 v170, v130, v131
    v_cvt_pk_bf16_f32 v172, v92, v93
    v_cvt_pk_bf16_f32 v173, v94, v95
    v_cvt_pk_bf16_f32 v174, v96, v97
    v_cvt_pk_bf16_f32 v175, v98, v99
    v_cvt_pk_bf16_f32 v176, v100, v101
    v_cvt_pk_bf16_f32 v177, v102, v103
    v_cvt_pk_bf16_f32 v178, v104, v105
    v_cvt_pk_bf16_f32 v179, v106, v107
    buffer_load_dwordx4 a[152:155], v253, s[8:11], s32 offen offset:2048 sc1
    v_cvt_pk_bf16_f32 v180, v108, v109
    v_cvt_pk_bf16_f32 v181, v110, v111
    v_mfma_f32_16x16x32_bf16 v[16:19], v[152:155], v[136:139], v[208:211]
    v_mfma_f32_16x16x32_bf16 v[20:23], v[156:159], v[136:139], v[204:207]
    v_mfma_f32_16x16x32_bf16 v[24:27], v[156:159], v[140:143], v[200:203]
    v_mfma_f32_16x16x32_bf16 v[28:31], v[160:163], v[140:143], v[204:207]
    v_mfma_f32_16x16x32_bf16 v[32:35], v[160:163], v[144:147], v[200:203]
    v_mfma_f32_16x16x32_bf16 v[36:39], v[164:167], v[144:147], v[204:207]
    v_mfma_f32_16x16x32_bf16 v[40:43], v[164:167], v[148:151], v[200:203]
    buffer_load_dwordx4 a[156:159], v253, s[8:11], s33 offen offset:2048 sc1
    v_mfma_f32_16x16x32_bf16 v[44:47], v[168:171], v[148:151], v[204:207]
    v_mfma_f32_16x16x32_bf16 v[56:59], v[132:135], v[192:195], v[196:199]
    v_mfma_f32_16x16x32_bf16 v[60:63], v[136:139], v[192:195], v[196:199]
    v_mfma_f32_16x16x32_bf16 v[64:67], v[140:143], v[192:195], v[196:199]
    v_mfma_f32_16x16x32_bf16 v[68:71], v[144:147], v[192:195], v[196:199]
    v_mfma_f32_16x16x32_bf16 v[72:75], v[148:151], v[192:195], v[196:199]
    v_max3_f32 v92, v16, v17, v18
    v_max3_f32 v96, v19, v20, v21
    v_max3_f32 v93, v24, v25, v26
    buffer_load_dwordx4 a[0:3], v5, s[8:11], s34 offen offset:2048 sc1
    v_max3_f32 v97, v27, v28, v29
    v_max3_f32 v94, v32, v33, v34
    v_max3_f32 v98, v35, v36, v37
    v_max3_f32 v95, v40, v41, v42
    v_max3_f32 v99, v43, v44, v45
    v_max3_f32 v92, v92, v22, v23
    v_max3_f32 v93, v93, v30, v31
    v_max3_f32 v94, v94, v38, v39
    v_max3_f32 v95, v95, v46, v47
    buffer_load_dwordx4 a[4:7], v253, s[8:11], s32 offen offset:3072 sc1
    s_add_u32 s32, s32, 4096
    v_max_f32 v92, v92, v96
    v_max_f32 v93, v93, v97
    v_max_f32 v94, v94, v98
    v_max_f32 v95, v95, v99
    s_mov_b32 s18, 0x3eae1a93
    v_cvt_pk_bf16_f32 v182, v56, v57
    v_permlane32_swap_b32 v92, v93
    v_permlane32_swap_b32 v94, v95
    v_max_f32 v92, v92, v93
    buffer_load_dwordx4 a[8:11], v253, s[8:11], s33 offen offset:3072 sc1
    s_add_u32 s33, s33, 4096
    v_max_f32 v94, v94, v95
    v_cvt_pk_bf16_f32 v183, v58, v59
    v_cvt_pk_bf16_f32 v184, v60, v61
    v_permlane16_swap_b32 v92, v94
    v_max_f32 v92, v92, v94
    v_mul_f32 v92, 0xbeae1a93, v92
    v_mov_b32 v94, v92
    v_cvt_pk_bf16_f32 v185, v62, v63
    v_cvt_pk_bf16_f32 v186, v64, v65
    buffer_load_dwordx4 a[12:15], v5, s[8:11], s34 offen offset:3072 sc1
    s_add_u32 s34, s34, 4096
    v_permlane16_swap_b32 v92, v94
    v_mov_b32 v93, v92
    v_mov_b32 v95, v94
    v_cvt_pk_bf16_f32 v187, v66, v67
    v_cvt_pk_bf16_f32 v188, v68, v69
    v_permlane32_swap_b32 v92, v93
    v_permlane32_swap_b32 v94, v95
    v_cvt_pk_bf16_f32 v189, v70, v71
    v_cvt_pk_bf16_f32 v190, v72, v73
    buffer_load_dwordx4 a[16:19], v253, s[8:11], s32 offen offset:0 sc1
    v_cvt_pk_bf16_f32 v191, v74, v75
    v_fma_f32 v16, v16, s18, v92
    v_fma_f32 v17, v17, s18, v92
    v_fma_f32 v18, v18, s18, v92
    v_fma_f32 v19, v19, s18, v92
    v_fma_f32 v20, v20, s18, v92
    v_fma_f32 v21, v21, s18, v92
    v_fma_f32 v22, v22, s18, v92
    v_fma_f32 v23, v23, s18, v92
    buffer_load_dwordx4 a[20:23], v253, s[8:11], s33 offen offset:0 sc1
    v_exp_f32 v16, v16
    v_exp_f32 v17, v17
    v_exp_f32 v18, v18
    v_exp_f32 v19, v19
    v_exp_f32 v20, v20
    v_exp_f32 v21, v21
    v_exp_f32 v22, v22
    v_exp_f32 v23, v23
    s_nop 0
    buffer_load_dwordx4 a[24:27], v5, s[8:11], s34 offen offset:0 sc1
    v_cvt_pk_bf16_f32 v76, v16, v17
    v_cvt_pk_bf16_f32 v77, v18, v19
    v_cvt_pk_bf16_f32 v78, v20, v21
    v_cvt_pk_bf16_f32 v79, v22, v23
    v_fma_f32 v24, v24, s18, v93
    v_fma_f32 v25, v25, s18, v93
    v_fma_f32 v26, v26, s18, v93
    v_fma_f32 v27, v27, s18, v93
    v_fma_f32 v28, v28, s18, v93
    buffer_load_dwordx4 a[28:31], v253, s[8:11], s32 offen offset:1024 sc1
    v_fma_f32 v29, v29, s18, v93
    v_fma_f32 v30, v30, s18, v93
    v_fma_f32 v31, v31, s18, v93
    v_exp_f32 v24, v24
    v_exp_f32 v25, v25
    v_exp_f32 v26, v26
    v_exp_f32 v27, v27
    v_exp_f32 v28, v28
    v_exp_f32 v29, v29
    buffer_load_dwordx4 a[32:35], v253, s[8:11], s33 offen offset:1024 sc1
    v_exp_f32 v30, v30
    v_exp_f32 v31, v31
    v_mfma_f32_16x16x32_bf16 v[100:103], v[172:175], v[76:79], 0
    v_mfma_f32_16x16x32_bf16 v[116:119], v[182:185], v[76:79], 0
    v_cvt_pk_bf16_f32 v80, v24, v25
    v_cvt_pk_bf16_f32 v81, v26, v27
    v_cvt_pk_bf16_f32 v82, v28, v29
    v_cvt_pk_bf16_f32 v83, v30, v31
    v_fma_f32 v32, v32, s18, v94
    buffer_load_dwordx4 a[36:39], v5, s[8:11], s34 offen offset:1024 sc1
    v_fma_f32 v33, v33, s18, v94
    v_fma_f32 v34, v34, s18, v94
    v_fma_f32 v35, v35, s18, v94
    v_fma_f32 v36, v36, s18, v94
    v_fma_f32 v37, v37, s18, v94
    v_fma_f32 v38, v38, s18, v94
    v_fma_f32 v39, v39, s18, v94
    v_exp_f32 v32, v32
    v_exp_f32 v33, v33
    buffer_load_dwordx4 a[40:43], v253, s[8:11], s32 offen offset:2048 sc1
    v_exp_f32 v34, v34
    v_exp_f32 v35, v35
    v_exp_f32 v36, v36
    v_exp_f32 v37, v37
    v_exp_f32 v38, v38
    v_exp_f32 v39, v39
    v_mfma_f32_16x16x32_bf16 v[104:107], v[174:177], v[80:83], 0
    v_mfma_f32_16x16x32_bf16 v[120:123], v[184:187], v[80:83], 0
    v_cvt_pk_bf16_f32 v84, v32, v33
    buffer_load_dwordx4 a[44:47], v253, s[8:11], s33 offen offset:2048 sc1
    v_cvt_pk_bf16_f32 v85, v34, v35
    v_cvt_pk_bf16_f32 v86, v36, v37
    v_cvt_pk_bf16_f32 v87, v38, v39
    v_fma_f32 v40, v40, s18, v95
    v_fma_f32 v41, v41, s18, v95
    v_fma_f32 v42, v42, s18, v95
    v_fma_f32 v43, v43, s18, v95
    v_fma_f32 v44, v44, s18, v95
    v_fma_f32 v45, v45, s18, v95
    buffer_load_dwordx4 a[48:51], v5, s[8:11], s34 offen offset:2048 sc1
    v_fma_f32 v46, v46, s18, v95
    v_fma_f32 v47, v47, s18, v95
    v_exp_f32 v40, v40
    v_exp_f32 v41, v41
    v_exp_f32 v42, v42
    v_exp_f32 v43, v43
    v_exp_f32 v44, v44
    v_exp_f32 v45, v45
    v_exp_f32 v46, v46
    buffer_load_dwordx4 a[52:55], v253, s[8:11], s32 offen offset:3072 sc1
    s_add_u32 s32, s32, 4096
    v_exp_f32 v47, v47
    v_mfma_f32_16x16x32_bf16 v[108:111], v[176:179], v[84:87], 0
    v_mfma_f32_16x16x32_bf16 v[124:127], v[186:189], v[84:87], 0
    v_cvt_pk_bf16_f32 v88, v40, v41
    v_cvt_pk_bf16_f32 v89, v42, v43
    v_cvt_pk_bf16_f32 v90, v44, v45
    v_cvt_pk_bf16_f32 v91, v46, v47
    v_rcp_f32 v96, v118
    v_rcp_f32 v97, v122
    buffer_load_dwordx4 v[240:243], v9, s[8:11], s37 offen offset:0 sc1
    v_mfma_f32_16x16x32_bf16 v[112:115], v[178:181], v[88:91], 0
    v_mfma_f32_16x16x32_bf16 v[128:131], v[188:191], v[88:91], 0
    v_pk_mul_f32 v[100:101], v[96:97], v[100:101] op_sel:[0,0] op_sel_hi:[0,1]
    v_pk_mul_f32 v[102:103], v[96:97], v[102:103] op_sel:[0,0] op_sel_hi:[0,1]
    v_pk_mul_f32 v[116:117], v[96:97], v[116:117] op_sel:[0,0] op_sel_hi:[0,1]
    v_cvt_pk_bf16_f32 v212, v100, v101
    v_cvt_pk_bf16_f32 v213, v102, v103
    v_cvt_pk_bf16_f32 v220, v116, v117
    v_rcp_f32 v98, v126
    buffer_load_dwordx4 v[244:247], v9, s[8:11], s37 offen offset:1024 sc1
    v_pk_mul_f32 v[104:105], v[96:97], v[104:105] op_sel:[1,0] op_sel_hi:[1,1]
    v_pk_mul_f32 v[106:107], v[96:97], v[106:107] op_sel:[1,0] op_sel_hi:[1,1]
    v_pk_mul_f32 v[120:121], v[96:97], v[120:121] op_sel:[1,0] op_sel_hi:[1,1]
    v_cvt_pk_bf16_f32 v214, v104, v105
    v_cvt_pk_bf16_f32 v215, v106, v107
    v_cvt_pk_bf16_f32 v221, v120, v121
    v_rcp_f32 v99, v130
    v_permlane16_swap_b32 v212, v214
    v_permlane16_swap_b32 v213, v215
    buffer_load_dwordx4 v[248:251], v7, s[8:11], s37 offen offset:2048 sc1
    v_pk_mul_f32 v[108:109], v[98:99], v[108:109] op_sel:[0,0] op_sel_hi:[0,1]
    v_pk_mul_f32 v[110:111], v[98:99], v[110:111] op_sel:[0,0] op_sel_hi:[0,1]
    v_pk_mul_f32 v[124:125], v[98:99], v[124:125] op_sel:[0,0] op_sel_hi:[0,1]
    v_cvt_pk_bf16_f32 v216, v108, v109
    v_cvt_pk_bf16_f32 v217, v110, v111
    v_cvt_pk_bf16_f32 v222, v124, v125
    v_pk_mul_f32 v[112:113], v[98:99], v[112:113] op_sel:[1,0] op_sel_hi:[1,1]
    v_pk_mul_f32 v[114:115], v[98:99], v[114:115] op_sel:[1,0] op_sel_hi:[1,1]
    v_pk_mul_f32 v[128:129], v[98:99], v[128:129] op_sel:[1,0] op_sel_hi:[1,1]
    buffer_load_dword v252, v8, s[8:11], s47 offen sc1
    v_cvt_pk_bf16_f32 v218, v112, v113
    v_cvt_pk_bf16_f32 v219, v114, v115
    v_cvt_pk_bf16_f32 v223, v128, v129
    s_lshl_b32 s7, s3, 2
    s_add_u32 s7, s7, 94208
    v_permlane16_swap_b32 v220, v221
    v_permlane16_swap_b32 v222, v223
    v_add_u32 v11, s7, v253
    v_lshrrev_b32 v10, 3, v0
    v_permlane32_swap_b32 v220, v222
    v_mul_u32_u24 v10, 9216, v10
    ds_write_b32 v11, v220
    v_permlane16_swap_b32 v216, v218
    v_permlane16_swap_b32 v217, v219
    s_mul_i32 s7, s40, 1152
    s_add_u32 s22, s22, s7
    s_add_u32 s22, s22, 41156608
    s_lshl_b32 s7, s3, 8
    s_add_u32 s23, s22, s7
    s_add_u32 s24, s23, 36864
    buffer_store_dwordx4 v[212:215], v9, s[8:11], s23 offen sc1
    buffer_store_dwordx4 v[216:219], v9, s[8:11], s24 offen sc1
    v_and_b32 v11, 7, v0
    v_lshl_add_u32 v10, v11, 4, v10
    s_cmp_eq_u32 s3, 3
    s_cselect_b32 s7, 0, 1073741824
    v_add_u32 v10, s7, v10
    v_add_u32 v11, 94208, v253
    s_waitcnt lgkmcnt(0)
    s_barrier
    ds_read_b128 v[220:223], v11
    s_waitcnt lgkmcnt(0)
    buffer_store_dwordx4 v[220:223], v10, s[8:11], s22 offen offset:1024 sc1
    v_lshlrev_b32 v15, 7, v0
    s_lshl_b32 s6, s40, 2
    s_add_u32 s6, s6, s44
    v_mov_b32 v1, s76
    s_mov_b64 vcc, 0xff
    s_waitcnt vmcnt(0)
    s_barrier
    s_cmp_lg_u32 s3, 0
    s_cbranch_scc1 L_pub_17
    s_mov_b64 exec, vcc
    buffer_store_dword v1, v15, s[8:11], s6 offen sc1
L_pub_17:
    s_mov_b64 exec, -1
    buffer_load_dwordx4 a[56:59], v253, s[8:11], s33 offen offset:3072 sc1
    s_add_u32 s33, s33, 4096
    buffer_load_dwordx4 a[60:63], v5, s[8:11], s34 offen offset:3072 sc1
    s_add_u32 s34, s34, 4096
    buffer_load_dwordx4 a[64:67], v253, s[8:11], s32 offen offset:0 sc1
    buffer_load_dwordx4 a[68:71], v253, s[8:11], s33 offen offset:0 sc1
    buffer_load_dwordx4 a[72:75], v5, s[8:11], s34 offen offset:0 sc1
    buffer_load_dwordx4 a[76:79], v253, s[8:11], s32 offen offset:1024 sc1
    buffer_load_dwordx4 a[80:83], v253, s[8:11], s33 offen offset:1024 sc1
    buffer_load_dwordx4 a[84:87], v5, s[8:11], s34 offen offset:1024 sc1
    s_cmp_lg_u32 s42, 0
    s_cbranch_scc1 L_swz_18
    s_cmp_eq_u32 s93, 2
    s_cselect_b32 s6, 2, 3
    s_mov_b32 s7, 512
    s_cmov_b32 s7, 2048
    v_lshrrev_b32 v14, 4, v0
    v_lshlrev_b32 v14, s6, v14
    v_bfe_u32 v15, v0, 2, 2
    v_add_u32 v14, v14, v15
    v_mul_u32_u24 v14, 128, v14
    v_and_b32 v15, 3, v0
    v_lshl_add_u32 v14, v15, 3, v14
    v_add_u32 v14, s79, v14
    v_add_u32 v15, s7, v14
    ds_read_b64_tr_b16 v[76:77], v14 offset:4096
    ds_read_b64_tr_b16 v[78:79], v15 offset:4096
    ds_read_b64_tr_b16 v[80:81], v14 offset:4128
    ds_read_b64_tr_b16 v[82:83], v15 offset:4128
    ds_read_b64_tr_b16 v[84:85], v14 offset:4160
    ds_read_b64_tr_b16 v[86:87], v15 offset:4160
    ds_read_b64_tr_b16 v[88:89], v14 offset:4192
    ds_read_b64_tr_b16 v[90:91], v15 offset:4192
    ds_read_b64_tr_b16 v[92:93], v14 offset:8192
    ds_read_b64_tr_b16 v[94:95], v15 offset:8192
    ds_read_b64_tr_b16 v[96:97], v14 offset:8224
    ds_read_b64_tr_b16 v[98:99], v15 offset:8224
    ds_read_b64_tr_b16 v[176:177], v14 offset:8256
    ds_read_b64_tr_b16 v[178:179], v15 offset:8256
    ds_read_b64_tr_b16 v[180:181], v14 offset:8288
    ds_read_b64_tr_b16 v[182:183], v15 offset:8288
    ds_read_b64_tr_b16 v[196:197], v14 offset:12288
    ds_read_b64_tr_b16 v[198:199], v15 offset:12288
    ds_read_b64_tr_b16 v[200:201], v14 offset:12320
    ds_read_b64_tr_b16 v[202:203], v15 offset:12320
    ds_read_b64_tr_b16 v[204:205], v14 offset:12352
    ds_read_b64_tr_b16 v[206:207], v15 offset:12352
    ds_read_b64_tr_b16 v[208:209], v14 offset:12384
    ds_read_b64_tr_b16 v[210:211], v15 offset:12384
    s_waitcnt lgkmcnt(0)
    s_add_u32 s7, s95, 0
    buffer_store_dwordx4 v[76:79], v253, s[8:11], s7 offen sc1
    s_add_u32 s7, s95, 497664
    buffer_store_dwordx4 v[80:83], v253, s[8:11], s7 offen sc1
    s_add_u32 s7, s95, 995328
    buffer_store_dwordx4 v[84:87], v253, s[8:11], s7 offen sc1
    s_add_u32 s7, s95, 1492992
    buffer_store_dwordx4 v[88:91], v253, s[8:11], s7 offen sc1
    s_add_u32 s7, s78, 0
    buffer_store_dwordx4 v[92:95], v253, s[8:11], s7 offen sc1
    s_add_u32 s7, s78, 497664
    buffer_store_dwordx4 v[96:99], v253, s[8:11], s7 offen sc1
    s_add_u32 s7, s78, 995328
    buffer_store_dwordx4 v[176:179], v253, s[8:11], s7 offen sc1
    s_add_u32 s7, s78, 1492992
    buffer_store_dwordx4 v[180:183], v253, s[8:11], s7 offen sc1
    s_add_u32 s7, s70, 0
    buffer_store_dwordx4 v[196:199], v253, s[8:11], s7 offen sc1
    s_add_u32 s7, s70, 497664
    buffer_store_dwordx4 v[200:203], v253, s[8:11], s7 offen sc1
    s_add_u32 s7, s70, 995328
    buffer_store_dwordx4 v[204:207], v253, s[8:11], s7 offen sc1
    s_add_u32 s7, s70, 1492992
    buffer_store_dwordx4 v[208:211], v253, s[8:11], s7 offen sc1
    s_lshr_b32 s7, s2, 3
    s_lshl_b32 s7, s7, 2
    s_add_u32 s7, s7, s3
    s_lshl_b32 s7, s7, 9
    v_lshrrev_b32 v1, 1, v253
    v_add_u32 v1, s7, v1
    buffer_load_dwordx2 v[14:15], v1, s[96:99], 0 offen
L_swz_18:
    s_and_b32 s7, s3, 1
    s_mul_i32 s7, s7, 18432
    s_add_u32 s24, s30, s7
    s_lshr_b32 s7, s3, 1
    s_lshl_b32 s7, s7, 9
    s_add_u32 s24, s24, s7
    s_add_u32 s24, s24, 41156608
    s_mov_b32 s16, 0xffff0000
    v_lshlrev_b32 v124, 16, v240
    v_and_b32 v125, s16, v240
    v_lshlrev_b32 v126, 16, v241
    v_and_b32 v127, s16, v241
    v_lshlrev_b32 v128, 16, v242
    v_and_b32 v129, s16, v242
    v_lshlrev_b32 v130, 16, v243
    v_and_b32 v131, s16, v243
    v_lshlrev_b32 v132, 16, v244
    v_and_b32 v133, s16, v244
    v_lshlrev_b32 v134, 16, v245
    v_and_b32 v135, s16, v245
    v_lshlrev_b32 v136, 16, v246
    v_and_b32 v137, s16, v246
    v_lshlrev_b32 v138, 16, v247
    v_and_b32 v139, s16, v247
    v_lshlrev_b32 v140, 16, v248
    v_and_b32 v141, s16, v248
    v_lshlrev_b32 v142, 16, v249
    v_and_b32 v143, s16, v249
    v_lshlrev_b32 v144, 16, v250
    v_and_b32 v145, s16, v250
    v_lshlrev_b32 v146, 16, v251
    v_and_b32 v147, s16, v251
    s_cmp_eq_u32 s3, 1
    s_cselect_b32 s7, 16, 0
    v_lshlrev_b32 v12, 2, v0
    v_cmp_gt_u32 vcc, s7, v0
    v_add_u32 v10, 40960, v12
    v_add_u32 v11, 41472, v12
    v_cndmask_b32 v10, v11, v10, vcc
    v_and_b32 v11, 0x7c, v12
    v_cmp_gt_u32 vcc, 32, v0
    v_mov_b32 v13, 1073741824
    s_and_b32 s7, s40, 3
    s_lshl_b32 s45, s45, 2
    v_cndmask_b32 v8, v13, v12, vcc
    s_add_u32 s6, s7, s3
    s_cmp_eq_u32 s6, 0
    s_cselect_b32 s6, 0, 1073741824
    v_add_u32 v6, s6, v8
    s_add_u32 s45, s45, s7
    s_lshl_b32 s45, s45, 2
    s_add_u32 s45, s45, s3
    s_lshl_b32 s45, s45, 7
    s_add_u32 s45, s45, s43
    s_add_u32 s45, s45, 48300032
    s_cmp_eq_u32 s3, 0
    s_cselect_b32 s35, 1.0, 0
    s_lshl_b32 s7, s40, 2
    s_add_u32 s7, s7, s3
    s_mul_i32 s23, s7, 497664
    s_add_u32 s23, s23, 3145728
    s_add_u32 s50, s23, 497664
    s_mul_i32 s50, s50, s42
    v_mov_b32 v184, v253
    v_add_u32 v185, 4096, v253
    v_add_u32 v186, 8192, v253
    v_add_u32 v187, 12288, v253
    v_add_u32 v188, 16384, v253
    v_add_u32 v189, 20480, v253
    v_add_u32 v190, 24576, v253
    v_add_u32 v191, 28672, v253
    v_add_u32 v192, 32768, v253
    s_cmp_lg_u32 s3, 3
    s_cbranch_scc1 L_pollout_21
    s_lshl_b32 s7, s40, 7
    s_add_u32 s7, s7, s44
    s_add_u32 s52, s4, s7
    s_addc_u32 s53, s5, 0
    s_mov_b32 s6, 0
L_poll_19:
    s_load_dwordx8 s[56:63], s[52:53], 0 glc
    s_add_u32 s6, s6, 1
    s_waitcnt lgkmcnt(0)
    s_xor_b64 s[56:57], s[56:57], s[76:77]
    s_xor_b64 s[58:59], s[58:59], s[76:77]
    s_xor_b64 s[60:61], s[60:61], s[76:77]
    s_xor_b64 s[62:63], s[62:63], s[76:77]
    s_or_b64 s[56:57], s[56:57], s[58:59]
    s_or_b64 s[60:61], s[60:61], s[62:63]
    s_or_b64 s[56:57], s[56:57], s[60:61]
    s_cbranch_scc0 L_polled_20
    s_cmp_lt_u32 s6, 1048576
    s_cbranch_scc1 L_poll_19
    s_branch L_main_end
L_polled_20:
L_pollout_21:
    s_barrier
    s_lshl_b32 m0, s3, 10
    s_nop 0
    buffer_load_dwordx4 v2, s[8:11], s24 offen sc1 lds
    s_add_u32 m0, m0, 4096
    s_add_u32 s24, s24, 1024
    buffer_load_dwordx4 v2, s[8:11], s24 offen sc1 lds
    s_add_u32 m0, m0, 4096
    s_add_u32 s24, s24, 1024
    buffer_load_dwordx4 v2, s[8:11], s24 offen sc1 lds
    s_add_u32 m0, m0, 4096
    s_add_u32 s24, s24, 1024
    buffer_load_dwordx4 v2, s[8:11], s24 offen sc1 lds
    s_add_u32 m0, m0, 4096
    s_add_u32 s24, s24, 1024
    buffer_load_dwordx4 v2, s[8:11], s24 offen sc1 lds
    s_add_u32 m0, m0, 4096
    s_add_u32 s24, s24, 1024
    buffer_load_dwordx4 v2, s[8:11], s24 offen sc1 lds
    s_add_u32 m0, m0, 4096
    s_add_u32 s24, s24, 1024
    buffer_load_dwordx4 v2, s[8:11], s24 offen sc1 lds
    s_add_u32 m0, m0, 4096
    s_add_u32 s24, s24, 1024
    buffer_load_dwordx4 v2, s[8:11], s24 offen sc1 lds
    s_add_u32 m0, m0, 4096
    s_add_u32 s24, s24, 1024
    buffer_load_dwordx4 v2, s[8:11], s24 offen sc1 lds
    s_waitcnt vmcnt(4)
    s_barrier
    ds_read_b128 v[160:163], v253 offset:0
    ds_read_b128 v[164:167], v253 offset:1024
    s_waitcnt lgkmcnt(0)
    v_mfma_f32_16x16x32_bf16 v[100:103], a[160:163], v[160:163], 0
    ds_read_b128 v[168:171], v253 offset:2048
    v_mfma_f32_16x16x32_bf16 v[104:107], a[160:163], v[164:167], 0
    ds_read_b128 v[172:175], v253 offset:3072
    v_mfma_f32_16x16x32_bf16 v[108:111], a[164:167], v[160:163], 0
    v_mfma_f32_16x16x32_bf16 v[112:115], a[164:167], v[164:167], 0
    buffer_load_dwordx4 v[16:19], v184, s[48:51], s23 offen offset:0 sc1
    v_mfma_f32_16x16x32_bf16 v[116:119], a[168:171], v[160:163], 0
    v_mfma_f32_16x16x32_bf16 v[120:123], a[168:171], v[164:167], 0
    s_waitcnt lgkmcnt(0)
    v_mfma_f32_16x16x32_bf16 v[100:103], a[172:175], v[168:171], v[100:103]
    ds_read_b128 v[160:163], v253 offset:4096
    v_mfma_f32_16x16x32_bf16 v[104:107], a[172:175], v[172:175], v[104:107]
    ds_read_b128 v[164:167], v253 offset:5120
    v_mfma_f32_16x16x32_bf16 v[108:111], a[176:179], v[168:171], v[108:111]
    v_mfma_f32_16x16x32_bf16 v[112:115], a[176:179], v[172:175], v[112:115]
    buffer_load_dwordx4 v[20:23], v184, s[48:51], s23 offen offset:1024 sc1
    v_mfma_f32_16x16x32_bf16 v[116:119], a[180:183], v[168:171], v[116:119]
    v_mfma_f32_16x16x32_bf16 v[120:123], a[180:183], v[172:175], v[120:123]
    s_waitcnt lgkmcnt(0)
    v_mfma_f32_16x16x32_bf16 v[100:103], a[184:187], v[160:163], v[100:103]
    ds_read_b128 v[168:171], v253 offset:6144
    v_mfma_f32_16x16x32_bf16 v[104:107], a[184:187], v[164:167], v[104:107]
    ds_read_b128 v[172:175], v253 offset:7168
    v_mfma_f32_16x16x32_bf16 v[108:111], a[188:191], v[160:163], v[108:111]
    v_mfma_f32_16x16x32_bf16 v[112:115], a[188:191], v[164:167], v[112:115]
    buffer_load_dwordx4 v[24:27], v184, s[48:51], s23 offen offset:2048 sc1
    v_mfma_f32_16x16x32_bf16 v[116:119], a[192:195], v[160:163], v[116:119]
    v_mfma_f32_16x16x32_bf16 v[120:123], a[192:195], v[164:167], v[120:123]
    s_waitcnt lgkmcnt(0)
    v_mfma_f32_16x16x32_bf16 v[100:103], a[196:199], v[168:171], v[100:103]
    ds_read_b128 v[160:163], v253 offset:8192
    v_mfma_f32_16x16x32_bf16 v[104:107], a[196:199], v[172:175], v[104:107]
    ds_read_b128 v[164:167], v253 offset:9216
    v_mfma_f32_16x16x32_bf16 v[108:111], a[200:203], v[168:171], v[108:111]
    v_mfma_f32_16x16x32_bf16 v[112:115], a[200:203], v[172:175], v[112:115]
    buffer_load_dwordx4 v[28:31], v184, s[48:51], s23 offen offset:3072 sc1
    v_mfma_f32_16x16x32_bf16 v[116:119], a[204:207], v[168:171], v[116:119]
    v_mfma_f32_16x16x32_bf16 v[120:123], a[204:207], v[172:175], v[120:123]
    s_waitcnt lgkmcnt(0)
    v_mfma_f32_16x16x32_bf16 v[100:103], a[208:211], v[160:163], v[100:103]
    ds_read_b128 v[168:171], v253 offset:10240
    v_mfma_f32_16x16x32_bf16 v[104:107], a[208:211], v[164:167], v[104:107]
    ds_read_b128 v[172:175], v253 offset:11264
    v_mfma_f32_16x16x32_bf16 v[108:111], a[212:215], v[160:163], v[108:111]
    v_mfma_f32_16x16x32_bf16 v[112:115], a[212:215], v[164:167], v[112:115]
    buffer_load_dwordx4 v[32:35], v185, s[48:51], s23 offen offset:0 sc1
    v_mfma_f32_16x16x32_bf16 v[116:119], a[216:219], v[160:163], v[116:119]
    v_mfma_f32_16x16x32_bf16 v[120:123], a[216:219], v[164:167], v[120:123]
    s_waitcnt lgkmcnt(0)
    v_mfma_f32_16x16x32_bf16 v[100:103], a[220:223], v[168:171], v[100:103]
    ds_read_b128 v[160:163], v253 offset:12288
    v_mfma_f32_16x16x32_bf16 v[104:107], a[220:223], v[172:175], v[104:107]
    ds_read_b128 v[164:167], v253 offset:13312
    v_mfma_f32_16x16x32_bf16 v[108:111], a[224:227], v[168:171], v[108:111]
    v_mfma_f32_16x16x32_bf16 v[112:115], a[224:227], v[172:175], v[112:115]
    buffer_load_dwordx4 v[36:39], v185, s[48:51], s23 offen offset:1024 sc1
    v_mfma_f32_16x16x32_bf16 v[116:119], a[228:231], v[168:171], v[116:119]
    v_mfma_f32_16x16x32_bf16 v[120:123], a[228:231], v[172:175], v[120:123]
    s_waitcnt lgkmcnt(0)
    v_mfma_f32_16x16x32_bf16 v[100:103], a[232:235], v[160:163], v[100:103]
    ds_read_b128 v[168:171], v253 offset:14336
    v_mfma_f32_16x16x32_bf16 v[104:107], a[232:235], v[164:167], v[104:107]
    ds_read_b128 v[172:175], v253 offset:15360
    v_mfma_f32_16x16x32_bf16 v[108:111], a[236:239], v[160:163], v[108:111]
    v_mfma_f32_16x16x32_bf16 v[112:115], a[236:239], v[164:167], v[112:115]
    buffer_load_dwordx4 v[40:43], v185, s[48:51], s23 offen offset:2048 sc1
    v_mfma_f32_16x16x32_bf16 v[116:119], a[240:243], v[160:163], v[116:119]
    v_mfma_f32_16x16x32_bf16 v[120:123], a[240:243], v[164:167], v[120:123]
    s_waitcnt lgkmcnt(0)
    v_mfma_f32_16x16x32_bf16 v[100:103], a[244:247], v[168:171], v[100:103]
    ds_read_b128 v[160:163], v253 offset:16384
    v_mfma_f32_16x16x32_bf16 v[104:107], a[244:247], v[172:175], v[104:107]
    ds_read_b128 v[164:167], v253 offset:17408
    v_mfma_f32_16x16x32_bf16 v[108:111], a[248:251], v[168:171], v[108:111]
    v_mfma_f32_16x16x32_bf16 v[112:115], a[248:251], v[172:175], v[112:115]
    buffer_load_dwordx4 v[44:47], v185, s[48:51], s23 offen offset:3072 sc1
    v_mfma_f32_16x16x32_bf16 v[116:119], a[252:255], v[168:171], v[116:119]
    v_mfma_f32_16x16x32_bf16 v[120:123], a[252:255], v[172:175], v[120:123]
    s_waitcnt lgkmcnt(0)
    v_mfma_f32_16x16x32_bf16 v[100:103], a[128:131], v[160:163], v[100:103]
    ds_read_b128 v[168:171], v253 offset:18432
    v_mfma_f32_16x16x32_bf16 v[104:107], a[128:131], v[164:167], v[104:107]
    ds_read_b128 v[172:175], v253 offset:19456
    v_mfma_f32_16x16x32_bf16 v[108:111], a[132:135], v[160:163], v[108:111]
    v_mfma_f32_16x16x32_bf16 v[112:115], a[132:135], v[164:167], v[112:115]
    buffer_load_dwordx4 v[48:51], v186, s[48:51], s23 offen offset:0 sc1
    v_mfma_f32_16x16x32_bf16 v[116:119], a[136:139], v[160:163], v[116:119]
    v_mfma_f32_16x16x32_bf16 v[120:123], a[136:139], v[164:167], v[120:123]
    s_waitcnt vmcnt(9) lgkmcnt(0)
    s_barrier
    s_xor_b32 s7, s3, 0
    s_or_b32 s7, s7, s42
    s_cbranch_scc1 L_swz_22
    s_lshl_b32 s6, s40, 7
    s_lshl_b32 s7, s41, 2
    s_add_u32 s6, s6, s7
    s_add_u32 s6, s6, 19464192
    s_mov_b64 exec, 0xffffffff
    v_lshlrev_b32 v15, 10, v0
    v_mov_b32 v1, s76
    buffer_store_dword v1, v15, s[8:11], s6 offen sc1
    s_mov_b64 exec, -1
L_swz_22:
    v_mfma_f32_16x16x32_bf16 v[100:103], a[140:143], v[168:171], v[100:103]
    ds_read_b128 v[160:163], v253 offset:20480
    v_mfma_f32_16x16x32_bf16 v[104:107], a[140:143], v[172:175], v[104:107]
    ds_read_b128 v[164:167], v253 offset:21504
    v_mfma_f32_16x16x32_bf16 v[108:111], a[144:147], v[168:171], v[108:111]
    v_mfma_f32_16x16x32_bf16 v[112:115], a[144:147], v[172:175], v[112:115]
    buffer_load_dwordx4 v[52:55], v186, s[48:51], s23 offen offset:1024 sc1
    v_mfma_f32_16x16x32_bf16 v[116:119], a[148:151], v[168:171], v[116:119]
    v_mfma_f32_16x16x32_bf16 v[120:123], a[148:151], v[172:175], v[120:123]
    s_waitcnt lgkmcnt(0)
    v_mfma_f32_16x16x32_bf16 v[100:103], a[152:155], v[160:163], v[100:103]
    ds_read_b128 v[168:171], v253 offset:22528
    v_mfma_f32_16x16x32_bf16 v[104:107], a[152:155], v[164:167], v[104:107]
    ds_read_b128 v[172:175], v253 offset:23552
    v_mfma_f32_16x16x32_bf16 v[108:111], a[156:159], v[160:163], v[108:111]
    v_mfma_f32_16x16x32_bf16 v[112:115], a[156:159], v[164:167], v[112:115]
    buffer_load_dwordx4 v[56:59], v186, s[48:51], s23 offen offset:2048 sc1
    v_mfma_f32_16x16x32_bf16 v[116:119], a[0:3], v[160:163], v[116:119]
    v_mfma_f32_16x16x32_bf16 v[120:123], a[0:3], v[164:167], v[120:123]
    s_waitcnt lgkmcnt(0)
    v_mfma_f32_16x16x32_bf16 v[100:103], a[4:7], v[168:171], v[100:103]
    ds_read_b128 v[160:163], v253 offset:24576
    v_mfma_f32_16x16x32_bf16 v[104:107], a[4:7], v[172:175], v[104:107]
    ds_read_b128 v[164:167], v253 offset:25600
    v_mfma_f32_16x16x32_bf16 v[108:111], a[8:11], v[168:171], v[108:111]
    v_mfma_f32_16x16x32_bf16 v[112:115], a[8:11], v[172:175], v[112:115]
    buffer_load_dwordx4 v[60:63], v186, s[48:51], s23 offen offset:3072 sc1
    v_mfma_f32_16x16x32_bf16 v[116:119], a[12:15], v[168:171], v[116:119]
    v_mfma_f32_16x16x32_bf16 v[120:123], a[12:15], v[172:175], v[120:123]
    s_waitcnt lgkmcnt(0)
    v_mfma_f32_16x16x32_bf16 v[100:103], a[16:19], v[160:163], v[100:103]
    ds_read_b128 v[168:171], v253 offset:26624
    v_mfma_f32_16x16x32_bf16 v[104:107], a[16:19], v[164:167], v[104:107]
    ds_read_b128 v[172:175], v253 offset:27648
    v_mfma_f32_16x16x32_bf16 v[108:111], a[20:23], v[160:163], v[108:111]
    v_mfma_f32_16x16x32_bf16 v[112:115], a[20:23], v[164:167], v[112:115]
    buffer_load_dwordx4 v[64:67], v187, s[48:51], s23 offen offset:0 sc1
    v_mfma_f32_16x16x32_bf16 v[116:119], a[24:27], v[160:163], v[116:119]
    v_mfma_f32_16x16x32_bf16 v[120:123], a[24:27], v[164:167], v[120:123]
    s_waitcnt lgkmcnt(0)
    v_mfma_f32_16x16x32_bf16 v[100:103], a[28:31], v[168:171], v[100:103]
    ds_read_b128 v[160:163], v253 offset:28672
    v_mfma_f32_16x16x32_bf16 v[104:107], a[28:31], v[172:175], v[104:107]
    ds_read_b128 v[164:167], v253 offset:29696
    v_mfma_f32_16x16x32_bf16 v[108:111], a[32:35], v[168:171], v[108:111]
    v_mfma_f32_16x16x32_bf16 v[112:115], a[32:35], v[172:175], v[112:115]
    buffer_load_dwordx4 v[68:71], v187, s[48:51], s23 offen offset:1024 sc1
    v_mfma_f32_16x16x32_bf16 v[116:119], a[36:39], v[168:171], v[116:119]
    v_mfma_f32_16x16x32_bf16 v[120:123], a[36:39], v[172:175], v[120:123]
    s_waitcnt lgkmcnt(0)
    v_mfma_f32_16x16x32_bf16 v[100:103], a[40:43], v[160:163], v[100:103]
    ds_read_b128 v[168:171], v253 offset:30720
    v_mfma_f32_16x16x32_bf16 v[104:107], a[40:43], v[164:167], v[104:107]
    ds_read_b128 v[172:175], v253 offset:31744
    v_mfma_f32_16x16x32_bf16 v[108:111], a[44:47], v[160:163], v[108:111]
    v_mfma_f32_16x16x32_bf16 v[112:115], a[44:47], v[164:167], v[112:115]
    buffer_load_dwordx4 v[72:75], v187, s[48:51], s23 offen offset:2048 sc1
    v_mfma_f32_16x16x32_bf16 v[116:119], a[48:51], v[160:163], v[116:119]
    v_mfma_f32_16x16x32_bf16 v[120:123], a[48:51], v[164:167], v[120:123]
    s_waitcnt lgkmcnt(0)
    v_mfma_f32_16x16x32_bf16 v[100:103], a[52:55], v[168:171], v[100:103]
    ds_read_b128 v[160:163], v253 offset:32768
    v_mfma_f32_16x16x32_bf16 v[104:107], a[52:55], v[172:175], v[104:107]
    ds_read_b128 v[164:167], v253 offset:33792
    v_mfma_f32_16x16x32_bf16 v[108:111], a[56:59], v[168:171], v[108:111]
    v_mfma_f32_16x16x32_bf16 v[112:115], a[56:59], v[172:175], v[112:115]
    v_mfma_f32_16x16x32_bf16 v[116:119], a[60:63], v[168:171], v[116:119]
    v_mfma_f32_16x16x32_bf16 v[120:123], a[60:63], v[172:175], v[120:123]
    s_waitcnt lgkmcnt(0)
    v_mfma_f32_16x16x32_bf16 v[100:103], a[64:67], v[160:163], v[100:103]
    ds_read_b128 v[168:171], v253 offset:34816
    v_mfma_f32_16x16x32_bf16 v[104:107], a[64:67], v[164:167], v[104:107]
    ds_read_b128 v[172:175], v253 offset:35840
    v_mfma_f32_16x16x32_bf16 v[108:111], a[68:71], v[160:163], v[108:111]
    v_mfma_f32_16x16x32_bf16 v[112:115], a[68:71], v[164:167], v[112:115]
    v_mfma_f32_16x16x32_bf16 v[116:119], a[72:75], v[160:163], v[116:119]
    v_mfma_f32_16x16x32_bf16 v[120:123], a[72:75], v[164:167], v[120:123]
    s_waitcnt lgkmcnt(0)
    v_mfma_f32_16x16x32_bf16 v[100:103], a[76:79], v[168:171], v[100:103]
    v_mfma_f32_16x16x32_bf16 v[104:107], a[76:79], v[172:175], v[104:107]
    v_mfma_f32_16x16x32_bf16 v[108:111], a[80:83], v[168:171], v[108:111]
    v_mfma_f32_16x16x32_bf16 v[112:115], a[80:83], v[172:175], v[112:115]
    v_mfma_f32_16x16x32_bf16 v[116:119], a[84:87], v[168:171], v[116:119]
    v_mfma_f32_16x16x32_bf16 v[120:123], a[84:87], v[172:175], v[120:123]
    s_nop 3
    v_permlane16_swap_b32 v100, v104
    v_permlane16_swap_b32 v101, v105
    v_permlane16_swap_b32 v102, v106
    v_permlane16_swap_b32 v103, v107
    v_add_f32 v12, v116, v117
    v_add_f32 v13, v120, v121
    ds_write_b32 v10, v12
    ds_write_b32 v10, v13 offset:64
    v_permlane16_swap_b32 v108, v112
    v_permlane16_swap_b32 v109, v113
    v_permlane16_swap_b32 v110, v114
    v_permlane16_swap_b32 v111, v115
    v_permlane16_swap_b32 v116, v120
    v_permlane16_swap_b32 v117, v121
    v_permlane16_swap_b32 v118, v122
    v_permlane16_swap_b32 v119, v123
    s_waitcnt lgkmcnt(0)
    s_barrier
    ds_read_b32 v12, v11 offset:40960
    v_pk_add_f32 v[124:125], v[124:125], v[100:101]
    v_pk_add_f32 v[126:127], v[126:127], v[102:103]
    v_pk_add_f32 v[128:129], v[128:129], v[104:105]
    v_pk_add_f32 v[130:131], v[130:131], v[106:107]
    v_pk_add_f32 v[132:133], v[132:133], v[108:109]
    v_pk_add_f32 v[134:135], v[134:135], v[110:111]
    v_pk_add_f32 v[136:137], v[136:137], v[112:113]
    v_pk_add_f32 v[138:139], v[138:139], v[114:115]
    v_pk_add_f32 v[140:141], v[140:141], v[116:117]
    v_pk_add_f32 v[142:143], v[142:143], v[118:119]
    v_pk_add_f32 v[144:145], v[144:145], v[120:121]
    v_pk_add_f32 v[146:147], v[146:147], v[122:123]
    v_mov_b32 v14, 0
    v_mov_b32 v15, 0
    s_waitcnt lgkmcnt(0)
    v_add_f32 v12, v12, v252
    v_pk_add_f32 v[100:101], v[124:125], v[12:13] op_sel_hi:[1,0] neg_lo:[0,1] neg_hi:[0,1]
    v_pk_add_f32 v[102:103], v[126:127], v[12:13] op_sel_hi:[1,0] neg_lo:[0,1] neg_hi:[0,1]
    v_pk_add_f32 v[104:105], v[128:129], v[12:13] op_sel_hi:[1,0] neg_lo:[0,1] neg_hi:[0,1]
    v_pk_add_f32 v[106:107], v[130:131], v[12:13] op_sel_hi:[1,0] neg_lo:[0,1] neg_hi:[0,1]
    v_cvt_pk_bf16_f32 v148, v100, v101
    v_cvt_pk_bf16_f32 v149, v102, v103
    v_cvt_pk_bf16_f32 v150, v104, v105
    v_cvt_pk_bf16_f32 v151, v106, v107
    buffer_store_dwordx4 v[148:151], v9, s[8:11], s46 offen offset:0 sc1
    v_pk_add_f32 v[108:109], v[132:133], v[12:13] op_sel_hi:[1,0] neg_lo:[0,1] neg_hi:[0,1]
    v_pk_add_f32 v[110:111], v[134:135], v[12:13] op_sel_hi:[1,0] neg_lo:[0,1] neg_hi:[0,1]
    v_pk_add_f32 v[112:113], v[136:137], v[12:13] op_sel_hi:[1,0] neg_lo:[0,1] neg_hi:[0,1]
    v_pk_add_f32 v[114:115], v[138:139], v[12:13] op_sel_hi:[1,0] neg_lo:[0,1] neg_hi:[0,1]
    v_cvt_pk_bf16_f32 v152, v108, v109
    v_cvt_pk_bf16_f32 v153, v110, v111
    v_cvt_pk_bf16_f32 v154, v112, v113
    v_cvt_pk_bf16_f32 v155, v114, v115
    buffer_store_dwordx4 v[152:155], v9, s[8:11], s46 offen offset:1024 sc1
    v_pk_add_f32 v[116:117], v[140:141], v[12:13] op_sel_hi:[1,0] neg_lo:[0,1] neg_hi:[0,1]
    v_pk_add_f32 v[118:119], v[142:143], v[12:13] op_sel_hi:[1,0] neg_lo:[0,1] neg_hi:[0,1]
    v_pk_add_f32 v[120:121], v[144:145], v[12:13] op_sel_hi:[1,0] neg_lo:[0,1] neg_hi:[0,1]
    v_pk_add_f32 v[122:123], v[146:147], v[12:13] op_sel_hi:[1,0] neg_lo:[0,1] neg_hi:[0,1]
    v_cvt_pk_bf16_f32 v156, v116, v117
    v_cvt_pk_bf16_f32 v157, v118, v119
    v_cvt_pk_bf16_f32 v158, v120, v121
    v_cvt_pk_bf16_f32 v159, v122, v123
    buffer_store_dwordx4 v[156:159], v7, s[8:11], s46 offen offset:2048 sc1
    v_dot2c_f32_bf16 v14, v148, v148
    v_dot2c_f32_bf16 v14, v149, v149
    v_dot2c_f32_bf16 v14, v150, v150
    v_dot2c_f32_bf16 v14, v151, v151
    v_dot2c_f32_bf16 v14, v152, v152
    v_dot2c_f32_bf16 v14, v153, v153
    v_dot2c_f32_bf16 v14, v154, v154
    v_dot2c_f32_bf16 v14, v155, v155
    v_dot2c_f32_bf16 v15, v156, v156
    v_dot2c_f32_bf16 v15, v157, v157
    v_dot2c_f32_bf16 v15, v158, v158
    v_dot2c_f32_bf16 v15, v159, v159
    buffer_store_dword v12, v6, s[8:11], s36 offen sc1
    s_nop 1
    v_fma_f32 v14, v15, s35, v14
    v_mov_b32 v15, v14
    s_nop 1
    v_permlane32_swap_b32 v14, v15
    v_add_f32 v14, v14, v15
    buffer_store_dword v14, v8, s[8:11], s45 offen sc1
    v_lshlrev_b32 v15, 7, v0
    s_lshl_b32 s6, s40, 2
    s_add_u32 s6, s6, s44
    s_add_u32 s6, s6, 32768
    v_mov_b32 v1, s76
    s_mov_b64 vcc, 0xff
    s_waitcnt vmcnt(0)
    s_barrier
    s_cmp_lg_u32 s3, 0
    s_cbranch_scc1 L_pub_23
    s_mov_b64 exec, vcc
    buffer_store_dword v1, v15, s[8:11], s6 offen sc1
L_pub_23:
    s_mov_b64 exec, -1
    s_lshl_b32 s7, s41, 2
    s_add_u32 s7, s7, s3
    s_mul_i32 s22, s7, 18432
    s_add_u32 s22, s22, s43
    s_add_u32 s22, s22, 45875200
    s_mul_i32 s24, s3, 18432
    s_lshl_b32 s25, s41, 12
    s_add_u32 s25, s25, s43
    s_add_u32 s25, s25, 48300032
    v_lshrrev_b32 v3, 5, v0
    v_and_b32 v10, 31, v0
    v_lshlrev_b32 v10, 2, v10
    v_lshl_add_u32 v3, v3, 11, v10
    v_add_u32 v11, 36864, v184
    s_mov_b32 s16, 0xffff0000
    s_lshl_b32 s7, s3, 10
    v_add_u32 v172, s7, v253
    v_add_u32 v174, 5120, v172
    v_and_b32 v178, 7, v0
    v_mul_u32_u24 v178, 1152, v178
    v_lshrrev_b32 v179, 3, v0
    v_lshl_add_u32 v178, v179, 4, v178
    s_lshl_b32 s7, s3, 7
    v_add_u32 v175, s7, v178
    v_add_u32 v177, 640, v175
    s_cmp_eq_u32 s3, 0
    s_mov_b32 s17, 1073741824
    s_cmov_b32 s17, 4096
    v_add_u32 v173, s17, v172
    s_mov_b32 s17, 1073741824
    s_cmov_b32 s17, 512
    v_add_u32 v176, s17, v175
    s_lshl_b32 s21, s41, 3
    s_add_u32 s21, s21, s40
    s_mul_i32 s18, s21, 9216
    s_mul_i32 s20, s21, 73728
    s_add_u32 s20, s20, 19922944
    v_bfe_u32 v1, v0, 3, 2
    s_mov_b32 s7, 73728
    v_mul_lo_u32 v178, v1, s7
    v_lshrrev_b32 v1, 5, v0
    v_lshl_add_u32 v178, v1, 7, v178
    v_and_b32 v1, 7, v0
    v_lshl_add_u32 v178, v1, 4, v178
    v_add_u32 v179, 294912, v178
    v_lshrrev_b32 v1, 5, v0
    v_and_b32 v15, 7, v0
    v_lshlrev_b32 v15, 4, v15
    v_lshl_add_u32 v15, v1, 7, v15
    s_lshl_b32 s7, s3, 8
    s_add_u32 s7, s7, 3072
    v_add_u32 v15, s7, v15
    v_bfe_u32 v1, v0, 3, 2
    v_mov_b32 v182, 1073741824
    v_add_u32 v183, 14336, v253
    s_sub_u32 s7, s40, 0
    v_cmp_eq_u32 vcc, s7, v1
    s_nop 1
    v_cndmask_b32 v178, v178, v182, vcc
    v_cndmask_b32 v216, v183, v15, vcc
    v_cndmask_b32 v218, 0, 1, vcc
    v_lshlrev_b32 v218, 10, v218
    s_sub_u32 s7, s40, 4
    v_cmp_eq_u32 vcc, s7, v1
    s_nop 1
    v_cndmask_b32 v179, v179, v182, vcc
    v_cndmask_b32 v217, v183, v15, vcc
    v_cndmask_b32 v219, 0, 1, vcc
    v_lshlrev_b32 v219, 10, v219
    s_mul_i32 s26, s41, 589824
    s_mul_i32 s7, s40, 9216
    s_add_u32 s26, s26, s7
    s_lshl_b32 s7, s3, 8
    s_add_u32 s27, s26, s7
    s_add_u32 s27, s27, 19921920
    s_mov_b32 s72, s8
    s_mov_b32 s73, s9
    s_mov_b32 s74, 0
    s_mul_i32 s7, s42, 98304
    s_sub_u32 s29, s44, s7
    s_add_u32 s29, s29, 360448
    s_lshl_b32 s7, s40, 7
    s_add_u32 s7, s7, s29
    s_add_u32 s38, s4, s7
    s_addc_u32 s39, s5, 0
    s_lshl_b32 s7, s40, 2
    s_add_u32 s29, s29, s7
    s_add_u32 s50, s23, 497664
    s_cmp_lg_u32 s42, 0
    s_cbranch_scc1 L_ring_24
    s_cmp_lg_u32 s3, 0
    s_cbranch_scc1 L_ring_25
    s_lshl_b32 s7, s41, 3
    s_add_u32 s7, s7, s40
    s_lshl_b32 s7, s7, 7
    s_add_u32 s7, s7, 19464192
    s_add_u32 s68, s4, s7
    s_addc_u32 s69, s5, 0
    s_mov_b32 s6, 0
    s_mov_b32 s7, 0
L_cpoll_26:
    s_load_dwordx16 s[52:67], s[68:69], s7 glc
    s_add_u32 s6, s6, 1
    s_waitcnt lgkmcnt(0)
    s_xor_b64 s[52:53], s[52:53], s[76:77]
    s_xor_b64 s[54:55], s[54:55], s[76:77]
    s_xor_b64 s[56:57], s[56:57], s[76:77]
    s_xor_b64 s[58:59], s[58:59], s[76:77]
    s_xor_b64 s[60:61], s[60:61], s[76:77]
    s_xor_b64 s[62:63], s[62:63], s[76:77]
    s_xor_b64 s[64:65], s[64:65], s[76:77]
    s_xor_b64 s[66:67], s[66:67], s[76:77]
    s_or_b64 s[52:53], s[52:53], s[60:61]
    s_or_b64 s[54:55], s[54:55], s[62:63]
    s_or_b64 s[56:57], s[56:57], s[64:65]
    s_or_b64 s[58:59], s[58:59], s[66:67]
    s_or_b64 s[52:53], s[52:53], s[56:57]
    s_or_b64 s[54:55], s[54:55], s[58:59]
    s_or_b64 s[52:53], s[52:53], s[54:55]
    s_cbranch_scc1 L_cpoll_27
    s_add_u32 s7, s7, 64
    s_cmp_eq_u32 s7, 128
    s_cbranch_scc1 L_cpolled_28
L_cpoll_27:
    s_cmp_lt_u32 s6, 1048576
    s_cbranch_scc1 L_cpoll_26
    s_branch L_main_end
L_cpolled_28:
L_ring_25:
    s_barrier
    buffer_load_dwordx4 v[16:19], v184, s[48:51], s23 offen offset:0 sc1
    buffer_load_dwordx4 v[20:23], v184, s[48:51], s23 offen offset:1024 sc1
    buffer_load_dwordx4 v[24:27], v184, s[48:51], s23 offen offset:2048 sc1
    buffer_load_dwordx4 v[28:31], v184, s[48:51], s23 offen offset:3072 sc1
    buffer_load_dwordx4 v[32:35], v185, s[48:51], s23 offen offset:0 sc1
    buffer_load_dwordx4 v[36:39], v185, s[48:51], s23 offen offset:1024 sc1
    buffer_load_dwordx4 v[40:43], v185, s[48:51], s23 offen offset:2048 sc1
    buffer_load_dwordx4 v[44:47], v185, s[48:51], s23 offen offset:3072 sc1
    buffer_load_dwordx4 v[48:51], v186, s[48:51], s23 offen offset:0 sc1
    buffer_load_dwordx4 v[52:55], v186, s[48:51], s23 offen offset:1024 sc1
    buffer_load_dwordx4 v[56:59], v186, s[48:51], s23 offen offset:2048 sc1
    buffer_load_dwordx4 v[60:63], v186, s[48:51], s23 offen offset:3072 sc1
    buffer_load_dwordx4 v[64:67], v187, s[48:51], s23 offen offset:0 sc1
    buffer_load_dwordx4 v[68:71], v187, s[48:51], s23 offen offset:1024 sc1
    buffer_load_dwordx4 v[72:75], v187, s[48:51], s23 offen offset:2048 sc1
L_ring_24:
    s_cmp_lg_u32 s3, 3
    s_cbranch_scc1 L_pollout_31
    s_lshl_b32 s7, s40, 7
    s_add_u32 s7, s7, s44
    s_add_u32 s7, s7, 32768
    s_add_u32 s52, s4, s7
    s_addc_u32 s53, s5, 0
    s_mov_b32 s6, 0
L_poll_29:
    s_load_dwordx8 s[56:63], s[52:53], 0 glc
    s_add_u32 s6, s6, 1
    s_waitcnt lgkmcnt(0)
    s_xor_b64 s[56:57], s[56:57], s[76:77]
    s_xor_b64 s[58:59], s[58:59], s[76:77]
    s_xor_b64 s[60:61], s[60:61], s[76:77]
    s_xor_b64 s[62:63], s[62:63], s[76:77]
    s_or_b64 s[56:57], s[56:57], s[58:59]
    s_or_b64 s[60:61], s[60:61], s[62:63]
    s_or_b64 s[56:57], s[56:57], s[60:61]
    s_cbranch_scc0 L_polled_30
    s_cmp_lt_u32 s6, 1048576
    s_cbranch_scc1 L_poll_29
    s_branch L_main_end
L_polled_30:
L_pollout_31:
    s_barrier
    s_add_u32 m0, s24, 0
    s_nop 0
    buffer_load_dwordx4 v2, s[8:11], s22 offen offset:0 sc1 lds
    s_add_u32 m0, s24, 512
    s_nop 0
    buffer_load_dwordx4 v2, s[8:11], s22 offen offset:512 sc1 lds
    s_add_u32 m0, s24, 1024
    s_nop 0
    buffer_load_dwordx4 v2, s[8:11], s22 offen offset:1024 sc1 lds
    s_add_u32 m0, s24, 1536
    s_nop 0
    buffer_load_dwordx4 v2, s[8:11], s22 offen offset:1536 sc1 lds
    s_add_u32 m0, s24, 2048
    s_nop 0
    buffer_load_dwordx4 v2, s[8:11], s22 offen offset:2048 sc1 lds
    s_add_u32 m0, s24, 2560
    s_nop 0
    buffer_load_dwordx4 v2, s[8:11], s22 offen offset:2560 sc1 lds
    s_add_u32 m0, s24, 3072
    s_nop 0
    buffer_load_dwordx4 v2, s[8:11], s22 offen offset:3072 sc1 lds
    s_add_u32 m0, s24, 3584
    s_nop 0
    buffer_load_dwordx4 v2, s[8:11], s22 offen offset:3584 sc1 lds
    s_add_u32 m0, s24, 8192
    s_add_u32 s22, s22, 4096
    buffer_load_dwordx4 v2, s[8:11], s22 offen offset:0 sc1 lds
    s_add_u32 m0, s24, 8704
    s_nop 0
    buffer_load_dwordx4 v2, s[8:11], s22 offen offset:512 sc1 lds
    s_add_u32 m0, s24, 9216
    s_nop 0
    buffer_load_dwordx4 v2, s[8:11], s22 offen offset:1024 sc1 lds
    s_add_u32 m0, s24, 9728
    s_nop 0
    buffer_load_dwordx4 v2, s[8:11], s22 offen offset:1536 sc1 lds
    s_add_u32 s23, s23, 15360
    s_lshr_b32 s7, s3, 1
    s_lshl_b32 s7, s7, 10
    s_and_b32 s6, s3, 1
    s_lshl_b32 s6, s6, 3
    s_add_u32 s28, s7, s6
    s_add_u32 s28, s28, 73728
    s_waitcnt vmcnt(6)
    s_barrier
    ds_read_b128 a[0:3], v184 offset:0
    ds_read_b128 a[72:75], v184 offset:18432
    ds_read_b128 a[144:147], v11 offset:0
    ds_read_b128 a[216:219], v11 offset:18432
    ds_read_b128 a[4:7], v184 offset:1024
    ds_read_b128 a[76:79], v184 offset:19456
    ds_read_b128 a[148:151], v11 offset:1024
    ds_read_b128 a[220:223], v11 offset:19456
    ds_read_b128 a[8:11], v184 offset:2048
    ds_read_b128 a[80:83], v184 offset:20480
    ds_read_b128 a[152:155], v11 offset:2048
    ds_read_b128 a[224:227], v11 offset:20480
    s_waitcnt vmcnt(24) lgkmcnt(0)
    v_mfma_f32_16x16x32_bf16 v[88:91], v[16:19], a[0:3], 0
    ds_read_b128 a[12:15], v184 offset:3072
    v_mfma_f32_16x16x32_bf16 v[88:91], v[20:23], a[4:7], v[88:91]
    buffer_load_dwordx4 v[76:79], v184, s[48:51], s23 offen offset:0 sc1
    v_mfma_f32_16x16x32_bf16 v[88:91], v[24:27], a[8:11], v[88:91]
    ds_read_b128 a[84:87], v184 offset:21504
    v_mfma_f32_16x16x32_bf16 v[92:95], v[16:19], a[72:75], 0
    s_add_u32 m0, s24, 10240
    s_nop 0
    buffer_load_dwordx4 v2, s[8:11], s22 offen offset:2048 sc1 lds
    v_mfma_f32_16x16x32_bf16 v[92:95], v[20:23], a[76:79], v[92:95]
    ds_read_b128 a[156:159], v11 offset:3072
    ds_read_b128 a[228:231], v11 offset:21504
    v_mfma_f32_16x16x32_bf16 v[92:95], v[24:27], a[80:83], v[92:95]
    buffer_load_dwordx4 v[80:83], v184, s[48:51], s23 offen offset:1024 sc1
    v_mfma_f32_16x16x32_bf16 v[96:99], v[16:19], a[144:147], 0
    ds_read_b128 a[16:19], v184 offset:4096
    v_mfma_f32_16x16x32_bf16 v[96:99], v[20:23], a[148:151], v[96:99]
    s_add_u32 m0, s24, 10752
    s_nop 0
    buffer_load_dwordx4 v2, s[8:11], s22 offen offset:2560 sc1 lds
    v_mfma_f32_16x16x32_bf16 v[96:99], v[24:27], a[152:155], v[96:99]
    ds_read_b128 a[88:91], v184 offset:22528
    v_mfma_f32_16x16x32_bf16 v[100:103], v[16:19], a[216:219], 0
    buffer_load_dwordx4 v[84:87], v184, s[48:51], s23 offen offset:2048 sc1
    v_mfma_f32_16x16x32_bf16 v[100:103], v[20:23], a[220:223], v[100:103]
    ds_read_b128 a[160:163], v11 offset:4096
    ds_read_b128 a[232:235], v11 offset:22528
    v_mfma_f32_16x16x32_bf16 v[100:103], v[24:27], a[224:227], v[100:103]
    s_add_u32 m0, s24, 11264
    s_nop 0
    buffer_load_dwordx4 v2, s[8:11], s22 offen offset:3072 sc1 lds
    s_waitcnt vmcnt(27) lgkmcnt(8)
    v_mfma_f32_16x16x32_bf16 v[104:107], v[28:31], a[0:3], 0
    ds_read_b128 a[20:23], v184 offset:5120
    v_mfma_f32_16x16x32_bf16 v[104:107], v[32:35], a[4:7], v[104:107]
    buffer_load_dwordx4 v[16:19], v184, s[48:51], s23 offen offset:3072 sc1
    v_mfma_f32_16x16x32_bf16 v[104:107], v[36:39], a[8:11], v[104:107]
    ds_read_b128 a[92:95], v184 offset:23552
    v_mfma_f32_16x16x32_bf16 v[108:111], v[28:31], a[72:75], 0
    s_add_u32 m0, s24, 11776
    s_nop 0
    buffer_load_dwordx4 v2, s[8:11], s22 offen offset:3584 sc1 lds
    v_mfma_f32_16x16x32_bf16 v[108:111], v[32:35], a[76:79], v[108:111]
    ds_read_b128 a[164:167], v11 offset:5120
    ds_read_b128 a[236:239], v11 offset:23552
    v_mfma_f32_16x16x32_bf16 v[108:111], v[36:39], a[80:83], v[108:111]
    buffer_load_dwordx4 v[20:23], v185, s[48:51], s23 offen offset:0 sc1
    v_mfma_f32_16x16x32_bf16 v[112:115], v[28:31], a[144:147], 0
    v_mfma_f32_16x16x32_bf16 v[112:115], v[32:35], a[148:151], v[112:115]
    s_add_u32 m0, s24, 16384
    s_add_u32 s22, s22, 4096
    buffer_load_dwordx4 v2, s[8:11], s22 offen offset:0 sc1 lds
    v_mfma_f32_16x16x32_bf16 v[112:115], v[36:39], a[152:155], v[112:115]
    v_mfma_f32_16x16x32_bf16 v[116:119], v[28:31], a[216:219], 0
    buffer_load_dwordx4 v[24:27], v185, s[48:51], s23 offen offset:1024 sc1
    v_mfma_f32_16x16x32_bf16 v[116:119], v[32:35], a[220:223], v[116:119]
    v_mfma_f32_16x16x32_bf16 v[116:119], v[36:39], a[224:227], v[116:119]
    s_add_u32 m0, s24, 16896
    s_nop 0
    buffer_load_dwordx4 v2, s[8:11], s22 offen offset:512 sc1 lds
    s_waitcnt vmcnt(12) lgkmcnt(0)
    s_barrier
    v_mfma_f32_16x16x32_bf16 v[88:91], v[40:43], a[12:15], v[88:91]
    ds_read_b128 a[24:27], v184 offset:6144
    v_mfma_f32_16x16x32_bf16 v[88:91], v[44:47], a[16:19], v[88:91]
    buffer_load_dwordx4 v[28:31], v185, s[48:51], s23 offen offset:2048 sc1
    v_mfma_f32_16x16x32_bf16 v[88:91], v[48:51], a[20:23], v[88:91]
    ds_read_b128 a[96:99], v184 offset:24576
    v_mfma_f32_16x16x32_bf16 v[92:95], v[40:43], a[84:87], v[92:95]
    buffer_load_dword v136, v3, s[8:11], s25 offen offset:0 sc1
    v_mfma_f32_16x16x32_bf16 v[92:95], v[44:47], a[88:91], v[92:95]
    ds_read_b128 a[168:171], v11 offset:6144
    ds_read_b128 a[240:243], v11 offset:24576
    v_mfma_f32_16x16x32_bf16 v[92:95], v[48:51], a[92:95], v[92:95]
    buffer_load_dwordx4 v[32:35], v185, s[48:51], s23 offen offset:3072 sc1
    v_mfma_f32_16x16x32_bf16 v[96:99], v[40:43], a[156:159], v[96:99]
    buffer_load_dword v137, v3, s[8:11], s25 offen offset:128 sc1
    v_mfma_f32_16x16x32_bf16 v[96:99], v[44:47], a[160:163], v[96:99]
    buffer_load_dword v138, v3, s[8:11], s25 offen offset:256 sc1
    v_mfma_f32_16x16x32_bf16 v[96:99], v[48:51], a[164:167], v[96:99]
    ds_read_b128 a[28:31], v184 offset:7168
    ds_read_b128 a[100:103], v184 offset:25600
    v_mfma_f32_16x16x32_bf16 v[100:103], v[40:43], a[228:231], v[100:103]
    buffer_load_dwordx4 v[36:39], v186, s[48:51], s23 offen offset:0 sc1
    v_mfma_f32_16x16x32_bf16 v[100:103], v[44:47], a[232:235], v[100:103]
    buffer_load_dword v139, v3, s[8:11], s25 offen offset:384 sc1
    v_mfma_f32_16x16x32_bf16 v[100:103], v[48:51], a[236:239], v[100:103]
    buffer_load_dword v140, v3, s[8:11], s25 offen offset:512 sc1
    s_waitcnt vmcnt(35) lgkmcnt(6)
    v_mfma_f32_16x16x32_bf16 v[104:107], v[52:55], a[12:15], v[104:107]
    ds_read_b128 a[172:175], v11 offset:7168
    ds_read_b128 a[244:247], v11 offset:25600
    v_mfma_f32_16x16x32_bf16 v[104:107], v[56:59], a[16:19], v[104:107]
    buffer_load_dwordx4 v[40:43], v186, s[48:51], s23 offen offset:1024 sc1
    v_mfma_f32_16x16x32_bf16 v[104:107], v[60:63], a[20:23], v[104:107]
    ds_read_b128 a[32:35], v184 offset:8192
    ds_read_b128 a[104:107], v184 offset:26624
    v_mfma_f32_16x16x32_bf16 v[108:111], v[52:55], a[84:87], v[108:111]
    buffer_load_dword v141, v3, s[8:11], s25 offen offset:640 sc1
    v_mfma_f32_16x16x32_bf16 v[108:111], v[56:59], a[88:91], v[108:111]
    ds_read_b128 a[176:179], v11 offset:8192
    ds_read_b128 a[248:251], v11 offset:26624
    v_mfma_f32_16x16x32_bf16 v[108:111], v[60:63], a[92:95], v[108:111]
    buffer_load_dwordx4 v[44:47], v186, s[48:51], s23 offen offset:2048 sc1
    v_mfma_f32_16x16x32_bf16 v[112:115], v[52:55], a[156:159], v[112:115]
    buffer_load_dword v142, v3, s[8:11], s25 offen offset:768 sc1
    v_mfma_f32_16x16x32_bf16 v[112:115], v[56:59], a[160:163], v[112:115]
    buffer_load_dword v143, v3, s[8:11], s25 offen offset:896 sc1
    v_mfma_f32_16x16x32_bf16 v[112:115], v[60:63], a[164:167], v[112:115]
    v_mfma_f32_16x16x32_bf16 v[116:119], v[52:55], a[228:231], v[116:119]
    buffer_load_dwordx4 v[48:51], v186, s[48:51], s23 offen offset:3072 sc1
    v_mfma_f32_16x16x32_bf16 v[116:119], v[56:59], a[232:235], v[116:119]
    buffer_load_dword v144, v3, s[8:11], s25 offen offset:1024 sc1
    v_mfma_f32_16x16x32_bf16 v[116:119], v[60:63], a[236:239], v[116:119]
    buffer_load_dword v145, v3, s[8:11], s25 offen offset:1152 sc1
    s_waitcnt vmcnt(40) lgkmcnt(0)
    v_mfma_f32_16x16x32_bf16 v[88:91], v[64:67], a[24:27], v[88:91]
    ds_read_b128 a[36:39], v184 offset:9216
    v_mfma_f32_16x16x32_bf16 v[88:91], v[68:71], a[28:31], v[88:91]
    buffer_load_dwordx4 v[52:55], v187, s[48:51], s23 offen offset:0 sc1
    v_mfma_f32_16x16x32_bf16 v[88:91], v[72:75], a[32:35], v[88:91]
    ds_read_b128 a[108:111], v184 offset:27648
    v_mfma_f32_16x16x32_bf16 v[92:95], v[64:67], a[96:99], v[92:95]
    buffer_load_dword v146, v3, s[8:11], s25 offen offset:1280 sc1
    v_mfma_f32_16x16x32_bf16 v[92:95], v[68:71], a[100:103], v[92:95]
    ds_read_b128 a[180:183], v11 offset:9216
    ds_read_b128 a[252:255], v11 offset:27648
    v_mfma_f32_16x16x32_bf16 v[92:95], v[72:75], a[104:107], v[92:95]
    buffer_load_dwordx4 v[56:59], v187, s[48:51], s23 offen offset:1024 sc1
    v_mfma_f32_16x16x32_bf16 v[96:99], v[64:67], a[168:171], v[96:99]
    buffer_load_dword v147, v3, s[8:11], s25 offen offset:1408 sc1
    v_mfma_f32_16x16x32_bf16 v[96:99], v[68:71], a[172:175], v[96:99]
    buffer_load_dword v148, v3, s[8:11], s25 offen offset:1536 sc1
    v_mfma_f32_16x16x32_bf16 v[96:99], v[72:75], a[176:179], v[96:99]
    ds_read_b128 a[40:43], v184 offset:10240
    ds_read_b128 a[112:115], v184 offset:28672
    v_mfma_f32_16x16x32_bf16 v[100:103], v[64:67], a[240:243], v[100:103]
    buffer_load_dwordx4 v[60:63], v187, s[48:51], s23 offen offset:2048 sc1
    v_mfma_f32_16x16x32_bf16 v[100:103], v[68:71], a[244:247], v[100:103]
    buffer_load_dword v149, v3, s[8:11], s25 offen offset:1664 sc1
    v_mfma_f32_16x16x32_bf16 v[100:103], v[72:75], a[248:251], v[100:103]
    buffer_load_dword v150, v3, s[8:11], s25 offen offset:1792 sc1
    s_waitcnt vmcnt(31) lgkmcnt(6)
    v_mfma_f32_16x16x32_bf16 v[104:107], v[76:79], a[24:27], v[104:107]
    ds_read_b128 a[184:187], v11 offset:10240
    ds_read_b128 v[220:223], v11 offset:28672
    v_mfma_f32_16x16x32_bf16 v[104:107], v[80:83], a[28:31], v[104:107]
    buffer_load_dwordx4 v[64:67], v187, s[48:51], s23 offen offset:3072 sc1
    v_mfma_f32_16x16x32_bf16 v[104:107], v[84:87], a[32:35], v[104:107]
    ds_read_b128 a[44:47], v184 offset:11264
    ds_read_b128 a[116:119], v184 offset:29696
    v_mfma_f32_16x16x32_bf16 v[108:111], v[76:79], a[96:99], v[108:111]
    buffer_load_dword v151, v3, s[8:11], s25 offen offset:1920 sc1
    v_mfma_f32_16x16x32_bf16 v[108:111], v[80:83], a[100:103], v[108:111]
    ds_read_b128 a[188:191], v11 offset:11264
    ds_read_b128 v[224:227], v11 offset:29696
    v_mfma_f32_16x16x32_bf16 v[108:111], v[84:87], a[104:107], v[108:111]
    buffer_load_dwordx4 v[68:71], v188, s[48:51], s23 offen offset:0 sc1
    v_mfma_f32_16x16x32_bf16 v[112:115], v[76:79], a[168:171], v[112:115]
    v_mfma_f32_16x16x32_bf16 v[112:115], v[80:83], a[172:175], v[112:115]
    v_mfma_f32_16x16x32_bf16 v[112:115], v[84:87], a[176:179], v[112:115]
    v_mfma_f32_16x16x32_bf16 v[116:119], v[76:79], a[240:243], v[116:119]
    buffer_load_dwordx4 v[72:75], v188, s[48:51], s23 offen offset:1024 sc1
    v_mfma_f32_16x16x32_bf16 v[116:119], v[80:83], a[244:247], v[116:119]
    v_mfma_f32_16x16x32_bf16 v[116:119], v[84:87], a[248:251], v[116:119]
    s_waitcnt vmcnt(28) lgkmcnt(0)
    s_barrier
    v_mfma_f32_16x16x32_bf16 v[88:91], v[16:19], a[36:39], v[88:91]
    ds_read_b128 a[48:51], v184 offset:12288
    v_mfma_f32_16x16x32_bf16 v[88:91], v[20:23], a[40:43], v[88:91]
    buffer_load_dwordx4 v[76:79], v188, s[48:51], s23 offen offset:2048 sc1
    v_mfma_f32_16x16x32_bf16 v[88:91], v[24:27], a[44:47], v[88:91]
    ds_read_b128 a[120:123], v184 offset:30720
    v_mfma_f32_16x16x32_bf16 v[92:95], v[16:19], a[108:111], v[92:95]
    ds_read_b128 a[192:195], v11 offset:12288
    v_mfma_f32_16x16x32_bf16 v[92:95], v[20:23], a[112:115], v[92:95]
    ds_read_b128 v[228:231], v11 offset:30720
    v_mfma_f32_16x16x32_bf16 v[92:95], v[24:27], a[116:119], v[92:95]
    buffer_load_dwordx4 v[80:83], v188, s[48:51], s23 offen offset:3072 sc1
    v_mfma_f32_16x16x32_bf16 v[96:99], v[16:19], a[180:183], v[96:99]
    ds_read_b128 a[52:55], v184 offset:13312
    v_mfma_f32_16x16x32_bf16 v[96:99], v[20:23], a[184:187], v[96:99]
    ds_read_b128 a[124:127], v184 offset:31744
    v_mfma_f32_16x16x32_bf16 v[96:99], v[24:27], a[188:191], v[96:99]
    v_mfma_f32_16x16x32_bf16 v[100:103], v[16:19], a[252:255], v[100:103]
    buffer_load_dwordx4 v[84:87], v189, s[48:51], s23 offen offset:0 sc1
    v_mfma_f32_16x16x32_bf16 v[100:103], v[20:23], v[220:223], v[100:103]
    ds_read_b128 a[196:199], v11 offset:13312
    ds_read_b128 v[232:235], v11 offset:31744
    v_mfma_f32_16x16x32_bf16 v[100:103], v[24:27], v[224:227], v[100:103]
    s_waitcnt vmcnt(25) lgkmcnt(8)
    v_mfma_f32_16x16x32_bf16 v[104:107], v[28:31], a[36:39], v[104:107]
    ds_read_b128 a[56:59], v184 offset:14336
    v_mfma_f32_16x16x32_bf16 v[104:107], v[32:35], a[40:43], v[104:107]
    buffer_load_dwordx4 v[16:19], v189, s[48:51], s23 offen offset:1024 sc1
    v_mfma_f32_16x16x32_bf16 v[104:107], v[36:39], a[44:47], v[104:107]
    ds_read_b128 a[128:131], v184 offset:32768
    v_mfma_f32_16x16x32_bf16 v[108:111], v[28:31], a[108:111], v[108:111]
    ds_read_b128 a[200:203], v11 offset:14336
    v_mfma_f32_16x16x32_bf16 v[108:111], v[32:35], a[112:115], v[108:111]
    ds_read_b128 v[236:239], v11 offset:32768
    v_mfma_f32_16x16x32_bf16 v[108:111], v[36:39], a[116:119], v[108:111]
    buffer_load_dwordx4 v[20:23], v189, s[48:51], s23 offen offset:2048 sc1
    v_mfma_f32_16x16x32_bf16 v[112:115], v[28:31], a[180:183], v[112:115]
    v_mfma_f32_16x16x32_bf16 v[112:115], v[32:35], a[184:187], v[112:115]
    v_mfma_f32_16x16x32_bf16 v[112:115], v[36:39], a[188:191], v[112:115]
    v_mfma_f32_16x16x32_bf16 v[116:119], v[28:31], a[252:255], v[116:119]
    buffer_load_dwordx4 v[24:27], v189, s[48:51], s23 offen offset:3072 sc1
    v_mfma_f32_16x16x32_bf16 v[116:119], v[32:35], v[220:223], v[116:119]
    v_mfma_f32_16x16x32_bf16 v[116:119], v[36:39], v[224:227], v[116:119]
    s_waitcnt vmcnt(8) lgkmcnt(0)
    v_mfma_f32_16x16x32_bf16 v[88:91], v[40:43], a[48:51], v[88:91]
    ds_read_b128 a[60:63], v184 offset:15360
    v_add_f32 v136, v136, v144
    v_mfma_f32_16x16x32_bf16 v[88:91], v[44:47], a[52:55], v[88:91]
    buffer_load_dwordx4 v[28:31], v190, s[48:51], s23 offen offset:0 sc1
    v_mfma_f32_16x16x32_bf16 v[88:91], v[48:51], a[56:59], v[88:91]
    ds_read_b128 a[132:135], v184 offset:33792
    v_add_f32 v137, v137, v145
    v_mfma_f32_16x16x32_bf16 v[92:95], v[40:43], a[120:123], v[92:95]
    ds_read_b128 a[204:207], v11 offset:15360
    v_add_f32 v138, v138, v146
    v_mfma_f32_16x16x32_bf16 v[92:95], v[44:47], a[124:127], v[92:95]
    ds_read_b128 v[240:243], v11 offset:33792
    v_add_f32 v139, v139, v147
    v_mfma_f32_16x16x32_bf16 v[92:95], v[48:51], a[128:131], v[92:95]
    buffer_load_dwordx4 v[32:35], v190, s[48:51], s23 offen offset:1024 sc1
    v_mfma_f32_16x16x32_bf16 v[96:99], v[40:43], a[192:195], v[96:99]
    ds_read_b128 a[64:67], v184 offset:16384
    v_add_f32 v140, v140, v148
    v_mfma_f32_16x16x32_bf16 v[96:99], v[44:47], a[196:199], v[96:99]
    ds_read_b128 a[136:139], v184 offset:34816
    v_add_f32 v141, v141, v149
    v_mfma_f32_16x16x32_bf16 v[96:99], v[48:51], a[200:203], v[96:99]
    v_add_f32 v142, v142, v150
    v_add_f32 v143, v143, v151
    v_mfma_f32_16x16x32_bf16 v[100:103], v[40:43], v[228:231], v[100:103]
    buffer_load_dwordx4 v[36:39], v190, s[48:51], s23 offen offset:2048 sc1
    v_mfma_f32_16x16x32_bf16 v[100:103], v[44:47], v[232:235], v[100:103]
    ds_read_b128 a[208:211], v11 offset:16384
    ds_read_b128 v[244:247], v11 offset:34816
    v_mfma_f32_16x16x32_bf16 v[100:103], v[48:51], v[236:239], v[100:103]
    v_add_f32 v136, v136, v140
    v_add_f32 v137, v137, v141
    s_waitcnt vmcnt(15) lgkmcnt(8)
    v_mfma_f32_16x16x32_bf16 v[104:107], v[52:55], a[48:51], v[104:107]
    ds_read_b128 a[68:71], v184 offset:17408
    v_add_f32 v138, v138, v142
    v_mfma_f32_16x16x32_bf16 v[104:107], v[56:59], a[52:55], v[104:107]
    buffer_load_dwordx4 v[40:43], v190, s[48:51], s23 offen offset:3072 sc1
    v_mfma_f32_16x16x32_bf16 v[104:107], v[60:63], a[56:59], v[104:107]
    ds_read_b128 a[140:143], v184 offset:35840
    v_add_f32 v139, v139, v143
    v_mfma_f32_16x16x32_bf16 v[108:111], v[52:55], a[120:123], v[108:111]
    ds_read_b128 a[212:215], v11 offset:17408
    v_add_f32 v136, v136, v138
    v_mfma_f32_16x16x32_bf16 v[108:111], v[56:59], a[124:127], v[108:111]
    ds_read_b128 v[248:251], v11 offset:35840
    v_add_f32 v137, v137, v139
    v_mfma_f32_16x16x32_bf16 v[108:111], v[60:63], a[128:131], v[108:111]
    buffer_load_dwordx4 v[44:47], v191, s[48:51], s23 offen offset:0 sc1
    v_mfma_f32_16x16x32_bf16 v[112:115], v[52:55], a[192:195], v[112:115]
    v_add_f32 v136, v136, v137
    v_mov_b32 v137, 0x3727c5ac
    v_mfma_f32_16x16x32_bf16 v[112:115], v[56:59], a[196:199], v[112:115]
    v_fmac_f32 v137, 0x3ae38e39, v136
    v_mov_b32 v193, v137
    v_mfma_f32_16x16x32_bf16 v[112:115], v[60:63], a[200:203], v[112:115]
    s_nop 0
    v_permlane16_swap_b32 v193, v137
    v_mfma_f32_16x16x32_bf16 v[116:119], v[52:55], v[228:231], v[116:119]
    buffer_load_dwordx4 v[48:51], v191, s[48:51], s23 offen offset:1024 sc1
    v_mfma_f32_16x16x32_bf16 v[116:119], v[56:59], v[232:235], v[116:119]
    v_mov_b32 v195, v193
    v_mov_b32 v194, v137
    v_mfma_f32_16x16x32_bf16 v[116:119], v[60:63], v[236:239], v[116:119]
    v_mov_b32 v252, v137
    s_waitcnt vmcnt(12) lgkmcnt(0)
    v_mfma_f32_16x16x32_bf16 v[88:91], v[64:67], a[60:63], v[88:91]
    s_nop 0
    v_permlane32_swap_b32 v193, v195
    v_mfma_f32_16x16x32_bf16 v[88:91], v[68:71], a[64:67], v[88:91]
    buffer_load_dwordx4 v[52:55], v191, s[48:51], s23 offen offset:2048 sc1
    v_mfma_f32_16x16x32_bf16 v[120:123], v[72:75], a[68:71], v[88:91]
    v_permlane32_swap_b32 v194, v252
    v_mfma_f32_16x16x32_bf16 v[92:95], v[64:67], a[132:135], v[92:95]
    v_rsq_f32 v4, v193
    v_mfma_f32_16x16x32_bf16 v[92:95], v[68:71], a[136:139], v[92:95]
    v_rsq_f32 v5, v194
    v_mfma_f32_16x16x32_bf16 v[124:127], v[72:75], a[140:143], v[92:95]
    buffer_load_dwordx4 v[56:59], v191, s[48:51], s23 offen offset:3072 sc1
    v_mfma_f32_16x16x32_bf16 v[96:99], v[64:67], a[204:207], v[96:99]
    v_rsq_f32 v6, v195
    v_mfma_f32_16x16x32_bf16 v[96:99], v[68:71], a[208:211], v[96:99]
    v_rsq_f32 v7, v252
    v_mfma_f32_16x16x32_bf16 v[128:131], v[72:75], a[212:215], v[96:99]
    v_mul_f32 v8, v4, v4
    v_mul_f32 v9, v5, v5
    v_mfma_f32_16x16x32_bf16 v[100:103], v[64:67], v[240:243], v[100:103]
    buffer_load_dwordx4 v[60:63], v192, s[48:51], s23 offen offset:0 sc1
    v_mfma_f32_16x16x32_bf16 v[100:103], v[68:71], v[244:247], v[100:103]
    v_mul_f32 v13, v6, v6
    v_mul_f32 v14, v7, v7
    v_mfma_f32_16x16x32_bf16 v[132:135], v[72:75], v[248:251], v[100:103]
    v_mul_f32 v4, 0xc0135761, v4
    v_mul_f32 v5, 0xc0135761, v5
    s_waitcnt vmcnt(12) lgkmcnt(0)
    v_mfma_f32_16x16x32_bf16 v[104:107], v[76:79], a[60:63], v[104:107]
    v_mul_f32 v6, 0xc0135761, v6
    v_mul_f32 v7, 0xc0135761, v7
    v_mfma_f32_16x16x32_bf16 v[104:107], v[80:83], a[64:67], v[104:107]
    buffer_load_dwordx4 v[64:67], v192, s[48:51], s23 offen offset:1024 sc1
    v_mfma_f32_16x16x32_bf16 v[136:139], v[84:87], a[68:71], v[104:107]
    v_mul_f32 v8, 0x3d372713, v8
    v_mul_f32 v9, 0x3d372713, v9
    v_mfma_f32_16x16x32_bf16 v[108:111], v[76:79], a[132:135], v[108:111]
    v_mul_f32 v13, 0x3d372713, v13
    v_mul_f32 v14, 0x3d372713, v14
    v_mfma_f32_16x16x32_bf16 v[108:111], v[80:83], a[136:139], v[108:111]
    v_mul_f32 v8, v8, v4
    v_mul_f32 v9, v9, v5
    v_mfma_f32_16x16x32_bf16 v[140:143], v[84:87], a[140:143], v[108:111]
    buffer_load_dwordx4 v[68:71], v192, s[48:51], s23 offen offset:2048 sc1
    v_mfma_f32_16x16x32_bf16 v[112:115], v[76:79], a[204:207], v[112:115]
    v_mul_f32 v13, v13, v6
    v_mul_f32 v14, v14, v7
    v_mfma_f32_16x16x32_bf16 v[112:115], v[80:83], a[208:211], v[112:115]
    s_mov_b32 s25, 0
    v_mfma_f32_16x16x32_bf16 v[144:147], v[84:87], a[212:215], v[112:115]
    s_mov_b32 s7, s28
    v_mfma_f32_16x16x32_bf16 v[116:119], v[76:79], v[240:243], v[116:119]
    buffer_load_dwordx4 v[72:75], v192, s[48:51], s23 offen offset:3072 sc1
    v_mfma_f32_16x16x32_bf16 v[116:119], v[80:83], v[244:247], v[116:119]
    s_add_u32 s23, s23, 36864
    v_mfma_f32_16x16x32_bf16 v[148:151], v[84:87], v[248:251], v[116:119]
    v_add_u32 v12, s7, v184
    s_add_u32 s25, s25, 1
L_ffn_gu_32:
    s_waitcnt vmcnt(12)
    v_mfma_f32_16x16x32_bf16 v[88:91], v[16:19], a[0:3], 0
    v_mfma_f32_16x16x32_bf16 v[88:91], v[20:23], a[4:7], v[88:91]
    buffer_load_dwordx4 v[76:79], v184, s[48:51], s23 offen offset:0 sc1
    v_mfma_f32_16x16x32_bf16 v[88:91], v[24:27], a[8:11], v[88:91]
    v_mul_f32 v152, v120, v120
    v_mul_f32 v153, v121, v121
    v_mfma_f32_16x16x32_bf16 v[92:95], v[16:19], a[72:75], 0
    v_mul_f32 v154, v122, v122
    v_mul_f32 v155, v123, v123
    v_mfma_f32_16x16x32_bf16 v[92:95], v[20:23], a[76:79], v[92:95]
    v_fma_f32 v152, v152, v8, v4
    v_fma_f32 v153, v153, v8, v4
    v_mfma_f32_16x16x32_bf16 v[92:95], v[24:27], a[80:83], v[92:95]
    buffer_load_dwordx4 v[80:83], v184, s[48:51], s23 offen offset:1024 sc1
    v_mfma_f32_16x16x32_bf16 v[96:99], v[16:19], a[144:147], 0
    v_fma_f32 v154, v154, v8, v4
    v_fma_f32 v155, v155, v8, v4
    v_mfma_f32_16x16x32_bf16 v[96:99], v[20:23], a[148:151], v[96:99]
    v_mul_f32 v152, v120, v152
    v_mul_f32 v153, v121, v153
    v_mfma_f32_16x16x32_bf16 v[96:99], v[24:27], a[152:155], v[96:99]
    v_mul_f32 v154, v122, v154
    v_mul_f32 v155, v123, v155
    v_mfma_f32_16x16x32_bf16 v[100:103], v[16:19], a[216:219], 0
    buffer_load_dwordx4 v[84:87], v184, s[48:51], s23 offen offset:2048 sc1
    v_mfma_f32_16x16x32_bf16 v[100:103], v[20:23], a[220:223], v[100:103]
    v_exp_f32 v152, v152
    v_mfma_f32_16x16x32_bf16 v[100:103], v[24:27], a[224:227], v[100:103]
    v_exp_f32 v153, v153
    s_waitcnt vmcnt(12)
    v_mfma_f32_16x16x32_bf16 v[104:107], v[28:31], a[0:3], 0
    v_exp_f32 v154, v154
    v_mfma_f32_16x16x32_bf16 v[104:107], v[32:35], a[4:7], v[104:107]
    buffer_load_dwordx4 v[16:19], v184, s[48:51], s23 offen offset:3072 sc1
    v_mfma_f32_16x16x32_bf16 v[104:107], v[36:39], a[8:11], v[104:107]
    v_exp_f32 v155, v155
    v_mfma_f32_16x16x32_bf16 v[108:111], v[28:31], a[72:75], 0
    v_mul_f32 v156, v120, v136
    v_mul_f32 v157, v121, v137
    v_mfma_f32_16x16x32_bf16 v[108:111], v[32:35], a[76:79], v[108:111]
    v_mul_f32 v158, v122, v138
    v_mul_f32 v159, v123, v139
    v_mfma_f32_16x16x32_bf16 v[108:111], v[36:39], a[80:83], v[108:111]
    buffer_load_dwordx4 v[20:23], v185, s[48:51], s23 offen offset:0 sc1
    v_mfma_f32_16x16x32_bf16 v[112:115], v[28:31], a[144:147], 0
    v_fma_f32 v152, v152, v193, v193
    v_fma_f32 v153, v153, v193, v193
    v_mfma_f32_16x16x32_bf16 v[112:115], v[32:35], a[148:151], v[112:115]
    v_fma_f32 v154, v154, v193, v193
    v_fma_f32 v155, v155, v193, v193
    v_mfma_f32_16x16x32_bf16 v[112:115], v[36:39], a[152:155], v[112:115]
    v_rcp_f32 v152, v152
    v_mfma_f32_16x16x32_bf16 v[116:119], v[28:31], a[216:219], 0
    buffer_load_dwordx4 v[24:27], v185, s[48:51], s23 offen offset:1024 sc1
    v_mfma_f32_16x16x32_bf16 v[116:119], v[32:35], a[220:223], v[116:119]
    v_rcp_f32 v153, v153
    v_mfma_f32_16x16x32_bf16 v[116:119], v[36:39], a[224:227], v[116:119]
    v_rcp_f32 v154, v154
    s_waitcnt vmcnt(12)
    v_mfma_f32_16x16x32_bf16 v[88:91], v[40:43], a[12:15], v[88:91]
    v_rcp_f32 v155, v155
    v_mfma_f32_16x16x32_bf16 v[88:91], v[44:47], a[16:19], v[88:91]
    buffer_load_dwordx4 v[28:31], v185, s[48:51], s23 offen offset:2048 sc1
    v_mfma_f32_16x16x32_bf16 v[88:91], v[48:51], a[20:23], v[88:91]
    v_mul_f32 v156, v156, v152
    v_mul_f32 v157, v157, v153
    v_mfma_f32_16x16x32_bf16 v[92:95], v[40:43], a[84:87], v[92:95]
    v_mul_f32 v158, v158, v154
    v_mul_f32 v159, v159, v155
    v_mfma_f32_16x16x32_bf16 v[92:95], v[44:47], a[88:91], v[92:95]
    v_cvt_pk_bf16_f32 v160, v156, v157
    v_cvt_pk_bf16_f32 v161, v158, v159
    v_mfma_f32_16x16x32_bf16 v[92:95], v[48:51], a[92:95], v[92:95]
    buffer_load_dwordx4 v[32:35], v185, s[48:51], s23 offen offset:3072 sc1
    v_mfma_f32_16x16x32_bf16 v[96:99], v[40:43], a[156:159], v[96:99]
    ds_write_b64 v12, v[160:161] offset:0
    v_mfma_f32_16x16x32_bf16 v[96:99], v[44:47], a[160:163], v[96:99]
    v_mul_f32 v162, v124, v124
    v_mul_f32 v163, v125, v125
    v_mfma_f32_16x16x32_bf16 v[96:99], v[48:51], a[164:167], v[96:99]
    v_mul_f32 v164, v126, v126
    v_mul_f32 v165, v127, v127
    v_mfma_f32_16x16x32_bf16 v[100:103], v[40:43], a[228:231], v[100:103]
    buffer_load_dwordx4 v[36:39], v186, s[48:51], s23 offen offset:0 sc1
    v_mfma_f32_16x16x32_bf16 v[100:103], v[44:47], a[232:235], v[100:103]
    v_fma_f32 v162, v162, v9, v5
    v_fma_f32 v163, v163, v9, v5
    v_mfma_f32_16x16x32_bf16 v[100:103], v[48:51], a[236:239], v[100:103]
    v_fma_f32 v164, v164, v9, v5
    v_fma_f32 v165, v165, v9, v5
    s_waitcnt vmcnt(12)
    v_mfma_f32_16x16x32_bf16 v[104:107], v[52:55], a[12:15], v[104:107]
    v_mul_f32 v162, v124, v162
    v_mul_f32 v163, v125, v163
    v_mfma_f32_16x16x32_bf16 v[104:107], v[56:59], a[16:19], v[104:107]
    buffer_load_dwordx4 v[40:43], v186, s[48:51], s23 offen offset:1024 sc1
    v_mfma_f32_16x16x32_bf16 v[104:107], v[60:63], a[20:23], v[104:107]
    v_mul_f32 v164, v126, v164
    v_mul_f32 v165, v127, v165
    v_mfma_f32_16x16x32_bf16 v[108:111], v[52:55], a[84:87], v[108:111]
    v_exp_f32 v162, v162
    v_mfma_f32_16x16x32_bf16 v[108:111], v[56:59], a[88:91], v[108:111]
    v_exp_f32 v163, v163
    v_mfma_f32_16x16x32_bf16 v[108:111], v[60:63], a[92:95], v[108:111]
    buffer_load_dwordx4 v[44:47], v186, s[48:51], s23 offen offset:2048 sc1
    v_mfma_f32_16x16x32_bf16 v[112:115], v[52:55], a[156:159], v[112:115]
    v_exp_f32 v164, v164
    v_mfma_f32_16x16x32_bf16 v[112:115], v[56:59], a[160:163], v[112:115]
    v_exp_f32 v165, v165
    v_mfma_f32_16x16x32_bf16 v[112:115], v[60:63], a[164:167], v[112:115]
    v_mul_f32 v166, v124, v140
    v_mul_f32 v167, v125, v141
    v_mfma_f32_16x16x32_bf16 v[116:119], v[52:55], a[228:231], v[116:119]
    buffer_load_dwordx4 v[48:51], v186, s[48:51], s23 offen offset:3072 sc1
    v_mfma_f32_16x16x32_bf16 v[116:119], v[56:59], a[232:235], v[116:119]
    v_mul_f32 v168, v126, v142
    v_mul_f32 v169, v127, v143
    v_mfma_f32_16x16x32_bf16 v[116:119], v[60:63], a[236:239], v[116:119]
    v_fma_f32 v162, v162, v194, v194
    v_fma_f32 v163, v163, v194, v194
    s_waitcnt vmcnt(12)
    v_mfma_f32_16x16x32_bf16 v[88:91], v[64:67], a[24:27], v[88:91]
    v_fma_f32 v164, v164, v194, v194
    v_fma_f32 v165, v165, v194, v194
    v_mfma_f32_16x16x32_bf16 v[88:91], v[68:71], a[28:31], v[88:91]
    buffer_load_dwordx4 v[52:55], v187, s[48:51], s23 offen offset:0 sc1
    v_mfma_f32_16x16x32_bf16 v[88:91], v[72:75], a[32:35], v[88:91]
    v_rcp_f32 v162, v162
    v_mfma_f32_16x16x32_bf16 v[92:95], v[64:67], a[96:99], v[92:95]
    v_rcp_f32 v163, v163
    v_mfma_f32_16x16x32_bf16 v[92:95], v[68:71], a[100:103], v[92:95]
    v_rcp_f32 v164, v164
    v_mfma_f32_16x16x32_bf16 v[92:95], v[72:75], a[104:107], v[92:95]
    buffer_load_dwordx4 v[56:59], v187, s[48:51], s23 offen offset:1024 sc1
    v_mfma_f32_16x16x32_bf16 v[96:99], v[64:67], a[168:171], v[96:99]
    v_rcp_f32 v165, v165
    v_mfma_f32_16x16x32_bf16 v[96:99], v[68:71], a[172:175], v[96:99]
    v_mul_f32 v166, v166, v162
    v_mul_f32 v167, v167, v163
    v_mfma_f32_16x16x32_bf16 v[96:99], v[72:75], a[176:179], v[96:99]
    v_mul_f32 v168, v168, v164
    v_mul_f32 v169, v169, v165
    v_mfma_f32_16x16x32_bf16 v[100:103], v[64:67], a[240:243], v[100:103]
    buffer_load_dwordx4 v[60:63], v187, s[48:51], s23 offen offset:2048 sc1
    v_mfma_f32_16x16x32_bf16 v[100:103], v[68:71], a[244:247], v[100:103]
    v_cvt_pk_bf16_f32 v170, v166, v167
    v_cvt_pk_bf16_f32 v171, v168, v169
    v_mfma_f32_16x16x32_bf16 v[100:103], v[72:75], a[248:251], v[100:103]
    ds_write_b64 v12, v[170:171] offset:18432
    s_waitcnt vmcnt(12)
    v_mfma_f32_16x16x32_bf16 v[104:107], v[76:79], a[24:27], v[104:107]
    v_mul_f32 v152, v128, v128
    v_mul_f32 v153, v129, v129
    v_mfma_f32_16x16x32_bf16 v[104:107], v[80:83], a[28:31], v[104:107]
    buffer_load_dwordx4 v[64:67], v187, s[48:51], s23 offen offset:3072 sc1
    v_mfma_f32_16x16x32_bf16 v[104:107], v[84:87], a[32:35], v[104:107]
    v_mul_f32 v154, v130, v130
    v_mul_f32 v155, v131, v131
    v_mfma_f32_16x16x32_bf16 v[108:111], v[76:79], a[96:99], v[108:111]
    v_fma_f32 v152, v152, v13, v6
    v_fma_f32 v153, v153, v13, v6
    v_mfma_f32_16x16x32_bf16 v[108:111], v[80:83], a[100:103], v[108:111]
    v_fma_f32 v154, v154, v13, v6
    v_fma_f32 v155, v155, v13, v6
    v_mfma_f32_16x16x32_bf16 v[108:111], v[84:87], a[104:107], v[108:111]
    buffer_load_dwordx4 v[68:71], v188, s[48:51], s23 offen offset:0 sc1
    v_mfma_f32_16x16x32_bf16 v[112:115], v[76:79], a[168:171], v[112:115]
    v_mul_f32 v152, v128, v152
    v_mul_f32 v153, v129, v153
    v_mfma_f32_16x16x32_bf16 v[112:115], v[80:83], a[172:175], v[112:115]
    v_mul_f32 v154, v130, v154
    v_mul_f32 v155, v131, v155
    v_mfma_f32_16x16x32_bf16 v[112:115], v[84:87], a[176:179], v[112:115]
    v_exp_f32 v152, v152
    v_mfma_f32_16x16x32_bf16 v[116:119], v[76:79], a[240:243], v[116:119]
    buffer_load_dwordx4 v[72:75], v188, s[48:51], s23 offen offset:1024 sc1
    v_mfma_f32_16x16x32_bf16 v[116:119], v[80:83], a[244:247], v[116:119]
    v_exp_f32 v153, v153
    v_mfma_f32_16x16x32_bf16 v[116:119], v[84:87], a[248:251], v[116:119]
    v_exp_f32 v154, v154
    s_waitcnt vmcnt(12)
    v_mfma_f32_16x16x32_bf16 v[88:91], v[16:19], a[36:39], v[88:91]
    v_exp_f32 v155, v155
    v_mfma_f32_16x16x32_bf16 v[88:91], v[20:23], a[40:43], v[88:91]
    buffer_load_dwordx4 v[76:79], v188, s[48:51], s23 offen offset:2048 sc1
    v_mfma_f32_16x16x32_bf16 v[88:91], v[24:27], a[44:47], v[88:91]
    v_mul_f32 v156, v128, v144
    v_mul_f32 v157, v129, v145
    v_mfma_f32_16x16x32_bf16 v[92:95], v[16:19], a[108:111], v[92:95]
    v_mul_f32 v158, v130, v146
    v_mul_f32 v159, v131, v147
    v_mfma_f32_16x16x32_bf16 v[92:95], v[20:23], a[112:115], v[92:95]
    v_fma_f32 v152, v152, v195, v195
    v_fma_f32 v153, v153, v195, v195
    v_mfma_f32_16x16x32_bf16 v[92:95], v[24:27], a[116:119], v[92:95]
    buffer_load_dwordx4 v[80:83], v188, s[48:51], s23 offen offset:3072 sc1
    v_mfma_f32_16x16x32_bf16 v[96:99], v[16:19], a[180:183], v[96:99]
    v_fma_f32 v154, v154, v195, v195
    v_fma_f32 v155, v155, v195, v195
    v_mfma_f32_16x16x32_bf16 v[96:99], v[20:23], a[184:187], v[96:99]
    v_rcp_f32 v152, v152
    v_mfma_f32_16x16x32_bf16 v[96:99], v[24:27], a[188:191], v[96:99]
    v_rcp_f32 v153, v153
    v_mfma_f32_16x16x32_bf16 v[100:103], v[16:19], a[252:255], v[100:103]
    buffer_load_dwordx4 v[84:87], v189, s[48:51], s23 offen offset:0 sc1
    v_mfma_f32_16x16x32_bf16 v[100:103], v[20:23], v[220:223], v[100:103]
    v_rcp_f32 v154, v154
    v_mfma_f32_16x16x32_bf16 v[100:103], v[24:27], v[224:227], v[100:103]
    v_rcp_f32 v155, v155
    s_waitcnt vmcnt(12)
    v_mfma_f32_16x16x32_bf16 v[104:107], v[28:31], a[36:39], v[104:107]
    v_mul_f32 v156, v156, v152
    v_mul_f32 v157, v157, v153
    v_mfma_f32_16x16x32_bf16 v[104:107], v[32:35], a[40:43], v[104:107]
    buffer_load_dwordx4 v[16:19], v189, s[48:51], s23 offen offset:1024 sc1
    v_mfma_f32_16x16x32_bf16 v[104:107], v[36:39], a[44:47], v[104:107]
    v_mul_f32 v158, v158, v154
    v_mul_f32 v159, v159, v155
    v_mfma_f32_16x16x32_bf16 v[108:111], v[28:31], a[108:111], v[108:111]
    v_cvt_pk_bf16_f32 v160, v156, v157
    v_cvt_pk_bf16_f32 v161, v158, v159
    v_mfma_f32_16x16x32_bf16 v[108:111], v[32:35], a[112:115], v[108:111]
    ds_write_b64 v12, v[160:161] offset:36864
    v_mfma_f32_16x16x32_bf16 v[108:111], v[36:39], a[116:119], v[108:111]
    buffer_load_dwordx4 v[20:23], v189, s[48:51], s23 offen offset:2048 sc1
    v_mfma_f32_16x16x32_bf16 v[112:115], v[28:31], a[180:183], v[112:115]
    v_mul_f32 v162, v132, v132
    v_mul_f32 v163, v133, v133
    v_mfma_f32_16x16x32_bf16 v[112:115], v[32:35], a[184:187], v[112:115]
    v_mul_f32 v164, v134, v134
    v_mul_f32 v165, v135, v135
    v_mfma_f32_16x16x32_bf16 v[112:115], v[36:39], a[188:191], v[112:115]
    v_fma_f32 v162, v162, v14, v7
    v_fma_f32 v163, v163, v14, v7
    v_mfma_f32_16x16x32_bf16 v[116:119], v[28:31], a[252:255], v[116:119]
    buffer_load_dwordx4 v[24:27], v189, s[48:51], s23 offen offset:3072 sc1
    v_mfma_f32_16x16x32_bf16 v[116:119], v[32:35], v[220:223], v[116:119]
    v_fma_f32 v164, v164, v14, v7
    v_fma_f32 v165, v165, v14, v7
    v_mfma_f32_16x16x32_bf16 v[116:119], v[36:39], v[224:227], v[116:119]
    v_mul_f32 v162, v132, v162
    v_mul_f32 v163, v133, v163
    s_waitcnt vmcnt(12)
    v_mfma_f32_16x16x32_bf16 v[88:91], v[40:43], a[48:51], v[88:91]
    v_mul_f32 v164, v134, v164
    v_mul_f32 v165, v135, v165
    v_mfma_f32_16x16x32_bf16 v[88:91], v[44:47], a[52:55], v[88:91]
    buffer_load_dwordx4 v[28:31], v190, s[48:51], s23 offen offset:0 sc1
    v_mfma_f32_16x16x32_bf16 v[88:91], v[48:51], a[56:59], v[88:91]
    v_exp_f32 v162, v162
    v_mfma_f32_16x16x32_bf16 v[92:95], v[40:43], a[120:123], v[92:95]
    v_exp_f32 v163, v163
    v_mfma_f32_16x16x32_bf16 v[92:95], v[44:47], a[124:127], v[92:95]
    v_exp_f32 v164, v164
    v_mfma_f32_16x16x32_bf16 v[92:95], v[48:51], a[128:131], v[92:95]
    buffer_load_dwordx4 v[32:35], v190, s[48:51], s23 offen offset:1024 sc1
    v_mfma_f32_16x16x32_bf16 v[96:99], v[40:43], a[192:195], v[96:99]
    v_exp_f32 v165, v165
    v_mfma_f32_16x16x32_bf16 v[96:99], v[44:47], a[196:199], v[96:99]
    v_mul_f32 v166, v132, v148
    v_mul_f32 v167, v133, v149
    v_mfma_f32_16x16x32_bf16 v[96:99], v[48:51], a[200:203], v[96:99]
    v_mul_f32 v168, v134, v150
    v_mul_f32 v169, v135, v151
    v_mfma_f32_16x16x32_bf16 v[100:103], v[40:43], v[228:231], v[100:103]
    buffer_load_dwordx4 v[36:39], v190, s[48:51], s23 offen offset:2048 sc1
    v_mfma_f32_16x16x32_bf16 v[100:103], v[44:47], v[232:235], v[100:103]
    v_fma_f32 v162, v162, v252, v252
    v_fma_f32 v163, v163, v252, v252
    v_mfma_f32_16x16x32_bf16 v[100:103], v[48:51], v[236:239], v[100:103]
    v_fma_f32 v164, v164, v252, v252
    v_fma_f32 v165, v165, v252, v252
    s_waitcnt vmcnt(12)
    v_mfma_f32_16x16x32_bf16 v[104:107], v[52:55], a[48:51], v[104:107]
    v_rcp_f32 v162, v162
    v_mfma_f32_16x16x32_bf16 v[104:107], v[56:59], a[52:55], v[104:107]
    buffer_load_dwordx4 v[40:43], v190, s[48:51], s23 offen offset:3072 sc1
    v_mfma_f32_16x16x32_bf16 v[104:107], v[60:63], a[56:59], v[104:107]
    v_rcp_f32 v163, v163
    v_mfma_f32_16x16x32_bf16 v[108:111], v[52:55], a[120:123], v[108:111]
    v_rcp_f32 v164, v164
    v_mfma_f32_16x16x32_bf16 v[108:111], v[56:59], a[124:127], v[108:111]
    v_rcp_f32 v165, v165
    v_mfma_f32_16x16x32_bf16 v[108:111], v[60:63], a[128:131], v[108:111]
    buffer_load_dwordx4 v[44:47], v191, s[48:51], s23 offen offset:0 sc1
    v_mfma_f32_16x16x32_bf16 v[112:115], v[52:55], a[192:195], v[112:115]
    v_mul_f32 v166, v166, v162
    v_mul_f32 v167, v167, v163
    v_mfma_f32_16x16x32_bf16 v[112:115], v[56:59], a[196:199], v[112:115]
    v_mul_f32 v168, v168, v164
    v_mul_f32 v169, v169, v165
    v_mfma_f32_16x16x32_bf16 v[112:115], v[60:63], a[200:203], v[112:115]
    v_cvt_pk_bf16_f32 v170, v166, v167
    v_cvt_pk_bf16_f32 v171, v168, v169
    v_mfma_f32_16x16x32_bf16 v[116:119], v[52:55], v[228:231], v[116:119]
    buffer_load_dwordx4 v[48:51], v191, s[48:51], s23 offen offset:1024 sc1
    v_mfma_f32_16x16x32_bf16 v[116:119], v[56:59], v[232:235], v[116:119]
    ds_write_b64 v12, v[170:171] offset:55296
    v_mfma_f32_16x16x32_bf16 v[116:119], v[60:63], v[236:239], v[116:119]
    s_waitcnt vmcnt(12)
    v_mfma_f32_16x16x32_bf16 v[88:91], v[64:67], a[60:63], v[88:91]
    v_mfma_f32_16x16x32_bf16 v[88:91], v[68:71], a[64:67], v[88:91]
    buffer_load_dwordx4 v[52:55], v191, s[48:51], s23 offen offset:2048 sc1
    v_mfma_f32_16x16x32_bf16 v[120:123], v[72:75], a[68:71], v[88:91]
    v_mfma_f32_16x16x32_bf16 v[92:95], v[64:67], a[132:135], v[92:95]
    v_mfma_f32_16x16x32_bf16 v[92:95], v[68:71], a[136:139], v[92:95]
    v_mfma_f32_16x16x32_bf16 v[124:127], v[72:75], a[140:143], v[92:95]
    buffer_load_dwordx4 v[56:59], v191, s[48:51], s23 offen offset:3072 sc1
    v_mfma_f32_16x16x32_bf16 v[96:99], v[64:67], a[204:207], v[96:99]
    v_mfma_f32_16x16x32_bf16 v[96:99], v[68:71], a[208:211], v[96:99]
    v_mfma_f32_16x16x32_bf16 v[128:131], v[72:75], a[212:215], v[96:99]
    v_mfma_f32_16x16x32_bf16 v[100:103], v[64:67], v[240:243], v[100:103]
    buffer_load_dwordx4 v[60:63], v192, s[48:51], s23 offen offset:0 sc1
    v_mfma_f32_16x16x32_bf16 v[100:103], v[68:71], v[244:247], v[100:103]
    v_mfma_f32_16x16x32_bf16 v[132:135], v[72:75], v[248:251], v[100:103]
    s_waitcnt vmcnt(12)
    v_mfma_f32_16x16x32_bf16 v[104:107], v[76:79], a[60:63], v[104:107]
    v_mfma_f32_16x16x32_bf16 v[104:107], v[80:83], a[64:67], v[104:107]
    buffer_load_dwordx4 v[64:67], v192, s[48:51], s23 offen offset:1024 sc1
    v_mfma_f32_16x16x32_bf16 v[136:139], v[84:87], a[68:71], v[104:107]
    v_mfma_f32_16x16x32_bf16 v[108:111], v[76:79], a[132:135], v[108:111]
    v_mfma_f32_16x16x32_bf16 v[108:111], v[80:83], a[136:139], v[108:111]
    v_mfma_f32_16x16x32_bf16 v[140:143], v[84:87], a[140:143], v[108:111]
    buffer_load_dwordx4 v[68:71], v192, s[48:51], s23 offen offset:2048 sc1
    v_mfma_f32_16x16x32_bf16 v[112:115], v[76:79], a[204:207], v[112:115]
    v_mfma_f32_16x16x32_bf16 v[112:115], v[80:83], a[208:211], v[112:115]
    s_lshl_b32 s7, s25, 11
    v_mfma_f32_16x16x32_bf16 v[144:147], v[84:87], a[212:215], v[112:115]
    s_add_u32 s7, s7, s28
    v_mfma_f32_16x16x32_bf16 v[116:119], v[76:79], v[240:243], v[116:119]
    buffer_load_dwordx4 v[72:75], v192, s[48:51], s23 offen offset:3072 sc1
    v_mfma_f32_16x16x32_bf16 v[116:119], v[80:83], v[244:247], v[116:119]
    s_add_u32 s23, s23, 36864
    v_mfma_f32_16x16x32_bf16 v[148:151], v[84:87], v[248:251], v[116:119]
    v_add_u32 v12, s7, v184
    s_add_u32 s25, s25, 1
    s_cmp_lt_u32 s25, 8
    s_cbranch_scc1 L_ffn_gu_32
    v_add_u32 v10, 73728, v184
    v_add_u32 v11, 110592, v184
    s_lshr_b32 s7, s2, 3
    s_lshl_b32 s7, s7, 2
    s_add_u32 s7, s7, s3
    s_lshl_b32 s7, s7, 9
    v_lshrrev_b32 v1, 1, v253
    v_add_u32 v1, s7, v1
    buffer_load_dwordx2 v[2:3], v1, s[96:99], 0 offen
    s_waitcnt lgkmcnt(0)
    s_barrier
    s_waitcnt vmcnt(12)
    v_mfma_f32_16x16x32_bf16 v[88:91], v[16:19], a[0:3], 0
    v_mfma_f32_16x16x32_bf16 v[88:91], v[20:23], a[4:7], v[88:91]
    buffer_load_dwordx4 v[76:79], v184, s[48:51], s23 offen offset:0 sc1
    v_mfma_f32_16x16x32_bf16 v[88:91], v[24:27], a[8:11], v[88:91]
    v_mul_f32 v152, v120, v120
    v_mul_f32 v153, v121, v121
    v_mfma_f32_16x16x32_bf16 v[92:95], v[16:19], a[72:75], 0
    v_mul_f32 v154, v122, v122
    v_mul_f32 v155, v123, v123
    v_mfma_f32_16x16x32_bf16 v[92:95], v[20:23], a[76:79], v[92:95]
    v_fma_f32 v152, v152, v8, v4
    v_fma_f32 v153, v153, v8, v4
    v_mfma_f32_16x16x32_bf16 v[92:95], v[24:27], a[80:83], v[92:95]
    buffer_load_dwordx4 v[80:83], v184, s[48:51], s23 offen offset:1024 sc1
    v_mfma_f32_16x16x32_bf16 v[96:99], v[16:19], a[144:147], 0
    v_fma_f32 v154, v154, v8, v4
    v_fma_f32 v155, v155, v8, v4
    v_mfma_f32_16x16x32_bf16 v[96:99], v[20:23], a[148:151], v[96:99]
    v_mul_f32 v152, v120, v152
    v_mul_f32 v153, v121, v153
    v_mfma_f32_16x16x32_bf16 v[96:99], v[24:27], a[152:155], v[96:99]
    v_mul_f32 v154, v122, v154
    v_mul_f32 v155, v123, v155
    v_mfma_f32_16x16x32_bf16 v[100:103], v[16:19], a[216:219], 0
    buffer_load_dwordx4 v[84:87], v184, s[48:51], s23 offen offset:2048 sc1
    v_mfma_f32_16x16x32_bf16 v[100:103], v[20:23], a[220:223], v[100:103]
    v_exp_f32 v152, v152
    v_mfma_f32_16x16x32_bf16 v[100:103], v[24:27], a[224:227], v[100:103]
    v_exp_f32 v153, v153
    s_waitcnt vmcnt(12)
    v_mfma_f32_16x16x32_bf16 v[104:107], v[28:31], a[0:3], 0
    v_exp_f32 v154, v154
    ds_read_b128 a[0:3], v10 offset:0
    v_mfma_f32_16x16x32_bf16 v[104:107], v[32:35], a[4:7], v[104:107]
    buffer_load_dwordx4 v[16:19], v184, s[48:51], s23 offen offset:3072 sc1
    v_mfma_f32_16x16x32_bf16 v[104:107], v[36:39], a[8:11], v[104:107]
    v_exp_f32 v155, v155
    v_mfma_f32_16x16x32_bf16 v[108:111], v[28:31], a[72:75], 0
    v_mul_f32 v156, v120, v136
    v_mul_f32 v157, v121, v137
    ds_read_b128 a[72:75], v10 offset:18432
    v_mfma_f32_16x16x32_bf16 v[108:111], v[32:35], a[76:79], v[108:111]
    v_mul_f32 v158, v122, v138
    v_mul_f32 v159, v123, v139
    v_mfma_f32_16x16x32_bf16 v[108:111], v[36:39], a[80:83], v[108:111]
    buffer_load_dwordx4 v[20:23], v185, s[48:51], s23 offen offset:0 sc1
    v_mfma_f32_16x16x32_bf16 v[112:115], v[28:31], a[144:147], 0
    v_fma_f32 v152, v152, v193, v193
    v_fma_f32 v153, v153, v193, v193
    ds_read_b128 a[144:147], v11 offset:0
    v_mfma_f32_16x16x32_bf16 v[112:115], v[32:35], a[148:151], v[112:115]
    v_fma_f32 v154, v154, v193, v193
    v_fma_f32 v155, v155, v193, v193
    v_mfma_f32_16x16x32_bf16 v[112:115], v[36:39], a[152:155], v[112:115]
    v_rcp_f32 v152, v152
    v_mfma_f32_16x16x32_bf16 v[116:119], v[28:31], a[216:219], 0
    buffer_load_dwordx4 v[24:27], v185, s[48:51], s23 offen offset:1024 sc1
    v_mfma_f32_16x16x32_bf16 v[116:119], v[32:35], a[220:223], v[116:119]
    v_rcp_f32 v153, v153
    ds_read_b128 a[216:219], v11 offset:18432
    v_mfma_f32_16x16x32_bf16 v[116:119], v[36:39], a[224:227], v[116:119]
    v_rcp_f32 v154, v154
    ds_read_b128 a[4:7], v10 offset:1024
    s_waitcnt vmcnt(12)
    v_mfma_f32_16x16x32_bf16 v[88:91], v[40:43], a[12:15], v[88:91]
    v_rcp_f32 v155, v155
    ds_read_b128 a[76:79], v10 offset:19456
    v_mfma_f32_16x16x32_bf16 v[88:91], v[44:47], a[16:19], v[88:91]
    buffer_load_dwordx4 v[28:31], v185, s[48:51], s23 offen offset:2048 sc1
    v_mfma_f32_16x16x32_bf16 v[88:91], v[48:51], a[20:23], v[88:91]
    v_mul_f32 v156, v156, v152
    v_mul_f32 v157, v157, v153
    ds_read_b128 a[148:151], v11 offset:1024
    v_mfma_f32_16x16x32_bf16 v[92:95], v[40:43], a[84:87], v[92:95]
    v_mul_f32 v158, v158, v154
    v_mul_f32 v159, v159, v155
    ds_read_b128 a[220:223], v11 offset:19456
    v_mfma_f32_16x16x32_bf16 v[92:95], v[44:47], a[88:91], v[92:95]
    v_cvt_pk_bf16_f32 v160, v156, v157
    v_cvt_pk_bf16_f32 v161, v158, v159
    ds_read_b128 a[8:11], v10 offset:2048
    v_mfma_f32_16x16x32_bf16 v[92:95], v[48:51], a[92:95], v[92:95]
    buffer_load_dwordx4 v[32:35], v185, s[48:51], s23 offen offset:3072 sc1
    v_mfma_f32_16x16x32_bf16 v[96:99], v[40:43], a[156:159], v[96:99]
    ds_write_b64 v12, v[160:161] offset:0
    v_mfma_f32_16x16x32_bf16 v[96:99], v[44:47], a[160:163], v[96:99]
    v_mul_f32 v162, v124, v124
    v_mul_f32 v163, v125, v125
    ds_read_b128 a[80:83], v10 offset:20480
    v_mfma_f32_16x16x32_bf16 v[96:99], v[48:51], a[164:167], v[96:99]
    v_mul_f32 v164, v126, v126
    v_mul_f32 v165, v127, v127
    ds_read_b128 a[152:155], v11 offset:2048
    v_mfma_f32_16x16x32_bf16 v[100:103], v[40:43], a[228:231], v[100:103]
    buffer_load_dwordx4 v[36:39], v186, s[48:51], s23 offen offset:0 sc1
    v_mfma_f32_16x16x32_bf16 v[100:103], v[44:47], a[232:235], v[100:103]
    v_fma_f32 v162, v162, v9, v5
    v_fma_f32 v163, v163, v9, v5
    ds_read_b128 a[224:227], v11 offset:20480
    v_mfma_f32_16x16x32_bf16 v[100:103], v[48:51], a[236:239], v[100:103]
    v_fma_f32 v164, v164, v9, v5
    v_fma_f32 v165, v165, v9, v5
    s_waitcnt vmcnt(12)
    v_mfma_f32_16x16x32_bf16 v[104:107], v[52:55], a[12:15], v[104:107]
    v_mul_f32 v162, v124, v162
    v_mul_f32 v163, v125, v163
    ds_read_b128 a[12:15], v10 offset:3072
    v_mfma_f32_16x16x32_bf16 v[104:107], v[56:59], a[16:19], v[104:107]
    buffer_load_dwordx4 v[40:43], v186, s[48:51], s23 offen offset:1024 sc1
    v_mfma_f32_16x16x32_bf16 v[104:107], v[60:63], a[20:23], v[104:107]
    v_mul_f32 v164, v126, v164
    v_mul_f32 v165, v127, v165
    v_mfma_f32_16x16x32_bf16 v[108:111], v[52:55], a[84:87], v[108:111]
    v_exp_f32 v162, v162
    ds_read_b128 a[84:87], v10 offset:21504
    v_mfma_f32_16x16x32_bf16 v[108:111], v[56:59], a[88:91], v[108:111]
    v_exp_f32 v163, v163
    v_mfma_f32_16x16x32_bf16 v[108:111], v[60:63], a[92:95], v[108:111]
    buffer_load_dwordx4 v[44:47], v186, s[48:51], s23 offen offset:2048 sc1
    v_mfma_f32_16x16x32_bf16 v[112:115], v[52:55], a[156:159], v[112:115]
    v_exp_f32 v164, v164
    ds_read_b128 a[156:159], v11 offset:3072
    v_mfma_f32_16x16x32_bf16 v[112:115], v[56:59], a[160:163], v[112:115]
    v_exp_f32 v165, v165
    v_mfma_f32_16x16x32_bf16 v[112:115], v[60:63], a[164:167], v[112:115]
    v_mul_f32 v166, v124, v140
    v_mul_f32 v167, v125, v141
    v_mfma_f32_16x16x32_bf16 v[116:119], v[52:55], a[228:231], v[116:119]
    buffer_load_dwordx4 v[48:51], v186, s[48:51], s23 offen offset:3072 sc1
    v_mfma_f32_16x16x32_bf16 v[116:119], v[56:59], a[232:235], v[116:119]
    v_mul_f32 v168, v126, v142
    v_mul_f32 v169, v127, v143
    ds_read_b128 a[228:231], v11 offset:21504
    v_mfma_f32_16x16x32_bf16 v[116:119], v[60:63], a[236:239], v[116:119]
    v_fma_f32 v162, v162, v194, v194
    v_fma_f32 v163, v163, v194, v194
    ds_read_b128 a[16:19], v10 offset:4096
    s_waitcnt vmcnt(12)
    v_mfma_f32_16x16x32_bf16 v[88:91], v[64:67], a[24:27], v[88:91]
    v_fma_f32 v164, v164, v194, v194
    v_fma_f32 v165, v165, v194, v194
    ds_read_b128 a[88:91], v10 offset:22528
    v_mfma_f32_16x16x32_bf16 v[88:91], v[68:71], a[28:31], v[88:91]
    buffer_load_dwordx4 v[52:55], v187, s[48:51], s23 offen offset:0 sc1
    v_mfma_f32_16x16x32_bf16 v[88:91], v[72:75], a[32:35], v[88:91]
    v_rcp_f32 v162, v162
    ds_read_b128 a[160:163], v11 offset:4096
    v_mfma_f32_16x16x32_bf16 v[92:95], v[64:67], a[96:99], v[92:95]
    v_rcp_f32 v163, v163
    ds_read_b128 a[232:235], v11 offset:22528
    v_mfma_f32_16x16x32_bf16 v[92:95], v[68:71], a[100:103], v[92:95]
    v_rcp_f32 v164, v164
    ds_read_b128 a[20:23], v10 offset:5120
    v_mfma_f32_16x16x32_bf16 v[92:95], v[72:75], a[104:107], v[92:95]
    buffer_load_dwordx4 v[56:59], v187, s[48:51], s23 offen offset:1024 sc1
    v_mfma_f32_16x16x32_bf16 v[96:99], v[64:67], a[168:171], v[96:99]
    v_rcp_f32 v165, v165
    ds_read_b128 a[92:95], v10 offset:23552
    v_mfma_f32_16x16x32_bf16 v[96:99], v[68:71], a[172:175], v[96:99]
    v_mul_f32 v166, v166, v162
    v_mul_f32 v167, v167, v163
    ds_read_b128 a[164:167], v11 offset:5120
    v_mfma_f32_16x16x32_bf16 v[96:99], v[72:75], a[176:179], v[96:99]
    v_mul_f32 v168, v168, v164
    v_mul_f32 v169, v169, v165
    ds_read_b128 a[236:239], v11 offset:23552
    v_mfma_f32_16x16x32_bf16 v[100:103], v[64:67], a[240:243], v[100:103]
    buffer_load_dwordx4 v[60:63], v187, s[48:51], s23 offen offset:2048 sc1
    v_mfma_f32_16x16x32_bf16 v[100:103], v[68:71], a[244:247], v[100:103]
    v_cvt_pk_bf16_f32 v170, v166, v167
    v_cvt_pk_bf16_f32 v171, v168, v169
    v_mfma_f32_16x16x32_bf16 v[100:103], v[72:75], a[248:251], v[100:103]
    ds_write_b64 v12, v[170:171] offset:18432
    s_waitcnt vmcnt(12)
    v_mfma_f32_16x16x32_bf16 v[104:107], v[76:79], a[24:27], v[104:107]
    v_mul_f32 v152, v128, v128
    v_mul_f32 v153, v129, v129
    ds_read_b128 a[24:27], v10 offset:6144
    v_mfma_f32_16x16x32_bf16 v[104:107], v[80:83], a[28:31], v[104:107]
    buffer_load_dwordx4 v[64:67], v187, s[48:51], s23 offen offset:3072 sc1
    v_mfma_f32_16x16x32_bf16 v[104:107], v[84:87], a[32:35], v[104:107]
    v_mul_f32 v154, v130, v130
    v_mul_f32 v155, v131, v131
    v_mfma_f32_16x16x32_bf16 v[108:111], v[76:79], a[96:99], v[108:111]
    v_fma_f32 v152, v152, v13, v6
    v_fma_f32 v153, v153, v13, v6
    ds_read_b128 a[96:99], v10 offset:24576
    v_mfma_f32_16x16x32_bf16 v[108:111], v[80:83], a[100:103], v[108:111]
    v_fma_f32 v154, v154, v13, v6
    v_fma_f32 v155, v155, v13, v6
    v_mfma_f32_16x16x32_bf16 v[108:111], v[84:87], a[104:107], v[108:111]
    buffer_load_dwordx4 v[68:71], v188, s[48:51], s23 offen offset:0 sc1
    v_mfma_f32_16x16x32_bf16 v[112:115], v[76:79], a[168:171], v[112:115]
    v_mul_f32 v152, v128, v152
    v_mul_f32 v153, v129, v153
    ds_read_b128 a[168:171], v11 offset:6144
    v_mfma_f32_16x16x32_bf16 v[112:115], v[80:83], a[172:175], v[112:115]
    v_mul_f32 v154, v130, v154
    v_mul_f32 v155, v131, v155
    v_mfma_f32_16x16x32_bf16 v[112:115], v[84:87], a[176:179], v[112:115]
    v_exp_f32 v152, v152
    v_mfma_f32_16x16x32_bf16 v[116:119], v[76:79], a[240:243], v[116:119]
    buffer_load_dwordx4 v[72:75], v188, s[48:51], s23 offen offset:1024 sc1
    v_mfma_f32_16x16x32_bf16 v[116:119], v[80:83], a[244:247], v[116:119]
    v_exp_f32 v153, v153
    ds_read_b128 a[240:243], v11 offset:24576
    v_mfma_f32_16x16x32_bf16 v[116:119], v[84:87], a[248:251], v[116:119]
    v_exp_f32 v154, v154
    ds_read_b128 a[28:31], v10 offset:7168
    s_waitcnt vmcnt(12)
    v_mfma_f32_16x16x32_bf16 v[88:91], v[16:19], a[36:39], v[88:91]
    v_exp_f32 v155, v155
    ds_read_b128 a[100:103], v10 offset:25600
    v_mfma_f32_16x16x32_bf16 v[88:91], v[20:23], a[40:43], v[88:91]
    buffer_load_dwordx4 v[76:79], v188, s[48:51], s23 offen offset:2048 sc1
    v_mfma_f32_16x16x32_bf16 v[88:91], v[24:27], a[44:47], v[88:91]
    v_mul_f32 v156, v128, v144
    v_mul_f32 v157, v129, v145
    ds_read_b128 a[172:175], v11 offset:7168
    v_mfma_f32_16x16x32_bf16 v[92:95], v[16:19], a[108:111], v[92:95]
    v_mul_f32 v158, v130, v146
    v_mul_f32 v159, v131, v147
    ds_read_b128 a[244:247], v11 offset:25600
    v_mfma_f32_16x16x32_bf16 v[92:95], v[20:23], a[112:115], v[92:95]
    v_fma_f32 v152, v152, v195, v195
    v_fma_f32 v153, v153, v195, v195
    ds_read_b128 a[32:35], v10 offset:8192
    v_mfma_f32_16x16x32_bf16 v[92:95], v[24:27], a[116:119], v[92:95]
    buffer_load_dwordx4 v[80:83], v188, s[48:51], s23 offen offset:3072 sc1
    v_mfma_f32_16x16x32_bf16 v[96:99], v[16:19], a[180:183], v[96:99]
    v_fma_f32 v154, v154, v195, v195
    v_fma_f32 v155, v155, v195, v195
    ds_read_b128 a[104:107], v10 offset:26624
    v_mfma_f32_16x16x32_bf16 v[96:99], v[20:23], a[184:187], v[96:99]
    v_rcp_f32 v152, v152
    ds_read_b128 a[176:179], v11 offset:8192
    v_mfma_f32_16x16x32_bf16 v[96:99], v[24:27], a[188:191], v[96:99]
    v_rcp_f32 v153, v153
    ds_read_b128 a[248:251], v11 offset:26624
    v_mfma_f32_16x16x32_bf16 v[100:103], v[16:19], a[252:255], v[100:103]
    buffer_load_dwordx4 v[84:87], v189, s[48:51], s23 offen offset:0 sc1
    v_mfma_f32_16x16x32_bf16 v[100:103], v[20:23], v[220:223], v[100:103]
    v_rcp_f32 v154, v154
    v_mfma_f32_16x16x32_bf16 v[100:103], v[24:27], v[224:227], v[100:103]
    v_rcp_f32 v155, v155
    s_waitcnt vmcnt(12)
    v_mfma_f32_16x16x32_bf16 v[104:107], v[28:31], a[36:39], v[104:107]
    v_mul_f32 v156, v156, v152
    v_mul_f32 v157, v157, v153
    ds_read_b128 a[36:39], v10 offset:9216
    v_mfma_f32_16x16x32_bf16 v[104:107], v[32:35], a[40:43], v[104:107]
    buffer_load_dwordx4 v[16:19], v189, s[48:51], s23 offen offset:1024 sc1
    v_mfma_f32_16x16x32_bf16 v[104:107], v[36:39], a[44:47], v[104:107]
    v_mul_f32 v158, v158, v154
    v_mul_f32 v159, v159, v155
    v_mfma_f32_16x16x32_bf16 v[108:111], v[28:31], a[108:111], v[108:111]
    v_cvt_pk_bf16_f32 v160, v156, v157
    v_cvt_pk_bf16_f32 v161, v158, v159
    ds_read_b128 a[108:111], v10 offset:27648
    v_mfma_f32_16x16x32_bf16 v[108:111], v[32:35], a[112:115], v[108:111]
    ds_write_b64 v12, v[160:161] offset:36864
    v_mfma_f32_16x16x32_bf16 v[108:111], v[36:39], a[116:119], v[108:111]
    buffer_load_dwordx4 v[20:23], v189, s[48:51], s23 offen offset:2048 sc1
    v_mfma_f32_16x16x32_bf16 v[112:115], v[28:31], a[180:183], v[112:115]
    v_mul_f32 v162, v132, v132
    v_mul_f32 v163, v133, v133
    ds_read_b128 a[180:183], v11 offset:9216
    v_mfma_f32_16x16x32_bf16 v[112:115], v[32:35], a[184:187], v[112:115]
    v_mul_f32 v164, v134, v134
    v_mul_f32 v165, v135, v135
    v_mfma_f32_16x16x32_bf16 v[112:115], v[36:39], a[188:191], v[112:115]
    v_fma_f32 v162, v162, v14, v7
    v_fma_f32 v163, v163, v14, v7
    v_mfma_f32_16x16x32_bf16 v[116:119], v[28:31], a[252:255], v[116:119]
    buffer_load_dwordx4 v[24:27], v189, s[48:51], s23 offen offset:3072 sc1
    v_mfma_f32_16x16x32_bf16 v[116:119], v[32:35], v[220:223], v[116:119]
    v_fma_f32 v164, v164, v14, v7
    v_fma_f32 v165, v165, v14, v7
    ds_read_b128 a[252:255], v11 offset:27648
    v_mfma_f32_16x16x32_bf16 v[116:119], v[36:39], v[224:227], v[116:119]
    v_mul_f32 v162, v132, v162
    v_mul_f32 v163, v133, v163
    ds_read_b128 a[40:43], v10 offset:10240
    s_waitcnt vmcnt(12)
    v_mfma_f32_16x16x32_bf16 v[88:91], v[40:43], a[48:51], v[88:91]
    v_mul_f32 v164, v134, v164
    v_mul_f32 v165, v135, v165
    ds_read_b128 a[112:115], v10 offset:28672
    v_mfma_f32_16x16x32_bf16 v[88:91], v[44:47], a[52:55], v[88:91]
    buffer_load_dwordx4 v[28:31], v190, s[48:51], s23 offen offset:0 sc1
    v_mfma_f32_16x16x32_bf16 v[88:91], v[48:51], a[56:59], v[88:91]
    v_exp_f32 v162, v162
    ds_read_b128 a[184:187], v11 offset:10240
    v_mfma_f32_16x16x32_bf16 v[92:95], v[40:43], a[120:123], v[92:95]
    v_exp_f32 v163, v163
    ds_read_b128 v[220:223], v11 offset:28672
    v_mfma_f32_16x16x32_bf16 v[92:95], v[44:47], a[124:127], v[92:95]
    v_exp_f32 v164, v164
    ds_read_b128 a[44:47], v10 offset:11264
    v_mfma_f32_16x16x32_bf16 v[92:95], v[48:51], a[128:131], v[92:95]
    buffer_load_dwordx4 v[32:35], v190, s[48:51], s23 offen offset:1024 sc1
    v_mfma_f32_16x16x32_bf16 v[96:99], v[40:43], a[192:195], v[96:99]
    v_exp_f32 v165, v165
    ds_read_b128 a[116:119], v10 offset:29696
    v_mfma_f32_16x16x32_bf16 v[96:99], v[44:47], a[196:199], v[96:99]
    v_mul_f32 v166, v132, v148
    v_mul_f32 v167, v133, v149
    ds_read_b128 a[188:191], v11 offset:11264
    v_mfma_f32_16x16x32_bf16 v[96:99], v[48:51], a[200:203], v[96:99]
    v_mul_f32 v168, v134, v150
    v_mul_f32 v169, v135, v151
    ds_read_b128 v[224:227], v11 offset:29696
    v_mfma_f32_16x16x32_bf16 v[100:103], v[40:43], v[228:231], v[100:103]
    buffer_load_dwordx4 v[36:39], v190, s[48:51], s23 offen offset:2048 sc1
    v_mfma_f32_16x16x32_bf16 v[100:103], v[44:47], v[232:235], v[100:103]
    v_fma_f32 v162, v162, v252, v252
    v_fma_f32 v163, v163, v252, v252
    v_mfma_f32_16x16x32_bf16 v[100:103], v[48:51], v[236:239], v[100:103]
    v_fma_f32 v164, v164, v252, v252
    v_fma_f32 v165, v165, v252, v252
    s_waitcnt vmcnt(12)
    v_mfma_f32_16x16x32_bf16 v[104:107], v[52:55], a[48:51], v[104:107]
    v_rcp_f32 v162, v162
    ds_read_b128 a[48:51], v10 offset:12288
    v_mfma_f32_16x16x32_bf16 v[104:107], v[56:59], a[52:55], v[104:107]
    buffer_load_dwordx4 v[40:43], v190, s[48:51], s23 offen offset:3072 sc1
    v_mfma_f32_16x16x32_bf16 v[104:107], v[60:63], a[56:59], v[104:107]
    v_rcp_f32 v163, v163
    v_mfma_f32_16x16x32_bf16 v[108:111], v[52:55], a[120:123], v[108:111]
    v_rcp_f32 v164, v164
    ds_read_b128 a[120:123], v10 offset:30720
    v_mfma_f32_16x16x32_bf16 v[108:111], v[56:59], a[124:127], v[108:111]
    v_rcp_f32 v165, v165
    v_mfma_f32_16x16x32_bf16 v[108:111], v[60:63], a[128:131], v[108:111]
    buffer_load_dwordx4 v[44:47], v191, s[48:51], s23 offen offset:0 sc1
    v_mfma_f32_16x16x32_bf16 v[112:115], v[52:55], a[192:195], v[112:115]
    v_mul_f32 v166, v166, v162
    v_mul_f32 v167, v167, v163
    ds_read_b128 a[192:195], v11 offset:12288
    v_mfma_f32_16x16x32_bf16 v[112:115], v[56:59], a[196:199], v[112:115]
    v_mul_f32 v168, v168, v164
    v_mul_f32 v169, v169, v165
    v_mfma_f32_16x16x32_bf16 v[112:115], v[60:63], a[200:203], v[112:115]
    v_cvt_pk_bf16_f32 v170, v166, v167
    v_cvt_pk_bf16_f32 v171, v168, v169
    v_mfma_f32_16x16x32_bf16 v[116:119], v[52:55], v[228:231], v[116:119]
    buffer_load_dwordx4 v[48:51], v191, s[48:51], s23 offen offset:1024 sc1
    v_mfma_f32_16x16x32_bf16 v[116:119], v[56:59], v[232:235], v[116:119]
    ds_write_b64 v12, v[170:171] offset:55296
    v_mfma_f32_16x16x32_bf16 v[116:119], v[60:63], v[236:239], v[116:119]
    ds_read_b128 v[228:231], v11 offset:30720
    s_waitcnt vmcnt(12)
    v_mfma_f32_16x16x32_bf16 v[88:91], v[64:67], a[60:63], v[88:91]
    ds_read_b128 a[52:55], v10 offset:13312
    v_mfma_f32_16x16x32_bf16 v[88:91], v[68:71], a[64:67], v[88:91]
    buffer_load_dwordx4 v[52:55], v191, s[48:51], s23 offen offset:2048 sc1
    v_mfma_f32_16x16x32_bf16 v[120:123], v[72:75], a[68:71], v[88:91]
    ds_read_b128 a[124:127], v10 offset:31744
    v_mfma_f32_16x16x32_bf16 v[92:95], v[64:67], a[132:135], v[92:95]
    ds_read_b128 a[196:199], v11 offset:13312
    v_mfma_f32_16x16x32_bf16 v[92:95], v[68:71], a[136:139], v[92:95]
    ds_read_b128 v[232:235], v11 offset:31744
    v_mfma_f32_16x16x32_bf16 v[124:127], v[72:75], a[140:143], v[92:95]
    buffer_load_dwordx4 v[56:59], v191, s[48:51], s23 offen offset:3072 sc1
    v_mfma_f32_16x16x32_bf16 v[96:99], v[64:67], a[204:207], v[96:99]
    v_mfma_f32_16x16x32_bf16 v[96:99], v[68:71], a[208:211], v[96:99]
    v_mfma_f32_16x16x32_bf16 v[128:131], v[72:75], a[212:215], v[96:99]
    v_mfma_f32_16x16x32_bf16 v[100:103], v[64:67], v[240:243], v[100:103]
    buffer_load_dwordx4 v[60:63], v192, s[48:51], s23 offen offset:0 sc1
    v_mfma_f32_16x16x32_bf16 v[100:103], v[68:71], v[244:247], v[100:103]
    v_mfma_f32_16x16x32_bf16 v[132:135], v[72:75], v[248:251], v[100:103]
    s_waitcnt vmcnt(12)
    v_mfma_f32_16x16x32_bf16 v[104:107], v[76:79], a[60:63], v[104:107]
    v_mfma_f32_16x16x32_bf16 v[104:107], v[80:83], a[64:67], v[104:107]
    buffer_load_dwordx4 v[64:67], v192, s[48:51], s23 offen offset:1024 sc1
    v_mfma_f32_16x16x32_bf16 v[136:139], v[84:87], a[68:71], v[104:107]
    v_mfma_f32_16x16x32_bf16 v[108:111], v[76:79], a[132:135], v[108:111]
    v_mfma_f32_16x16x32_bf16 v[108:111], v[80:83], a[136:139], v[108:111]
    v_mfma_f32_16x16x32_bf16 v[140:143], v[84:87], a[140:143], v[108:111]
    buffer_load_dwordx4 v[68:71], v192, s[48:51], s23 offen offset:2048 sc1
    v_mfma_f32_16x16x32_bf16 v[112:115], v[76:79], a[204:207], v[112:115]
    v_mfma_f32_16x16x32_bf16 v[112:115], v[80:83], a[208:211], v[112:115]
    s_lshl_b32 s7, s25, 11
    v_mfma_f32_16x16x32_bf16 v[144:147], v[84:87], a[212:215], v[112:115]
    s_add_u32 s7, s7, s28
    v_mfma_f32_16x16x32_bf16 v[116:119], v[76:79], v[240:243], v[116:119]
    buffer_load_dwordx4 v[72:75], v192, s[48:51], s23 offen offset:3072 sc1
    v_mfma_f32_16x16x32_bf16 v[116:119], v[80:83], v[244:247], v[116:119]
    s_add_u32 s23, s23, 36864
    v_mfma_f32_16x16x32_bf16 v[148:151], v[84:87], v[248:251], v[116:119]
    v_add_u32 v12, s7, v184
    s_add_u32 s25, s25, 1
    s_waitcnt lgkmcnt(0)
    s_barrier
    v_pk_mul_f32 v[152:153], v[120:121], v[120:121]
    ds_read_b128 a[56:59], v10 offset:14336
    v_pk_mul_f32 v[154:155], v[122:123], v[122:123]
    ds_read_b128 a[128:131], v10 offset:32768
    v_pk_fma_f32 v[152:153], v[152:153], v[8:9], v[4:5] op_sel:[0,0,0] op_sel_hi:[1,0,0]
    ds_read_b128 a[200:203], v11 offset:14336
    v_pk_fma_f32 v[154:155], v[154:155], v[8:9], v[4:5] op_sel:[0,0,0] op_sel_hi:[1,0,0]
    v_pk_mul_f32 v[152:153], v[120:121], v[152:153]
    ds_read_b128 v[236:239], v11 offset:32768
    v_pk_mul_f32 v[154:155], v[122:123], v[154:155]
    ds_read_b128 a[60:63], v10 offset:15360
    buffer_load_dwordx4 v[76:79], v184, s[48:51], s23 offen offset:0 sc1
    v_exp_f32 v152, v152
    ds_read_b128 a[132:135], v10 offset:33792
    v_exp_f32 v153, v153
    v_exp_f32 v154, v154
    ds_read_b128 a[204:207], v11 offset:15360
    v_exp_f32 v155, v155
    ds_read_b128 v[240:243], v11 offset:33792
    v_pk_mul_f32 v[156:157], v[120:121], v[136:137]
    v_pk_mul_f32 v[158:159], v[122:123], v[138:139]
    buffer_load_dwordx4 v[80:83], v184, s[48:51], s23 offen offset:1024 sc1
    v_pk_fma_f32 v[152:153], v[152:153], v[192:193], v[192:193] op_sel:[0,1,1] op_sel_hi:[1,1,1]
    v_pk_fma_f32 v[154:155], v[154:155], v[192:193], v[192:193] op_sel:[0,1,1] op_sel_hi:[1,1,1]
    v_rcp_f32 v152, v152
    v_rcp_f32 v153, v153
    v_rcp_f32 v154, v154
    v_rcp_f32 v155, v155
    buffer_load_dwordx4 v[84:87], v184, s[48:51], s23 offen offset:2048 sc1
    s_nop 0
    v_pk_mul_f32 v[156:157], v[156:157], v[152:153]
    v_pk_mul_f32 v[158:159], v[158:159], v[154:155]
    v_cvt_pk_bf16_f32 v160, v156, v157
    v_cvt_pk_bf16_f32 v161, v158, v159
    ds_write_b64 v12, v[160:161] offset:0
    buffer_load_dwordx4 v[104:107], v184, s[48:51], s23 offen offset:3072 sc1
    v_pk_mul_f32 v[162:163], v[124:125], v[124:125]
    v_pk_mul_f32 v[164:165], v[126:127], v[126:127]
    v_pk_fma_f32 v[162:163], v[162:163], v[8:9], v[4:5] op_sel:[0,1,1] op_sel_hi:[1,1,1]
    v_pk_fma_f32 v[164:165], v[164:165], v[8:9], v[4:5] op_sel:[0,1,1] op_sel_hi:[1,1,1]
    v_pk_mul_f32 v[162:163], v[124:125], v[162:163]
    v_pk_mul_f32 v[164:165], v[126:127], v[164:165]
    buffer_load_dwordx4 v[108:111], v185, s[48:51], s23 offen offset:0 sc1
    v_exp_f32 v162, v162
    v_exp_f32 v163, v163
    v_exp_f32 v164, v164
    v_exp_f32 v165, v165
    v_pk_mul_f32 v[166:167], v[124:125], v[140:141]
    v_pk_mul_f32 v[168:169], v[126:127], v[142:143]
    buffer_load_dwordx4 v[112:115], v185, s[48:51], s23 offen offset:1024 sc1
    v_pk_fma_f32 v[162:163], v[162:163], v[194:195], v[194:195] op_sel:[0,0,0] op_sel_hi:[1,0,0]
    v_pk_fma_f32 v[164:165], v[164:165], v[194:195], v[194:195] op_sel:[0,0,0] op_sel_hi:[1,0,0]
    v_rcp_f32 v162, v162
    v_rcp_f32 v163, v163
    v_rcp_f32 v164, v164
    v_rcp_f32 v165, v165
    buffer_load_dwordx4 v[116:119], v185, s[48:51], s23 offen offset:2048 sc1
    s_nop 0
    v_pk_mul_f32 v[166:167], v[166:167], v[162:163]
    v_pk_mul_f32 v[168:169], v[168:169], v[164:165]
    v_cvt_pk_bf16_f32 v170, v166, v167
    v_cvt_pk_bf16_f32 v171, v168, v169
    ds_write_b64 v12, v[170:171] offset:18432
    buffer_load_dwordx4 v[180:183], v185, s[48:51], s23 offen offset:3072 sc1
    v_pk_mul_f32 v[152:153], v[128:129], v[128:129]
    v_pk_mul_f32 v[154:155], v[130:131], v[130:131]
    v_pk_fma_f32 v[152:153], v[152:153], v[12:13], v[6:7] op_sel:[0,1,0] op_sel_hi:[1,1,0]
    v_pk_fma_f32 v[154:155], v[154:155], v[12:13], v[6:7] op_sel:[0,1,0] op_sel_hi:[1,1,0]
    v_pk_mul_f32 v[152:153], v[128:129], v[152:153]
    v_pk_mul_f32 v[154:155], v[130:131], v[154:155]
    buffer_load_dwordx4 v[196:199], v186, s[48:51], s23 offen offset:0 sc1
    v_exp_f32 v152, v152
    v_exp_f32 v153, v153
    v_exp_f32 v154, v154
    v_exp_f32 v155, v155
    v_pk_mul_f32 v[156:157], v[128:129], v[144:145]
    v_pk_mul_f32 v[158:159], v[130:131], v[146:147]
    buffer_load_dwordx4 v[200:203], v186, s[48:51], s23 offen offset:1024 sc1
    v_pk_fma_f32 v[152:153], v[152:153], v[194:195], v[194:195] op_sel:[0,1,1] op_sel_hi:[1,1,1]
    v_pk_fma_f32 v[154:155], v[154:155], v[194:195], v[194:195] op_sel:[0,1,1] op_sel_hi:[1,1,1]
    v_rcp_f32 v152, v152
    v_rcp_f32 v153, v153
    v_rcp_f32 v154, v154
    v_rcp_f32 v155, v155
    buffer_load_dwordx4 v[204:207], v186, s[48:51], s23 offen offset:2048 sc1
    s_nop 0
    v_pk_mul_f32 v[156:157], v[156:157], v[152:153]
    v_pk_mul_f32 v[158:159], v[158:159], v[154:155]
    v_cvt_pk_bf16_f32 v160, v156, v157
    v_cvt_pk_bf16_f32 v161, v158, v159
    ds_write_b64 v12, v[160:161] offset:36864
    buffer_load_dwordx4 v[208:211], v186, s[48:51], s23 offen offset:3072 sc1
    v_pk_mul_f32 v[162:163], v[132:133], v[132:133]
    v_pk_mul_f32 v[164:165], v[134:135], v[134:135]
    v_pk_fma_f32 v[162:163], v[162:163], v[14:15], v[6:7] op_sel:[0,0,1] op_sel_hi:[1,0,1]
    v_pk_fma_f32 v[164:165], v[164:165], v[14:15], v[6:7] op_sel:[0,0,1] op_sel_hi:[1,0,1]
    v_pk_mul_f32 v[162:163], v[132:133], v[162:163]
    v_pk_mul_f32 v[164:165], v[134:135], v[164:165]
    buffer_load_dwordx4 v[212:215], v187, s[48:51], s23 offen offset:0 sc1
    v_exp_f32 v162, v162
    v_exp_f32 v163, v163
    v_exp_f32 v164, v164
    v_exp_f32 v165, v165
    v_pk_mul_f32 v[166:167], v[132:133], v[148:149]
    v_pk_mul_f32 v[168:169], v[134:135], v[150:151]
    v_pk_fma_f32 v[162:163], v[162:163], v[252:253], v[252:253] op_sel:[0,0,0] op_sel_hi:[1,0,0]
    v_pk_fma_f32 v[164:165], v[164:165], v[252:253], v[252:253] op_sel:[0,0,0] op_sel_hi:[1,0,0]
    v_rcp_f32 v162, v162
    v_rcp_f32 v163, v163
    v_rcp_f32 v164, v164
    v_rcp_f32 v165, v165
    s_nop 0
    v_pk_mul_f32 v[166:167], v[166:167], v[162:163]
    v_pk_mul_f32 v[168:169], v[168:169], v[164:165]
    v_cvt_pk_bf16_f32 v170, v166, v167
    v_cvt_pk_bf16_f32 v171, v168, v169
    ds_write_b64 v12, v[170:171] offset:55296
    buffer_load_dwordx4 v[136:139], v187, s[48:51], s23 offen offset:1024 sc1
    buffer_load_dwordx4 v[140:143], v187, s[48:51], s23 offen offset:2048 sc1
    buffer_load_dwordx4 v[144:147], v187, s[48:51], s23 offen offset:3072 sc1
    buffer_load_dwordx4 v[160:163], v188, s[48:51], s23 offen offset:0 sc1
    buffer_load_dwordx4 v[164:167], v188, s[48:51], s23 offen offset:1024 sc1
    s_add_u32 s23, s23, 18432
    s_waitcnt lgkmcnt(0)
    s_barrier
    ds_read_b128 a[64:67], v10 offset:16384
    ds_read_b128 a[136:139], v10 offset:34816
    ds_read_b128 a[208:211], v11 offset:16384
    ds_read_b128 v[244:247], v11 offset:34816
    ds_read_b128 a[68:71], v10 offset:17408
    ds_read_b128 a[140:143], v10 offset:35840
    ds_read_b128 a[212:215], v11 offset:17408
    ds_read_b128 v[248:251], v11 offset:35840
    s_mov_b32 s25, 0
    s_waitcnt lgkmcnt(0)
    s_branch L_ffn_dn_mid_34
L_ffn_dn_33:
    s_waitcnt vmcnt(32)
    v_mfma_f32_16x16x32_bf16 v[88:91], v[104:107], a[0:3], 0
    v_mfma_f32_16x16x32_bf16 v[88:91], v[108:111], a[4:7], v[88:91]
    buffer_load_dwordx4 v[76:79], v184, s[48:51], s23 offen offset:0 sc1
    v_mfma_f32_16x16x32_bf16 v[88:91], v[112:115], a[8:11], v[88:91]
    v_mfma_f32_16x16x32_bf16 v[92:95], v[104:107], a[72:75], 0
    v_mfma_f32_16x16x32_bf16 v[92:95], v[108:111], a[76:79], v[92:95]
    v_mfma_f32_16x16x32_bf16 v[92:95], v[112:115], a[80:83], v[92:95]
    buffer_load_dwordx4 v[80:83], v184, s[48:51], s23 offen offset:1024 sc1
    v_mfma_f32_16x16x32_bf16 v[96:99], v[104:107], a[144:147], 0
    v_cvt_pk_bf16_f32 v152, v120, v121
    v_cvt_pk_bf16_f32 v153, v122, v123
    v_mfma_f32_16x16x32_bf16 v[96:99], v[108:111], a[148:151], v[96:99]
    v_cvt_pk_bf16_f32 v154, v124, v125
    v_cvt_pk_bf16_f32 v155, v126, v127
    v_mfma_f32_16x16x32_bf16 v[96:99], v[112:115], a[152:155], v[96:99]
    s_nop 0
    v_permlane16_swap_b32 v152, v154
    v_mfma_f32_16x16x32_bf16 v[100:103], v[104:107], a[216:219], 0
    buffer_load_dwordx4 v[84:87], v184, s[48:51], s23 offen offset:2048 sc1
    v_mfma_f32_16x16x32_bf16 v[100:103], v[108:111], a[220:223], v[100:103]
    v_permlane16_swap_b32 v153, v155
    v_mfma_f32_16x16x32_bf16 v[100:103], v[112:115], a[224:227], v[100:103]
    buffer_store_dwordx4 v[152:155], v178, s[72:75], s27 offen sc1
    s_waitcnt vmcnt(33)
    v_mfma_f32_16x16x32_bf16 v[88:91], v[116:119], a[12:15], v[88:91]
    ds_write_b128 v216, v[152:155]
    v_mfma_f32_16x16x32_bf16 v[88:91], v[180:183], a[16:19], v[88:91]
    buffer_load_dwordx4 v[104:107], v184, s[48:51], s23 offen offset:3072 sc1
    v_mfma_f32_16x16x32_bf16 v[88:91], v[196:199], a[20:23], v[88:91]
    v_add_u32 v216, v216, v218
    v_mfma_f32_16x16x32_bf16 v[92:95], v[116:119], a[84:87], v[92:95]
    v_mfma_f32_16x16x32_bf16 v[92:95], v[180:183], a[88:91], v[92:95]
    v_mfma_f32_16x16x32_bf16 v[92:95], v[196:199], a[92:95], v[92:95]
    buffer_load_dwordx4 v[108:111], v185, s[48:51], s23 offen offset:0 sc1
    v_mfma_f32_16x16x32_bf16 v[96:99], v[116:119], a[156:159], v[96:99]
    v_mfma_f32_16x16x32_bf16 v[96:99], v[180:183], a[160:163], v[96:99]
    v_mfma_f32_16x16x32_bf16 v[96:99], v[196:199], a[164:167], v[96:99]
    v_mfma_f32_16x16x32_bf16 v[100:103], v[116:119], a[228:231], v[100:103]
    buffer_load_dwordx4 v[112:115], v185, s[48:51], s23 offen offset:1024 sc1
    v_mfma_f32_16x16x32_bf16 v[100:103], v[180:183], a[232:235], v[100:103]
    v_mfma_f32_16x16x32_bf16 v[100:103], v[196:199], a[236:239], v[100:103]
    s_waitcnt vmcnt(33)
    v_mfma_f32_16x16x32_bf16 v[88:91], v[200:203], a[24:27], v[88:91]
    v_mfma_f32_16x16x32_bf16 v[88:91], v[204:207], a[28:31], v[88:91]
    buffer_load_dwordx4 v[116:119], v185, s[48:51], s23 offen offset:2048 sc1
    v_mfma_f32_16x16x32_bf16 v[88:91], v[208:211], a[32:35], v[88:91]
    v_mfma_f32_16x16x32_bf16 v[92:95], v[200:203], a[96:99], v[92:95]
    v_mfma_f32_16x16x32_bf16 v[92:95], v[204:207], a[100:103], v[92:95]
    v_mfma_f32_16x16x32_bf16 v[92:95], v[208:211], a[104:107], v[92:95]
    buffer_load_dwordx4 v[180:183], v185, s[48:51], s23 offen offset:3072 sc1
    v_mfma_f32_16x16x32_bf16 v[96:99], v[200:203], a[168:171], v[96:99]
    v_mfma_f32_16x16x32_bf16 v[96:99], v[204:207], a[172:175], v[96:99]
    v_mfma_f32_16x16x32_bf16 v[96:99], v[208:211], a[176:179], v[96:99]
    v_mfma_f32_16x16x32_bf16 v[100:103], v[200:203], a[240:243], v[100:103]
    buffer_load_dwordx4 v[196:199], v186, s[48:51], s23 offen offset:0 sc1
    v_mfma_f32_16x16x32_bf16 v[100:103], v[204:207], a[244:247], v[100:103]
    v_mfma_f32_16x16x32_bf16 v[100:103], v[208:211], a[248:251], v[100:103]
    s_waitcnt vmcnt(33)
    v_mfma_f32_16x16x32_bf16 v[88:91], v[212:215], a[36:39], v[88:91]
    v_mfma_f32_16x16x32_bf16 v[88:91], v[136:139], a[40:43], v[88:91]
    buffer_load_dwordx4 v[200:203], v186, s[48:51], s23 offen offset:1024 sc1
    v_mfma_f32_16x16x32_bf16 v[88:91], v[140:143], a[44:47], v[88:91]
    v_mfma_f32_16x16x32_bf16 v[92:95], v[212:215], a[108:111], v[92:95]
    v_mfma_f32_16x16x32_bf16 v[92:95], v[136:139], a[112:115], v[92:95]
    v_cvt_pk_bf16_f32 v156, v128, v129
    v_cvt_pk_bf16_f32 v157, v130, v131
    v_mfma_f32_16x16x32_bf16 v[92:95], v[140:143], a[116:119], v[92:95]
    buffer_load_dwordx4 v[204:207], v186, s[48:51], s23 offen offset:2048 sc1
    v_mfma_f32_16x16x32_bf16 v[96:99], v[212:215], a[180:183], v[96:99]
    v_cvt_pk_bf16_f32 v158, v132, v133
    v_cvt_pk_bf16_f32 v159, v134, v135
    v_mfma_f32_16x16x32_bf16 v[96:99], v[136:139], a[184:187], v[96:99]
    s_nop 0
    v_permlane16_swap_b32 v156, v158
    v_mfma_f32_16x16x32_bf16 v[96:99], v[140:143], a[188:191], v[96:99]
    v_permlane16_swap_b32 v157, v159
    v_mfma_f32_16x16x32_bf16 v[100:103], v[212:215], a[252:255], v[100:103]
    buffer_load_dwordx4 v[208:211], v186, s[48:51], s23 offen offset:3072 sc1
    v_mfma_f32_16x16x32_bf16 v[100:103], v[136:139], v[220:223], v[100:103]
    buffer_store_dwordx4 v[156:159], v179, s[72:75], s27 offen sc1
    v_mfma_f32_16x16x32_bf16 v[100:103], v[140:143], v[224:227], v[100:103]
    ds_write_b128 v217, v[156:159]
    s_waitcnt vmcnt(34)
    v_mfma_f32_16x16x32_bf16 v[88:91], v[144:147], a[48:51], v[88:91]
    v_add_u32 v217, v217, v219
    v_mfma_f32_16x16x32_bf16 v[88:91], v[160:163], a[52:55], v[88:91]
    buffer_load_dwordx4 v[212:215], v187, s[48:51], s23 offen offset:0 sc1
    v_mfma_f32_16x16x32_bf16 v[88:91], v[164:167], a[56:59], v[88:91]
    v_mfma_f32_16x16x32_bf16 v[92:95], v[144:147], a[120:123], v[92:95]
    v_mfma_f32_16x16x32_bf16 v[92:95], v[160:163], a[124:127], v[92:95]
    v_mfma_f32_16x16x32_bf16 v[92:95], v[164:167], a[128:131], v[92:95]
    buffer_load_dwordx4 v[136:139], v187, s[48:51], s23 offen offset:1024 sc1
    v_mfma_f32_16x16x32_bf16 v[96:99], v[144:147], a[192:195], v[96:99]
    v_mfma_f32_16x16x32_bf16 v[96:99], v[160:163], a[196:199], v[96:99]
    v_mfma_f32_16x16x32_bf16 v[96:99], v[164:167], a[200:203], v[96:99]
    v_mfma_f32_16x16x32_bf16 v[100:103], v[144:147], v[228:231], v[100:103]
    buffer_load_dwordx4 v[140:143], v187, s[48:51], s23 offen offset:2048 sc1
    v_mfma_f32_16x16x32_bf16 v[100:103], v[160:163], v[232:235], v[100:103]
    v_mfma_f32_16x16x32_bf16 v[100:103], v[164:167], v[236:239], v[100:103]
    s_waitcnt vmcnt(34)
    v_mfma_f32_16x16x32_bf16 v[88:91], v[168:171], a[60:63], v[88:91]
    v_mfma_f32_16x16x32_bf16 v[88:91], v[148:151], a[64:67], v[88:91]
    buffer_load_dwordx4 v[144:147], v187, s[48:51], s23 offen offset:3072 sc1
    v_mfma_f32_16x16x32_bf16 v[120:123], v[4:7], a[68:71], v[88:91]
    v_mfma_f32_16x16x32_bf16 v[92:95], v[168:171], a[132:135], v[92:95]
    v_mfma_f32_16x16x32_bf16 v[92:95], v[148:151], a[136:139], v[92:95]
    v_mfma_f32_16x16x32_bf16 v[124:127], v[4:7], a[140:143], v[92:95]
    buffer_load_dwordx4 v[160:163], v188, s[48:51], s23 offen offset:0 sc1
    v_mfma_f32_16x16x32_bf16 v[96:99], v[168:171], a[204:207], v[96:99]
    s_mov_b32 s74, 268435456
    v_mfma_f32_16x16x32_bf16 v[96:99], v[148:151], a[208:211], v[96:99]
    s_add_u32 s27, s27, 1024
    v_mfma_f32_16x16x32_bf16 v[128:131], v[4:7], a[212:215], v[96:99]
    s_add_u32 s25, s25, 1
    v_mfma_f32_16x16x32_bf16 v[100:103], v[168:171], v[240:243], v[100:103]
    buffer_load_dwordx4 v[164:167], v188, s[48:51], s23 offen offset:1024 sc1
    v_mfma_f32_16x16x32_bf16 v[100:103], v[148:151], v[244:247], v[100:103]
    s_add_u32 s23, s23, 18432
    v_mfma_f32_16x16x32_bf16 v[132:135], v[4:7], v[248:251], v[100:103]
L_ffn_dn_mid_34:
    s_waitcnt vmcnt(30)
    v_mfma_f32_16x16x32_bf16 v[88:91], v[16:19], a[0:3], 0
    v_mfma_f32_16x16x32_bf16 v[88:91], v[20:23], a[4:7], v[88:91]
    buffer_load_dwordx4 v[168:171], v184, s[48:51], s23 offen offset:0 sc1
    v_mfma_f32_16x16x32_bf16 v[88:91], v[24:27], a[8:11], v[88:91]
    v_mfma_f32_16x16x32_bf16 v[92:95], v[16:19], a[72:75], 0
    v_mfma_f32_16x16x32_bf16 v[92:95], v[20:23], a[76:79], v[92:95]
    v_mfma_f32_16x16x32_bf16 v[92:95], v[24:27], a[80:83], v[92:95]
    buffer_load_dwordx4 v[148:151], v184, s[48:51], s23 offen offset:1024 sc1
    v_mfma_f32_16x16x32_bf16 v[96:99], v[16:19], a[144:147], 0
    v_cvt_pk_bf16_f32 v152, v120, v121
    v_cvt_pk_bf16_f32 v153, v122, v123
    v_mfma_f32_16x16x32_bf16 v[96:99], v[20:23], a[148:151], v[96:99]
    v_cvt_pk_bf16_f32 v154, v124, v125
    v_cvt_pk_bf16_f32 v155, v126, v127
    v_mfma_f32_16x16x32_bf16 v[96:99], v[24:27], a[152:155], v[96:99]
    s_nop 0
    v_permlane16_swap_b32 v152, v154
    v_mfma_f32_16x16x32_bf16 v[100:103], v[16:19], a[216:219], 0
    buffer_load_dwordx4 v[4:7], v184, s[48:51], s23 offen offset:2048 sc1
    v_mfma_f32_16x16x32_bf16 v[100:103], v[20:23], a[220:223], v[100:103]
    v_permlane16_swap_b32 v153, v155
    v_mfma_f32_16x16x32_bf16 v[100:103], v[24:27], a[224:227], v[100:103]
    buffer_store_dwordx4 v[152:155], v178, s[72:75], s27 offen sc1
    s_waitcnt vmcnt(31)
    v_mfma_f32_16x16x32_bf16 v[88:91], v[28:31], a[12:15], v[88:91]
    ds_write_b128 v216, v[152:155]
    v_mfma_f32_16x16x32_bf16 v[88:91], v[32:35], a[16:19], v[88:91]
    buffer_load_dwordx4 v[16:19], v184, s[48:51], s23 offen offset:3072 sc1
    v_mfma_f32_16x16x32_bf16 v[88:91], v[36:39], a[20:23], v[88:91]
    v_add_u32 v216, v216, v218
    v_mfma_f32_16x16x32_bf16 v[92:95], v[28:31], a[84:87], v[92:95]
    v_mfma_f32_16x16x32_bf16 v[92:95], v[32:35], a[88:91], v[92:95]
    v_mfma_f32_16x16x32_bf16 v[92:95], v[36:39], a[92:95], v[92:95]
    buffer_load_dwordx4 v[20:23], v185, s[48:51], s23 offen offset:0 sc1
    v_mfma_f32_16x16x32_bf16 v[96:99], v[28:31], a[156:159], v[96:99]
    v_mfma_f32_16x16x32_bf16 v[96:99], v[32:35], a[160:163], v[96:99]
    v_mfma_f32_16x16x32_bf16 v[96:99], v[36:39], a[164:167], v[96:99]
    v_mfma_f32_16x16x32_bf16 v[100:103], v[28:31], a[228:231], v[100:103]
    buffer_load_dwordx4 v[24:27], v185, s[48:51], s23 offen offset:1024 sc1
    v_mfma_f32_16x16x32_bf16 v[100:103], v[32:35], a[232:235], v[100:103]
    v_mfma_f32_16x16x32_bf16 v[100:103], v[36:39], a[236:239], v[100:103]
    s_waitcnt vmcnt(31)
    v_mfma_f32_16x16x32_bf16 v[88:91], v[40:43], a[24:27], v[88:91]
    v_mfma_f32_16x16x32_bf16 v[88:91], v[44:47], a[28:31], v[88:91]
    buffer_load_dwordx4 v[28:31], v185, s[48:51], s23 offen offset:2048 sc1
    v_mfma_f32_16x16x32_bf16 v[88:91], v[48:51], a[32:35], v[88:91]
    v_mfma_f32_16x16x32_bf16 v[92:95], v[40:43], a[96:99], v[92:95]
    v_mfma_f32_16x16x32_bf16 v[92:95], v[44:47], a[100:103], v[92:95]
    v_mfma_f32_16x16x32_bf16 v[92:95], v[48:51], a[104:107], v[92:95]
    buffer_load_dwordx4 v[32:35], v185, s[48:51], s23 offen offset:3072 sc1
    v_mfma_f32_16x16x32_bf16 v[96:99], v[40:43], a[168:171], v[96:99]
    v_mfma_f32_16x16x32_bf16 v[96:99], v[44:47], a[172:175], v[96:99]
    v_mfma_f32_16x16x32_bf16 v[96:99], v[48:51], a[176:179], v[96:99]
    v_mfma_f32_16x16x32_bf16 v[100:103], v[40:43], a[240:243], v[100:103]
    buffer_load_dwordx4 v[36:39], v186, s[48:51], s23 offen offset:0 sc1
    v_mfma_f32_16x16x32_bf16 v[100:103], v[44:47], a[244:247], v[100:103]
    v_mfma_f32_16x16x32_bf16 v[100:103], v[48:51], a[248:251], v[100:103]
    s_waitcnt vmcnt(31)
    s_cmp_lg_u32 s25, 6
    s_cbranch_scc1 L_early_35
    s_waitcnt vmcnt(16)
    s_barrier
    s_cmp_lg_u32 s3, 0
    s_cbranch_scc1 L_early_35
    v_lshlrev_b32 v15, 7, v0
    v_mov_b32 v1, s76
    s_mov_b64 exec, 0xff
    buffer_store_dword v1, v15, s[8:11], s29 offen sc1
    s_mov_b64 exec, -1
L_early_35:
    v_mfma_f32_16x16x32_bf16 v[88:91], v[52:55], a[36:39], v[88:91]
    v_mfma_f32_16x16x32_bf16 v[88:91], v[56:59], a[40:43], v[88:91]
    buffer_load_dwordx4 v[40:43], v186, s[48:51], s23 offen offset:1024 sc1
    v_mfma_f32_16x16x32_bf16 v[88:91], v[60:63], a[44:47], v[88:91]
    v_mfma_f32_16x16x32_bf16 v[92:95], v[52:55], a[108:111], v[92:95]
    v_mfma_f32_16x16x32_bf16 v[92:95], v[56:59], a[112:115], v[92:95]
    v_cvt_pk_bf16_f32 v156, v128, v129
    v_cvt_pk_bf16_f32 v157, v130, v131
    v_mfma_f32_16x16x32_bf16 v[92:95], v[60:63], a[116:119], v[92:95]
    buffer_load_dwordx4 v[44:47], v186, s[48:51], s23 offen offset:2048 sc1
    v_mfma_f32_16x16x32_bf16 v[96:99], v[52:55], a[180:183], v[96:99]
    v_cvt_pk_bf16_f32 v158, v132, v133
    v_cvt_pk_bf16_f32 v159, v134, v135
    v_mfma_f32_16x16x32_bf16 v[96:99], v[56:59], a[184:187], v[96:99]
    s_nop 0
    v_permlane16_swap_b32 v156, v158
    v_mfma_f32_16x16x32_bf16 v[96:99], v[60:63], a[188:191], v[96:99]
    v_permlane16_swap_b32 v157, v159
    v_mfma_f32_16x16x32_bf16 v[100:103], v[52:55], a[252:255], v[100:103]
    buffer_load_dwordx4 v[48:51], v186, s[48:51], s23 offen offset:3072 sc1
    v_mfma_f32_16x16x32_bf16 v[100:103], v[56:59], v[220:223], v[100:103]
    buffer_store_dwordx4 v[156:159], v179, s[72:75], s27 offen sc1
    v_mfma_f32_16x16x32_bf16 v[100:103], v[60:63], v[224:227], v[100:103]
    ds_write_b128 v217, v[156:159]
    s_waitcnt vmcnt(32)
    v_mfma_f32_16x16x32_bf16 v[88:91], v[64:67], a[48:51], v[88:91]
    v_add_u32 v217, v217, v219
    v_mfma_f32_16x16x32_bf16 v[88:91], v[68:71], a[52:55], v[88:91]
    buffer_load_dwordx4 v[52:55], v187, s[48:51], s23 offen offset:0 sc1
    v_mfma_f32_16x16x32_bf16 v[88:91], v[72:75], a[56:59], v[88:91]
    v_mfma_f32_16x16x32_bf16 v[92:95], v[64:67], a[120:123], v[92:95]
    v_mfma_f32_16x16x32_bf16 v[92:95], v[68:71], a[124:127], v[92:95]
    v_mfma_f32_16x16x32_bf16 v[92:95], v[72:75], a[128:131], v[92:95]
    buffer_load_dwordx4 v[56:59], v187, s[48:51], s23 offen offset:1024 sc1
    v_mfma_f32_16x16x32_bf16 v[96:99], v[64:67], a[192:195], v[96:99]
    v_mfma_f32_16x16x32_bf16 v[96:99], v[68:71], a[196:199], v[96:99]
    v_mfma_f32_16x16x32_bf16 v[96:99], v[72:75], a[200:203], v[96:99]
    v_mfma_f32_16x16x32_bf16 v[100:103], v[64:67], v[228:231], v[100:103]
    buffer_load_dwordx4 v[60:63], v187, s[48:51], s23 offen offset:2048 sc1
    v_mfma_f32_16x16x32_bf16 v[100:103], v[68:71], v[232:235], v[100:103]
    v_mfma_f32_16x16x32_bf16 v[100:103], v[72:75], v[236:239], v[100:103]
    s_waitcnt vmcnt(32)
    v_mfma_f32_16x16x32_bf16 v[88:91], v[76:79], a[60:63], v[88:91]
    v_mfma_f32_16x16x32_bf16 v[88:91], v[80:83], a[64:67], v[88:91]
    buffer_load_dwordx4 v[64:67], v187, s[48:51], s23 offen offset:3072 sc1
    v_mfma_f32_16x16x32_bf16 v[120:123], v[84:87], a[68:71], v[88:91]
    v_mfma_f32_16x16x32_bf16 v[92:95], v[76:79], a[132:135], v[92:95]
    v_mfma_f32_16x16x32_bf16 v[92:95], v[80:83], a[136:139], v[92:95]
    v_mfma_f32_16x16x32_bf16 v[124:127], v[84:87], a[140:143], v[92:95]
    buffer_load_dwordx4 v[68:71], v188, s[48:51], s23 offen offset:0 sc1
    v_mfma_f32_16x16x32_bf16 v[96:99], v[76:79], a[204:207], v[96:99]
    s_mov_b32 s74, 268435456
    v_mfma_f32_16x16x32_bf16 v[96:99], v[80:83], a[208:211], v[96:99]
    s_add_u32 s27, s27, 1024
    v_mfma_f32_16x16x32_bf16 v[128:131], v[84:87], a[212:215], v[96:99]
    s_add_u32 s25, s25, 1
    v_mfma_f32_16x16x32_bf16 v[100:103], v[76:79], v[240:243], v[100:103]
    buffer_load_dwordx4 v[72:75], v188, s[48:51], s23 offen offset:1024 sc1
    v_mfma_f32_16x16x32_bf16 v[100:103], v[80:83], v[244:247], v[100:103]
    s_add_u32 s23, s23, 18432
    v_mfma_f32_16x16x32_bf16 v[132:135], v[84:87], v[248:251], v[100:103]
    s_cmp_lt_u32 s25, 7
    s_cbranch_scc1 L_ffn_dn_33
    s_waitcnt vmcnt(33)
    v_mfma_f32_16x16x32_bf16 v[88:91], v[104:107], a[0:3], 0
    v_mfma_f32_16x16x32_bf16 v[88:91], v[108:111], a[4:7], v[88:91]
    buffer_load_dwordx4 v[76:79], v184, s[48:51], s23 offen offset:0 sc1
    v_mfma_f32_16x16x32_bf16 v[88:91], v[112:115], a[8:11], v[88:91]
    v_mfma_f32_16x16x32_bf16 v[92:95], v[104:107], a[72:75], 0
    v_mfma_f32_16x16x32_bf16 v[92:95], v[108:111], a[76:79], v[92:95]
    v_mfma_f32_16x16x32_bf16 v[92:95], v[112:115], a[80:83], v[92:95]
    buffer_load_dwordx4 v[80:83], v184, s[48:51], s23 offen offset:1024 sc1
    v_mfma_f32_16x16x32_bf16 v[96:99], v[104:107], a[144:147], 0
    v_cvt_pk_bf16_f32 v152, v120, v121
    v_cvt_pk_bf16_f32 v153, v122, v123
    v_mfma_f32_16x16x32_bf16 v[96:99], v[108:111], a[148:151], v[96:99]
    v_cvt_pk_bf16_f32 v154, v124, v125
    v_cvt_pk_bf16_f32 v155, v126, v127
    v_mfma_f32_16x16x32_bf16 v[96:99], v[112:115], a[152:155], v[96:99]
    s_nop 0
    v_permlane16_swap_b32 v152, v154
    v_mfma_f32_16x16x32_bf16 v[100:103], v[104:107], a[216:219], 0
    buffer_load_dwordx4 v[84:87], v184, s[48:51], s23 offen offset:2048 sc1
    v_mfma_f32_16x16x32_bf16 v[100:103], v[108:111], a[220:223], v[100:103]
    v_permlane16_swap_b32 v153, v155
    v_mfma_f32_16x16x32_bf16 v[100:103], v[112:115], a[224:227], v[100:103]
    buffer_store_dwordx4 v[152:155], v178, s[72:75], s27 offen sc1
    s_waitcnt vmcnt(34)
    v_mfma_f32_16x16x32_bf16 v[88:91], v[116:119], a[12:15], v[88:91]
    ds_write_b128 v216, v[152:155]
    v_mfma_f32_16x16x32_bf16 v[88:91], v[180:183], a[16:19], v[88:91]
    v_add_u32 v216, v216, v218
    v_cvt_pk_bf16_f32 v156, v128, v129
    v_mfma_f32_16x16x32_bf16 v[88:91], v[196:199], a[20:23], v[88:91]
    v_cvt_pk_bf16_f32 v157, v130, v131
    v_cvt_pk_bf16_f32 v158, v132, v133
    s_load_dwordx8 s[56:63], s[38:39], 0 glc
    v_mfma_f32_16x16x32_bf16 v[92:95], v[116:119], a[84:87], v[92:95]
    v_cvt_pk_bf16_f32 v159, v134, v135
    v_mfma_f32_16x16x32_bf16 v[92:95], v[180:183], a[88:91], v[92:95]
    s_nop 0
    v_permlane16_swap_b32 v156, v158
    v_mfma_f32_16x16x32_bf16 v[92:95], v[196:199], a[92:95], v[92:95]
    v_permlane16_swap_b32 v157, v159
    v_mfma_f32_16x16x32_bf16 v[96:99], v[116:119], a[156:159], v[96:99]
    buffer_store_dwordx4 v[156:159], v179, s[72:75], s27 offen sc1
    v_mfma_f32_16x16x32_bf16 v[96:99], v[180:183], a[160:163], v[96:99]
    ds_write_b128 v217, v[156:159]
    v_mfma_f32_16x16x32_bf16 v[96:99], v[196:199], a[164:167], v[96:99]
    v_add_u32 v217, v217, v219
    v_mfma_f32_16x16x32_bf16 v[100:103], v[116:119], a[228:231], v[100:103]
    v_mfma_f32_16x16x32_bf16 v[100:103], v[180:183], a[232:235], v[100:103]
    v_mfma_f32_16x16x32_bf16 v[100:103], v[196:199], a[236:239], v[100:103]
    s_waitcnt vmcnt(32)
    s_mov_b32 s6, 0
L_epoll_36:
    s_waitcnt lgkmcnt(0)
    s_xor_b64 s[56:57], s[56:57], s[76:77]
    s_xor_b64 s[58:59], s[58:59], s[76:77]
    s_xor_b64 s[60:61], s[60:61], s[76:77]
    s_xor_b64 s[62:63], s[62:63], s[76:77]
    s_or_b64 s[56:57], s[56:57], s[58:59]
    s_or_b64 s[60:61], s[60:61], s[62:63]
    s_or_b64 s[56:57], s[56:57], s[60:61]
    s_cbranch_scc0 L_epolled_37
    s_load_dwordx8 s[56:63], s[38:39], 0 glc
    s_add_u32 s6, s6, 1
    s_cmp_lt_u32 s6, 1048576
    s_cbranch_scc1 L_epoll_36
    s_branch L_main_end
L_epolled_37:
    v_mfma_f32_16x16x32_bf16 v[88:91], v[200:203], a[24:27], v[88:91]
    v_mfma_f32_16x16x32_bf16 v[88:91], v[204:207], a[28:31], v[88:91]
    s_add_u32 s7, s40, 1
    s_and_b32 s7, s7, 7
    s_mul_i32 s7, s7, 9216
    s_add_u32 s19, s7, s20
    buffer_load_dwordx4 v[104:107], v172, s[8:11], s19 offen sc1
    v_mfma_f32_16x16x32_bf16 v[88:91], v[208:211], a[32:35], v[88:91]
    v_mfma_f32_16x16x32_bf16 v[92:95], v[200:203], a[96:99], v[92:95]
    v_mfma_f32_16x16x32_bf16 v[92:95], v[204:207], a[100:103], v[92:95]
    v_mfma_f32_16x16x32_bf16 v[92:95], v[208:211], a[104:107], v[92:95]
    buffer_load_dwordx4 v[108:111], v173, s[8:11], s19 offen sc1
    v_mfma_f32_16x16x32_bf16 v[96:99], v[200:203], a[168:171], v[96:99]
    v_mfma_f32_16x16x32_bf16 v[96:99], v[204:207], a[172:175], v[96:99]
    v_mfma_f32_16x16x32_bf16 v[96:99], v[208:211], a[176:179], v[96:99]
    v_mfma_f32_16x16x32_bf16 v[100:103], v[200:203], a[240:243], v[100:103]
    s_add_u32 s7, s40, 2
    s_and_b32 s7, s7, 7
    s_mul_i32 s7, s7, 9216
    s_add_u32 s19, s7, s20
    buffer_load_dwordx4 v[112:115], v172, s[8:11], s19 offen sc1
    v_mfma_f32_16x16x32_bf16 v[100:103], v[204:207], a[244:247], v[100:103]
    v_mfma_f32_16x16x32_bf16 v[100:103], v[208:211], a[248:251], v[100:103]
    s_waitcnt vmcnt(31)
    v_mfma_f32_16x16x32_bf16 v[88:91], v[212:215], a[36:39], v[88:91]
    v_mfma_f32_16x16x32_bf16 v[88:91], v[136:139], a[40:43], v[88:91]
    buffer_load_dwordx4 v[116:119], v173, s[8:11], s19 offen sc1
    v_mfma_f32_16x16x32_bf16 v[88:91], v[140:143], a[44:47], v[88:91]
    v_mfma_f32_16x16x32_bf16 v[92:95], v[212:215], a[108:111], v[92:95]
    v_mfma_f32_16x16x32_bf16 v[92:95], v[136:139], a[112:115], v[92:95]
    v_mfma_f32_16x16x32_bf16 v[92:95], v[140:143], a[116:119], v[92:95]
    s_add_u32 s7, s40, 3
    s_and_b32 s7, s7, 7
    s_mul_i32 s7, s7, 9216
    s_add_u32 s19, s7, s20
    buffer_load_dwordx4 v[180:183], v172, s[8:11], s19 offen sc1
    v_mfma_f32_16x16x32_bf16 v[96:99], v[212:215], a[180:183], v[96:99]
    v_mfma_f32_16x16x32_bf16 v[96:99], v[136:139], a[184:187], v[96:99]
    v_mfma_f32_16x16x32_bf16 v[96:99], v[140:143], a[188:191], v[96:99]
    v_mfma_f32_16x16x32_bf16 v[100:103], v[212:215], a[252:255], v[100:103]
    buffer_load_dwordx4 v[196:199], v173, s[8:11], s19 offen sc1
    v_mfma_f32_16x16x32_bf16 v[100:103], v[136:139], v[220:223], v[100:103]
    v_mfma_f32_16x16x32_bf16 v[100:103], v[140:143], v[224:227], v[100:103]
    s_waitcnt vmcnt(31)
    v_mfma_f32_16x16x32_bf16 v[88:91], v[144:147], a[48:51], v[88:91]
    v_mfma_f32_16x16x32_bf16 v[88:91], v[160:163], a[52:55], v[88:91]
    s_add_u32 s7, s40, 4
    s_and_b32 s7, s7, 7
    s_mul_i32 s7, s7, 9216
    s_add_u32 s19, s7, s20
    buffer_load_dwordx4 v[200:203], v172, s[8:11], s19 offen sc1
    v_mfma_f32_16x16x32_bf16 v[88:91], v[164:167], a[56:59], v[88:91]
    v_mfma_f32_16x16x32_bf16 v[92:95], v[144:147], a[120:123], v[92:95]
    v_mfma_f32_16x16x32_bf16 v[92:95], v[160:163], a[124:127], v[92:95]
    v_mfma_f32_16x16x32_bf16 v[92:95], v[164:167], a[128:131], v[92:95]
    buffer_load_dwordx4 v[204:207], v173, s[8:11], s19 offen sc1
    v_mfma_f32_16x16x32_bf16 v[96:99], v[144:147], a[192:195], v[96:99]
    v_mfma_f32_16x16x32_bf16 v[96:99], v[160:163], a[196:199], v[96:99]
    v_mfma_f32_16x16x32_bf16 v[96:99], v[164:167], a[200:203], v[96:99]
    v_mfma_f32_16x16x32_bf16 v[100:103], v[144:147], v[228:231], v[100:103]
    s_add_u32 s7, s40, 5
    s_and_b32 s7, s7, 7
    s_mul_i32 s7, s7, 9216
    s_add_u32 s19, s7, s20
    buffer_load_dwordx4 v[208:211], v172, s[8:11], s19 offen sc1
    v_mfma_f32_16x16x32_bf16 v[100:103], v[160:163], v[232:235], v[100:103]
    v_mfma_f32_16x16x32_bf16 v[100:103], v[164:167], v[236:239], v[100:103]
    s_waitcnt vmcnt(31)
    v_mfma_f32_16x16x32_bf16 v[88:91], v[168:171], a[60:63], v[88:91]
    v_mfma_f32_16x16x32_bf16 v[88:91], v[148:151], a[64:67], v[88:91]
    buffer_load_dwordx4 v[212:215], v173, s[8:11], s19 offen sc1
    v_mfma_f32_16x16x32_bf16 v[120:123], v[4:7], a[68:71], v[88:91]
    v_mfma_f32_16x16x32_bf16 v[92:95], v[168:171], a[132:135], v[92:95]
    v_mfma_f32_16x16x32_bf16 v[92:95], v[148:151], a[136:139], v[92:95]
    v_mfma_f32_16x16x32_bf16 v[124:127], v[4:7], a[140:143], v[92:95]
    s_add_u32 s7, s40, 6
    s_and_b32 s7, s7, 7
    s_mul_i32 s7, s7, 9216
    s_add_u32 s19, s7, s20
    buffer_load_dwordx4 v[136:139], v172, s[8:11], s19 offen sc1
    v_mfma_f32_16x16x32_bf16 v[96:99], v[168:171], a[204:207], v[96:99]
    s_mov_b32 s74, 268435456
    v_mfma_f32_16x16x32_bf16 v[96:99], v[148:151], a[208:211], v[96:99]
    s_add_u32 s27, s27, 1024
    v_mfma_f32_16x16x32_bf16 v[128:131], v[4:7], a[212:215], v[96:99]
    s_add_u32 s25, s25, 1
    v_mfma_f32_16x16x32_bf16 v[100:103], v[168:171], v[240:243], v[100:103]
    buffer_load_dwordx4 v[140:143], v173, s[8:11], s19 offen sc1
    v_mfma_f32_16x16x32_bf16 v[100:103], v[148:151], v[244:247], v[100:103]
    s_add_u32 s23, s23, 18432
    v_mfma_f32_16x16x32_bf16 v[132:135], v[4:7], v[248:251], v[100:103]
    s_waitcnt vmcnt(30)
    v_mfma_f32_16x16x32_bf16 v[88:91], v[16:19], a[0:3], 0
    v_mfma_f32_16x16x32_bf16 v[88:91], v[20:23], a[4:7], v[88:91]
    s_add_u32 s7, s40, 7
    s_and_b32 s7, s7, 7
    s_mul_i32 s7, s7, 9216
    s_add_u32 s19, s7, s20
    buffer_load_dwordx4 v[144:147], v172, s[8:11], s19 offen sc1
    v_mfma_f32_16x16x32_bf16 v[88:91], v[24:27], a[8:11], v[88:91]
    v_mfma_f32_16x16x32_bf16 v[92:95], v[16:19], a[72:75], 0
    v_mfma_f32_16x16x32_bf16 v[92:95], v[20:23], a[76:79], v[92:95]
    v_mfma_f32_16x16x32_bf16 v[92:95], v[24:27], a[80:83], v[92:95]
    buffer_load_dwordx4 v[160:163], v173, s[8:11], s19 offen sc1
    v_mfma_f32_16x16x32_bf16 v[96:99], v[16:19], a[144:147], 0
    v_cvt_pk_bf16_f32 v152, v120, v121
    v_cvt_pk_bf16_f32 v153, v122, v123
    v_mfma_f32_16x16x32_bf16 v[96:99], v[20:23], a[148:151], v[96:99]
    v_cvt_pk_bf16_f32 v154, v124, v125
    v_cvt_pk_bf16_f32 v155, v126, v127
    v_mfma_f32_16x16x32_bf16 v[96:99], v[24:27], a[152:155], v[96:99]
    s_nop 0
    v_permlane16_swap_b32 v152, v154
    v_mfma_f32_16x16x32_bf16 v[100:103], v[16:19], a[216:219], 0
    v_permlane16_swap_b32 v153, v155
    v_mfma_f32_16x16x32_bf16 v[100:103], v[20:23], a[220:223], v[100:103]
    buffer_store_dwordx4 v[152:155], v178, s[72:75], s27 offen sc1
    v_mfma_f32_16x16x32_bf16 v[100:103], v[24:27], a[224:227], v[100:103]
    ds_write_b128 v216, v[152:155]
    s_waitcnt vmcnt(30)
    v_mfma_f32_16x16x32_bf16 v[88:91], v[28:31], a[12:15], v[88:91]
    v_add_u32 v216, v216, v218
    v_cvt_pk_bf16_f32 v156, v128, v129
    v_mfma_f32_16x16x32_bf16 v[88:91], v[32:35], a[16:19], v[88:91]
    v_cvt_pk_bf16_f32 v157, v130, v131
    v_cvt_pk_bf16_f32 v158, v132, v133
    v_mfma_f32_16x16x32_bf16 v[88:91], v[36:39], a[20:23], v[88:91]
    v_cvt_pk_bf16_f32 v159, v134, v135
    v_mfma_f32_16x16x32_bf16 v[92:95], v[28:31], a[84:87], v[92:95]
    s_nop 0
    v_permlane16_swap_b32 v156, v158
    v_mfma_f32_16x16x32_bf16 v[92:95], v[32:35], a[88:91], v[92:95]
    v_permlane16_swap_b32 v157, v159
    v_mfma_f32_16x16x32_bf16 v[92:95], v[36:39], a[92:95], v[92:95]
    buffer_store_dwordx4 v[156:159], v179, s[72:75], s27 offen sc1
    v_mfma_f32_16x16x32_bf16 v[96:99], v[28:31], a[156:159], v[96:99]
    ds_write_b128 v217, v[156:159]
    v_mfma_f32_16x16x32_bf16 v[96:99], v[32:35], a[160:163], v[96:99]
    v_add_u32 v217, v217, v219
    v_mfma_f32_16x16x32_bf16 v[96:99], v[36:39], a[164:167], v[96:99]
    v_mfma_f32_16x16x32_bf16 v[100:103], v[28:31], a[228:231], v[100:103]
    v_mfma_f32_16x16x32_bf16 v[100:103], v[32:35], a[232:235], v[100:103]
    v_mfma_f32_16x16x32_bf16 v[100:103], v[36:39], a[236:239], v[100:103]
    s_waitcnt vmcnt(28)
    s_waitcnt vmcnt(16)
    s_barrier
    s_cmp_lg_u32 s3, 0
    s_cbranch_scc1 L_early_38
    s_mov_b64 exec, 0xff
    buffer_store_dword v1, v15, s[8:11], s29 offen offset:32 sc1
    s_mov_b64 exec, -1
L_early_38:
    v_mfma_f32_16x16x32_bf16 v[88:91], v[40:43], a[24:27], v[88:91]
    v_mfma_f32_16x16x32_bf16 v[88:91], v[44:47], a[28:31], v[88:91]
    v_mfma_f32_16x16x32_bf16 v[88:91], v[48:51], a[32:35], v[88:91]
    v_mfma_f32_16x16x32_bf16 v[92:95], v[40:43], a[96:99], v[92:95]
    v_mfma_f32_16x16x32_bf16 v[92:95], v[44:47], a[100:103], v[92:95]
    v_mfma_f32_16x16x32_bf16 v[92:95], v[48:51], a[104:107], v[92:95]
    v_mfma_f32_16x16x32_bf16 v[96:99], v[40:43], a[168:171], v[96:99]
    v_mfma_f32_16x16x32_bf16 v[96:99], v[44:47], a[172:175], v[96:99]
    v_mfma_f32_16x16x32_bf16 v[96:99], v[48:51], a[176:179], v[96:99]
    v_mfma_f32_16x16x32_bf16 v[100:103], v[40:43], a[240:243], v[100:103]
    v_mfma_f32_16x16x32_bf16 v[100:103], v[44:47], a[244:247], v[100:103]
    v_mfma_f32_16x16x32_bf16 v[100:103], v[48:51], a[248:251], v[100:103]
    s_waitcnt vmcnt(24)
    v_mfma_f32_16x16x32_bf16 v[88:91], v[52:55], a[36:39], v[88:91]
    v_mfma_f32_16x16x32_bf16 v[88:91], v[56:59], a[40:43], v[88:91]
    v_mfma_f32_16x16x32_bf16 v[88:91], v[60:63], a[44:47], v[88:91]
    v_mfma_f32_16x16x32_bf16 v[92:95], v[52:55], a[108:111], v[92:95]
    v_mfma_f32_16x16x32_bf16 v[92:95], v[56:59], a[112:115], v[92:95]
    v_mfma_f32_16x16x32_bf16 v[92:95], v[60:63], a[116:119], v[92:95]
    v_mfma_f32_16x16x32_bf16 v[96:99], v[52:55], a[180:183], v[96:99]
    v_mfma_f32_16x16x32_bf16 v[96:99], v[56:59], a[184:187], v[96:99]
    v_mfma_f32_16x16x32_bf16 v[96:99], v[60:63], a[188:191], v[96:99]
    v_mfma_f32_16x16x32_bf16 v[100:103], v[52:55], a[252:255], v[100:103]
    v_mfma_f32_16x16x32_bf16 v[100:103], v[56:59], v[220:223], v[100:103]
    v_mfma_f32_16x16x32_bf16 v[100:103], v[60:63], v[224:227], v[100:103]
    s_waitcnt vmcnt(21)
    v_mfma_f32_16x16x32_bf16 v[88:91], v[64:67], a[48:51], v[88:91]
    v_mfma_f32_16x16x32_bf16 v[88:91], v[68:71], a[52:55], v[88:91]
    v_mfma_f32_16x16x32_bf16 v[88:91], v[72:75], a[56:59], v[88:91]
    v_mfma_f32_16x16x32_bf16 v[92:95], v[64:67], a[120:123], v[92:95]
    v_mfma_f32_16x16x32_bf16 v[92:95], v[68:71], a[124:127], v[92:95]
    v_mfma_f32_16x16x32_bf16 v[92:95], v[72:75], a[128:131], v[92:95]
    v_mfma_f32_16x16x32_bf16 v[96:99], v[64:67], a[192:195], v[96:99]
    v_mfma_f32_16x16x32_bf16 v[96:99], v[68:71], a[196:199], v[96:99]
    v_mfma_f32_16x16x32_bf16 v[96:99], v[72:75], a[200:203], v[96:99]
    v_mfma_f32_16x16x32_bf16 v[100:103], v[64:67], v[228:231], v[100:103]
    v_mfma_f32_16x16x32_bf16 v[100:103], v[68:71], v[232:235], v[100:103]
    v_mfma_f32_16x16x32_bf16 v[100:103], v[72:75], v[236:239], v[100:103]
    s_waitcnt vmcnt(18)
    v_mfma_f32_16x16x32_bf16 v[88:91], v[76:79], a[60:63], v[88:91]
    v_mfma_f32_16x16x32_bf16 v[88:91], v[80:83], a[64:67], v[88:91]
    v_mfma_f32_16x16x32_bf16 v[120:123], v[84:87], a[68:71], v[88:91]
    v_mfma_f32_16x16x32_bf16 v[92:95], v[76:79], a[132:135], v[92:95]
    v_mfma_f32_16x16x32_bf16 v[92:95], v[80:83], a[136:139], v[92:95]
    v_mfma_f32_16x16x32_bf16 v[124:127], v[84:87], a[140:143], v[92:95]
    v_mfma_f32_16x16x32_bf16 v[96:99], v[76:79], a[204:207], v[96:99]
    s_mov_b32 s74, 268435456
    v_mfma_f32_16x16x32_bf16 v[96:99], v[80:83], a[208:211], v[96:99]
    s_add_u32 s27, s27, 1024
    v_mfma_f32_16x16x32_bf16 v[128:131], v[84:87], a[212:215], v[96:99]
    s_add_u32 s25, s25, 1
    v_mfma_f32_16x16x32_bf16 v[100:103], v[76:79], v[240:243], v[100:103]
    v_mfma_f32_16x16x32_bf16 v[100:103], v[80:83], v[244:247], v[100:103]
    s_add_u32 s23, s23, 18432
    v_mfma_f32_16x16x32_bf16 v[132:135], v[84:87], v[248:251], v[100:103]
    s_nop 7
    v_cvt_pk_bf16_f32 v152, v120, v121
    v_cvt_pk_bf16_f32 v153, v122, v123
    v_cvt_pk_bf16_f32 v154, v124, v125
    v_cvt_pk_bf16_f32 v155, v126, v127
    v_cvt_pk_bf16_f32 v156, v128, v129
    v_cvt_pk_bf16_f32 v157, v130, v131
    v_cvt_pk_bf16_f32 v158, v132, v133
    v_cvt_pk_bf16_f32 v159, v134, v135
    s_nop 0
    v_permlane16_swap_b32 v152, v154
    v_permlane16_swap_b32 v153, v155
    buffer_store_dwordx4 v[152:155], v178, s[72:75], s27 offen sc1
    s_nop 0
    v_permlane16_swap_b32 v156, v158
    v_permlane16_swap_b32 v157, v159
    buffer_store_dwordx4 v[156:159], v179, s[72:75], s27 offen sc1
    ds_write_b128 v216, v[152:155]
    ds_write_b128 v217, v[156:159]
    s_waitcnt lgkmcnt(0)
    v_lshlrev_b32 v15, 7, v0
    s_lshl_b32 s6, s40, 2
    s_add_u32 s6, s6, s44
    s_add_u32 s6, s6, 65536
    v_mov_b32 v1, s76
    s_mov_b64 vcc, 0xff
    s_waitcnt vmcnt(0)
    s_barrier
    s_cmp_lg_u32 s3, 0
    s_cbranch_scc1 L_pub_39
    s_mov_b64 exec, vcc
    buffer_store_dword v1, v15, s[8:11], s6 offen sc1
L_pub_39:
    s_mov_b64 exec, -1
    s_add_u32 s19, s18, s43
    s_add_u32 s22, s19, 45875200
    s_lshl_b32 s23, s21, 5
    s_add_u32 s23, s23, s43
    s_add_u32 s23, s23, 48431104
    s_cmp_ge_u32 s3, 2
    s_cbranch_scc1 L_late_40
    s_load_dwordx8 s[56:63], s[38:39], 32 glc
L_late_40:
    v_and_b32 v12, 7, v0
    v_lshlrev_b32 v12, 2, v12
    buffer_load_dword v10, v12, s[8:11], s23 offen sc1
    buffer_load_dwordx4 v[92:95], v172, s[8:11], s22 offen sc1
    buffer_load_dwordx4 v[96:99], v173, s[8:11], s22 offen sc1
    buffer_load_dwordx4 v[100:103], v174, s[8:11], s22 offen sc1
    v_min_u32 v13, 9216, v173
    ds_read_b128 v[148:151], v172 offset:4096
    ds_read_b128 v[152:155], v13 offset:4096
    ds_read_b128 v[156:159], v174 offset:4096
    s_lshl_b32 s28, s40, 2
    s_add_u32 s28, s28, s3
    s_mul_i32 s28, s28, 73728
    v_and_b32 v229, 8, v0
    v_lshl_add_u32 v229, v229, 27, v253
    s_mul_i32 s7, s42, 1073741824
    v_add_u32 v3, s7, v253
    v_or_b32 v229, s7, v229
    v_lshlrev_b32 v16, 16, v104
    v_and_b32 v17, s16, v104
    v_lshlrev_b32 v18, 16, v105
    v_and_b32 v19, s16, v105
    v_lshlrev_b32 v20, 16, v106
    v_and_b32 v21, s16, v106
    v_lshlrev_b32 v22, 16, v107
    v_and_b32 v23, s16, v107
    v_lshlrev_b32 v24, 16, v108
    v_and_b32 v25, s16, v108
    v_lshlrev_b32 v26, 16, v109
    v_and_b32 v27, s16, v109
    v_lshlrev_b32 v28, 16, v110
    v_and_b32 v29, s16, v110
    v_lshlrev_b32 v30, 16, v111
    v_and_b32 v31, s16, v111
    s_cmp_ge_u32 s3, 2
    s_cbranch_scc1 L_late_41
    s_mov_b32 s6, 0
L_epoll_43:
    s_waitcnt lgkmcnt(0)
    s_xor_b64 s[56:57], s[56:57], s[76:77]
    s_xor_b64 s[58:59], s[58:59], s[76:77]
    s_xor_b64 s[60:61], s[60:61], s[76:77]
    s_xor_b64 s[62:63], s[62:63], s[76:77]
    s_or_b64 s[56:57], s[56:57], s[58:59]
    s_or_b64 s[60:61], s[60:61], s[62:63]
    s_or_b64 s[56:57], s[56:57], s[60:61]
    s_cbranch_scc0 L_epolled_44
    s_load_dwordx8 s[56:63], s[38:39], 32 glc
    s_add_u32 s6, s6, 1
    s_cmp_lt_u32 s6, 1048576
    s_cbranch_scc1 L_epoll_43
    s_branch L_main_end
L_epolled_44:
    s_add_u32 s7, s40, 1
    s_and_b32 s7, s7, 7
    s_mul_i32 s7, s7, 9216
    s_add_u32 s19, s7, s20
    buffer_load_dwordx4 v[60:63], v174, s[8:11], s19 offen sc1
    s_add_u32 s7, s40, 2
    s_and_b32 s7, s7, 7
    s_mul_i32 s7, s7, 9216
    s_add_u32 s19, s7, s20
    buffer_load_dwordx4 v[64:67], v174, s[8:11], s19 offen sc1
    s_add_u32 s7, s40, 3
    s_and_b32 s7, s7, 7
    s_mul_i32 s7, s7, 9216
    s_add_u32 s19, s7, s20
    buffer_load_dwordx4 v[68:71], v174, s[8:11], s19 offen sc1
    s_add_u32 s7, s40, 4
    s_and_b32 s7, s7, 7
    s_mul_i32 s7, s7, 9216
    s_add_u32 s19, s7, s20
    buffer_load_dwordx4 v[72:75], v174, s[8:11], s19 offen sc1
    s_add_u32 s7, s40, 5
    s_and_b32 s7, s7, 7
    s_mul_i32 s7, s7, 9216
    s_add_u32 s19, s7, s20
    buffer_load_dwordx4 v[76:79], v174, s[8:11], s19 offen sc1
    s_add_u32 s7, s40, 6
    s_and_b32 s7, s7, 7
    s_mul_i32 s7, s7, 9216
    s_add_u32 s19, s7, s20
    buffer_load_dwordx4 v[80:83], v174, s[8:11], s19 offen sc1
    s_add_u32 s7, s40, 7
    s_and_b32 s7, s7, 7
    s_mul_i32 s7, s7, 9216
    s_add_u32 s19, s7, s20
    buffer_load_dwordx4 v[84:87], v174, s[8:11], s19 offen sc1
L_late_41:
    s_cmp_lg_u32 s42, 0
    s_cbranch_scc1 L_nopf_45
    buffer_load_dwordx4 a[0:3], v3, s[8:11], s28 offen offset:0 sc1
    buffer_load_dwordx4 a[4:7], v3, s[8:11], s28 offen offset:1024 sc1
    buffer_load_dwordx4 a[8:11], v3, s[8:11], s28 offen offset:2048 sc1
    buffer_load_dwordx4 a[12:15], v229, s[8:11], s28 offen offset:3072 sc1
    s_add_u32 s28, s28, 4096
    buffer_load_dwordx4 a[16:19], v3, s[8:11], s28 offen offset:0 sc1
    buffer_load_dwordx4 a[20:23], v3, s[8:11], s28 offen offset:1024 sc1
    buffer_load_dwordx4 a[24:27], v3, s[8:11], s28 offen offset:2048 sc1
    buffer_load_dwordx4 a[28:31], v229, s[8:11], s28 offen offset:3072 sc1
L_nopf_45:
    v_lshlrev_b32 v40, 16, v112
    v_and_b32 v41, s16, v112
    v_lshlrev_b32 v42, 16, v113
    v_and_b32 v43, s16, v113
    v_lshlrev_b32 v44, 16, v114
    v_and_b32 v45, s16, v114
    v_lshlrev_b32 v46, 16, v115
    v_and_b32 v47, s16, v115
    v_pk_add_f32 v[16:17], v[16:17], v[40:41]
    v_pk_add_f32 v[18:19], v[18:19], v[42:43]
    v_pk_add_f32 v[20:21], v[20:21], v[44:45]
    v_pk_add_f32 v[22:23], v[22:23], v[46:47]
    v_lshlrev_b32 v40, 16, v116
    v_and_b32 v41, s16, v116
    v_lshlrev_b32 v42, 16, v117
    v_and_b32 v43, s16, v117
    v_lshlrev_b32 v44, 16, v118
    v_and_b32 v45, s16, v118
    v_lshlrev_b32 v46, 16, v119
    v_and_b32 v47, s16, v119
    v_pk_add_f32 v[24:25], v[24:25], v[40:41]
    v_pk_add_f32 v[26:27], v[26:27], v[42:43]
    v_pk_add_f32 v[28:29], v[28:29], v[44:45]
    v_pk_add_f32 v[30:31], v[30:31], v[46:47]
    s_cmp_lg_u32 s42, 0
    s_cbranch_scc1 L_nopf_46
    s_add_u32 s28, s28, 4096
    buffer_load_dwordx4 a[32:35], v3, s[8:11], s28 offen offset:0 sc1
    buffer_load_dwordx4 a[36:39], v3, s[8:11], s28 offen offset:1024 sc1
    buffer_load_dwordx4 a[40:43], v3, s[8:11], s28 offen offset:2048 sc1
    buffer_load_dwordx4 a[44:47], v229, s[8:11], s28 offen offset:3072 sc1
    s_add_u32 s28, s28, 4096
    buffer_load_dwordx4 a[48:51], v3, s[8:11], s28 offen offset:0 sc1
    buffer_load_dwordx4 a[52:55], v3, s[8:11], s28 offen offset:1024 sc1
    buffer_load_dwordx4 a[56:59], v3, s[8:11], s28 offen offset:2048 sc1
    buffer_load_dwordx4 a[60:63], v229, s[8:11], s28 offen offset:3072 sc1
L_nopf_46:
    v_lshlrev_b32 v40, 16, v180
    v_and_b32 v41, s16, v180
    v_lshlrev_b32 v42, 16, v181
    v_and_b32 v43, s16, v181
    v_lshlrev_b32 v44, 16, v182
    v_and_b32 v45, s16, v182
    v_lshlrev_b32 v46, 16, v183
    v_and_b32 v47, s16, v183
    v_pk_add_f32 v[16:17], v[16:17], v[40:41]
    v_pk_add_f32 v[18:19], v[18:19], v[42:43]
    v_pk_add_f32 v[20:21], v[20:21], v[44:45]
    v_pk_add_f32 v[22:23], v[22:23], v[46:47]
    v_lshlrev_b32 v40, 16, v196
    v_and_b32 v41, s16, v196
    v_lshlrev_b32 v42, 16, v197
    v_and_b32 v43, s16, v197
    v_lshlrev_b32 v44, 16, v198
    v_and_b32 v45, s16, v198
    v_lshlrev_b32 v46, 16, v199
    v_and_b32 v47, s16, v199
    v_pk_add_f32 v[24:25], v[24:25], v[40:41]
    v_pk_add_f32 v[26:27], v[26:27], v[42:43]
    v_pk_add_f32 v[28:29], v[28:29], v[44:45]
    v_pk_add_f32 v[30:31], v[30:31], v[46:47]
    v_lshlrev_b32 v40, 16, v200
    v_and_b32 v41, s16, v200
    v_lshlrev_b32 v42, 16, v201
    v_and_b32 v43, s16, v201
    v_lshlrev_b32 v44, 16, v202
    v_and_b32 v45, s16, v202
    v_lshlrev_b32 v46, 16, v203
    v_and_b32 v47, s16, v203
    v_pk_add_f32 v[16:17], v[16:17], v[40:41]
    v_pk_add_f32 v[18:19], v[18:19], v[42:43]
    v_pk_add_f32 v[20:21], v[20:21], v[44:45]
    v_pk_add_f32 v[22:23], v[22:23], v[46:47]
    v_lshlrev_b32 v40, 16, v204
    v_and_b32 v41, s16, v204
    v_lshlrev_b32 v42, 16, v205
    v_and_b32 v43, s16, v205
    v_lshlrev_b32 v44, 16, v206
    v_and_b32 v45, s16, v206
    v_lshlrev_b32 v46, 16, v207
    v_and_b32 v47, s16, v207
    v_pk_add_f32 v[24:25], v[24:25], v[40:41]
    v_pk_add_f32 v[26:27], v[26:27], v[42:43]
    v_pk_add_f32 v[28:29], v[28:29], v[44:45]
    v_pk_add_f32 v[30:31], v[30:31], v[46:47]
    v_lshlrev_b32 v40, 16, v208
    v_and_b32 v41, s16, v208
    v_lshlrev_b32 v42, 16, v209
    v_and_b32 v43, s16, v209
    v_lshlrev_b32 v44, 16, v210
    v_and_b32 v45, s16, v210
    v_lshlrev_b32 v46, 16, v211
    v_and_b32 v47, s16, v211
    v_pk_add_f32 v[16:17], v[16:17], v[40:41]
    v_pk_add_f32 v[18:19], v[18:19], v[42:43]
    v_pk_add_f32 v[20:21], v[20:21], v[44:45]
    v_pk_add_f32 v[22:23], v[22:23], v[46:47]
    v_lshlrev_b32 v40, 16, v212
    v_and_b32 v41, s16, v212
    v_lshlrev_b32 v42, 16, v213
    v_and_b32 v43, s16, v213
    v_lshlrev_b32 v44, 16, v214
    v_and_b32 v45, s16, v214
    v_lshlrev_b32 v46, 16, v215
    v_and_b32 v47, s16, v215
    v_pk_add_f32 v[24:25], v[24:25], v[40:41]
    v_pk_add_f32 v[26:27], v[26:27], v[42:43]
    v_pk_add_f32 v[28:29], v[28:29], v[44:45]
    v_pk_add_f32 v[30:31], v[30:31], v[46:47]
    v_lshlrev_b32 v40, 16, v136
    v_and_b32 v41, s16, v136
    v_lshlrev_b32 v42, 16, v137
    v_and_b32 v43, s16, v137
    v_lshlrev_b32 v44, 16, v138
    v_and_b32 v45, s16, v138
    v_lshlrev_b32 v46, 16, v139
    v_and_b32 v47, s16, v139
    v_pk_add_f32 v[16:17], v[16:17], v[40:41]
    v_pk_add_f32 v[18:19], v[18:19], v[42:43]
    v_pk_add_f32 v[20:21], v[20:21], v[44:45]
    v_pk_add_f32 v[22:23], v[22:23], v[46:47]
    v_lshlrev_b32 v40, 16, v140
    v_and_b32 v41, s16, v140
    v_lshlrev_b32 v42, 16, v141
    v_and_b32 v43, s16, v141
    v_lshlrev_b32 v44, 16, v142
    v_and_b32 v45, s16, v142
    v_lshlrev_b32 v46, 16, v143
    v_and_b32 v47, s16, v143
    v_pk_add_f32 v[24:25], v[24:25], v[40:41]
    v_pk_add_f32 v[26:27], v[26:27], v[42:43]
    v_pk_add_f32 v[28:29], v[28:29], v[44:45]
    v_pk_add_f32 v[30:31], v[30:31], v[46:47]
    v_lshlrev_b32 v40, 16, v144
    v_and_b32 v41, s16, v144
    v_lshlrev_b32 v42, 16, v145
    v_and_b32 v43, s16, v145
    v_lshlrev_b32 v44, 16, v146
    v_and_b32 v45, s16, v146
    v_lshlrev_b32 v46, 16, v147
    v_and_b32 v47, s16, v147
    v_pk_add_f32 v[16:17], v[16:17], v[40:41]
    v_pk_add_f32 v[18:19], v[18:19], v[42:43]
    v_pk_add_f32 v[20:21], v[20:21], v[44:45]
    v_pk_add_f32 v[22:23], v[22:23], v[46:47]
    v_lshlrev_b32 v40, 16, v160
    v_and_b32 v41, s16, v160
    v_lshlrev_b32 v42, 16, v161
    v_and_b32 v43, s16, v161
    v_lshlrev_b32 v44, 16, v162
    v_and_b32 v45, s16, v162
    v_lshlrev_b32 v46, 16, v163
    v_and_b32 v47, s16, v163
    v_pk_add_f32 v[24:25], v[24:25], v[40:41]
    v_pk_add_f32 v[26:27], v[26:27], v[42:43]
    v_pk_add_f32 v[28:29], v[28:29], v[44:45]
    v_pk_add_f32 v[30:31], v[30:31], v[46:47]
    s_cmp_lg_u32 s3, 3
    s_cbranch_scc1 L_pollout_49
    s_lshl_b32 s7, s40, 7
    s_add_u32 s7, s7, s44
    s_add_u32 s7, s7, 65536
    s_add_u32 s52, s4, s7
    s_addc_u32 s53, s5, 0
    s_mov_b32 s6, 0
L_poll_47:
    s_load_dwordx8 s[56:63], s[52:53], 0 glc
    s_add_u32 s6, s6, 1
    s_waitcnt lgkmcnt(0)
    s_xor_b64 s[56:57], s[56:57], s[76:77]
    s_xor_b64 s[58:59], s[58:59], s[76:77]
    s_xor_b64 s[60:61], s[60:61], s[76:77]
    s_xor_b64 s[62:63], s[62:63], s[76:77]
    s_or_b64 s[56:57], s[56:57], s[58:59]
    s_or_b64 s[60:61], s[60:61], s[62:63]
    s_or_b64 s[56:57], s[56:57], s[60:61]
    s_cbranch_scc0 L_polled_48
    s_cmp_lt_u32 s6, 1048576
    s_cbranch_scc1 L_poll_47
    s_branch L_main_end
L_polled_48:
L_pollout_49:
    s_barrier
    s_cmp_lt_u32 s3, 2
    s_cbranch_scc1 L_late_42
    s_add_u32 s7, s40, 1
    s_and_b32 s7, s7, 7
    s_mul_i32 s7, s7, 9216
    s_add_u32 s19, s7, s20
    buffer_load_dwordx4 v[60:63], v174, s[8:11], s19 offen sc1
    s_add_u32 s7, s40, 2
    s_and_b32 s7, s7, 7
    s_mul_i32 s7, s7, 9216
    s_add_u32 s19, s7, s20
    buffer_load_dwordx4 v[64:67], v174, s[8:11], s19 offen sc1
    s_add_u32 s7, s40, 3
    s_and_b32 s7, s7, 7
    s_mul_i32 s7, s7, 9216
    s_add_u32 s19, s7, s20
    buffer_load_dwordx4 v[68:71], v174, s[8:11], s19 offen sc1
    s_add_u32 s7, s40, 4
    s_and_b32 s7, s7, 7
    s_mul_i32 s7, s7, 9216
    s_add_u32 s19, s7, s20
    buffer_load_dwordx4 v[72:75], v174, s[8:11], s19 offen sc1
    s_add_u32 s7, s40, 5
    s_and_b32 s7, s7, 7
    s_mul_i32 s7, s7, 9216
    s_add_u32 s19, s7, s20
    buffer_load_dwordx4 v[76:79], v174, s[8:11], s19 offen sc1
    s_add_u32 s7, s40, 6
    s_and_b32 s7, s7, 7
    s_mul_i32 s7, s7, 9216
    s_add_u32 s19, s7, s20
    buffer_load_dwordx4 v[80:83], v174, s[8:11], s19 offen sc1
    s_add_u32 s7, s40, 7
    s_and_b32 s7, s7, 7
    s_mul_i32 s7, s7, 9216
    s_add_u32 s19, s7, s20
    buffer_load_dwordx4 v[84:87], v174, s[8:11], s19 offen sc1
L_late_42:
    s_cmp_eq_u32 s3, 0
    s_cselect_b32 s7, 1.0, 0
    s_cselect_b32 s6, -1, 0
    s_waitcnt vmcnt(7) lgkmcnt(0)
    v_and_b32 v152, s6, v152
    v_and_b32 v153, s6, v153
    v_and_b32 v154, s6, v154
    v_and_b32 v155, s6, v155
    v_mul_f32 v11, s7, v10
    v_lshlrev_b32 v40, 16, v92
    v_and_b32 v41, s16, v92
    v_lshlrev_b32 v42, 16, v93
    v_and_b32 v43, s16, v93
    v_lshlrev_b32 v44, 16, v94
    v_and_b32 v45, s16, v94
    v_lshlrev_b32 v46, 16, v95
    v_and_b32 v47, s16, v95
    v_pk_add_f32 v[16:17], v[16:17], v[40:41]
    v_pk_add_f32 v[18:19], v[18:19], v[42:43]
    v_pk_add_f32 v[20:21], v[20:21], v[44:45]
    v_pk_add_f32 v[22:23], v[22:23], v[46:47]
    v_lshlrev_b32 v40, 16, v96
    v_and_b32 v41, s16, v96
    v_lshlrev_b32 v42, 16, v97
    v_and_b32 v43, s16, v97
    v_lshlrev_b32 v44, 16, v98
    v_and_b32 v45, s16, v98
    v_lshlrev_b32 v46, 16, v99
    v_and_b32 v47, s16, v99
    v_pk_add_f32 v[24:25], v[24:25], v[40:41]
    v_pk_add_f32 v[26:27], v[26:27], v[42:43]
    v_pk_add_f32 v[28:29], v[28:29], v[44:45]
    v_pk_add_f32 v[30:31], v[30:31], v[46:47]
    v_lshlrev_b32 v32, 16, v100
    v_and_b32 v33, s16, v100
    v_lshlrev_b32 v34, 16, v101
    v_and_b32 v35, s16, v101
    v_lshlrev_b32 v36, 16, v102
    v_and_b32 v37, s16, v102
    v_lshlrev_b32 v38, 16, v103
    v_and_b32 v39, s16, v103
    v_lshlrev_b32 v40, 16, v148
    v_and_b32 v41, s16, v148
    v_lshlrev_b32 v42, 16, v149
    v_and_b32 v43, s16, v149
    v_lshlrev_b32 v44, 16, v150
    v_and_b32 v45, s16, v150
    v_lshlrev_b32 v46, 16, v151
    v_and_b32 v47, s16, v151
    v_pk_add_f32 v[16:17], v[16:17], v[40:41]
    v_pk_add_f32 v[18:19], v[18:19], v[42:43]
    v_pk_add_f32 v[20:21], v[20:21], v[44:45]
    v_pk_add_f32 v[22:23], v[22:23], v[46:47]
    v_lshlrev_b32 v40, 16, v152
    v_and_b32 v41, s16, v152
    v_lshlrev_b32 v42, 16, v153
    v_and_b32 v43, s16, v153
    v_lshlrev_b32 v44, 16, v154
    v_and_b32 v45, s16, v154
    v_lshlrev_b32 v46, 16, v155
    v_and_b32 v47, s16, v155
    v_pk_add_f32 v[24:25], v[24:25], v[40:41]
    v_pk_add_f32 v[26:27], v[26:27], v[42:43]
    v_pk_add_f32 v[28:29], v[28:29], v[44:45]
    v_pk_add_f32 v[30:31], v[30:31], v[46:47]
    v_lshlrev_b32 v40, 16, v156
    v_and_b32 v41, s16, v156
    v_lshlrev_b32 v42, 16, v157
    v_and_b32 v43, s16, v157
    v_lshlrev_b32 v44, 16, v158
    v_and_b32 v45, s16, v158
    v_lshlrev_b32 v46, 16, v159
    v_and_b32 v47, s16, v159
    v_pk_add_f32 v[32:33], v[32:33], v[40:41]
    v_pk_add_f32 v[34:35], v[34:35], v[42:43]
    v_pk_add_f32 v[36:37], v[36:37], v[44:45]
    v_pk_add_f32 v[38:39], v[38:39], v[46:47]
    v_pk_add_f32 v[16:17], v[16:17], v[10:11] op_sel_hi:[1,0]
    v_pk_add_f32 v[18:19], v[18:19], v[10:11] op_sel_hi:[1,0]
    v_pk_add_f32 v[20:21], v[20:21], v[10:11] op_sel_hi:[1,0]
    v_pk_add_f32 v[22:23], v[22:23], v[10:11] op_sel_hi:[1,0]
    v_pk_add_f32 v[24:25], v[24:25], v[10:11] op_sel:[0,1] op_sel_hi:[1,1]
    v_pk_add_f32 v[26:27], v[26:27], v[10:11] op_sel:[0,1] op_sel_hi:[1,1]
    v_pk_add_f32 v[28:29], v[28:29], v[10:11] op_sel:[0,1] op_sel_hi:[1,1]
    v_pk_add_f32 v[30:31], v[30:31], v[10:11] op_sel:[0,1] op_sel_hi:[1,1]
    v_pk_add_f32 v[32:33], v[32:33], v[10:11] op_sel_hi:[1,0]
    v_pk_add_f32 v[34:35], v[34:35], v[10:11] op_sel_hi:[1,0]
    v_pk_add_f32 v[36:37], v[36:37], v[10:11] op_sel_hi:[1,0]
    v_pk_add_f32 v[38:39], v[38:39], v[10:11] op_sel_hi:[1,0]
    s_waitcnt vmcnt(6)
    s_add_u32 s28, s28, 4096
    buffer_load_dwordx4 a[64:67], v3, s[8:11], s28 offen offset:0 sc1
    v_lshlrev_b32 v40, 16, v60
    v_and_b32 v41, s16, v60
    v_lshlrev_b32 v42, 16, v61
    v_and_b32 v43, s16, v61
    v_lshlrev_b32 v44, 16, v62
    v_and_b32 v45, s16, v62
    v_lshlrev_b32 v46, 16, v63
    v_and_b32 v47, s16, v63
    v_pk_add_f32 v[32:33], v[32:33], v[40:41]
    v_pk_add_f32 v[34:35], v[34:35], v[42:43]
    v_pk_add_f32 v[36:37], v[36:37], v[44:45]
    v_pk_add_f32 v[38:39], v[38:39], v[46:47]
    s_waitcnt vmcnt(6)
    buffer_load_dwordx4 a[68:71], v3, s[8:11], s28 offen offset:1024 sc1
    v_lshlrev_b32 v40, 16, v64
    v_and_b32 v41, s16, v64
    v_lshlrev_b32 v42, 16, v65
    v_and_b32 v43, s16, v65
    v_lshlrev_b32 v44, 16, v66
    v_and_b32 v45, s16, v66
    v_lshlrev_b32 v46, 16, v67
    v_and_b32 v47, s16, v67
    v_pk_add_f32 v[32:33], v[32:33], v[40:41]
    v_pk_add_f32 v[34:35], v[34:35], v[42:43]
    v_pk_add_f32 v[36:37], v[36:37], v[44:45]
    v_pk_add_f32 v[38:39], v[38:39], v[46:47]
    s_waitcnt vmcnt(6)
    buffer_load_dwordx4 a[72:75], v3, s[8:11], s28 offen offset:2048 sc1
    v_lshlrev_b32 v40, 16, v68
    v_and_b32 v41, s16, v68
    v_lshlrev_b32 v42, 16, v69
    v_and_b32 v43, s16, v69
    v_lshlrev_b32 v44, 16, v70
    v_and_b32 v45, s16, v70
    v_lshlrev_b32 v46, 16, v71
    v_and_b32 v47, s16, v71
    v_pk_add_f32 v[32:33], v[32:33], v[40:41]
    v_pk_add_f32 v[34:35], v[34:35], v[42:43]
    v_pk_add_f32 v[36:37], v[36:37], v[44:45]
    v_pk_add_f32 v[38:39], v[38:39], v[46:47]
    s_waitcnt vmcnt(6)
    buffer_load_dwordx4 a[76:79], v229, s[8:11], s28 offen offset:3072 sc1
    v_lshlrev_b32 v40, 16, v72
    v_and_b32 v41, s16, v72
    v_lshlrev_b32 v42, 16, v73
    v_and_b32 v43, s16, v73
    v_lshlrev_b32 v44, 16, v74
    v_and_b32 v45, s16, v74
    v_lshlrev_b32 v46, 16, v75
    v_and_b32 v47, s16, v75
    v_pk_add_f32 v[32:33], v[32:33], v[40:41]
    v_pk_add_f32 v[34:35], v[34:35], v[42:43]
    v_pk_add_f32 v[36:37], v[36:37], v[44:45]
    v_pk_add_f32 v[38:39], v[38:39], v[46:47]
    s_waitcnt vmcnt(6)
    s_add_u32 s28, s28, 4096
    buffer_load_dwordx4 a[80:83], v3, s[8:11], s28 offen offset:0 sc1
    v_lshlrev_b32 v40, 16, v76
    v_and_b32 v41, s16, v76
    v_lshlrev_b32 v42, 16, v77
    v_and_b32 v43, s16, v77
    v_lshlrev_b32 v44, 16, v78
    v_and_b32 v45, s16, v78
    v_lshlrev_b32 v46, 16, v79
    v_and_b32 v47, s16, v79
    v_pk_add_f32 v[32:33], v[32:33], v[40:41]
    v_pk_add_f32 v[34:35], v[34:35], v[42:43]
    v_pk_add_f32 v[36:37], v[36:37], v[44:45]
    v_pk_add_f32 v[38:39], v[38:39], v[46:47]
    s_waitcnt vmcnt(6)
    buffer_load_dwordx4 a[84:87], v3, s[8:11], s28 offen offset:1024 sc1
    v_lshlrev_b32 v40, 16, v80
    v_and_b32 v41, s16, v80
    v_lshlrev_b32 v42, 16, v81
    v_and_b32 v43, s16, v81
    v_lshlrev_b32 v44, 16, v82
    v_and_b32 v45, s16, v82
    v_lshlrev_b32 v46, 16, v83
    v_and_b32 v47, s16, v83
    v_pk_add_f32 v[32:33], v[32:33], v[40:41]
    v_pk_add_f32 v[34:35], v[34:35], v[42:43]
    v_pk_add_f32 v[36:37], v[36:37], v[44:45]
    v_pk_add_f32 v[38:39], v[38:39], v[46:47]
    s_waitcnt vmcnt(6)
    buffer_load_dwordx4 a[88:91], v3, s[8:11], s28 offen offset:2048 sc1
    v_lshlrev_b32 v40, 16, v84
    v_and_b32 v41, s16, v84
    v_lshlrev_b32 v42, 16, v85
    v_and_b32 v43, s16, v85
    v_lshlrev_b32 v44, 16, v86
    v_and_b32 v45, s16, v86
    v_lshlrev_b32 v46, 16, v87
    v_and_b32 v47, s16, v87
    v_pk_add_f32 v[32:33], v[32:33], v[40:41]
    v_pk_add_f32 v[34:35], v[34:35], v[42:43]
    v_pk_add_f32 v[36:37], v[36:37], v[44:45]
    v_pk_add_f32 v[38:39], v[38:39], v[46:47]
    buffer_load_dwordx4 a[92:95], v229, s[8:11], s28 offen offset:3072 sc1
    v_cvt_pk_bf16_f32 v120, v16, v17
    v_cvt_pk_bf16_f32 v121, v18, v19
    v_cvt_pk_bf16_f32 v122, v20, v21
    v_cvt_pk_bf16_f32 v123, v22, v23
    v_cvt_pk_bf16_f32 v124, v24, v25
    v_cvt_pk_bf16_f32 v125, v26, v27
    v_cvt_pk_bf16_f32 v126, v28, v29
    v_cvt_pk_bf16_f32 v127, v30, v31
    v_cvt_pk_bf16_f32 v128, v32, v33
    v_cvt_pk_bf16_f32 v129, v34, v35
    v_cvt_pk_bf16_f32 v130, v36, v37
    v_cvt_pk_bf16_f32 v131, v38, v39
    s_cmp_lg_u32 s42, 0
    s_cbranch_scc1 L_main_last
    s_add_u32 s19, s18, 53215232
    s_add_u32 s20, s18, 48496640
    s_lshl_b32 s22, s21, 7
    s_add_u32 s22, s22, 57933824
    buffer_store_dwordx4 v[120:123], v172, s[8:11], s19 offen sc1
    buffer_store_dwordx4 v[124:127], v173, s[8:11], s19 offen sc1
    buffer_store_dwordx4 v[128:131], v174, s[8:11], s19 offen sc1
    s_mov_b32 s17, 0x3f803f80
    v_mov_b32 v8, 0
    v_mov_b32 v9, 0
    v_mov_b32 v10, 0
    v_mov_b32 v11, 0
    v_dot2c_f32_bf16 v8, s17, v120
    v_dot2c_f32_bf16 v9, v120, v120
    v_dot2c_f32_bf16 v10, s17, v121
    v_dot2c_f32_bf16 v11, v121, v121
    v_dot2c_f32_bf16 v8, s17, v122
    v_dot2c_f32_bf16 v9, v122, v122
    v_dot2c_f32_bf16 v10, s17, v123
    v_dot2c_f32_bf16 v11, v123, v123
    v_dot2c_f32_bf16 v8, s17, v124
    v_dot2c_f32_bf16 v9, v124, v124
    v_dot2c_f32_bf16 v10, s17, v125
    v_dot2c_f32_bf16 v11, v125, v125
    v_dot2c_f32_bf16 v8, s17, v126
    v_dot2c_f32_bf16 v9, v126, v126
    v_dot2c_f32_bf16 v10, s17, v127
    v_dot2c_f32_bf16 v11, v127, v127
    v_dot2c_f32_bf16 v8, s17, v128
    v_dot2c_f32_bf16 v9, v128, v128
    v_dot2c_f32_bf16 v10, s17, v129
    v_dot2c_f32_bf16 v11, v129, v129
    v_dot2c_f32_bf16 v8, s17, v130
    v_dot2c_f32_bf16 v9, v130, v130
    v_dot2c_f32_bf16 v10, s17, v131
    v_dot2c_f32_bf16 v11, v131, v131
    v_and_b32 v12, 7, v0
    v_lshlrev_b32 v12, 3, v12
    s_lshl_b32 s7, s3, 6
    v_add_u32 v13, s7, v12
    v_pk_add_f32 v[8:9], v[8:9], v[10:11]
    s_nop 1
    v_add_f32_dpp v8, v8, v8 row_ror:8 row_mask:0xf bank_mask:0xf
    v_add_f32_dpp v9, v9, v9 row_ror:8 row_mask:0xf bank_mask:0xf
    v_mov_b32 v10, v8
    v_mov_b32 v11, v9
    s_nop 1
    v_permlane32_swap_b32 v10, v8
    v_permlane32_swap_b32 v11, v9
    v_add_f32 v8, v8, v10
    v_add_f32 v9, v9, v11
    v_mov_b32 v10, v8
    v_mov_b32 v11, v9
    s_nop 1
    v_permlane16_swap_b32 v10, v8
    v_permlane16_swap_b32 v11, v9
    v_add_f32 v8, v8, v10
    v_add_f32 v9, v9, v11
    ds_write_b64 v13, v[8:9]
    s_waitcnt lgkmcnt(0)
    s_barrier
    ds_read_b64 v[40:41], v12 offset:0
    ds_read_b64 v[42:43], v12 offset:64
    ds_read_b64 v[44:45], v12 offset:128
    ds_read_b64 v[46:47], v12 offset:192
    s_waitcnt lgkmcnt(0)
    v_pk_add_f32 v[40:41], v[40:41], v[42:43]
    v_pk_add_f32 v[44:45], v[44:45], v[46:47]
    v_pk_add_f32 v[8:9], v[40:41], v[44:45]
    v_mul_f32 v8, 0x3ae38e39, v8
    v_mul_f32 v9, 0x3ae38e39, v9
    v_fma_f32 v9, -v8, v8, v9
    v_max_f32 v9, 0, v9
    v_add_f32 v9, 0x3727c5ac, v9
    v_rsq_f32 v10, v9
    s_nop 0
    v_mul_f32 v12, v8, v10
    v_mov_b32 v11, v10
    v_sub_f32 v12, 0, v12
    v_mov_b32 v13, v12
    s_cmp_eq_u32 s3, 0
    s_cselect_b32 s7, 32, 0
    v_lshlrev_b32 v14, 2, v0
    v_cmp_gt_u32 vcc, s7, v0
    v_mov_b32 v9, 1073741824
    s_nop 0
    v_cndmask_b32 v14, v9, v14, vcc
    buffer_store_dword v8, v14, s[8:11], s22 offen sc1
    v_lshlrev_b32 v40, 16, v120
    v_and_b32 v41, s16, v120
    v_lshlrev_b32 v42, 16, v121
    v_and_b32 v43, s16, v121
    v_lshlrev_b32 v44, 16, v122
    v_and_b32 v45, s16, v122
    v_lshlrev_b32 v46, 16, v123
    v_and_b32 v47, s16, v123
    v_pk_fma_f32 v[40:41], v[40:41], v[10:11], v[12:13]
    v_pk_fma_f32 v[42:43], v[42:43], v[10:11], v[12:13]
    v_pk_fma_f32 v[44:45], v[44:45], v[10:11], v[12:13]
    v_pk_fma_f32 v[46:47], v[46:47], v[10:11], v[12:13]
    v_cvt_pk_bf16_f32 v48, v40, v41
    v_cvt_pk_bf16_f32 v49, v42, v43
    v_cvt_pk_bf16_f32 v50, v44, v45
    v_cvt_pk_bf16_f32 v51, v46, v47
    v_lshlrev_b32 v40, 16, v124
    v_and_b32 v41, s16, v124
    v_lshlrev_b32 v42, 16, v125
    v_and_b32 v43, s16, v125
    v_lshlrev_b32 v44, 16, v126
    v_and_b32 v45, s16, v126
    v_lshlrev_b32 v46, 16, v127
    v_and_b32 v47, s16, v127
    v_pk_fma_f32 v[40:41], v[40:41], v[10:11], v[12:13]
    v_pk_fma_f32 v[42:43], v[42:43], v[10:11], v[12:13]
    v_pk_fma_f32 v[44:45], v[44:45], v[10:11], v[12:13]
    v_pk_fma_f32 v[46:47], v[46:47], v[10:11], v[12:13]
    v_cvt_pk_bf16_f32 v52, v40, v41
    v_cvt_pk_bf16_f32 v53, v42, v43
    v_cvt_pk_bf16_f32 v54, v44, v45
    v_cvt_pk_bf16_f32 v55, v46, v47
    v_lshlrev_b32 v40, 16, v128
    v_and_b32 v41, s16, v128
    v_lshlrev_b32 v42, 16, v129
    v_and_b32 v43, s16, v129
    v_lshlrev_b32 v44, 16, v130
    v_and_b32 v45, s16, v130
    v_lshlrev_b32 v46, 16, v131
    v_and_b32 v47, s16, v131
    v_pk_fma_f32 v[40:41], v[40:41], v[10:11], v[12:13]
    v_pk_fma_f32 v[42:43], v[42:43], v[10:11], v[12:13]
    v_pk_fma_f32 v[44:45], v[44:45], v[10:11], v[12:13]
    v_pk_fma_f32 v[46:47], v[46:47], v[10:11], v[12:13]
    v_cvt_pk_bf16_f32 v56, v40, v41
    v_cvt_pk_bf16_f32 v57, v42, v43
    v_cvt_pk_bf16_f32 v58, v44, v45
    v_cvt_pk_bf16_f32 v59, v46, v47
    buffer_store_dwordx4 v[48:51], v172, s[8:11], s20 offen sc1
    buffer_store_dwordx4 v[52:55], v173, s[8:11], s20 offen sc1
    buffer_store_dwordx4 v[56:59], v174, s[8:11], s20 offen sc1
    v_lshlrev_b32 v15, 7, v0
    s_lshl_b32 s6, s40, 2
    s_add_u32 s6, s6, s44
    s_add_u32 s6, s6, 98304
    v_mov_b32 v1, s76
    s_mov_b64 vcc, 0xff
    v_lshrrev_b32 v14, 3, v0
    v_lshl_add_u32 v15, v14, 3, v15
    s_cmp_ge_u32 s40, 6
    s_cselect_b32 s7, s41, 31
    s_cmp_lt_u32 s7, 31
    s_cmov_b64 vcc, 0xffff
    s_waitcnt vmcnt(0)
    s_barrier
    s_cmp_lg_u32 s3, 0
    s_cbranch_scc1 L_pub_50
    s_mov_b64 exec, vcc
    buffer_store_dword v1, v15, s[8:11], s6 offen sc1
L_pub_50:
    s_mov_b64 exec, -1
    s_add_u32 s28, s28, 4096
    buffer_load_dwordx4 a[96:99], v3, s[8:11], s28 offen offset:0 sc1
    buffer_load_dwordx4 a[100:103], v3, s[8:11], s28 offen offset:1024 sc1
    buffer_load_dwordx4 a[104:107], v3, s[8:11], s28 offen offset:2048 sc1
    buffer_load_dwordx4 a[108:111], v229, s[8:11], s28 offen offset:3072 sc1
    s_add_u32 s28, s28, 4096
    buffer_load_dwordx4 a[112:115], v3, s[8:11], s28 offen offset:0 sc1
    buffer_load_dwordx4 a[116:119], v3, s[8:11], s28 offen offset:1024 sc1
    buffer_load_dwordx4 a[120:123], v3, s[8:11], s28 offen offset:2048 sc1
    buffer_load_dwordx4 a[124:127], v229, s[8:11], s28 offen offset:3072 sc1
    s_add_u32 s28, s28, 4096
    buffer_load_dwordx4 a[128:131], v3, s[8:11], s28 offen offset:0 sc1
    buffer_load_dwordx4 a[132:135], v3, s[8:11], s28 offen offset:1024 sc1
    buffer_load_dwordx4 a[136:139], v3, s[8:11], s28 offen offset:2048 sc1
    buffer_load_dwordx4 a[140:143], v229, s[8:11], s28 offen offset:3072 sc1
    s_add_u32 s28, s28, 4096
    s_mov_b32 s42, 1
    s_mov_b32 s43, 9699328
    s_add_u32 s44, s44, 131072
    s_branch L_main_layer
L_main_last:
    buffer_store_dwordx4 v[120:123], v175, s[12:15], s18 offen sc0 sc1
    buffer_store_dwordx4 v[124:127], v176, s[12:15], s18 offen sc0 sc1
    buffer_store_dwordx4 v[128:131], v177, s[12:15], s18 offen sc0 sc1
    s_or_b32 s7, s40, s41
    s_or_b32 s7, s7, s3
    s_cbranch_scc1 L_done_51
    v_mov_b32 v1, s76
    s_mov_b32 s7, 19660800
    s_mov_b64 exec, 1
    buffer_store_dword v1, off, s[8:11], s7 sc1
    s_mov_b64 exec, -1
L_done_51:
L_main_end:
    s_endpgm
L_main_code_end:
.section .rodata,"a"
.p2align 6
.amdhsa_kernel interleave_layers__sliding_local_dilated__glu_gated_geglu__prompt_kernel
.amdhsa_next_free_vgpr 512
.amdhsa_next_free_sgpr 102
.amdhsa_accum_offset 256
.amdhsa_group_segment_fixed_size 0
.amdhsa_kernarg_size 80
.amdhsa_user_sgpr_count 2
.amdhsa_user_sgpr_kernarg_segment_ptr 1
.amdhsa_system_sgpr_workgroup_id_x 1
.amdhsa_float_denorm_mode_32 3
.amdhsa_float_denorm_mode_16_64 3
.end_amdhsa_kernel
```

```asm
; @launch grid=(256,1,1) block=(256,1,1) lds=163840
.amdgcn_target "amdgcn-amd-amdhsa--gfx950"
.text
.globl interleave_layers__sliding_local_dilated__glu_gated_geglu__prompt_kernel
.p2align 8
.type interleave_layers__sliding_local_dilated__glu_gated_geglu__prompt_kernel,@function
interleave_layers__sliding_local_dilated__glu_gated_geglu__prompt_kernel:
    s_cmp_ge_u32 s2, 256
    s_cbranch_scc1 L_main_end
    s_load_dwordx2 s[4:5], s[0:1], 72
    s_load_dwordx4 s[16:19], s[0:1], 0
    s_load_dwordx2 s[22:23], s[0:1], 16
    s_load_dwordx8 s[24:31], s[0:1], 32
    s_getpc_b64 s[96:97]
L_main_pc:
    s_sub_u32 s96, s96, L_main_pc-interleave_layers__sliding_local_dilated__glu_gated_geglu__prompt_kernel
    s_subb_u32 s97, s97, 0
    s_and_b32 s97, s97, 0xffff
    s_mov_b32 s98, L_main_code_end-interleave_layers__sliding_local_dilated__glu_gated_geglu__prompt_kernel
    s_mov_b32 s99, 0x20000
    s_lshr_b32 s7, s2, 3
    s_lshl_b32 s7, s7, 11
    v_lshl_add_u32 v253, v0, 3, s7
    buffer_load_dwordx2 v[2:3], v253, s[96:99], 0 offen
    v_lshrrev_b32 v1, 6, v0
    v_and_b32 v0, 63, v0
    v_readfirstlane_b32 s3, v1
    s_waitcnt lgkmcnt(0)
    s_mov_b32 s8, s4
    s_and_b32 s9, s5, 0xffff
    s_mov_b32 s10, 268435456
    s_mov_b32 s11, 0x20000
    s_mov_b32 s7, 19660800
    s_load_dword s76, s[4:5], s7
    s_mov_b64 s[20:21], s[18:19]
    s_mov_b64 s[18:19], s[16:17]
    s_mov_b32 s48, s4
    s_and_b32 s49, s5, 0xffff
    s_mov_b32 s50, 268435456
    s_mov_b32 s51, 0x20000
    s_and_b32 s40, s2, 3
    s_lshl_b32 s40, s40, 1
    s_bfe_u32 s7, s2, 65539
    s_add_u32 s40, s40, s7
    s_bfe_u32 s41, s2, 65538
    s_lshl_b32 s41, s41, 4
    s_lshr_b32 s7, s2, 4
    s_add_u32 s41, s41, s7
    s_mov_b32 s42, 0
    s_mov_b32 s43, 0
    s_lshl_b32 s44, s41, 10
    s_add_u32 s44, s44, 19169280
    v_lshlrev_b32 v253, 4, v0
    s_mov_b32 s12, s18
    s_and_b32 s13, s19, 0xffff
    s_mov_b32 s14, 2359296
    s_mov_b32 s15, 0x20000
    s_mov_b32 s64, s20
    s_and_b32 s65, s21, 0xffff
    s_mov_b32 s66, 1990656
    s_mov_b32 s67, 0x20000
    s_mov_b32 s68, s22
    s_and_b32 s69, s23, 0xffff
    s_mov_b32 s70, 663552
    s_mov_b32 s71, 0x20000
    s_mov_b32 s16, 0xffff0000
    s_lshl_b32 s7, s3, 10
    v_add_u32 v172, s7, v253
    v_add_u32 v174, 5120, v172
    v_and_b32 v178, 7, v0
    v_mul_u32_u24 v178, 1152, v178
    v_lshrrev_b32 v179, 3, v0
    v_lshl_add_u32 v178, v179, 4, v178
    s_lshl_b32 s7, s3, 7
    v_add_u32 v175, s7, v178
    v_add_u32 v177, 640, v175
    s_cmp_eq_u32 s3, 0
    s_mov_b32 s17, 1073741824
    s_cmov_b32 s17, 4096
    v_add_u32 v173, s17, v172
    s_mov_b32 s17, 1073741824
    s_cmov_b32 s17, 512
    v_add_u32 v176, s17, v175
    s_lshl_b32 s21, s41, 3
    s_add_u32 s21, s21, s40
    s_mul_i32 s18, s21, 9216
    buffer_load_dwordx4 v[16:19], v175, s[12:15], s18 offen nt
    buffer_load_dwordx4 v[20:23], v176, s[12:15], s18 offen nt
    buffer_load_dwordx4 v[24:27], v177, s[12:15], s18 offen nt
    s_mov_b32 s12, s30
    s_and_b32 s13, s31, 0xffff
    s_mov_b32 s14, 2359296
    s_mov_b32 s15, 0x20000
    s_lshl_b32 s79, s3, 14
    s_add_u32 s79, s79, 98304
    s_and_b32 s32, s41, 15
    s_lshl_b32 s32, s32, 1
    s_lshr_b32 s7, s41, 4
    s_add_u32 s32, s32, s7
    s_lshl_b32 s36, s32, 3
    s_add_u32 s36, s36, s40
    s_sub_u32 s36, s36, 144
    s_cmp_ge_u32 s32, 18
    s_cbranch_scc1 L_prep_o_1
    s_mul_i32 s35, s32, 110592
    s_mul_i32 s7, s40, 144
    s_and_b32 s46, s7, 127
    s_sub_u32 s7, s7, s46
    s_add_u32 s35, s35, s7
    s_mul_i32 s7, s3, 13824
    s_add_u32 s35, s35, s7
    v_lshrrev_b32 v8, 4, v0
    v_mul_u32_u24 v8, 3456, v8
    v_and_b32 v9, 15, v0
    v_lshl_add_u32 v8, v9, 4, v8
    s_lshl_b32 s34, s3, 10
    s_add_u32 m0, s34, 8192
    s_add_u32 s7, s35, 0
    buffer_load_dwordx4 v8, s[64:67], s7 offen nt lds
    s_add_u32 m0, s34, 12288
    s_add_u32 s7, s35, 55296
    buffer_load_dwordx4 v8, s[64:67], s7 offen nt lds
    s_add_u32 m0, s34, 16384
    s_add_u32 s7, s35, 1152
    buffer_load_dwordx4 v8, s[64:67], s7 offen nt lds
    s_add_u32 m0, s34, 20480
    s_add_u32 s7, s35, 56448
    buffer_load_dwordx4 v8, s[64:67], s7 offen nt lds
    s_add_u32 m0, s34, 24576
    s_add_u32 s7, s35, 2304
    buffer_load_dwordx4 v8, s[64:67], s7 offen nt lds
    s_add_u32 m0, s34, 28672
    s_add_u32 s7, s35, 57600
    buffer_load_dwordx4 v8, s[64:67], s7 offen nt lds
    s_branch L_prep_go_3
L_prep_o_1:
    s_cmp_ge_u32 s36, 54
    s_cbranch_scc1 L_prep_m_2
    s_mul_i32 s33, s36, 349526
    s_lshr_b32 s33, s33, 20
    s_mul_i32 s34, s33, 3
    s_sub_u32 s34, s36, s34
    s_lshl_b32 s7, s33, 2
    s_add_u32 s7, s7, s3
    v_mov_b32 v8, s7
    v_lshrrev_b32 v9, 3, v0
    v_mul_u32_u24 v11, 7282, v8
    v_lshrrev_b32 v11, 16, v11
    v_mul_u32_u24 v12, 9, v11
    v_sub_u32 v12, v8, v12
    v_mul_u32_u24 v11, 72, v11
    v_cmp_eq_u32 vcc, 8, v12
    v_lshrrev_b32 v10, 1, v12
    v_mad_u32_u24 v10, v10, 18, v11
    v_and_b32 v12, 1, v12
    v_lshl_add_u32 v10, v12, 3, v10
    v_add_u32 v10, v10, v9
    v_lshrrev_b32 v12, 1, v9
    v_mad_u32_u24 v11, v12, 18, v11
    v_and_b32 v12, 1, v9
    v_add3_u32 v11, v11, v12, 16
    v_cndmask_b32 v10, v10, v11, vcc
    v_mul_u32_u24 v10, 1152, v10
    v_and_b32 v9, 7, v0
    v_lshl_add_u32 v10, v9, 4, v10
    s_mul_i32 s35, s34, 384
    s_lshl_b32 s6, s3, 10
    s_add_u32 m0, s6, 8192
    s_add_u32 s7, s35, 0
    buffer_load_dwordx4 v10, s[68:71], s7 offen nt lds
    s_add_u32 m0, s6, 12288
    s_add_u32 s7, s35, 128
    buffer_load_dwordx4 v10, s[68:71], s7 offen nt lds
    s_add_u32 m0, s6, 16384
    s_add_u32 s7, s35, 256
    buffer_load_dwordx4 v10, s[68:71], s7 offen nt lds
    s_branch L_prep_go_3
L_prep_m_2:
    s_sub_u32 s37, s36, 54
    s_lshl_b32 s7, s3, 6
    s_add_u32 s37, s37, s7
    s_cmp_ge_u32 s37, 36
    s_cbranch_scc1 L_prep_go_3
    s_lshl_b32 s7, s37, 1
    v_bfe_u32 v8, v0, 3, 1
    v_add_u32 v8, s7, v8
    v_and_b32 v9, 7, v0
    v_mul_u32_u24 v11, 7282, v8
    v_lshrrev_b32 v11, 16, v11
    v_mul_u32_u24 v12, 9, v11
    v_sub_u32 v12, v8, v12
    v_mul_u32_u24 v11, 72, v11
    v_cmp_eq_u32 vcc, 8, v12
    v_lshrrev_b32 v10, 1, v12
    v_mad_u32_u24 v10, v10, 18, v11
    v_and_b32 v12, 1, v12
    v_lshl_add_u32 v10, v12, 3, v10
    v_add_u32 v10, v10, v9
    v_lshrrev_b32 v12, 1, v9
    v_mad_u32_u24 v11, v12, 18, v11
    v_and_b32 v12, 1, v9
    v_add3_u32 v11, v11, v12, 16
    v_cndmask_b32 v10, v10, v11, vcc
    v_mul_u32_u24 v10, 1152, v10
    v_lshrrev_b32 v9, 4, v0
    v_lshl_add_u32 v10, v9, 4, v10
    buffer_load_dwordx4 v[64:67], v10, s[68:71], 0 offen offset:0
    buffer_load_dwordx4 v[68:71], v10, s[68:71], 0 offen offset:64
    buffer_load_dwordx4 v[72:75], v10, s[68:71], 0 offen offset:128
    buffer_load_dwordx4 v[76:79], v10, s[68:71], 0 offen offset:192
    buffer_load_dwordx4 v[80:83], v10, s[68:71], 0 offen offset:256
    buffer_load_dwordx4 v[84:87], v10, s[68:71], 0 offen offset:320
    buffer_load_dwordx4 v[88:91], v10, s[68:71], 0 offen offset:384
    buffer_load_dwordx4 v[92:95], v10, s[68:71], 0 offen offset:448
    buffer_load_dwordx4 v[96:99], v10, s[68:71], 0 offen offset:512
    buffer_load_dwordx4 v[100:103], v10, s[68:71], 0 offen offset:576
    buffer_load_dwordx4 v[104:107], v10, s[68:71], 0 offen offset:640
    buffer_load_dwordx4 v[108:111], v10, s[68:71], 0 offen offset:704
    buffer_load_dwordx4 v[112:115], v10, s[68:71], 0 offen offset:768
    buffer_load_dwordx4 v[116:119], v10, s[68:71], 0 offen offset:832
    buffer_load_dwordx4 v[120:123], v10, s[68:71], 0 offen offset:896
    buffer_load_dwordx4 v[124:127], v10, s[68:71], 0 offen offset:960
    buffer_load_dwordx4 v[128:131], v10, s[68:71], 0 offen offset:1024
    buffer_load_dwordx4 v[132:135], v10, s[68:71], 0 offen offset:1088
L_prep_go_3:
    s_lshl_b32 s7, s32, 2
    s_add_u32 s7, s7, s3
    s_cmp_ge_u32 s7, 72
    s_cbranch_scc1 L_blocks_7
    s_cmp_ge_u32 s7, 54
    s_cselect_b32 s93, 1, 0
    s_cselect_b32 s6, 54, 0
    s_sub_u32 s7, s7, s6
    s_mul_i32 s17, s7, 3
    s_mov_b32 s45, 1
    s_branch L_blocks_8
L_blocks_7:
    s_sub_u32 s7, s7, 72
    s_cmp_ge_u32 s7, 22
    s_cselect_b32 s93, 2, 1
    s_cselect_b32 s6, 22, 0
    s_cselect_b32 s17, 0, 54
    s_sub_u32 s7, s7, s6
    s_mul_i32 s7, s7, 5
    s_add_u32 s17, s17, s7
    s_mov_b32 s45, 3
L_blocks_8:
    s_cmp_eq_u32 s93, 1
    s_cselect_b32 s72, s26, s24
    s_cselect_b32 s73, s27, s25
    s_cmp_eq_u32 s93, 2
    s_cselect_b32 s72, s28, s72
    s_cselect_b32 s73, s29, s73
    s_mov_b32 s92, 73728
    s_cmov_b32 s92, 9216
    s_mov_b32 s47, 1152
    s_cmov_b32 s47, 663552
    s_and_b32 s73, s73, 0xffff
    s_mov_b32 s74, 5308416
    s_mov_b32 s75, 0x20000
    s_mul_i32 s47, s47, s40
    s_add_u32 s7, s17, 0
    s_min_u32 s7, s7, 161
    s_mul_i32 s52, s7, 116509
    s_lshr_b32 s52, s52, 20
    s_mul_i32 s53, s52, 9
    s_sub_u32 s53, s7, s53
    s_mul_i32 s7, s52, s92
    s_lshl_b32 s7, s7, 2
    s_add_u32 s7, s7, s47
    s_lshl_b32 s6, s53, 7
    s_add_u32 s80, s7, s6
    s_add_u32 s7, s17, 1
    s_min_u32 s7, s7, 161
    s_mul_i32 s54, s7, 116509
    s_lshr_b32 s54, s54, 20
    s_mul_i32 s55, s54, 9
    s_sub_u32 s55, s7, s55
    s_mul_i32 s7, s54, s92
    s_lshl_b32 s7, s7, 2
    s_add_u32 s7, s7, s47
    s_lshl_b32 s6, s55, 7
    s_add_u32 s81, s7, s6
    s_add_u32 s7, s17, 2
    s_min_u32 s7, s7, 161
    s_mul_i32 s56, s7, 116509
    s_lshr_b32 s56, s56, 20
    s_mul_i32 s57, s56, 9
    s_sub_u32 s57, s7, s57
    s_mul_i32 s7, s56, s92
    s_lshl_b32 s7, s7, 2
    s_add_u32 s7, s7, s47
    s_lshl_b32 s6, s57, 7
    s_add_u32 s82, s7, s6
    s_add_u32 s7, s17, 0
    s_add_u32 s7, s7, s45
    s_min_u32 s7, s7, 161
    s_mul_i32 s58, s7, 116509
    s_lshr_b32 s58, s58, 20
    s_mul_i32 s59, s58, 9
    s_sub_u32 s59, s7, s59
    s_mul_i32 s7, s58, s92
    s_lshl_b32 s7, s7, 2
    s_add_u32 s7, s7, s47
    s_lshl_b32 s6, s59, 7
    s_add_u32 s83, s7, s6
    s_add_u32 s7, s17, 1
    s_add_u32 s7, s7, s45
    s_min_u32 s7, s7, 161
    s_mul_i32 s60, s7, 116509
    s_lshr_b32 s60, s60, 20
    s_mul_i32 s61, s60, 9
    s_sub_u32 s61, s7, s61
    s_mul_i32 s7, s60, s92
    s_lshl_b32 s7, s7, 2
    s_add_u32 s7, s7, s47
    s_lshl_b32 s6, s61, 7
    s_add_u32 s84, s7, s6
    s_lshr_b32 s7, s92, 3
    v_lshrrev_b32 v224, 3, v0
    v_mul_lo_u32 v224, v224, s7
    v_and_b32 v8, 7, v0
    v_lshl_add_u32 v224, v8, 4, v224
    s_waitcnt lgkmcnt(0)
    s_mul_i32 s76, s76, 0x9e3779b1
    s_add_u32 s76, s76, 0x7f4a7c15
    s_mov_b32 s77, s76
    s_add_u32 m0, s79, 0
    s_mov_b32 s71, s80
    buffer_load_dwordx4 v224, s[72:75], s71 offen nt lds
    s_add_u32 m0, s79, 1024
    s_add_u32 s71, s71, s92
    buffer_load_dwordx4 v224, s[72:75], s71 offen nt lds
    s_add_u32 m0, s79, 2048
    s_add_u32 s71, s71, s92
    buffer_load_dwordx4 v224, s[72:75], s71 offen nt lds
    s_add_u32 m0, s79, 3072
    s_add_u32 s71, s71, s92
    buffer_load_dwordx4 v224, s[72:75], s71 offen nt lds
    s_cmp_lt_u32 s32, 18
    s_cbranch_scc1 L_raw_9
    s_add_u32 m0, s79, 4096
    s_mov_b32 s71, s81
    buffer_load_dwordx4 v224, s[72:75], s71 offen nt lds
    s_add_u32 m0, s79, 5120
    s_add_u32 s71, s71, s92
    buffer_load_dwordx4 v224, s[72:75], s71 offen nt lds
    s_add_u32 m0, s79, 6144
    s_add_u32 s71, s71, s92
    buffer_load_dwordx4 v224, s[72:75], s71 offen nt lds
    s_add_u32 m0, s79, 7168
    s_add_u32 s71, s71, s92
    buffer_load_dwordx4 v224, s[72:75], s71 offen nt lds
    s_add_u32 m0, s79, 8192
    s_mov_b32 s71, s82
    buffer_load_dwordx4 v224, s[72:75], s71 offen nt lds
    s_add_u32 m0, s79, 9216
    s_add_u32 s71, s71, s92
    buffer_load_dwordx4 v224, s[72:75], s71 offen nt lds
    s_add_u32 m0, s79, 10240
    s_add_u32 s71, s71, s92
    buffer_load_dwordx4 v224, s[72:75], s71 offen nt lds
    s_add_u32 m0, s79, 11264
    s_add_u32 s71, s71, s92
    buffer_load_dwordx4 v224, s[72:75], s71 offen nt lds
    s_mul_i32 s68, s40, 1990656
    s_add_u32 s68, s68, 3145728
    s_mul_i32 s6, s52, 349526
    s_lshr_b32 s6, s6, 20
    s_mul_i32 s7, s6, 3
    s_sub_u32 s7, s52, s7
    s_mul_i32 s6, s6, 6
    s_add_u32 s7, s7, s6
    s_mul_i32 s6, s53, 36
    s_add_u32 s7, s7, s6
    s_mul_i32 s6, s93, 3
    s_add_u32 s7, s7, s6
    s_mul_i32 s6, s53, 18
    s_add_u32 s6, s6, s52
    s_add_u32 s6, s6, 324
    s_cmp_eq_u32 s93, 2
    s_cselect_b32 s7, s6, s7
    s_lshl_b32 s7, s7, 10
    s_add_u32 s94, s7, s68
    s_mul_i32 s6, s54, 349526
    s_lshr_b32 s6, s6, 20
    s_mul_i32 s7, s6, 3
    s_sub_u32 s7, s54, s7
    s_mul_i32 s6, s6, 6
    s_add_u32 s7, s7, s6
    s_mul_i32 s6, s55, 36
    s_add_u32 s7, s7, s6
    s_mul_i32 s6, s93, 3
    s_add_u32 s7, s7, s6
    s_mul_i32 s6, s55, 18
    s_add_u32 s6, s6, s54
    s_add_u32 s6, s6, 324
    s_cmp_eq_u32 s93, 2
    s_cselect_b32 s7, s6, s7
    s_lshl_b32 s7, s7, 10
    s_add_u32 s95, s7, s68
    s_mul_i32 s6, s56, 349526
    s_lshr_b32 s6, s6, 20
    s_mul_i32 s7, s6, 3
    s_sub_u32 s7, s56, s7
    s_mul_i32 s6, s6, 6
    s_add_u32 s7, s7, s6
    s_mul_i32 s6, s57, 36
    s_add_u32 s7, s7, s6
    s_mul_i32 s6, s93, 3
    s_add_u32 s7, s7, s6
    s_mul_i32 s6, s57, 18
    s_add_u32 s6, s6, s56
    s_add_u32 s6, s6, 324
    s_cmp_eq_u32 s93, 2
    s_cselect_b32 s7, s6, s7
    s_lshl_b32 s7, s7, 10
    s_add_u32 s85, s7, s68
    s_mul_i32 s6, s58, 349526
    s_lshr_b32 s6, s6, 20
    s_mul_i32 s7, s6, 3
    s_sub_u32 s7, s58, s7
    s_mul_i32 s6, s6, 6
    s_add_u32 s7, s7, s6
    s_mul_i32 s6, s59, 36
    s_add_u32 s7, s7, s6
    s_mul_i32 s6, s93, 3
    s_add_u32 s7, s7, s6
    s_mul_i32 s6, s59, 18
    s_add_u32 s6, s6, s58
    s_add_u32 s6, s6, 324
    s_cmp_eq_u32 s93, 2
    s_cselect_b32 s7, s6, s7
    s_lshl_b32 s7, s7, 10
    s_add_u32 s78, s7, s68
    s_mul_i32 s6, s60, 349526
    s_lshr_b32 s6, s6, 20
    s_mul_i32 s7, s6, 3
    s_sub_u32 s7, s60, s7
    s_mul_i32 s6, s6, 6
    s_add_u32 s7, s7, s6
    s_mul_i32 s6, s61, 36
    s_add_u32 s7, s7, s6
    s_mul_i32 s6, s93, 3
    s_add_u32 s7, s7, s6
    s_mul_i32 s6, s61, 18
    s_add_u32 s6, s6, s60
    s_add_u32 s6, s6, 324
    s_cmp_eq_u32 s93, 2
    s_cselect_b32 s7, s6, s7
    s_lshl_b32 s7, s7, 10
    s_add_u32 s70, s7, s68
    s_waitcnt vmcnt(12)
    s_branch L_raw_10
L_raw_9:
    s_mul_i32 s68, s40, 1990656
    s_add_u32 s68, s68, 3145728
    s_mul_i32 s6, s52, 349526
    s_lshr_b32 s6, s6, 20
    s_mul_i32 s7, s6, 3
    s_sub_u32 s7, s52, s7
    s_mul_i32 s6, s6, 6
    s_add_u32 s7, s7, s6
    s_mul_i32 s6, s53, 36
    s_add_u32 s7, s7, s6
    s_mul_i32 s6, s93, 3
    s_add_u32 s7, s7, s6
    s_mul_i32 s6, s53, 18
    s_add_u32 s6, s6, s52
    s_add_u32 s6, s6, 324
    s_cmp_eq_u32 s93, 2
    s_cselect_b32 s7, s6, s7
    s_lshl_b32 s7, s7, 10
    s_add_u32 s94, s7, s68
    s_mul_i32 s6, s54, 349526
    s_lshr_b32 s6, s6, 20
    s_mul_i32 s7, s6, 3
    s_sub_u32 s7, s54, s7
    s_mul_i32 s6, s6, 6
    s_add_u32 s7, s7, s6
    s_mul_i32 s6, s55, 36
    s_add_u32 s7, s7, s6
    s_mul_i32 s6, s93, 3
    s_add_u32 s7, s7, s6
    s_mul_i32 s6, s55, 18
    s_add_u32 s6, s6, s54
    s_add_u32 s6, s6, 324
    s_cmp_eq_u32 s93, 2
    s_cselect_b32 s7, s6, s7
    s_lshl_b32 s7, s7, 10
    s_add_u32 s95, s7, s68
    s_mul_i32 s6, s56, 349526
    s_lshr_b32 s6, s6, 20
    s_mul_i32 s7, s6, 3
    s_sub_u32 s7, s56, s7
    s_mul_i32 s6, s6, 6
    s_add_u32 s7, s7, s6
    s_mul_i32 s6, s57, 36
    s_add_u32 s7, s7, s6
    s_mul_i32 s6, s93, 3
    s_add_u32 s7, s7, s6
    s_mul_i32 s6, s57, 18
    s_add_u32 s6, s6, s56
    s_add_u32 s6, s6, 324
    s_cmp_eq_u32 s93, 2
    s_cselect_b32 s7, s6, s7
    s_lshl_b32 s7, s7, 10
    s_add_u32 s85, s7, s68
    s_mul_i32 s6, s58, 349526
    s_lshr_b32 s6, s6, 20
    s_mul_i32 s7, s6, 3
    s_sub_u32 s7, s58, s7
    s_mul_i32 s6, s6, 6
    s_add_u32 s7, s7, s6
    s_mul_i32 s6, s59, 36
    s_add_u32 s7, s7, s6
    s_mul_i32 s6, s93, 3
    s_add_u32 s7, s7, s6
    s_mul_i32 s6, s59, 18
    s_add_u32 s6, s6, s58
    s_add_u32 s6, s6, 324
    s_cmp_eq_u32 s93, 2
    s_cselect_b32 s7, s6, s7
    s_lshl_b32 s7, s7, 10
    s_add_u32 s78, s7, s68
    s_mul_i32 s6, s60, 349526
    s_lshr_b32 s6, s6, 20
    s_mul_i32 s7, s6, 3
    s_sub_u32 s7, s60, s7
    s_mul_i32 s6, s6, 6
    s_add_u32 s7, s7, s6
    s_mul_i32 s6, s61, 36
    s_add_u32 s7, s7, s6
    s_mul_i32 s6, s93, 3
    s_add_u32 s7, s7, s6
    s_mul_i32 s6, s61, 18
    s_add_u32 s6, s6, s60
    s_add_u32 s6, s6, 324
    s_cmp_eq_u32 s93, 2
    s_cselect_b32 s7, s6, s7
    s_lshl_b32 s7, s7, 10
    s_add_u32 s70, s7, s68
    s_waitcnt vmcnt(4)
L_raw_10:
    s_barrier
    s_cmp_ge_u32 s32, 18
    s_cbranch_scc1 L_prep_o_4
    s_mul_i32 s7, s3, 36
    s_add_u32 s7, s7, s46
    v_lshrrev_b32 v8, 4, v0
    v_lshlrev_b32 v8, 11, v8
    v_add_u32 v8, s7, v8
    v_and_b32 v9, 15, v0
    v_cmp_gt_u32 s[22:23], 6, v9
    v_lshrrev_b32 v10, 1, v9
    v_min_u32 v10, 2, v10
    v_lshl_add_u32 v10, v10, 13, v8
    v_and_b32 v11, 1, v0
    v_lshl_add_u32 v10, v11, 1, v10
    v_lshl_add_u32 v8, v9, 1, v8
    ds_read_u16 v136, v8 offset:8192
    ds_read_u16 v137, v8 offset:8448
    ds_read_u16 v138, v8 offset:8704
    ds_read_u16 v139, v8 offset:8960
    ds_read_u16 v140, v8 offset:9216
    ds_read_u16 v141, v8 offset:9472
    ds_read_u16 v142, v8 offset:9728
    ds_read_u16 v143, v8 offset:9984
    s_lshl_b32 s33, s40, 2
    s_add_u32 s33, s33, s3
    s_mul_i32 s33, s33, 18
    s_add_u32 s33, s33, s32
    s_lshl_b32 s33, s33, 12
    ds_read_u16 v144, v8 offset:16384
    ds_read_u16 v145, v8 offset:16640
    ds_read_u16 v146, v8 offset:16896
    ds_read_u16 v147, v8 offset:17152
    ds_read_u16 v148, v8 offset:17408
    ds_read_u16 v149, v8 offset:17664
    ds_read_u16 v150, v8 offset:17920
    ds_read_u16 v151, v8 offset:18176
    s_waitcnt lgkmcnt(8)
    v_lshl_or_b32 v32, v137, 16, v136
    v_lshl_or_b32 v33, v139, 16, v138
    v_lshl_or_b32 v34, v141, 16, v140
    v_lshl_or_b32 v35, v143, 16, v142
    buffer_store_dwordx4 v[32:35], v253, s[8:11], s33 offen offset:0 sc1
    ds_read_u16 v152, v8 offset:24576
    ds_read_u16 v153, v8 offset:24832
    ds_read_u16 v154, v8 offset:25088
    ds_read_u16 v155, v8 offset:25344
    ds_read_u16 v156, v8 offset:25600
    ds_read_u16 v157, v8 offset:25856
    ds_read_u16 v158, v8 offset:26112
    ds_read_u16 v159, v8 offset:26368
    s_waitcnt lgkmcnt(8)
    v_lshl_or_b32 v36, v145, 16, v144
    v_lshl_or_b32 v37, v147, 16, v146
    v_lshl_or_b32 v38, v149, 16, v148
    v_lshl_or_b32 v39, v151, 16, v150
    buffer_store_dwordx4 v[36:39], v253, s[8:11], s33 offen offset:1024 sc1
    ds_read_u16 v160, v10 offset:8224
    ds_read_u16 v161, v10 offset:8480
    ds_read_u16 v162, v10 offset:8736
    ds_read_u16 v163, v10 offset:8992
    ds_read_u16 v164, v10 offset:9248
    ds_read_u16 v165, v10 offset:9504
    ds_read_u16 v166, v10 offset:9760
    ds_read_u16 v167, v10 offset:10016
    s_waitcnt lgkmcnt(8)
    v_lshl_or_b32 v40, v153, 16, v152
    v_lshl_or_b32 v41, v155, 16, v154
    v_lshl_or_b32 v42, v157, 16, v156
    v_lshl_or_b32 v43, v159, 16, v158
    buffer_store_dwordx4 v[40:43], v253, s[8:11], s33 offen offset:2048 sc1
    s_waitcnt lgkmcnt(0)
    v_lshl_or_b32 v44, v161, 16, v160
    v_cndmask_b32 v44, 0, v44, s[22:23]
    v_lshl_or_b32 v45, v163, 16, v162
    v_cndmask_b32 v45, 0, v45, s[22:23]
    v_lshl_or_b32 v46, v165, 16, v164
    v_cndmask_b32 v46, 0, v46, s[22:23]
    v_lshl_or_b32 v47, v167, 16, v166
    v_cndmask_b32 v47, 0, v47, s[22:23]
    buffer_store_dwordx4 v[44:47], v253, s[8:11], s33 offen offset:3072 sc1
    s_branch L_prep_done_6
L_prep_o_4:
    s_cmp_ge_u32 s36, 54
    s_cbranch_scc1 L_prep_m_5
    v_lshrrev_b32 v8, 4, v0
    v_lshlrev_b32 v8, 3, v8
    v_bfe_u32 v9, v0, 2, 2
    v_add_u32 v8, v8, v9
    v_mul_u32_u24 v8, 128, v8
    v_and_b32 v9, 3, v0
    v_lshl_add_u32 v8, v9, 3, v8
    s_lshl_b32 s7, s3, 5
    v_add_u32 v8, s7, v8
    ds_read_b64_tr_b16 v[32:33], v8 offset:8192
    ds_read_b64_tr_b16 v[34:35], v8 offset:8704
    ds_read_b64_tr_b16 v[36:37], v8 offset:12288
    ds_read_b64_tr_b16 v[38:39], v8 offset:12800
    ds_read_b64_tr_b16 v[40:41], v8 offset:16384
    ds_read_b64_tr_b16 v[42:43], v8 offset:16896
    s_mul_i32 s34, s34, 12
    s_add_u32 s34, s34, s3
    s_mul_i32 s34, s34, 18
    s_add_u32 s34, s34, s33
    s_lshl_b32 s34, s34, 10
    s_add_u32 s7, s34, 2359296
    s_waitcnt lgkmcnt(4)
    buffer_store_dwordx4 v[32:35], v253, s[8:11], s7 offen sc1
    s_add_u32 s7, s34, 2433024
    s_waitcnt lgkmcnt(2)
    buffer_store_dwordx4 v[36:39], v253, s[8:11], s7 offen sc1
    s_add_u32 s7, s34, 2506752
    s_waitcnt lgkmcnt(0)
    buffer_store_dwordx4 v[40:43], v253, s[8:11], s7 offen sc1
    s_branch L_prep_done_6
L_prep_m_5:
    s_cmp_ge_u32 s37, 36
    s_cbranch_scc1 L_prep_done_6
    v_mov_b32 v28, 0x3f803f80
    v_mov_b32 v29, 0x3f803f80
    v_mov_b32 v30, 0x3f803f80
    v_mov_b32 v31, 0x3f803f80
    v_and_b32 v9, 15, v0
    v_cmp_eq_u32 vcc, 0, v9
    v_cmp_eq_u32 s[22:23], 1, v9
    v_mfma_f32_16x16x32_bf16 v[32:35], v[64:67], v[28:31], 0
    v_mfma_f32_16x16x32_bf16 v[32:35], v[68:71], v[28:31], v[32:35]
    v_mfma_f32_16x16x32_bf16 v[32:35], v[72:75], v[28:31], v[32:35]
    v_mfma_f32_16x16x32_bf16 v[32:35], v[76:79], v[28:31], v[32:35]
    v_mfma_f32_16x16x32_bf16 v[32:35], v[80:83], v[28:31], v[32:35]
    v_mfma_f32_16x16x32_bf16 v[32:35], v[84:87], v[28:31], v[32:35]
    v_mfma_f32_16x16x32_bf16 v[32:35], v[88:91], v[28:31], v[32:35]
    v_mfma_f32_16x16x32_bf16 v[32:35], v[92:95], v[28:31], v[32:35]
    v_mfma_f32_16x16x32_bf16 v[32:35], v[96:99], v[28:31], v[32:35]
    v_mfma_f32_16x16x32_bf16 v[32:35], v[100:103], v[28:31], v[32:35]
    v_mfma_f32_16x16x32_bf16 v[32:35], v[104:107], v[28:31], v[32:35]
    v_mfma_f32_16x16x32_bf16 v[32:35], v[108:111], v[28:31], v[32:35]
    v_mfma_f32_16x16x32_bf16 v[32:35], v[112:115], v[28:31], v[32:35]
    v_mfma_f32_16x16x32_bf16 v[32:35], v[116:119], v[28:31], v[32:35]
    v_mfma_f32_16x16x32_bf16 v[32:35], v[120:123], v[28:31], v[32:35]
    v_mfma_f32_16x16x32_bf16 v[32:35], v[124:127], v[28:31], v[32:35]
    v_mfma_f32_16x16x32_bf16 v[32:35], v[128:131], v[28:31], v[32:35]
    v_mfma_f32_16x16x32_bf16 v[32:35], v[132:135], v[28:31], v[32:35]
    v_lshrrev_b32 v10, 5, v0
    v_lshlrev_b32 v10, 8, v10
    v_lshl_add_u32 v10, v9, 4, v10
    v_bfe_u32 v9, v0, 4, 1
    v_lshl_add_u32 v10, v9, 3, v10
    s_lshl_b32 s7, s37, 9
    s_add_u32 s7, s7, 3022848
    s_nop 0
    v_mul_f32 v32, 0x3ae38e39, v32
    v_mul_f32 v33, 0x3ae38e39, v33
    v_mul_f32 v34, 0x3ae38e39, v34
    v_mul_f32 v35, 0x3ae38e39, v35
    v_cvt_pk_bf16_f32 v36, v32, v33
    v_cvt_pk_bf16_f32 v37, v34, v35
    v_lshlrev_b32 v38, 16, v36
    v_and_b32 v39, s16, v36
    v_sub_f32 v38, v32, v38
    v_sub_f32 v39, v33, v39
    v_cvt_pk_bf16_f32 v28, v38, v39
    v_cndmask_b32 v28, 0, v28, s[22:23]
    v_cndmask_b32 v28, v28, v36, vcc
    v_lshlrev_b32 v38, 16, v37
    v_and_b32 v39, s16, v37
    v_sub_f32 v38, v34, v38
    v_sub_f32 v39, v35, v39
    v_cvt_pk_bf16_f32 v29, v38, v39
    v_cndmask_b32 v29, 0, v29, s[22:23]
    v_cndmask_b32 v29, v29, v37, vcc
    buffer_store_dwordx2 v[28:29], v10, s[8:11], s7 offen sc1
L_prep_done_6:
    s_add_u32 s19, s18, 43515904
    s_add_u32 s20, s18, 38797312
    s_lshl_b32 s22, s21, 7
    s_add_u32 s22, s22, 48234496
    buffer_store_dwordx4 v[16:19], v172, s[8:11], s19 offen sc1
    buffer_store_dwordx4 v[20:23], v173, s[8:11], s19 offen sc1
    buffer_store_dwordx4 v[24:27], v174, s[8:11], s19 offen sc1
    s_mov_b32 s17, 0x3f803f80
    v_mov_b32 v8, 0
    v_mov_b32 v9, 0
    v_mov_b32 v10, 0
    v_mov_b32 v11, 0
    v_dot2c_f32_bf16 v8, s17, v16
    v_dot2c_f32_bf16 v9, v16, v16
    v_dot2c_f32_bf16 v10, s17, v17
    v_dot2c_f32_bf16 v11, v17, v17
    v_dot2c_f32_bf16 v8, s17, v18
    v_dot2c_f32_bf16 v9, v18, v18
    v_dot2c_f32_bf16 v10, s17, v19
    v_dot2c_f32_bf16 v11, v19, v19
    v_dot2c_f32_bf16 v8, s17, v20
    v_dot2c_f32_bf16 v9, v20, v20
    v_dot2c_f32_bf16 v10, s17, v21
    v_dot2c_f32_bf16 v11, v21, v21
    v_dot2c_f32_bf16 v8, s17, v22
    v_dot2c_f32_bf16 v9, v22, v22
    v_dot2c_f32_bf16 v10, s17, v23
    v_dot2c_f32_bf16 v11, v23, v23
    v_dot2c_f32_bf16 v8, s17, v24
    v_dot2c_f32_bf16 v9, v24, v24
    v_dot2c_f32_bf16 v10, s17, v25
    v_dot2c_f32_bf16 v11, v25, v25
    v_dot2c_f32_bf16 v8, s17, v26
    v_dot2c_f32_bf16 v9, v26, v26
    v_dot2c_f32_bf16 v10, s17, v27
    v_dot2c_f32_bf16 v11, v27, v27
    v_and_b32 v12, 7, v0
    v_lshlrev_b32 v12, 3, v12
    s_lshl_b32 s7, s3, 6
    v_add_u32 v13, s7, v12
    v_pk_add_f32 v[8:9], v[8:9], v[10:11]
    s_nop 1
    v_add_f32_dpp v8, v8, v8 row_ror:8 row_mask:0xf bank_mask:0xf
    v_add_f32_dpp v9, v9, v9 row_ror:8 row_mask:0xf bank_mask:0xf
    v_mov_b32 v10, v8
    v_mov_b32 v11, v9
    s_nop 1
    v_permlane32_swap_b32 v10, v8
    v_permlane32_swap_b32 v11, v9
    v_add_f32 v8, v8, v10
    v_add_f32 v9, v9, v11
    v_mov_b32 v10, v8
    v_mov_b32 v11, v9
    s_nop 1
    v_permlane16_swap_b32 v10, v8
    v_permlane16_swap_b32 v11, v9
    v_add_f32 v8, v8, v10
    v_add_f32 v9, v9, v11
    ds_write_b64 v13, v[8:9]
    s_waitcnt lgkmcnt(0)
    s_barrier
    ds_read_b64 v[40:41], v12 offset:0
    ds_read_b64 v[42:43], v12 offset:64
    ds_read_b64 v[44:45], v12 offset:128
    ds_read_b64 v[46:47], v12 offset:192
    s_waitcnt lgkmcnt(0)
    v_pk_add_f32 v[40:41], v[40:41], v[42:43]
    v_pk_add_f32 v[44:45], v[44:45], v[46:47]
    v_pk_add_f32 v[8:9], v[40:41], v[44:45]
    v_mul_f32 v8, 0x3ae38e39, v8
    v_mul_f32 v9, 0x3ae38e39, v9
    v_fma_f32 v9, -v8, v8, v9
    v_max_f32 v9, 0, v9
    v_add_f32 v9, 0x3727c5ac, v9
    v_rsq_f32 v10, v9
    s_nop 0
    v_mul_f32 v12, v8, v10
    v_mov_b32 v11, v10
    v_sub_f32 v12, 0, v12
    v_mov_b32 v13, v12
    s_cmp_eq_u32 s3, 0
    s_cselect_b32 s7, 32, 0
    v_lshlrev_b32 v14, 2, v0
    v_cmp_gt_u32 vcc, s7, v0
    v_mov_b32 v9, 1073741824
    s_nop 0
    v_cndmask_b32 v14, v9, v14, vcc
    buffer_store_dword v8, v14, s[8:11], s22 offen sc1
    v_lshlrev_b32 v40, 16, v16
    v_and_b32 v41, s16, v16
    v_lshlrev_b32 v42, 16, v17
    v_and_b32 v43, s16, v17
    v_lshlrev_b32 v44, 16, v18
    v_and_b32 v45, s16, v18
    v_lshlrev_b32 v46, 16, v19
    v_and_b32 v47, s16, v19
    v_pk_fma_f32 v[40:41], v[40:41], v[10:11], v[12:13]
    v_pk_fma_f32 v[42:43], v[42:43], v[10:11], v[12:13]
    v_pk_fma_f32 v[44:45], v[44:45], v[10:11], v[12:13]
    v_pk_fma_f32 v[46:47], v[46:47], v[10:11], v[12:13]
    v_cvt_pk_bf16_f32 v48, v40, v41
    v_cvt_pk_bf16_f32 v49, v42, v43
    v_cvt_pk_bf16_f32 v50, v44, v45
    v_cvt_pk_bf16_f32 v51, v46, v47
    v_lshlrev_b32 v40, 16, v20
    v_and_b32 v41, s16, v20
    v_lshlrev_b32 v42, 16, v21
    v_and_b32 v43, s16, v21
    v_lshlrev_b32 v44, 16, v22
    v_and_b32 v45, s16, v22
    v_lshlrev_b32 v46, 16, v23
    v_and_b32 v47, s16, v23
    v_pk_fma_f32 v[40:41], v[40:41], v[10:11], v[12:13]
    v_pk_fma_f32 v[42:43], v[42:43], v[10:11], v[12:13]
    v_pk_fma_f32 v[44:45], v[44:45], v[10:11], v[12:13]
    v_pk_fma_f32 v[46:47], v[46:47], v[10:11], v[12:13]
    v_cvt_pk_bf16_f32 v52, v40, v41
    v_cvt_pk_bf16_f32 v53, v42, v43
    v_cvt_pk_bf16_f32 v54, v44, v45
    v_cvt_pk_bf16_f32 v55, v46, v47
    v_lshlrev_b32 v40, 16, v24
    v_and_b32 v41, s16, v24
    v_lshlrev_b32 v42, 16, v25
    v_and_b32 v43, s16, v25
    v_lshlrev_b32 v44, 16, v26
    v_and_b32 v45, s16, v26
    v_lshlrev_b32 v46, 16, v27
    v_and_b32 v47, s16, v27
    v_pk_fma_f32 v[40:41], v[40:41], v[10:11], v[12:13]
    v_pk_fma_f32 v[42:43], v[42:43], v[10:11], v[12:13]
    v_pk_fma_f32 v[44:45], v[44:45], v[10:11], v[12:13]
    v_pk_fma_f32 v[46:47], v[46:47], v[10:11], v[12:13]
    v_cvt_pk_bf16_f32 v56, v40, v41
    v_cvt_pk_bf16_f32 v57, v42, v43
    v_cvt_pk_bf16_f32 v58, v44, v45
    v_cvt_pk_bf16_f32 v59, v46, v47
    buffer_store_dwordx4 v[48:51], v172, s[8:11], s20 offen sc1
    buffer_store_dwordx4 v[52:55], v173, s[8:11], s20 offen sc1
    buffer_store_dwordx4 v[56:59], v174, s[8:11], s20 offen sc1
    v_lshlrev_b32 v15, 7, v0
    s_lshl_b32 s6, s40, 2
    s_add_u32 s6, s6, s44
    s_sub_u32 s6, s6, 32768
    v_mov_b32 v1, s76
    s_mov_b64 vcc, 0xff
    v_lshrrev_b32 v14, 3, v0
    v_lshl_add_u32 v15, v14, 3, v15
    s_cmp_ge_u32 s40, 6
    s_cselect_b32 s7, s41, 31
    s_cmp_lt_u32 s7, 31
    s_cmov_b64 vcc, 0xffff
    s_waitcnt vmcnt(0)
    s_barrier
    s_cmp_lg_u32 s3, 0
    s_cbranch_scc1 L_pub_11
    s_mov_b64 exec, vcc
    buffer_store_dword v1, v15, s[8:11], s6 offen sc1
    s_lshl_b32 s6, s40, 7
    s_lshl_b32 s7, s32, 2
    s_add_u32 s6, s6, s7
    s_add_u32 s6, s6, 19431424
    s_mov_b64 exec, 0xffffffff
    v_lshlrev_b32 v15, 10, v0
    v_mov_b32 v1, s76
    buffer_store_dword v1, v15, s[8:11], s6 offen sc1
    s_cmp_lt_u32 s32, 18
    s_cbranch_scc1 L_pub_11
    s_lshl_b32 s6, s36, 2
    s_add_u32 s6, s6, 19496960
    s_mov_b64 exec, 1
    buffer_store_dword v1, off, s[8:11], s6 sc1
L_pub_11:
    s_mov_b64 exec, -1
    s_cmp_lt_u32 s32, 18
    s_cbranch_scc1 L_raw_12
    s_cmp_eq_u32 s93, 2
    s_cselect_b32 s6, 2, 3
    s_mov_b32 s7, 512
    s_cmov_b32 s7, 2048
    v_lshrrev_b32 v14, 4, v0
    v_lshlrev_b32 v14, s6, v14
    v_bfe_u32 v15, v0, 2, 2
    v_add_u32 v14, v14, v15
    v_mul_u32_u24 v14, 128, v14
    v_and_b32 v15, 3, v0
    v_lshl_add_u32 v14, v15, 3, v14
    v_add_u32 v14, s79, v14
    v_add_u32 v15, s7, v14
    ds_read_b64_tr_b16 v[64:65], v14 offset:0
    ds_read_b64_tr_b16 v[66:67], v15 offset:0
    ds_read_b64_tr_b16 v[68:69], v14 offset:32
    ds_read_b64_tr_b16 v[70:71], v15 offset:32
    ds_read_b64_tr_b16 v[72:73], v14 offset:64
    ds_read_b64_tr_b16 v[74:75], v15 offset:64
    ds_read_b64_tr_b16 v[76:77], v14 offset:96
    ds_read_b64_tr_b16 v[78:79], v15 offset:96
    ds_read_b64_tr_b16 v[80:81], v14 offset:4096
    ds_read_b64_tr_b16 v[82:83], v15 offset:4096
    ds_read_b64_tr_b16 v[84:85], v14 offset:4128
    ds_read_b64_tr_b16 v[86:87], v15 offset:4128
    ds_read_b64_tr_b16 v[88:89], v14 offset:4160
    ds_read_b64_tr_b16 v[90:91], v15 offset:4160
    ds_read_b64_tr_b16 v[92:93], v14 offset:4192
    ds_read_b64_tr_b16 v[94:95], v15 offset:4192
    ds_read_b64_tr_b16 v[96:97], v14 offset:8192
    ds_read_b64_tr_b16 v[98:99], v15 offset:8192
    ds_read_b64_tr_b16 v[100:101], v14 offset:8224
    ds_read_b64_tr_b16 v[102:103], v15 offset:8224
    ds_read_b64_tr_b16 v[104:105], v14 offset:8256
    ds_read_b64_tr_b16 v[106:107], v15 offset:8256
    ds_read_b64_tr_b16 v[108:109], v14 offset:8288
    ds_read_b64_tr_b16 v[110:111], v15 offset:8288
    s_waitcnt lgkmcnt(0)
    s_add_u32 m0, s79, 8192
    s_mov_b32 s71, s83
    buffer_load_dwordx4 v224, s[72:75], s71 offen nt lds
    s_add_u32 m0, s79, 9216
    s_add_u32 s71, s71, s92
    buffer_load_dwordx4 v224, s[72:75], s71 offen nt lds
    s_add_u32 m0, s79, 10240
    s_add_u32 s71, s71, s92
    buffer_load_dwordx4 v224, s[72:75], s71 offen nt lds
    s_add_u32 m0, s79, 11264
    s_add_u32 s71, s71, s92
    buffer_load_dwordx4 v224, s[72:75], s71 offen nt lds
    s_add_u32 m0, s79, 12288
    s_mov_b32 s71, s84
    buffer_load_dwordx4 v224, s[72:75], s71 offen nt lds
    s_add_u32 m0, s79, 13312
    s_add_u32 s71, s71, s92
    buffer_load_dwordx4 v224, s[72:75], s71 offen nt lds
    s_add_u32 m0, s79, 14336
    s_add_u32 s71, s71, s92
    buffer_load_dwordx4 v224, s[72:75], s71 offen nt lds
    s_add_u32 m0, s79, 15360
    s_add_u32 s71, s71, s92
    buffer_load_dwordx4 v224, s[72:75], s71 offen nt lds
    s_add_u32 s7, s94, 0
    buffer_store_dwordx4 v[64:67], v253, s[8:11], s7 offen sc1
    s_add_u32 s7, s94, 497664
    buffer_store_dwordx4 v[68:71], v253, s[8:11], s7 offen sc1
    s_add_u32 s7, s94, 995328
    buffer_store_dwordx4 v[72:75], v253, s[8:11], s7 offen sc1
    s_add_u32 s7, s94, 1492992
    buffer_store_dwordx4 v[76:79], v253, s[8:11], s7 offen sc1
    s_add_u32 s7, s95, 0
    buffer_store_dwordx4 v[80:83], v253, s[8:11], s7 offen sc1
    s_add_u32 s7, s95, 497664
    buffer_store_dwordx4 v[84:87], v253, s[8:11], s7 offen sc1
    s_add_u32 s7, s95, 995328
    buffer_store_dwordx4 v[88:91], v253, s[8:11], s7 offen sc1
    s_add_u32 s7, s95, 1492992
    buffer_store_dwordx4 v[92:95], v253, s[8:11], s7 offen sc1
    s_add_u32 s7, s85, 0
    buffer_store_dwordx4 v[96:99], v253, s[8:11], s7 offen sc1
    s_add_u32 s7, s85, 497664
    buffer_store_dwordx4 v[100:103], v253, s[8:11], s7 offen sc1
    s_add_u32 s7, s85, 995328
    buffer_store_dwordx4 v[104:107], v253, s[8:11], s7 offen sc1
    s_add_u32 s7, s85, 1492992
    buffer_store_dwordx4 v[108:111], v253, s[8:11], s7 offen sc1
    s_branch L_raw_13
L_raw_12:
    s_cmp_eq_u32 s93, 2
    s_cselect_b32 s6, 2, 3
    s_mov_b32 s7, 512
    s_cmov_b32 s7, 2048
    v_lshrrev_b32 v14, 4, v0
    v_lshlrev_b32 v14, s6, v14
    v_bfe_u32 v15, v0, 2, 2
    v_add_u32 v14, v14, v15
    v_mul_u32_u24 v14, 128, v14
    v_and_b32 v15, 3, v0
    v_lshl_add_u32 v14, v15, 3, v14
    v_add_u32 v14, s79, v14
    v_add_u32 v15, s7, v14
    ds_read_b64_tr_b16 v[64:65], v14 offset:0
    ds_read_b64_tr_b16 v[66:67], v15 offset:0
    ds_read_b64_tr_b16 v[68:69], v14 offset:32
    ds_read_b64_tr_b16 v[70:71], v15 offset:32
    ds_read_b64_tr_b16 v[72:73], v14 offset:64
    ds_read_b64_tr_b16 v[74:75], v15 offset:64
    ds_read_b64_tr_b16 v[76:77], v14 offset:96
    ds_read_b64_tr_b16 v[78:79], v15 offset:96
    s_waitcnt lgkmcnt(0)
    s_add_u32 m0, s79, 8192
    s_mov_b32 s71, s83
    buffer_load_dwordx4 v224, s[72:75], s71 offen nt lds
    s_add_u32 m0, s79, 9216
    s_add_u32 s71, s71, s92
    buffer_load_dwordx4 v224, s[72:75], s71 offen nt lds
    s_add_u32 m0, s79, 10240
    s_add_u32 s71, s71, s92
    buffer_load_dwordx4 v224, s[72:75], s71 offen nt lds
    s_add_u32 m0, s79, 11264
    s_add_u32 s71, s71, s92
    buffer_load_dwordx4 v224, s[72:75], s71 offen nt lds
    s_add_u32 m0, s79, 12288
    s_mov_b32 s71, s84
    buffer_load_dwordx4 v224, s[72:75], s71 offen nt lds
    s_add_u32 m0, s79, 13312
    s_add_u32 s71, s71, s92
    buffer_load_dwordx4 v224, s[72:75], s71 offen nt lds
    s_add_u32 m0, s79, 14336
    s_add_u32 s71, s71, s92
    buffer_load_dwordx4 v224, s[72:75], s71 offen nt lds
    s_add_u32 m0, s79, 15360
    s_add_u32 s71, s71, s92
    buffer_load_dwordx4 v224, s[72:75], s71 offen nt lds
    s_add_u32 s7, s94, 0
    buffer_store_dwordx4 v[64:67], v253, s[8:11], s7 offen sc1
    s_add_u32 s7, s94, 497664
    buffer_store_dwordx4 v[68:71], v253, s[8:11], s7 offen sc1
    s_add_u32 s7, s94, 995328
    buffer_store_dwordx4 v[72:75], v253, s[8:11], s7 offen sc1
    s_add_u32 s7, s94, 1492992
    buffer_store_dwordx4 v[76:79], v253, s[8:11], s7 offen sc1
L_raw_13:
    s_cmp_lg_u32 s3, 0
    s_cbranch_scc1 L_wq_ready_14
    s_lshl_b32 s7, s41, 3
    s_add_u32 s7, s7, s40
    s_lshl_b32 s7, s7, 7
    s_add_u32 s7, s7, 19431424
    s_add_u32 s68, s4, s7
    s_addc_u32 s69, s5, 0
    s_mov_b32 s6, 0
    s_mov_b32 s7, 0
L_cpoll_15:
    s_load_dwordx16 s[52:67], s[68:69], s7 glc
    s_add_u32 s6, s6, 1
    s_waitcnt lgkmcnt(0)
    s_xor_b64 s[52:53], s[52:53], s[76:77]
    s_xor_b64 s[54:55], s[54:55], s[76:77]
    s_xor_b64 s[56:57], s[56:57], s[76:77]
    s_xor_b64 s[58:59], s[58:59], s[76:77]
    s_xor_b64 s[60:61], s[60:61], s[76:77]
    s_xor_b64 s[62:63], s[62:63], s[76:77]
    s_xor_b64 s[64:65], s[64:65], s[76:77]
    s_xor_b64 s[66:67], s[66:67], s[76:77]
    s_or_b64 s[52:53], s[52:53], s[60:61]
    s_or_b64 s[54:55], s[54:55], s[62:63]
    s_or_b64 s[56:57], s[56:57], s[64:65]
    s_or_b64 s[58:59], s[58:59], s[66:67]
    s_or_b64 s[52:53], s[52:53], s[56:57]
    s_or_b64 s[54:55], s[54:55], s[58:59]
    s_or_b64 s[52:53], s[52:53], s[54:55]
    s_cbranch_scc1 L_cpoll_16
    s_add_u32 s7, s7, 8
    s_cmp_eq_u32 s7, 16
    s_cbranch_scc1 L_cpolled_17
L_cpoll_16:
    s_cmp_lt_u32 s6, 1048576
    s_cbranch_scc1 L_cpoll_15
    s_branch L_main_end
L_cpolled_17:
L_wq_ready_14:
    s_barrier
    s_lshl_b32 s28, s40, 2
    s_add_u32 s28, s28, s3
    s_mul_i32 s28, s28, 73728
    v_and_b32 v229, 8, v0
    v_lshl_add_u32 v229, v229, 27, v253
    buffer_load_dwordx4 a[0:3], v253, s[8:11], s28 offen offset:0 sc1
    buffer_load_dwordx4 a[4:7], v253, s[8:11], s28 offen offset:1024 sc1
    buffer_load_dwordx4 a[8:11], v253, s[8:11], s28 offen offset:2048 sc1
    buffer_load_dwordx4 a[12:15], v229, s[8:11], s28 offen offset:3072 sc1
    s_add_u32 s28, s28, 4096
    buffer_load_dwordx4 a[16:19], v253, s[8:11], s28 offen offset:0 sc1
    buffer_load_dwordx4 a[20:23], v253, s[8:11], s28 offen offset:1024 sc1
    buffer_load_dwordx4 a[24:27], v253, s[8:11], s28 offen offset:2048 sc1
    buffer_load_dwordx4 a[28:31], v229, s[8:11], s28 offen offset:3072 sc1
    s_add_u32 s28, s28, 4096
    buffer_load_dwordx4 a[32:35], v253, s[8:11], s28 offen offset:0 sc1
    buffer_load_dwordx4 a[36:39], v253, s[8:11], s28 offen offset:1024 sc1
    buffer_load_dwordx4 a[40:43], v253, s[8:11], s28 offen offset:2048 sc1
    buffer_load_dwordx4 a[44:47], v229, s[8:11], s28 offen offset:3072 sc1
    s_add_u32 s28, s28, 4096
    buffer_load_dwordx4 a[48:51], v253, s[8:11], s28 offen offset:0 sc1
    buffer_load_dwordx4 a[52:55], v253, s[8:11], s28 offen offset:1024 sc1
    buffer_load_dwordx4 a[56:59], v253, s[8:11], s28 offen offset:2048 sc1
    buffer_load_dwordx4 a[60:63], v229, s[8:11], s28 offen offset:3072 sc1
    s_add_u32 s28, s28, 4096
    buffer_load_dwordx4 a[64:67], v253, s[8:11], s28 offen offset:0 sc1
    buffer_load_dwordx4 a[68:71], v253, s[8:11], s28 offen offset:1024 sc1
    buffer_load_dwordx4 a[72:75], v253, s[8:11], s28 offen offset:2048 sc1
    buffer_load_dwordx4 a[76:79], v229, s[8:11], s28 offen offset:3072 sc1
    s_add_u32 s28, s28, 4096
    buffer_load_dwordx4 a[80:83], v253, s[8:11], s28 offen offset:0 sc1
    buffer_load_dwordx4 a[84:87], v253, s[8:11], s28 offen offset:1024 sc1
    buffer_load_dwordx4 a[88:91], v253, s[8:11], s28 offen offset:2048 sc1
    buffer_load_dwordx4 a[92:95], v229, s[8:11], s28 offen offset:3072 sc1
    s_add_u32 s28, s28, 4096
    buffer_load_dwordx4 a[96:99], v253, s[8:11], s28 offen offset:0 sc1
    buffer_load_dwordx4 a[100:103], v253, s[8:11], s28 offen offset:1024 sc1
    buffer_load_dwordx4 a[104:107], v253, s[8:11], s28 offen offset:2048 sc1
    buffer_load_dwordx4 a[108:111], v229, s[8:11], s28 offen offset:3072 sc1
    s_add_u32 s28, s28, 4096
    buffer_load_dwordx4 a[112:115], v253, s[8:11], s28 offen offset:0 sc1
    buffer_load_dwordx4 a[116:119], v253, s[8:11], s28 offen offset:1024 sc1
    buffer_load_dwordx4 a[120:123], v253, s[8:11], s28 offen offset:2048 sc1
    buffer_load_dwordx4 a[124:127], v229, s[8:11], s28 offen offset:3072 sc1
    s_add_u32 s28, s28, 4096
    buffer_load_dwordx4 a[128:131], v253, s[8:11], s28 offen offset:0 sc1
    buffer_load_dwordx4 a[132:135], v253, s[8:11], s28 offen offset:1024 sc1
    buffer_load_dwordx4 a[136:139], v253, s[8:11], s28 offen offset:2048 sc1
    buffer_load_dwordx4 a[140:143], v229, s[8:11], s28 offen offset:3072 sc1
    s_add_u32 s28, s28, 4096
L_main_layer:
    v_bfe_u32 v3, v0, 3, 1
    v_mul_u32_u24 v2, 9216, v3
    v_lshrrev_b32 v3, 4, v0
    v_lshl_add_u32 v2, v3, 7, v2
    v_and_b32 v3, 7, v0
    v_lshl_add_u32 v2, v3, 4, v2
    v_bfe_u32 v3, v0, 3, 2
    s_mov_b32 s7, 9216
    v_mul_lo_u32 v9, v3, s7
    v_lshrrev_b32 v3, 5, v0
    v_lshl_add_u32 v9, v3, 7, v9
    v_and_b32 v3, 7, v0
    v_lshl_add_u32 v9, v3, 4, v9
    s_mul_i32 s22, s41, 73728
    s_add_u32 s22, s22, s43
    s_add_u32 s23, s22, 38797312
    s_mul_i32 s7, s3, 18432
    s_add_u32 s24, s23, s7
    s_cmp_eq_u32 s41, 0
    s_cselect_b32 s7, 0, 18432
    s_sub_u32 s23, s23, s7
    s_lshl_b32 s25, s3, 10
    s_add_u32 s25, s25, 1024
    s_mul_i32 s26, s3, 5120
    s_lshl_b32 s7, s3, 9
    s_add_u32 s27, s23, s7
    s_and_b32 s7, s3, 1
    s_add_u32 s7, s7, 4
    s_mul_i32 s29, s7, 5120
    s_lshl_b32 s7, s7, 9
    s_add_u32 s23, s23, s7
    s_cmp_lg_u32 s3, 3
    s_cbranch_scc1 L_pollout_20
    s_lshl_b32 s7, s40, 7
    s_add_u32 s7, s7, s44
    s_sub_u32 s7, s7, 32768
    s_add_u32 s52, s4, s7
    s_addc_u32 s53, s5, 0
    s_cmp_eq_u32 s41, 0
    s_cselect_b32 s7, 0, 32
    s_mov_b32 s6, 0
L_poll_18:
    s_load_dwordx8 s[56:63], s[52:53], 0 glc
    s_load_dwordx2 s[54:55], s[52:53], s7 glc
    s_add_u32 s6, s6, 1
    s_waitcnt lgkmcnt(0)
    s_xor_b64 s[54:55], s[54:55], s[76:77]
    s_xor_b64 s[56:57], s[56:57], s[76:77]
    s_xor_b64 s[58:59], s[58:59], s[76:77]
    s_xor_b64 s[60:61], s[60:61], s[76:77]
    s_xor_b64 s[62:63], s[62:63], s[76:77]
    s_or_b64 s[56:57], s[56:57], s[58:59]
    s_or_b64 s[60:61], s[60:61], s[62:63]
    s_or_b64 s[56:57], s[56:57], s[54:55]
    s_or_b64 s[56:57], s[56:57], s[60:61]
    s_cbranch_scc0 L_polled_19
    s_cmp_lt_u32 s6, 1048576
    s_cbranch_scc1 L_poll_18
    s_branch L_main_end
L_polled_19:
L_pollout_20:
    s_barrier
    s_add_u32 m0, s25, 0
    s_nop 0
    buffer_load_dwordx4 v2, s[8:11], s24 offen offset:0 sc1 lds
    s_add_u32 m0, s25, 4608
    s_nop 0
    buffer_load_dwordx4 v2, s[8:11], s24 offen offset:512 sc1 lds
    s_add_u32 m0, s25, 9216
    s_nop 0
    buffer_load_dwordx4 v2, s[8:11], s24 offen offset:1024 sc1 lds
    s_add_u32 m0, s25, 13824
    s_nop 0
    buffer_load_dwordx4 v2, s[8:11], s24 offen offset:1536 sc1 lds
    s_add_u32 m0, s25, 18432
    s_nop 0
    buffer_load_dwordx4 v2, s[8:11], s24 offen offset:2048 sc1 lds
    s_add_u32 m0, s25, 23040
    s_nop 0
    buffer_load_dwordx4 v2, s[8:11], s24 offen offset:2560 sc1 lds
    s_add_u32 m0, s26, 0
    s_add_u32 s7, s27, 0
    buffer_load_dwordx4 v2, s[8:11], s7 offen sc1 lds
    s_add_u32 m0, s29, 0
    s_add_u32 s7, s23, 0
    buffer_load_dwordx4 v2, s[8:11], s7 offen sc1 lds
    v_add_u32 v6, 46080, v253
    s_waitcnt vmcnt(0)
    s_barrier
    ds_read_b128 v[16:19], v253 offset:0
    ds_read_b128 v[20:23], v253 offset:1024
    ds_read_b128 v[24:27], v253 offset:2048
    ds_read_b128 v[28:31], v253 offset:3072
    ds_read_b128 v[32:35], v253 offset:4096
    s_waitcnt lgkmcnt(0)
    v_mfma_f32_16x16x32_bf16 v[56:59], a[0:3], v[20:23], 0
    ds_read_b128 v[36:39], v253 offset:5120
    v_mfma_f32_16x16x32_bf16 v[60:63], a[0:3], v[24:27], 0
    ds_read_b128 v[40:43], v253 offset:6144
    v_mfma_f32_16x16x32_bf16 v[64:67], a[0:3], v[28:31], 0
    ds_read_b128 v[44:47], v253 offset:7168
    v_mfma_f32_16x16x32_bf16 v[68:71], a[0:3], v[32:35], 0
    ds_read_b128 v[48:51], v253 offset:8192
    v_mfma_f32_16x16x32_bf16 v[72:75], a[4:7], v[16:19], 0
    ds_read_b128 v[52:55], v253 offset:9216
    v_mfma_f32_16x16x32_bf16 v[76:79], a[4:7], v[20:23], 0
    s_add_u32 m0, s25, 27648
    s_nop 0
    buffer_load_dwordx4 v2, s[8:11], s24 offen offset:3072 sc1 lds
    v_mfma_f32_16x16x32_bf16 v[80:83], a[4:7], v[24:27], 0
    v_mov_b32 v132, 0
    v_mov_b32 v133, 0
    v_mfma_f32_16x16x32_bf16 v[84:87], a[4:7], v[28:31], 0
    s_add_u32 m0, s25, 32256
    s_nop 0
    buffer_load_dwordx4 v2, s[8:11], s24 offen offset:3584 sc1 lds
    v_mfma_f32_16x16x32_bf16 v[88:91], a[4:7], v[32:35], 0
    v_mov_b32 v192, 0
    v_mov_b32 v193, 0
    v_mfma_f32_16x16x32_bf16 v[92:95], v[16:19], a[8:11], 0
    buffer_load_dwordx4 a[144:147], v253, s[8:11], s28 offen offset:0 sc1
    v_mfma_f32_16x16x32_bf16 v[96:99], v[20:23], a[8:11], 0
    v_mov_b32 v195, 0
    v_mov_b32 v135, 0
    v_mfma_f32_16x16x32_bf16 v[100:103], v[24:27], a[8:11], 0
    buffer_load_dwordx4 a[148:151], v253, s[8:11], s28 offen offset:1024 sc1
    v_mfma_f32_16x16x32_bf16 v[104:107], v[28:31], a[8:11], 0
    v_mov_b32 v139, 0
    v_mov_b32 v143, 0
    v_mfma_f32_16x16x32_bf16 v[108:111], v[32:35], a[8:11], 0
    buffer_load_dwordx4 a[152:155], v253, s[8:11], s28 offen offset:2048 sc1
    v_mfma_f32_16x16x32_bf16 v[112:115], a[12:15], v[16:19], 0
    v_mov_b32 v147, 0
    v_mov_b32 v151, 0
    v_mfma_f32_16x16x32_bf16 v[116:119], a[12:15], v[20:23], 0
    v_mov_b32 v155, 0
    v_mov_b32 v159, 0
    v_mfma_f32_16x16x32_bf16 v[120:123], a[12:15], v[24:27], 0
    v_mov_b32 v163, 0
    v_mov_b32 v167, 0
    v_mfma_f32_16x16x32_bf16 v[124:127], a[12:15], v[28:31], 0
    v_mov_b32 v171, 0
    v_cmp_eq_u32 vcc, 16, v0
    v_mov_b32 v10, 0x3f80
    v_mfma_f32_16x16x32_bf16 v[128:131], a[12:15], v[32:35], 0
    v_cmp_eq_u32 s[20:21], 17, v0
    v_cndmask_b32 v194, 0, v10, vcc
    v_and_b32 v11, 3, v0
    s_waitcnt lgkmcnt(0)
    v_mfma_f32_16x16x32_bf16 v[56:59], a[16:19], v[40:43], v[56:59]
    ds_read_b128 v[16:19], v253 offset:10240
    v_mfma_f32_16x16x32_bf16 v[60:63], a[16:19], v[44:47], v[60:63]
    ds_read_b128 v[20:23], v253 offset:11264
    v_mfma_f32_16x16x32_bf16 v[64:67], a[16:19], v[48:51], v[64:67]
    ds_read_b128 v[24:27], v253 offset:12288
    v_mfma_f32_16x16x32_bf16 v[68:71], a[16:19], v[52:55], v[68:71]
    ds_read_b128 v[28:31], v253 offset:13312
    v_mfma_f32_16x16x32_bf16 v[72:75], a[20:23], v[36:39], v[72:75]
    ds_read_b128 v[32:35], v253 offset:14336
    v_mfma_f32_16x16x32_bf16 v[76:79], a[20:23], v[40:43], v[76:79]
    s_add_u32 m0, s25, 40960
    s_add_u32 s24, s24, 4096
    buffer_load_dwordx4 v2, s[8:11], s24 offen offset:0 sc1 lds
    v_mfma_f32_16x16x32_bf16 v[80:83], a[20:23], v[44:47], v[80:83]
    v_cndmask_b32 v194, v194, 1.0, s[20:21]
    v_cmp_eq_u32 vcc, 2, v11
    v_and_b32 v10, 15, v0
    v_mfma_f32_16x16x32_bf16 v[84:87], a[20:23], v[48:51], v[84:87]
    s_add_u32 m0, s25, 45568
    s_nop 0
    buffer_load_dwordx4 v2, s[8:11], s24 offen offset:512 sc1 lds
    v_mfma_f32_16x16x32_bf16 v[88:91], a[20:23], v[52:55], v[88:91]
    v_lshrrev_b32 v11, 4, v0
    v_cndmask_b32 v196, 0, 1.0, vcc
    v_mfma_f32_16x16x32_bf16 v[92:95], v[36:39], a[24:27], v[92:95]
    buffer_load_dwordx4 a[156:159], v229, s[8:11], s28 offen offset:3072 sc1
    s_add_u32 s28, s28, 4096
    v_mfma_f32_16x16x32_bf16 v[96:99], v[40:43], a[24:27], v[96:99]
    v_cndmask_b32 v197, 0, 1.0, vcc
    v_cndmask_b32 v198, 0, 1.0, vcc
    v_mfma_f32_16x16x32_bf16 v[100:103], v[44:47], a[24:27], v[100:103]
    buffer_load_dwordx4 a[0:3], v253, s[8:11], s28 offen offset:0 sc1
    v_mfma_f32_16x16x32_bf16 v[104:107], v[48:51], a[24:27], v[104:107]
    v_cndmask_b32 v199, 0, 1.0, vcc
    v_lshlrev_b32 v11, 2, v11
    v_mfma_f32_16x16x32_bf16 v[108:111], v[52:55], a[24:27], v[108:111]
    buffer_load_dwordx4 a[4:7], v253, s[8:11], s28 offen offset:1024 sc1
    v_mfma_f32_16x16x32_bf16 v[112:115], a[28:31], v[36:39], v[112:115]
    v_sub_u32 v10, v11, v10
    v_mov_b32 v12, 0xf149f2ca
    v_mfma_f32_16x16x32_bf16 v[116:119], a[28:31], v[40:43], v[116:119]
    s_cmp_eq_u32 s41, 0
    s_cselect_b64 s[38:39], 0, -1
    v_add_u32 v11, 0, v10
    v_and_b32 v13, 1, v11
    v_mfma_f32_16x16x32_bf16 v[120:123], a[28:31], v[44:47], v[120:123]
    v_cmp_eq_u32 s[20:21], 0, v13
    v_cmp_lt_i32 vcc, 1, v11
    v_cmp_gt_i32 s[18:19], 1, v11
    s_and_b64 vcc, vcc, s[20:21]
    s_and_b64 s[18:19], s[18:19], s[20:21]
    s_and_b64 s[20:21], vcc, s[38:39]
    v_cndmask_b32 v200, v12, 0, vcc
    v_cndmask_b32 v204, v12, 0, s[18:19]
    v_mfma_f32_16x16x32_bf16 v[124:127], a[28:31], v[48:51], v[124:127]
    v_cndmask_b32 v208, v12, 0, s[20:21]
    v_add_u32 v11, 1, v10
    v_mfma_f32_16x16x32_bf16 v[128:131], a[28:31], v[52:55], v[128:131]
    v_and_b32 v13, 1, v11
    v_cmp_eq_u32 s[20:21], 0, v13
    v_cmp_lt_i32 vcc, 1, v11
    v_cmp_gt_i32 s[18:19], 1, v11
    s_and_b64 vcc, vcc, s[20:21]
    s_and_b64 s[18:19], s[18:19], s[20:21]
    s_and_b64 s[20:21], vcc, s[38:39]
    v_cndmask_b32 v201, v12, 0, vcc
    s_waitcnt lgkmcnt(0)
    v_mfma_f32_16x16x32_bf16 v[56:59], a[32:35], v[20:23], v[56:59]
    ds_read_b128 v[36:39], v253 offset:15360
    v_mfma_f32_16x16x32_bf16 v[60:63], a[32:35], v[24:27], v[60:63]
    ds_read_b128 v[40:43], v253 offset:16384
    v_mfma_f32_16x16x32_bf16 v[64:67], a[32:35], v[28:31], v[64:67]
    ds_read_b128 v[44:47], v253 offset:17408
    v_mfma_f32_16x16x32_bf16 v[68:71], a[32:35], v[32:35], v[68:71]
    ds_read_b128 v[48:51], v253 offset:18432
    v_mfma_f32_16x16x32_bf16 v[72:75], a[36:39], v[16:19], v[72:75]
    ds_read_b128 v[52:55], v253 offset:19456
    v_mfma_f32_16x16x32_bf16 v[76:79], a[36:39], v[20:23], v[76:79]
    s_add_u32 m0, s25, 50176
    s_nop 0
    buffer_load_dwordx4 v2, s[8:11], s24 offen offset:1024 sc1 lds
    v_mfma_f32_16x16x32_bf16 v[80:83], a[36:39], v[24:27], v[80:83]
    v_cndmask_b32 v205, v12, 0, s[18:19]
    v_cndmask_b32 v209, v12, 0, s[20:21]
    v_mfma_f32_16x16x32_bf16 v[84:87], a[36:39], v[28:31], v[84:87]
    s_add_u32 m0, s25, 54784
    s_nop 0
    buffer_load_dwordx4 v2, s[8:11], s24 offen offset:1536 sc1 lds
    v_mfma_f32_16x16x32_bf16 v[88:91], a[36:39], v[32:35], v[88:91]
    v_add_u32 v11, 2, v10
    v_and_b32 v13, 1, v11
    v_mfma_f32_16x16x32_bf16 v[92:95], v[16:19], a[40:43], v[92:95]
    buffer_load_dwordx4 a[8:11], v253, s[8:11], s28 offen offset:2048 sc1
    v_mfma_f32_16x16x32_bf16 v[96:99], v[20:23], a[40:43], v[96:99]
    v_cmp_eq_u32 s[20:21], 0, v13
    v_cmp_lt_i32 vcc, 1, v11
    v_cmp_gt_i32 s[18:19], 1, v11
    s_and_b64 vcc, vcc, s[20:21]
    s_and_b64 s[18:19], s[18:19], s[20:21]
    s_and_b64 s[20:21], vcc, s[38:39]
    v_cndmask_b32 v202, v12, 0, vcc
    v_cndmask_b32 v206, v12, 0, s[18:19]
    v_mfma_f32_16x16x32_bf16 v[100:103], v[24:27], a[40:43], v[100:103]
    buffer_load_dwordx4 a[12:15], v229, s[8:11], s28 offen offset:3072 sc1
    s_add_u32 s28, s28, 4096
    v_mfma_f32_16x16x32_bf16 v[104:107], v[28:31], a[40:43], v[104:107]
    v_cndmask_b32 v210, v12, 0, s[20:21]
    v_add_u32 v11, 3, v10
    v_mfma_f32_16x16x32_bf16 v[108:111], v[32:35], a[40:43], v[108:111]
    buffer_load_dwordx4 a[16:19], v253, s[8:11], s28 offen offset:0 sc1
    v_mfma_f32_16x16x32_bf16 v[112:115], a[44:47], v[16:19], v[112:115]
    v_and_b32 v13, 1, v11
    v_cmp_eq_u32 s[20:21], 0, v13
    v_cmp_lt_i32 vcc, 1, v11
    v_cmp_gt_i32 s[18:19], 1, v11
    s_and_b64 vcc, vcc, s[20:21]
    s_and_b64 s[18:19], s[18:19], s[20:21]
    s_and_b64 s[20:21], vcc, s[38:39]
    v_cndmask_b32 v203, v12, 0, vcc
    v_mfma_f32_16x16x32_bf16 v[116:119], a[44:47], v[20:23], v[116:119]
    v_cndmask_b32 v207, v12, 0, s[18:19]
    v_cndmask_b32 v211, v12, 0, s[20:21]
    v_mfma_f32_16x16x32_bf16 v[120:123], a[44:47], v[24:27], v[120:123]
    s_lshl_b32 s45, s41, 1
    s_lshr_b32 s7, s40, 2
    s_add_u32 s45, s45, s7
    s_mul_i32 s30, s45, 36864
    s_add_u32 s30, s30, s43
    s_and_b32 s31, s40, 3
    s_mul_i32 s31, s31, 9
    s_add_u32 s31, s31, s3
    s_mul_i32 s32, s31, 18432
    s_add_u32 s32, s32, 2359296
    s_add_u32 s33, s32, 73728
    s_add_u32 s34, s32, 147456
    s_mov_b32 s39, 19496960
    v_min_u32 v228, 44, v0
    v_lshlrev_b32 v228, 3, v228
    v_mfma_f32_16x16x32_bf16 v[124:127], a[44:47], v[28:31], v[124:127]
    s_cmp_eq_u32 s3, 1
    s_cmov_b32 s34, 3022848
    s_cmp_lt_u32 s3, 2
    s_cselect_b32 s35, 0, 1073741824
    v_add_u32 v5, s35, v253
    s_cmp_eq_u32 s3, 1
    s_cselect_b32 s7, 8, 0
    v_and_b32 v10, s7, v0
    v_mfma_f32_16x16x32_bf16 v[128:131], a[44:47], v[32:35], v[128:131]
    v_lshl_add_u32 v5, v10, 27, v5
    s_cmp_eq_u32 s3, 0
    s_cselect_b32 s35, 0, 1073741824
    v_add_u32 v7, s35, v9
    s_waitcnt lgkmcnt(0)
    v_mfma_f32_16x16x32_bf16 v[56:59], a[48:51], v[40:43], v[56:59]
    ds_read_b128 v[16:19], v253 offset:20480
    v_mfma_f32_16x16x32_bf16 v[60:63], a[48:51], v[44:47], v[60:63]
    ds_read_b128 v[20:23], v253 offset:21504
    v_mfma_f32_16x16x32_bf16 v[64:67], a[48:51], v[48:51], v[64:67]
    ds_read_b128 v[24:27], v253 offset:22528
    v_mfma_f32_16x16x32_bf16 v[68:71], a[48:51], v[52:55], v[68:71]
    ds_read_b128 v[28:31], v253 offset:23552
    v_mfma_f32_16x16x32_bf16 v[72:75], a[52:55], v[36:39], v[72:75]
    ds_read_b128 v[32:35], v253 offset:24576
    v_mfma_f32_16x16x32_bf16 v[76:79], a[52:55], v[40:43], v[76:79]
    s_add_u32 m0, s26, 30720
    s_add_u32 s7, s27, 3072
    buffer_load_dwordx4 v2, s[8:11], s7 offen sc1 lds
    v_mfma_f32_16x16x32_bf16 v[80:83], a[52:55], v[44:47], v[80:83]
    s_lshl_b32 s7, s31, 8
    s_add_u32 s36, s30, s7
    s_add_u32 s37, s36, 43515904
    s_add_u32 s46, s36, 45875200
    s_lshl_b32 s36, s45, 7
    s_add_u32 s36, s36, s43
    s_add_u32 s36, s36, 48431104
    s_lshl_b32 s47, s45, 9
    s_add_u32 s47, s47, s43
    s_add_u32 s47, s47, 48234496
    v_bfe_u32 v10, v0, 3, 2
    v_and_b32 v8, 7, v0
    v_mfma_f32_16x16x32_bf16 v[84:87], a[52:55], v[48:51], v[84:87]
    s_add_u32 m0, s29, 30720
    s_add_u32 s7, s23, 3072
    buffer_load_dwordx4 v2, s[8:11], s7 offen sc1 lds
    v_mfma_f32_16x16x32_bf16 v[88:91], a[52:55], v[52:55], v[88:91]
    v_lshlrev_b32 v8, 2, v8
    v_lshl_add_u32 v8, v10, 7, v8
    v_mfma_f32_16x16x32_bf16 v[92:95], v[36:39], a[56:59], v[92:95]
    buffer_load_dwordx4 a[20:23], v253, s[8:11], s28 offen offset:1024 sc1
    v_mfma_f32_16x16x32_bf16 v[96:99], v[40:43], a[56:59], v[96:99]
    v_mfma_f32_16x16x32_bf16 v[100:103], v[44:47], a[56:59], v[100:103]
    buffer_load_dwordx4 a[24:27], v253, s[8:11], s28 offen offset:2048 sc1
    v_mfma_f32_16x16x32_bf16 v[104:107], v[48:51], a[56:59], v[104:107]
    v_mfma_f32_16x16x32_bf16 v[108:111], v[52:55], a[56:59], v[108:111]
    buffer_load_dwordx4 a[28:31], v229, s[8:11], s28 offen offset:3072 sc1
    s_add_u32 s28, s28, 4096
    v_mfma_f32_16x16x32_bf16 v[112:115], a[60:63], v[36:39], v[112:115]
    v_mfma_f32_16x16x32_bf16 v[116:119], a[60:63], v[40:43], v[116:119]
    v_mfma_f32_16x16x32_bf16 v[120:123], a[60:63], v[44:47], v[120:123]
    v_mfma_f32_16x16x32_bf16 v[124:127], a[60:63], v[48:51], v[124:127]
    v_mfma_f32_16x16x32_bf16 v[128:131], a[60:63], v[52:55], v[128:131]
    s_waitcnt lgkmcnt(0)
    v_mfma_f32_16x16x32_bf16 v[56:59], a[64:67], v[20:23], v[56:59]
    ds_read_b128 v[36:39], v253 offset:25600
    v_mfma_f32_16x16x32_bf16 v[60:63], a[64:67], v[24:27], v[60:63]
    ds_read_b128 v[40:43], v253 offset:26624
    v_mfma_f32_16x16x32_bf16 v[64:67], a[64:67], v[28:31], v[64:67]
    ds_read_b128 v[44:47], v253 offset:27648
    v_mfma_f32_16x16x32_bf16 v[68:71], a[64:67], v[32:35], v[68:71]
    ds_read_b128 v[48:51], v253 offset:28672
    v_mfma_f32_16x16x32_bf16 v[72:75], a[68:71], v[16:19], v[72:75]
    ds_read_b128 v[52:55], v253 offset:29696
    v_mfma_f32_16x16x32_bf16 v[76:79], a[68:71], v[20:23], v[76:79]
    buffer_load_dwordx4 a[32:35], v253, s[8:11], s28 offen offset:0 sc1
    v_mfma_f32_16x16x32_bf16 v[80:83], a[68:71], v[24:27], v[80:83]
    v_mfma_f32_16x16x32_bf16 v[84:87], a[68:71], v[28:31], v[84:87]
    buffer_load_dwordx4 a[36:39], v253, s[8:11], s28 offen offset:1024 sc1
    v_mfma_f32_16x16x32_bf16 v[88:91], a[68:71], v[32:35], v[88:91]
    v_mfma_f32_16x16x32_bf16 v[92:95], v[16:19], a[72:75], v[92:95]
    buffer_load_dwordx4 a[40:43], v253, s[8:11], s28 offen offset:2048 sc1
    v_mfma_f32_16x16x32_bf16 v[96:99], v[20:23], a[72:75], v[96:99]
    v_mfma_f32_16x16x32_bf16 v[100:103], v[24:27], a[72:75], v[100:103]
    v_mfma_f32_16x16x32_bf16 v[104:107], v[28:31], a[72:75], v[104:107]
    v_mfma_f32_16x16x32_bf16 v[108:111], v[32:35], a[72:75], v[108:111]
    v_mfma_f32_16x16x32_bf16 v[112:115], a[76:79], v[16:19], v[112:115]
    v_mfma_f32_16x16x32_bf16 v[116:119], a[76:79], v[20:23], v[116:119]
    v_mfma_f32_16x16x32_bf16 v[120:123], a[76:79], v[24:27], v[120:123]
    v_mfma_f32_16x16x32_bf16 v[124:127], a[76:79], v[28:31], v[124:127]
    v_mfma_f32_16x16x32_bf16 v[128:131], a[76:79], v[32:35], v[128:131]
    s_waitcnt vmcnt(6) lgkmcnt(0)
    s_barrier
    v_mfma_f32_16x16x32_bf16 v[56:59], a[80:83], v[40:43], v[56:59]
    ds_read_b128 v[16:19], v253 offset:30720
    v_mfma_f32_16x16x32_bf16 v[60:63], a[80:83], v[44:47], v[60:63]
    ds_read_b128 v[20:23], v253 offset:31744
    v_mfma_f32_16x16x32_bf16 v[64:67], a[80:83], v[48:51], v[64:67]
    ds_read_b128 v[24:27], v253 offset:32768
    v_mfma_f32_16x16x32_bf16 v[68:71], a[80:83], v[52:55], v[68:71]
    ds_read_b128 v[28:31], v253 offset:33792
    v_mfma_f32_16x16x32_bf16 v[72:75], a[84:87], v[36:39], v[72:75]
    ds_read_b128 v[32:35], v253 offset:34816
    v_mfma_f32_16x16x32_bf16 v[76:79], a[84:87], v[40:43], v[76:79]
    s_add_u32 m0, s25, 59392
    s_nop 0
    buffer_load_dwordx4 v2, s[8:11], s24 offen offset:2048 sc1 lds
    v_mfma_f32_16x16x32_bf16 v[80:83], a[84:87], v[44:47], v[80:83]
    v_mfma_f32_16x16x32_bf16 v[84:87], a[84:87], v[48:51], v[84:87]
    s_add_u32 m0, s25, 64000
    s_nop 0
    buffer_load_dwordx4 v2, s[8:11], s24 offen offset:2560 sc1 lds
    v_mfma_f32_16x16x32_bf16 v[88:91], a[84:87], v[52:55], v[88:91]
    v_mfma_f32_16x16x32_bf16 v[92:95], v[36:39], a[88:91], v[92:95]
    buffer_load_dwordx4 a[44:47], v229, s[8:11], s28 offen offset:3072 sc1
    s_add_u32 s28, s28, 4096
    v_mfma_f32_16x16x32_bf16 v[96:99], v[40:43], a[88:91], v[96:99]
    v_mfma_f32_16x16x32_bf16 v[100:103], v[44:47], a[88:91], v[100:103]
    buffer_load_dwordx4 a[48:51], v253, s[8:11], s28 offen offset:0 sc1
    v_mfma_f32_16x16x32_bf16 v[104:107], v[48:51], a[88:91], v[104:107]
    v_mfma_f32_16x16x32_bf16 v[108:111], v[52:55], a[88:91], v[108:111]
    buffer_load_dwordx4 a[52:55], v253, s[8:11], s28 offen offset:1024 sc1
    v_mfma_f32_16x16x32_bf16 v[112:115], a[92:95], v[36:39], v[112:115]
    v_mfma_f32_16x16x32_bf16 v[116:119], a[92:95], v[40:43], v[116:119]
    v_mfma_f32_16x16x32_bf16 v[120:123], a[92:95], v[44:47], v[120:123]
    v_mfma_f32_16x16x32_bf16 v[124:127], a[92:95], v[48:51], v[124:127]
    v_mfma_f32_16x16x32_bf16 v[128:131], a[92:95], v[52:55], v[128:131]
    s_waitcnt lgkmcnt(0)
    v_mfma_f32_16x16x32_bf16 v[56:59], a[96:99], v[20:23], v[56:59]
    ds_read_b128 v[36:39], v253 offset:35840
    v_mfma_f32_16x16x32_bf16 v[60:63], a[96:99], v[24:27], v[60:63]
    ds_read_b128 v[40:43], v253 offset:36864
    v_mfma_f32_16x16x32_bf16 v[64:67], a[96:99], v[28:31], v[64:67]
    ds_read_b128 v[44:47], v253 offset:37888
    v_mfma_f32_16x16x32_bf16 v[68:71], a[96:99], v[32:35], v[68:71]
    ds_read_b128 v[48:51], v253 offset:38912
    v_mfma_f32_16x16x32_bf16 v[72:75], a[100:103], v[16:19], v[72:75]
    ds_read_b128 v[52:55], v253 offset:39936
    v_mfma_f32_16x16x32_bf16 v[76:79], a[100:103], v[20:23], v[76:79]
    s_add_u32 m0, s25, 68608
    s_nop 0
    buffer_load_dwordx4 v2, s[8:11], s24 offen offset:3072 sc1 lds
    v_mfma_f32_16x16x32_bf16 v[80:83], a[100:103], v[24:27], v[80:83]
    v_mfma_f32_16x16x32_bf16 v[84:87], a[100:103], v[28:31], v[84:87]
    s_add_u32 m0, s25, 73216
    s_nop 0
    buffer_load_dwordx4 v2, s[8:11], s24 offen offset:3584 sc1 lds
    v_mfma_f32_16x16x32_bf16 v[88:91], a[100:103], v[32:35], v[88:91]
    v_mfma_f32_16x16x32_bf16 v[92:95], v[16:19], a[104:107], v[92:95]
    buffer_load_dwordx4 a[56:59], v253, s[8:11], s28 offen offset:2048 sc1
    v_mfma_f32_16x16x32_bf16 v[96:99], v[20:23], a[104:107], v[96:99]
    v_mfma_f32_16x16x32_bf16 v[100:103], v[24:27], a[104:107], v[100:103]
    buffer_load_dwordx4 a[60:63], v229, s[8:11], s28 offen offset:3072 sc1
    s_add_u32 s28, s28, 4096
    v_mfma_f32_16x16x32_bf16 v[104:107], v[28:31], a[104:107], v[104:107]
    v_mfma_f32_16x16x32_bf16 v[108:111], v[32:35], a[104:107], v[108:111]
    buffer_load_dwordx4 a[64:67], v253, s[8:11], s28 offen offset:0 sc1
    v_mfma_f32_16x16x32_bf16 v[112:115], a[108:111], v[16:19], v[112:115]
    v_mfma_f32_16x16x32_bf16 v[116:119], a[108:111], v[20:23], v[116:119]
    buffer_load_dwordx2 v[226:227], v228, s[8:11], s39 offen sc1
    v_mfma_f32_16x16x32_bf16 v[120:123], a[108:111], v[24:27], v[120:123]
    v_mfma_f32_16x16x32_bf16 v[124:127], a[108:111], v[28:31], v[124:127]
    v_mfma_f32_16x16x32_bf16 v[128:131], a[108:111], v[32:35], v[128:131]
    s_waitcnt lgkmcnt(0)
    v_mfma_f32_16x16x32_bf16 v[56:59], a[112:115], v[40:43], v[56:59]
    ds_read_b128 v[16:19], v253 offset:40960
    v_mfma_f32_16x16x32_bf16 v[60:63], a[112:115], v[44:47], v[60:63]
    ds_read_b128 v[20:23], v253 offset:41984
    v_mfma_f32_16x16x32_bf16 v[64:67], a[112:115], v[48:51], v[64:67]
    ds_read_b128 v[24:27], v253 offset:43008
    v_mfma_f32_16x16x32_bf16 v[68:71], a[112:115], v[52:55], v[68:71]
    ds_read_b128 v[28:31], v253 offset:44032
    v_mfma_f32_16x16x32_bf16 v[72:75], a[116:119], v[36:39], v[72:75]
    ds_read_b128 v[32:35], v253 offset:45056
    v_mfma_f32_16x16x32_bf16 v[76:79], a[116:119], v[40:43], v[76:79]
    s_add_u32 m0, s25, 81920
    s_add_u32 s24, s24, 4096
    buffer_load_dwordx4 v2, s[8:11], s24 offen offset:0 sc1 lds
    v_mfma_f32_16x16x32_bf16 v[80:83], a[116:119], v[44:47], v[80:83]
    v_mfma_f32_16x16x32_bf16 v[84:87], a[116:119], v[48:51], v[84:87]
    s_add_u32 m0, s25, 86528
    s_nop 0
    buffer_load_dwordx4 v2, s[8:11], s24 offen offset:512 sc1 lds
    v_mfma_f32_16x16x32_bf16 v[88:91], a[116:119], v[52:55], v[88:91]
    v_mfma_f32_16x16x32_bf16 v[92:95], v[36:39], a[120:123], v[92:95]
    buffer_load_dwordx4 a[68:71], v253, s[8:11], s28 offen offset:1024 sc1
    v_mfma_f32_16x16x32_bf16 v[96:99], v[40:43], a[120:123], v[96:99]
    v_mfma_f32_16x16x32_bf16 v[100:103], v[44:47], a[120:123], v[100:103]
    buffer_load_dwordx4 a[72:75], v253, s[8:11], s28 offen offset:2048 sc1
    v_mfma_f32_16x16x32_bf16 v[104:107], v[48:51], a[120:123], v[104:107]
    v_mfma_f32_16x16x32_bf16 v[108:111], v[52:55], a[120:123], v[108:111]
    buffer_load_dwordx4 a[76:79], v229, s[8:11], s28 offen offset:3072 sc1
    s_add_u32 s28, s28, 4096
    v_mfma_f32_16x16x32_bf16 v[112:115], a[124:127], v[36:39], v[112:115]
    v_mfma_f32_16x16x32_bf16 v[116:119], a[124:127], v[40:43], v[116:119]
    v_mfma_f32_16x16x32_bf16 v[120:123], a[124:127], v[44:47], v[120:123]
    v_mfma_f32_16x16x32_bf16 v[124:127], a[124:127], v[48:51], v[124:127]
    v_mfma_f32_16x16x32_bf16 v[128:131], a[124:127], v[52:55], v[128:131]
    s_waitcnt lgkmcnt(0)
    v_mfma_f32_16x16x32_bf16 v[56:59], a[128:131], v[20:23], v[56:59]
    ds_read_b128 v[36:39], v6 offset:0
    v_mfma_f32_16x16x32_bf16 v[60:63], a[128:131], v[24:27], v[60:63]
    ds_read_b128 v[40:43], v6 offset:1024
    v_mfma_f32_16x16x32_bf16 v[64:67], a[128:131], v[28:31], v[64:67]
    ds_read_b128 v[44:47], v6 offset:2048
    v_mfma_f32_16x16x32_bf16 v[68:71], a[128:131], v[32:35], v[68:71]
    ds_read_b128 v[48:51], v6 offset:3072
    v_mfma_f32_16x16x32_bf16 v[72:75], a[132:135], v[16:19], v[72:75]
    ds_read_b128 v[52:55], v6 offset:4096
    v_mfma_f32_16x16x32_bf16 v[76:79], a[132:135], v[20:23], v[76:79]
    s_add_u32 m0, s26, 61440
    s_add_u32 s7, s27, 6144
    buffer_load_dwordx4 v2, s[8:11], s7 offen sc1 lds
    v_mfma_f32_16x16x32_bf16 v[80:83], a[132:135], v[24:27], v[80:83]
    v_mfma_f32_16x16x32_bf16 v[84:87], a[132:135], v[28:31], v[84:87]
    s_add_u32 m0, s29, 61440
    s_add_u32 s7, s23, 6144
    buffer_load_dwordx4 v2, s[8:11], s7 offen sc1 lds
    v_mfma_f32_16x16x32_bf16 v[88:91], a[132:135], v[32:35], v[88:91]
    v_mfma_f32_16x16x32_bf16 v[92:95], v[16:19], a[136:139], v[92:95]
    buffer_load_dwordx4 a[80:83], v253, s[8:11], s28 offen offset:0 sc1
    v_mfma_f32_16x16x32_bf16 v[96:99], v[20:23], a[136:139], v[96:99]
    v_mfma_f32_16x16x32_bf16 v[100:103], v[24:27], a[136:139], v[100:103]
    buffer_load_dwordx4 a[84:87], v253, s[8:11], s28 offen offset:1024 sc1
    v_mfma_f32_16x16x32_bf16 v[104:107], v[28:31], a[136:139], v[104:107]
    v_mfma_f32_16x16x32_bf16 v[108:111], v[32:35], a[136:139], v[108:111]
    buffer_load_dwordx4 a[88:91], v253, s[8:11], s28 offen offset:2048 sc1
    v_mfma_f32_16x16x32_bf16 v[112:115], a[140:143], v[16:19], v[112:115]
    v_mfma_f32_16x16x32_bf16 v[116:119], a[140:143], v[20:23], v[116:119]
    v_mfma_f32_16x16x32_bf16 v[120:123], a[140:143], v[24:27], v[120:123]
    v_mfma_f32_16x16x32_bf16 v[124:127], a[140:143], v[28:31], v[124:127]
    v_mfma_f32_16x16x32_bf16 v[128:131], a[140:143], v[32:35], v[128:131]
    s_waitcnt vmcnt(10) lgkmcnt(0)
    s_mov_b32 s6, 0
L_wo_poll_21:
    v_cmp_eq_u32 vcc, s76, v226
    v_cmp_eq_u32 s[20:21], s76, v227
    s_and_b64 vcc, vcc, s[20:21]
    s_cmp_eq_u64 vcc, exec
    s_cbranch_scc1 L_wo_ready_22
    buffer_load_dwordx2 v[226:227], v228, s[8:11], s39 offen sc1
    s_add_u32 s6, s6, 1
    s_cmp_lt_u32 s6, 1048576
    s_waitcnt vmcnt(0)
    s_cbranch_scc1 L_wo_poll_21
    s_branch L_main_end
L_wo_ready_22:
    v_mfma_f32_16x16x32_bf16 v[56:59], a[144:147], v[40:43], v[56:59]
    ds_read_b128 v[16:19], v6 offset:5120
    v_mfma_f32_16x16x32_bf16 v[60:63], a[144:147], v[44:47], v[60:63]
    ds_read_b128 v[20:23], v6 offset:6144
    v_mfma_f32_16x16x32_bf16 v[64:67], a[144:147], v[48:51], v[64:67]
    ds_read_b128 v[24:27], v6 offset:7168
    v_mfma_f32_16x16x32_bf16 v[68:71], a[144:147], v[52:55], v[68:71]
    ds_read_b128 v[28:31], v6 offset:8192
    v_mfma_f32_16x16x32_bf16 v[72:75], a[148:151], v[36:39], v[72:75]
    ds_read_b128 v[32:35], v6 offset:9216
    v_mfma_f32_16x16x32_bf16 v[76:79], a[148:151], v[40:43], v[76:79]
    buffer_load_dwordx4 a[92:95], v229, s[8:11], s28 offen offset:3072 sc1
    s_add_u32 s28, s28, 4096
    v_mfma_f32_16x16x32_bf16 v[80:83], a[148:151], v[44:47], v[80:83]
    v_mfma_f32_16x16x32_bf16 v[84:87], a[148:151], v[48:51], v[84:87]
    buffer_load_dwordx4 a[96:99], v253, s[8:11], s28 offen offset:0 sc1
    v_mfma_f32_16x16x32_bf16 v[88:91], a[148:151], v[52:55], v[88:91]
    v_mfma_f32_16x16x32_bf16 v[92:95], v[36:39], a[152:155], v[92:95]
    buffer_load_dwordx4 a[100:103], v253, s[8:11], s28 offen offset:1024 sc1
    v_mfma_f32_16x16x32_bf16 v[96:99], v[40:43], a[152:155], v[96:99]
    v_mfma_f32_16x16x32_bf16 v[100:103], v[44:47], a[152:155], v[100:103]
    buffer_load_dwordx4 a[160:163], v253, s[8:11], s32 offen offset:0 sc1
    v_mfma_f32_16x16x32_bf16 v[104:107], v[48:51], a[152:155], v[104:107]
    v_mfma_f32_16x16x32_bf16 v[108:111], v[52:55], a[152:155], v[108:111]
    v_mfma_f32_16x16x32_bf16 v[112:115], a[156:159], v[36:39], v[112:115]
    v_mfma_f32_16x16x32_bf16 v[116:119], a[156:159], v[40:43], v[116:119]
    v_mfma_f32_16x16x32_bf16 v[120:123], a[156:159], v[44:47], v[120:123]
    v_mfma_f32_16x16x32_bf16 v[124:127], a[156:159], v[48:51], v[124:127]
    v_mfma_f32_16x16x32_bf16 v[128:131], a[156:159], v[52:55], v[128:131]
    s_waitcnt vmcnt(34) lgkmcnt(0)
    v_mfma_f32_16x16x32_bf16 v[56:59], a[0:3], v[20:23], v[56:59]
    ds_read_b128 v[36:39], v6 offset:10240
    v_mfma_f32_16x16x32_bf16 v[60:63], a[0:3], v[24:27], v[60:63]
    ds_read_b128 v[40:43], v6 offset:11264
    v_mfma_f32_16x16x32_bf16 v[64:67], a[0:3], v[28:31], v[64:67]
    ds_read_b128 v[44:47], v6 offset:12288
    v_mfma_f32_16x16x32_bf16 v[68:71], a[0:3], v[32:35], v[68:71]
    ds_read_b128 v[48:51], v6 offset:13312
    v_mfma_f32_16x16x32_bf16 v[72:75], a[4:7], v[16:19], v[72:75]
    ds_read_b128 v[52:55], v6 offset:14336
    v_mfma_f32_16x16x32_bf16 v[76:79], a[4:7], v[20:23], v[76:79]
    buffer_load_dwordx4 a[104:107], v253, s[8:11], s28 offen offset:2048 sc1
    v_mfma_f32_16x16x32_bf16 v[80:83], a[4:7], v[24:27], v[80:83]
    v_mfma_f32_16x16x32_bf16 v[84:87], a[4:7], v[28:31], v[84:87]
    buffer_load_dwordx4 a[108:111], v229, s[8:11], s28 offen offset:3072 sc1
    s_add_u32 s28, s28, 4096
    v_mfma_f32_16x16x32_bf16 v[88:91], a[4:7], v[32:35], v[88:91]
    v_mfma_f32_16x16x32_bf16 v[92:95], v[16:19], a[8:11], v[92:95]
    buffer_load_dwordx4 a[112:115], v253, s[8:11], s28 offen offset:0 sc1
    v_mfma_f32_16x16x32_bf16 v[96:99], v[20:23], a[8:11], v[96:99]
    v_mfma_f32_16x16x32_bf16 v[100:103], v[24:27], a[8:11], v[100:103]
    buffer_load_dwordx4 a[164:167], v253, s[8:11], s33 offen offset:0 sc1
    v_mfma_f32_16x16x32_bf16 v[104:107], v[28:31], a[8:11], v[104:107]
    v_mfma_f32_16x16x32_bf16 v[108:111], v[32:35], a[8:11], v[108:111]
    v_mfma_f32_16x16x32_bf16 v[112:115], a[12:15], v[16:19], v[112:115]
    v_mfma_f32_16x16x32_bf16 v[116:119], a[12:15], v[20:23], v[116:119]
    v_mfma_f32_16x16x32_bf16 v[120:123], a[12:15], v[24:27], v[120:123]
    v_mfma_f32_16x16x32_bf16 v[124:127], a[12:15], v[28:31], v[124:127]
    v_mfma_f32_16x16x32_bf16 v[128:131], a[12:15], v[32:35], v[128:131]
    s_waitcnt vmcnt(11) lgkmcnt(0)
    s_barrier
    v_mfma_f32_16x16x32_bf16 v[56:59], a[16:19], v[40:43], v[56:59]
    ds_read_b128 v[16:19], v6 offset:15360
    v_mfma_f32_16x16x32_bf16 v[60:63], a[16:19], v[44:47], v[60:63]
    ds_read_b128 v[20:23], v6 offset:16384
    v_mfma_f32_16x16x32_bf16 v[64:67], a[16:19], v[48:51], v[64:67]
    ds_read_b128 v[24:27], v6 offset:17408
    v_mfma_f32_16x16x32_bf16 v[68:71], a[16:19], v[52:55], v[68:71]
    ds_read_b128 v[28:31], v6 offset:18432
    v_mfma_f32_16x16x32_bf16 v[72:75], a[20:23], v[36:39], v[72:75]
    ds_read_b128 v[32:35], v6 offset:19456
    v_mfma_f32_16x16x32_bf16 v[76:79], a[20:23], v[40:43], v[76:79]
    buffer_load_dwordx4 a[116:119], v253, s[8:11], s28 offen offset:1024 sc1
    v_mfma_f32_16x16x32_bf16 v[80:83], a[20:23], v[44:47], v[80:83]
    v_mfma_f32_16x16x32_bf16 v[84:87], a[20:23], v[48:51], v[84:87]
    buffer_load_dwordx4 a[120:123], v253, s[8:11], s28 offen offset:2048 sc1
    v_mfma_f32_16x16x32_bf16 v[88:91], a[20:23], v[52:55], v[88:91]
    v_mfma_f32_16x16x32_bf16 v[92:95], v[36:39], a[24:27], v[92:95]
    buffer_load_dwordx4 a[124:127], v229, s[8:11], s28 offen offset:3072 sc1
    s_add_u32 s28, s28, 4096
    v_mfma_f32_16x16x32_bf16 v[96:99], v[40:43], a[24:27], v[96:99]
    v_mfma_f32_16x16x32_bf16 v[100:103], v[44:47], a[24:27], v[100:103]
    buffer_load_dwordx4 a[168:171], v5, s[8:11], s34 offen offset:0 sc1
    v_mfma_f32_16x16x32_bf16 v[104:107], v[48:51], a[24:27], v[104:107]
    v_mfma_f32_16x16x32_bf16 v[108:111], v[52:55], a[24:27], v[108:111]
    v_mfma_f32_16x16x32_bf16 v[112:115], a[28:31], v[36:39], v[112:115]
    v_mfma_f32_16x16x32_bf16 v[116:119], a[28:31], v[40:43], v[116:119]
    v_mfma_f32_16x16x32_bf16 v[120:123], a[28:31], v[44:47], v[120:123]
    v_mfma_f32_16x16x32_bf16 v[124:127], a[28:31], v[48:51], v[124:127]
    v_mfma_f32_16x16x32_bf16 v[128:131], a[28:31], v[52:55], v[128:131]
    s_waitcnt vmcnt(30) lgkmcnt(0)
    v_mfma_f32_16x16x32_bf16 v[56:59], a[32:35], v[20:23], v[56:59]
    ds_read_b128 v[36:39], v6 offset:20480
    v_mfma_f32_16x16x32_bf16 v[60:63], a[32:35], v[24:27], v[60:63]
    ds_read_b128 v[40:43], v6 offset:21504
    v_mfma_f32_16x16x32_bf16 v[64:67], a[32:35], v[28:31], v[64:67]
    ds_read_b128 v[44:47], v6 offset:22528
    v_mfma_f32_16x16x32_bf16 v[68:71], a[32:35], v[32:35], v[68:71]
    ds_read_b128 v[48:51], v6 offset:23552
    v_mfma_f32_16x16x32_bf16 v[72:75], a[36:39], v[16:19], v[72:75]
    ds_read_b128 v[52:55], v6 offset:24576
    v_mfma_f32_16x16x32_bf16 v[76:79], a[36:39], v[20:23], v[76:79]
    buffer_load_dwordx4 a[172:175], v253, s[8:11], s32 offen offset:1024 sc1
    v_mfma_f32_16x16x32_bf16 v[80:83], a[36:39], v[24:27], v[80:83]
    v_mfma_f32_16x16x32_bf16 v[84:87], a[36:39], v[28:31], v[84:87]
    buffer_load_dwordx4 a[176:179], v253, s[8:11], s33 offen offset:1024 sc1
    v_mfma_f32_16x16x32_bf16 v[88:91], a[36:39], v[32:35], v[88:91]
    v_mfma_f32_16x16x32_bf16 v[92:95], v[16:19], a[40:43], v[92:95]
    buffer_load_dwordx4 a[180:183], v5, s[8:11], s34 offen offset:1024 sc1
    v_mfma_f32_16x16x32_bf16 v[96:99], v[20:23], a[40:43], v[96:99]
    v_mfma_f32_16x16x32_bf16 v[100:103], v[24:27], a[40:43], v[100:103]
    buffer_load_dwordx4 a[184:187], v253, s[8:11], s32 offen offset:2048 sc1
    v_mfma_f32_16x16x32_bf16 v[104:107], v[28:31], a[40:43], v[104:107]
    v_mfma_f32_16x16x32_bf16 v[108:111], v[32:35], a[40:43], v[108:111]
    v_mfma_f32_16x16x32_bf16 v[112:115], a[44:47], v[16:19], v[112:115]
    v_mfma_f32_16x16x32_bf16 v[116:119], a[44:47], v[20:23], v[116:119]
    v_mfma_f32_16x16x32_bf16 v[120:123], a[44:47], v[24:27], v[120:123]
    v_mfma_f32_16x16x32_bf16 v[124:127], a[44:47], v[28:31], v[124:127]
    v_mfma_f32_16x16x32_bf16 v[128:131], a[44:47], v[32:35], v[128:131]
    s_waitcnt vmcnt(28) lgkmcnt(0)
    v_mfma_f32_16x16x32_bf16 v[56:59], a[48:51], v[40:43], v[56:59]
    ds_read_b128 v[16:19], v6 offset:25600
    v_mfma_f32_16x16x32_bf16 v[60:63], a[48:51], v[44:47], v[60:63]
    ds_read_b128 v[20:23], v6 offset:26624
    v_mfma_f32_16x16x32_bf16 v[64:67], a[48:51], v[48:51], v[64:67]
    ds_read_b128 v[24:27], v6 offset:27648
    v_mfma_f32_16x16x32_bf16 v[68:71], a[48:51], v[52:55], v[68:71]
    ds_read_b128 v[28:31], v6 offset:28672
    v_mfma_f32_16x16x32_bf16 v[72:75], a[52:55], v[36:39], v[72:75]
    ds_read_b128 v[32:35], v6 offset:29696
    v_mfma_f32_16x16x32_bf16 v[76:79], a[52:55], v[40:43], v[76:79]
    buffer_load_dwordx4 a[188:191], v253, s[8:11], s33 offen offset:2048 sc1
    v_mfma_f32_16x16x32_bf16 v[80:83], a[52:55], v[44:47], v[80:83]
    v_mfma_f32_16x16x32_bf16 v[84:87], a[52:55], v[48:51], v[84:87]
    buffer_load_dwordx4 a[192:195], v5, s[8:11], s34 offen offset:2048 sc1
    v_mfma_f32_16x16x32_bf16 v[88:91], a[52:55], v[52:55], v[88:91]
    v_mfma_f32_16x16x32_bf16 v[92:95], v[36:39], a[56:59], v[92:95]
    buffer_load_dwordx4 a[196:199], v253, s[8:11], s32 offen offset:3072 sc1
    s_add_u32 s32, s32, 4096
    v_mfma_f32_16x16x32_bf16 v[96:99], v[40:43], a[56:59], v[96:99]
    v_mfma_f32_16x16x32_bf16 v[100:103], v[44:47], a[56:59], v[100:103]
    buffer_load_dwordx4 a[200:203], v253, s[8:11], s33 offen offset:3072 sc1
    s_add_u32 s33, s33, 4096
    v_mfma_f32_16x16x32_bf16 v[104:107], v[48:51], a[56:59], v[104:107]
    v_mfma_f32_16x16x32_bf16 v[108:111], v[52:55], a[56:59], v[108:111]
    v_mfma_f32_16x16x32_bf16 v[112:115], a[60:63], v[36:39], v[112:115]
    v_mfma_f32_16x16x32_bf16 v[116:119], a[60:63], v[40:43], v[116:119]
    v_mfma_f32_16x16x32_bf16 v[120:123], a[60:63], v[44:47], v[120:123]
    v_mfma_f32_16x16x32_bf16 v[124:127], a[60:63], v[48:51], v[124:127]
    v_mfma_f32_16x16x32_bf16 v[128:131], a[60:63], v[52:55], v[128:131]
    s_waitcnt vmcnt(25) lgkmcnt(0)
    v_mfma_f32_16x16x32_bf16 v[56:59], a[64:67], v[20:23], v[56:59]
    ds_read_b128 v[36:39], v6 offset:30720
    v_mfma_f32_16x16x32_bf16 v[60:63], a[64:67], v[24:27], v[60:63]
    ds_read_b128 v[40:43], v6 offset:31744
    v_mfma_f32_16x16x32_bf16 v[64:67], a[64:67], v[28:31], v[64:67]
    ds_read_b128 v[44:47], v6 offset:32768
    v_mfma_f32_16x16x32_bf16 v[68:71], a[64:67], v[32:35], v[68:71]
    ds_read_b128 v[48:51], v6 offset:33792
    v_mfma_f32_16x16x32_bf16 v[72:75], a[68:71], v[16:19], v[72:75]
    ds_read_b128 v[52:55], v6 offset:34816
    v_mfma_f32_16x16x32_bf16 v[76:79], a[68:71], v[20:23], v[76:79]
    buffer_load_dwordx4 a[204:207], v5, s[8:11], s34 offen offset:3072 sc1
    s_add_u32 s34, s34, 4096
    v_mfma_f32_16x16x32_bf16 v[80:83], a[68:71], v[24:27], v[80:83]
    v_mfma_f32_16x16x32_bf16 v[84:87], a[68:71], v[28:31], v[84:87]
    buffer_load_dwordx4 a[208:211], v253, s[8:11], s32 offen offset:0 sc1
    v_mfma_f32_16x16x32_bf16 v[88:91], a[68:71], v[32:35], v[88:91]
    v_mfma_f32_16x16x32_bf16 v[92:95], v[16:19], a[72:75], v[92:95]
    buffer_load_dwordx4 a[212:215], v253, s[8:11], s33 offen offset:0 sc1
    v_mfma_f32_16x16x32_bf16 v[96:99], v[20:23], a[72:75], v[96:99]
    v_mfma_f32_16x16x32_bf16 v[100:103], v[24:27], a[72:75], v[100:103]
    buffer_load_dwordx4 a[216:219], v5, s[8:11], s34 offen offset:0 sc1
    v_mfma_f32_16x16x32_bf16 v[104:107], v[28:31], a[72:75], v[104:107]
    v_mfma_f32_16x16x32_bf16 v[108:111], v[32:35], a[72:75], v[108:111]
    v_mfma_f32_16x16x32_bf16 v[112:115], a[76:79], v[16:19], v[112:115]
    v_mfma_f32_16x16x32_bf16 v[116:119], a[76:79], v[20:23], v[116:119]
    v_mfma_f32_16x16x32_bf16 v[120:123], a[76:79], v[24:27], v[120:123]
    v_mfma_f32_16x16x32_bf16 v[124:127], a[76:79], v[28:31], v[124:127]
    v_mfma_f32_16x16x32_bf16 v[128:131], a[76:79], v[32:35], v[128:131]
    s_waitcnt vmcnt(23) lgkmcnt(0)
    v_mfma_f32_16x16x32_bf16 v[56:59], a[80:83], v[40:43], v[56:59]
    ds_read_b128 v[16:19], v6 offset:35840
    v_mfma_f32_16x16x32_bf16 v[60:63], a[80:83], v[44:47], v[60:63]
    ds_read_b128 v[20:23], v6 offset:36864
    v_mfma_f32_16x16x32_bf16 v[64:67], a[80:83], v[48:51], v[64:67]
    ds_read_b128 v[24:27], v6 offset:37888
    v_mfma_f32_16x16x32_bf16 v[68:71], a[80:83], v[52:55], v[68:71]
    ds_read_b128 v[28:31], v6 offset:38912
    v_mfma_f32_16x16x32_bf16 v[72:75], a[84:87], v[36:39], v[72:75]
    ds_read_b128 v[32:35], v6 offset:39936
    v_mfma_f32_16x16x32_bf16 v[76:79], a[84:87], v[40:43], v[76:79]
    buffer_load_dwordx4 a[220:223], v253, s[8:11], s32 offen offset:1024 sc1
    v_mfma_f32_16x16x32_bf16 v[80:83], a[84:87], v[44:47], v[80:83]
    v_mfma_f32_16x16x32_bf16 v[84:87], a[84:87], v[48:51], v[84:87]
    buffer_load_dwordx4 a[224:227], v253, s[8:11], s33 offen offset:1024 sc1
    v_mfma_f32_16x16x32_bf16 v[88:91], a[84:87], v[52:55], v[88:91]
    v_mfma_f32_16x16x32_bf16 v[92:95], v[36:39], a[88:91], v[92:95]
    buffer_load_dwordx4 a[228:231], v5, s[8:11], s34 offen offset:1024 sc1
    v_mfma_f32_16x16x32_bf16 v[96:99], v[40:43], a[88:91], v[96:99]
    v_mfma_f32_16x16x32_bf16 v[100:103], v[44:47], a[88:91], v[100:103]
    buffer_load_dwordx4 a[232:235], v253, s[8:11], s32 offen offset:2048 sc1
    v_mfma_f32_16x16x32_bf16 v[104:107], v[48:51], a[88:91], v[104:107]
    v_mfma_f32_16x16x32_bf16 v[108:111], v[52:55], a[88:91], v[108:111]
    v_mfma_f32_16x16x32_bf16 v[112:115], a[92:95], v[36:39], v[112:115]
    v_mfma_f32_16x16x32_bf16 v[116:119], a[92:95], v[40:43], v[116:119]
    v_mfma_f32_16x16x32_bf16 v[120:123], a[92:95], v[44:47], v[120:123]
    v_mfma_f32_16x16x32_bf16 v[124:127], a[92:95], v[48:51], v[124:127]
    v_mfma_f32_16x16x32_bf16 v[128:131], a[92:95], v[52:55], v[128:131]
    s_waitcnt vmcnt(22) lgkmcnt(0)
    v_mfma_f32_16x16x32_bf16 v[56:59], a[96:99], v[20:23], v[56:59]
    ds_read_b128 v[36:39], v6 offset:40960
    v_mfma_f32_16x16x32_bf16 v[60:63], a[96:99], v[24:27], v[60:63]
    ds_read_b128 v[40:43], v6 offset:41984
    v_mfma_f32_16x16x32_bf16 v[64:67], a[96:99], v[28:31], v[64:67]
    ds_read_b128 v[44:47], v6 offset:43008
    v_mfma_f32_16x16x32_bf16 v[68:71], a[96:99], v[32:35], v[68:71]
    ds_read_b128 v[48:51], v6 offset:44032
    v_mfma_f32_16x16x32_bf16 v[72:75], a[100:103], v[16:19], v[72:75]
    ds_read_b128 v[52:55], v6 offset:45056
    v_mfma_f32_16x16x32_bf16 v[76:79], a[100:103], v[20:23], v[76:79]
    buffer_load_dwordx4 a[236:239], v253, s[8:11], s33 offen offset:2048 sc1
    v_mfma_f32_16x16x32_bf16 v[80:83], a[100:103], v[24:27], v[80:83]
    v_mfma_f32_16x16x32_bf16 v[84:87], a[100:103], v[28:31], v[84:87]
    buffer_load_dwordx4 a[240:243], v5, s[8:11], s34 offen offset:2048 sc1
    v_mfma_f32_16x16x32_bf16 v[88:91], a[100:103], v[32:35], v[88:91]
    v_mfma_f32_16x16x32_bf16 v[92:95], v[16:19], a[104:107], v[92:95]
    buffer_load_dwordx4 a[244:247], v253, s[8:11], s32 offen offset:3072 sc1
    s_add_u32 s32, s32, 4096
    v_mfma_f32_16x16x32_bf16 v[96:99], v[20:23], a[104:107], v[96:99]
    v_mfma_f32_16x16x32_bf16 v[100:103], v[24:27], a[104:107], v[100:103]
    buffer_load_dwordx4 a[248:251], v253, s[8:11], s33 offen offset:3072 sc1
    s_add_u32 s33, s33, 4096
    v_mfma_f32_16x16x32_bf16 v[104:107], v[28:31], a[104:107], v[104:107]
    v_mfma_f32_16x16x32_bf16 v[108:111], v[32:35], a[104:107], v[108:111]
    v_mfma_f32_16x16x32_bf16 v[112:115], a[108:111], v[16:19], v[112:115]
    v_mfma_f32_16x16x32_bf16 v[116:119], a[108:111], v[20:23], v[116:119]
    v_mfma_f32_16x16x32_bf16 v[120:123], a[108:111], v[24:27], v[120:123]
    v_mfma_f32_16x16x32_bf16 v[124:127], a[108:111], v[28:31], v[124:127]
    v_mfma_f32_16x16x32_bf16 v[128:131], a[108:111], v[32:35], v[128:131]
    s_waitcnt vmcnt(21) lgkmcnt(0)
    v_mfma_f32_16x16x32_bf16 v[56:59], a[112:115], v[40:43], v[56:59]
    v_mfma_f32_16x16x32_bf16 v[60:63], a[112:115], v[44:47], v[60:63]
    v_mfma_f32_16x16x32_bf16 v[64:67], a[112:115], v[48:51], v[64:67]
    v_mfma_f32_16x16x32_bf16 v[68:71], a[112:115], v[52:55], v[68:71]
    v_mfma_f32_16x16x32_bf16 v[72:75], a[116:119], v[36:39], v[72:75]
    v_mfma_f32_16x16x32_bf16 v[76:79], a[116:119], v[40:43], v[76:79]
    buffer_load_dwordx4 a[252:255], v5, s[8:11], s34 offen offset:3072 sc1
    s_add_u32 s34, s34, 4096
    v_mfma_f32_16x16x32_bf16 v[80:83], a[116:119], v[44:47], v[80:83]
    v_mfma_f32_16x16x32_bf16 v[84:87], a[116:119], v[48:51], v[84:87]
    buffer_load_dwordx4 a[128:131], v253, s[8:11], s32 offen offset:0 sc1
    v_mfma_f32_16x16x32_bf16 v[88:91], a[116:119], v[52:55], v[88:91]
    v_mfma_f32_16x16x32_bf16 v[92:95], v[36:39], a[120:123], v[92:95]
    buffer_load_dwordx4 a[132:135], v253, s[8:11], s33 offen offset:0 sc1
    v_mfma_f32_16x16x32_bf16 v[96:99], v[40:43], a[120:123], v[96:99]
    v_mfma_f32_16x16x32_bf16 v[100:103], v[44:47], a[120:123], v[100:103]
    buffer_load_dwordx4 a[136:139], v5, s[8:11], s34 offen offset:0 sc1
    v_mfma_f32_16x16x32_bf16 v[104:107], v[48:51], a[120:123], v[104:107]
    v_mfma_f32_16x16x32_bf16 v[108:111], v[52:55], a[120:123], v[108:111]
    v_mfma_f32_16x16x32_bf16 v[112:115], a[124:127], v[36:39], v[112:115]
    v_mfma_f32_16x16x32_bf16 v[116:119], a[124:127], v[40:43], v[116:119]
    v_mfma_f32_16x16x32_bf16 v[120:123], a[124:127], v[44:47], v[120:123]
    v_mfma_f32_16x16x32_bf16 v[124:127], a[124:127], v[48:51], v[124:127]
    v_mfma_f32_16x16x32_bf16 v[128:131], a[124:127], v[52:55], v[128:131]
    v_cvt_pk_bf16_f32 v136, v56, v57
    v_cvt_pk_bf16_f32 v137, v58, v59
    v_cvt_pk_bf16_f32 v140, v60, v61
    v_cvt_pk_bf16_f32 v141, v62, v63
    v_cvt_pk_bf16_f32 v144, v64, v65
    v_cvt_pk_bf16_f32 v145, v66, v67
    v_cvt_pk_bf16_f32 v148, v68, v69
    v_cvt_pk_bf16_f32 v149, v70, v71
    v_cvt_pk_bf16_f32 v152, v72, v73
    buffer_load_dwordx4 a[140:143], v253, s[8:11], s32 offen offset:1024 sc1
    v_cvt_pk_bf16_f32 v153, v74, v75
    v_cvt_pk_bf16_f32 v156, v76, v77
    v_cvt_pk_bf16_f32 v157, v78, v79
    v_cvt_pk_bf16_f32 v160, v80, v81
    v_cvt_pk_bf16_f32 v161, v82, v83
    v_cvt_pk_bf16_f32 v164, v84, v85
    v_cvt_pk_bf16_f32 v165, v86, v87
    v_cvt_pk_bf16_f32 v168, v88, v89
    v_cvt_pk_bf16_f32 v169, v90, v91
    buffer_load_dwordx4 a[144:147], v253, s[8:11], s33 offen offset:1024 sc1
    v_cvt_pk_bf16_f32 v134, v112, v113
    v_cvt_pk_bf16_f32 v154, v114, v115
    v_cvt_pk_bf16_f32 v138, v116, v117
    v_cvt_pk_bf16_f32 v158, v118, v119
    v_cvt_pk_bf16_f32 v142, v120, v121
    v_cvt_pk_bf16_f32 v162, v122, v123
    v_cvt_pk_bf16_f32 v146, v124, v125
    v_cvt_pk_bf16_f32 v166, v126, v127
    v_cvt_pk_bf16_f32 v150, v128, v129
    buffer_load_dwordx4 a[148:151], v5, s[8:11], s34 offen offset:1024 sc1
    v_cvt_pk_bf16_f32 v170, v130, v131
    v_cvt_pk_bf16_f32 v172, v92, v93
    v_cvt_pk_bf16_f32 v173, v94, v95
    v_cvt_pk_bf16_f32 v174, v96, v97
    v_cvt_pk_bf16_f32 v175, v98, v99
    v_cvt_pk_bf16_f32 v176, v100, v101
    v_cvt_pk_bf16_f32 v177, v102, v103
    v_cvt_pk_bf16_f32 v178, v104, v105
    v_cvt_pk_bf16_f32 v179, v106, v107
    buffer_load_dwordx4 a[152:155], v253, s[8:11], s32 offen offset:2048 sc1
    v_cvt_pk_bf16_f32 v180, v108, v109
    v_cvt_pk_bf16_f32 v181, v110, v111
    v_mfma_f32_16x16x32_bf16 v[16:19], v[152:155], v[136:139], v[208:211]
    v_mfma_f32_16x16x32_bf16 v[20:23], v[156:159], v[136:139], v[204:207]
    v_mfma_f32_16x16x32_bf16 v[24:27], v[156:159], v[140:143], v[200:203]
    v_mfma_f32_16x16x32_bf16 v[28:31], v[160:163], v[140:143], v[204:207]
    v_mfma_f32_16x16x32_bf16 v[32:35], v[160:163], v[144:147], v[200:203]
    v_mfma_f32_16x16x32_bf16 v[36:39], v[164:167], v[144:147], v[204:207]
    v_mfma_f32_16x16x32_bf16 v[40:43], v[164:167], v[148:151], v[200:203]
    buffer_load_dwordx4 a[156:159], v253, s[8:11], s33 offen offset:2048 sc1
    v_mfma_f32_16x16x32_bf16 v[44:47], v[168:171], v[148:151], v[204:207]
    v_mfma_f32_16x16x32_bf16 v[56:59], v[132:135], v[192:195], v[196:199]
    v_mfma_f32_16x16x32_bf16 v[60:63], v[136:139], v[192:195], v[196:199]
    v_mfma_f32_16x16x32_bf16 v[64:67], v[140:143], v[192:195], v[196:199]
    v_mfma_f32_16x16x32_bf16 v[68:71], v[144:147], v[192:195], v[196:199]
    v_mfma_f32_16x16x32_bf16 v[72:75], v[148:151], v[192:195], v[196:199]
    v_max3_f32 v92, v16, v17, v18
    v_max3_f32 v96, v19, v20, v21
    v_max3_f32 v93, v24, v25, v26
    buffer_load_dwordx4 a[0:3], v5, s[8:11], s34 offen offset:2048 sc1
    v_max3_f32 v97, v27, v28, v29
    v_max3_f32 v94, v32, v33, v34
    v_max3_f32 v98, v35, v36, v37
    v_max3_f32 v95, v40, v41, v42
    v_max3_f32 v99, v43, v44, v45
    v_max3_f32 v92, v92, v22, v23
    v_max3_f32 v93, v93, v30, v31
    v_max3_f32 v94, v94, v38, v39
    v_max3_f32 v95, v95, v46, v47
    buffer_load_dwordx4 a[4:7], v253, s[8:11], s32 offen offset:3072 sc1
    s_add_u32 s32, s32, 4096
    v_max_f32 v92, v92, v96
    v_max_f32 v93, v93, v97
    v_max_f32 v94, v94, v98
    v_max_f32 v95, v95, v99
    s_mov_b32 s18, 0x3eae1a93
    v_cvt_pk_bf16_f32 v182, v56, v57
    v_permlane32_swap_b32 v92, v93
    v_permlane32_swap_b32 v94, v95
    v_max_f32 v92, v92, v93
    buffer_load_dwordx4 a[8:11], v253, s[8:11], s33 offen offset:3072 sc1
    s_add_u32 s33, s33, 4096
    v_max_f32 v94, v94, v95
    v_cvt_pk_bf16_f32 v183, v58, v59
    v_cvt_pk_bf16_f32 v184, v60, v61
    v_permlane16_swap_b32 v92, v94
    v_max_f32 v92, v92, v94
    v_mul_f32 v92, 0xbeae1a93, v92
    v_mov_b32 v94, v92
    v_cvt_pk_bf16_f32 v185, v62, v63
    v_cvt_pk_bf16_f32 v186, v64, v65
    buffer_load_dwordx4 a[12:15], v5, s[8:11], s34 offen offset:3072 sc1
    s_add_u32 s34, s34, 4096
    v_permlane16_swap_b32 v92, v94
    v_mov_b32 v93, v92
    v_mov_b32 v95, v94
    v_cvt_pk_bf16_f32 v187, v66, v67
    v_cvt_pk_bf16_f32 v188, v68, v69
    v_permlane32_swap_b32 v92, v93
    v_permlane32_swap_b32 v94, v95
    v_cvt_pk_bf16_f32 v189, v70, v71
    v_cvt_pk_bf16_f32 v190, v72, v73
    buffer_load_dwordx4 a[16:19], v253, s[8:11], s32 offen offset:0 sc1
    v_cvt_pk_bf16_f32 v191, v74, v75
    v_fma_f32 v16, v16, s18, v92
    v_fma_f32 v17, v17, s18, v92
    v_fma_f32 v18, v18, s18, v92
    v_fma_f32 v19, v19, s18, v92
    v_fma_f32 v20, v20, s18, v92
    v_fma_f32 v21, v21, s18, v92
    v_fma_f32 v22, v22, s18, v92
    v_fma_f32 v23, v23, s18, v92
    buffer_load_dwordx4 a[20:23], v253, s[8:11], s33 offen offset:0 sc1
    v_exp_f32 v16, v16
    v_exp_f32 v17, v17
    v_exp_f32 v18, v18
    v_exp_f32 v19, v19
    v_exp_f32 v20, v20
    v_exp_f32 v21, v21
    v_exp_f32 v22, v22
    v_exp_f32 v23, v23
    s_nop 0
    buffer_load_dwordx4 a[24:27], v5, s[8:11], s34 offen offset:0 sc1
    v_cvt_pk_bf16_f32 v76, v16, v17
    v_cvt_pk_bf16_f32 v77, v18, v19
    v_cvt_pk_bf16_f32 v78, v20, v21
    v_cvt_pk_bf16_f32 v79, v22, v23
    v_fma_f32 v24, v24, s18, v93
    v_fma_f32 v25, v25, s18, v93
    v_fma_f32 v26, v26, s18, v93
    v_fma_f32 v27, v27, s18, v93
    v_fma_f32 v28, v28, s18, v93
    buffer_load_dwordx4 a[28:31], v253, s[8:11], s32 offen offset:1024 sc1
    v_fma_f32 v29, v29, s18, v93
    v_fma_f32 v30, v30, s18, v93
    v_fma_f32 v31, v31, s18, v93
    v_exp_f32 v24, v24
    v_exp_f32 v25, v25
    v_exp_f32 v26, v26
    v_exp_f32 v27, v27
    v_exp_f32 v28, v28
    v_exp_f32 v29, v29
    buffer_load_dwordx4 a[32:35], v253, s[8:11], s33 offen offset:1024 sc1
    v_exp_f32 v30, v30
    v_exp_f32 v31, v31
    v_mfma_f32_16x16x32_bf16 v[100:103], v[172:175], v[76:79], 0
    v_mfma_f32_16x16x32_bf16 v[116:119], v[182:185], v[76:79], 0
    v_cvt_pk_bf16_f32 v80, v24, v25
    v_cvt_pk_bf16_f32 v81, v26, v27
    v_cvt_pk_bf16_f32 v82, v28, v29
    v_cvt_pk_bf16_f32 v83, v30, v31
    v_fma_f32 v32, v32, s18, v94
    buffer_load_dwordx4 a[36:39], v5, s[8:11], s34 offen offset:1024 sc1
    v_fma_f32 v33, v33, s18, v94
    v_fma_f32 v34, v34, s18, v94
    v_fma_f32 v35, v35, s18, v94
    v_fma_f32 v36, v36, s18, v94
    v_fma_f32 v37, v37, s18, v94
    v_fma_f32 v38, v38, s18, v94
    v_fma_f32 v39, v39, s18, v94
    v_exp_f32 v32, v32
    v_exp_f32 v33, v33
    buffer_load_dwordx4 a[40:43], v253, s[8:11], s32 offen offset:2048 sc1
    v_exp_f32 v34, v34
    v_exp_f32 v35, v35
    v_exp_f32 v36, v36
    v_exp_f32 v37, v37
    v_exp_f32 v38, v38
    v_exp_f32 v39, v39
    v_mfma_f32_16x16x32_bf16 v[104:107], v[174:177], v[80:83], 0
    v_mfma_f32_16x16x32_bf16 v[120:123], v[184:187], v[80:83], 0
    v_cvt_pk_bf16_f32 v84, v32, v33
    buffer_load_dwordx4 a[44:47], v253, s[8:11], s33 offen offset:2048 sc1
    v_cvt_pk_bf16_f32 v85, v34, v35
    v_cvt_pk_bf16_f32 v86, v36, v37
    v_cvt_pk_bf16_f32 v87, v38, v39
    v_fma_f32 v40, v40, s18, v95
    v_fma_f32 v41, v41, s18, v95
    v_fma_f32 v42, v42, s18, v95
    v_fma_f32 v43, v43, s18, v95
    v_fma_f32 v44, v44, s18, v95
    v_fma_f32 v45, v45, s18, v95
    buffer_load_dwordx4 a[48:51], v5, s[8:11], s34 offen offset:2048 sc1
    v_fma_f32 v46, v46, s18, v95
    v_fma_f32 v47, v47, s18, v95
    v_exp_f32 v40, v40
    v_exp_f32 v41, v41
    v_exp_f32 v42, v42
    v_exp_f32 v43, v43
    v_exp_f32 v44, v44
    v_exp_f32 v45, v45
    v_exp_f32 v46, v46
    buffer_load_dwordx4 a[52:55], v253, s[8:11], s32 offen offset:3072 sc1
    s_add_u32 s32, s32, 4096
    v_exp_f32 v47, v47
    v_mfma_f32_16x16x32_bf16 v[108:111], v[176:179], v[84:87], 0
    v_mfma_f32_16x16x32_bf16 v[124:127], v[186:189], v[84:87], 0
    v_cvt_pk_bf16_f32 v88, v40, v41
    v_cvt_pk_bf16_f32 v89, v42, v43
    v_cvt_pk_bf16_f32 v90, v44, v45
    v_cvt_pk_bf16_f32 v91, v46, v47
    v_rcp_f32 v96, v118
    v_rcp_f32 v97, v122
    buffer_load_dwordx4 v[240:243], v9, s[8:11], s37 offen offset:0 sc1
    v_mfma_f32_16x16x32_bf16 v[112:115], v[178:181], v[88:91], 0
    v_mfma_f32_16x16x32_bf16 v[128:131], v[188:191], v[88:91], 0
    v_pk_mul_f32 v[100:101], v[96:97], v[100:101] op_sel:[0,0] op_sel_hi:[0,1]
    v_pk_mul_f32 v[102:103], v[96:97], v[102:103] op_sel:[0,0] op_sel_hi:[0,1]
    v_pk_mul_f32 v[116:117], v[96:97], v[116:117] op_sel:[0,0] op_sel_hi:[0,1]
    v_cvt_pk_bf16_f32 v212, v100, v101
    v_cvt_pk_bf16_f32 v213, v102, v103
    v_cvt_pk_bf16_f32 v220, v116, v117
    v_rcp_f32 v98, v126
    buffer_load_dwordx4 v[244:247], v9, s[8:11], s37 offen offset:1024 sc1
    v_pk_mul_f32 v[104:105], v[96:97], v[104:105] op_sel:[1,0] op_sel_hi:[1,1]
    v_pk_mul_f32 v[106:107], v[96:97], v[106:107] op_sel:[1,0] op_sel_hi:[1,1]
    v_pk_mul_f32 v[120:121], v[96:97], v[120:121] op_sel:[1,0] op_sel_hi:[1,1]
    v_cvt_pk_bf16_f32 v214, v104, v105
    v_cvt_pk_bf16_f32 v215, v106, v107
    v_cvt_pk_bf16_f32 v221, v120, v121
    v_rcp_f32 v99, v130
    v_permlane16_swap_b32 v212, v214
    v_permlane16_swap_b32 v213, v215
    buffer_load_dwordx4 v[248:251], v7, s[8:11], s37 offen offset:2048 sc1
    v_pk_mul_f32 v[108:109], v[98:99], v[108:109] op_sel:[0,0] op_sel_hi:[0,1]
    v_pk_mul_f32 v[110:111], v[98:99], v[110:111] op_sel:[0,0] op_sel_hi:[0,1]
    v_pk_mul_f32 v[124:125], v[98:99], v[124:125] op_sel:[0,0] op_sel_hi:[0,1]
    v_cvt_pk_bf16_f32 v216, v108, v109
    v_cvt_pk_bf16_f32 v217, v110, v111
    v_cvt_pk_bf16_f32 v222, v124, v125
    v_pk_mul_f32 v[112:113], v[98:99], v[112:113] op_sel:[1,0] op_sel_hi:[1,1]
    v_pk_mul_f32 v[114:115], v[98:99], v[114:115] op_sel:[1,0] op_sel_hi:[1,1]
    v_pk_mul_f32 v[128:129], v[98:99], v[128:129] op_sel:[1,0] op_sel_hi:[1,1]
    buffer_load_dword v252, v8, s[8:11], s47 offen sc1
    v_cvt_pk_bf16_f32 v218, v112, v113
    v_cvt_pk_bf16_f32 v219, v114, v115
    v_cvt_pk_bf16_f32 v223, v128, v129
    s_lshl_b32 s7, s3, 2
    s_add_u32 s7, s7, 94208
    v_permlane16_swap_b32 v220, v221
    v_permlane16_swap_b32 v222, v223
    v_add_u32 v11, s7, v253
    v_lshrrev_b32 v10, 3, v0
    v_permlane32_swap_b32 v220, v222
    v_mul_u32_u24 v10, 9216, v10
    ds_write_b32 v11, v220
    v_permlane16_swap_b32 v216, v218
    v_permlane16_swap_b32 v217, v219
    s_mul_i32 s7, s40, 1152
    s_add_u32 s22, s22, s7
    s_add_u32 s22, s22, 41156608
    s_lshl_b32 s7, s3, 8
    s_add_u32 s23, s22, s7
    s_add_u32 s24, s23, 36864
    buffer_store_dwordx4 v[212:215], v9, s[8:11], s23 offen sc1
    buffer_store_dwordx4 v[216:219], v9, s[8:11], s24 offen sc1
    v_and_b32 v11, 7, v0
    v_lshl_add_u32 v10, v11, 4, v10
    s_cmp_eq_u32 s3, 3
    s_cselect_b32 s7, 0, 1073741824
    v_add_u32 v10, s7, v10
    v_add_u32 v11, 94208, v253
    s_waitcnt lgkmcnt(0)
    s_barrier
    ds_read_b128 v[220:223], v11
    s_waitcnt lgkmcnt(0)
    buffer_store_dwordx4 v[220:223], v10, s[8:11], s22 offen offset:1024 sc1
    v_lshlrev_b32 v15, 7, v0
    s_lshl_b32 s6, s40, 2
    s_add_u32 s6, s6, s44
    v_mov_b32 v1, s76
    s_mov_b64 vcc, 0xff
    s_waitcnt vmcnt(0)
    s_barrier
    s_cmp_lg_u32 s3, 0
    s_cbranch_scc1 L_pub_23
    s_mov_b64 exec, vcc
    buffer_store_dword v1, v15, s[8:11], s6 offen sc1
L_pub_23:
    s_mov_b64 exec, -1
    buffer_load_dwordx4 a[56:59], v253, s[8:11], s33 offen offset:3072 sc1
    s_add_u32 s33, s33, 4096
    buffer_load_dwordx4 a[60:63], v5, s[8:11], s34 offen offset:3072 sc1
    s_add_u32 s34, s34, 4096
    buffer_load_dwordx4 a[64:67], v253, s[8:11], s32 offen offset:0 sc1
    buffer_load_dwordx4 a[68:71], v253, s[8:11], s33 offen offset:0 sc1
    buffer_load_dwordx4 a[72:75], v5, s[8:11], s34 offen offset:0 sc1
    buffer_load_dwordx4 a[76:79], v253, s[8:11], s32 offen offset:1024 sc1
    buffer_load_dwordx4 a[80:83], v253, s[8:11], s33 offen offset:1024 sc1
    buffer_load_dwordx4 a[84:87], v5, s[8:11], s34 offen offset:1024 sc1
    s_cmp_lg_u32 s42, 0
    s_cbranch_scc1 L_swz_24
    s_cmp_eq_u32 s93, 2
    s_cselect_b32 s6, 2, 3
    s_mov_b32 s7, 512
    s_cmov_b32 s7, 2048
    v_lshrrev_b32 v14, 4, v0
    v_lshlrev_b32 v14, s6, v14
    v_bfe_u32 v15, v0, 2, 2
    v_add_u32 v14, v14, v15
    v_mul_u32_u24 v14, 128, v14
    v_and_b32 v15, 3, v0
    v_lshl_add_u32 v14, v15, 3, v14
    v_add_u32 v14, s79, v14
    v_add_u32 v15, s7, v14
    ds_read_b64_tr_b16 v[76:77], v14 offset:8192
    ds_read_b64_tr_b16 v[78:79], v15 offset:8192
    ds_read_b64_tr_b16 v[80:81], v14 offset:8224
    ds_read_b64_tr_b16 v[82:83], v15 offset:8224
    ds_read_b64_tr_b16 v[84:85], v14 offset:8256
    ds_read_b64_tr_b16 v[86:87], v15 offset:8256
    ds_read_b64_tr_b16 v[88:89], v14 offset:8288
    ds_read_b64_tr_b16 v[90:91], v15 offset:8288
    ds_read_b64_tr_b16 v[92:93], v14 offset:12288
    ds_read_b64_tr_b16 v[94:95], v15 offset:12288
    ds_read_b64_tr_b16 v[96:97], v14 offset:12320
    ds_read_b64_tr_b16 v[98:99], v15 offset:12320
    ds_read_b64_tr_b16 v[176:177], v14 offset:12352
    ds_read_b64_tr_b16 v[178:179], v15 offset:12352
    ds_read_b64_tr_b16 v[180:181], v14 offset:12384
    ds_read_b64_tr_b16 v[182:183], v15 offset:12384
    s_waitcnt lgkmcnt(0)
    s_add_u32 s7, s78, 0
    buffer_store_dwordx4 v[76:79], v253, s[8:11], s7 offen sc1
    s_add_u32 s7, s78, 497664
    buffer_store_dwordx4 v[80:83], v253, s[8:11], s7 offen sc1
    s_add_u32 s7, s78, 995328
    buffer_store_dwordx4 v[84:87], v253, s[8:11], s7 offen sc1
    s_add_u32 s7, s78, 1492992
    buffer_store_dwordx4 v[88:91], v253, s[8:11], s7 offen sc1
    s_add_u32 s7, s70, 0
    buffer_store_dwordx4 v[92:95], v253, s[8:11], s7 offen sc1
    s_add_u32 s7, s70, 497664
    buffer_store_dwordx4 v[96:99], v253, s[8:11], s7 offen sc1
    s_add_u32 s7, s70, 995328
    buffer_store_dwordx4 v[176:179], v253, s[8:11], s7 offen sc1
    s_add_u32 s7, s70, 1492992
    buffer_store_dwordx4 v[180:183], v253, s[8:11], s7 offen sc1
    s_lshr_b32 s7, s2, 3
    s_lshl_b32 s7, s7, 2
    s_add_u32 s7, s7, s3
    s_lshl_b32 s7, s7, 9
    v_lshrrev_b32 v1, 1, v253
    v_add_u32 v1, s7, v1
    buffer_load_dwordx2 v[14:15], v1, s[96:99], 0 offen
L_swz_24:
    s_and_b32 s7, s3, 1
    s_mul_i32 s7, s7, 18432
    s_add_u32 s24, s30, s7
    s_lshr_b32 s7, s3, 1
    s_lshl_b32 s7, s7, 9
    s_add_u32 s24, s24, s7
    s_add_u32 s24, s24, 41156608
    s_mov_b32 s16, 0xffff0000
    v_lshlrev_b32 v124, 16, v240
    v_and_b32 v125, s16, v240
    v_lshlrev_b32 v126, 16, v241
    v_and_b32 v127, s16, v241
    v_lshlrev_b32 v128, 16, v242
    v_and_b32 v129, s16, v242
    v_lshlrev_b32 v130, 16, v243
    v_and_b32 v131, s16, v243
    v_lshlrev_b32 v132, 16, v244
    v_and_b32 v133, s16, v244
    v_lshlrev_b32 v134, 16, v245
    v_and_b32 v135, s16, v245
    v_lshlrev_b32 v136, 16, v246
    v_and_b32 v137, s16, v246
    v_lshlrev_b32 v138, 16, v247
    v_and_b32 v139, s16, v247
    v_lshlrev_b32 v140, 16, v248
    v_and_b32 v141, s16, v248
    v_lshlrev_b32 v142, 16, v249
    v_and_b32 v143, s16, v249
    v_lshlrev_b32 v144, 16, v250
    v_and_b32 v145, s16, v250
    v_lshlrev_b32 v146, 16, v251
    v_and_b32 v147, s16, v251
    s_cmp_eq_u32 s3, 1
    s_cselect_b32 s7, 16, 0
    v_lshlrev_b32 v12, 2, v0
    v_cmp_gt_u32 vcc, s7, v0
    v_add_u32 v10, 40960, v12
    v_add_u32 v11, 41472, v12
    v_cndmask_b32 v10, v11, v10, vcc
    v_and_b32 v11, 0x7c, v12
    v_cmp_gt_u32 vcc, 32, v0
    v_mov_b32 v13, 1073741824
    s_and_b32 s7, s40, 3
    s_lshl_b32 s45, s45, 2
    v_cndmask_b32 v8, v13, v12, vcc
    s_add_u32 s6, s7, s3
    s_cmp_eq_u32 s6, 0
    s_cselect_b32 s6, 0, 1073741824
    v_add_u32 v6, s6, v8
    s_add_u32 s45, s45, s7
    s_lshl_b32 s45, s45, 2
    s_add_u32 s45, s45, s3
    s_lshl_b32 s45, s45, 7
    s_add_u32 s45, s45, s43
    s_add_u32 s45, s45, 48300032
    s_cmp_eq_u32 s3, 0
    s_cselect_b32 s35, 1.0, 0
    s_lshl_b32 s7, s40, 2
    s_add_u32 s7, s7, s3
    s_mul_i32 s23, s7, 497664
    s_add_u32 s23, s23, 3145728
    s_add_u32 s50, s23, 497664
    s_mul_i32 s50, s50, s42
    v_mov_b32 v184, v253
    v_add_u32 v185, 4096, v253
    v_add_u32 v186, 8192, v253
    v_add_u32 v187, 12288, v253
    v_add_u32 v188, 16384, v253
    v_add_u32 v189, 20480, v253
    v_add_u32 v190, 24576, v253
    v_add_u32 v191, 28672, v253
    v_add_u32 v192, 32768, v253
    s_cmp_lg_u32 s3, 3
    s_cbranch_scc1 L_pollout_27
    s_lshl_b32 s7, s40, 7
    s_add_u32 s7, s7, s44
    s_add_u32 s52, s4, s7
    s_addc_u32 s53, s5, 0
    s_mov_b32 s6, 0
L_poll_25:
    s_load_dwordx8 s[56:63], s[52:53], 0 glc
    s_add_u32 s6, s6, 1
    s_waitcnt lgkmcnt(0)
    s_xor_b64 s[56:57], s[56:57], s[76:77]
    s_xor_b64 s[58:59], s[58:59], s[76:77]
    s_xor_b64 s[60:61], s[60:61], s[76:77]
    s_xor_b64 s[62:63], s[62:63], s[76:77]
    s_or_b64 s[56:57], s[56:57], s[58:59]
    s_or_b64 s[60:61], s[60:61], s[62:63]
    s_or_b64 s[56:57], s[56:57], s[60:61]
    s_cbranch_scc0 L_polled_26
    s_cmp_lt_u32 s6, 1048576
    s_cbranch_scc1 L_poll_25
    s_branch L_main_end
L_polled_26:
L_pollout_27:
    s_barrier
    s_lshl_b32 m0, s3, 10
    s_nop 0
    buffer_load_dwordx4 v2, s[8:11], s24 offen sc1 lds
    s_add_u32 m0, m0, 4096
    s_add_u32 s24, s24, 1024
    buffer_load_dwordx4 v2, s[8:11], s24 offen sc1 lds
    s_add_u32 m0, m0, 4096
    s_add_u32 s24, s24, 1024
    buffer_load_dwordx4 v2, s[8:11], s24 offen sc1 lds
    s_add_u32 m0, m0, 4096
    s_add_u32 s24, s24, 1024
    buffer_load_dwordx4 v2, s[8:11], s24 offen sc1 lds
    s_add_u32 m0, m0, 4096
    s_add_u32 s24, s24, 1024
    buffer_load_dwordx4 v2, s[8:11], s24 offen sc1 lds
    s_add_u32 m0, m0, 4096
    s_add_u32 s24, s24, 1024
    buffer_load_dwordx4 v2, s[8:11], s24 offen sc1 lds
    s_add_u32 m0, m0, 4096
    s_add_u32 s24, s24, 1024
    buffer_load_dwordx4 v2, s[8:11], s24 offen sc1 lds
    s_add_u32 m0, m0, 4096
    s_add_u32 s24, s24, 1024
    buffer_load_dwordx4 v2, s[8:11], s24 offen sc1 lds
    s_add_u32 m0, m0, 4096
    s_add_u32 s24, s24, 1024
    buffer_load_dwordx4 v2, s[8:11], s24 offen sc1 lds
    s_waitcnt vmcnt(4)
    s_barrier
    ds_read_b128 v[160:163], v253 offset:0
    ds_read_b128 v[164:167], v253 offset:1024
    s_waitcnt lgkmcnt(0)
    v_mfma_f32_16x16x32_bf16 v[100:103], a[160:163], v[160:163], 0
    ds_read_b128 v[168:171], v253 offset:2048
    v_mfma_f32_16x16x32_bf16 v[104:107], a[160:163], v[164:167], 0
    ds_read_b128 v[172:175], v253 offset:3072
    v_mfma_f32_16x16x32_bf16 v[108:111], a[164:167], v[160:163], 0
    v_mfma_f32_16x16x32_bf16 v[112:115], a[164:167], v[164:167], 0
    buffer_load_dwordx4 v[16:19], v184, s[48:51], s23 offen offset:0 sc1
    v_mfma_f32_16x16x32_bf16 v[116:119], a[168:171], v[160:163], 0
    v_mfma_f32_16x16x32_bf16 v[120:123], a[168:171], v[164:167], 0
    s_waitcnt lgkmcnt(0)
    v_mfma_f32_16x16x32_bf16 v[100:103], a[172:175], v[168:171], v[100:103]
    ds_read_b128 v[160:163], v253 offset:4096
    v_mfma_f32_16x16x32_bf16 v[104:107], a[172:175], v[172:175], v[104:107]
    ds_read_b128 v[164:167], v253 offset:5120
    v_mfma_f32_16x16x32_bf16 v[108:111], a[176:179], v[168:171], v[108:111]
    v_mfma_f32_16x16x32_bf16 v[112:115], a[176:179], v[172:175], v[112:115]
    buffer_load_dwordx4 v[20:23], v184, s[48:51], s23 offen offset:1024 sc1
    v_mfma_f32_16x16x32_bf16 v[116:119], a[180:183], v[168:171], v[116:119]
    v_mfma_f32_16x16x32_bf16 v[120:123], a[180:183], v[172:175], v[120:123]
    s_waitcnt lgkmcnt(0)
    v_mfma_f32_16x16x32_bf16 v[100:103], a[184:187], v[160:163], v[100:103]
    ds_read_b128 v[168:171], v253 offset:6144
    v_mfma_f32_16x16x32_bf16 v[104:107], a[184:187], v[164:167], v[104:107]
    ds_read_b128 v[172:175], v253 offset:7168
    v_mfma_f32_16x16x32_bf16 v[108:111], a[188:191], v[160:163], v[108:111]
    v_mfma_f32_16x16x32_bf16 v[112:115], a[188:191], v[164:167], v[112:115]
    buffer_load_dwordx4 v[24:27], v184, s[48:51], s23 offen offset:2048 sc1
    v_mfma_f32_16x16x32_bf16 v[116:119], a[192:195], v[160:163], v[116:119]
    v_mfma_f32_16x16x32_bf16 v[120:123], a[192:195], v[164:167], v[120:123]
    s_waitcnt lgkmcnt(0)
    v_mfma_f32_16x16x32_bf16 v[100:103], a[196:199], v[168:171], v[100:103]
    ds_read_b128 v[160:163], v253 offset:8192
    v_mfma_f32_16x16x32_bf16 v[104:107], a[196:199], v[172:175], v[104:107]
    ds_read_b128 v[164:167], v253 offset:9216
    v_mfma_f32_16x16x32_bf16 v[108:111], a[200:203], v[168:171], v[108:111]
    v_mfma_f32_16x16x32_bf16 v[112:115], a[200:203], v[172:175], v[112:115]
    buffer_load_dwordx4 v[28:31], v184, s[48:51], s23 offen offset:3072 sc1
    v_mfma_f32_16x16x32_bf16 v[116:119], a[204:207], v[168:171], v[116:119]
    v_mfma_f32_16x16x32_bf16 v[120:123], a[204:207], v[172:175], v[120:123]
    s_waitcnt lgkmcnt(0)
    v_mfma_f32_16x16x32_bf16 v[100:103], a[208:211], v[160:163], v[100:103]
    ds_read_b128 v[168:171], v253 offset:10240
    v_mfma_f32_16x16x32_bf16 v[104:107], a[208:211], v[164:167], v[104:107]
    ds_read_b128 v[172:175], v253 offset:11264
    v_mfma_f32_16x16x32_bf16 v[108:111], a[212:215], v[160:163], v[108:111]
    v_mfma_f32_16x16x32_bf16 v[112:115], a[212:215], v[164:167], v[112:115]
    buffer_load_dwordx4 v[32:35], v185, s[48:51], s23 offen offset:0 sc1
    v_mfma_f32_16x16x32_bf16 v[116:119], a[216:219], v[160:163], v[116:119]
    v_mfma_f32_16x16x32_bf16 v[120:123], a[216:219], v[164:167], v[120:123]
    s_waitcnt lgkmcnt(0)
    v_mfma_f32_16x16x32_bf16 v[100:103], a[220:223], v[168:171], v[100:103]
    ds_read_b128 v[160:163], v253 offset:12288
    v_mfma_f32_16x16x32_bf16 v[104:107], a[220:223], v[172:175], v[104:107]
    ds_read_b128 v[164:167], v253 offset:13312
    v_mfma_f32_16x16x32_bf16 v[108:111], a[224:227], v[168:171], v[108:111]
    v_mfma_f32_16x16x32_bf16 v[112:115], a[224:227], v[172:175], v[112:115]
    buffer_load_dwordx4 v[36:39], v185, s[48:51], s23 offen offset:1024 sc1
    v_mfma_f32_16x16x32_bf16 v[116:119], a[228:231], v[168:171], v[116:119]
    v_mfma_f32_16x16x32_bf16 v[120:123], a[228:231], v[172:175], v[120:123]
    s_waitcnt lgkmcnt(0)
    v_mfma_f32_16x16x32_bf16 v[100:103], a[232:235], v[160:163], v[100:103]
    ds_read_b128 v[168:171], v253 offset:14336
    v_mfma_f32_16x16x32_bf16 v[104:107], a[232:235], v[164:167], v[104:107]
    ds_read_b128 v[172:175], v253 offset:15360
    v_mfma_f32_16x16x32_bf16 v[108:111], a[236:239], v[160:163], v[108:111]
    v_mfma_f32_16x16x32_bf16 v[112:115], a[236:239], v[164:167], v[112:115]
    buffer_load_dwordx4 v[40:43], v185, s[48:51], s23 offen offset:2048 sc1
    v_mfma_f32_16x16x32_bf16 v[116:119], a[240:243], v[160:163], v[116:119]
    v_mfma_f32_16x16x32_bf16 v[120:123], a[240:243], v[164:167], v[120:123]
    s_waitcnt lgkmcnt(0)
    v_mfma_f32_16x16x32_bf16 v[100:103], a[244:247], v[168:171], v[100:103]
    ds_read_b128 v[160:163], v253 offset:16384
    v_mfma_f32_16x16x32_bf16 v[104:107], a[244:247], v[172:175], v[104:107]
    ds_read_b128 v[164:167], v253 offset:17408
    v_mfma_f32_16x16x32_bf16 v[108:111], a[248:251], v[168:171], v[108:111]
    v_mfma_f32_16x16x32_bf16 v[112:115], a[248:251], v[172:175], v[112:115]
    buffer_load_dwordx4 v[44:47], v185, s[48:51], s23 offen offset:3072 sc1
    v_mfma_f32_16x16x32_bf16 v[116:119], a[252:255], v[168:171], v[116:119]
    v_mfma_f32_16x16x32_bf16 v[120:123], a[252:255], v[172:175], v[120:123]
    s_waitcnt lgkmcnt(0)
    v_mfma_f32_16x16x32_bf16 v[100:103], a[128:131], v[160:163], v[100:103]
    ds_read_b128 v[168:171], v253 offset:18432
    v_mfma_f32_16x16x32_bf16 v[104:107], a[128:131], v[164:167], v[104:107]
    ds_read_b128 v[172:175], v253 offset:19456
    v_mfma_f32_16x16x32_bf16 v[108:111], a[132:135], v[160:163], v[108:111]
    v_mfma_f32_16x16x32_bf16 v[112:115], a[132:135], v[164:167], v[112:115]
    buffer_load_dwordx4 v[48:51], v186, s[48:51], s23 offen offset:0 sc1
    v_mfma_f32_16x16x32_bf16 v[116:119], a[136:139], v[160:163], v[116:119]
    v_mfma_f32_16x16x32_bf16 v[120:123], a[136:139], v[164:167], v[120:123]
    s_waitcnt vmcnt(9) lgkmcnt(0)
    s_barrier
    s_xor_b32 s7, s3, 0
    s_or_b32 s7, s7, s42
    s_cbranch_scc1 L_swz_28
    s_lshl_b32 s6, s40, 7
    s_lshl_b32 s7, s41, 2
    s_add_u32 s6, s6, s7
    s_add_u32 s6, s6, 19464192
    s_mov_b64 exec, 0xffffffff
    v_lshlrev_b32 v15, 10, v0
    v_mov_b32 v1, s76
    buffer_store_dword v1, v15, s[8:11], s6 offen sc1
    s_mov_b64 exec, -1
L_swz_28:
    v_mfma_f32_16x16x32_bf16 v[100:103], a[140:143], v[168:171], v[100:103]
    ds_read_b128 v[160:163], v253 offset:20480
    v_mfma_f32_16x16x32_bf16 v[104:107], a[140:143], v[172:175], v[104:107]
    ds_read_b128 v[164:167], v253 offset:21504
    v_mfma_f32_16x16x32_bf16 v[108:111], a[144:147], v[168:171], v[108:111]
    v_mfma_f32_16x16x32_bf16 v[112:115], a[144:147], v[172:175], v[112:115]
    buffer_load_dwordx4 v[52:55], v186, s[48:51], s23 offen offset:1024 sc1
    v_mfma_f32_16x16x32_bf16 v[116:119], a[148:151], v[168:171], v[116:119]
    v_mfma_f32_16x16x32_bf16 v[120:123], a[148:151], v[172:175], v[120:123]
    s_waitcnt lgkmcnt(0)
    v_mfma_f32_16x16x32_bf16 v[100:103], a[152:155], v[160:163], v[100:103]
    ds_read_b128 v[168:171], v253 offset:22528
    v_mfma_f32_16x16x32_bf16 v[104:107], a[152:155], v[164:167], v[104:107]
    ds_read_b128 v[172:175], v253 offset:23552
    v_mfma_f32_16x16x32_bf16 v[108:111], a[156:159], v[160:163], v[108:111]
    v_mfma_f32_16x16x32_bf16 v[112:115], a[156:159], v[164:167], v[112:115]
    buffer_load_dwordx4 v[56:59], v186, s[48:51], s23 offen offset:2048 sc1
    v_mfma_f32_16x16x32_bf16 v[116:119], a[0:3], v[160:163], v[116:119]
    v_mfma_f32_16x16x32_bf16 v[120:123], a[0:3], v[164:167], v[120:123]
    s_waitcnt lgkmcnt(0)
    v_mfma_f32_16x16x32_bf16 v[100:103], a[4:7], v[168:171], v[100:103]
    ds_read_b128 v[160:163], v253 offset:24576
    v_mfma_f32_16x16x32_bf16 v[104:107], a[4:7], v[172:175], v[104:107]
    ds_read_b128 v[164:167], v253 offset:25600
    v_mfma_f32_16x16x32_bf16 v[108:111], a[8:11], v[168:171], v[108:111]
    v_mfma_f32_16x16x32_bf16 v[112:115], a[8:11], v[172:175], v[112:115]
    buffer_load_dwordx4 v[60:63], v186, s[48:51], s23 offen offset:3072 sc1
    v_mfma_f32_16x16x32_bf16 v[116:119], a[12:15], v[168:171], v[116:119]
    v_mfma_f32_16x16x32_bf16 v[120:123], a[12:15], v[172:175], v[120:123]
    s_waitcnt lgkmcnt(0)
    v_mfma_f32_16x16x32_bf16 v[100:103], a[16:19], v[160:163], v[100:103]
    ds_read_b128 v[168:171], v253 offset:26624
    v_mfma_f32_16x16x32_bf16 v[104:107], a[16:19], v[164:167], v[104:107]
    ds_read_b128 v[172:175], v253 offset:27648
    v_mfma_f32_16x16x32_bf16 v[108:111], a[20:23], v[160:163], v[108:111]
    v_mfma_f32_16x16x32_bf16 v[112:115], a[20:23], v[164:167], v[112:115]
    buffer_load_dwordx4 v[64:67], v187, s[48:51], s23 offen offset:0 sc1
    v_mfma_f32_16x16x32_bf16 v[116:119], a[24:27], v[160:163], v[116:119]
    v_mfma_f32_16x16x32_bf16 v[120:123], a[24:27], v[164:167], v[120:123]
    s_waitcnt lgkmcnt(0)
    v_mfma_f32_16x16x32_bf16 v[100:103], a[28:31], v[168:171], v[100:103]
    ds_read_b128 v[160:163], v253 offset:28672
    v_mfma_f32_16x16x32_bf16 v[104:107], a[28:31], v[172:175], v[104:107]
    ds_read_b128 v[164:167], v253 offset:29696
    v_mfma_f32_16x16x32_bf16 v[108:111], a[32:35], v[168:171], v[108:111]
    v_mfma_f32_16x16x32_bf16 v[112:115], a[32:35], v[172:175], v[112:115]
    buffer_load_dwordx4 v[68:71], v187, s[48:51], s23 offen offset:1024 sc1
    v_mfma_f32_16x16x32_bf16 v[116:119], a[36:39], v[168:171], v[116:119]
    v_mfma_f32_16x16x32_bf16 v[120:123], a[36:39], v[172:175], v[120:123]
    s_waitcnt lgkmcnt(0)
    v_mfma_f32_16x16x32_bf16 v[100:103], a[40:43], v[160:163], v[100:103]
    ds_read_b128 v[168:171], v253 offset:30720
    v_mfma_f32_16x16x32_bf16 v[104:107], a[40:43], v[164:167], v[104:107]
    ds_read_b128 v[172:175], v253 offset:31744
    v_mfma_f32_16x16x32_bf16 v[108:111], a[44:47], v[160:163], v[108:111]
    v_mfma_f32_16x16x32_bf16 v[112:115], a[44:47], v[164:167], v[112:115]
    buffer_load_dwordx4 v[72:75], v187, s[48:51], s23 offen offset:2048 sc1
    v_mfma_f32_16x16x32_bf16 v[116:119], a[48:51], v[160:163], v[116:119]
    v_mfma_f32_16x16x32_bf16 v[120:123], a[48:51], v[164:167], v[120:123]
    s_waitcnt lgkmcnt(0)
    v_mfma_f32_16x16x32_bf16 v[100:103], a[52:55], v[168:171], v[100:103]
    ds_read_b128 v[160:163], v253 offset:32768
    v_mfma_f32_16x16x32_bf16 v[104:107], a[52:55], v[172:175], v[104:107]
    ds_read_b128 v[164:167], v253 offset:33792
    v_mfma_f32_16x16x32_bf16 v[108:111], a[56:59], v[168:171], v[108:111]
    v_mfma_f32_16x16x32_bf16 v[112:115], a[56:59], v[172:175], v[112:115]
    v_mfma_f32_16x16x32_bf16 v[116:119], a[60:63], v[168:171], v[116:119]
    v_mfma_f32_16x16x32_bf16 v[120:123], a[60:63], v[172:175], v[120:123]
    s_waitcnt lgkmcnt(0)
    v_mfma_f32_16x16x32_bf16 v[100:103], a[64:67], v[160:163], v[100:103]
    ds_read_b128 v[168:171], v253 offset:34816
    v_mfma_f32_16x16x32_bf16 v[104:107], a[64:67], v[164:167], v[104:107]
    ds_read_b128 v[172:175], v253 offset:35840
    v_mfma_f32_16x16x32_bf16 v[108:111], a[68:71], v[160:163], v[108:111]
    v_mfma_f32_16x16x32_bf16 v[112:115], a[68:71], v[164:167], v[112:115]
    v_mfma_f32_16x16x32_bf16 v[116:119], a[72:75], v[160:163], v[116:119]
    v_mfma_f32_16x16x32_bf16 v[120:123], a[72:75], v[164:167], v[120:123]
    s_waitcnt lgkmcnt(0)
    v_mfma_f32_16x16x32_bf16 v[100:103], a[76:79], v[168:171], v[100:103]
    v_mfma_f32_16x16x32_bf16 v[104:107], a[76:79], v[172:175], v[104:107]
    v_mfma_f32_16x16x32_bf16 v[108:111], a[80:83], v[168:171], v[108:111]
    v_mfma_f32_16x16x32_bf16 v[112:115], a[80:83], v[172:175], v[112:115]
    v_mfma_f32_16x16x32_bf16 v[116:119], a[84:87], v[168:171], v[116:119]
    v_mfma_f32_16x16x32_bf16 v[120:123], a[84:87], v[172:175], v[120:123]
    s_nop 3
    v_permlane16_swap_b32 v100, v104
    v_permlane16_swap_b32 v101, v105
    v_permlane16_swap_b32 v102, v106
    v_permlane16_swap_b32 v103, v107
    v_add_f32 v12, v116, v117
    v_add_f32 v13, v120, v121
    ds_write_b32 v10, v12
    ds_write_b32 v10, v13 offset:64
    v_permlane16_swap_b32 v108, v112
    v_permlane16_swap_b32 v109, v113
    v_permlane16_swap_b32 v110, v114
    v_permlane16_swap_b32 v111, v115
    v_permlane16_swap_b32 v116, v120
    v_permlane16_swap_b32 v117, v121
    v_permlane16_swap_b32 v118, v122
    v_permlane16_swap_b32 v119, v123
    s_waitcnt lgkmcnt(0)
    s_barrier
    ds_read_b32 v12, v11 offset:40960
    v_pk_add_f32 v[124:125], v[124:125], v[100:101]
    v_pk_add_f32 v[126:127], v[126:127], v[102:103]
    v_pk_add_f32 v[128:129], v[128:129], v[104:105]
    v_pk_add_f32 v[130:131], v[130:131], v[106:107]
    v_pk_add_f32 v[132:133], v[132:133], v[108:109]
    v_pk_add_f32 v[134:135], v[134:135], v[110:111]
    v_pk_add_f32 v[136:137], v[136:137], v[112:113]
    v_pk_add_f32 v[138:139], v[138:139], v[114:115]
    v_pk_add_f32 v[140:141], v[140:141], v[116:117]
    v_pk_add_f32 v[142:143], v[142:143], v[118:119]
    v_pk_add_f32 v[144:145], v[144:145], v[120:121]
    v_pk_add_f32 v[146:147], v[146:147], v[122:123]
    v_mov_b32 v14, 0
    v_mov_b32 v15, 0
    s_waitcnt lgkmcnt(0)
    v_add_f32 v12, v12, v252
    v_pk_add_f32 v[100:101], v[124:125], v[12:13] op_sel_hi:[1,0] neg_lo:[0,1] neg_hi:[0,1]
    v_pk_add_f32 v[102:103], v[126:127], v[12:13] op_sel_hi:[1,0] neg_lo:[0,1] neg_hi:[0,1]
    v_pk_add_f32 v[104:105], v[128:129], v[12:13] op_sel_hi:[1,0] neg_lo:[0,1] neg_hi:[0,1]
    v_pk_add_f32 v[106:107], v[130:131], v[12:13] op_sel_hi:[1,0] neg_lo:[0,1] neg_hi:[0,1]
    v_cvt_pk_bf16_f32 v148, v100, v101
    v_cvt_pk_bf16_f32 v149, v102, v103
    v_cvt_pk_bf16_f32 v150, v104, v105
    v_cvt_pk_bf16_f32 v151, v106, v107
    buffer_store_dwordx4 v[148:151], v9, s[8:11], s46 offen offset:0 sc1
    v_pk_add_f32 v[108:109], v[132:133], v[12:13] op_sel_hi:[1,0] neg_lo:[0,1] neg_hi:[0,1]
    v_pk_add_f32 v[110:111], v[134:135], v[12:13] op_sel_hi:[1,0] neg_lo:[0,1] neg_hi:[0,1]
    v_pk_add_f32 v[112:113], v[136:137], v[12:13] op_sel_hi:[1,0] neg_lo:[0,1] neg_hi:[0,1]
    v_pk_add_f32 v[114:115], v[138:139], v[12:13] op_sel_hi:[1,0] neg_lo:[0,1] neg_hi:[0,1]
    v_cvt_pk_bf16_f32 v152, v108, v109
    v_cvt_pk_bf16_f32 v153, v110, v111
    v_cvt_pk_bf16_f32 v154, v112, v113
    v_cvt_pk_bf16_f32 v155, v114, v115
    buffer_store_dwordx4 v[152:155], v9, s[8:11], s46 offen offset:1024 sc1
    v_pk_add_f32 v[116:117], v[140:141], v[12:13] op_sel_hi:[1,0] neg_lo:[0,1] neg_hi:[0,1]
    v_pk_add_f32 v[118:119], v[142:143], v[12:13] op_sel_hi:[1,0] neg_lo:[0,1] neg_hi:[0,1]
    v_pk_add_f32 v[120:121], v[144:145], v[12:13] op_sel_hi:[1,0] neg_lo:[0,1] neg_hi:[0,1]
    v_pk_add_f32 v[122:123], v[146:147], v[12:13] op_sel_hi:[1,0] neg_lo:[0,1] neg_hi:[0,1]
    v_cvt_pk_bf16_f32 v156, v116, v117
    v_cvt_pk_bf16_f32 v157, v118, v119
    v_cvt_pk_bf16_f32 v158, v120, v121
    v_cvt_pk_bf16_f32 v159, v122, v123
    buffer_store_dwordx4 v[156:159], v7, s[8:11], s46 offen offset:2048 sc1
    v_dot2c_f32_bf16 v14, v148, v148
    v_dot2c_f32_bf16 v14, v149, v149
    v_dot2c_f32_bf16 v14, v150, v150
    v_dot2c_f32_bf16 v14, v151, v151
    v_dot2c_f32_bf16 v14, v152, v152
    v_dot2c_f32_bf16 v14, v153, v153
    v_dot2c_f32_bf16 v14, v154, v154
    v_dot2c_f32_bf16 v14, v155, v155
    v_dot2c_f32_bf16 v15, v156, v156
    v_dot2c_f32_bf16 v15, v157, v157
    v_dot2c_f32_bf16 v15, v158, v158
    v_dot2c_f32_bf16 v15, v159, v159
    buffer_store_dword v12, v6, s[8:11], s36 offen sc1
    s_nop 1
    v_fma_f32 v14, v15, s35, v14
    v_mov_b32 v15, v14
    s_nop 1
    v_permlane32_swap_b32 v14, v15
    v_add_f32 v14, v14, v15
    buffer_store_dword v14, v8, s[8:11], s45 offen sc1
    v_lshlrev_b32 v15, 7, v0
    s_lshl_b32 s6, s40, 2
    s_add_u32 s6, s6, s44
    s_add_u32 s6, s6, 32768
    v_mov_b32 v1, s76
    s_mov_b64 vcc, 0xff
    s_waitcnt vmcnt(0)
    s_barrier
    s_cmp_lg_u32 s3, 0
    s_cbranch_scc1 L_pub_29
    s_mov_b64 exec, vcc
    buffer_store_dword v1, v15, s[8:11], s6 offen sc1
L_pub_29:
    s_mov_b64 exec, -1
    s_lshl_b32 s7, s41, 2
    s_add_u32 s7, s7, s3
    s_mul_i32 s22, s7, 18432
    s_add_u32 s22, s22, s43
    s_add_u32 s22, s22, 45875200
    s_mul_i32 s24, s3, 18432
    s_lshl_b32 s25, s41, 12
    s_add_u32 s25, s25, s43
    s_add_u32 s25, s25, 48300032
    v_lshrrev_b32 v3, 5, v0
    v_and_b32 v10, 31, v0
    v_lshlrev_b32 v10, 2, v10
    v_lshl_add_u32 v3, v3, 11, v10
    v_add_u32 v11, 36864, v184
    s_mov_b32 s16, 0xffff0000
    s_lshl_b32 s7, s3, 10
    v_add_u32 v172, s7, v253
    v_add_u32 v174, 5120, v172
    v_and_b32 v178, 7, v0
    v_mul_u32_u24 v178, 1152, v178
    v_lshrrev_b32 v179, 3, v0
    v_lshl_add_u32 v178, v179, 4, v178
    s_lshl_b32 s7, s3, 7
    v_add_u32 v175, s7, v178
    v_add_u32 v177, 640, v175
    s_cmp_eq_u32 s3, 0
    s_mov_b32 s17, 1073741824
    s_cmov_b32 s17, 4096
    v_add_u32 v173, s17, v172
    s_mov_b32 s17, 1073741824
    s_cmov_b32 s17, 512
    v_add_u32 v176, s17, v175
    s_lshl_b32 s21, s41, 3
    s_add_u32 s21, s21, s40
    s_mul_i32 s18, s21, 9216
    s_mul_i32 s20, s21, 73728
    s_add_u32 s20, s20, 19922944
    v_bfe_u32 v1, v0, 3, 2
    s_mov_b32 s7, 73728
    v_mul_lo_u32 v178, v1, s7
    v_lshrrev_b32 v1, 5, v0
    v_lshl_add_u32 v178, v1, 7, v178
    v_and_b32 v1, 7, v0
    v_lshl_add_u32 v178, v1, 4, v178
    v_add_u32 v179, 294912, v178
    v_lshrrev_b32 v1, 5, v0
    v_and_b32 v15, 7, v0
    v_lshlrev_b32 v15, 4, v15
    v_lshl_add_u32 v15, v1, 7, v15
    s_lshl_b32 s7, s3, 8
    s_add_u32 s7, s7, 3072
    v_add_u32 v15, s7, v15
    v_bfe_u32 v1, v0, 3, 2
    v_mov_b32 v182, 1073741824
    v_add_u32 v183, 14336, v253
    s_sub_u32 s7, s40, 0
    v_cmp_eq_u32 vcc, s7, v1
    s_nop 1
    v_cndmask_b32 v178, v178, v182, vcc
    v_cndmask_b32 v216, v183, v15, vcc
    v_cndmask_b32 v218, 0, 1, vcc
    v_lshlrev_b32 v218, 10, v218
    s_sub_u32 s7, s40, 4
    v_cmp_eq_u32 vcc, s7, v1
    s_nop 1
    v_cndmask_b32 v179, v179, v182, vcc
    v_cndmask_b32 v217, v183, v15, vcc
    v_cndmask_b32 v219, 0, 1, vcc
    v_lshlrev_b32 v219, 10, v219
    s_mul_i32 s26, s41, 589824
    s_mul_i32 s7, s40, 9216
    s_add_u32 s26, s26, s7
    s_lshl_b32 s7, s3, 8
    s_add_u32 s27, s26, s7
    s_add_u32 s27, s27, 19921920
    s_mov_b32 s72, s8
    s_mov_b32 s73, s9
    s_mov_b32 s74, 0
    s_mul_i32 s7, s42, 98304
    s_sub_u32 s29, s44, s7
    s_add_u32 s29, s29, 360448
    s_lshl_b32 s7, s40, 7
    s_add_u32 s7, s7, s29
    s_add_u32 s38, s4, s7
    s_addc_u32 s39, s5, 0
    s_lshl_b32 s7, s40, 2
    s_add_u32 s29, s29, s7
    s_add_u32 s50, s23, 497664
    s_cmp_lg_u32 s42, 0
    s_cbranch_scc1 L_ring_30
    s_cmp_lg_u32 s3, 0
    s_cbranch_scc1 L_ring_31
    s_lshl_b32 s7, s41, 3
    s_add_u32 s7, s7, s40
    s_lshl_b32 s7, s7, 7
    s_add_u32 s7, s7, 19464192
    s_add_u32 s68, s4, s7
    s_addc_u32 s69, s5, 0
    s_mov_b32 s6, 0
    s_mov_b32 s7, 0
L_cpoll_32:
    s_load_dwordx16 s[52:67], s[68:69], s7 glc
    s_add_u32 s6, s6, 1
    s_waitcnt lgkmcnt(0)
    s_xor_b64 s[52:53], s[52:53], s[76:77]
    s_xor_b64 s[54:55], s[54:55], s[76:77]
    s_xor_b64 s[56:57], s[56:57], s[76:77]
    s_xor_b64 s[58:59], s[58:59], s[76:77]
    s_xor_b64 s[60:61], s[60:61], s[76:77]
    s_xor_b64 s[62:63], s[62:63], s[76:77]
    s_xor_b64 s[64:65], s[64:65], s[76:77]
    s_xor_b64 s[66:67], s[66:67], s[76:77]
    s_or_b64 s[52:53], s[52:53], s[60:61]
    s_or_b64 s[54:55], s[54:55], s[62:63]
    s_or_b64 s[56:57], s[56:57], s[64:65]
    s_or_b64 s[58:59], s[58:59], s[66:67]
    s_or_b64 s[52:53], s[52:53], s[56:57]
    s_or_b64 s[54:55], s[54:55], s[58:59]
    s_or_b64 s[52:53], s[52:53], s[54:55]
    s_cbranch_scc1 L_cpoll_33
    s_add_u32 s7, s7, 64
    s_cmp_eq_u32 s7, 128
    s_cbranch_scc1 L_cpolled_34
L_cpoll_33:
    s_cmp_lt_u32 s6, 1048576
    s_cbranch_scc1 L_cpoll_32
    s_branch L_main_end
L_cpolled_34:
L_ring_31:
    s_barrier
    buffer_load_dwordx4 v[16:19], v184, s[48:51], s23 offen offset:0 sc1
    buffer_load_dwordx4 v[20:23], v184, s[48:51], s23 offen offset:1024 sc1
    buffer_load_dwordx4 v[24:27], v184, s[48:51], s23 offen offset:2048 sc1
    buffer_load_dwordx4 v[28:31], v184, s[48:51], s23 offen offset:3072 sc1
    buffer_load_dwordx4 v[32:35], v185, s[48:51], s23 offen offset:0 sc1
    buffer_load_dwordx4 v[36:39], v185, s[48:51], s23 offen offset:1024 sc1
    buffer_load_dwordx4 v[40:43], v185, s[48:51], s23 offen offset:2048 sc1
    buffer_load_dwordx4 v[44:47], v185, s[48:51], s23 offen offset:3072 sc1
    buffer_load_dwordx4 v[48:51], v186, s[48:51], s23 offen offset:0 sc1
    buffer_load_dwordx4 v[52:55], v186, s[48:51], s23 offen offset:1024 sc1
    buffer_load_dwordx4 v[56:59], v186, s[48:51], s23 offen offset:2048 sc1
    buffer_load_dwordx4 v[60:63], v186, s[48:51], s23 offen offset:3072 sc1
    buffer_load_dwordx4 v[64:67], v187, s[48:51], s23 offen offset:0 sc1
    buffer_load_dwordx4 v[68:71], v187, s[48:51], s23 offen offset:1024 sc1
    buffer_load_dwordx4 v[72:75], v187, s[48:51], s23 offen offset:2048 sc1
L_ring_30:
    s_cmp_lg_u32 s3, 3
    s_cbranch_scc1 L_pollout_37
    s_lshl_b32 s7, s40, 7
    s_add_u32 s7, s7, s44
    s_add_u32 s7, s7, 32768
    s_add_u32 s52, s4, s7
    s_addc_u32 s53, s5, 0
    s_mov_b32 s6, 0
L_poll_35:
    s_load_dwordx8 s[56:63], s[52:53], 0 glc
    s_add_u32 s6, s6, 1
    s_waitcnt lgkmcnt(0)
    s_xor_b64 s[56:57], s[56:57], s[76:77]
    s_xor_b64 s[58:59], s[58:59], s[76:77]
    s_xor_b64 s[60:61], s[60:61], s[76:77]
    s_xor_b64 s[62:63], s[62:63], s[76:77]
    s_or_b64 s[56:57], s[56:57], s[58:59]
    s_or_b64 s[60:61], s[60:61], s[62:63]
    s_or_b64 s[56:57], s[56:57], s[60:61]
    s_cbranch_scc0 L_polled_36
    s_cmp_lt_u32 s6, 1048576
    s_cbranch_scc1 L_poll_35
    s_branch L_main_end
L_polled_36:
L_pollout_37:
    s_barrier
    s_add_u32 m0, s24, 0
    s_nop 0
    buffer_load_dwordx4 v2, s[8:11], s22 offen offset:0 sc1 lds
    s_add_u32 m0, s24, 512
    s_nop 0
    buffer_load_dwordx4 v2, s[8:11], s22 offen offset:512 sc1 lds
    s_add_u32 m0, s24, 1024
    s_nop 0
    buffer_load_dwordx4 v2, s[8:11], s22 offen offset:1024 sc1 lds
    s_add_u32 m0, s24, 1536
    s_nop 0
    buffer_load_dwordx4 v2, s[8:11], s22 offen offset:1536 sc1 lds
    s_add_u32 m0, s24, 2048
    s_nop 0
    buffer_load_dwordx4 v2, s[8:11], s22 offen offset:2048 sc1 lds
    s_add_u32 m0, s24, 2560
    s_nop 0
    buffer_load_dwordx4 v2, s[8:11], s22 offen offset:2560 sc1 lds
    s_add_u32 m0, s24, 3072
    s_nop 0
    buffer_load_dwordx4 v2, s[8:11], s22 offen offset:3072 sc1 lds
    s_add_u32 m0, s24, 3584
    s_nop 0
    buffer_load_dwordx4 v2, s[8:11], s22 offen offset:3584 sc1 lds
    s_add_u32 m0, s24, 8192
    s_add_u32 s22, s22, 4096
    buffer_load_dwordx4 v2, s[8:11], s22 offen offset:0 sc1 lds
    s_add_u32 m0, s24, 8704
    s_nop 0
    buffer_load_dwordx4 v2, s[8:11], s22 offen offset:512 sc1 lds
    s_add_u32 m0, s24, 9216
    s_nop 0
    buffer_load_dwordx4 v2, s[8:11], s22 offen offset:1024 sc1 lds
    s_add_u32 m0, s24, 9728
    s_nop 0
    buffer_load_dwordx4 v2, s[8:11], s22 offen offset:1536 sc1 lds
    s_add_u32 s23, s23, 15360
    s_lshr_b32 s7, s3, 1
    s_lshl_b32 s7, s7, 10
    s_and_b32 s6, s3, 1
    s_lshl_b32 s6, s6, 3
    s_add_u32 s28, s7, s6
    s_add_u32 s28, s28, 73728
    s_waitcnt vmcnt(6)
    s_barrier
    ds_read_b128 a[0:3], v184 offset:0
    ds_read_b128 a[72:75], v184 offset:18432
    ds_read_b128 a[144:147], v11 offset:0
    ds_read_b128 a[216:219], v11 offset:18432
    ds_read_b128 a[4:7], v184 offset:1024
    ds_read_b128 a[76:79], v184 offset:19456
    ds_read_b128 a[148:151], v11 offset:1024
    ds_read_b128 a[220:223], v11 offset:19456
    ds_read_b128 a[8:11], v184 offset:2048
    ds_read_b128 a[80:83], v184 offset:20480
    ds_read_b128 a[152:155], v11 offset:2048
    ds_read_b128 a[224:227], v11 offset:20480
    s_waitcnt vmcnt(24) lgkmcnt(0)
    v_mfma_f32_16x16x32_bf16 v[88:91], v[16:19], a[0:3], 0
    ds_read_b128 a[12:15], v184 offset:3072
    v_mfma_f32_16x16x32_bf16 v[88:91], v[20:23], a[4:7], v[88:91]
    buffer_load_dwordx4 v[76:79], v184, s[48:51], s23 offen offset:0 sc1
    v_mfma_f32_16x16x32_bf16 v[88:91], v[24:27], a[8:11], v[88:91]
    ds_read_b128 a[84:87], v184 offset:21504
    v_mfma_f32_16x16x32_bf16 v[92:95], v[16:19], a[72:75], 0
    s_add_u32 m0, s24, 10240
    s_nop 0
    buffer_load_dwordx4 v2, s[8:11], s22 offen offset:2048 sc1 lds
    v_mfma_f32_16x16x32_bf16 v[92:95], v[20:23], a[76:79], v[92:95]
    ds_read_b128 a[156:159], v11 offset:3072
    ds_read_b128 a[228:231], v11 offset:21504
    v_mfma_f32_16x16x32_bf16 v[92:95], v[24:27], a[80:83], v[92:95]
    buffer_load_dwordx4 v[80:83], v184, s[48:51], s23 offen offset:1024 sc1
    v_mfma_f32_16x16x32_bf16 v[96:99], v[16:19], a[144:147], 0
    ds_read_b128 a[16:19], v184 offset:4096
    v_mfma_f32_16x16x32_bf16 v[96:99], v[20:23], a[148:151], v[96:99]
    s_add_u32 m0, s24, 10752
    s_nop 0
    buffer_load_dwordx4 v2, s[8:11], s22 offen offset:2560 sc1 lds
    v_mfma_f32_16x16x32_bf16 v[96:99], v[24:27], a[152:155], v[96:99]
    ds_read_b128 a[88:91], v184 offset:22528
    v_mfma_f32_16x16x32_bf16 v[100:103], v[16:19], a[216:219], 0
    buffer_load_dwordx4 v[84:87], v184, s[48:51], s23 offen offset:2048 sc1
    v_mfma_f32_16x16x32_bf16 v[100:103], v[20:23], a[220:223], v[100:103]
    ds_read_b128 a[160:163], v11 offset:4096
    ds_read_b128 a[232:235], v11 offset:22528
    v_mfma_f32_16x16x32_bf16 v[100:103], v[24:27], a[224:227], v[100:103]
    s_add_u32 m0, s24, 11264
    s_nop 0
    buffer_load_dwordx4 v2, s[8:11], s22 offen offset:3072 sc1 lds
    s_waitcnt vmcnt(27) lgkmcnt(8)
    v_mfma_f32_16x16x32_bf16 v[104:107], v[28:31], a[0:3], 0
    ds_read_b128 a[20:23], v184 offset:5120
    v_mfma_f32_16x16x32_bf16 v[104:107], v[32:35], a[4:7], v[104:107]
    buffer_load_dwordx4 v[16:19], v184, s[48:51], s23 offen offset:3072 sc1
    v_mfma_f32_16x16x32_bf16 v[104:107], v[36:39], a[8:11], v[104:107]
    ds_read_b128 a[92:95], v184 offset:23552
    v_mfma_f32_16x16x32_bf16 v[108:111], v[28:31], a[72:75], 0
    s_add_u32 m0, s24, 11776
    s_nop 0
    buffer_load_dwordx4 v2, s[8:11], s22 offen offset:3584 sc1 lds
    v_mfma_f32_16x16x32_bf16 v[108:111], v[32:35], a[76:79], v[108:111]
    ds_read_b128 a[164:167], v11 offset:5120
    ds_read_b128 a[236:239], v11 offset:23552
    v_mfma_f32_16x16x32_bf16 v[108:111], v[36:39], a[80:83], v[108:111]
    buffer_load_dwordx4 v[20:23], v185, s[48:51], s23 offen offset:0 sc1
    v_mfma_f32_16x16x32_bf16 v[112:115], v[28:31], a[144:147], 0
    v_mfma_f32_16x16x32_bf16 v[112:115], v[32:35], a[148:151], v[112:115]
    s_add_u32 m0, s24, 16384
    s_add_u32 s22, s22, 4096
    buffer_load_dwordx4 v2, s[8:11], s22 offen offset:0 sc1 lds
    v_mfma_f32_16x16x32_bf16 v[112:115], v[36:39], a[152:155], v[112:115]
    v_mfma_f32_16x16x32_bf16 v[116:119], v[28:31], a[216:219], 0
    buffer_load_dwordx4 v[24:27], v185, s[48:51], s23 offen offset:1024 sc1
    v_mfma_f32_16x16x32_bf16 v[116:119], v[32:35], a[220:223], v[116:119]
    v_mfma_f32_16x16x32_bf16 v[116:119], v[36:39], a[224:227], v[116:119]
    s_add_u32 m0, s24, 16896
    s_nop 0
    buffer_load_dwordx4 v2, s[8:11], s22 offen offset:512 sc1 lds
    s_waitcnt vmcnt(12) lgkmcnt(0)
    s_barrier
    v_mfma_f32_16x16x32_bf16 v[88:91], v[40:43], a[12:15], v[88:91]
    ds_read_b128 a[24:27], v184 offset:6144
    v_mfma_f32_16x16x32_bf16 v[88:91], v[44:47], a[16:19], v[88:91]
    buffer_load_dwordx4 v[28:31], v185, s[48:51], s23 offen offset:2048 sc1
    v_mfma_f32_16x16x32_bf16 v[88:91], v[48:51], a[20:23], v[88:91]
    ds_read_b128 a[96:99], v184 offset:24576
    v_mfma_f32_16x16x32_bf16 v[92:95], v[40:43], a[84:87], v[92:95]
    buffer_load_dword v136, v3, s[8:11], s25 offen offset:0 sc1
    v_mfma_f32_16x16x32_bf16 v[92:95], v[44:47], a[88:91], v[92:95]
    ds_read_b128 a[168:171], v11 offset:6144
    ds_read_b128 a[240:243], v11 offset:24576
    v_mfma_f32_16x16x32_bf16 v[92:95], v[48:51], a[92:95], v[92:95]
    buffer_load_dwordx4 v[32:35], v185, s[48:51], s23 offen offset:3072 sc1
    v_mfma_f32_16x16x32_bf16 v[96:99], v[40:43], a[156:159], v[96:99]
    buffer_load_dword v137, v3, s[8:11], s25 offen offset:128 sc1
    v_mfma_f32_16x16x32_bf16 v[96:99], v[44:47], a[160:163], v[96:99]
    buffer_load_dword v138, v3, s[8:11], s25 offen offset:256 sc1
    v_mfma_f32_16x16x32_bf16 v[96:99], v[48:51], a[164:167], v[96:99]
    ds_read_b128 a[28:31], v184 offset:7168
    ds_read_b128 a[100:103], v184 offset:25600
    v_mfma_f32_16x16x32_bf16 v[100:103], v[40:43], a[228:231], v[100:103]
    buffer_load_dwordx4 v[36:39], v186, s[48:51], s23 offen offset:0 sc1
    v_mfma_f32_16x16x32_bf16 v[100:103], v[44:47], a[232:235], v[100:103]
    buffer_load_dword v139, v3, s[8:11], s25 offen offset:384 sc1
    v_mfma_f32_16x16x32_bf16 v[100:103], v[48:51], a[236:239], v[100:103]
    buffer_load_dword v140, v3, s[8:11], s25 offen offset:512 sc1
    s_waitcnt vmcnt(35) lgkmcnt(6)
    v_mfma_f32_16x16x32_bf16 v[104:107], v[52:55], a[12:15], v[104:107]
    ds_read_b128 a[172:175], v11 offset:7168
    ds_read_b128 a[244:247], v11 offset:25600
    v_mfma_f32_16x16x32_bf16 v[104:107], v[56:59], a[16:19], v[104:107]
    buffer_load_dwordx4 v[40:43], v186, s[48:51], s23 offen offset:1024 sc1
    v_mfma_f32_16x16x32_bf16 v[104:107], v[60:63], a[20:23], v[104:107]
    ds_read_b128 a[32:35], v184 offset:8192
    ds_read_b128 a[104:107], v184 offset:26624
    v_mfma_f32_16x16x32_bf16 v[108:111], v[52:55], a[84:87], v[108:111]
    buffer_load_dword v141, v3, s[8:11], s25 offen offset:640 sc1
    v_mfma_f32_16x16x32_bf16 v[108:111], v[56:59], a[88:91], v[108:111]
    ds_read_b128 a[176:179], v11 offset:8192
    ds_read_b128 a[248:251], v11 offset:26624
    v_mfma_f32_16x16x32_bf16 v[108:111], v[60:63], a[92:95], v[108:111]
    buffer_load_dwordx4 v[44:47], v186, s[48:51], s23 offen offset:2048 sc1
    v_mfma_f32_16x16x32_bf16 v[112:115], v[52:55], a[156:159], v[112:115]
    buffer_load_dword v142, v3, s[8:11], s25 offen offset:768 sc1
    v_mfma_f32_16x16x32_bf16 v[112:115], v[56:59], a[160:163], v[112:115]
    buffer_load_dword v143, v3, s[8:11], s25 offen offset:896 sc1
    v_mfma_f32_16x16x32_bf16 v[112:115], v[60:63], a[164:167], v[112:115]
    v_mfma_f32_16x16x32_bf16 v[116:119], v[52:55], a[228:231], v[116:119]
    buffer_load_dwordx4 v[48:51], v186, s[48:51], s23 offen offset:3072 sc1
    v_mfma_f32_16x16x32_bf16 v[116:119], v[56:59], a[232:235], v[116:119]
    buffer_load_dword v144, v3, s[8:11], s25 offen offset:1024 sc1
    v_mfma_f32_16x16x32_bf16 v[116:119], v[60:63], a[236:239], v[116:119]
    buffer_load_dword v145, v3, s[8:11], s25 offen offset:1152 sc1
    s_waitcnt vmcnt(40) lgkmcnt(0)
    v_mfma_f32_16x16x32_bf16 v[88:91], v[64:67], a[24:27], v[88:91]
    ds_read_b128 a[36:39], v184 offset:9216
    v_mfma_f32_16x16x32_bf16 v[88:91], v[68:71], a[28:31], v[88:91]
    buffer_load_dwordx4 v[52:55], v187, s[48:51], s23 offen offset:0 sc1
    v_mfma_f32_16x16x32_bf16 v[88:91], v[72:75], a[32:35], v[88:91]
    ds_read_b128 a[108:111], v184 offset:27648
    v_mfma_f32_16x16x32_bf16 v[92:95], v[64:67], a[96:99], v[92:95]
    buffer_load_dword v146, v3, s[8:11], s25 offen offset:1280 sc1
    v_mfma_f32_16x16x32_bf16 v[92:95], v[68:71], a[100:103], v[92:95]
    ds_read_b128 a[180:183], v11 offset:9216
    ds_read_b128 a[252:255], v11 offset:27648
    v_mfma_f32_16x16x32_bf16 v[92:95], v[72:75], a[104:107], v[92:95]
    buffer_load_dwordx4 v[56:59], v187, s[48:51], s23 offen offset:1024 sc1
    v_mfma_f32_16x16x32_bf16 v[96:99], v[64:67], a[168:171], v[96:99]
    buffer_load_dword v147, v3, s[8:11], s25 offen offset:1408 sc1
    v_mfma_f32_16x16x32_bf16 v[96:99], v[68:71], a[172:175], v[96:99]
    buffer_load_dword v148, v3, s[8:11], s25 offen offset:1536 sc1
    v_mfma_f32_16x16x32_bf16 v[96:99], v[72:75], a[176:179], v[96:99]
    ds_read_b128 a[40:43], v184 offset:10240
    ds_read_b128 a[112:115], v184 offset:28672
    v_mfma_f32_16x16x32_bf16 v[100:103], v[64:67], a[240:243], v[100:103]
    buffer_load_dwordx4 v[60:63], v187, s[48:51], s23 offen offset:2048 sc1
    v_mfma_f32_16x16x32_bf16 v[100:103], v[68:71], a[244:247], v[100:103]
    buffer_load_dword v149, v3, s[8:11], s25 offen offset:1664 sc1
    v_mfma_f32_16x16x32_bf16 v[100:103], v[72:75], a[248:251], v[100:103]
    buffer_load_dword v150, v3, s[8:11], s25 offen offset:1792 sc1
    s_waitcnt vmcnt(31) lgkmcnt(6)
    v_mfma_f32_16x16x32_bf16 v[104:107], v[76:79], a[24:27], v[104:107]
    ds_read_b128 a[184:187], v11 offset:10240
    ds_read_b128 v[220:223], v11 offset:28672
    v_mfma_f32_16x16x32_bf16 v[104:107], v[80:83], a[28:31], v[104:107]
    buffer_load_dwordx4 v[64:67], v187, s[48:51], s23 offen offset:3072 sc1
    v_mfma_f32_16x16x32_bf16 v[104:107], v[84:87], a[32:35], v[104:107]
    ds_read_b128 a[44:47], v184 offset:11264
    ds_read_b128 a[116:119], v184 offset:29696
    v_mfma_f32_16x16x32_bf16 v[108:111], v[76:79], a[96:99], v[108:111]
    buffer_load_dword v151, v3, s[8:11], s25 offen offset:1920 sc1
    v_mfma_f32_16x16x32_bf16 v[108:111], v[80:83], a[100:103], v[108:111]
    ds_read_b128 a[188:191], v11 offset:11264
    ds_read_b128 v[224:227], v11 offset:29696
    v_mfma_f32_16x16x32_bf16 v[108:111], v[84:87], a[104:107], v[108:111]
    buffer_load_dwordx4 v[68:71], v188, s[48:51], s23 offen offset:0 sc1
    v_mfma_f32_16x16x32_bf16 v[112:115], v[76:79], a[168:171], v[112:115]
    v_mfma_f32_16x16x32_bf16 v[112:115], v[80:83], a[172:175], v[112:115]
    v_mfma_f32_16x16x32_bf16 v[112:115], v[84:87], a[176:179], v[112:115]
    v_mfma_f32_16x16x32_bf16 v[116:119], v[76:79], a[240:243], v[116:119]
    buffer_load_dwordx4 v[72:75], v188, s[48:51], s23 offen offset:1024 sc1
    v_mfma_f32_16x16x32_bf16 v[116:119], v[80:83], a[244:247], v[116:119]
    v_mfma_f32_16x16x32_bf16 v[116:119], v[84:87], a[248:251], v[116:119]
    s_waitcnt vmcnt(28) lgkmcnt(0)
    s_barrier
    v_mfma_f32_16x16x32_bf16 v[88:91], v[16:19], a[36:39], v[88:91]
    ds_read_b128 a[48:51], v184 offset:12288
    v_mfma_f32_16x16x32_bf16 v[88:91], v[20:23], a[40:43], v[88:91]
    buffer_load_dwordx4 v[76:79], v188, s[48:51], s23 offen offset:2048 sc1
    v_mfma_f32_16x16x32_bf16 v[88:91], v[24:27], a[44:47], v[88:91]
    ds_read_b128 a[120:123], v184 offset:30720
    v_mfma_f32_16x16x32_bf16 v[92:95], v[16:19], a[108:111], v[92:95]
    ds_read_b128 a[192:195], v11 offset:12288
    v_mfma_f32_16x16x32_bf16 v[92:95], v[20:23], a[112:115], v[92:95]
    ds_read_b128 v[228:231], v11 offset:30720
    v_mfma_f32_16x16x32_bf16 v[92:95], v[24:27], a[116:119], v[92:95]
    buffer_load_dwordx4 v[80:83], v188, s[48:51], s23 offen offset:3072 sc1
    v_mfma_f32_16x16x32_bf16 v[96:99], v[16:19], a[180:183], v[96:99]
    ds_read_b128 a[52:55], v184 offset:13312
    v_mfma_f32_16x16x32_bf16 v[96:99], v[20:23], a[184:187], v[96:99]
    ds_read_b128 a[124:127], v184 offset:31744
    v_mfma_f32_16x16x32_bf16 v[96:99], v[24:27], a[188:191], v[96:99]
    v_mfma_f32_16x16x32_bf16 v[100:103], v[16:19], a[252:255], v[100:103]
    buffer_load_dwordx4 v[84:87], v189, s[48:51], s23 offen offset:0 sc1
    v_mfma_f32_16x16x32_bf16 v[100:103], v[20:23], v[220:223], v[100:103]
    ds_read_b128 a[196:199], v11 offset:13312
    ds_read_b128 v[232:235], v11 offset:31744
    v_mfma_f32_16x16x32_bf16 v[100:103], v[24:27], v[224:227], v[100:103]
    s_waitcnt vmcnt(25) lgkmcnt(8)
    v_mfma_f32_16x16x32_bf16 v[104:107], v[28:31], a[36:39], v[104:107]
    ds_read_b128 a[56:59], v184 offset:14336
    v_mfma_f32_16x16x32_bf16 v[104:107], v[32:35], a[40:43], v[104:107]
    buffer_load_dwordx4 v[16:19], v189, s[48:51], s23 offen offset:1024 sc1
    v_mfma_f32_16x16x32_bf16 v[104:107], v[36:39], a[44:47], v[104:107]
    ds_read_b128 a[128:131], v184 offset:32768
    v_mfma_f32_16x16x32_bf16 v[108:111], v[28:31], a[108:111], v[108:111]
    ds_read_b128 a[200:203], v11 offset:14336
    v_mfma_f32_16x16x32_bf16 v[108:111], v[32:35], a[112:115], v[108:111]
    ds_read_b128 v[236:239], v11 offset:32768
    v_mfma_f32_16x16x32_bf16 v[108:111], v[36:39], a[116:119], v[108:111]
    buffer_load_dwordx4 v[20:23], v189, s[48:51], s23 offen offset:2048 sc1
    v_mfma_f32_16x16x32_bf16 v[112:115], v[28:31], a[180:183], v[112:115]
    v_mfma_f32_16x16x32_bf16 v[112:115], v[32:35], a[184:187], v[112:115]
    v_mfma_f32_16x16x32_bf16 v[112:115], v[36:39], a[188:191], v[112:115]
    v_mfma_f32_16x16x32_bf16 v[116:119], v[28:31], a[252:255], v[116:119]
    buffer_load_dwordx4 v[24:27], v189, s[48:51], s23 offen offset:3072 sc1
    v_mfma_f32_16x16x32_bf16 v[116:119], v[32:35], v[220:223], v[116:119]
    v_mfma_f32_16x16x32_bf16 v[116:119], v[36:39], v[224:227], v[116:119]
    s_waitcnt vmcnt(8) lgkmcnt(0)
    v_mfma_f32_16x16x32_bf16 v[88:91], v[40:43], a[48:51], v[88:91]
    ds_read_b128 a[60:63], v184 offset:15360
    v_add_f32 v136, v136, v144
    v_mfma_f32_16x16x32_bf16 v[88:91], v[44:47], a[52:55], v[88:91]
    buffer_load_dwordx4 v[28:31], v190, s[48:51], s23 offen offset:0 sc1
    v_mfma_f32_16x16x32_bf16 v[88:91], v[48:51], a[56:59], v[88:91]
    ds_read_b128 a[132:135], v184 offset:33792
    v_add_f32 v137, v137, v145
    v_mfma_f32_16x16x32_bf16 v[92:95], v[40:43], a[120:123], v[92:95]
    ds_read_b128 a[204:207], v11 offset:15360
    v_add_f32 v138, v138, v146
    v_mfma_f32_16x16x32_bf16 v[92:95], v[44:47], a[124:127], v[92:95]
    ds_read_b128 v[240:243], v11 offset:33792
    v_add_f32 v139, v139, v147
    v_mfma_f32_16x16x32_bf16 v[92:95], v[48:51], a[128:131], v[92:95]
    buffer_load_dwordx4 v[32:35], v190, s[48:51], s23 offen offset:1024 sc1
    v_mfma_f32_16x16x32_bf16 v[96:99], v[40:43], a[192:195], v[96:99]
    ds_read_b128 a[64:67], v184 offset:16384
    v_add_f32 v140, v140, v148
    v_mfma_f32_16x16x32_bf16 v[96:99], v[44:47], a[196:199], v[96:99]
    ds_read_b128 a[136:139], v184 offset:34816
    v_add_f32 v141, v141, v149
    v_mfma_f32_16x16x32_bf16 v[96:99], v[48:51], a[200:203], v[96:99]
    v_add_f32 v142, v142, v150
    v_add_f32 v143, v143, v151
    v_mfma_f32_16x16x32_bf16 v[100:103], v[40:43], v[228:231], v[100:103]
    buffer_load_dwordx4 v[36:39], v190, s[48:51], s23 offen offset:2048 sc1
    v_mfma_f32_16x16x32_bf16 v[100:103], v[44:47], v[232:235], v[100:103]
    ds_read_b128 a[208:211], v11 offset:16384
    ds_read_b128 v[244:247], v11 offset:34816
    v_mfma_f32_16x16x32_bf16 v[100:103], v[48:51], v[236:239], v[100:103]
    v_add_f32 v136, v136, v140
    v_add_f32 v137, v137, v141
    s_waitcnt vmcnt(15) lgkmcnt(8)
    v_mfma_f32_16x16x32_bf16 v[104:107], v[52:55], a[48:51], v[104:107]
    ds_read_b128 a[68:71], v184 offset:17408
    v_add_f32 v138, v138, v142
    v_mfma_f32_16x16x32_bf16 v[104:107], v[56:59], a[52:55], v[104:107]
    buffer_load_dwordx4 v[40:43], v190, s[48:51], s23 offen offset:3072 sc1
    v_mfma_f32_16x16x32_bf16 v[104:107], v[60:63], a[56:59], v[104:107]
    ds_read_b128 a[140:143], v184 offset:35840
    v_add_f32 v139, v139, v143
    v_mfma_f32_16x16x32_bf16 v[108:111], v[52:55], a[120:123], v[108:111]
    ds_read_b128 a[212:215], v11 offset:17408
    v_add_f32 v136, v136, v138
    v_mfma_f32_16x16x32_bf16 v[108:111], v[56:59], a[124:127], v[108:111]
    ds_read_b128 v[248:251], v11 offset:35840
    v_add_f32 v137, v137, v139
    v_mfma_f32_16x16x32_bf16 v[108:111], v[60:63], a[128:131], v[108:111]
    buffer_load_dwordx4 v[44:47], v191, s[48:51], s23 offen offset:0 sc1
    v_mfma_f32_16x16x32_bf16 v[112:115], v[52:55], a[192:195], v[112:115]
    v_add_f32 v136, v136, v137
    v_mov_b32 v137, 0x3727c5ac
    v_mfma_f32_16x16x32_bf16 v[112:115], v[56:59], a[196:199], v[112:115]
    v_fmac_f32 v137, 0x3ae38e39, v136
    v_mov_b32 v193, v137
    v_mfma_f32_16x16x32_bf16 v[112:115], v[60:63], a[200:203], v[112:115]
    s_nop 0
    v_permlane16_swap_b32 v193, v137
    v_mfma_f32_16x16x32_bf16 v[116:119], v[52:55], v[228:231], v[116:119]
    buffer_load_dwordx4 v[48:51], v191, s[48:51], s23 offen offset:1024 sc1
    v_mfma_f32_16x16x32_bf16 v[116:119], v[56:59], v[232:235], v[116:119]
    v_mov_b32 v195, v193
    v_mov_b32 v194, v137
    v_mfma_f32_16x16x32_bf16 v[116:119], v[60:63], v[236:239], v[116:119]
    v_mov_b32 v252, v137
    s_waitcnt vmcnt(12) lgkmcnt(0)
    v_mfma_f32_16x16x32_bf16 v[88:91], v[64:67], a[60:63], v[88:91]
    s_nop 0
    v_permlane32_swap_b32 v193, v195
    v_mfma_f32_16x16x32_bf16 v[88:91], v[68:71], a[64:67], v[88:91]
    buffer_load_dwordx4 v[52:55], v191, s[48:51], s23 offen offset:2048 sc1
    v_mfma_f32_16x16x32_bf16 v[120:123], v[72:75], a[68:71], v[88:91]
    v_permlane32_swap_b32 v194, v252
    v_mfma_f32_16x16x32_bf16 v[92:95], v[64:67], a[132:135], v[92:95]
    v_rsq_f32 v4, v193
    v_mfma_f32_16x16x32_bf16 v[92:95], v[68:71], a[136:139], v[92:95]
    v_rsq_f32 v5, v194
    v_mfma_f32_16x16x32_bf16 v[124:127], v[72:75], a[140:143], v[92:95]
    buffer_load_dwordx4 v[56:59], v191, s[48:51], s23 offen offset:3072 sc1
    v_mfma_f32_16x16x32_bf16 v[96:99], v[64:67], a[204:207], v[96:99]
    v_rsq_f32 v6, v195
    v_mfma_f32_16x16x32_bf16 v[96:99], v[68:71], a[208:211], v[96:99]
    v_rsq_f32 v7, v252
    v_mfma_f32_16x16x32_bf16 v[128:131], v[72:75], a[212:215], v[96:99]
    v_mul_f32 v8, v4, v4
    v_mul_f32 v9, v5, v5
    v_mfma_f32_16x16x32_bf16 v[100:103], v[64:67], v[240:243], v[100:103]
    buffer_load_dwordx4 v[60:63], v192, s[48:51], s23 offen offset:0 sc1
    v_mfma_f32_16x16x32_bf16 v[100:103], v[68:71], v[244:247], v[100:103]
    v_mul_f32 v13, v6, v6
    v_mul_f32 v14, v7, v7
    v_mfma_f32_16x16x32_bf16 v[132:135], v[72:75], v[248:251], v[100:103]
    v_mul_f32 v4, 0xc0135761, v4
    v_mul_f32 v5, 0xc0135761, v5
    s_waitcnt vmcnt(12) lgkmcnt(0)
    v_mfma_f32_16x16x32_bf16 v[104:107], v[76:79], a[60:63], v[104:107]
    v_mul_f32 v6, 0xc0135761, v6
    v_mul_f32 v7, 0xc0135761, v7
    v_mfma_f32_16x16x32_bf16 v[104:107], v[80:83], a[64:67], v[104:107]
    buffer_load_dwordx4 v[64:67], v192, s[48:51], s23 offen offset:1024 sc1
    v_mfma_f32_16x16x32_bf16 v[136:139], v[84:87], a[68:71], v[104:107]
    v_mul_f32 v8, 0x3d372713, v8
    v_mul_f32 v9, 0x3d372713, v9
    v_mfma_f32_16x16x32_bf16 v[108:111], v[76:79], a[132:135], v[108:111]
    v_mul_f32 v13, 0x3d372713, v13
    v_mul_f32 v14, 0x3d372713, v14
    v_mfma_f32_16x16x32_bf16 v[108:111], v[80:83], a[136:139], v[108:111]
    v_mul_f32 v8, v8, v4
    v_mul_f32 v9, v9, v5
    v_mfma_f32_16x16x32_bf16 v[140:143], v[84:87], a[140:143], v[108:111]
    buffer_load_dwordx4 v[68:71], v192, s[48:51], s23 offen offset:2048 sc1
    v_mfma_f32_16x16x32_bf16 v[112:115], v[76:79], a[204:207], v[112:115]
    v_mul_f32 v13, v13, v6
    v_mul_f32 v14, v14, v7
    v_mfma_f32_16x16x32_bf16 v[112:115], v[80:83], a[208:211], v[112:115]
    s_mov_b32 s25, 0
    v_mfma_f32_16x16x32_bf16 v[144:147], v[84:87], a[212:215], v[112:115]
    s_mov_b32 s7, s28
    v_mfma_f32_16x16x32_bf16 v[116:119], v[76:79], v[240:243], v[116:119]
    buffer_load_dwordx4 v[72:75], v192, s[48:51], s23 offen offset:3072 sc1
    v_mfma_f32_16x16x32_bf16 v[116:119], v[80:83], v[244:247], v[116:119]
    s_add_u32 s23, s23, 36864
    v_mfma_f32_16x16x32_bf16 v[148:151], v[84:87], v[248:251], v[116:119]
    v_add_u32 v12, s7, v184
    s_add_u32 s25, s25, 1
L_ffn_gu_38:
    s_waitcnt vmcnt(12)
    v_mfma_f32_16x16x32_bf16 v[88:91], v[16:19], a[0:3], 0
    v_mfma_f32_16x16x32_bf16 v[88:91], v[20:23], a[4:7], v[88:91]
    buffer_load_dwordx4 v[76:79], v184, s[48:51], s23 offen offset:0 sc1
    v_mfma_f32_16x16x32_bf16 v[88:91], v[24:27], a[8:11], v[88:91]
    v_mul_f32 v152, v120, v120
    v_mul_f32 v153, v121, v121
    v_mfma_f32_16x16x32_bf16 v[92:95], v[16:19], a[72:75], 0
    v_mul_f32 v154, v122, v122
    v_mul_f32 v155, v123, v123
    v_mfma_f32_16x16x32_bf16 v[92:95], v[20:23], a[76:79], v[92:95]
    v_fma_f32 v152, v152, v8, v4
    v_fma_f32 v153, v153, v8, v4
    v_mfma_f32_16x16x32_bf16 v[92:95], v[24:27], a[80:83], v[92:95]
    buffer_load_dwordx4 v[80:83], v184, s[48:51], s23 offen offset:1024 sc1
    v_mfma_f32_16x16x32_bf16 v[96:99], v[16:19], a[144:147], 0
    v_fma_f32 v154, v154, v8, v4
    v_fma_f32 v155, v155, v8, v4
    v_mfma_f32_16x16x32_bf16 v[96:99], v[20:23], a[148:151], v[96:99]
    v_mul_f32 v152, v120, v152
    v_mul_f32 v153, v121, v153
    v_mfma_f32_16x16x32_bf16 v[96:99], v[24:27], a[152:155], v[96:99]
    v_mul_f32 v154, v122, v154
    v_mul_f32 v155, v123, v155
    v_mfma_f32_16x16x32_bf16 v[100:103], v[16:19], a[216:219], 0
    buffer_load_dwordx4 v[84:87], v184, s[48:51], s23 offen offset:2048 sc1
    v_mfma_f32_16x16x32_bf16 v[100:103], v[20:23], a[220:223], v[100:103]
    v_exp_f32 v152, v152
    v_mfma_f32_16x16x32_bf16 v[100:103], v[24:27], a[224:227], v[100:103]
    v_exp_f32 v153, v153
    s_waitcnt vmcnt(12)
    v_mfma_f32_16x16x32_bf16 v[104:107], v[28:31], a[0:3], 0
    v_exp_f32 v154, v154
    v_mfma_f32_16x16x32_bf16 v[104:107], v[32:35], a[4:7], v[104:107]
    buffer_load_dwordx4 v[16:19], v184, s[48:51], s23 offen offset:3072 sc1
    v_mfma_f32_16x16x32_bf16 v[104:107], v[36:39], a[8:11], v[104:107]
    v_exp_f32 v155, v155
    v_mfma_f32_16x16x32_bf16 v[108:111], v[28:31], a[72:75], 0
    v_mul_f32 v156, v120, v136
    v_mul_f32 v157, v121, v137
    v_mfma_f32_16x16x32_bf16 v[108:111], v[32:35], a[76:79], v[108:111]
    v_mul_f32 v158, v122, v138
    v_mul_f32 v159, v123, v139
    v_mfma_f32_16x16x32_bf16 v[108:111], v[36:39], a[80:83], v[108:111]
    buffer_load_dwordx4 v[20:23], v185, s[48:51], s23 offen offset:0 sc1
    v_mfma_f32_16x16x32_bf16 v[112:115], v[28:31], a[144:147], 0
    v_fma_f32 v152, v152, v193, v193
    v_fma_f32 v153, v153, v193, v193
    v_mfma_f32_16x16x32_bf16 v[112:115], v[32:35], a[148:151], v[112:115]
    v_fma_f32 v154, v154, v193, v193
    v_fma_f32 v155, v155, v193, v193
    v_mfma_f32_16x16x32_bf16 v[112:115], v[36:39], a[152:155], v[112:115]
    v_rcp_f32 v152, v152
    v_mfma_f32_16x16x32_bf16 v[116:119], v[28:31], a[216:219], 0
    buffer_load_dwordx4 v[24:27], v185, s[48:51], s23 offen offset:1024 sc1
    v_mfma_f32_16x16x32_bf16 v[116:119], v[32:35], a[220:223], v[116:119]
    v_rcp_f32 v153, v153
    v_mfma_f32_16x16x32_bf16 v[116:119], v[36:39], a[224:227], v[116:119]
    v_rcp_f32 v154, v154
    s_waitcnt vmcnt(12)
    v_mfma_f32_16x16x32_bf16 v[88:91], v[40:43], a[12:15], v[88:91]
    v_rcp_f32 v155, v155
    v_mfma_f32_16x16x32_bf16 v[88:91], v[44:47], a[16:19], v[88:91]
    buffer_load_dwordx4 v[28:31], v185, s[48:51], s23 offen offset:2048 sc1
    v_mfma_f32_16x16x32_bf16 v[88:91], v[48:51], a[20:23], v[88:91]
    v_mul_f32 v156, v156, v152
    v_mul_f32 v157, v157, v153
    v_mfma_f32_16x16x32_bf16 v[92:95], v[40:43], a[84:87], v[92:95]
    v_mul_f32 v158, v158, v154
    v_mul_f32 v159, v159, v155
    v_mfma_f32_16x16x32_bf16 v[92:95], v[44:47], a[88:91], v[92:95]
    v_cvt_pk_bf16_f32 v160, v156, v157
    v_cvt_pk_bf16_f32 v161, v158, v159
    v_mfma_f32_16x16x32_bf16 v[92:95], v[48:51], a[92:95], v[92:95]
    buffer_load_dwordx4 v[32:35], v185, s[48:51], s23 offen offset:3072 sc1
    v_mfma_f32_16x16x32_bf16 v[96:99], v[40:43], a[156:159], v[96:99]
    ds_write_b64 v12, v[160:161] offset:0
    v_mfma_f32_16x16x32_bf16 v[96:99], v[44:47], a[160:163], v[96:99]
    v_mul_f32 v162, v124, v124
    v_mul_f32 v163, v125, v125
    v_mfma_f32_16x16x32_bf16 v[96:99], v[48:51], a[164:167], v[96:99]
    v_mul_f32 v164, v126, v126
    v_mul_f32 v165, v127, v127
    v_mfma_f32_16x16x32_bf16 v[100:103], v[40:43], a[228:231], v[100:103]
    buffer_load_dwordx4 v[36:39], v186, s[48:51], s23 offen offset:0 sc1
    v_mfma_f32_16x16x32_bf16 v[100:103], v[44:47], a[232:235], v[100:103]
    v_fma_f32 v162, v162, v9, v5
    v_fma_f32 v163, v163, v9, v5
    v_mfma_f32_16x16x32_bf16 v[100:103], v[48:51], a[236:239], v[100:103]
    v_fma_f32 v164, v164, v9, v5
    v_fma_f32 v165, v165, v9, v5
    s_waitcnt vmcnt(12)
    v_mfma_f32_16x16x32_bf16 v[104:107], v[52:55], a[12:15], v[104:107]
    v_mul_f32 v162, v124, v162
    v_mul_f32 v163, v125, v163
    v_mfma_f32_16x16x32_bf16 v[104:107], v[56:59], a[16:19], v[104:107]
    buffer_load_dwordx4 v[40:43], v186, s[48:51], s23 offen offset:1024 sc1
    v_mfma_f32_16x16x32_bf16 v[104:107], v[60:63], a[20:23], v[104:107]
    v_mul_f32 v164, v126, v164
    v_mul_f32 v165, v127, v165
    v_mfma_f32_16x16x32_bf16 v[108:111], v[52:55], a[84:87], v[108:111]
    v_exp_f32 v162, v162
    v_mfma_f32_16x16x32_bf16 v[108:111], v[56:59], a[88:91], v[108:111]
    v_exp_f32 v163, v163
    v_mfma_f32_16x16x32_bf16 v[108:111], v[60:63], a[92:95], v[108:111]
    buffer_load_dwordx4 v[44:47], v186, s[48:51], s23 offen offset:2048 sc1
    v_mfma_f32_16x16x32_bf16 v[112:115], v[52:55], a[156:159], v[112:115]
    v_exp_f32 v164, v164
    v_mfma_f32_16x16x32_bf16 v[112:115], v[56:59], a[160:163], v[112:115]
    v_exp_f32 v165, v165
    v_mfma_f32_16x16x32_bf16 v[112:115], v[60:63], a[164:167], v[112:115]
    v_mul_f32 v166, v124, v140
    v_mul_f32 v167, v125, v141
    v_mfma_f32_16x16x32_bf16 v[116:119], v[52:55], a[228:231], v[116:119]
    buffer_load_dwordx4 v[48:51], v186, s[48:51], s23 offen offset:3072 sc1
    v_mfma_f32_16x16x32_bf16 v[116:119], v[56:59], a[232:235], v[116:119]
    v_mul_f32 v168, v126, v142
    v_mul_f32 v169, v127, v143
    v_mfma_f32_16x16x32_bf16 v[116:119], v[60:63], a[236:239], v[116:119]
    v_fma_f32 v162, v162, v194, v194
    v_fma_f32 v163, v163, v194, v194
    s_waitcnt vmcnt(12)
    v_mfma_f32_16x16x32_bf16 v[88:91], v[64:67], a[24:27], v[88:91]
    v_fma_f32 v164, v164, v194, v194
    v_fma_f32 v165, v165, v194, v194
    v_mfma_f32_16x16x32_bf16 v[88:91], v[68:71], a[28:31], v[88:91]
    buffer_load_dwordx4 v[52:55], v187, s[48:51], s23 offen offset:0 sc1
    v_mfma_f32_16x16x32_bf16 v[88:91], v[72:75], a[32:35], v[88:91]
    v_rcp_f32 v162, v162
    v_mfma_f32_16x16x32_bf16 v[92:95], v[64:67], a[96:99], v[92:95]
    v_rcp_f32 v163, v163
    v_mfma_f32_16x16x32_bf16 v[92:95], v[68:71], a[100:103], v[92:95]
    v_rcp_f32 v164, v164
    v_mfma_f32_16x16x32_bf16 v[92:95], v[72:75], a[104:107], v[92:95]
    buffer_load_dwordx4 v[56:59], v187, s[48:51], s23 offen offset:1024 sc1
    v_mfma_f32_16x16x32_bf16 v[96:99], v[64:67], a[168:171], v[96:99]
    v_rcp_f32 v165, v165
    v_mfma_f32_16x16x32_bf16 v[96:99], v[68:71], a[172:175], v[96:99]
    v_mul_f32 v166, v166, v162
    v_mul_f32 v167, v167, v163
    v_mfma_f32_16x16x32_bf16 v[96:99], v[72:75], a[176:179], v[96:99]
    v_mul_f32 v168, v168, v164
    v_mul_f32 v169, v169, v165
    v_mfma_f32_16x16x32_bf16 v[100:103], v[64:67], a[240:243], v[100:103]
    buffer_load_dwordx4 v[60:63], v187, s[48:51], s23 offen offset:2048 sc1
    v_mfma_f32_16x16x32_bf16 v[100:103], v[68:71], a[244:247], v[100:103]
    v_cvt_pk_bf16_f32 v170, v166, v167
    v_cvt_pk_bf16_f32 v171, v168, v169
    v_mfma_f32_16x16x32_bf16 v[100:103], v[72:75], a[248:251], v[100:103]
    ds_write_b64 v12, v[170:171] offset:18432
    s_waitcnt vmcnt(12)
    v_mfma_f32_16x16x32_bf16 v[104:107], v[76:79], a[24:27], v[104:107]
    v_mul_f32 v152, v128, v128
    v_mul_f32 v153, v129, v129
    v_mfma_f32_16x16x32_bf16 v[104:107], v[80:83], a[28:31], v[104:107]
    buffer_load_dwordx4 v[64:67], v187, s[48:51], s23 offen offset:3072 sc1
    v_mfma_f32_16x16x32_bf16 v[104:107], v[84:87], a[32:35], v[104:107]
    v_mul_f32 v154, v130, v130
    v_mul_f32 v155, v131, v131
    v_mfma_f32_16x16x32_bf16 v[108:111], v[76:79], a[96:99], v[108:111]
    v_fma_f32 v152, v152, v13, v6
    v_fma_f32 v153, v153, v13, v6
    v_mfma_f32_16x16x32_bf16 v[108:111], v[80:83], a[100:103], v[108:111]
    v_fma_f32 v154, v154, v13, v6
    v_fma_f32 v155, v155, v13, v6
    v_mfma_f32_16x16x32_bf16 v[108:111], v[84:87], a[104:107], v[108:111]
    buffer_load_dwordx4 v[68:71], v188, s[48:51], s23 offen offset:0 sc1
    v_mfma_f32_16x16x32_bf16 v[112:115], v[76:79], a[168:171], v[112:115]
    v_mul_f32 v152, v128, v152
    v_mul_f32 v153, v129, v153
    v_mfma_f32_16x16x32_bf16 v[112:115], v[80:83], a[172:175], v[112:115]
    v_mul_f32 v154, v130, v154
    v_mul_f32 v155, v131, v155
    v_mfma_f32_16x16x32_bf16 v[112:115], v[84:87], a[176:179], v[112:115]
    v_exp_f32 v152, v152
    v_mfma_f32_16x16x32_bf16 v[116:119], v[76:79], a[240:243], v[116:119]
    buffer_load_dwordx4 v[72:75], v188, s[48:51], s23 offen offset:1024 sc1
    v_mfma_f32_16x16x32_bf16 v[116:119], v[80:83], a[244:247], v[116:119]
    v_exp_f32 v153, v153
    v_mfma_f32_16x16x32_bf16 v[116:119], v[84:87], a[248:251], v[116:119]
    v_exp_f32 v154, v154
    s_waitcnt vmcnt(12)
    v_mfma_f32_16x16x32_bf16 v[88:91], v[16:19], a[36:39], v[88:91]
    v_exp_f32 v155, v155
    v_mfma_f32_16x16x32_bf16 v[88:91], v[20:23], a[40:43], v[88:91]
    buffer_load_dwordx4 v[76:79], v188, s[48:51], s23 offen offset:2048 sc1
    v_mfma_f32_16x16x32_bf16 v[88:91], v[24:27], a[44:47], v[88:91]
    v_mul_f32 v156, v128, v144
    v_mul_f32 v157, v129, v145
    v_mfma_f32_16x16x32_bf16 v[92:95], v[16:19], a[108:111], v[92:95]
    v_mul_f32 v158, v130, v146
    v_mul_f32 v159, v131, v147
    v_mfma_f32_16x16x32_bf16 v[92:95], v[20:23], a[112:115], v[92:95]
    v_fma_f32 v152, v152, v195, v195
    v_fma_f32 v153, v153, v195, v195
    v_mfma_f32_16x16x32_bf16 v[92:95], v[24:27], a[116:119], v[92:95]
    buffer_load_dwordx4 v[80:83], v188, s[48:51], s23 offen offset:3072 sc1
    v_mfma_f32_16x16x32_bf16 v[96:99], v[16:19], a[180:183], v[96:99]
    v_fma_f32 v154, v154, v195, v195
    v_fma_f32 v155, v155, v195, v195
    v_mfma_f32_16x16x32_bf16 v[96:99], v[20:23], a[184:187], v[96:99]
    v_rcp_f32 v152, v152
    v_mfma_f32_16x16x32_bf16 v[96:99], v[24:27], a[188:191], v[96:99]
    v_rcp_f32 v153, v153
    v_mfma_f32_16x16x32_bf16 v[100:103], v[16:19], a[252:255], v[100:103]
    buffer_load_dwordx4 v[84:87], v189, s[48:51], s23 offen offset:0 sc1
    v_mfma_f32_16x16x32_bf16 v[100:103], v[20:23], v[220:223], v[100:103]
    v_rcp_f32 v154, v154
    v_mfma_f32_16x16x32_bf16 v[100:103], v[24:27], v[224:227], v[100:103]
    v_rcp_f32 v155, v155
    s_waitcnt vmcnt(12)
    v_mfma_f32_16x16x32_bf16 v[104:107], v[28:31], a[36:39], v[104:107]
    v_mul_f32 v156, v156, v152
    v_mul_f32 v157, v157, v153
    v_mfma_f32_16x16x32_bf16 v[104:107], v[32:35], a[40:43], v[104:107]
    buffer_load_dwordx4 v[16:19], v189, s[48:51], s23 offen offset:1024 sc1
    v_mfma_f32_16x16x32_bf16 v[104:107], v[36:39], a[44:47], v[104:107]
    v_mul_f32 v158, v158, v154
    v_mul_f32 v159, v159, v155
    v_mfma_f32_16x16x32_bf16 v[108:111], v[28:31], a[108:111], v[108:111]
    v_cvt_pk_bf16_f32 v160, v156, v157
    v_cvt_pk_bf16_f32 v161, v158, v159
    v_mfma_f32_16x16x32_bf16 v[108:111], v[32:35], a[112:115], v[108:111]
    ds_write_b64 v12, v[160:161] offset:36864
    v_mfma_f32_16x16x32_bf16 v[108:111], v[36:39], a[116:119], v[108:111]
    buffer_load_dwordx4 v[20:23], v189, s[48:51], s23 offen offset:2048 sc1
    v_mfma_f32_16x16x32_bf16 v[112:115], v[28:31], a[180:183], v[112:115]
    v_mul_f32 v162, v132, v132
    v_mul_f32 v163, v133, v133
    v_mfma_f32_16x16x32_bf16 v[112:115], v[32:35], a[184:187], v[112:115]
    v_mul_f32 v164, v134, v134
    v_mul_f32 v165, v135, v135
    v_mfma_f32_16x16x32_bf16 v[112:115], v[36:39], a[188:191], v[112:115]
    v_fma_f32 v162, v162, v14, v7
    v_fma_f32 v163, v163, v14, v7
    v_mfma_f32_16x16x32_bf16 v[116:119], v[28:31], a[252:255], v[116:119]
    buffer_load_dwordx4 v[24:27], v189, s[48:51], s23 offen offset:3072 sc1
    v_mfma_f32_16x16x32_bf16 v[116:119], v[32:35], v[220:223], v[116:119]
    v_fma_f32 v164, v164, v14, v7
    v_fma_f32 v165, v165, v14, v7
    v_mfma_f32_16x16x32_bf16 v[116:119], v[36:39], v[224:227], v[116:119]
    v_mul_f32 v162, v132, v162
    v_mul_f32 v163, v133, v163
    s_waitcnt vmcnt(12)
    v_mfma_f32_16x16x32_bf16 v[88:91], v[40:43], a[48:51], v[88:91]
    v_mul_f32 v164, v134, v164
    v_mul_f32 v165, v135, v165
    v_mfma_f32_16x16x32_bf16 v[88:91], v[44:47], a[52:55], v[88:91]
    buffer_load_dwordx4 v[28:31], v190, s[48:51], s23 offen offset:0 sc1
    v_mfma_f32_16x16x32_bf16 v[88:91], v[48:51], a[56:59], v[88:91]
    v_exp_f32 v162, v162
    v_mfma_f32_16x16x32_bf16 v[92:95], v[40:43], a[120:123], v[92:95]
    v_exp_f32 v163, v163
    v_mfma_f32_16x16x32_bf16 v[92:95], v[44:47], a[124:127], v[92:95]
    v_exp_f32 v164, v164
    v_mfma_f32_16x16x32_bf16 v[92:95], v[48:51], a[128:131], v[92:95]
    buffer_load_dwordx4 v[32:35], v190, s[48:51], s23 offen offset:1024 sc1
    v_mfma_f32_16x16x32_bf16 v[96:99], v[40:43], a[192:195], v[96:99]
    v_exp_f32 v165, v165
    v_mfma_f32_16x16x32_bf16 v[96:99], v[44:47], a[196:199], v[96:99]
    v_mul_f32 v166, v132, v148
    v_mul_f32 v167, v133, v149
    v_mfma_f32_16x16x32_bf16 v[96:99], v[48:51], a[200:203], v[96:99]
    v_mul_f32 v168, v134, v150
    v_mul_f32 v169, v135, v151
    v_mfma_f32_16x16x32_bf16 v[100:103], v[40:43], v[228:231], v[100:103]
    buffer_load_dwordx4 v[36:39], v190, s[48:51], s23 offen offset:2048 sc1
    v_mfma_f32_16x16x32_bf16 v[100:103], v[44:47], v[232:235], v[100:103]
    v_fma_f32 v162, v162, v252, v252
    v_fma_f32 v163, v163, v252, v252
    v_mfma_f32_16x16x32_bf16 v[100:103], v[48:51], v[236:239], v[100:103]
    v_fma_f32 v164, v164, v252, v252
    v_fma_f32 v165, v165, v252, v252
    s_waitcnt vmcnt(12)
    v_mfma_f32_16x16x32_bf16 v[104:107], v[52:55], a[48:51], v[104:107]
    v_rcp_f32 v162, v162
    v_mfma_f32_16x16x32_bf16 v[104:107], v[56:59], a[52:55], v[104:107]
    buffer_load_dwordx4 v[40:43], v190, s[48:51], s23 offen offset:3072 sc1
    v_mfma_f32_16x16x32_bf16 v[104:107], v[60:63], a[56:59], v[104:107]
    v_rcp_f32 v163, v163
    v_mfma_f32_16x16x32_bf16 v[108:111], v[52:55], a[120:123], v[108:111]
    v_rcp_f32 v164, v164
    v_mfma_f32_16x16x32_bf16 v[108:111], v[56:59], a[124:127], v[108:111]
    v_rcp_f32 v165, v165
    v_mfma_f32_16x16x32_bf16 v[108:111], v[60:63], a[128:131], v[108:111]
    buffer_load_dwordx4 v[44:47], v191, s[48:51], s23 offen offset:0 sc1
    v_mfma_f32_16x16x32_bf16 v[112:115], v[52:55], a[192:195], v[112:115]
    v_mul_f32 v166, v166, v162
    v_mul_f32 v167, v167, v163
    v_mfma_f32_16x16x32_bf16 v[112:115], v[56:59], a[196:199], v[112:115]
    v_mul_f32 v168, v168, v164
    v_mul_f32 v169, v169, v165
    v_mfma_f32_16x16x32_bf16 v[112:115], v[60:63], a[200:203], v[112:115]
    v_cvt_pk_bf16_f32 v170, v166, v167
    v_cvt_pk_bf16_f32 v171, v168, v169
    v_mfma_f32_16x16x32_bf16 v[116:119], v[52:55], v[228:231], v[116:119]
    buffer_load_dwordx4 v[48:51], v191, s[48:51], s23 offen offset:1024 sc1
    v_mfma_f32_16x16x32_bf16 v[116:119], v[56:59], v[232:235], v[116:119]
    ds_write_b64 v12, v[170:171] offset:55296
    v_mfma_f32_16x16x32_bf16 v[116:119], v[60:63], v[236:239], v[116:119]
    s_waitcnt vmcnt(12)
    v_mfma_f32_16x16x32_bf16 v[88:91], v[64:67], a[60:63], v[88:91]
    v_mfma_f32_16x16x32_bf16 v[88:91], v[68:71], a[64:67], v[88:91]
    buffer_load_dwordx4 v[52:55], v191, s[48:51], s23 offen offset:2048 sc1
    v_mfma_f32_16x16x32_bf16 v[120:123], v[72:75], a[68:71], v[88:91]
    v_mfma_f32_16x16x32_bf16 v[92:95], v[64:67], a[132:135], v[92:95]
    v_mfma_f32_16x16x32_bf16 v[92:95], v[68:71], a[136:139], v[92:95]
    v_mfma_f32_16x16x32_bf16 v[124:127], v[72:75], a[140:143], v[92:95]
    buffer_load_dwordx4 v[56:59], v191, s[48:51], s23 offen offset:3072 sc1
    v_mfma_f32_16x16x32_bf16 v[96:99], v[64:67], a[204:207], v[96:99]
    v_mfma_f32_16x16x32_bf16 v[96:99], v[68:71], a[208:211], v[96:99]
    v_mfma_f32_16x16x32_bf16 v[128:131], v[72:75], a[212:215], v[96:99]
    v_mfma_f32_16x16x32_bf16 v[100:103], v[64:67], v[240:243], v[100:103]
    buffer_load_dwordx4 v[60:63], v192, s[48:51], s23 offen offset:0 sc1
    v_mfma_f32_16x16x32_bf16 v[100:103], v[68:71], v[244:247], v[100:103]
    v_mfma_f32_16x16x32_bf16 v[132:135], v[72:75], v[248:251], v[100:103]
    s_waitcnt vmcnt(12)
    v_mfma_f32_16x16x32_bf16 v[104:107], v[76:79], a[60:63], v[104:107]
    v_mfma_f32_16x16x32_bf16 v[104:107], v[80:83], a[64:67], v[104:107]
    buffer_load_dwordx4 v[64:67], v192, s[48:51], s23 offen offset:1024 sc1
    v_mfma_f32_16x16x32_bf16 v[136:139], v[84:87], a[68:71], v[104:107]
    v_mfma_f32_16x16x32_bf16 v[108:111], v[76:79], a[132:135], v[108:111]
    v_mfma_f32_16x16x32_bf16 v[108:111], v[80:83], a[136:139], v[108:111]
    v_mfma_f32_16x16x32_bf16 v[140:143], v[84:87], a[140:143], v[108:111]
    buffer_load_dwordx4 v[68:71], v192, s[48:51], s23 offen offset:2048 sc1
    v_mfma_f32_16x16x32_bf16 v[112:115], v[76:79], a[204:207], v[112:115]
    v_mfma_f32_16x16x32_bf16 v[112:115], v[80:83], a[208:211], v[112:115]
    s_lshl_b32 s7, s25, 11
    v_mfma_f32_16x16x32_bf16 v[144:147], v[84:87], a[212:215], v[112:115]
    s_add_u32 s7, s7, s28
    v_mfma_f32_16x16x32_bf16 v[116:119], v[76:79], v[240:243], v[116:119]
    buffer_load_dwordx4 v[72:75], v192, s[48:51], s23 offen offset:3072 sc1
    v_mfma_f32_16x16x32_bf16 v[116:119], v[80:83], v[244:247], v[116:119]
    s_add_u32 s23, s23, 36864
    v_mfma_f32_16x16x32_bf16 v[148:151], v[84:87], v[248:251], v[116:119]
    v_add_u32 v12, s7, v184
    s_add_u32 s25, s25, 1
    s_cmp_lt_u32 s25, 8
    s_cbranch_scc1 L_ffn_gu_38
    v_add_u32 v10, 73728, v184
    v_add_u32 v11, 110592, v184
    s_lshr_b32 s7, s2, 3
    s_lshl_b32 s7, s7, 2
    s_add_u32 s7, s7, s3
    s_lshl_b32 s7, s7, 9
    v_lshrrev_b32 v1, 1, v253
    v_add_u32 v1, s7, v1
    buffer_load_dwordx2 v[2:3], v1, s[96:99], 0 offen
    s_waitcnt lgkmcnt(0)
    s_barrier
    s_waitcnt vmcnt(12)
    v_mfma_f32_16x16x32_bf16 v[88:91], v[16:19], a[0:3], 0
    v_mfma_f32_16x16x32_bf16 v[88:91], v[20:23], a[4:7], v[88:91]
    buffer_load_dwordx4 v[76:79], v184, s[48:51], s23 offen offset:0 sc1
    v_mfma_f32_16x16x32_bf16 v[88:91], v[24:27], a[8:11], v[88:91]
    v_mul_f32 v152, v120, v120
    v_mul_f32 v153, v121, v121
    v_mfma_f32_16x16x32_bf16 v[92:95], v[16:19], a[72:75], 0
    v_mul_f32 v154, v122, v122
    v_mul_f32 v155, v123, v123
    v_mfma_f32_16x16x32_bf16 v[92:95], v[20:23], a[76:79], v[92:95]
    v_fma_f32 v152, v152, v8, v4
    v_fma_f32 v153, v153, v8, v4
    v_mfma_f32_16x16x32_bf16 v[92:95], v[24:27], a[80:83], v[92:95]
    buffer_load_dwordx4 v[80:83], v184, s[48:51], s23 offen offset:1024 sc1
    v_mfma_f32_16x16x32_bf16 v[96:99], v[16:19], a[144:147], 0
    v_fma_f32 v154, v154, v8, v4
    v_fma_f32 v155, v155, v8, v4
    v_mfma_f32_16x16x32_bf16 v[96:99], v[20:23], a[148:151], v[96:99]
    v_mul_f32 v152, v120, v152
    v_mul_f32 v153, v121, v153
    v_mfma_f32_16x16x32_bf16 v[96:99], v[24:27], a[152:155], v[96:99]
    v_mul_f32 v154, v122, v154
    v_mul_f32 v155, v123, v155
    v_mfma_f32_16x16x32_bf16 v[100:103], v[16:19], a[216:219], 0
    buffer_load_dwordx4 v[84:87], v184, s[48:51], s23 offen offset:2048 sc1
    v_mfma_f32_16x16x32_bf16 v[100:103], v[20:23], a[220:223], v[100:103]
    v_exp_f32 v152, v152
    v_mfma_f32_16x16x32_bf16 v[100:103], v[24:27], a[224:227], v[100:103]
    v_exp_f32 v153, v153
    s_waitcnt vmcnt(12)
    v_mfma_f32_16x16x32_bf16 v[104:107], v[28:31], a[0:3], 0
    v_exp_f32 v154, v154
    ds_read_b128 a[0:3], v10 offset:0
    v_mfma_f32_16x16x32_bf16 v[104:107], v[32:35], a[4:7], v[104:107]
    buffer_load_dwordx4 v[16:19], v184, s[48:51], s23 offen offset:3072 sc1
    v_mfma_f32_16x16x32_bf16 v[104:107], v[36:39], a[8:11], v[104:107]
    v_exp_f32 v155, v155
    v_mfma_f32_16x16x32_bf16 v[108:111], v[28:31], a[72:75], 0
    v_mul_f32 v156, v120, v136
    v_mul_f32 v157, v121, v137
    ds_read_b128 a[72:75], v10 offset:18432
    v_mfma_f32_16x16x32_bf16 v[108:111], v[32:35], a[76:79], v[108:111]
    v_mul_f32 v158, v122, v138
    v_mul_f32 v159, v123, v139
    v_mfma_f32_16x16x32_bf16 v[108:111], v[36:39], a[80:83], v[108:111]
    buffer_load_dwordx4 v[20:23], v185, s[48:51], s23 offen offset:0 sc1
    v_mfma_f32_16x16x32_bf16 v[112:115], v[28:31], a[144:147], 0
    v_fma_f32 v152, v152, v193, v193
    v_fma_f32 v153, v153, v193, v193
    ds_read_b128 a[144:147], v11 offset:0
    v_mfma_f32_16x16x32_bf16 v[112:115], v[32:35], a[148:151], v[112:115]
    v_fma_f32 v154, v154, v193, v193
    v_fma_f32 v155, v155, v193, v193
    v_mfma_f32_16x16x32_bf16 v[112:115], v[36:39], a[152:155], v[112:115]
    v_rcp_f32 v152, v152
    v_mfma_f32_16x16x32_bf16 v[116:119], v[28:31], a[216:219], 0
    buffer_load_dwordx4 v[24:27], v185, s[48:51], s23 offen offset:1024 sc1
    v_mfma_f32_16x16x32_bf16 v[116:119], v[32:35], a[220:223], v[116:119]
    v_rcp_f32 v153, v153
    ds_read_b128 a[216:219], v11 offset:18432
    v_mfma_f32_16x16x32_bf16 v[116:119], v[36:39], a[224:227], v[116:119]
    v_rcp_f32 v154, v154
    ds_read_b128 a[4:7], v10 offset:1024
    s_waitcnt vmcnt(12)
    v_mfma_f32_16x16x32_bf16 v[88:91], v[40:43], a[12:15], v[88:91]
    v_rcp_f32 v155, v155
    ds_read_b128 a[76:79], v10 offset:19456
    v_mfma_f32_16x16x32_bf16 v[88:91], v[44:47], a[16:19], v[88:91]
    buffer_load_dwordx4 v[28:31], v185, s[48:51], s23 offen offset:2048 sc1
    v_mfma_f32_16x16x32_bf16 v[88:91], v[48:51], a[20:23], v[88:91]
    v_mul_f32 v156, v156, v152
    v_mul_f32 v157, v157, v153
    ds_read_b128 a[148:151], v11 offset:1024
    v_mfma_f32_16x16x32_bf16 v[92:95], v[40:43], a[84:87], v[92:95]
    v_mul_f32 v158, v158, v154
    v_mul_f32 v159, v159, v155
    ds_read_b128 a[220:223], v11 offset:19456
    v_mfma_f32_16x16x32_bf16 v[92:95], v[44:47], a[88:91], v[92:95]
    v_cvt_pk_bf16_f32 v160, v156, v157
    v_cvt_pk_bf16_f32 v161, v158, v159
    ds_read_b128 a[8:11], v10 offset:2048
    v_mfma_f32_16x16x32_bf16 v[92:95], v[48:51], a[92:95], v[92:95]
    buffer_load_dwordx4 v[32:35], v185, s[48:51], s23 offen offset:3072 sc1
    v_mfma_f32_16x16x32_bf16 v[96:99], v[40:43], a[156:159], v[96:99]
    ds_write_b64 v12, v[160:161] offset:0
    v_mfma_f32_16x16x32_bf16 v[96:99], v[44:47], a[160:163], v[96:99]
    v_mul_f32 v162, v124, v124
    v_mul_f32 v163, v125, v125
    ds_read_b128 a[80:83], v10 offset:20480
    v_mfma_f32_16x16x32_bf16 v[96:99], v[48:51], a[164:167], v[96:99]
    v_mul_f32 v164, v126, v126
    v_mul_f32 v165, v127, v127
    ds_read_b128 a[152:155], v11 offset:2048
    v_mfma_f32_16x16x32_bf16 v[100:103], v[40:43], a[228:231], v[100:103]
    buffer_load_dwordx4 v[36:39], v186, s[48:51], s23 offen offset:0 sc1
    v_mfma_f32_16x16x32_bf16 v[100:103], v[44:47], a[232:235], v[100:103]
    v_fma_f32 v162, v162, v9, v5
    v_fma_f32 v163, v163, v9, v5
    ds_read_b128 a[224:227], v11 offset:20480
    v_mfma_f32_16x16x32_bf16 v[100:103], v[48:51], a[236:239], v[100:103]
    v_fma_f32 v164, v164, v9, v5
    v_fma_f32 v165, v165, v9, v5
    s_waitcnt vmcnt(12)
    v_mfma_f32_16x16x32_bf16 v[104:107], v[52:55], a[12:15], v[104:107]
    v_mul_f32 v162, v124, v162
    v_mul_f32 v163, v125, v163
    ds_read_b128 a[12:15], v10 offset:3072
    v_mfma_f32_16x16x32_bf16 v[104:107], v[56:59], a[16:19], v[104:107]
    buffer_load_dwordx4 v[40:43], v186, s[48:51], s23 offen offset:1024 sc1
    v_mfma_f32_16x16x32_bf16 v[104:107], v[60:63], a[20:23], v[104:107]
    v_mul_f32 v164, v126, v164
    v_mul_f32 v165, v127, v165
    v_mfma_f32_16x16x32_bf16 v[108:111], v[52:55], a[84:87], v[108:111]
    v_exp_f32 v162, v162
    ds_read_b128 a[84:87], v10 offset:21504
    v_mfma_f32_16x16x32_bf16 v[108:111], v[56:59], a[88:91], v[108:111]
    v_exp_f32 v163, v163
    v_mfma_f32_16x16x32_bf16 v[108:111], v[60:63], a[92:95], v[108:111]
    buffer_load_dwordx4 v[44:47], v186, s[48:51], s23 offen offset:2048 sc1
    v_mfma_f32_16x16x32_bf16 v[112:115], v[52:55], a[156:159], v[112:115]
    v_exp_f32 v164, v164
    ds_read_b128 a[156:159], v11 offset:3072
    v_mfma_f32_16x16x32_bf16 v[112:115], v[56:59], a[160:163], v[112:115]
    v_exp_f32 v165, v165
    v_mfma_f32_16x16x32_bf16 v[112:115], v[60:63], a[164:167], v[112:115]
    v_mul_f32 v166, v124, v140
    v_mul_f32 v167, v125, v141
    v_mfma_f32_16x16x32_bf16 v[116:119], v[52:55], a[228:231], v[116:119]
    buffer_load_dwordx4 v[48:51], v186, s[48:51], s23 offen offset:3072 sc1
    v_mfma_f32_16x16x32_bf16 v[116:119], v[56:59], a[232:235], v[116:119]
    v_mul_f32 v168, v126, v142
    v_mul_f32 v169, v127, v143
    ds_read_b128 a[228:231], v11 offset:21504
    v_mfma_f32_16x16x32_bf16 v[116:119], v[60:63], a[236:239], v[116:119]
    v_fma_f32 v162, v162, v194, v194
    v_fma_f32 v163, v163, v194, v194
    ds_read_b128 a[16:19], v10 offset:4096
    s_waitcnt vmcnt(12)
    v_mfma_f32_16x16x32_bf16 v[88:91], v[64:67], a[24:27], v[88:91]
    v_fma_f32 v164, v164, v194, v194
    v_fma_f32 v165, v165, v194, v194
    ds_read_b128 a[88:91], v10 offset:22528
    v_mfma_f32_16x16x32_bf16 v[88:91], v[68:71], a[28:31], v[88:91]
    buffer_load_dwordx4 v[52:55], v187, s[48:51], s23 offen offset:0 sc1
    v_mfma_f32_16x16x32_bf16 v[88:91], v[72:75], a[32:35], v[88:91]
    v_rcp_f32 v162, v162
    ds_read_b128 a[160:163], v11 offset:4096
    v_mfma_f32_16x16x32_bf16 v[92:95], v[64:67], a[96:99], v[92:95]
    v_rcp_f32 v163, v163
    ds_read_b128 a[232:235], v11 offset:22528
    v_mfma_f32_16x16x32_bf16 v[92:95], v[68:71], a[100:103], v[92:95]
    v_rcp_f32 v164, v164
    ds_read_b128 a[20:23], v10 offset:5120
    v_mfma_f32_16x16x32_bf16 v[92:95], v[72:75], a[104:107], v[92:95]
    buffer_load_dwordx4 v[56:59], v187, s[48:51], s23 offen offset:1024 sc1
    v_mfma_f32_16x16x32_bf16 v[96:99], v[64:67], a[168:171], v[96:99]
    v_rcp_f32 v165, v165
    ds_read_b128 a[92:95], v10 offset:23552
    v_mfma_f32_16x16x32_bf16 v[96:99], v[68:71], a[172:175], v[96:99]
    v_mul_f32 v166, v166, v162
    v_mul_f32 v167, v167, v163
    ds_read_b128 a[164:167], v11 offset:5120
    v_mfma_f32_16x16x32_bf16 v[96:99], v[72:75], a[176:179], v[96:99]
    v_mul_f32 v168, v168, v164
    v_mul_f32 v169, v169, v165
    ds_read_b128 a[236:239], v11 offset:23552
    v_mfma_f32_16x16x32_bf16 v[100:103], v[64:67], a[240:243], v[100:103]
    buffer_load_dwordx4 v[60:63], v187, s[48:51], s23 offen offset:2048 sc1
    v_mfma_f32_16x16x32_bf16 v[100:103], v[68:71], a[244:247], v[100:103]
    v_cvt_pk_bf16_f32 v170, v166, v167
    v_cvt_pk_bf16_f32 v171, v168, v169
    v_mfma_f32_16x16x32_bf16 v[100:103], v[72:75], a[248:251], v[100:103]
    ds_write_b64 v12, v[170:171] offset:18432
    s_waitcnt vmcnt(12)
    v_mfma_f32_16x16x32_bf16 v[104:107], v[76:79], a[24:27], v[104:107]
    v_mul_f32 v152, v128, v128
    v_mul_f32 v153, v129, v129
    ds_read_b128 a[24:27], v10 offset:6144
    v_mfma_f32_16x16x32_bf16 v[104:107], v[80:83], a[28:31], v[104:107]
    buffer_load_dwordx4 v[64:67], v187, s[48:51], s23 offen offset:3072 sc1
    v_mfma_f32_16x16x32_bf16 v[104:107], v[84:87], a[32:35], v[104:107]
    v_mul_f32 v154, v130, v130
    v_mul_f32 v155, v131, v131
    v_mfma_f32_16x16x32_bf16 v[108:111], v[76:79], a[96:99], v[108:111]
    v_fma_f32 v152, v152, v13, v6
    v_fma_f32 v153, v153, v13, v6
    ds_read_b128 a[96:99], v10 offset:24576
    v_mfma_f32_16x16x32_bf16 v[108:111], v[80:83], a[100:103], v[108:111]
    v_fma_f32 v154, v154, v13, v6
    v_fma_f32 v155, v155, v13, v6
    v_mfma_f32_16x16x32_bf16 v[108:111], v[84:87], a[104:107], v[108:111]
    buffer_load_dwordx4 v[68:71], v188, s[48:51], s23 offen offset:0 sc1
    v_mfma_f32_16x16x32_bf16 v[112:115], v[76:79], a[168:171], v[112:115]
    v_mul_f32 v152, v128, v152
    v_mul_f32 v153, v129, v153
    ds_read_b128 a[168:171], v11 offset:6144
    v_mfma_f32_16x16x32_bf16 v[112:115], v[80:83], a[172:175], v[112:115]
    v_mul_f32 v154, v130, v154
    v_mul_f32 v155, v131, v155
    v_mfma_f32_16x16x32_bf16 v[112:115], v[84:87], a[176:179], v[112:115]
    v_exp_f32 v152, v152
    v_mfma_f32_16x16x32_bf16 v[116:119], v[76:79], a[240:243], v[116:119]
    buffer_load_dwordx4 v[72:75], v188, s[48:51], s23 offen offset:1024 sc1
    v_mfma_f32_16x16x32_bf16 v[116:119], v[80:83], a[244:247], v[116:119]
    v_exp_f32 v153, v153
    ds_read_b128 a[240:243], v11 offset:24576
    v_mfma_f32_16x16x32_bf16 v[116:119], v[84:87], a[248:251], v[116:119]
    v_exp_f32 v154, v154
    ds_read_b128 a[28:31], v10 offset:7168
    s_waitcnt vmcnt(12)
    v_mfma_f32_16x16x32_bf16 v[88:91], v[16:19], a[36:39], v[88:91]
    v_exp_f32 v155, v155
    ds_read_b128 a[100:103], v10 offset:25600
    v_mfma_f32_16x16x32_bf16 v[88:91], v[20:23], a[40:43], v[88:91]
    buffer_load_dwordx4 v[76:79], v188, s[48:51], s23 offen offset:2048 sc1
    v_mfma_f32_16x16x32_bf16 v[88:91], v[24:27], a[44:47], v[88:91]
    v_mul_f32 v156, v128, v144
    v_mul_f32 v157, v129, v145
    ds_read_b128 a[172:175], v11 offset:7168
    v_mfma_f32_16x16x32_bf16 v[92:95], v[16:19], a[108:111], v[92:95]
    v_mul_f32 v158, v130, v146
    v_mul_f32 v159, v131, v147
    ds_read_b128 a[244:247], v11 offset:25600
    v_mfma_f32_16x16x32_bf16 v[92:95], v[20:23], a[112:115], v[92:95]
    v_fma_f32 v152, v152, v195, v195
    v_fma_f32 v153, v153, v195, v195
    ds_read_b128 a[32:35], v10 offset:8192
    v_mfma_f32_16x16x32_bf16 v[92:95], v[24:27], a[116:119], v[92:95]
    buffer_load_dwordx4 v[80:83], v188, s[48:51], s23 offen offset:3072 sc1
    v_mfma_f32_16x16x32_bf16 v[96:99], v[16:19], a[180:183], v[96:99]
    v_fma_f32 v154, v154, v195, v195
    v_fma_f32 v155, v155, v195, v195
    ds_read_b128 a[104:107], v10 offset:26624
    v_mfma_f32_16x16x32_bf16 v[96:99], v[20:23], a[184:187], v[96:99]
    v_rcp_f32 v152, v152
    ds_read_b128 a[176:179], v11 offset:8192
    v_mfma_f32_16x16x32_bf16 v[96:99], v[24:27], a[188:191], v[96:99]
    v_rcp_f32 v153, v153
    ds_read_b128 a[248:251], v11 offset:26624
    v_mfma_f32_16x16x32_bf16 v[100:103], v[16:19], a[252:255], v[100:103]
    buffer_load_dwordx4 v[84:87], v189, s[48:51], s23 offen offset:0 sc1
    v_mfma_f32_16x16x32_bf16 v[100:103], v[20:23], v[220:223], v[100:103]
    v_rcp_f32 v154, v154
    v_mfma_f32_16x16x32_bf16 v[100:103], v[24:27], v[224:227], v[100:103]
    v_rcp_f32 v155, v155
    s_waitcnt vmcnt(12)
    v_mfma_f32_16x16x32_bf16 v[104:107], v[28:31], a[36:39], v[104:107]
    v_mul_f32 v156, v156, v152
    v_mul_f32 v157, v157, v153
    ds_read_b128 a[36:39], v10 offset:9216
    v_mfma_f32_16x16x32_bf16 v[104:107], v[32:35], a[40:43], v[104:107]
    buffer_load_dwordx4 v[16:19], v189, s[48:51], s23 offen offset:1024 sc1
    v_mfma_f32_16x16x32_bf16 v[104:107], v[36:39], a[44:47], v[104:107]
    v_mul_f32 v158, v158, v154
    v_mul_f32 v159, v159, v155
    v_mfma_f32_16x16x32_bf16 v[108:111], v[28:31], a[108:111], v[108:111]
    v_cvt_pk_bf16_f32 v160, v156, v157
    v_cvt_pk_bf16_f32 v161, v158, v159
    ds_read_b128 a[108:111], v10 offset:27648
    v_mfma_f32_16x16x32_bf16 v[108:111], v[32:35], a[112:115], v[108:111]
    ds_write_b64 v12, v[160:161] offset:36864
    v_mfma_f32_16x16x32_bf16 v[108:111], v[36:39], a[116:119], v[108:111]
    buffer_load_dwordx4 v[20:23], v189, s[48:51], s23 offen offset:2048 sc1
    v_mfma_f32_16x16x32_bf16 v[112:115], v[28:31], a[180:183], v[112:115]
    v_mul_f32 v162, v132, v132
    v_mul_f32 v163, v133, v133
    ds_read_b128 a[180:183], v11 offset:9216
    v_mfma_f32_16x16x32_bf16 v[112:115], v[32:35], a[184:187], v[112:115]
    v_mul_f32 v164, v134, v134
    v_mul_f32 v165, v135, v135
    v_mfma_f32_16x16x32_bf16 v[112:115], v[36:39], a[188:191], v[112:115]
    v_fma_f32 v162, v162, v14, v7
    v_fma_f32 v163, v163, v14, v7
    v_mfma_f32_16x16x32_bf16 v[116:119], v[28:31], a[252:255], v[116:119]
    buffer_load_dwordx4 v[24:27], v189, s[48:51], s23 offen offset:3072 sc1
    v_mfma_f32_16x16x32_bf16 v[116:119], v[32:35], v[220:223], v[116:119]
    v_fma_f32 v164, v164, v14, v7
    v_fma_f32 v165, v165, v14, v7
    ds_read_b128 a[252:255], v11 offset:27648
    v_mfma_f32_16x16x32_bf16 v[116:119], v[36:39], v[224:227], v[116:119]
    v_mul_f32 v162, v132, v162
    v_mul_f32 v163, v133, v163
    ds_read_b128 a[40:43], v10 offset:10240
    s_waitcnt vmcnt(12)
    v_mfma_f32_16x16x32_bf16 v[88:91], v[40:43], a[48:51], v[88:91]
    v_mul_f32 v164, v134, v164
    v_mul_f32 v165, v135, v165
    ds_read_b128 a[112:115], v10 offset:28672
    v_mfma_f32_16x16x32_bf16 v[88:91], v[44:47], a[52:55], v[88:91]
    buffer_load_dwordx4 v[28:31], v190, s[48:51], s23 offen offset:0 sc1
    v_mfma_f32_16x16x32_bf16 v[88:91], v[48:51], a[56:59], v[88:91]
    v_exp_f32 v162, v162
    ds_read_b128 a[184:187], v11 offset:10240
    v_mfma_f32_16x16x32_bf16 v[92:95], v[40:43], a[120:123], v[92:95]
    v_exp_f32 v163, v163
    ds_read_b128 v[220:223], v11 offset:28672
    v_mfma_f32_16x16x32_bf16 v[92:95], v[44:47], a[124:127], v[92:95]
    v_exp_f32 v164, v164
    ds_read_b128 a[44:47], v10 offset:11264
    v_mfma_f32_16x16x32_bf16 v[92:95], v[48:51], a[128:131], v[92:95]
    buffer_load_dwordx4 v[32:35], v190, s[48:51], s23 offen offset:1024 sc1
    v_mfma_f32_16x16x32_bf16 v[96:99], v[40:43], a[192:195], v[96:99]
    v_exp_f32 v165, v165
    ds_read_b128 a[116:119], v10 offset:29696
    v_mfma_f32_16x16x32_bf16 v[96:99], v[44:47], a[196:199], v[96:99]
    v_mul_f32 v166, v132, v148
    v_mul_f32 v167, v133, v149
    ds_read_b128 a[188:191], v11 offset:11264
    v_mfma_f32_16x16x32_bf16 v[96:99], v[48:51], a[200:203], v[96:99]
    v_mul_f32 v168, v134, v150
    v_mul_f32 v169, v135, v151
    ds_read_b128 v[224:227], v11 offset:29696
    v_mfma_f32_16x16x32_bf16 v[100:103], v[40:43], v[228:231], v[100:103]
    buffer_load_dwordx4 v[36:39], v190, s[48:51], s23 offen offset:2048 sc1
    v_mfma_f32_16x16x32_bf16 v[100:103], v[44:47], v[232:235], v[100:103]
    v_fma_f32 v162, v162, v252, v252
    v_fma_f32 v163, v163, v252, v252
    v_mfma_f32_16x16x32_bf16 v[100:103], v[48:51], v[236:239], v[100:103]
    v_fma_f32 v164, v164, v252, v252
    v_fma_f32 v165, v165, v252, v252
    s_waitcnt vmcnt(12)
    v_mfma_f32_16x16x32_bf16 v[104:107], v[52:55], a[48:51], v[104:107]
    v_rcp_f32 v162, v162
    ds_read_b128 a[48:51], v10 offset:12288
    v_mfma_f32_16x16x32_bf16 v[104:107], v[56:59], a[52:55], v[104:107]
    buffer_load_dwordx4 v[40:43], v190, s[48:51], s23 offen offset:3072 sc1
    v_mfma_f32_16x16x32_bf16 v[104:107], v[60:63], a[56:59], v[104:107]
    v_rcp_f32 v163, v163
    v_mfma_f32_16x16x32_bf16 v[108:111], v[52:55], a[120:123], v[108:111]
    v_rcp_f32 v164, v164
    ds_read_b128 a[120:123], v10 offset:30720
    v_mfma_f32_16x16x32_bf16 v[108:111], v[56:59], a[124:127], v[108:111]
    v_rcp_f32 v165, v165
    v_mfma_f32_16x16x32_bf16 v[108:111], v[60:63], a[128:131], v[108:111]
    buffer_load_dwordx4 v[44:47], v191, s[48:51], s23 offen offset:0 sc1
    v_mfma_f32_16x16x32_bf16 v[112:115], v[52:55], a[192:195], v[112:115]
    v_mul_f32 v166, v166, v162
    v_mul_f32 v167, v167, v163
    ds_read_b128 a[192:195], v11 offset:12288
    v_mfma_f32_16x16x32_bf16 v[112:115], v[56:59], a[196:199], v[112:115]
    v_mul_f32 v168, v168, v164
    v_mul_f32 v169, v169, v165
    v_mfma_f32_16x16x32_bf16 v[112:115], v[60:63], a[200:203], v[112:115]
    v_cvt_pk_bf16_f32 v170, v166, v167
    v_cvt_pk_bf16_f32 v171, v168, v169
    v_mfma_f32_16x16x32_bf16 v[116:119], v[52:55], v[228:231], v[116:119]
    buffer_load_dwordx4 v[48:51], v191, s[48:51], s23 offen offset:1024 sc1
    v_mfma_f32_16x16x32_bf16 v[116:119], v[56:59], v[232:235], v[116:119]
    ds_write_b64 v12, v[170:171] offset:55296
    v_mfma_f32_16x16x32_bf16 v[116:119], v[60:63], v[236:239], v[116:119]
    ds_read_b128 v[228:231], v11 offset:30720
    s_waitcnt vmcnt(12)
    v_mfma_f32_16x16x32_bf16 v[88:91], v[64:67], a[60:63], v[88:91]
    ds_read_b128 a[52:55], v10 offset:13312
    v_mfma_f32_16x16x32_bf16 v[88:91], v[68:71], a[64:67], v[88:91]
    buffer_load_dwordx4 v[52:55], v191, s[48:51], s23 offen offset:2048 sc1
    v_mfma_f32_16x16x32_bf16 v[120:123], v[72:75], a[68:71], v[88:91]
    ds_read_b128 a[124:127], v10 offset:31744
    v_mfma_f32_16x16x32_bf16 v[92:95], v[64:67], a[132:135], v[92:95]
    ds_read_b128 a[196:199], v11 offset:13312
    v_mfma_f32_16x16x32_bf16 v[92:95], v[68:71], a[136:139], v[92:95]
    ds_read_b128 v[232:235], v11 offset:31744
    v_mfma_f32_16x16x32_bf16 v[124:127], v[72:75], a[140:143], v[92:95]
    buffer_load_dwordx4 v[56:59], v191, s[48:51], s23 offen offset:3072 sc1
    v_mfma_f32_16x16x32_bf16 v[96:99], v[64:67], a[204:207], v[96:99]
    v_mfma_f32_16x16x32_bf16 v[96:99], v[68:71], a[208:211], v[96:99]
    v_mfma_f32_16x16x32_bf16 v[128:131], v[72:75], a[212:215], v[96:99]
    v_mfma_f32_16x16x32_bf16 v[100:103], v[64:67], v[240:243], v[100:103]
    buffer_load_dwordx4 v[60:63], v192, s[48:51], s23 offen offset:0 sc1
    v_mfma_f32_16x16x32_bf16 v[100:103], v[68:71], v[244:247], v[100:103]
    v_mfma_f32_16x16x32_bf16 v[132:135], v[72:75], v[248:251], v[100:103]
    s_waitcnt vmcnt(12)
    v_mfma_f32_16x16x32_bf16 v[104:107], v[76:79], a[60:63], v[104:107]
    v_mfma_f32_16x16x32_bf16 v[104:107], v[80:83], a[64:67], v[104:107]
    buffer_load_dwordx4 v[64:67], v192, s[48:51], s23 offen offset:1024 sc1
    v_mfma_f32_16x16x32_bf16 v[136:139], v[84:87], a[68:71], v[104:107]
    v_mfma_f32_16x16x32_bf16 v[108:111], v[76:79], a[132:135], v[108:111]
    v_mfma_f32_16x16x32_bf16 v[108:111], v[80:83], a[136:139], v[108:111]
    v_mfma_f32_16x16x32_bf16 v[140:143], v[84:87], a[140:143], v[108:111]
    buffer_load_dwordx4 v[68:71], v192, s[48:51], s23 offen offset:2048 sc1
    v_mfma_f32_16x16x32_bf16 v[112:115], v[76:79], a[204:207], v[112:115]
    v_mfma_f32_16x16x32_bf16 v[112:115], v[80:83], a[208:211], v[112:115]
    s_lshl_b32 s7, s25, 11
    v_mfma_f32_16x16x32_bf16 v[144:147], v[84:87], a[212:215], v[112:115]
    s_add_u32 s7, s7, s28
    v_mfma_f32_16x16x32_bf16 v[116:119], v[76:79], v[240:243], v[116:119]
    buffer_load_dwordx4 v[72:75], v192, s[48:51], s23 offen offset:3072 sc1
    v_mfma_f32_16x16x32_bf16 v[116:119], v[80:83], v[244:247], v[116:119]
    s_add_u32 s23, s23, 36864
    v_mfma_f32_16x16x32_bf16 v[148:151], v[84:87], v[248:251], v[116:119]
    v_add_u32 v12, s7, v184
    s_add_u32 s25, s25, 1
    s_waitcnt lgkmcnt(0)
    s_barrier
    v_pk_mul_f32 v[152:153], v[120:121], v[120:121]
    ds_read_b128 a[56:59], v10 offset:14336
    v_pk_mul_f32 v[154:155], v[122:123], v[122:123]
    ds_read_b128 a[128:131], v10 offset:32768
    v_pk_fma_f32 v[152:153], v[152:153], v[8:9], v[4:5] op_sel:[0,0,0] op_sel_hi:[1,0,0]
    ds_read_b128 a[200:203], v11 offset:14336
    v_pk_fma_f32 v[154:155], v[154:155], v[8:9], v[4:5] op_sel:[0,0,0] op_sel_hi:[1,0,0]
    v_pk_mul_f32 v[152:153], v[120:121], v[152:153]
    ds_read_b128 v[236:239], v11 offset:32768
    v_pk_mul_f32 v[154:155], v[122:123], v[154:155]
    ds_read_b128 a[60:63], v10 offset:15360
    buffer_load_dwordx4 v[76:79], v184, s[48:51], s23 offen offset:0 sc1
    v_exp_f32 v152, v152
    ds_read_b128 a[132:135], v10 offset:33792
    v_exp_f32 v153, v153
    v_exp_f32 v154, v154
    ds_read_b128 a[204:207], v11 offset:15360
    v_exp_f32 v155, v155
    ds_read_b128 v[240:243], v11 offset:33792
    v_pk_mul_f32 v[156:157], v[120:121], v[136:137]
    v_pk_mul_f32 v[158:159], v[122:123], v[138:139]
    buffer_load_dwordx4 v[80:83], v184, s[48:51], s23 offen offset:1024 sc1
    v_pk_fma_f32 v[152:153], v[152:153], v[192:193], v[192:193] op_sel:[0,1,1] op_sel_hi:[1,1,1]
    v_pk_fma_f32 v[154:155], v[154:155], v[192:193], v[192:193] op_sel:[0,1,1] op_sel_hi:[1,1,1]
    v_rcp_f32 v152, v152
    v_rcp_f32 v153, v153
    v_rcp_f32 v154, v154
    v_rcp_f32 v155, v155
    buffer_load_dwordx4 v[84:87], v184, s[48:51], s23 offen offset:2048 sc1
    s_nop 0
    v_pk_mul_f32 v[156:157], v[156:157], v[152:153]
    v_pk_mul_f32 v[158:159], v[158:159], v[154:155]
    v_cvt_pk_bf16_f32 v160, v156, v157
    v_cvt_pk_bf16_f32 v161, v158, v159
    ds_write_b64 v12, v[160:161] offset:0
    buffer_load_dwordx4 v[104:107], v184, s[48:51], s23 offen offset:3072 sc1
    v_pk_mul_f32 v[162:163], v[124:125], v[124:125]
    v_pk_mul_f32 v[164:165], v[126:127], v[126:127]
    v_pk_fma_f32 v[162:163], v[162:163], v[8:9], v[4:5] op_sel:[0,1,1] op_sel_hi:[1,1,1]
    v_pk_fma_f32 v[164:165], v[164:165], v[8:9], v[4:5] op_sel:[0,1,1] op_sel_hi:[1,1,1]
    v_pk_mul_f32 v[162:163], v[124:125], v[162:163]
    v_pk_mul_f32 v[164:165], v[126:127], v[164:165]
    buffer_load_dwordx4 v[108:111], v185, s[48:51], s23 offen offset:0 sc1
    v_exp_f32 v162, v162
    v_exp_f32 v163, v163
    v_exp_f32 v164, v164
    v_exp_f32 v165, v165
    v_pk_mul_f32 v[166:167], v[124:125], v[140:141]
    v_pk_mul_f32 v[168:169], v[126:127], v[142:143]
    buffer_load_dwordx4 v[112:115], v185, s[48:51], s23 offen offset:1024 sc1
    v_pk_fma_f32 v[162:163], v[162:163], v[194:195], v[194:195] op_sel:[0,0,0] op_sel_hi:[1,0,0]
    v_pk_fma_f32 v[164:165], v[164:165], v[194:195], v[194:195] op_sel:[0,0,0] op_sel_hi:[1,0,0]
    v_rcp_f32 v162, v162
    v_rcp_f32 v163, v163
    v_rcp_f32 v164, v164
    v_rcp_f32 v165, v165
    buffer_load_dwordx4 v[116:119], v185, s[48:51], s23 offen offset:2048 sc1
    s_nop 0
    v_pk_mul_f32 v[166:167], v[166:167], v[162:163]
    v_pk_mul_f32 v[168:169], v[168:169], v[164:165]
    v_cvt_pk_bf16_f32 v170, v166, v167
    v_cvt_pk_bf16_f32 v171, v168, v169
    ds_write_b64 v12, v[170:171] offset:18432
    buffer_load_dwordx4 v[180:183], v185, s[48:51], s23 offen offset:3072 sc1
    v_pk_mul_f32 v[152:153], v[128:129], v[128:129]
    v_pk_mul_f32 v[154:155], v[130:131], v[130:131]
    v_pk_fma_f32 v[152:153], v[152:153], v[12:13], v[6:7] op_sel:[0,1,0] op_sel_hi:[1,1,0]
    v_pk_fma_f32 v[154:155], v[154:155], v[12:13], v[6:7] op_sel:[0,1,0] op_sel_hi:[1,1,0]
    v_pk_mul_f32 v[152:153], v[128:129], v[152:153]
    v_pk_mul_f32 v[154:155], v[130:131], v[154:155]
    buffer_load_dwordx4 v[196:199], v186, s[48:51], s23 offen offset:0 sc1
    v_exp_f32 v152, v152
    v_exp_f32 v153, v153
    v_exp_f32 v154, v154
    v_exp_f32 v155, v155
    v_pk_mul_f32 v[156:157], v[128:129], v[144:145]
    v_pk_mul_f32 v[158:159], v[130:131], v[146:147]
    buffer_load_dwordx4 v[200:203], v186, s[48:51], s23 offen offset:1024 sc1
    v_pk_fma_f32 v[152:153], v[152:153], v[194:195], v[194:195] op_sel:[0,1,1] op_sel_hi:[1,1,1]
    v_pk_fma_f32 v[154:155], v[154:155], v[194:195], v[194:195] op_sel:[0,1,1] op_sel_hi:[1,1,1]
    v_rcp_f32 v152, v152
    v_rcp_f32 v153, v153
    v_rcp_f32 v154, v154
    v_rcp_f32 v155, v155
    buffer_load_dwordx4 v[204:207], v186, s[48:51], s23 offen offset:2048 sc1
    s_nop 0
    v_pk_mul_f32 v[156:157], v[156:157], v[152:153]
    v_pk_mul_f32 v[158:159], v[158:159], v[154:155]
    v_cvt_pk_bf16_f32 v160, v156, v157
    v_cvt_pk_bf16_f32 v161, v158, v159
    ds_write_b64 v12, v[160:161] offset:36864
    buffer_load_dwordx4 v[208:211], v186, s[48:51], s23 offen offset:3072 sc1
    v_pk_mul_f32 v[162:163], v[132:133], v[132:133]
    v_pk_mul_f32 v[164:165], v[134:135], v[134:135]
    v_pk_fma_f32 v[162:163], v[162:163], v[14:15], v[6:7] op_sel:[0,0,1] op_sel_hi:[1,0,1]
    v_pk_fma_f32 v[164:165], v[164:165], v[14:15], v[6:7] op_sel:[0,0,1] op_sel_hi:[1,0,1]
    v_pk_mul_f32 v[162:163], v[132:133], v[162:163]
    v_pk_mul_f32 v[164:165], v[134:135], v[164:165]
    buffer_load_dwordx4 v[212:215], v187, s[48:51], s23 offen offset:0 sc1
    v_exp_f32 v162, v162
    v_exp_f32 v163, v163
    v_exp_f32 v164, v164
    v_exp_f32 v165, v165
    v_pk_mul_f32 v[166:167], v[132:133], v[148:149]
    v_pk_mul_f32 v[168:169], v[134:135], v[150:151]
    v_pk_fma_f32 v[162:163], v[162:163], v[252:253], v[252:253] op_sel:[0,0,0] op_sel_hi:[1,0,0]
    v_pk_fma_f32 v[164:165], v[164:165], v[252:253], v[252:253] op_sel:[0,0,0] op_sel_hi:[1,0,0]
    v_rcp_f32 v162, v162
    v_rcp_f32 v163, v163
    v_rcp_f32 v164, v164
    v_rcp_f32 v165, v165
    s_nop 0
    v_pk_mul_f32 v[166:167], v[166:167], v[162:163]
    v_pk_mul_f32 v[168:169], v[168:169], v[164:165]
    v_cvt_pk_bf16_f32 v170, v166, v167
    v_cvt_pk_bf16_f32 v171, v168, v169
    ds_write_b64 v12, v[170:171] offset:55296
    buffer_load_dwordx4 v[136:139], v187, s[48:51], s23 offen offset:1024 sc1
    buffer_load_dwordx4 v[140:143], v187, s[48:51], s23 offen offset:2048 sc1
    buffer_load_dwordx4 v[144:147], v187, s[48:51], s23 offen offset:3072 sc1
    buffer_load_dwordx4 v[160:163], v188, s[48:51], s23 offen offset:0 sc1
    buffer_load_dwordx4 v[164:167], v188, s[48:51], s23 offen offset:1024 sc1
    s_add_u32 s23, s23, 18432
    s_waitcnt lgkmcnt(0)
    s_barrier
    ds_read_b128 a[64:67], v10 offset:16384
    ds_read_b128 a[136:139], v10 offset:34816
    ds_read_b128 a[208:211], v11 offset:16384
    ds_read_b128 v[244:247], v11 offset:34816
    ds_read_b128 a[68:71], v10 offset:17408
    ds_read_b128 a[140:143], v10 offset:35840
    ds_read_b128 a[212:215], v11 offset:17408
    ds_read_b128 v[248:251], v11 offset:35840
    s_mov_b32 s25, 0
    s_waitcnt lgkmcnt(0)
    s_branch L_ffn_dn_mid_40
L_ffn_dn_39:
    s_waitcnt vmcnt(32)
    v_mfma_f32_16x16x32_bf16 v[88:91], v[104:107], a[0:3], 0
    v_mfma_f32_16x16x32_bf16 v[88:91], v[108:111], a[4:7], v[88:91]
    buffer_load_dwordx4 v[76:79], v184, s[48:51], s23 offen offset:0 sc1
    v_mfma_f32_16x16x32_bf16 v[88:91], v[112:115], a[8:11], v[88:91]
    v_mfma_f32_16x16x32_bf16 v[92:95], v[104:107], a[72:75], 0
    v_mfma_f32_16x16x32_bf16 v[92:95], v[108:111], a[76:79], v[92:95]
    v_mfma_f32_16x16x32_bf16 v[92:95], v[112:115], a[80:83], v[92:95]
    buffer_load_dwordx4 v[80:83], v184, s[48:51], s23 offen offset:1024 sc1
    v_mfma_f32_16x16x32_bf16 v[96:99], v[104:107], a[144:147], 0
    v_cvt_pk_bf16_f32 v152, v120, v121
    v_cvt_pk_bf16_f32 v153, v122, v123
    v_mfma_f32_16x16x32_bf16 v[96:99], v[108:111], a[148:151], v[96:99]
    v_cvt_pk_bf16_f32 v154, v124, v125
    v_cvt_pk_bf16_f32 v155, v126, v127
    v_mfma_f32_16x16x32_bf16 v[96:99], v[112:115], a[152:155], v[96:99]
    s_nop 0
    v_permlane16_swap_b32 v152, v154
    v_mfma_f32_16x16x32_bf16 v[100:103], v[104:107], a[216:219], 0
    buffer_load_dwordx4 v[84:87], v184, s[48:51], s23 offen offset:2048 sc1
    v_mfma_f32_16x16x32_bf16 v[100:103], v[108:111], a[220:223], v[100:103]
    v_permlane16_swap_b32 v153, v155
    v_mfma_f32_16x16x32_bf16 v[100:103], v[112:115], a[224:227], v[100:103]
    buffer_store_dwordx4 v[152:155], v178, s[72:75], s27 offen sc1
    s_waitcnt vmcnt(33)
    v_mfma_f32_16x16x32_bf16 v[88:91], v[116:119], a[12:15], v[88:91]
    ds_write_b128 v216, v[152:155]
    v_mfma_f32_16x16x32_bf16 v[88:91], v[180:183], a[16:19], v[88:91]
    buffer_load_dwordx4 v[104:107], v184, s[48:51], s23 offen offset:3072 sc1
    v_mfma_f32_16x16x32_bf16 v[88:91], v[196:199], a[20:23], v[88:91]
    v_add_u32 v216, v216, v218
    v_mfma_f32_16x16x32_bf16 v[92:95], v[116:119], a[84:87], v[92:95]
    v_mfma_f32_16x16x32_bf16 v[92:95], v[180:183], a[88:91], v[92:95]
    v_mfma_f32_16x16x32_bf16 v[92:95], v[196:199], a[92:95], v[92:95]
    buffer_load_dwordx4 v[108:111], v185, s[48:51], s23 offen offset:0 sc1
    v_mfma_f32_16x16x32_bf16 v[96:99], v[116:119], a[156:159], v[96:99]
    v_mfma_f32_16x16x32_bf16 v[96:99], v[180:183], a[160:163], v[96:99]
    v_mfma_f32_16x16x32_bf16 v[96:99], v[196:199], a[164:167], v[96:99]
    v_mfma_f32_16x16x32_bf16 v[100:103], v[116:119], a[228:231], v[100:103]
    buffer_load_dwordx4 v[112:115], v185, s[48:51], s23 offen offset:1024 sc1
    v_mfma_f32_16x16x32_bf16 v[100:103], v[180:183], a[232:235], v[100:103]
    v_mfma_f32_16x16x32_bf16 v[100:103], v[196:199], a[236:239], v[100:103]
    s_waitcnt vmcnt(33)
    v_mfma_f32_16x16x32_bf16 v[88:91], v[200:203], a[24:27], v[88:91]
    v_mfma_f32_16x16x32_bf16 v[88:91], v[204:207], a[28:31], v[88:91]
    buffer_load_dwordx4 v[116:119], v185, s[48:51], s23 offen offset:2048 sc1
    v_mfma_f32_16x16x32_bf16 v[88:91], v[208:211], a[32:35], v[88:91]
    v_mfma_f32_16x16x32_bf16 v[92:95], v[200:203], a[96:99], v[92:95]
    v_mfma_f32_16x16x32_bf16 v[92:95], v[204:207], a[100:103], v[92:95]
    v_mfma_f32_16x16x32_bf16 v[92:95], v[208:211], a[104:107], v[92:95]
    buffer_load_dwordx4 v[180:183], v185, s[48:51], s23 offen offset:3072 sc1
    v_mfma_f32_16x16x32_bf16 v[96:99], v[200:203], a[168:171], v[96:99]
    v_mfma_f32_16x16x32_bf16 v[96:99], v[204:207], a[172:175], v[96:99]
    v_mfma_f32_16x16x32_bf16 v[96:99], v[208:211], a[176:179], v[96:99]
    v_mfma_f32_16x16x32_bf16 v[100:103], v[200:203], a[240:243], v[100:103]
    buffer_load_dwordx4 v[196:199], v186, s[48:51], s23 offen offset:0 sc1
    v_mfma_f32_16x16x32_bf16 v[100:103], v[204:207], a[244:247], v[100:103]
    v_mfma_f32_16x16x32_bf16 v[100:103], v[208:211], a[248:251], v[100:103]
    s_waitcnt vmcnt(33)
    v_mfma_f32_16x16x32_bf16 v[88:91], v[212:215], a[36:39], v[88:91]
    v_mfma_f32_16x16x32_bf16 v[88:91], v[136:139], a[40:43], v[88:91]
    buffer_load_dwordx4 v[200:203], v186, s[48:51], s23 offen offset:1024 sc1
    v_mfma_f32_16x16x32_bf16 v[88:91], v[140:143], a[44:47], v[88:91]
    v_mfma_f32_16x16x32_bf16 v[92:95], v[212:215], a[108:111], v[92:95]
    v_mfma_f32_16x16x32_bf16 v[92:95], v[136:139], a[112:115], v[92:95]
    v_cvt_pk_bf16_f32 v156, v128, v129
    v_cvt_pk_bf16_f32 v157, v130, v131
    v_mfma_f32_16x16x32_bf16 v[92:95], v[140:143], a[116:119], v[92:95]
    buffer_load_dwordx4 v[204:207], v186, s[48:51], s23 offen offset:2048 sc1
    v_mfma_f32_16x16x32_bf16 v[96:99], v[212:215], a[180:183], v[96:99]
    v_cvt_pk_bf16_f32 v158, v132, v133
    v_cvt_pk_bf16_f32 v159, v134, v135
    v_mfma_f32_16x16x32_bf16 v[96:99], v[136:139], a[184:187], v[96:99]
    s_nop 0
    v_permlane16_swap_b32 v156, v158
    v_mfma_f32_16x16x32_bf16 v[96:99], v[140:143], a[188:191], v[96:99]
    v_permlane16_swap_b32 v157, v159
    v_mfma_f32_16x16x32_bf16 v[100:103], v[212:215], a[252:255], v[100:103]
    buffer_load_dwordx4 v[208:211], v186, s[48:51], s23 offen offset:3072 sc1
    v_mfma_f32_16x16x32_bf16 v[100:103], v[136:139], v[220:223], v[100:103]
    buffer_store_dwordx4 v[156:159], v179, s[72:75], s27 offen sc1
    v_mfma_f32_16x16x32_bf16 v[100:103], v[140:143], v[224:227], v[100:103]
    ds_write_b128 v217, v[156:159]
    s_waitcnt vmcnt(34)
    v_mfma_f32_16x16x32_bf16 v[88:91], v[144:147], a[48:51], v[88:91]
    v_add_u32 v217, v217, v219
    v_mfma_f32_16x16x32_bf16 v[88:91], v[160:163], a[52:55], v[88:91]
    buffer_load_dwordx4 v[212:215], v187, s[48:51], s23 offen offset:0 sc1
    v_mfma_f32_16x16x32_bf16 v[88:91], v[164:167], a[56:59], v[88:91]
    v_mfma_f32_16x16x32_bf16 v[92:95], v[144:147], a[120:123], v[92:95]
    v_mfma_f32_16x16x32_bf16 v[92:95], v[160:163], a[124:127], v[92:95]
    v_mfma_f32_16x16x32_bf16 v[92:95], v[164:167], a[128:131], v[92:95]
    buffer_load_dwordx4 v[136:139], v187, s[48:51], s23 offen offset:1024 sc1
    v_mfma_f32_16x16x32_bf16 v[96:99], v[144:147], a[192:195], v[96:99]
    v_mfma_f32_16x16x32_bf16 v[96:99], v[160:163], a[196:199], v[96:99]
    v_mfma_f32_16x16x32_bf16 v[96:99], v[164:167], a[200:203], v[96:99]
    v_mfma_f32_16x16x32_bf16 v[100:103], v[144:147], v[228:231], v[100:103]
    buffer_load_dwordx4 v[140:143], v187, s[48:51], s23 offen offset:2048 sc1
    v_mfma_f32_16x16x32_bf16 v[100:103], v[160:163], v[232:235], v[100:103]
    v_mfma_f32_16x16x32_bf16 v[100:103], v[164:167], v[236:239], v[100:103]
    s_waitcnt vmcnt(34)
    v_mfma_f32_16x16x32_bf16 v[88:91], v[168:171], a[60:63], v[88:91]
    v_mfma_f32_16x16x32_bf16 v[88:91], v[148:151], a[64:67], v[88:91]
    buffer_load_dwordx4 v[144:147], v187, s[48:51], s23 offen offset:3072 sc1
    v_mfma_f32_16x16x32_bf16 v[120:123], v[4:7], a[68:71], v[88:91]
    v_mfma_f32_16x16x32_bf16 v[92:95], v[168:171], a[132:135], v[92:95]
    v_mfma_f32_16x16x32_bf16 v[92:95], v[148:151], a[136:139], v[92:95]
    v_mfma_f32_16x16x32_bf16 v[124:127], v[4:7], a[140:143], v[92:95]
    buffer_load_dwordx4 v[160:163], v188, s[48:51], s23 offen offset:0 sc1
    v_mfma_f32_16x16x32_bf16 v[96:99], v[168:171], a[204:207], v[96:99]
    s_mov_b32 s74, 268435456
    v_mfma_f32_16x16x32_bf16 v[96:99], v[148:151], a[208:211], v[96:99]
    s_add_u32 s27, s27, 1024
    v_mfma_f32_16x16x32_bf16 v[128:131], v[4:7], a[212:215], v[96:99]
    s_add_u32 s25, s25, 1
    v_mfma_f32_16x16x32_bf16 v[100:103], v[168:171], v[240:243], v[100:103]
    buffer_load_dwordx4 v[164:167], v188, s[48:51], s23 offen offset:1024 sc1
    v_mfma_f32_16x16x32_bf16 v[100:103], v[148:151], v[244:247], v[100:103]
    s_add_u32 s23, s23, 18432
    v_mfma_f32_16x16x32_bf16 v[132:135], v[4:7], v[248:251], v[100:103]
L_ffn_dn_mid_40:
    s_waitcnt vmcnt(30)
    v_mfma_f32_16x16x32_bf16 v[88:91], v[16:19], a[0:3], 0
    v_mfma_f32_16x16x32_bf16 v[88:91], v[20:23], a[4:7], v[88:91]
    buffer_load_dwordx4 v[168:171], v184, s[48:51], s23 offen offset:0 sc1
    v_mfma_f32_16x16x32_bf16 v[88:91], v[24:27], a[8:11], v[88:91]
    v_mfma_f32_16x16x32_bf16 v[92:95], v[16:19], a[72:75], 0
    v_mfma_f32_16x16x32_bf16 v[92:95], v[20:23], a[76:79], v[92:95]
    v_mfma_f32_16x16x32_bf16 v[92:95], v[24:27], a[80:83], v[92:95]
    buffer_load_dwordx4 v[148:151], v184, s[48:51], s23 offen offset:1024 sc1
    v_mfma_f32_16x16x32_bf16 v[96:99], v[16:19], a[144:147], 0
    v_cvt_pk_bf16_f32 v152, v120, v121
    v_cvt_pk_bf16_f32 v153, v122, v123
    v_mfma_f32_16x16x32_bf16 v[96:99], v[20:23], a[148:151], v[96:99]
    v_cvt_pk_bf16_f32 v154, v124, v125
    v_cvt_pk_bf16_f32 v155, v126, v127
    v_mfma_f32_16x16x32_bf16 v[96:99], v[24:27], a[152:155], v[96:99]
    s_nop 0
    v_permlane16_swap_b32 v152, v154
    v_mfma_f32_16x16x32_bf16 v[100:103], v[16:19], a[216:219], 0
    buffer_load_dwordx4 v[4:7], v184, s[48:51], s23 offen offset:2048 sc1
    v_mfma_f32_16x16x32_bf16 v[100:103], v[20:23], a[220:223], v[100:103]
    v_permlane16_swap_b32 v153, v155
    v_mfma_f32_16x16x32_bf16 v[100:103], v[24:27], a[224:227], v[100:103]
    buffer_store_dwordx4 v[152:155], v178, s[72:75], s27 offen sc1
    s_waitcnt vmcnt(31)
    v_mfma_f32_16x16x32_bf16 v[88:91], v[28:31], a[12:15], v[88:91]
    ds_write_b128 v216, v[152:155]
    v_mfma_f32_16x16x32_bf16 v[88:91], v[32:35], a[16:19], v[88:91]
    buffer_load_dwordx4 v[16:19], v184, s[48:51], s23 offen offset:3072 sc1
    v_mfma_f32_16x16x32_bf16 v[88:91], v[36:39], a[20:23], v[88:91]
    v_add_u32 v216, v216, v218
    v_mfma_f32_16x16x32_bf16 v[92:95], v[28:31], a[84:87], v[92:95]
    v_mfma_f32_16x16x32_bf16 v[92:95], v[32:35], a[88:91], v[92:95]
    v_mfma_f32_16x16x32_bf16 v[92:95], v[36:39], a[92:95], v[92:95]
    buffer_load_dwordx4 v[20:23], v185, s[48:51], s23 offen offset:0 sc1
    v_mfma_f32_16x16x32_bf16 v[96:99], v[28:31], a[156:159], v[96:99]
    v_mfma_f32_16x16x32_bf16 v[96:99], v[32:35], a[160:163], v[96:99]
    v_mfma_f32_16x16x32_bf16 v[96:99], v[36:39], a[164:167], v[96:99]
    v_mfma_f32_16x16x32_bf16 v[100:103], v[28:31], a[228:231], v[100:103]
    buffer_load_dwordx4 v[24:27], v185, s[48:51], s23 offen offset:1024 sc1
    v_mfma_f32_16x16x32_bf16 v[100:103], v[32:35], a[232:235], v[100:103]
    v_mfma_f32_16x16x32_bf16 v[100:103], v[36:39], a[236:239], v[100:103]
    s_waitcnt vmcnt(31)
    v_mfma_f32_16x16x32_bf16 v[88:91], v[40:43], a[24:27], v[88:91]
    v_mfma_f32_16x16x32_bf16 v[88:91], v[44:47], a[28:31], v[88:91]
    buffer_load_dwordx4 v[28:31], v185, s[48:51], s23 offen offset:2048 sc1
    v_mfma_f32_16x16x32_bf16 v[88:91], v[48:51], a[32:35], v[88:91]
    v_mfma_f32_16x16x32_bf16 v[92:95], v[40:43], a[96:99], v[92:95]
    v_mfma_f32_16x16x32_bf16 v[92:95], v[44:47], a[100:103], v[92:95]
    v_mfma_f32_16x16x32_bf16 v[92:95], v[48:51], a[104:107], v[92:95]
    buffer_load_dwordx4 v[32:35], v185, s[48:51], s23 offen offset:3072 sc1
    v_mfma_f32_16x16x32_bf16 v[96:99], v[40:43], a[168:171], v[96:99]
    v_mfma_f32_16x16x32_bf16 v[96:99], v[44:47], a[172:175], v[96:99]
    v_mfma_f32_16x16x32_bf16 v[96:99], v[48:51], a[176:179], v[96:99]
    v_mfma_f32_16x16x32_bf16 v[100:103], v[40:43], a[240:243], v[100:103]
    buffer_load_dwordx4 v[36:39], v186, s[48:51], s23 offen offset:0 sc1
    v_mfma_f32_16x16x32_bf16 v[100:103], v[44:47], a[244:247], v[100:103]
    v_mfma_f32_16x16x32_bf16 v[100:103], v[48:51], a[248:251], v[100:103]
    s_waitcnt vmcnt(31)
    s_cmp_lg_u32 s25, 6
    s_cbranch_scc1 L_early_41
    s_waitcnt vmcnt(16)
    s_barrier
    s_cmp_lg_u32 s3, 0
    s_cbranch_scc1 L_early_41
    v_lshlrev_b32 v15, 7, v0
    v_mov_b32 v1, s76
    s_mov_b64 exec, 0xff
    buffer_store_dword v1, v15, s[8:11], s29 offen sc1
    s_mov_b64 exec, -1
L_early_41:
    v_mfma_f32_16x16x32_bf16 v[88:91], v[52:55], a[36:39], v[88:91]
    v_mfma_f32_16x16x32_bf16 v[88:91], v[56:59], a[40:43], v[88:91]
    buffer_load_dwordx4 v[40:43], v186, s[48:51], s23 offen offset:1024 sc1
    v_mfma_f32_16x16x32_bf16 v[88:91], v[60:63], a[44:47], v[88:91]
    v_mfma_f32_16x16x32_bf16 v[92:95], v[52:55], a[108:111], v[92:95]
    v_mfma_f32_16x16x32_bf16 v[92:95], v[56:59], a[112:115], v[92:95]
    v_cvt_pk_bf16_f32 v156, v128, v129
    v_cvt_pk_bf16_f32 v157, v130, v131
    v_mfma_f32_16x16x32_bf16 v[92:95], v[60:63], a[116:119], v[92:95]
    buffer_load_dwordx4 v[44:47], v186, s[48:51], s23 offen offset:2048 sc1
    v_mfma_f32_16x16x32_bf16 v[96:99], v[52:55], a[180:183], v[96:99]
    v_cvt_pk_bf16_f32 v158, v132, v133
    v_cvt_pk_bf16_f32 v159, v134, v135
    v_mfma_f32_16x16x32_bf16 v[96:99], v[56:59], a[184:187], v[96:99]
    s_nop 0
    v_permlane16_swap_b32 v156, v158
    v_mfma_f32_16x16x32_bf16 v[96:99], v[60:63], a[188:191], v[96:99]
    v_permlane16_swap_b32 v157, v159
    v_mfma_f32_16x16x32_bf16 v[100:103], v[52:55], a[252:255], v[100:103]
    buffer_load_dwordx4 v[48:51], v186, s[48:51], s23 offen offset:3072 sc1
    v_mfma_f32_16x16x32_bf16 v[100:103], v[56:59], v[220:223], v[100:103]
    buffer_store_dwordx4 v[156:159], v179, s[72:75], s27 offen sc1
    v_mfma_f32_16x16x32_bf16 v[100:103], v[60:63], v[224:227], v[100:103]
    ds_write_b128 v217, v[156:159]
    s_waitcnt vmcnt(32)
    v_mfma_f32_16x16x32_bf16 v[88:91], v[64:67], a[48:51], v[88:91]
    v_add_u32 v217, v217, v219
    v_mfma_f32_16x16x32_bf16 v[88:91], v[68:71], a[52:55], v[88:91]
    buffer_load_dwordx4 v[52:55], v187, s[48:51], s23 offen offset:0 sc1
    v_mfma_f32_16x16x32_bf16 v[88:91], v[72:75], a[56:59], v[88:91]
    v_mfma_f32_16x16x32_bf16 v[92:95], v[64:67], a[120:123], v[92:95]
    v_mfma_f32_16x16x32_bf16 v[92:95], v[68:71], a[124:127], v[92:95]
    v_mfma_f32_16x16x32_bf16 v[92:95], v[72:75], a[128:131], v[92:95]
    buffer_load_dwordx4 v[56:59], v187, s[48:51], s23 offen offset:1024 sc1
    v_mfma_f32_16x16x32_bf16 v[96:99], v[64:67], a[192:195], v[96:99]
    v_mfma_f32_16x16x32_bf16 v[96:99], v[68:71], a[196:199], v[96:99]
    v_mfma_f32_16x16x32_bf16 v[96:99], v[72:75], a[200:203], v[96:99]
    v_mfma_f32_16x16x32_bf16 v[100:103], v[64:67], v[228:231], v[100:103]
    buffer_load_dwordx4 v[60:63], v187, s[48:51], s23 offen offset:2048 sc1
    v_mfma_f32_16x16x32_bf16 v[100:103], v[68:71], v[232:235], v[100:103]
    v_mfma_f32_16x16x32_bf16 v[100:103], v[72:75], v[236:239], v[100:103]
    s_waitcnt vmcnt(32)
    v_mfma_f32_16x16x32_bf16 v[88:91], v[76:79], a[60:63], v[88:91]
    v_mfma_f32_16x16x32_bf16 v[88:91], v[80:83], a[64:67], v[88:91]
    buffer_load_dwordx4 v[64:67], v187, s[48:51], s23 offen offset:3072 sc1
    v_mfma_f32_16x16x32_bf16 v[120:123], v[84:87], a[68:71], v[88:91]
    v_mfma_f32_16x16x32_bf16 v[92:95], v[76:79], a[132:135], v[92:95]
    v_mfma_f32_16x16x32_bf16 v[92:95], v[80:83], a[136:139], v[92:95]
    v_mfma_f32_16x16x32_bf16 v[124:127], v[84:87], a[140:143], v[92:95]
    buffer_load_dwordx4 v[68:71], v188, s[48:51], s23 offen offset:0 sc1
    v_mfma_f32_16x16x32_bf16 v[96:99], v[76:79], a[204:207], v[96:99]
    s_mov_b32 s74, 268435456
    v_mfma_f32_16x16x32_bf16 v[96:99], v[80:83], a[208:211], v[96:99]
    s_add_u32 s27, s27, 1024
    v_mfma_f32_16x16x32_bf16 v[128:131], v[84:87], a[212:215], v[96:99]
    s_add_u32 s25, s25, 1
    v_mfma_f32_16x16x32_bf16 v[100:103], v[76:79], v[240:243], v[100:103]
    buffer_load_dwordx4 v[72:75], v188, s[48:51], s23 offen offset:1024 sc1
    v_mfma_f32_16x16x32_bf16 v[100:103], v[80:83], v[244:247], v[100:103]
    s_add_u32 s23, s23, 18432
    v_mfma_f32_16x16x32_bf16 v[132:135], v[84:87], v[248:251], v[100:103]
    s_cmp_lt_u32 s25, 7
    s_cbranch_scc1 L_ffn_dn_39
    s_waitcnt vmcnt(33)
    v_mfma_f32_16x16x32_bf16 v[88:91], v[104:107], a[0:3], 0
    v_mfma_f32_16x16x32_bf16 v[88:91], v[108:111], a[4:7], v[88:91]
    buffer_load_dwordx4 v[76:79], v184, s[48:51], s23 offen offset:0 sc1
    v_mfma_f32_16x16x32_bf16 v[88:91], v[112:115], a[8:11], v[88:91]
    v_mfma_f32_16x16x32_bf16 v[92:95], v[104:107], a[72:75], 0
    v_mfma_f32_16x16x32_bf16 v[92:95], v[108:111], a[76:79], v[92:95]
    v_mfma_f32_16x16x32_bf16 v[92:95], v[112:115], a[80:83], v[92:95]
    buffer_load_dwordx4 v[80:83], v184, s[48:51], s23 offen offset:1024 sc1
    v_mfma_f32_16x16x32_bf16 v[96:99], v[104:107], a[144:147], 0
    v_cvt_pk_bf16_f32 v152, v120, v121
    v_cvt_pk_bf16_f32 v153, v122, v123
    v_mfma_f32_16x16x32_bf16 v[96:99], v[108:111], a[148:151], v[96:99]
    v_cvt_pk_bf16_f32 v154, v124, v125
    v_cvt_pk_bf16_f32 v155, v126, v127
    v_mfma_f32_16x16x32_bf16 v[96:99], v[112:115], a[152:155], v[96:99]
    s_nop 0
    v_permlane16_swap_b32 v152, v154
    v_mfma_f32_16x16x32_bf16 v[100:103], v[104:107], a[216:219], 0
    buffer_load_dwordx4 v[84:87], v184, s[48:51], s23 offen offset:2048 sc1
    v_mfma_f32_16x16x32_bf16 v[100:103], v[108:111], a[220:223], v[100:103]
    v_permlane16_swap_b32 v153, v155
    v_mfma_f32_16x16x32_bf16 v[100:103], v[112:115], a[224:227], v[100:103]
    buffer_store_dwordx4 v[152:155], v178, s[72:75], s27 offen sc1
    s_waitcnt vmcnt(34)
    v_mfma_f32_16x16x32_bf16 v[88:91], v[116:119], a[12:15], v[88:91]
    ds_write_b128 v216, v[152:155]
    v_mfma_f32_16x16x32_bf16 v[88:91], v[180:183], a[16:19], v[88:91]
    v_add_u32 v216, v216, v218
    v_cvt_pk_bf16_f32 v156, v128, v129
    v_mfma_f32_16x16x32_bf16 v[88:91], v[196:199], a[20:23], v[88:91]
    v_cvt_pk_bf16_f32 v157, v130, v131
    v_cvt_pk_bf16_f32 v158, v132, v133
    s_load_dwordx8 s[56:63], s[38:39], 0 glc
    v_mfma_f32_16x16x32_bf16 v[92:95], v[116:119], a[84:87], v[92:95]
    v_cvt_pk_bf16_f32 v159, v134, v135
    v_mfma_f32_16x16x32_bf16 v[92:95], v[180:183], a[88:91], v[92:95]
    s_nop 0
    v_permlane16_swap_b32 v156, v158
    v_mfma_f32_16x16x32_bf16 v[92:95], v[196:199], a[92:95], v[92:95]
    v_permlane16_swap_b32 v157, v159
    v_mfma_f32_16x16x32_bf16 v[96:99], v[116:119], a[156:159], v[96:99]
    buffer_store_dwordx4 v[156:159], v179, s[72:75], s27 offen sc1
    v_mfma_f32_16x16x32_bf16 v[96:99], v[180:183], a[160:163], v[96:99]
    ds_write_b128 v217, v[156:159]
    v_mfma_f32_16x16x32_bf16 v[96:99], v[196:199], a[164:167], v[96:99]
    v_add_u32 v217, v217, v219
    v_mfma_f32_16x16x32_bf16 v[100:103], v[116:119], a[228:231], v[100:103]
    v_mfma_f32_16x16x32_bf16 v[100:103], v[180:183], a[232:235], v[100:103]
    v_mfma_f32_16x16x32_bf16 v[100:103], v[196:199], a[236:239], v[100:103]
    s_waitcnt vmcnt(32)
    s_mov_b32 s6, 0
L_epoll_42:
    s_waitcnt lgkmcnt(0)
    s_xor_b64 s[56:57], s[56:57], s[76:77]
    s_xor_b64 s[58:59], s[58:59], s[76:77]
    s_xor_b64 s[60:61], s[60:61], s[76:77]
    s_xor_b64 s[62:63], s[62:63], s[76:77]
    s_or_b64 s[56:57], s[56:57], s[58:59]
    s_or_b64 s[60:61], s[60:61], s[62:63]
    s_or_b64 s[56:57], s[56:57], s[60:61]
    s_cbranch_scc0 L_epolled_43
    s_load_dwordx8 s[56:63], s[38:39], 0 glc
    s_add_u32 s6, s6, 1
    s_cmp_lt_u32 s6, 1048576
    s_cbranch_scc1 L_epoll_42
    s_branch L_main_end
L_epolled_43:
    v_mfma_f32_16x16x32_bf16 v[88:91], v[200:203], a[24:27], v[88:91]
    v_mfma_f32_16x16x32_bf16 v[88:91], v[204:207], a[28:31], v[88:91]
    s_add_u32 s7, s40, 1
    s_and_b32 s7, s7, 7
    s_mul_i32 s7, s7, 9216
    s_add_u32 s19, s7, s20
    buffer_load_dwordx4 v[104:107], v172, s[8:11], s19 offen sc1
    v_mfma_f32_16x16x32_bf16 v[88:91], v[208:211], a[32:35], v[88:91]
    v_mfma_f32_16x16x32_bf16 v[92:95], v[200:203], a[96:99], v[92:95]
    v_mfma_f32_16x16x32_bf16 v[92:95], v[204:207], a[100:103], v[92:95]
    v_mfma_f32_16x16x32_bf16 v[92:95], v[208:211], a[104:107], v[92:95]
    buffer_load_dwordx4 v[108:111], v173, s[8:11], s19 offen sc1
    v_mfma_f32_16x16x32_bf16 v[96:99], v[200:203], a[168:171], v[96:99]
    v_mfma_f32_16x16x32_bf16 v[96:99], v[204:207], a[172:175], v[96:99]
    v_mfma_f32_16x16x32_bf16 v[96:99], v[208:211], a[176:179], v[96:99]
    v_mfma_f32_16x16x32_bf16 v[100:103], v[200:203], a[240:243], v[100:103]
    s_add_u32 s7, s40, 2
    s_and_b32 s7, s7, 7
    s_mul_i32 s7, s7, 9216
    s_add_u32 s19, s7, s20
    buffer_load_dwordx4 v[112:115], v172, s[8:11], s19 offen sc1
    v_mfma_f32_16x16x32_bf16 v[100:103], v[204:207], a[244:247], v[100:103]
    v_mfma_f32_16x16x32_bf16 v[100:103], v[208:211], a[248:251], v[100:103]
    s_waitcnt vmcnt(31)
    v_mfma_f32_16x16x32_bf16 v[88:91], v[212:215], a[36:39], v[88:91]
    v_mfma_f32_16x16x32_bf16 v[88:91], v[136:139], a[40:43], v[88:91]
    buffer_load_dwordx4 v[116:119], v173, s[8:11], s19 offen sc1
    v_mfma_f32_16x16x32_bf16 v[88:91], v[140:143], a[44:47], v[88:91]
    v_mfma_f32_16x16x32_bf16 v[92:95], v[212:215], a[108:111], v[92:95]
    v_mfma_f32_16x16x32_bf16 v[92:95], v[136:139], a[112:115], v[92:95]
    v_mfma_f32_16x16x32_bf16 v[92:95], v[140:143], a[116:119], v[92:95]
    s_add_u32 s7, s40, 3
    s_and_b32 s7, s7, 7
    s_mul_i32 s7, s7, 9216
    s_add_u32 s19, s7, s20
    buffer_load_dwordx4 v[180:183], v172, s[8:11], s19 offen sc1
    v_mfma_f32_16x16x32_bf16 v[96:99], v[212:215], a[180:183], v[96:99]
    v_mfma_f32_16x16x32_bf16 v[96:99], v[136:139], a[184:187], v[96:99]
    v_mfma_f32_16x16x32_bf16 v[96:99], v[140:143], a[188:191], v[96:99]
    v_mfma_f32_16x16x32_bf16 v[100:103], v[212:215], a[252:255], v[100:103]
    buffer_load_dwordx4 v[196:199], v173, s[8:11], s19 offen sc1
    v_mfma_f32_16x16x32_bf16 v[100:103], v[136:139], v[220:223], v[100:103]
    v_mfma_f32_16x16x32_bf16 v[100:103], v[140:143], v[224:227], v[100:103]
    s_waitcnt vmcnt(31)
    v_mfma_f32_16x16x32_bf16 v[88:91], v[144:147], a[48:51], v[88:91]
    v_mfma_f32_16x16x32_bf16 v[88:91], v[160:163], a[52:55], v[88:91]
    s_add_u32 s7, s40, 4
    s_and_b32 s7, s7, 7
    s_mul_i32 s7, s7, 9216
    s_add_u32 s19, s7, s20
    buffer_load_dwordx4 v[200:203], v172, s[8:11], s19 offen sc1
    v_mfma_f32_16x16x32_bf16 v[88:91], v[164:167], a[56:59], v[88:91]
    v_mfma_f32_16x16x32_bf16 v[92:95], v[144:147], a[120:123], v[92:95]
    v_mfma_f32_16x16x32_bf16 v[92:95], v[160:163], a[124:127], v[92:95]
    v_mfma_f32_16x16x32_bf16 v[92:95], v[164:167], a[128:131], v[92:95]
    buffer_load_dwordx4 v[204:207], v173, s[8:11], s19 offen sc1
    v_mfma_f32_16x16x32_bf16 v[96:99], v[144:147], a[192:195], v[96:99]
    v_mfma_f32_16x16x32_bf16 v[96:99], v[160:163], a[196:199], v[96:99]
    v_mfma_f32_16x16x32_bf16 v[96:99], v[164:167], a[200:203], v[96:99]
    v_mfma_f32_16x16x32_bf16 v[100:103], v[144:147], v[228:231], v[100:103]
    s_add_u32 s7, s40, 5
    s_and_b32 s7, s7, 7
    s_mul_i32 s7, s7, 9216
    s_add_u32 s19, s7, s20
    buffer_load_dwordx4 v[208:211], v172, s[8:11], s19 offen sc1
    v_mfma_f32_16x16x32_bf16 v[100:103], v[160:163], v[232:235], v[100:103]
    v_mfma_f32_16x16x32_bf16 v[100:103], v[164:167], v[236:239], v[100:103]
    s_waitcnt vmcnt(31)
    v_mfma_f32_16x16x32_bf16 v[88:91], v[168:171], a[60:63], v[88:91]
    v_mfma_f32_16x16x32_bf16 v[88:91], v[148:151], a[64:67], v[88:91]
    buffer_load_dwordx4 v[212:215], v173, s[8:11], s19 offen sc1
    v_mfma_f32_16x16x32_bf16 v[120:123], v[4:7], a[68:71], v[88:91]
    v_mfma_f32_16x16x32_bf16 v[92:95], v[168:171], a[132:135], v[92:95]
    v_mfma_f32_16x16x32_bf16 v[92:95], v[148:151], a[136:139], v[92:95]
    v_mfma_f32_16x16x32_bf16 v[124:127], v[4:7], a[140:143], v[92:95]
    s_add_u32 s7, s40, 6
    s_and_b32 s7, s7, 7
    s_mul_i32 s7, s7, 9216
    s_add_u32 s19, s7, s20
    buffer_load_dwordx4 v[136:139], v172, s[8:11], s19 offen sc1
    v_mfma_f32_16x16x32_bf16 v[96:99], v[168:171], a[204:207], v[96:99]
    s_mov_b32 s74, 268435456
    v_mfma_f32_16x16x32_bf16 v[96:99], v[148:151], a[208:211], v[96:99]
    s_add_u32 s27, s27, 1024
    v_mfma_f32_16x16x32_bf16 v[128:131], v[4:7], a[212:215], v[96:99]
    s_add_u32 s25, s25, 1
    v_mfma_f32_16x16x32_bf16 v[100:103], v[168:171], v[240:243], v[100:103]
    buffer_load_dwordx4 v[140:143], v173, s[8:11], s19 offen sc1
    v_mfma_f32_16x16x32_bf16 v[100:103], v[148:151], v[244:247], v[100:103]
    s_add_u32 s23, s23, 18432
    v_mfma_f32_16x16x32_bf16 v[132:135], v[4:7], v[248:251], v[100:103]
    s_waitcnt vmcnt(30)
    v_mfma_f32_16x16x32_bf16 v[88:91], v[16:19], a[0:3], 0
    v_mfma_f32_16x16x32_bf16 v[88:91], v[20:23], a[4:7], v[88:91]
    s_add_u32 s7, s40, 7
    s_and_b32 s7, s7, 7
    s_mul_i32 s7, s7, 9216
    s_add_u32 s19, s7, s20
    buffer_load_dwordx4 v[144:147], v172, s[8:11], s19 offen sc1
    v_mfma_f32_16x16x32_bf16 v[88:91], v[24:27], a[8:11], v[88:91]
    v_mfma_f32_16x16x32_bf16 v[92:95], v[16:19], a[72:75], 0
    v_mfma_f32_16x16x32_bf16 v[92:95], v[20:23], a[76:79], v[92:95]
    v_mfma_f32_16x16x32_bf16 v[92:95], v[24:27], a[80:83], v[92:95]
    buffer_load_dwordx4 v[160:163], v173, s[8:11], s19 offen sc1
    v_mfma_f32_16x16x32_bf16 v[96:99], v[16:19], a[144:147], 0
    v_cvt_pk_bf16_f32 v152, v120, v121
    v_cvt_pk_bf16_f32 v153, v122, v123
    v_mfma_f32_16x16x32_bf16 v[96:99], v[20:23], a[148:151], v[96:99]
    v_cvt_pk_bf16_f32 v154, v124, v125
    v_cvt_pk_bf16_f32 v155, v126, v127
    v_mfma_f32_16x16x32_bf16 v[96:99], v[24:27], a[152:155], v[96:99]
    s_nop 0
    v_permlane16_swap_b32 v152, v154
    v_mfma_f32_16x16x32_bf16 v[100:103], v[16:19], a[216:219], 0
    v_permlane16_swap_b32 v153, v155
    v_mfma_f32_16x16x32_bf16 v[100:103], v[20:23], a[220:223], v[100:103]
    buffer_store_dwordx4 v[152:155], v178, s[72:75], s27 offen sc1
    v_mfma_f32_16x16x32_bf16 v[100:103], v[24:27], a[224:227], v[100:103]
    ds_write_b128 v216, v[152:155]
    s_waitcnt vmcnt(30)
    v_mfma_f32_16x16x32_bf16 v[88:91], v[28:31], a[12:15], v[88:91]
    v_add_u32 v216, v216, v218
    v_cvt_pk_bf16_f32 v156, v128, v129
    v_mfma_f32_16x16x32_bf16 v[88:91], v[32:35], a[16:19], v[88:91]
    v_cvt_pk_bf16_f32 v157, v130, v131
    v_cvt_pk_bf16_f32 v158, v132, v133
    v_mfma_f32_16x16x32_bf16 v[88:91], v[36:39], a[20:23], v[88:91]
    v_cvt_pk_bf16_f32 v159, v134, v135
    v_mfma_f32_16x16x32_bf16 v[92:95], v[28:31], a[84:87], v[92:95]
    s_nop 0
    v_permlane16_swap_b32 v156, v158
    v_mfma_f32_16x16x32_bf16 v[92:95], v[32:35], a[88:91], v[92:95]
    v_permlane16_swap_b32 v157, v159
    v_mfma_f32_16x16x32_bf16 v[92:95], v[36:39], a[92:95], v[92:95]
    buffer_store_dwordx4 v[156:159], v179, s[72:75], s27 offen sc1
    v_mfma_f32_16x16x32_bf16 v[96:99], v[28:31], a[156:159], v[96:99]
    ds_write_b128 v217, v[156:159]
    v_mfma_f32_16x16x32_bf16 v[96:99], v[32:35], a[160:163], v[96:99]
    v_add_u32 v217, v217, v219
    v_mfma_f32_16x16x32_bf16 v[96:99], v[36:39], a[164:167], v[96:99]
    v_mfma_f32_16x16x32_bf16 v[100:103], v[28:31], a[228:231], v[100:103]
    v_mfma_f32_16x16x32_bf16 v[100:103], v[32:35], a[232:235], v[100:103]
    v_mfma_f32_16x16x32_bf16 v[100:103], v[36:39], a[236:239], v[100:103]
    s_waitcnt vmcnt(28)
    s_waitcnt vmcnt(16)
    s_barrier
    s_cmp_lg_u32 s3, 0
    s_cbranch_scc1 L_early_44
    s_mov_b64 exec, 0xff
    buffer_store_dword v1, v15, s[8:11], s29 offen offset:32 sc1
    s_mov_b64 exec, -1
L_early_44:
    v_mfma_f32_16x16x32_bf16 v[88:91], v[40:43], a[24:27], v[88:91]
    v_mfma_f32_16x16x32_bf16 v[88:91], v[44:47], a[28:31], v[88:91]
    v_mfma_f32_16x16x32_bf16 v[88:91], v[48:51], a[32:35], v[88:91]
    v_mfma_f32_16x16x32_bf16 v[92:95], v[40:43], a[96:99], v[92:95]
    v_mfma_f32_16x16x32_bf16 v[92:95], v[44:47], a[100:103], v[92:95]
    v_mfma_f32_16x16x32_bf16 v[92:95], v[48:51], a[104:107], v[92:95]
    v_mfma_f32_16x16x32_bf16 v[96:99], v[40:43], a[168:171], v[96:99]
    v_mfma_f32_16x16x32_bf16 v[96:99], v[44:47], a[172:175], v[96:99]
    v_mfma_f32_16x16x32_bf16 v[96:99], v[48:51], a[176:179], v[96:99]
    v_mfma_f32_16x16x32_bf16 v[100:103], v[40:43], a[240:243], v[100:103]
    v_mfma_f32_16x16x32_bf16 v[100:103], v[44:47], a[244:247], v[100:103]
    v_mfma_f32_16x16x32_bf16 v[100:103], v[48:51], a[248:251], v[100:103]
    s_waitcnt vmcnt(24)
    v_mfma_f32_16x16x32_bf16 v[88:91], v[52:55], a[36:39], v[88:91]
    v_mfma_f32_16x16x32_bf16 v[88:91], v[56:59], a[40:43], v[88:91]
    v_mfma_f32_16x16x32_bf16 v[88:91], v[60:63], a[44:47], v[88:91]
    v_mfma_f32_16x16x32_bf16 v[92:95], v[52:55], a[108:111], v[92:95]
    v_mfma_f32_16x16x32_bf16 v[92:95], v[56:59], a[112:115], v[92:95]
    v_mfma_f32_16x16x32_bf16 v[92:95], v[60:63], a[116:119], v[92:95]
    v_mfma_f32_16x16x32_bf16 v[96:99], v[52:55], a[180:183], v[96:99]
    v_mfma_f32_16x16x32_bf16 v[96:99], v[56:59], a[184:187], v[96:99]
    v_mfma_f32_16x16x32_bf16 v[96:99], v[60:63], a[188:191], v[96:99]
    v_mfma_f32_16x16x32_bf16 v[100:103], v[52:55], a[252:255], v[100:103]
    v_mfma_f32_16x16x32_bf16 v[100:103], v[56:59], v[220:223], v[100:103]
    v_mfma_f32_16x16x32_bf16 v[100:103], v[60:63], v[224:227], v[100:103]
    s_waitcnt vmcnt(21)
    v_mfma_f32_16x16x32_bf16 v[88:91], v[64:67], a[48:51], v[88:91]
    v_mfma_f32_16x16x32_bf16 v[88:91], v[68:71], a[52:55], v[88:91]
    v_mfma_f32_16x16x32_bf16 v[88:91], v[72:75], a[56:59], v[88:91]
    v_mfma_f32_16x16x32_bf16 v[92:95], v[64:67], a[120:123], v[92:95]
    v_mfma_f32_16x16x32_bf16 v[92:95], v[68:71], a[124:127], v[92:95]
    v_mfma_f32_16x16x32_bf16 v[92:95], v[72:75], a[128:131], v[92:95]
    v_mfma_f32_16x16x32_bf16 v[96:99], v[64:67], a[192:195], v[96:99]
    v_mfma_f32_16x16x32_bf16 v[96:99], v[68:71], a[196:199], v[96:99]
    v_mfma_f32_16x16x32_bf16 v[96:99], v[72:75], a[200:203], v[96:99]
    v_mfma_f32_16x16x32_bf16 v[100:103], v[64:67], v[228:231], v[100:103]
    v_mfma_f32_16x16x32_bf16 v[100:103], v[68:71], v[232:235], v[100:103]
    v_mfma_f32_16x16x32_bf16 v[100:103], v[72:75], v[236:239], v[100:103]
    s_waitcnt vmcnt(18)
    v_mfma_f32_16x16x32_bf16 v[88:91], v[76:79], a[60:63], v[88:91]
    v_mfma_f32_16x16x32_bf16 v[88:91], v[80:83], a[64:67], v[88:91]
    v_mfma_f32_16x16x32_bf16 v[120:123], v[84:87], a[68:71], v[88:91]
    v_mfma_f32_16x16x32_bf16 v[92:95], v[76:79], a[132:135], v[92:95]
    v_mfma_f32_16x16x32_bf16 v[92:95], v[80:83], a[136:139], v[92:95]
    v_mfma_f32_16x16x32_bf16 v[124:127], v[84:87], a[140:143], v[92:95]
    v_mfma_f32_16x16x32_bf16 v[96:99], v[76:79], a[204:207], v[96:99]
    s_mov_b32 s74, 268435456
    v_mfma_f32_16x16x32_bf16 v[96:99], v[80:83], a[208:211], v[96:99]
    s_add_u32 s27, s27, 1024
    v_mfma_f32_16x16x32_bf16 v[128:131], v[84:87], a[212:215], v[96:99]
    s_add_u32 s25, s25, 1
    v_mfma_f32_16x16x32_bf16 v[100:103], v[76:79], v[240:243], v[100:103]
    v_mfma_f32_16x16x32_bf16 v[100:103], v[80:83], v[244:247], v[100:103]
    s_add_u32 s23, s23, 18432
    v_mfma_f32_16x16x32_bf16 v[132:135], v[84:87], v[248:251], v[100:103]
    s_nop 7
    v_cvt_pk_bf16_f32 v152, v120, v121
    v_cvt_pk_bf16_f32 v153, v122, v123
    v_cvt_pk_bf16_f32 v154, v124, v125
    v_cvt_pk_bf16_f32 v155, v126, v127
    v_cvt_pk_bf16_f32 v156, v128, v129
    v_cvt_pk_bf16_f32 v157, v130, v131
    v_cvt_pk_bf16_f32 v158, v132, v133
    v_cvt_pk_bf16_f32 v159, v134, v135
    s_nop 0
    v_permlane16_swap_b32 v152, v154
    v_permlane16_swap_b32 v153, v155
    buffer_store_dwordx4 v[152:155], v178, s[72:75], s27 offen sc1
    s_nop 0
    v_permlane16_swap_b32 v156, v158
    v_permlane16_swap_b32 v157, v159
    buffer_store_dwordx4 v[156:159], v179, s[72:75], s27 offen sc1
    ds_write_b128 v216, v[152:155]
    ds_write_b128 v217, v[156:159]
    s_waitcnt lgkmcnt(0)
    v_lshlrev_b32 v15, 7, v0
    s_lshl_b32 s6, s40, 2
    s_add_u32 s6, s6, s44
    s_add_u32 s6, s6, 65536
    v_mov_b32 v1, s76
    s_mov_b64 vcc, 0xff
    s_waitcnt vmcnt(0)
    s_barrier
    s_cmp_lg_u32 s3, 0
    s_cbranch_scc1 L_pub_45
    s_mov_b64 exec, vcc
    buffer_store_dword v1, v15, s[8:11], s6 offen sc1
L_pub_45:
    s_mov_b64 exec, -1
    s_add_u32 s19, s18, s43
    s_add_u32 s22, s19, 45875200
    s_lshl_b32 s23, s21, 5
    s_add_u32 s23, s23, s43
    s_add_u32 s23, s23, 48431104
    s_cmp_ge_u32 s3, 2
    s_cbranch_scc1 L_late_46
    s_load_dwordx8 s[56:63], s[38:39], 32 glc
L_late_46:
    v_and_b32 v12, 7, v0
    v_lshlrev_b32 v12, 2, v12
    buffer_load_dword v10, v12, s[8:11], s23 offen sc1
    buffer_load_dwordx4 v[92:95], v172, s[8:11], s22 offen sc1
    buffer_load_dwordx4 v[96:99], v173, s[8:11], s22 offen sc1
    buffer_load_dwordx4 v[100:103], v174, s[8:11], s22 offen sc1
    v_min_u32 v13, 9216, v173
    ds_read_b128 v[148:151], v172 offset:4096
    ds_read_b128 v[152:155], v13 offset:4096
    ds_read_b128 v[156:159], v174 offset:4096
    s_lshl_b32 s28, s40, 2
    s_add_u32 s28, s28, s3
    s_mul_i32 s28, s28, 73728
    v_and_b32 v229, 8, v0
    v_lshl_add_u32 v229, v229, 27, v253
    s_mul_i32 s7, s42, 1073741824
    v_add_u32 v3, s7, v253
    v_or_b32 v229, s7, v229
    v_lshlrev_b32 v16, 16, v104
    v_and_b32 v17, s16, v104
    v_lshlrev_b32 v18, 16, v105
    v_and_b32 v19, s16, v105
    v_lshlrev_b32 v20, 16, v106
    v_and_b32 v21, s16, v106
    v_lshlrev_b32 v22, 16, v107
    v_and_b32 v23, s16, v107
    v_lshlrev_b32 v24, 16, v108
    v_and_b32 v25, s16, v108
    v_lshlrev_b32 v26, 16, v109
    v_and_b32 v27, s16, v109
    v_lshlrev_b32 v28, 16, v110
    v_and_b32 v29, s16, v110
    v_lshlrev_b32 v30, 16, v111
    v_and_b32 v31, s16, v111
    s_cmp_ge_u32 s3, 2
    s_cbranch_scc1 L_late_47
    s_mov_b32 s6, 0
L_epoll_49:
    s_waitcnt lgkmcnt(0)
    s_xor_b64 s[56:57], s[56:57], s[76:77]
    s_xor_b64 s[58:59], s[58:59], s[76:77]
    s_xor_b64 s[60:61], s[60:61], s[76:77]
    s_xor_b64 s[62:63], s[62:63], s[76:77]
    s_or_b64 s[56:57], s[56:57], s[58:59]
    s_or_b64 s[60:61], s[60:61], s[62:63]
    s_or_b64 s[56:57], s[56:57], s[60:61]
    s_cbranch_scc0 L_epolled_50
    s_load_dwordx8 s[56:63], s[38:39], 32 glc
    s_add_u32 s6, s6, 1
    s_cmp_lt_u32 s6, 1048576
    s_cbranch_scc1 L_epoll_49
    s_branch L_main_end
L_epolled_50:
    s_add_u32 s7, s40, 1
    s_and_b32 s7, s7, 7
    s_mul_i32 s7, s7, 9216
    s_add_u32 s19, s7, s20
    buffer_load_dwordx4 v[60:63], v174, s[8:11], s19 offen sc1
    s_add_u32 s7, s40, 2
    s_and_b32 s7, s7, 7
    s_mul_i32 s7, s7, 9216
    s_add_u32 s19, s7, s20
    buffer_load_dwordx4 v[64:67], v174, s[8:11], s19 offen sc1
    s_add_u32 s7, s40, 3
    s_and_b32 s7, s7, 7
    s_mul_i32 s7, s7, 9216
    s_add_u32 s19, s7, s20
    buffer_load_dwordx4 v[68:71], v174, s[8:11], s19 offen sc1
    s_add_u32 s7, s40, 4
    s_and_b32 s7, s7, 7
    s_mul_i32 s7, s7, 9216
    s_add_u32 s19, s7, s20
    buffer_load_dwordx4 v[72:75], v174, s[8:11], s19 offen sc1
    s_add_u32 s7, s40, 5
    s_and_b32 s7, s7, 7
    s_mul_i32 s7, s7, 9216
    s_add_u32 s19, s7, s20
    buffer_load_dwordx4 v[76:79], v174, s[8:11], s19 offen sc1
    s_add_u32 s7, s40, 6
    s_and_b32 s7, s7, 7
    s_mul_i32 s7, s7, 9216
    s_add_u32 s19, s7, s20
    buffer_load_dwordx4 v[80:83], v174, s[8:11], s19 offen sc1
    s_add_u32 s7, s40, 7
    s_and_b32 s7, s7, 7
    s_mul_i32 s7, s7, 9216
    s_add_u32 s19, s7, s20
    buffer_load_dwordx4 v[84:87], v174, s[8:11], s19 offen sc1
L_late_47:
    s_cmp_lg_u32 s42, 0
    s_cbranch_scc1 L_nopf_51
    buffer_load_dwordx4 a[0:3], v3, s[8:11], s28 offen offset:0 sc1
    buffer_load_dwordx4 a[4:7], v3, s[8:11], s28 offen offset:1024 sc1
    buffer_load_dwordx4 a[8:11], v3, s[8:11], s28 offen offset:2048 sc1
    buffer_load_dwordx4 a[12:15], v229, s[8:11], s28 offen offset:3072 sc1
    s_add_u32 s28, s28, 4096
    buffer_load_dwordx4 a[16:19], v3, s[8:11], s28 offen offset:0 sc1
    buffer_load_dwordx4 a[20:23], v3, s[8:11], s28 offen offset:1024 sc1
    buffer_load_dwordx4 a[24:27], v3, s[8:11], s28 offen offset:2048 sc1
    buffer_load_dwordx4 a[28:31], v229, s[8:11], s28 offen offset:3072 sc1
L_nopf_51:
    v_lshlrev_b32 v40, 16, v112
    v_and_b32 v41, s16, v112
    v_lshlrev_b32 v42, 16, v113
    v_and_b32 v43, s16, v113
    v_lshlrev_b32 v44, 16, v114
    v_and_b32 v45, s16, v114
    v_lshlrev_b32 v46, 16, v115
    v_and_b32 v47, s16, v115
    v_pk_add_f32 v[16:17], v[16:17], v[40:41]
    v_pk_add_f32 v[18:19], v[18:19], v[42:43]
    v_pk_add_f32 v[20:21], v[20:21], v[44:45]
    v_pk_add_f32 v[22:23], v[22:23], v[46:47]
    v_lshlrev_b32 v40, 16, v116
    v_and_b32 v41, s16, v116
    v_lshlrev_b32 v42, 16, v117
    v_and_b32 v43, s16, v117
    v_lshlrev_b32 v44, 16, v118
    v_and_b32 v45, s16, v118
    v_lshlrev_b32 v46, 16, v119
    v_and_b32 v47, s16, v119
    v_pk_add_f32 v[24:25], v[24:25], v[40:41]
    v_pk_add_f32 v[26:27], v[26:27], v[42:43]
    v_pk_add_f32 v[28:29], v[28:29], v[44:45]
    v_pk_add_f32 v[30:31], v[30:31], v[46:47]
    s_cmp_lg_u32 s42, 0
    s_cbranch_scc1 L_nopf_52
    s_add_u32 s28, s28, 4096
    buffer_load_dwordx4 a[32:35], v3, s[8:11], s28 offen offset:0 sc1
    buffer_load_dwordx4 a[36:39], v3, s[8:11], s28 offen offset:1024 sc1
    buffer_load_dwordx4 a[40:43], v3, s[8:11], s28 offen offset:2048 sc1
    buffer_load_dwordx4 a[44:47], v229, s[8:11], s28 offen offset:3072 sc1
    s_add_u32 s28, s28, 4096
    buffer_load_dwordx4 a[48:51], v3, s[8:11], s28 offen offset:0 sc1
    buffer_load_dwordx4 a[52:55], v3, s[8:11], s28 offen offset:1024 sc1
    buffer_load_dwordx4 a[56:59], v3, s[8:11], s28 offen offset:2048 sc1
    buffer_load_dwordx4 a[60:63], v229, s[8:11], s28 offen offset:3072 sc1
L_nopf_52:
    v_lshlrev_b32 v40, 16, v180
    v_and_b32 v41, s16, v180
    v_lshlrev_b32 v42, 16, v181
    v_and_b32 v43, s16, v181
    v_lshlrev_b32 v44, 16, v182
    v_and_b32 v45, s16, v182
    v_lshlrev_b32 v46, 16, v183
    v_and_b32 v47, s16, v183
    v_pk_add_f32 v[16:17], v[16:17], v[40:41]
    v_pk_add_f32 v[18:19], v[18:19], v[42:43]
    v_pk_add_f32 v[20:21], v[20:21], v[44:45]
    v_pk_add_f32 v[22:23], v[22:23], v[46:47]
    v_lshlrev_b32 v40, 16, v196
    v_and_b32 v41, s16, v196
    v_lshlrev_b32 v42, 16, v197
    v_and_b32 v43, s16, v197
    v_lshlrev_b32 v44, 16, v198
    v_and_b32 v45, s16, v198
    v_lshlrev_b32 v46, 16, v199
    v_and_b32 v47, s16, v199
    v_pk_add_f32 v[24:25], v[24:25], v[40:41]
    v_pk_add_f32 v[26:27], v[26:27], v[42:43]
    v_pk_add_f32 v[28:29], v[28:29], v[44:45]
    v_pk_add_f32 v[30:31], v[30:31], v[46:47]
    v_lshlrev_b32 v40, 16, v200
    v_and_b32 v41, s16, v200
    v_lshlrev_b32 v42, 16, v201
    v_and_b32 v43, s16, v201
    v_lshlrev_b32 v44, 16, v202
    v_and_b32 v45, s16, v202
    v_lshlrev_b32 v46, 16, v203
    v_and_b32 v47, s16, v203
    v_pk_add_f32 v[16:17], v[16:17], v[40:41]
    v_pk_add_f32 v[18:19], v[18:19], v[42:43]
    v_pk_add_f32 v[20:21], v[20:21], v[44:45]
    v_pk_add_f32 v[22:23], v[22:23], v[46:47]
    v_lshlrev_b32 v40, 16, v204
    v_and_b32 v41, s16, v204
    v_lshlrev_b32 v42, 16, v205
    v_and_b32 v43, s16, v205
    v_lshlrev_b32 v44, 16, v206
    v_and_b32 v45, s16, v206
    v_lshlrev_b32 v46, 16, v207
    v_and_b32 v47, s16, v207
    v_pk_add_f32 v[24:25], v[24:25], v[40:41]
    v_pk_add_f32 v[26:27], v[26:27], v[42:43]
    v_pk_add_f32 v[28:29], v[28:29], v[44:45]
    v_pk_add_f32 v[30:31], v[30:31], v[46:47]
    v_lshlrev_b32 v40, 16, v208
    v_and_b32 v41, s16, v208
    v_lshlrev_b32 v42, 16, v209
    v_and_b32 v43, s16, v209
    v_lshlrev_b32 v44, 16, v210
    v_and_b32 v45, s16, v210
    v_lshlrev_b32 v46, 16, v211
    v_and_b32 v47, s16, v211
    v_pk_add_f32 v[16:17], v[16:17], v[40:41]
    v_pk_add_f32 v[18:19], v[18:19], v[42:43]
    v_pk_add_f32 v[20:21], v[20:21], v[44:45]
    v_pk_add_f32 v[22:23], v[22:23], v[46:47]
    v_lshlrev_b32 v40, 16, v212
    v_and_b32 v41, s16, v212
    v_lshlrev_b32 v42, 16, v213
    v_and_b32 v43, s16, v213
    v_lshlrev_b32 v44, 16, v214
    v_and_b32 v45, s16, v214
    v_lshlrev_b32 v46, 16, v215
    v_and_b32 v47, s16, v215
    v_pk_add_f32 v[24:25], v[24:25], v[40:41]
    v_pk_add_f32 v[26:27], v[26:27], v[42:43]
    v_pk_add_f32 v[28:29], v[28:29], v[44:45]
    v_pk_add_f32 v[30:31], v[30:31], v[46:47]
    v_lshlrev_b32 v40, 16, v136
    v_and_b32 v41, s16, v136
    v_lshlrev_b32 v42, 16, v137
    v_and_b32 v43, s16, v137
    v_lshlrev_b32 v44, 16, v138
    v_and_b32 v45, s16, v138
    v_lshlrev_b32 v46, 16, v139
    v_and_b32 v47, s16, v139
    v_pk_add_f32 v[16:17], v[16:17], v[40:41]
    v_pk_add_f32 v[18:19], v[18:19], v[42:43]
    v_pk_add_f32 v[20:21], v[20:21], v[44:45]
    v_pk_add_f32 v[22:23], v[22:23], v[46:47]
    v_lshlrev_b32 v40, 16, v140
    v_and_b32 v41, s16, v140
    v_lshlrev_b32 v42, 16, v141
    v_and_b32 v43, s16, v141
    v_lshlrev_b32 v44, 16, v142
    v_and_b32 v45, s16, v142
    v_lshlrev_b32 v46, 16, v143
    v_and_b32 v47, s16, v143
    v_pk_add_f32 v[24:25], v[24:25], v[40:41]
    v_pk_add_f32 v[26:27], v[26:27], v[42:43]
    v_pk_add_f32 v[28:29], v[28:29], v[44:45]
    v_pk_add_f32 v[30:31], v[30:31], v[46:47]
    v_lshlrev_b32 v40, 16, v144
    v_and_b32 v41, s16, v144
    v_lshlrev_b32 v42, 16, v145
    v_and_b32 v43, s16, v145
    v_lshlrev_b32 v44, 16, v146
    v_and_b32 v45, s16, v146
    v_lshlrev_b32 v46, 16, v147
    v_and_b32 v47, s16, v147
    v_pk_add_f32 v[16:17], v[16:17], v[40:41]
    v_pk_add_f32 v[18:19], v[18:19], v[42:43]
    v_pk_add_f32 v[20:21], v[20:21], v[44:45]
    v_pk_add_f32 v[22:23], v[22:23], v[46:47]
    v_lshlrev_b32 v40, 16, v160
    v_and_b32 v41, s16, v160
    v_lshlrev_b32 v42, 16, v161
    v_and_b32 v43, s16, v161
    v_lshlrev_b32 v44, 16, v162
    v_and_b32 v45, s16, v162
    v_lshlrev_b32 v46, 16, v163
    v_and_b32 v47, s16, v163
    v_pk_add_f32 v[24:25], v[24:25], v[40:41]
    v_pk_add_f32 v[26:27], v[26:27], v[42:43]
    v_pk_add_f32 v[28:29], v[28:29], v[44:45]
    v_pk_add_f32 v[30:31], v[30:31], v[46:47]
    s_cmp_lg_u32 s3, 3
    s_cbranch_scc1 L_pollout_55
    s_lshl_b32 s7, s40, 7
    s_add_u32 s7, s7, s44
    s_add_u32 s7, s7, 65536
    s_add_u32 s52, s4, s7
    s_addc_u32 s53, s5, 0
    s_mov_b32 s6, 0
L_poll_53:
    s_load_dwordx8 s[56:63], s[52:53], 0 glc
    s_add_u32 s6, s6, 1
    s_waitcnt lgkmcnt(0)
    s_xor_b64 s[56:57], s[56:57], s[76:77]
    s_xor_b64 s[58:59], s[58:59], s[76:77]
    s_xor_b64 s[60:61], s[60:61], s[76:77]
    s_xor_b64 s[62:63], s[62:63], s[76:77]
    s_or_b64 s[56:57], s[56:57], s[58:59]
    s_or_b64 s[60:61], s[60:61], s[62:63]
    s_or_b64 s[56:57], s[56:57], s[60:61]
    s_cbranch_scc0 L_polled_54
    s_cmp_lt_u32 s6, 1048576
    s_cbranch_scc1 L_poll_53
    s_branch L_main_end
L_polled_54:
L_pollout_55:
    s_barrier
    s_cmp_lt_u32 s3, 2
    s_cbranch_scc1 L_late_48
    s_add_u32 s7, s40, 1
    s_and_b32 s7, s7, 7
    s_mul_i32 s7, s7, 9216
    s_add_u32 s19, s7, s20
    buffer_load_dwordx4 v[60:63], v174, s[8:11], s19 offen sc1
    s_add_u32 s7, s40, 2
    s_and_b32 s7, s7, 7
    s_mul_i32 s7, s7, 9216
    s_add_u32 s19, s7, s20
    buffer_load_dwordx4 v[64:67], v174, s[8:11], s19 offen sc1
    s_add_u32 s7, s40, 3
    s_and_b32 s7, s7, 7
    s_mul_i32 s7, s7, 9216
    s_add_u32 s19, s7, s20
    buffer_load_dwordx4 v[68:71], v174, s[8:11], s19 offen sc1
    s_add_u32 s7, s40, 4
    s_and_b32 s7, s7, 7
    s_mul_i32 s7, s7, 9216
    s_add_u32 s19, s7, s20
    buffer_load_dwordx4 v[72:75], v174, s[8:11], s19 offen sc1
    s_add_u32 s7, s40, 5
    s_and_b32 s7, s7, 7
    s_mul_i32 s7, s7, 9216
    s_add_u32 s19, s7, s20
    buffer_load_dwordx4 v[76:79], v174, s[8:11], s19 offen sc1
    s_add_u32 s7, s40, 6
    s_and_b32 s7, s7, 7
    s_mul_i32 s7, s7, 9216
    s_add_u32 s19, s7, s20
    buffer_load_dwordx4 v[80:83], v174, s[8:11], s19 offen sc1
    s_add_u32 s7, s40, 7
    s_and_b32 s7, s7, 7
    s_mul_i32 s7, s7, 9216
    s_add_u32 s19, s7, s20
    buffer_load_dwordx4 v[84:87], v174, s[8:11], s19 offen sc1
L_late_48:
    s_cmp_eq_u32 s3, 0
    s_cselect_b32 s7, 1.0, 0
    s_cselect_b32 s6, -1, 0
    s_waitcnt vmcnt(7) lgkmcnt(0)
    v_and_b32 v152, s6, v152
    v_and_b32 v153, s6, v153
    v_and_b32 v154, s6, v154
    v_and_b32 v155, s6, v155
    v_mul_f32 v11, s7, v10
    v_lshlrev_b32 v40, 16, v92
    v_and_b32 v41, s16, v92
    v_lshlrev_b32 v42, 16, v93
    v_and_b32 v43, s16, v93
    v_lshlrev_b32 v44, 16, v94
    v_and_b32 v45, s16, v94
    v_lshlrev_b32 v46, 16, v95
    v_and_b32 v47, s16, v95
    v_pk_add_f32 v[16:17], v[16:17], v[40:41]
    v_pk_add_f32 v[18:19], v[18:19], v[42:43]
    v_pk_add_f32 v[20:21], v[20:21], v[44:45]
    v_pk_add_f32 v[22:23], v[22:23], v[46:47]
    v_lshlrev_b32 v40, 16, v96
    v_and_b32 v41, s16, v96
    v_lshlrev_b32 v42, 16, v97
    v_and_b32 v43, s16, v97
    v_lshlrev_b32 v44, 16, v98
    v_and_b32 v45, s16, v98
    v_lshlrev_b32 v46, 16, v99
    v_and_b32 v47, s16, v99
    v_pk_add_f32 v[24:25], v[24:25], v[40:41]
    v_pk_add_f32 v[26:27], v[26:27], v[42:43]
    v_pk_add_f32 v[28:29], v[28:29], v[44:45]
    v_pk_add_f32 v[30:31], v[30:31], v[46:47]
    v_lshlrev_b32 v32, 16, v100
    v_and_b32 v33, s16, v100
    v_lshlrev_b32 v34, 16, v101
    v_and_b32 v35, s16, v101
    v_lshlrev_b32 v36, 16, v102
    v_and_b32 v37, s16, v102
    v_lshlrev_b32 v38, 16, v103
    v_and_b32 v39, s16, v103
    v_lshlrev_b32 v40, 16, v148
    v_and_b32 v41, s16, v148
    v_lshlrev_b32 v42, 16, v149
    v_and_b32 v43, s16, v149
    v_lshlrev_b32 v44, 16, v150
    v_and_b32 v45, s16, v150
    v_lshlrev_b32 v46, 16, v151
    v_and_b32 v47, s16, v151
    v_pk_add_f32 v[16:17], v[16:17], v[40:41]
    v_pk_add_f32 v[18:19], v[18:19], v[42:43]
    v_pk_add_f32 v[20:21], v[20:21], v[44:45]
    v_pk_add_f32 v[22:23], v[22:23], v[46:47]
    v_lshlrev_b32 v40, 16, v152
    v_and_b32 v41, s16, v152
    v_lshlrev_b32 v42, 16, v153
    v_and_b32 v43, s16, v153
    v_lshlrev_b32 v44, 16, v154
    v_and_b32 v45, s16, v154
    v_lshlrev_b32 v46, 16, v155
    v_and_b32 v47, s16, v155
    v_pk_add_f32 v[24:25], v[24:25], v[40:41]
    v_pk_add_f32 v[26:27], v[26:27], v[42:43]
    v_pk_add_f32 v[28:29], v[28:29], v[44:45]
    v_pk_add_f32 v[30:31], v[30:31], v[46:47]
    v_lshlrev_b32 v40, 16, v156
    v_and_b32 v41, s16, v156
    v_lshlrev_b32 v42, 16, v157
    v_and_b32 v43, s16, v157
    v_lshlrev_b32 v44, 16, v158
    v_and_b32 v45, s16, v158
    v_lshlrev_b32 v46, 16, v159
    v_and_b32 v47, s16, v159
    v_pk_add_f32 v[32:33], v[32:33], v[40:41]
    v_pk_add_f32 v[34:35], v[34:35], v[42:43]
    v_pk_add_f32 v[36:37], v[36:37], v[44:45]
    v_pk_add_f32 v[38:39], v[38:39], v[46:47]
    v_pk_add_f32 v[16:17], v[16:17], v[10:11] op_sel_hi:[1,0]
    v_pk_add_f32 v[18:19], v[18:19], v[10:11] op_sel_hi:[1,0]
    v_pk_add_f32 v[20:21], v[20:21], v[10:11] op_sel_hi:[1,0]
    v_pk_add_f32 v[22:23], v[22:23], v[10:11] op_sel_hi:[1,0]
    v_pk_add_f32 v[24:25], v[24:25], v[10:11] op_sel:[0,1] op_sel_hi:[1,1]
    v_pk_add_f32 v[26:27], v[26:27], v[10:11] op_sel:[0,1] op_sel_hi:[1,1]
    v_pk_add_f32 v[28:29], v[28:29], v[10:11] op_sel:[0,1] op_sel_hi:[1,1]
    v_pk_add_f32 v[30:31], v[30:31], v[10:11] op_sel:[0,1] op_sel_hi:[1,1]
    v_pk_add_f32 v[32:33], v[32:33], v[10:11] op_sel_hi:[1,0]
    v_pk_add_f32 v[34:35], v[34:35], v[10:11] op_sel_hi:[1,0]
    v_pk_add_f32 v[36:37], v[36:37], v[10:11] op_sel_hi:[1,0]
    v_pk_add_f32 v[38:39], v[38:39], v[10:11] op_sel_hi:[1,0]
    s_waitcnt vmcnt(6)
    s_add_u32 s28, s28, 4096
    buffer_load_dwordx4 a[64:67], v3, s[8:11], s28 offen offset:0 sc1
    v_lshlrev_b32 v40, 16, v60
    v_and_b32 v41, s16, v60
    v_lshlrev_b32 v42, 16, v61
    v_and_b32 v43, s16, v61
    v_lshlrev_b32 v44, 16, v62
    v_and_b32 v45, s16, v62
    v_lshlrev_b32 v46, 16, v63
    v_and_b32 v47, s16, v63
    v_pk_add_f32 v[32:33], v[32:33], v[40:41]
    v_pk_add_f32 v[34:35], v[34:35], v[42:43]
    v_pk_add_f32 v[36:37], v[36:37], v[44:45]
    v_pk_add_f32 v[38:39], v[38:39], v[46:47]
    s_waitcnt vmcnt(6)
    buffer_load_dwordx4 a[68:71], v3, s[8:11], s28 offen offset:1024 sc1
    v_lshlrev_b32 v40, 16, v64
    v_and_b32 v41, s16, v64
    v_lshlrev_b32 v42, 16, v65
    v_and_b32 v43, s16, v65
    v_lshlrev_b32 v44, 16, v66
    v_and_b32 v45, s16, v66
    v_lshlrev_b32 v46, 16, v67
    v_and_b32 v47, s16, v67
    v_pk_add_f32 v[32:33], v[32:33], v[40:41]
    v_pk_add_f32 v[34:35], v[34:35], v[42:43]
    v_pk_add_f32 v[36:37], v[36:37], v[44:45]
    v_pk_add_f32 v[38:39], v[38:39], v[46:47]
    s_waitcnt vmcnt(6)
    buffer_load_dwordx4 a[72:75], v3, s[8:11], s28 offen offset:2048 sc1
    v_lshlrev_b32 v40, 16, v68
    v_and_b32 v41, s16, v68
    v_lshlrev_b32 v42, 16, v69
    v_and_b32 v43, s16, v69
    v_lshlrev_b32 v44, 16, v70
    v_and_b32 v45, s16, v70
    v_lshlrev_b32 v46, 16, v71
    v_and_b32 v47, s16, v71
    v_pk_add_f32 v[32:33], v[32:33], v[40:41]
    v_pk_add_f32 v[34:35], v[34:35], v[42:43]
    v_pk_add_f32 v[36:37], v[36:37], v[44:45]
    v_pk_add_f32 v[38:39], v[38:39], v[46:47]
    s_waitcnt vmcnt(6)
    buffer_load_dwordx4 a[76:79], v229, s[8:11], s28 offen offset:3072 sc1
    v_lshlrev_b32 v40, 16, v72
    v_and_b32 v41, s16, v72
    v_lshlrev_b32 v42, 16, v73
    v_and_b32 v43, s16, v73
    v_lshlrev_b32 v44, 16, v74
    v_and_b32 v45, s16, v74
    v_lshlrev_b32 v46, 16, v75
    v_and_b32 v47, s16, v75
    v_pk_add_f32 v[32:33], v[32:33], v[40:41]
    v_pk_add_f32 v[34:35], v[34:35], v[42:43]
    v_pk_add_f32 v[36:37], v[36:37], v[44:45]
    v_pk_add_f32 v[38:39], v[38:39], v[46:47]
    s_waitcnt vmcnt(6)
    s_add_u32 s28, s28, 4096
    buffer_load_dwordx4 a[80:83], v3, s[8:11], s28 offen offset:0 sc1
    v_lshlrev_b32 v40, 16, v76
    v_and_b32 v41, s16, v76
    v_lshlrev_b32 v42, 16, v77
    v_and_b32 v43, s16, v77
    v_lshlrev_b32 v44, 16, v78
    v_and_b32 v45, s16, v78
    v_lshlrev_b32 v46, 16, v79
    v_and_b32 v47, s16, v79
    v_pk_add_f32 v[32:33], v[32:33], v[40:41]
    v_pk_add_f32 v[34:35], v[34:35], v[42:43]
    v_pk_add_f32 v[36:37], v[36:37], v[44:45]
    v_pk_add_f32 v[38:39], v[38:39], v[46:47]
    s_waitcnt vmcnt(6)
    buffer_load_dwordx4 a[84:87], v3, s[8:11], s28 offen offset:1024 sc1
    v_lshlrev_b32 v40, 16, v80
    v_and_b32 v41, s16, v80
    v_lshlrev_b32 v42, 16, v81
    v_and_b32 v43, s16, v81
    v_lshlrev_b32 v44, 16, v82
    v_and_b32 v45, s16, v82
    v_lshlrev_b32 v46, 16, v83
    v_and_b32 v47, s16, v83
    v_pk_add_f32 v[32:33], v[32:33], v[40:41]
    v_pk_add_f32 v[34:35], v[34:35], v[42:43]
    v_pk_add_f32 v[36:37], v[36:37], v[44:45]
    v_pk_add_f32 v[38:39], v[38:39], v[46:47]
    s_waitcnt vmcnt(6)
    buffer_load_dwordx4 a[88:91], v3, s[8:11], s28 offen offset:2048 sc1
    v_lshlrev_b32 v40, 16, v84
    v_and_b32 v41, s16, v84
    v_lshlrev_b32 v42, 16, v85
    v_and_b32 v43, s16, v85
    v_lshlrev_b32 v44, 16, v86
    v_and_b32 v45, s16, v86
    v_lshlrev_b32 v46, 16, v87
    v_and_b32 v47, s16, v87
    v_pk_add_f32 v[32:33], v[32:33], v[40:41]
    v_pk_add_f32 v[34:35], v[34:35], v[42:43]
    v_pk_add_f32 v[36:37], v[36:37], v[44:45]
    v_pk_add_f32 v[38:39], v[38:39], v[46:47]
    buffer_load_dwordx4 a[92:95], v229, s[8:11], s28 offen offset:3072 sc1
    v_cvt_pk_bf16_f32 v120, v16, v17
    v_cvt_pk_bf16_f32 v121, v18, v19
    v_cvt_pk_bf16_f32 v122, v20, v21
    v_cvt_pk_bf16_f32 v123, v22, v23
    v_cvt_pk_bf16_f32 v124, v24, v25
    v_cvt_pk_bf16_f32 v125, v26, v27
    v_cvt_pk_bf16_f32 v126, v28, v29
    v_cvt_pk_bf16_f32 v127, v30, v31
    v_cvt_pk_bf16_f32 v128, v32, v33
    v_cvt_pk_bf16_f32 v129, v34, v35
    v_cvt_pk_bf16_f32 v130, v36, v37
    v_cvt_pk_bf16_f32 v131, v38, v39
    s_cmp_lg_u32 s42, 0
    s_cbranch_scc1 L_main_last
    s_add_u32 s19, s18, 53215232
    s_add_u32 s20, s18, 48496640
    s_lshl_b32 s22, s21, 7
    s_add_u32 s22, s22, 57933824
    buffer_store_dwordx4 v[120:123], v172, s[8:11], s19 offen sc1
    buffer_store_dwordx4 v[124:127], v173, s[8:11], s19 offen sc1
    buffer_store_dwordx4 v[128:131], v174, s[8:11], s19 offen sc1
    s_mov_b32 s17, 0x3f803f80
    v_mov_b32 v8, 0
    v_mov_b32 v9, 0
    v_mov_b32 v10, 0
    v_mov_b32 v11, 0
    v_dot2c_f32_bf16 v8, s17, v120
    v_dot2c_f32_bf16 v9, v120, v120
    v_dot2c_f32_bf16 v10, s17, v121
    v_dot2c_f32_bf16 v11, v121, v121
    v_dot2c_f32_bf16 v8, s17, v122
    v_dot2c_f32_bf16 v9, v122, v122
    v_dot2c_f32_bf16 v10, s17, v123
    v_dot2c_f32_bf16 v11, v123, v123
    v_dot2c_f32_bf16 v8, s17, v124
    v_dot2c_f32_bf16 v9, v124, v124
    v_dot2c_f32_bf16 v10, s17, v125
    v_dot2c_f32_bf16 v11, v125, v125
    v_dot2c_f32_bf16 v8, s17, v126
    v_dot2c_f32_bf16 v9, v126, v126
    v_dot2c_f32_bf16 v10, s17, v127
    v_dot2c_f32_bf16 v11, v127, v127
    v_dot2c_f32_bf16 v8, s17, v128
    v_dot2c_f32_bf16 v9, v128, v128
    v_dot2c_f32_bf16 v10, s17, v129
    v_dot2c_f32_bf16 v11, v129, v129
    v_dot2c_f32_bf16 v8, s17, v130
    v_dot2c_f32_bf16 v9, v130, v130
    v_dot2c_f32_bf16 v10, s17, v131
    v_dot2c_f32_bf16 v11, v131, v131
    v_and_b32 v12, 7, v0
    v_lshlrev_b32 v12, 3, v12
    s_lshl_b32 s7, s3, 6
    v_add_u32 v13, s7, v12
    v_pk_add_f32 v[8:9], v[8:9], v[10:11]
    s_nop 1
    v_add_f32_dpp v8, v8, v8 row_ror:8 row_mask:0xf bank_mask:0xf
    v_add_f32_dpp v9, v9, v9 row_ror:8 row_mask:0xf bank_mask:0xf
    v_mov_b32 v10, v8
    v_mov_b32 v11, v9
    s_nop 1
    v_permlane32_swap_b32 v10, v8
    v_permlane32_swap_b32 v11, v9
    v_add_f32 v8, v8, v10
    v_add_f32 v9, v9, v11
    v_mov_b32 v10, v8
    v_mov_b32 v11, v9
    s_nop 1
    v_permlane16_swap_b32 v10, v8
    v_permlane16_swap_b32 v11, v9
    v_add_f32 v8, v8, v10
    v_add_f32 v9, v9, v11
    ds_write_b64 v13, v[8:9]
    s_waitcnt lgkmcnt(0)
    s_barrier
    ds_read_b64 v[40:41], v12 offset:0
    ds_read_b64 v[42:43], v12 offset:64
    ds_read_b64 v[44:45], v12 offset:128
    ds_read_b64 v[46:47], v12 offset:192
    s_waitcnt lgkmcnt(0)
    v_pk_add_f32 v[40:41], v[40:41], v[42:43]
    v_pk_add_f32 v[44:45], v[44:45], v[46:47]
    v_pk_add_f32 v[8:9], v[40:41], v[44:45]
    v_mul_f32 v8, 0x3ae38e39, v8
    v_mul_f32 v9, 0x3ae38e39, v9
    v_fma_f32 v9, -v8, v8, v9
    v_max_f32 v9, 0, v9
    v_add_f32 v9, 0x3727c5ac, v9
    v_rsq_f32 v10, v9
    s_nop 0
    v_mul_f32 v12, v8, v10
    v_mov_b32 v11, v10
    v_sub_f32 v12, 0, v12
    v_mov_b32 v13, v12
    s_cmp_eq_u32 s3, 0
    s_cselect_b32 s7, 32, 0
    v_lshlrev_b32 v14, 2, v0
    v_cmp_gt_u32 vcc, s7, v0
    v_mov_b32 v9, 1073741824
    s_nop 0
    v_cndmask_b32 v14, v9, v14, vcc
    buffer_store_dword v8, v14, s[8:11], s22 offen sc1
    v_lshlrev_b32 v40, 16, v120
    v_and_b32 v41, s16, v120
    v_lshlrev_b32 v42, 16, v121
    v_and_b32 v43, s16, v121
    v_lshlrev_b32 v44, 16, v122
    v_and_b32 v45, s16, v122
    v_lshlrev_b32 v46, 16, v123
    v_and_b32 v47, s16, v123
    v_pk_fma_f32 v[40:41], v[40:41], v[10:11], v[12:13]
    v_pk_fma_f32 v[42:43], v[42:43], v[10:11], v[12:13]
    v_pk_fma_f32 v[44:45], v[44:45], v[10:11], v[12:13]
    v_pk_fma_f32 v[46:47], v[46:47], v[10:11], v[12:13]
    v_cvt_pk_bf16_f32 v48, v40, v41
    v_cvt_pk_bf16_f32 v49, v42, v43
    v_cvt_pk_bf16_f32 v50, v44, v45
    v_cvt_pk_bf16_f32 v51, v46, v47
    v_lshlrev_b32 v40, 16, v124
    v_and_b32 v41, s16, v124
    v_lshlrev_b32 v42, 16, v125
    v_and_b32 v43, s16, v125
    v_lshlrev_b32 v44, 16, v126
    v_and_b32 v45, s16, v126
    v_lshlrev_b32 v46, 16, v127
    v_and_b32 v47, s16, v127
    v_pk_fma_f32 v[40:41], v[40:41], v[10:11], v[12:13]
    v_pk_fma_f32 v[42:43], v[42:43], v[10:11], v[12:13]
    v_pk_fma_f32 v[44:45], v[44:45], v[10:11], v[12:13]
    v_pk_fma_f32 v[46:47], v[46:47], v[10:11], v[12:13]
    v_cvt_pk_bf16_f32 v52, v40, v41
    v_cvt_pk_bf16_f32 v53, v42, v43
    v_cvt_pk_bf16_f32 v54, v44, v45
    v_cvt_pk_bf16_f32 v55, v46, v47
    v_lshlrev_b32 v40, 16, v128
    v_and_b32 v41, s16, v128
    v_lshlrev_b32 v42, 16, v129
    v_and_b32 v43, s16, v129
    v_lshlrev_b32 v44, 16, v130
    v_and_b32 v45, s16, v130
    v_lshlrev_b32 v46, 16, v131
    v_and_b32 v47, s16, v131
    v_pk_fma_f32 v[40:41], v[40:41], v[10:11], v[12:13]
    v_pk_fma_f32 v[42:43], v[42:43], v[10:11], v[12:13]
    v_pk_fma_f32 v[44:45], v[44:45], v[10:11], v[12:13]
    v_pk_fma_f32 v[46:47], v[46:47], v[10:11], v[12:13]
    v_cvt_pk_bf16_f32 v56, v40, v41
    v_cvt_pk_bf16_f32 v57, v42, v43
    v_cvt_pk_bf16_f32 v58, v44, v45
    v_cvt_pk_bf16_f32 v59, v46, v47
    buffer_store_dwordx4 v[48:51], v172, s[8:11], s20 offen sc1
    buffer_store_dwordx4 v[52:55], v173, s[8:11], s20 offen sc1
    buffer_store_dwordx4 v[56:59], v174, s[8:11], s20 offen sc1
    v_lshlrev_b32 v15, 7, v0
    s_lshl_b32 s6, s40, 2
    s_add_u32 s6, s6, s44
    s_add_u32 s6, s6, 98304
    v_mov_b32 v1, s76
    s_mov_b64 vcc, 0xff
    v_lshrrev_b32 v14, 3, v0
    v_lshl_add_u32 v15, v14, 3, v15
    s_cmp_ge_u32 s40, 6
    s_cselect_b32 s7, s41, 31
    s_cmp_lt_u32 s7, 31
    s_cmov_b64 vcc, 0xffff
    s_waitcnt vmcnt(0)
    s_barrier
    s_cmp_lg_u32 s3, 0
    s_cbranch_scc1 L_pub_56
    s_mov_b64 exec, vcc
    buffer_store_dword v1, v15, s[8:11], s6 offen sc1
L_pub_56:
    s_mov_b64 exec, -1
    s_add_u32 s28, s28, 4096
    buffer_load_dwordx4 a[96:99], v3, s[8:11], s28 offen offset:0 sc1
    buffer_load_dwordx4 a[100:103], v3, s[8:11], s28 offen offset:1024 sc1
    buffer_load_dwordx4 a[104:107], v3, s[8:11], s28 offen offset:2048 sc1
    buffer_load_dwordx4 a[108:111], v229, s[8:11], s28 offen offset:3072 sc1
    s_add_u32 s28, s28, 4096
    buffer_load_dwordx4 a[112:115], v3, s[8:11], s28 offen offset:0 sc1
    buffer_load_dwordx4 a[116:119], v3, s[8:11], s28 offen offset:1024 sc1
    buffer_load_dwordx4 a[120:123], v3, s[8:11], s28 offen offset:2048 sc1
    buffer_load_dwordx4 a[124:127], v229, s[8:11], s28 offen offset:3072 sc1
    s_add_u32 s28, s28, 4096
    buffer_load_dwordx4 a[128:131], v3, s[8:11], s28 offen offset:0 sc1
    buffer_load_dwordx4 a[132:135], v3, s[8:11], s28 offen offset:1024 sc1
    buffer_load_dwordx4 a[136:139], v3, s[8:11], s28 offen offset:2048 sc1
    buffer_load_dwordx4 a[140:143], v229, s[8:11], s28 offen offset:3072 sc1
    s_add_u32 s28, s28, 4096
    s_mov_b32 s42, 1
    s_mov_b32 s43, 9699328
    s_add_u32 s44, s44, 131072
    s_branch L_main_layer
L_main_last:
    buffer_store_dwordx4 v[120:123], v175, s[12:15], s18 offen sc0 sc1
    buffer_store_dwordx4 v[124:127], v176, s[12:15], s18 offen sc0 sc1
    buffer_store_dwordx4 v[128:131], v177, s[12:15], s18 offen sc0 sc1
    s_or_b32 s7, s40, s41
    s_or_b32 s7, s7, s3
    s_cbranch_scc1 L_done_57
    v_mov_b32 v1, s76
    s_mov_b32 s7, 19660800
    s_mov_b64 exec, 1
    buffer_store_dword v1, off, s[8:11], s7 sc1
    s_mov_b64 exec, -1
L_done_57:
L_main_end:
    s_endpgm
L_main_code_end:
.section .rodata,"a"
.p2align 6
.amdhsa_kernel interleave_layers__sliding_local_dilated__glu_gated_geglu__prompt_kernel
.amdhsa_next_free_vgpr 512
.amdhsa_next_free_sgpr 102
.amdhsa_accum_offset 256
.amdhsa_group_segment_fixed_size 0
.amdhsa_kernarg_size 80
.amdhsa_user_sgpr_count 2
.amdhsa_user_sgpr_kernarg_segment_ptr 1
.amdhsa_system_sgpr_workgroup_id_x 1
.amdhsa_float_denorm_mode_32 3
.amdhsa_float_denorm_mode_16_64 3
.end_amdhsa_kernel
```

```asm
; @launch grid=(256,1,1) block=(256,1,1) lds=163840
.amdgcn_target "amdgcn-amd-amdhsa--gfx950"
.text
.globl interleave_layers__sliding_local_dilated__glu_gated_geglu__prompt_kernel
.p2align 8
.type interleave_layers__sliding_local_dilated__glu_gated_geglu__prompt_kernel,@function
interleave_layers__sliding_local_dilated__glu_gated_geglu__prompt_kernel:
    s_cmp_ge_u32 s2, 256
    s_cbranch_scc1 L_main_end
    s_load_dwordx2 s[4:5], s[0:1], 72
    s_load_dwordx4 s[16:19], s[0:1], 0
    s_load_dwordx2 s[22:23], s[0:1], 16
    s_load_dwordx8 s[24:31], s[0:1], 32
    s_getpc_b64 s[96:97]
L_main_pc:
    s_sub_u32 s96, s96, L_main_pc-interleave_layers__sliding_local_dilated__glu_gated_geglu__prompt_kernel
    s_subb_u32 s97, s97, 0
    s_and_b32 s97, s97, 0xffff
    s_mov_b32 s98, L_main_code_end-interleave_layers__sliding_local_dilated__glu_gated_geglu__prompt_kernel
    s_mov_b32 s99, 0x20000
    s_lshr_b32 s7, s2, 3
    s_lshl_b32 s7, s7, 11
    v_lshl_add_u32 v253, v0, 3, s7
    buffer_load_dwordx2 v[2:3], v253, s[96:99], 0 offen
    v_lshrrev_b32 v1, 6, v0
    v_and_b32 v0, 63, v0
    v_readfirstlane_b32 s3, v1
    s_waitcnt lgkmcnt(0)
    s_mov_b32 s8, s4
    s_and_b32 s9, s5, 0xffff
    s_mov_b32 s10, 268435456
    s_mov_b32 s11, 0x20000
    s_mov_b32 s7, 19660800
    s_load_dword s76, s[4:5], s7
    s_mov_b64 s[20:21], s[18:19]
    s_mov_b64 s[18:19], s[16:17]
    s_mov_b32 s48, s4
    s_and_b32 s49, s5, 0xffff
    s_mov_b32 s50, 268435456
    s_mov_b32 s51, 0x20000
    s_and_b32 s40, s2, 3
    s_lshl_b32 s40, s40, 1
    s_bfe_u32 s7, s2, 65539
    s_add_u32 s40, s40, s7
    s_bfe_u32 s41, s2, 65538
    s_lshl_b32 s41, s41, 4
    s_lshr_b32 s7, s2, 4
    s_add_u32 s41, s41, s7
    s_mov_b32 s42, 0
    s_mov_b32 s43, 0
    s_lshl_b32 s44, s41, 10
    s_add_u32 s44, s44, 19169280
    v_lshlrev_b32 v253, 4, v0
    s_mov_b32 s12, s18
    s_and_b32 s13, s19, 0xffff
    s_mov_b32 s14, 2359296
    s_mov_b32 s15, 0x20000
    s_mov_b32 s64, s20
    s_and_b32 s65, s21, 0xffff
    s_mov_b32 s66, 1990656
    s_mov_b32 s67, 0x20000
    s_mov_b32 s68, s22
    s_and_b32 s69, s23, 0xffff
    s_mov_b32 s70, 663552
    s_mov_b32 s71, 0x20000
    s_mov_b32 s16, 0xffff0000
    s_lshl_b32 s7, s3, 10
    v_add_u32 v172, s7, v253
    v_add_u32 v174, 5120, v172
    v_and_b32 v178, 7, v0
    v_mul_u32_u24 v178, 1152, v178
    v_lshrrev_b32 v179, 3, v0
    v_lshl_add_u32 v178, v179, 4, v178
    s_lshl_b32 s7, s3, 7
    v_add_u32 v175, s7, v178
    v_add_u32 v177, 640, v175
    s_cmp_eq_u32 s3, 0
    s_mov_b32 s17, 1073741824
    s_cmov_b32 s17, 4096
    v_add_u32 v173, s17, v172
    s_mov_b32 s17, 1073741824
    s_cmov_b32 s17, 512
    v_add_u32 v176, s17, v175
    s_lshl_b32 s21, s41, 3
    s_add_u32 s21, s21, s40
    s_mul_i32 s18, s21, 9216
    buffer_load_dwordx4 v[16:19], v175, s[12:15], s18 offen nt
    buffer_load_dwordx4 v[20:23], v176, s[12:15], s18 offen nt
    buffer_load_dwordx4 v[24:27], v177, s[12:15], s18 offen nt
    s_mov_b32 s12, s30
    s_and_b32 s13, s31, 0xffff
    s_mov_b32 s14, 2359296
    s_mov_b32 s15, 0x20000
    s_lshl_b32 s79, s3, 14
    s_add_u32 s79, s79, 98304
    s_and_b32 s32, s41, 15
    s_lshl_b32 s32, s32, 1
    s_lshr_b32 s7, s41, 4
    s_add_u32 s32, s32, s7
    s_lshl_b32 s36, s32, 3
    s_add_u32 s36, s36, s40
    s_sub_u32 s36, s36, 144
    s_cmp_ge_u32 s32, 18
    s_cbranch_scc1 L_prep_o_1
    s_mul_i32 s35, s32, 110592
    s_mul_i32 s7, s40, 144
    s_and_b32 s46, s7, 127
    s_sub_u32 s7, s7, s46
    s_add_u32 s35, s35, s7
    s_mul_i32 s7, s3, 13824
    s_add_u32 s35, s35, s7
    v_lshrrev_b32 v8, 4, v0
    v_mul_u32_u24 v8, 3456, v8
    v_and_b32 v9, 15, v0
    v_lshl_add_u32 v8, v9, 4, v8
    s_lshl_b32 s34, s3, 10
    s_add_u32 m0, s34, 8192
    s_add_u32 s7, s35, 0
    buffer_load_dwordx4 v8, s[64:67], s7 offen nt lds
    s_add_u32 m0, s34, 12288
    s_add_u32 s7, s35, 55296
    buffer_load_dwordx4 v8, s[64:67], s7 offen nt lds
    s_add_u32 m0, s34, 16384
    s_add_u32 s7, s35, 1152
    buffer_load_dwordx4 v8, s[64:67], s7 offen nt lds
    s_add_u32 m0, s34, 20480
    s_add_u32 s7, s35, 56448
    buffer_load_dwordx4 v8, s[64:67], s7 offen nt lds
    s_add_u32 m0, s34, 24576
    s_add_u32 s7, s35, 2304
    buffer_load_dwordx4 v8, s[64:67], s7 offen nt lds
    s_add_u32 m0, s34, 28672
    s_add_u32 s7, s35, 57600
    buffer_load_dwordx4 v8, s[64:67], s7 offen nt lds
    s_branch L_prep_go_3
L_prep_o_1:
    s_cmp_ge_u32 s36, 54
    s_cbranch_scc1 L_prep_m_2
    s_mul_i32 s33, s36, 349526
    s_lshr_b32 s33, s33, 20
    s_mul_i32 s34, s33, 3
    s_sub_u32 s34, s36, s34
    s_lshl_b32 s7, s33, 2
    s_add_u32 s7, s7, s3
    v_mov_b32 v8, s7
    v_lshrrev_b32 v9, 3, v0
    v_mul_u32_u24 v11, 7282, v8
    v_lshrrev_b32 v11, 16, v11
    v_mul_u32_u24 v12, 9, v11
    v_sub_u32 v12, v8, v12
    v_mul_u32_u24 v11, 72, v11
    v_cmp_eq_u32 vcc, 8, v12
    v_lshrrev_b32 v10, 1, v12
    v_mad_u32_u24 v10, v10, 18, v11
    v_and_b32 v12, 1, v12
    v_lshl_add_u32 v10, v12, 3, v10
    v_add_u32 v10, v10, v9
    v_lshrrev_b32 v12, 1, v9
    v_mad_u32_u24 v11, v12, 18, v11
    v_and_b32 v12, 1, v9
    v_add3_u32 v11, v11, v12, 16
    v_cndmask_b32 v10, v10, v11, vcc
    v_mul_u32_u24 v10, 1152, v10
    v_and_b32 v9, 7, v0
    v_lshl_add_u32 v10, v9, 4, v10
    s_mul_i32 s35, s34, 384
    s_lshl_b32 s6, s3, 10
    s_add_u32 m0, s6, 8192
    s_add_u32 s7, s35, 0
    buffer_load_dwordx4 v10, s[68:71], s7 offen nt lds
    s_add_u32 m0, s6, 12288
    s_add_u32 s7, s35, 128
    buffer_load_dwordx4 v10, s[68:71], s7 offen nt lds
    s_add_u32 m0, s6, 16384
    s_add_u32 s7, s35, 256
    buffer_load_dwordx4 v10, s[68:71], s7 offen nt lds
    s_branch L_prep_go_3
L_prep_m_2:
    s_sub_u32 s37, s36, 54
    s_lshl_b32 s7, s3, 6
    s_add_u32 s37, s37, s7
    s_cmp_ge_u32 s37, 36
    s_cbranch_scc1 L_prep_go_3
    s_lshl_b32 s7, s37, 1
    v_bfe_u32 v8, v0, 3, 1
    v_add_u32 v8, s7, v8
    v_and_b32 v9, 7, v0
    v_mul_u32_u24 v11, 7282, v8
    v_lshrrev_b32 v11, 16, v11
    v_mul_u32_u24 v12, 9, v11
    v_sub_u32 v12, v8, v12
    v_mul_u32_u24 v11, 72, v11
    v_cmp_eq_u32 vcc, 8, v12
    v_lshrrev_b32 v10, 1, v12
    v_mad_u32_u24 v10, v10, 18, v11
    v_and_b32 v12, 1, v12
    v_lshl_add_u32 v10, v12, 3, v10
    v_add_u32 v10, v10, v9
    v_lshrrev_b32 v12, 1, v9
    v_mad_u32_u24 v11, v12, 18, v11
    v_and_b32 v12, 1, v9
    v_add3_u32 v11, v11, v12, 16
    v_cndmask_b32 v10, v10, v11, vcc
    v_mul_u32_u24 v10, 1152, v10
    v_lshrrev_b32 v9, 4, v0
    v_lshl_add_u32 v10, v9, 4, v10
    buffer_load_dwordx4 v[64:67], v10, s[68:71], 0 offen offset:0
    buffer_load_dwordx4 v[68:71], v10, s[68:71], 0 offen offset:64
    buffer_load_dwordx4 v[72:75], v10, s[68:71], 0 offen offset:128
    buffer_load_dwordx4 v[76:79], v10, s[68:71], 0 offen offset:192
    buffer_load_dwordx4 v[80:83], v10, s[68:71], 0 offen offset:256
    buffer_load_dwordx4 v[84:87], v10, s[68:71], 0 offen offset:320
    buffer_load_dwordx4 v[88:91], v10, s[68:71], 0 offen offset:384
    buffer_load_dwordx4 v[92:95], v10, s[68:71], 0 offen offset:448
    buffer_load_dwordx4 v[96:99], v10, s[68:71], 0 offen offset:512
    buffer_load_dwordx4 v[100:103], v10, s[68:71], 0 offen offset:576
    buffer_load_dwordx4 v[104:107], v10, s[68:71], 0 offen offset:640
    buffer_load_dwordx4 v[108:111], v10, s[68:71], 0 offen offset:704
    buffer_load_dwordx4 v[112:115], v10, s[68:71], 0 offen offset:768
    buffer_load_dwordx4 v[116:119], v10, s[68:71], 0 offen offset:832
    buffer_load_dwordx4 v[120:123], v10, s[68:71], 0 offen offset:896
    buffer_load_dwordx4 v[124:127], v10, s[68:71], 0 offen offset:960
    buffer_load_dwordx4 v[128:131], v10, s[68:71], 0 offen offset:1024
    buffer_load_dwordx4 v[132:135], v10, s[68:71], 0 offen offset:1088
L_prep_go_3:
    s_lshl_b32 s7, s32, 2
    s_add_u32 s7, s7, s3
    s_cmp_ge_u32 s7, 72
    s_cbranch_scc1 L_blocks_7
    s_cmp_ge_u32 s7, 54
    s_cselect_b32 s93, 1, 0
    s_cselect_b32 s6, 54, 0
    s_sub_u32 s7, s7, s6
    s_mul_i32 s17, s7, 3
    s_mov_b32 s45, 1
    s_branch L_blocks_8
L_blocks_7:
    s_sub_u32 s7, s7, 72
    s_cmp_ge_u32 s7, 22
    s_cselect_b32 s93, 2, 1
    s_cselect_b32 s6, 22, 0
    s_cselect_b32 s17, 0, 54
    s_sub_u32 s7, s7, s6
    s_mul_i32 s7, s7, 5
    s_add_u32 s17, s17, s7
    s_mov_b32 s45, 3
L_blocks_8:
    s_cmp_eq_u32 s93, 1
    s_cselect_b32 s72, s26, s24
    s_cselect_b32 s73, s27, s25
    s_cmp_eq_u32 s93, 2
    s_cselect_b32 s72, s28, s72
    s_cselect_b32 s73, s29, s73
    s_mov_b32 s92, 73728
    s_cmov_b32 s92, 9216
    s_mov_b32 s47, 1152
    s_cmov_b32 s47, 663552
    s_and_b32 s73, s73, 0xffff
    s_mov_b32 s74, 5308416
    s_mov_b32 s75, 0x20000
    s_mul_i32 s47, s47, s40
    s_add_u32 s7, s17, 0
    s_min_u32 s7, s7, 161
    s_mul_i32 s52, s7, 116509
    s_lshr_b32 s52, s52, 20
    s_mul_i32 s53, s52, 9
    s_sub_u32 s53, s7, s53
    s_mul_i32 s7, s52, s92
    s_lshl_b32 s7, s7, 2
    s_add_u32 s7, s7, s47
    s_lshl_b32 s6, s53, 7
    s_add_u32 s80, s7, s6
    s_add_u32 s7, s17, 1
    s_min_u32 s7, s7, 161
    s_mul_i32 s54, s7, 116509
    s_lshr_b32 s54, s54, 20
    s_mul_i32 s55, s54, 9
    s_sub_u32 s55, s7, s55
    s_mul_i32 s7, s54, s92
    s_lshl_b32 s7, s7, 2
    s_add_u32 s7, s7, s47
    s_lshl_b32 s6, s55, 7
    s_add_u32 s81, s7, s6
    s_add_u32 s7, s17, 2
    s_min_u32 s7, s7, 161
    s_mul_i32 s56, s7, 116509
    s_lshr_b32 s56, s56, 20
    s_mul_i32 s57, s56, 9
    s_sub_u32 s57, s7, s57
    s_mul_i32 s7, s56, s92
    s_lshl_b32 s7, s7, 2
    s_add_u32 s7, s7, s47
    s_lshl_b32 s6, s57, 7
    s_add_u32 s82, s7, s6
    s_add_u32 s7, s17, 0
    s_add_u32 s7, s7, s45
    s_min_u32 s7, s7, 161
    s_mul_i32 s58, s7, 116509
    s_lshr_b32 s58, s58, 20
    s_mul_i32 s59, s58, 9
    s_sub_u32 s59, s7, s59
    s_mul_i32 s7, s58, s92
    s_lshl_b32 s7, s7, 2
    s_add_u32 s7, s7, s47
    s_lshl_b32 s6, s59, 7
    s_add_u32 s83, s7, s6
    s_add_u32 s7, s17, 1
    s_add_u32 s7, s7, s45
    s_min_u32 s7, s7, 161
    s_mul_i32 s60, s7, 116509
    s_lshr_b32 s60, s60, 20
    s_mul_i32 s61, s60, 9
    s_sub_u32 s61, s7, s61
    s_mul_i32 s7, s60, s92
    s_lshl_b32 s7, s7, 2
    s_add_u32 s7, s7, s47
    s_lshl_b32 s6, s61, 7
    s_add_u32 s84, s7, s6
    s_lshr_b32 s7, s92, 3
    v_lshrrev_b32 v224, 3, v0
    v_mul_lo_u32 v224, v224, s7
    v_and_b32 v8, 7, v0
    v_lshl_add_u32 v224, v8, 4, v224
    s_waitcnt lgkmcnt(0)
    s_mul_i32 s76, s76, 0x9e3779b1
    s_add_u32 s76, s76, 0x7f4a7c15
    s_mov_b32 s77, s76
    s_add_u32 m0, s79, 0
    s_mov_b32 s71, s80
    buffer_load_dwordx4 v224, s[72:75], s71 offen nt lds
    s_add_u32 m0, s79, 1024
    s_add_u32 s71, s71, s92
    buffer_load_dwordx4 v224, s[72:75], s71 offen nt lds
    s_add_u32 m0, s79, 2048
    s_add_u32 s71, s71, s92
    buffer_load_dwordx4 v224, s[72:75], s71 offen nt lds
    s_add_u32 m0, s79, 3072
    s_add_u32 s71, s71, s92
    buffer_load_dwordx4 v224, s[72:75], s71 offen nt lds
    s_cmp_lt_u32 s32, 18
    s_cbranch_scc1 L_raw_9
    s_add_u32 m0, s79, 4096
    s_mov_b32 s71, s81
    buffer_load_dwordx4 v224, s[72:75], s71 offen nt lds
    s_add_u32 m0, s79, 5120
    s_add_u32 s71, s71, s92
    buffer_load_dwordx4 v224, s[72:75], s71 offen nt lds
    s_add_u32 m0, s79, 6144
    s_add_u32 s71, s71, s92
    buffer_load_dwordx4 v224, s[72:75], s71 offen nt lds
    s_add_u32 m0, s79, 7168
    s_add_u32 s71, s71, s92
    buffer_load_dwordx4 v224, s[72:75], s71 offen nt lds
    s_add_u32 m0, s79, 8192
    s_mov_b32 s71, s82
    buffer_load_dwordx4 v224, s[72:75], s71 offen nt lds
    s_add_u32 m0, s79, 9216
    s_add_u32 s71, s71, s92
    buffer_load_dwordx4 v224, s[72:75], s71 offen nt lds
    s_add_u32 m0, s79, 10240
    s_add_u32 s71, s71, s92
    buffer_load_dwordx4 v224, s[72:75], s71 offen nt lds
    s_add_u32 m0, s79, 11264
    s_add_u32 s71, s71, s92
    buffer_load_dwordx4 v224, s[72:75], s71 offen nt lds
    s_mul_i32 s68, s40, 1990656
    s_add_u32 s68, s68, 3145728
    s_mul_i32 s6, s52, 349526
    s_lshr_b32 s6, s6, 20
    s_mul_i32 s7, s6, 3
    s_sub_u32 s7, s52, s7
    s_mul_i32 s6, s6, 6
    s_add_u32 s7, s7, s6
    s_mul_i32 s6, s53, 36
    s_add_u32 s7, s7, s6
    s_mul_i32 s6, s93, 3
    s_add_u32 s7, s7, s6
    s_mul_i32 s6, s53, 18
    s_add_u32 s6, s6, s52
    s_add_u32 s6, s6, 324
    s_cmp_eq_u32 s93, 2
    s_cselect_b32 s7, s6, s7
    s_lshl_b32 s7, s7, 10
    s_add_u32 s94, s7, s68
    s_mul_i32 s6, s54, 349526
    s_lshr_b32 s6, s6, 20
    s_mul_i32 s7, s6, 3
    s_sub_u32 s7, s54, s7
    s_mul_i32 s6, s6, 6
    s_add_u32 s7, s7, s6
    s_mul_i32 s6, s55, 36
    s_add_u32 s7, s7, s6
    s_mul_i32 s6, s93, 3
    s_add_u32 s7, s7, s6
    s_mul_i32 s6, s55, 18
    s_add_u32 s6, s6, s54
    s_add_u32 s6, s6, 324
    s_cmp_eq_u32 s93, 2
    s_cselect_b32 s7, s6, s7
    s_lshl_b32 s7, s7, 10
    s_add_u32 s95, s7, s68
    s_mul_i32 s6, s56, 349526
    s_lshr_b32 s6, s6, 20
    s_mul_i32 s7, s6, 3
    s_sub_u32 s7, s56, s7
    s_mul_i32 s6, s6, 6
    s_add_u32 s7, s7, s6
    s_mul_i32 s6, s57, 36
    s_add_u32 s7, s7, s6
    s_mul_i32 s6, s93, 3
    s_add_u32 s7, s7, s6
    s_mul_i32 s6, s57, 18
    s_add_u32 s6, s6, s56
    s_add_u32 s6, s6, 324
    s_cmp_eq_u32 s93, 2
    s_cselect_b32 s7, s6, s7
    s_lshl_b32 s7, s7, 10
    s_add_u32 s85, s7, s68
    s_mul_i32 s6, s58, 349526
    s_lshr_b32 s6, s6, 20
    s_mul_i32 s7, s6, 3
    s_sub_u32 s7, s58, s7
    s_mul_i32 s6, s6, 6
    s_add_u32 s7, s7, s6
    s_mul_i32 s6, s59, 36
    s_add_u32 s7, s7, s6
    s_mul_i32 s6, s93, 3
    s_add_u32 s7, s7, s6
    s_mul_i32 s6, s59, 18
    s_add_u32 s6, s6, s58
    s_add_u32 s6, s6, 324
    s_cmp_eq_u32 s93, 2
    s_cselect_b32 s7, s6, s7
    s_lshl_b32 s7, s7, 10
    s_add_u32 s78, s7, s68
    s_mul_i32 s6, s60, 349526
    s_lshr_b32 s6, s6, 20
    s_mul_i32 s7, s6, 3
    s_sub_u32 s7, s60, s7
    s_mul_i32 s6, s6, 6
    s_add_u32 s7, s7, s6
    s_mul_i32 s6, s61, 36
    s_add_u32 s7, s7, s6
    s_mul_i32 s6, s93, 3
    s_add_u32 s7, s7, s6
    s_mul_i32 s6, s61, 18
    s_add_u32 s6, s6, s60
    s_add_u32 s6, s6, 324
    s_cmp_eq_u32 s93, 2
    s_cselect_b32 s7, s6, s7
    s_lshl_b32 s7, s7, 10
    s_add_u32 s70, s7, s68
    s_waitcnt vmcnt(12)
    s_branch L_raw_10
L_raw_9:
    s_mul_i32 s68, s40, 1990656
    s_add_u32 s68, s68, 3145728
    s_mul_i32 s6, s52, 349526
    s_lshr_b32 s6, s6, 20
    s_mul_i32 s7, s6, 3
    s_sub_u32 s7, s52, s7
    s_mul_i32 s6, s6, 6
    s_add_u32 s7, s7, s6
    s_mul_i32 s6, s53, 36
    s_add_u32 s7, s7, s6
    s_mul_i32 s6, s93, 3
    s_add_u32 s7, s7, s6
    s_mul_i32 s6, s53, 18
    s_add_u32 s6, s6, s52
    s_add_u32 s6, s6, 324
    s_cmp_eq_u32 s93, 2
    s_cselect_b32 s7, s6, s7
    s_lshl_b32 s7, s7, 10
    s_add_u32 s94, s7, s68
    s_mul_i32 s6, s54, 349526
    s_lshr_b32 s6, s6, 20
    s_mul_i32 s7, s6, 3
    s_sub_u32 s7, s54, s7
    s_mul_i32 s6, s6, 6
    s_add_u32 s7, s7, s6
    s_mul_i32 s6, s55, 36
    s_add_u32 s7, s7, s6
    s_mul_i32 s6, s93, 3
    s_add_u32 s7, s7, s6
    s_mul_i32 s6, s55, 18
    s_add_u32 s6, s6, s54
    s_add_u32 s6, s6, 324
    s_cmp_eq_u32 s93, 2
    s_cselect_b32 s7, s6, s7
    s_lshl_b32 s7, s7, 10
    s_add_u32 s95, s7, s68
    s_mul_i32 s6, s56, 349526
    s_lshr_b32 s6, s6, 20
    s_mul_i32 s7, s6, 3
    s_sub_u32 s7, s56, s7
    s_mul_i32 s6, s6, 6
    s_add_u32 s7, s7, s6
    s_mul_i32 s6, s57, 36
    s_add_u32 s7, s7, s6
    s_mul_i32 s6, s93, 3
    s_add_u32 s7, s7, s6
    s_mul_i32 s6, s57, 18
    s_add_u32 s6, s6, s56
    s_add_u32 s6, s6, 324
    s_cmp_eq_u32 s93, 2
    s_cselect_b32 s7, s6, s7
    s_lshl_b32 s7, s7, 10
    s_add_u32 s85, s7, s68
    s_mul_i32 s6, s58, 349526
    s_lshr_b32 s6, s6, 20
    s_mul_i32 s7, s6, 3
    s_sub_u32 s7, s58, s7
    s_mul_i32 s6, s6, 6
    s_add_u32 s7, s7, s6
    s_mul_i32 s6, s59, 36
    s_add_u32 s7, s7, s6
    s_mul_i32 s6, s93, 3
    s_add_u32 s7, s7, s6
    s_mul_i32 s6, s59, 18
    s_add_u32 s6, s6, s58
    s_add_u32 s6, s6, 324
    s_cmp_eq_u32 s93, 2
    s_cselect_b32 s7, s6, s7
    s_lshl_b32 s7, s7, 10
    s_add_u32 s78, s7, s68
    s_mul_i32 s6, s60, 349526
    s_lshr_b32 s6, s6, 20
    s_mul_i32 s7, s6, 3
    s_sub_u32 s7, s60, s7
    s_mul_i32 s6, s6, 6
    s_add_u32 s7, s7, s6
    s_mul_i32 s6, s61, 36
    s_add_u32 s7, s7, s6
    s_mul_i32 s6, s93, 3
    s_add_u32 s7, s7, s6
    s_mul_i32 s6, s61, 18
    s_add_u32 s6, s6, s60
    s_add_u32 s6, s6, 324
    s_cmp_eq_u32 s93, 2
    s_cselect_b32 s7, s6, s7
    s_lshl_b32 s7, s7, 10
    s_add_u32 s70, s7, s68
    s_waitcnt vmcnt(4)
L_raw_10:
    s_barrier
    s_cmp_ge_u32 s32, 18
    s_cbranch_scc1 L_prep_o_4
    s_mul_i32 s7, s3, 36
    s_add_u32 s7, s7, s46
    v_lshrrev_b32 v8, 4, v0
    v_lshlrev_b32 v8, 11, v8
    v_add_u32 v8, s7, v8
    v_and_b32 v9, 15, v0
    v_cmp_gt_u32 s[22:23], 6, v9
    v_lshrrev_b32 v10, 1, v9
    v_min_u32 v10, 2, v10
    v_lshl_add_u32 v10, v10, 13, v8
    v_and_b32 v11, 1, v0
    v_lshl_add_u32 v10, v11, 1, v10
    v_lshl_add_u32 v8, v9, 1, v8
    ds_read_u16 v136, v8 offset:8192
    ds_read_u16 v137, v8 offset:8448
    ds_read_u16 v138, v8 offset:8704
    ds_read_u16 v139, v8 offset:8960
    ds_read_u16 v140, v8 offset:9216
    ds_read_u16 v141, v8 offset:9472
    ds_read_u16 v142, v8 offset:9728
    ds_read_u16 v143, v8 offset:9984
    s_lshl_b32 s33, s40, 2
    s_add_u32 s33, s33, s3
    s_mul_i32 s33, s33, 18
    s_add_u32 s33, s33, s32
    s_lshl_b32 s33, s33, 12
    ds_read_u16 v144, v8 offset:16384
    ds_read_u16 v145, v8 offset:16640
    ds_read_u16 v146, v8 offset:16896
    ds_read_u16 v147, v8 offset:17152
    ds_read_u16 v148, v8 offset:17408
    ds_read_u16 v149, v8 offset:17664
    ds_read_u16 v150, v8 offset:17920
    ds_read_u16 v151, v8 offset:18176
    s_waitcnt lgkmcnt(8)
    v_lshl_or_b32 v32, v137, 16, v136
    v_lshl_or_b32 v33, v139, 16, v138
    v_lshl_or_b32 v34, v141, 16, v140
    v_lshl_or_b32 v35, v143, 16, v142
    buffer_store_dwordx4 v[32:35], v253, s[8:11], s33 offen offset:0 sc1
    ds_read_u16 v152, v8 offset:24576
    ds_read_u16 v153, v8 offset:24832
    ds_read_u16 v154, v8 offset:25088
    ds_read_u16 v155, v8 offset:25344
    ds_read_u16 v156, v8 offset:25600
    ds_read_u16 v157, v8 offset:25856
    ds_read_u16 v158, v8 offset:26112
    ds_read_u16 v159, v8 offset:26368
    s_waitcnt lgkmcnt(8)
    v_lshl_or_b32 v36, v145, 16, v144
    v_lshl_or_b32 v37, v147, 16, v146
    v_lshl_or_b32 v38, v149, 16, v148
    v_lshl_or_b32 v39, v151, 16, v150
    buffer_store_dwordx4 v[36:39], v253, s[8:11], s33 offen offset:1024 sc1
    ds_read_u16 v160, v10 offset:8224
    ds_read_u16 v161, v10 offset:8480
    ds_read_u16 v162, v10 offset:8736
    ds_read_u16 v163, v10 offset:8992
    ds_read_u16 v164, v10 offset:9248
    ds_read_u16 v165, v10 offset:9504
    ds_read_u16 v166, v10 offset:9760
    ds_read_u16 v167, v10 offset:10016
    s_waitcnt lgkmcnt(8)
    v_lshl_or_b32 v40, v153, 16, v152
    v_lshl_or_b32 v41, v155, 16, v154
    v_lshl_or_b32 v42, v157, 16, v156
    v_lshl_or_b32 v43, v159, 16, v158
    buffer_store_dwordx4 v[40:43], v253, s[8:11], s33 offen offset:2048 sc1
    s_waitcnt lgkmcnt(0)
    v_lshl_or_b32 v44, v161, 16, v160
    v_cndmask_b32 v44, 0, v44, s[22:23]
    v_lshl_or_b32 v45, v163, 16, v162
    v_cndmask_b32 v45, 0, v45, s[22:23]
    v_lshl_or_b32 v46, v165, 16, v164
    v_cndmask_b32 v46, 0, v46, s[22:23]
    v_lshl_or_b32 v47, v167, 16, v166
    v_cndmask_b32 v47, 0, v47, s[22:23]
    buffer_store_dwordx4 v[44:47], v253, s[8:11], s33 offen offset:3072 sc1
    s_branch L_prep_done_6
L_prep_o_4:
    s_cmp_ge_u32 s36, 54
    s_cbranch_scc1 L_prep_m_5
    v_lshrrev_b32 v8, 4, v0
    v_lshlrev_b32 v8, 3, v8
    v_bfe_u32 v9, v0, 2, 2
    v_add_u32 v8, v8, v9
    v_mul_u32_u24 v8, 128, v8
    v_and_b32 v9, 3, v0
    v_lshl_add_u32 v8, v9, 3, v8
    s_lshl_b32 s7, s3, 5
    v_add_u32 v8, s7, v8
    ds_read_b64_tr_b16 v[32:33], v8 offset:8192
    ds_read_b64_tr_b16 v[34:35], v8 offset:8704
    ds_read_b64_tr_b16 v[36:37], v8 offset:12288
    ds_read_b64_tr_b16 v[38:39], v8 offset:12800
    ds_read_b64_tr_b16 v[40:41], v8 offset:16384
    ds_read_b64_tr_b16 v[42:43], v8 offset:16896
    s_mul_i32 s34, s34, 12
    s_add_u32 s34, s34, s3
    s_mul_i32 s34, s34, 18
    s_add_u32 s34, s34, s33
    s_lshl_b32 s34, s34, 10
    s_add_u32 s7, s34, 2359296
    s_waitcnt lgkmcnt(4)
    buffer_store_dwordx4 v[32:35], v253, s[8:11], s7 offen sc1
    s_add_u32 s7, s34, 2433024
    s_waitcnt lgkmcnt(2)
    buffer_store_dwordx4 v[36:39], v253, s[8:11], s7 offen sc1
    s_add_u32 s7, s34, 2506752
    s_waitcnt lgkmcnt(0)
    buffer_store_dwordx4 v[40:43], v253, s[8:11], s7 offen sc1
    s_branch L_prep_done_6
L_prep_m_5:
    s_cmp_ge_u32 s37, 36
    s_cbranch_scc1 L_prep_done_6
    v_mov_b32 v28, 0x3f803f80
    v_mov_b32 v29, 0x3f803f80
    v_mov_b32 v30, 0x3f803f80
    v_mov_b32 v31, 0x3f803f80
    v_and_b32 v9, 15, v0
    v_cmp_eq_u32 vcc, 0, v9
    v_cmp_eq_u32 s[22:23], 1, v9
    v_mfma_f32_16x16x32_bf16 v[32:35], v[64:67], v[28:31], 0
    v_mfma_f32_16x16x32_bf16 v[32:35], v[68:71], v[28:31], v[32:35]
    v_mfma_f32_16x16x32_bf16 v[32:35], v[72:75], v[28:31], v[32:35]
    v_mfma_f32_16x16x32_bf16 v[32:35], v[76:79], v[28:31], v[32:35]
    v_mfma_f32_16x16x32_bf16 v[32:35], v[80:83], v[28:31], v[32:35]
    v_mfma_f32_16x16x32_bf16 v[32:35], v[84:87], v[28:31], v[32:35]
    v_mfma_f32_16x16x32_bf16 v[32:35], v[88:91], v[28:31], v[32:35]
    v_mfma_f32_16x16x32_bf16 v[32:35], v[92:95], v[28:31], v[32:35]
    v_mfma_f32_16x16x32_bf16 v[32:35], v[96:99], v[28:31], v[32:35]
    v_mfma_f32_16x16x32_bf16 v[32:35], v[100:103], v[28:31], v[32:35]
    v_mfma_f32_16x16x32_bf16 v[32:35], v[104:107], v[28:31], v[32:35]
    v_mfma_f32_16x16x32_bf16 v[32:35], v[108:111], v[28:31], v[32:35]
    v_mfma_f32_16x16x32_bf16 v[32:35], v[112:115], v[28:31], v[32:35]
    v_mfma_f32_16x16x32_bf16 v[32:35], v[116:119], v[28:31], v[32:35]
    v_mfma_f32_16x16x32_bf16 v[32:35], v[120:123], v[28:31], v[32:35]
    v_mfma_f32_16x16x32_bf16 v[32:35], v[124:127], v[28:31], v[32:35]
    v_mfma_f32_16x16x32_bf16 v[32:35], v[128:131], v[28:31], v[32:35]
    v_mfma_f32_16x16x32_bf16 v[32:35], v[132:135], v[28:31], v[32:35]
    v_lshrrev_b32 v10, 5, v0
    v_lshlrev_b32 v10, 8, v10
    v_lshl_add_u32 v10, v9, 4, v10
    v_bfe_u32 v9, v0, 4, 1
    v_lshl_add_u32 v10, v9, 3, v10
    s_lshl_b32 s7, s37, 9
    s_add_u32 s7, s7, 3022848
    s_nop 0
    v_mul_f32 v32, 0x3ae38e39, v32
    v_mul_f32 v33, 0x3ae38e39, v33
    v_mul_f32 v34, 0x3ae38e39, v34
    v_mul_f32 v35, 0x3ae38e39, v35
    v_cvt_pk_bf16_f32 v36, v32, v33
    v_cvt_pk_bf16_f32 v37, v34, v35
    v_lshlrev_b32 v38, 16, v36
    v_and_b32 v39, s16, v36
    v_sub_f32 v38, v32, v38
    v_sub_f32 v39, v33, v39
    v_cvt_pk_bf16_f32 v28, v38, v39
    v_cndmask_b32 v28, 0, v28, s[22:23]
    v_cndmask_b32 v28, v28, v36, vcc
    v_lshlrev_b32 v38, 16, v37
    v_and_b32 v39, s16, v37
    v_sub_f32 v38, v34, v38
    v_sub_f32 v39, v35, v39
    v_cvt_pk_bf16_f32 v29, v38, v39
    v_cndmask_b32 v29, 0, v29, s[22:23]
    v_cndmask_b32 v29, v29, v37, vcc
    buffer_store_dwordx2 v[28:29], v10, s[8:11], s7 offen sc1
L_prep_done_6:
    s_add_u32 s19, s18, 43515904
    s_add_u32 s20, s18, 38797312
    s_lshl_b32 s22, s21, 7
    s_add_u32 s22, s22, 48234496
    buffer_store_dwordx4 v[16:19], v172, s[8:11], s19 offen sc1
    buffer_store_dwordx4 v[20:23], v173, s[8:11], s19 offen sc1
    buffer_store_dwordx4 v[24:27], v174, s[8:11], s19 offen sc1
    s_mov_b32 s17, 0x3f803f80
    v_mov_b32 v8, 0
    v_mov_b32 v9, 0
    v_mov_b32 v10, 0
    v_mov_b32 v11, 0
    v_dot2c_f32_bf16 v8, s17, v16
    v_dot2c_f32_bf16 v9, v16, v16
    v_dot2c_f32_bf16 v10, s17, v17
    v_dot2c_f32_bf16 v11, v17, v17
    v_dot2c_f32_bf16 v8, s17, v18
    v_dot2c_f32_bf16 v9, v18, v18
    v_dot2c_f32_bf16 v10, s17, v19
    v_dot2c_f32_bf16 v11, v19, v19
    v_dot2c_f32_bf16 v8, s17, v20
    v_dot2c_f32_bf16 v9, v20, v20
    v_dot2c_f32_bf16 v10, s17, v21
    v_dot2c_f32_bf16 v11, v21, v21
    v_dot2c_f32_bf16 v8, s17, v22
    v_dot2c_f32_bf16 v9, v22, v22
    v_dot2c_f32_bf16 v10, s17, v23
    v_dot2c_f32_bf16 v11, v23, v23
    v_dot2c_f32_bf16 v8, s17, v24
    v_dot2c_f32_bf16 v9, v24, v24
    v_dot2c_f32_bf16 v10, s17, v25
    v_dot2c_f32_bf16 v11, v25, v25
    v_dot2c_f32_bf16 v8, s17, v26
    v_dot2c_f32_bf16 v9, v26, v26
    v_dot2c_f32_bf16 v10, s17, v27
    v_dot2c_f32_bf16 v11, v27, v27
    v_and_b32 v12, 7, v0
    v_lshlrev_b32 v12, 3, v12
    s_lshl_b32 s7, s3, 6
    v_add_u32 v13, s7, v12
    v_pk_add_f32 v[8:9], v[8:9], v[10:11]
    s_nop 1
    v_add_f32_dpp v8, v8, v8 row_ror:8 row_mask:0xf bank_mask:0xf
    v_add_f32_dpp v9, v9, v9 row_ror:8 row_mask:0xf bank_mask:0xf
    v_mov_b32 v10, v8
    v_mov_b32 v11, v9
    s_nop 1
    v_permlane32_swap_b32 v10, v8
    v_permlane32_swap_b32 v11, v9
    v_add_f32 v8, v8, v10
    v_add_f32 v9, v9, v11
    v_mov_b32 v10, v8
    v_mov_b32 v11, v9
    s_nop 1
    v_permlane16_swap_b32 v10, v8
    v_permlane16_swap_b32 v11, v9
    v_add_f32 v8, v8, v10
    v_add_f32 v9, v9, v11
    ds_write_b64 v13, v[8:9]
    s_waitcnt lgkmcnt(0)
    s_barrier
    ds_read_b64 v[40:41], v12 offset:0
    ds_read_b64 v[42:43], v12 offset:64
    ds_read_b64 v[44:45], v12 offset:128
    ds_read_b64 v[46:47], v12 offset:192
    s_waitcnt lgkmcnt(0)
    v_pk_add_f32 v[40:41], v[40:41], v[42:43]
    v_pk_add_f32 v[44:45], v[44:45], v[46:47]
    v_pk_add_f32 v[8:9], v[40:41], v[44:45]
    v_mul_f32 v8, 0x3ae38e39, v8
    v_mul_f32 v9, 0x3ae38e39, v9
    v_fma_f32 v9, -v8, v8, v9
    v_max_f32 v9, 0, v9
    v_add_f32 v9, 0x3727c5ac, v9
    v_rsq_f32 v10, v9
    s_nop 0
    v_mul_f32 v12, v8, v10
    v_mov_b32 v11, v10
    v_sub_f32 v12, 0, v12
    v_mov_b32 v13, v12
    s_cmp_eq_u32 s3, 0
    s_cselect_b32 s7, 32, 0
    v_lshlrev_b32 v14, 2, v0
    v_cmp_gt_u32 vcc, s7, v0
    v_mov_b32 v9, 1073741824
    s_nop 0
    v_cndmask_b32 v14, v9, v14, vcc
    buffer_store_dword v8, v14, s[8:11], s22 offen sc1
    v_lshlrev_b32 v40, 16, v16
    v_and_b32 v41, s16, v16
    v_lshlrev_b32 v42, 16, v17
    v_and_b32 v43, s16, v17
    v_lshlrev_b32 v44, 16, v18
    v_and_b32 v45, s16, v18
    v_lshlrev_b32 v46, 16, v19
    v_and_b32 v47, s16, v19
    v_pk_fma_f32 v[40:41], v[40:41], v[10:11], v[12:13]
    v_pk_fma_f32 v[42:43], v[42:43], v[10:11], v[12:13]
    v_pk_fma_f32 v[44:45], v[44:45], v[10:11], v[12:13]
    v_pk_fma_f32 v[46:47], v[46:47], v[10:11], v[12:13]
    v_cvt_pk_bf16_f32 v48, v40, v41
    v_cvt_pk_bf16_f32 v49, v42, v43
    v_cvt_pk_bf16_f32 v50, v44, v45
    v_cvt_pk_bf16_f32 v51, v46, v47
    v_lshlrev_b32 v40, 16, v20
    v_and_b32 v41, s16, v20
    v_lshlrev_b32 v42, 16, v21
    v_and_b32 v43, s16, v21
    v_lshlrev_b32 v44, 16, v22
    v_and_b32 v45, s16, v22
    v_lshlrev_b32 v46, 16, v23
    v_and_b32 v47, s16, v23
    v_pk_fma_f32 v[40:41], v[40:41], v[10:11], v[12:13]
    v_pk_fma_f32 v[42:43], v[42:43], v[10:11], v[12:13]
    v_pk_fma_f32 v[44:45], v[44:45], v[10:11], v[12:13]
    v_pk_fma_f32 v[46:47], v[46:47], v[10:11], v[12:13]
    v_cvt_pk_bf16_f32 v52, v40, v41
    v_cvt_pk_bf16_f32 v53, v42, v43
    v_cvt_pk_bf16_f32 v54, v44, v45
    v_cvt_pk_bf16_f32 v55, v46, v47
    v_lshlrev_b32 v40, 16, v24
    v_and_b32 v41, s16, v24
    v_lshlrev_b32 v42, 16, v25
    v_and_b32 v43, s16, v25
    v_lshlrev_b32 v44, 16, v26
    v_and_b32 v45, s16, v26
    v_lshlrev_b32 v46, 16, v27
    v_and_b32 v47, s16, v27
    v_pk_fma_f32 v[40:41], v[40:41], v[10:11], v[12:13]
    v_pk_fma_f32 v[42:43], v[42:43], v[10:11], v[12:13]
    v_pk_fma_f32 v[44:45], v[44:45], v[10:11], v[12:13]
    v_pk_fma_f32 v[46:47], v[46:47], v[10:11], v[12:13]
    v_cvt_pk_bf16_f32 v56, v40, v41
    v_cvt_pk_bf16_f32 v57, v42, v43
    v_cvt_pk_bf16_f32 v58, v44, v45
    v_cvt_pk_bf16_f32 v59, v46, v47
    buffer_store_dwordx4 v[48:51], v172, s[8:11], s20 offen sc1
    buffer_store_dwordx4 v[52:55], v173, s[8:11], s20 offen sc1
    buffer_store_dwordx4 v[56:59], v174, s[8:11], s20 offen sc1
    v_lshlrev_b32 v15, 7, v0
    s_lshl_b32 s6, s40, 2
    s_add_u32 s6, s6, s44
    s_sub_u32 s6, s6, 32768
    v_mov_b32 v1, s76
    s_mov_b64 vcc, 0xff
    v_lshrrev_b32 v14, 3, v0
    v_lshl_add_u32 v15, v14, 3, v15
    s_cmp_ge_u32 s40, 6
    s_cselect_b32 s7, s41, 31
    s_cmp_lt_u32 s7, 31
    s_cmov_b64 vcc, 0xffff
    s_waitcnt vmcnt(0)
    s_barrier
    s_cmp_lg_u32 s3, 0
    s_cbranch_scc1 L_pub_11
    s_mov_b64 exec, vcc
    buffer_store_dword v1, v15, s[8:11], s6 offen sc1
    s_lshl_b32 s6, s40, 7
    s_lshl_b32 s7, s32, 2
    s_add_u32 s6, s6, s7
    s_add_u32 s6, s6, 19431424
    s_mov_b64 exec, 0xffffffff
    v_lshlrev_b32 v15, 10, v0
    v_mov_b32 v1, s76
    buffer_store_dword v1, v15, s[8:11], s6 offen sc1
    s_cmp_lt_u32 s32, 18
    s_cbranch_scc1 L_pub_11
    s_lshl_b32 s6, s36, 2
    s_add_u32 s6, s6, 19496960
    s_mov_b64 exec, 1
    buffer_store_dword v1, off, s[8:11], s6 sc1
L_pub_11:
    s_mov_b64 exec, -1
    s_cmp_lt_u32 s32, 18
    s_cbranch_scc1 L_raw_12
    s_cmp_eq_u32 s93, 2
    s_cselect_b32 s6, 2, 3
    s_mov_b32 s7, 512
    s_cmov_b32 s7, 2048
    v_lshrrev_b32 v14, 4, v0
    v_lshlrev_b32 v14, s6, v14
    v_bfe_u32 v15, v0, 2, 2
    v_add_u32 v14, v14, v15
    v_mul_u32_u24 v14, 128, v14
    v_and_b32 v15, 3, v0
    v_lshl_add_u32 v14, v15, 3, v14
    v_add_u32 v14, s79, v14
    v_add_u32 v15, s7, v14
    ds_read_b64_tr_b16 v[64:65], v14 offset:0
    ds_read_b64_tr_b16 v[66:67], v15 offset:0
    ds_read_b64_tr_b16 v[68:69], v14 offset:32
    ds_read_b64_tr_b16 v[70:71], v15 offset:32
    ds_read_b64_tr_b16 v[72:73], v14 offset:64
    ds_read_b64_tr_b16 v[74:75], v15 offset:64
    ds_read_b64_tr_b16 v[76:77], v14 offset:96
    ds_read_b64_tr_b16 v[78:79], v15 offset:96
    ds_read_b64_tr_b16 v[80:81], v14 offset:4096
    ds_read_b64_tr_b16 v[82:83], v15 offset:4096
    ds_read_b64_tr_b16 v[84:85], v14 offset:4128
    ds_read_b64_tr_b16 v[86:87], v15 offset:4128
    ds_read_b64_tr_b16 v[88:89], v14 offset:4160
    ds_read_b64_tr_b16 v[90:91], v15 offset:4160
    ds_read_b64_tr_b16 v[92:93], v14 offset:4192
    ds_read_b64_tr_b16 v[94:95], v15 offset:4192
    ds_read_b64_tr_b16 v[96:97], v14 offset:8192
    ds_read_b64_tr_b16 v[98:99], v15 offset:8192
    ds_read_b64_tr_b16 v[100:101], v14 offset:8224
    ds_read_b64_tr_b16 v[102:103], v15 offset:8224
    ds_read_b64_tr_b16 v[104:105], v14 offset:8256
    ds_read_b64_tr_b16 v[106:107], v15 offset:8256
    ds_read_b64_tr_b16 v[108:109], v14 offset:8288
    ds_read_b64_tr_b16 v[110:111], v15 offset:8288
    s_waitcnt lgkmcnt(0)
    s_add_u32 m0, s79, 8192
    s_mov_b32 s71, s83
    buffer_load_dwordx4 v224, s[72:75], s71 offen nt lds
    s_add_u32 m0, s79, 9216
    s_add_u32 s71, s71, s92
    buffer_load_dwordx4 v224, s[72:75], s71 offen nt lds
    s_add_u32 m0, s79, 10240
    s_add_u32 s71, s71, s92
    buffer_load_dwordx4 v224, s[72:75], s71 offen nt lds
    s_add_u32 m0, s79, 11264
    s_add_u32 s71, s71, s92
    buffer_load_dwordx4 v224, s[72:75], s71 offen nt lds
    s_add_u32 m0, s79, 12288
    s_mov_b32 s71, s84
    buffer_load_dwordx4 v224, s[72:75], s71 offen nt lds
    s_add_u32 m0, s79, 13312
    s_add_u32 s71, s71, s92
    buffer_load_dwordx4 v224, s[72:75], s71 offen nt lds
    s_add_u32 m0, s79, 14336
    s_add_u32 s71, s71, s92
    buffer_load_dwordx4 v224, s[72:75], s71 offen nt lds
    s_add_u32 m0, s79, 15360
    s_add_u32 s71, s71, s92
    buffer_load_dwordx4 v224, s[72:75], s71 offen nt lds
    s_add_u32 s7, s94, 0
    buffer_store_dwordx4 v[64:67], v253, s[8:11], s7 offen sc1
    s_add_u32 s7, s94, 497664
    buffer_store_dwordx4 v[68:71], v253, s[8:11], s7 offen sc1
    s_add_u32 s7, s94, 995328
    buffer_store_dwordx4 v[72:75], v253, s[8:11], s7 offen sc1
    s_add_u32 s7, s94, 1492992
    buffer_store_dwordx4 v[76:79], v253, s[8:11], s7 offen sc1
    s_add_u32 s7, s95, 0
    buffer_store_dwordx4 v[80:83], v253, s[8:11], s7 offen sc1
    s_add_u32 s7, s95, 497664
    buffer_store_dwordx4 v[84:87], v253, s[8:11], s7 offen sc1
    s_add_u32 s7, s95, 995328
    buffer_store_dwordx4 v[88:91], v253, s[8:11], s7 offen sc1
    s_add_u32 s7, s95, 1492992
    buffer_store_dwordx4 v[92:95], v253, s[8:11], s7 offen sc1
    s_add_u32 s7, s85, 0
    buffer_store_dwordx4 v[96:99], v253, s[8:11], s7 offen sc1
    s_add_u32 s7, s85, 497664
    buffer_store_dwordx4 v[100:103], v253, s[8:11], s7 offen sc1
    s_add_u32 s7, s85, 995328
    buffer_store_dwordx4 v[104:107], v253, s[8:11], s7 offen sc1
    s_add_u32 s7, s85, 1492992
    buffer_store_dwordx4 v[108:111], v253, s[8:11], s7 offen sc1
    s_branch L_raw_13
L_raw_12:
    s_cmp_eq_u32 s93, 2
    s_cselect_b32 s6, 2, 3
    s_mov_b32 s7, 512
    s_cmov_b32 s7, 2048
    v_lshrrev_b32 v14, 4, v0
    v_lshlrev_b32 v14, s6, v14
    v_bfe_u32 v15, v0, 2, 2
    v_add_u32 v14, v14, v15
    v_mul_u32_u24 v14, 128, v14
    v_and_b32 v15, 3, v0
    v_lshl_add_u32 v14, v15, 3, v14
    v_add_u32 v14, s79, v14
    v_add_u32 v15, s7, v14
    ds_read_b64_tr_b16 v[64:65], v14 offset:0
    ds_read_b64_tr_b16 v[66:67], v15 offset:0
    ds_read_b64_tr_b16 v[68:69], v14 offset:32
    ds_read_b64_tr_b16 v[70:71], v15 offset:32
    ds_read_b64_tr_b16 v[72:73], v14 offset:64
    ds_read_b64_tr_b16 v[74:75], v15 offset:64
    ds_read_b64_tr_b16 v[76:77], v14 offset:96
    ds_read_b64_tr_b16 v[78:79], v15 offset:96
    s_waitcnt lgkmcnt(0)
    s_add_u32 m0, s79, 8192
    s_mov_b32 s71, s83
    buffer_load_dwordx4 v224, s[72:75], s71 offen nt lds
    s_add_u32 m0, s79, 9216
    s_add_u32 s71, s71, s92
    buffer_load_dwordx4 v224, s[72:75], s71 offen nt lds
    s_add_u32 m0, s79, 10240
    s_add_u32 s71, s71, s92
    buffer_load_dwordx4 v224, s[72:75], s71 offen nt lds
    s_add_u32 m0, s79, 11264
    s_add_u32 s71, s71, s92
    buffer_load_dwordx4 v224, s[72:75], s71 offen nt lds
    s_add_u32 m0, s79, 12288
    s_mov_b32 s71, s84
    buffer_load_dwordx4 v224, s[72:75], s71 offen nt lds
    s_add_u32 m0, s79, 13312
    s_add_u32 s71, s71, s92
    buffer_load_dwordx4 v224, s[72:75], s71 offen nt lds
    s_add_u32 m0, s79, 14336
    s_add_u32 s71, s71, s92
    buffer_load_dwordx4 v224, s[72:75], s71 offen nt lds
    s_add_u32 m0, s79, 15360
    s_add_u32 s71, s71, s92
    buffer_load_dwordx4 v224, s[72:75], s71 offen nt lds
    s_add_u32 s7, s94, 0
    buffer_store_dwordx4 v[64:67], v253, s[8:11], s7 offen sc1
    s_add_u32 s7, s94, 497664
    buffer_store_dwordx4 v[68:71], v253, s[8:11], s7 offen sc1
    s_add_u32 s7, s94, 995328
    buffer_store_dwordx4 v[72:75], v253, s[8:11], s7 offen sc1
    s_add_u32 s7, s94, 1492992
    buffer_store_dwordx4 v[76:79], v253, s[8:11], s7 offen sc1
L_raw_13:
    s_cmp_lg_u32 s3, 0
    s_cbranch_scc1 L_wq_ready_14
    s_lshl_b32 s7, s41, 3
    s_add_u32 s7, s7, s40
    s_lshl_b32 s7, s7, 7
    s_add_u32 s7, s7, 19431424
    s_add_u32 s68, s4, s7
    s_addc_u32 s69, s5, 0
    s_mov_b32 s6, 0
    s_mov_b32 s7, 0
L_cpoll_15:
    s_load_dwordx16 s[52:67], s[68:69], s7 glc
    s_add_u32 s6, s6, 1
    s_waitcnt lgkmcnt(0)
    s_xor_b64 s[52:53], s[52:53], s[76:77]
    s_xor_b64 s[54:55], s[54:55], s[76:77]
    s_xor_b64 s[56:57], s[56:57], s[76:77]
    s_xor_b64 s[58:59], s[58:59], s[76:77]
    s_xor_b64 s[60:61], s[60:61], s[76:77]
    s_xor_b64 s[62:63], s[62:63], s[76:77]
    s_xor_b64 s[64:65], s[64:65], s[76:77]
    s_xor_b64 s[66:67], s[66:67], s[76:77]
    s_or_b64 s[52:53], s[52:53], s[60:61]
    s_or_b64 s[54:55], s[54:55], s[62:63]
    s_or_b64 s[56:57], s[56:57], s[64:65]
    s_or_b64 s[58:59], s[58:59], s[66:67]
    s_or_b64 s[52:53], s[52:53], s[56:57]
    s_or_b64 s[54:55], s[54:55], s[58:59]
    s_or_b64 s[52:53], s[52:53], s[54:55]
    s_cbranch_scc1 L_cpoll_16
    s_add_u32 s7, s7, 8
    s_cmp_eq_u32 s7, 16
    s_cbranch_scc1 L_cpolled_17
L_cpoll_16:
    s_cmp_lt_u32 s6, 1048576
    s_cbranch_scc1 L_cpoll_15
    s_branch L_main_end
L_cpolled_17:
L_wq_ready_14:
    s_barrier
    s_lshl_b32 s28, s40, 2
    s_add_u32 s28, s28, s3
    s_mul_i32 s28, s28, 73728
    v_and_b32 v229, 8, v0
    v_lshl_add_u32 v229, v229, 27, v253
    buffer_load_dwordx4 a[0:3], v253, s[8:11], s28 offen offset:0 sc1
    buffer_load_dwordx4 a[4:7], v253, s[8:11], s28 offen offset:1024 sc1
    buffer_load_dwordx4 a[8:11], v253, s[8:11], s28 offen offset:2048 sc1
    buffer_load_dwordx4 a[12:15], v229, s[8:11], s28 offen offset:3072 sc1
    s_add_u32 s28, s28, 4096
    buffer_load_dwordx4 a[16:19], v253, s[8:11], s28 offen offset:0 sc1
    buffer_load_dwordx4 a[20:23], v253, s[8:11], s28 offen offset:1024 sc1
    buffer_load_dwordx4 a[24:27], v253, s[8:11], s28 offen offset:2048 sc1
    buffer_load_dwordx4 a[28:31], v229, s[8:11], s28 offen offset:3072 sc1
    s_add_u32 s28, s28, 4096
    buffer_load_dwordx4 a[32:35], v253, s[8:11], s28 offen offset:0 sc1
    buffer_load_dwordx4 a[36:39], v253, s[8:11], s28 offen offset:1024 sc1
    buffer_load_dwordx4 a[40:43], v253, s[8:11], s28 offen offset:2048 sc1
    buffer_load_dwordx4 a[44:47], v229, s[8:11], s28 offen offset:3072 sc1
    s_add_u32 s28, s28, 4096
    buffer_load_dwordx4 a[48:51], v253, s[8:11], s28 offen offset:0 sc1
    buffer_load_dwordx4 a[52:55], v253, s[8:11], s28 offen offset:1024 sc1
    buffer_load_dwordx4 a[56:59], v253, s[8:11], s28 offen offset:2048 sc1
    buffer_load_dwordx4 a[60:63], v229, s[8:11], s28 offen offset:3072 sc1
    s_add_u32 s28, s28, 4096
    buffer_load_dwordx4 a[64:67], v253, s[8:11], s28 offen offset:0 sc1
    buffer_load_dwordx4 a[68:71], v253, s[8:11], s28 offen offset:1024 sc1
    buffer_load_dwordx4 a[72:75], v253, s[8:11], s28 offen offset:2048 sc1
    buffer_load_dwordx4 a[76:79], v229, s[8:11], s28 offen offset:3072 sc1
    s_add_u32 s28, s28, 4096
    buffer_load_dwordx4 a[80:83], v253, s[8:11], s28 offen offset:0 sc1
    buffer_load_dwordx4 a[84:87], v253, s[8:11], s28 offen offset:1024 sc1
    buffer_load_dwordx4 a[88:91], v253, s[8:11], s28 offen offset:2048 sc1
    buffer_load_dwordx4 a[92:95], v229, s[8:11], s28 offen offset:3072 sc1
    s_add_u32 s28, s28, 4096
    buffer_load_dwordx4 a[96:99], v253, s[8:11], s28 offen offset:0 sc1
    buffer_load_dwordx4 a[100:103], v253, s[8:11], s28 offen offset:1024 sc1
    buffer_load_dwordx4 a[104:107], v253, s[8:11], s28 offen offset:2048 sc1
    buffer_load_dwordx4 a[108:111], v229, s[8:11], s28 offen offset:3072 sc1
    s_add_u32 s28, s28, 4096
    buffer_load_dwordx4 a[112:115], v253, s[8:11], s28 offen offset:0 sc1
    buffer_load_dwordx4 a[116:119], v253, s[8:11], s28 offen offset:1024 sc1
    buffer_load_dwordx4 a[120:123], v253, s[8:11], s28 offen offset:2048 sc1
    buffer_load_dwordx4 a[124:127], v229, s[8:11], s28 offen offset:3072 sc1
    s_add_u32 s28, s28, 4096
    buffer_load_dwordx4 a[128:131], v253, s[8:11], s28 offen offset:0 sc1
    buffer_load_dwordx4 a[132:135], v253, s[8:11], s28 offen offset:1024 sc1
    buffer_load_dwordx4 a[136:139], v253, s[8:11], s28 offen offset:2048 sc1
    buffer_load_dwordx4 a[140:143], v229, s[8:11], s28 offen offset:3072 sc1
    s_add_u32 s28, s28, 4096
L_main_layer:
    v_bfe_u32 v3, v0, 3, 1
    v_mul_u32_u24 v2, 9216, v3
    v_lshrrev_b32 v3, 4, v0
    v_lshl_add_u32 v2, v3, 7, v2
    v_and_b32 v3, 7, v0
    v_lshl_add_u32 v2, v3, 4, v2
    v_bfe_u32 v3, v0, 3, 2
    s_mov_b32 s7, 9216
    v_mul_lo_u32 v9, v3, s7
    v_lshrrev_b32 v3, 5, v0
    v_lshl_add_u32 v9, v3, 7, v9
    v_and_b32 v3, 7, v0
    v_lshl_add_u32 v9, v3, 4, v9
    s_mul_i32 s22, s41, 73728
    s_add_u32 s22, s22, s43
    s_add_u32 s23, s22, 38797312
    s_mul_i32 s7, s3, 18432
    s_add_u32 s24, s23, s7
    s_cmp_eq_u32 s41, 0
    s_cselect_b32 s7, 0, 18432
    s_sub_u32 s23, s23, s7
    s_lshl_b32 s25, s3, 10
    s_add_u32 s25, s25, 1024
    s_mul_i32 s26, s3, 5120
    s_lshl_b32 s7, s3, 9
    s_add_u32 s27, s23, s7
    s_and_b32 s7, s3, 1
    s_add_u32 s7, s7, 4
    s_mul_i32 s29, s7, 5120
    s_lshl_b32 s7, s7, 9
    s_add_u32 s23, s23, s7
    s_cmp_lg_u32 s3, 3
    s_cbranch_scc1 L_pollout_20
    s_lshl_b32 s7, s40, 7
    s_add_u32 s7, s7, s44
    s_sub_u32 s7, s7, 32768
    s_add_u32 s52, s4, s7
    s_addc_u32 s53, s5, 0
    s_cmp_eq_u32 s41, 0
    s_cselect_b32 s7, 0, 32
    s_mov_b32 s6, 0
L_poll_18:
    s_load_dwordx8 s[56:63], s[52:53], 0 glc
    s_load_dwordx2 s[54:55], s[52:53], s7 glc
    s_add_u32 s6, s6, 1
    s_waitcnt lgkmcnt(0)
    s_xor_b64 s[54:55], s[54:55], s[76:77]
    s_xor_b64 s[56:57], s[56:57], s[76:77]
    s_xor_b64 s[58:59], s[58:59], s[76:77]
    s_xor_b64 s[60:61], s[60:61], s[76:77]
    s_xor_b64 s[62:63], s[62:63], s[76:77]
    s_or_b64 s[56:57], s[56:57], s[58:59]
    s_or_b64 s[60:61], s[60:61], s[62:63]
    s_or_b64 s[56:57], s[56:57], s[54:55]
    s_or_b64 s[56:57], s[56:57], s[60:61]
    s_cbranch_scc0 L_polled_19
    s_cmp_lt_u32 s6, 1048576
    s_cbranch_scc1 L_poll_18
    s_branch L_main_end
L_polled_19:
L_pollout_20:
    s_barrier
    s_add_u32 m0, s25, 0
    s_nop 0
    buffer_load_dwordx4 v2, s[8:11], s24 offen offset:0 sc1 lds
    s_add_u32 m0, s25, 4608
    s_nop 0
    buffer_load_dwordx4 v2, s[8:11], s24 offen offset:512 sc1 lds
    s_add_u32 m0, s25, 9216
    s_nop 0
    buffer_load_dwordx4 v2, s[8:11], s24 offen offset:1024 sc1 lds
    s_add_u32 m0, s25, 13824
    s_nop 0
    buffer_load_dwordx4 v2, s[8:11], s24 offen offset:1536 sc1 lds
    s_add_u32 m0, s25, 18432
    s_nop 0
    buffer_load_dwordx4 v2, s[8:11], s24 offen offset:2048 sc1 lds
    s_add_u32 m0, s25, 23040
    s_nop 0
    buffer_load_dwordx4 v2, s[8:11], s24 offen offset:2560 sc1 lds
    s_add_u32 m0, s26, 0
    s_add_u32 s7, s27, 0
    buffer_load_dwordx4 v2, s[8:11], s7 offen sc1 lds
    s_add_u32 m0, s29, 0
    s_add_u32 s7, s23, 0
    buffer_load_dwordx4 v2, s[8:11], s7 offen sc1 lds
    v_add_u32 v6, 46080, v253
    s_waitcnt vmcnt(0)
    s_barrier
    ds_read_b128 v[16:19], v253 offset:0
    ds_read_b128 v[20:23], v253 offset:1024
    ds_read_b128 v[24:27], v253 offset:2048
    ds_read_b128 v[28:31], v253 offset:3072
    ds_read_b128 v[32:35], v253 offset:4096
    s_waitcnt lgkmcnt(0)
    v_mfma_f32_16x16x32_bf16 v[56:59], a[0:3], v[20:23], 0
    ds_read_b128 v[36:39], v253 offset:5120
    v_mfma_f32_16x16x32_bf16 v[60:63], a[0:3], v[24:27], 0
    ds_read_b128 v[40:43], v253 offset:6144
    v_mfma_f32_16x16x32_bf16 v[64:67], a[0:3], v[28:31], 0
    ds_read_b128 v[44:47], v253 offset:7168
    v_mfma_f32_16x16x32_bf16 v[68:71], a[0:3], v[32:35], 0
    ds_read_b128 v[48:51], v253 offset:8192
    v_mfma_f32_16x16x32_bf16 v[72:75], a[4:7], v[16:19], 0
    ds_read_b128 v[52:55], v253 offset:9216
    v_mfma_f32_16x16x32_bf16 v[76:79], a[4:7], v[20:23], 0
    s_add_u32 m0, s25, 27648
    s_nop 0
    buffer_load_dwordx4 v2, s[8:11], s24 offen offset:3072 sc1 lds
    v_mfma_f32_16x16x32_bf16 v[80:83], a[4:7], v[24:27], 0
    v_mov_b32 v132, 0
    v_mov_b32 v133, 0
    v_mfma_f32_16x16x32_bf16 v[84:87], a[4:7], v[28:31], 0
    s_add_u32 m0, s25, 32256
    s_nop 0
    buffer_load_dwordx4 v2, s[8:11], s24 offen offset:3584 sc1 lds
    v_mfma_f32_16x16x32_bf16 v[88:91], a[4:7], v[32:35], 0
    v_mov_b32 v192, 0
    v_mov_b32 v193, 0
    v_mfma_f32_16x16x32_bf16 v[92:95], v[16:19], a[8:11], 0
    buffer_load_dwordx4 a[144:147], v253, s[8:11], s28 offen offset:0 sc1
    v_mfma_f32_16x16x32_bf16 v[96:99], v[20:23], a[8:11], 0
    v_mov_b32 v195, 0
    v_mov_b32 v135, 0
    v_mfma_f32_16x16x32_bf16 v[100:103], v[24:27], a[8:11], 0
    buffer_load_dwordx4 a[148:151], v253, s[8:11], s28 offen offset:1024 sc1
    v_mfma_f32_16x16x32_bf16 v[104:107], v[28:31], a[8:11], 0
    v_mov_b32 v139, 0
    v_mov_b32 v143, 0
    v_mfma_f32_16x16x32_bf16 v[108:111], v[32:35], a[8:11], 0
    buffer_load_dwordx4 a[152:155], v253, s[8:11], s28 offen offset:2048 sc1
    v_mfma_f32_16x16x32_bf16 v[112:115], a[12:15], v[16:19], 0
    v_mov_b32 v147, 0
    v_mov_b32 v151, 0
    v_mfma_f32_16x16x32_bf16 v[116:119], a[12:15], v[20:23], 0
    v_mov_b32 v155, 0
    v_mov_b32 v159, 0
    v_mfma_f32_16x16x32_bf16 v[120:123], a[12:15], v[24:27], 0
    v_mov_b32 v163, 0
    v_mov_b32 v167, 0
    v_mfma_f32_16x16x32_bf16 v[124:127], a[12:15], v[28:31], 0
    v_mov_b32 v171, 0
    v_cmp_eq_u32 vcc, 16, v0
    v_mov_b32 v10, 0x3f80
    v_mfma_f32_16x16x32_bf16 v[128:131], a[12:15], v[32:35], 0
    v_cmp_eq_u32 s[20:21], 17, v0
    v_cndmask_b32 v194, 0, v10, vcc
    v_and_b32 v11, 3, v0
    s_waitcnt lgkmcnt(0)
    v_mfma_f32_16x16x32_bf16 v[56:59], a[16:19], v[40:43], v[56:59]
    ds_read_b128 v[16:19], v253 offset:10240
    v_mfma_f32_16x16x32_bf16 v[60:63], a[16:19], v[44:47], v[60:63]
    ds_read_b128 v[20:23], v253 offset:11264
    v_mfma_f32_16x16x32_bf16 v[64:67], a[16:19], v[48:51], v[64:67]
    ds_read_b128 v[24:27], v253 offset:12288
    v_mfma_f32_16x16x32_bf16 v[68:71], a[16:19], v[52:55], v[68:71]
    ds_read_b128 v[28:31], v253 offset:13312
    v_mfma_f32_16x16x32_bf16 v[72:75], a[20:23], v[36:39], v[72:75]
    ds_read_b128 v[32:35], v253 offset:14336
    v_mfma_f32_16x16x32_bf16 v[76:79], a[20:23], v[40:43], v[76:79]
    s_add_u32 m0, s25, 40960
    s_add_u32 s24, s24, 4096
    buffer_load_dwordx4 v2, s[8:11], s24 offen offset:0 sc1 lds
    v_mfma_f32_16x16x32_bf16 v[80:83], a[20:23], v[44:47], v[80:83]
    v_cndmask_b32 v194, v194, 1.0, s[20:21]
    v_cmp_eq_u32 vcc, 2, v11
    v_and_b32 v10, 15, v0
    v_mfma_f32_16x16x32_bf16 v[84:87], a[20:23], v[48:51], v[84:87]
    s_add_u32 m0, s25, 45568
    s_nop 0
    buffer_load_dwordx4 v2, s[8:11], s24 offen offset:512 sc1 lds
    v_mfma_f32_16x16x32_bf16 v[88:91], a[20:23], v[52:55], v[88:91]
    v_lshrrev_b32 v11, 4, v0
    v_cndmask_b32 v196, 0, 1.0, vcc
    v_mfma_f32_16x16x32_bf16 v[92:95], v[36:39], a[24:27], v[92:95]
    buffer_load_dwordx4 a[156:159], v229, s[8:11], s28 offen offset:3072 sc1
    s_add_u32 s28, s28, 4096
    v_mfma_f32_16x16x32_bf16 v[96:99], v[40:43], a[24:27], v[96:99]
    v_cndmask_b32 v197, 0, 1.0, vcc
    v_cndmask_b32 v198, 0, 1.0, vcc
    v_mfma_f32_16x16x32_bf16 v[100:103], v[44:47], a[24:27], v[100:103]
    buffer_load_dwordx4 a[0:3], v253, s[8:11], s28 offen offset:0 sc1
    v_mfma_f32_16x16x32_bf16 v[104:107], v[48:51], a[24:27], v[104:107]
    v_cndmask_b32 v199, 0, 1.0, vcc
    v_lshlrev_b32 v11, 2, v11
    v_mfma_f32_16x16x32_bf16 v[108:111], v[52:55], a[24:27], v[108:111]
    buffer_load_dwordx4 a[4:7], v253, s[8:11], s28 offen offset:1024 sc1
    v_mfma_f32_16x16x32_bf16 v[112:115], a[28:31], v[36:39], v[112:115]
    v_sub_u32 v10, v11, v10
    v_mov_b32 v12, 0xf149f2ca
    v_mfma_f32_16x16x32_bf16 v[116:119], a[28:31], v[40:43], v[116:119]
    s_cmp_eq_u32 s41, 0
    s_cselect_b64 s[38:39], 0, -1
    v_add_u32 v11, 0, v10
    v_and_b32 v13, 1, v11
    v_mfma_f32_16x16x32_bf16 v[120:123], a[28:31], v[44:47], v[120:123]
    v_cmp_eq_u32 s[20:21], 0, v13
    v_cmp_lt_i32 vcc, 1, v11
    v_cmp_gt_i32 s[18:19], 1, v11
    s_and_b64 vcc, vcc, s[20:21]
    s_and_b64 s[18:19], s[18:19], s[20:21]
    s_and_b64 s[20:21], vcc, s[38:39]
    v_cndmask_b32 v200, v12, 0, vcc
    v_cndmask_b32 v204, v12, 0, s[18:19]
    v_mfma_f32_16x16x32_bf16 v[124:127], a[28:31], v[48:51], v[124:127]
    v_cndmask_b32 v208, v12, 0, s[20:21]
    v_add_u32 v11, 1, v10
    v_mfma_f32_16x16x32_bf16 v[128:131], a[28:31], v[52:55], v[128:131]
    v_and_b32 v13, 1, v11
    v_cmp_eq_u32 s[20:21], 0, v13
    v_cmp_lt_i32 vcc, 1, v11
    v_cmp_gt_i32 s[18:19], 1, v11
    s_and_b64 vcc, vcc, s[20:21]
    s_and_b64 s[18:19], s[18:19], s[20:21]
    s_and_b64 s[20:21], vcc, s[38:39]
    v_cndmask_b32 v201, v12, 0, vcc
    s_waitcnt lgkmcnt(0)
    v_mfma_f32_16x16x32_bf16 v[56:59], a[32:35], v[20:23], v[56:59]
    ds_read_b128 v[36:39], v253 offset:15360
    v_mfma_f32_16x16x32_bf16 v[60:63], a[32:35], v[24:27], v[60:63]
    ds_read_b128 v[40:43], v253 offset:16384
    v_mfma_f32_16x16x32_bf16 v[64:67], a[32:35], v[28:31], v[64:67]
    ds_read_b128 v[44:47], v253 offset:17408
    v_mfma_f32_16x16x32_bf16 v[68:71], a[32:35], v[32:35], v[68:71]
    ds_read_b128 v[48:51], v253 offset:18432
    v_mfma_f32_16x16x32_bf16 v[72:75], a[36:39], v[16:19], v[72:75]
    ds_read_b128 v[52:55], v253 offset:19456
    v_mfma_f32_16x16x32_bf16 v[76:79], a[36:39], v[20:23], v[76:79]
    s_add_u32 m0, s25, 50176
    s_nop 0
    buffer_load_dwordx4 v2, s[8:11], s24 offen offset:1024 sc1 lds
    v_mfma_f32_16x16x32_bf16 v[80:83], a[36:39], v[24:27], v[80:83]
    v_cndmask_b32 v205, v12, 0, s[18:19]
    v_cndmask_b32 v209, v12, 0, s[20:21]
    v_mfma_f32_16x16x32_bf16 v[84:87], a[36:39], v[28:31], v[84:87]
    s_add_u32 m0, s25, 54784
    s_nop 0
    buffer_load_dwordx4 v2, s[8:11], s24 offen offset:1536 sc1 lds
    v_mfma_f32_16x16x32_bf16 v[88:91], a[36:39], v[32:35], v[88:91]
    v_add_u32 v11, 2, v10
    v_and_b32 v13, 1, v11
    v_mfma_f32_16x16x32_bf16 v[92:95], v[16:19], a[40:43], v[92:95]
    buffer_load_dwordx4 a[8:11], v253, s[8:11], s28 offen offset:2048 sc1
    v_mfma_f32_16x16x32_bf16 v[96:99], v[20:23], a[40:43], v[96:99]
    v_cmp_eq_u32 s[20:21], 0, v13
    v_cmp_lt_i32 vcc, 1, v11
    v_cmp_gt_i32 s[18:19], 1, v11
    s_and_b64 vcc, vcc, s[20:21]
    s_and_b64 s[18:19], s[18:19], s[20:21]
    s_and_b64 s[20:21], vcc, s[38:39]
    v_cndmask_b32 v202, v12, 0, vcc
    v_cndmask_b32 v206, v12, 0, s[18:19]
    v_mfma_f32_16x16x32_bf16 v[100:103], v[24:27], a[40:43], v[100:103]
    buffer_load_dwordx4 a[12:15], v229, s[8:11], s28 offen offset:3072 sc1
    s_add_u32 s28, s28, 4096
    v_mfma_f32_16x16x32_bf16 v[104:107], v[28:31], a[40:43], v[104:107]
    v_cndmask_b32 v210, v12, 0, s[20:21]
    v_add_u32 v11, 3, v10
    v_mfma_f32_16x16x32_bf16 v[108:111], v[32:35], a[40:43], v[108:111]
    buffer_load_dwordx4 a[16:19], v253, s[8:11], s28 offen offset:0 sc1
    v_mfma_f32_16x16x32_bf16 v[112:115], a[44:47], v[16:19], v[112:115]
    v_and_b32 v13, 1, v11
    v_cmp_eq_u32 s[20:21], 0, v13
    v_cmp_lt_i32 vcc, 1, v11
    v_cmp_gt_i32 s[18:19], 1, v11
    s_and_b64 vcc, vcc, s[20:21]
    s_and_b64 s[18:19], s[18:19], s[20:21]
    s_and_b64 s[20:21], vcc, s[38:39]
    v_cndmask_b32 v203, v12, 0, vcc
    v_mfma_f32_16x16x32_bf16 v[116:119], a[44:47], v[20:23], v[116:119]
    v_cndmask_b32 v207, v12, 0, s[18:19]
    v_cndmask_b32 v211, v12, 0, s[20:21]
    v_mfma_f32_16x16x32_bf16 v[120:123], a[44:47], v[24:27], v[120:123]
    s_lshl_b32 s45, s41, 1
    s_lshr_b32 s7, s40, 2
    s_add_u32 s45, s45, s7
    s_mul_i32 s30, s45, 36864
    s_add_u32 s30, s30, s43
    s_and_b32 s31, s40, 3
    s_mul_i32 s31, s31, 9
    s_add_u32 s31, s31, s3
    s_mul_i32 s32, s31, 18432
    s_add_u32 s32, s32, 2359296
    s_add_u32 s33, s32, 73728
    s_add_u32 s34, s32, 147456
    s_mov_b32 s39, 19496960
    v_min_u32 v228, 44, v0
    v_lshlrev_b32 v228, 3, v228
    v_mfma_f32_16x16x32_bf16 v[124:127], a[44:47], v[28:31], v[124:127]
    s_cmp_eq_u32 s3, 1
    s_cmov_b32 s34, 3022848
    s_cmp_lt_u32 s3, 2
    s_cselect_b32 s35, 0, 1073741824
    v_add_u32 v5, s35, v253
    s_cmp_eq_u32 s3, 1
    s_cselect_b32 s7, 8, 0
    v_and_b32 v10, s7, v0
    v_mfma_f32_16x16x32_bf16 v[128:131], a[44:47], v[32:35], v[128:131]
    v_lshl_add_u32 v5, v10, 27, v5
    s_cmp_eq_u32 s3, 0
    s_cselect_b32 s35, 0, 1073741824
    v_add_u32 v7, s35, v9
    s_waitcnt lgkmcnt(0)
    v_mfma_f32_16x16x32_bf16 v[56:59], a[48:51], v[40:43], v[56:59]
    ds_read_b128 v[16:19], v253 offset:20480
    v_mfma_f32_16x16x32_bf16 v[60:63], a[48:51], v[44:47], v[60:63]
    ds_read_b128 v[20:23], v253 offset:21504
    v_mfma_f32_16x16x32_bf16 v[64:67], a[48:51], v[48:51], v[64:67]
    ds_read_b128 v[24:27], v253 offset:22528
    v_mfma_f32_16x16x32_bf16 v[68:71], a[48:51], v[52:55], v[68:71]
    ds_read_b128 v[28:31], v253 offset:23552
    v_mfma_f32_16x16x32_bf16 v[72:75], a[52:55], v[36:39], v[72:75]
    ds_read_b128 v[32:35], v253 offset:24576
    v_mfma_f32_16x16x32_bf16 v[76:79], a[52:55], v[40:43], v[76:79]
    s_add_u32 m0, s26, 30720
    s_add_u32 s7, s27, 3072
    buffer_load_dwordx4 v2, s[8:11], s7 offen sc1 lds
    v_mfma_f32_16x16x32_bf16 v[80:83], a[52:55], v[44:47], v[80:83]
    s_lshl_b32 s7, s31, 8
    s_add_u32 s36, s30, s7
    s_add_u32 s37, s36, 43515904
    s_add_u32 s46, s36, 45875200
    s_lshl_b32 s36, s45, 7
    s_add_u32 s36, s36, s43
    s_add_u32 s36, s36, 48431104
    s_lshl_b32 s47, s45, 9
    s_add_u32 s47, s47, s43
    s_add_u32 s47, s47, 48234496
    v_bfe_u32 v10, v0, 3, 2
    v_and_b32 v8, 7, v0
    v_mfma_f32_16x16x32_bf16 v[84:87], a[52:55], v[48:51], v[84:87]
    s_add_u32 m0, s29, 30720
    s_add_u32 s7, s23, 3072
    buffer_load_dwordx4 v2, s[8:11], s7 offen sc1 lds
    v_mfma_f32_16x16x32_bf16 v[88:91], a[52:55], v[52:55], v[88:91]
    v_lshlrev_b32 v8, 2, v8
    v_lshl_add_u32 v8, v10, 7, v8
    v_mfma_f32_16x16x32_bf16 v[92:95], v[36:39], a[56:59], v[92:95]
    buffer_load_dwordx4 a[20:23], v253, s[8:11], s28 offen offset:1024 sc1
    v_mfma_f32_16x16x32_bf16 v[96:99], v[40:43], a[56:59], v[96:99]
    v_mfma_f32_16x16x32_bf16 v[100:103], v[44:47], a[56:59], v[100:103]
    buffer_load_dwordx4 a[24:27], v253, s[8:11], s28 offen offset:2048 sc1
    v_mfma_f32_16x16x32_bf16 v[104:107], v[48:51], a[56:59], v[104:107]
    v_mfma_f32_16x16x32_bf16 v[108:111], v[52:55], a[56:59], v[108:111]
    buffer_load_dwordx4 a[28:31], v229, s[8:11], s28 offen offset:3072 sc1
    s_add_u32 s28, s28, 4096
    v_mfma_f32_16x16x32_bf16 v[112:115], a[60:63], v[36:39], v[112:115]
    v_mfma_f32_16x16x32_bf16 v[116:119], a[60:63], v[40:43], v[116:119]
    v_mfma_f32_16x16x32_bf16 v[120:123], a[60:63], v[44:47], v[120:123]
    v_mfma_f32_16x16x32_bf16 v[124:127], a[60:63], v[48:51], v[124:127]
    v_mfma_f32_16x16x32_bf16 v[128:131], a[60:63], v[52:55], v[128:131]
    s_waitcnt lgkmcnt(0)
    v_mfma_f32_16x16x32_bf16 v[56:59], a[64:67], v[20:23], v[56:59]
    ds_read_b128 v[36:39], v253 offset:25600
    v_mfma_f32_16x16x32_bf16 v[60:63], a[64:67], v[24:27], v[60:63]
    ds_read_b128 v[40:43], v253 offset:26624
    v_mfma_f32_16x16x32_bf16 v[64:67], a[64:67], v[28:31], v[64:67]
    ds_read_b128 v[44:47], v253 offset:27648
    v_mfma_f32_16x16x32_bf16 v[68:71], a[64:67], v[32:35], v[68:71]
    ds_read_b128 v[48:51], v253 offset:28672
    v_mfma_f32_16x16x32_bf16 v[72:75], a[68:71], v[16:19], v[72:75]
    ds_read_b128 v[52:55], v253 offset:29696
    v_mfma_f32_16x16x32_bf16 v[76:79], a[68:71], v[20:23], v[76:79]
    buffer_load_dwordx4 a[32:35], v253, s[8:11], s28 offen offset:0 sc1
    v_mfma_f32_16x16x32_bf16 v[80:83], a[68:71], v[24:27], v[80:83]
    v_mfma_f32_16x16x32_bf16 v[84:87], a[68:71], v[28:31], v[84:87]
    buffer_load_dwordx4 a[36:39], v253, s[8:11], s28 offen offset:1024 sc1
    v_mfma_f32_16x16x32_bf16 v[88:91], a[68:71], v[32:35], v[88:91]
    v_mfma_f32_16x16x32_bf16 v[92:95], v[16:19], a[72:75], v[92:95]
    buffer_load_dwordx4 a[40:43], v253, s[8:11], s28 offen offset:2048 sc1
    v_mfma_f32_16x16x32_bf16 v[96:99], v[20:23], a[72:75], v[96:99]
    v_mfma_f32_16x16x32_bf16 v[100:103], v[24:27], a[72:75], v[100:103]
    v_mfma_f32_16x16x32_bf16 v[104:107], v[28:31], a[72:75], v[104:107]
    v_mfma_f32_16x16x32_bf16 v[108:111], v[32:35], a[72:75], v[108:111]
    v_mfma_f32_16x16x32_bf16 v[112:115], a[76:79], v[16:19], v[112:115]
    v_mfma_f32_16x16x32_bf16 v[116:119], a[76:79], v[20:23], v[116:119]
    v_mfma_f32_16x16x32_bf16 v[120:123], a[76:79], v[24:27], v[120:123]
    v_mfma_f32_16x16x32_bf16 v[124:127], a[76:79], v[28:31], v[124:127]
    v_mfma_f32_16x16x32_bf16 v[128:131], a[76:79], v[32:35], v[128:131]
    s_waitcnt vmcnt(6) lgkmcnt(0)
    s_barrier
    v_mfma_f32_16x16x32_bf16 v[56:59], a[80:83], v[40:43], v[56:59]
    ds_read_b128 v[16:19], v253 offset:30720
    v_mfma_f32_16x16x32_bf16 v[60:63], a[80:83], v[44:47], v[60:63]
    ds_read_b128 v[20:23], v253 offset:31744
    v_mfma_f32_16x16x32_bf16 v[64:67], a[80:83], v[48:51], v[64:67]
    ds_read_b128 v[24:27], v253 offset:32768
    v_mfma_f32_16x16x32_bf16 v[68:71], a[80:83], v[52:55], v[68:71]
    ds_read_b128 v[28:31], v253 offset:33792
    v_mfma_f32_16x16x32_bf16 v[72:75], a[84:87], v[36:39], v[72:75]
    ds_read_b128 v[32:35], v253 offset:34816
    v_mfma_f32_16x16x32_bf16 v[76:79], a[84:87], v[40:43], v[76:79]
    s_add_u32 m0, s25, 59392
    s_nop 0
    buffer_load_dwordx4 v2, s[8:11], s24 offen offset:2048 sc1 lds
    v_mfma_f32_16x16x32_bf16 v[80:83], a[84:87], v[44:47], v[80:83]
    v_mfma_f32_16x16x32_bf16 v[84:87], a[84:87], v[48:51], v[84:87]
    s_add_u32 m0, s25, 64000
    s_nop 0
    buffer_load_dwordx4 v2, s[8:11], s24 offen offset:2560 sc1 lds
    v_mfma_f32_16x16x32_bf16 v[88:91], a[84:87], v[52:55], v[88:91]
    v_mfma_f32_16x16x32_bf16 v[92:95], v[36:39], a[88:91], v[92:95]
    buffer_load_dwordx4 a[44:47], v229, s[8:11], s28 offen offset:3072 sc1
    s_add_u32 s28, s28, 4096
    v_mfma_f32_16x16x32_bf16 v[96:99], v[40:43], a[88:91], v[96:99]
    v_mfma_f32_16x16x32_bf16 v[100:103], v[44:47], a[88:91], v[100:103]
    buffer_load_dwordx4 a[48:51], v253, s[8:11], s28 offen offset:0 sc1
    v_mfma_f32_16x16x32_bf16 v[104:107], v[48:51], a[88:91], v[104:107]
    v_mfma_f32_16x16x32_bf16 v[108:111], v[52:55], a[88:91], v[108:111]
    buffer_load_dwordx4 a[52:55], v253, s[8:11], s28 offen offset:1024 sc1
    v_mfma_f32_16x16x32_bf16 v[112:115], a[92:95], v[36:39], v[112:115]
    v_mfma_f32_16x16x32_bf16 v[116:119], a[92:95], v[40:43], v[116:119]
    v_mfma_f32_16x16x32_bf16 v[120:123], a[92:95], v[44:47], v[120:123]
    v_mfma_f32_16x16x32_bf16 v[124:127], a[92:95], v[48:51], v[124:127]
    v_mfma_f32_16x16x32_bf16 v[128:131], a[92:95], v[52:55], v[128:131]
    s_waitcnt lgkmcnt(0)
    v_mfma_f32_16x16x32_bf16 v[56:59], a[96:99], v[20:23], v[56:59]
    ds_read_b128 v[36:39], v253 offset:35840
    v_mfma_f32_16x16x32_bf16 v[60:63], a[96:99], v[24:27], v[60:63]
    ds_read_b128 v[40:43], v253 offset:36864
    v_mfma_f32_16x16x32_bf16 v[64:67], a[96:99], v[28:31], v[64:67]
    ds_read_b128 v[44:47], v253 offset:37888
    v_mfma_f32_16x16x32_bf16 v[68:71], a[96:99], v[32:35], v[68:71]
    ds_read_b128 v[48:51], v253 offset:38912
    v_mfma_f32_16x16x32_bf16 v[72:75], a[100:103], v[16:19], v[72:75]
    ds_read_b128 v[52:55], v253 offset:39936
    v_mfma_f32_16x16x32_bf16 v[76:79], a[100:103], v[20:23], v[76:79]
    s_add_u32 m0, s25, 68608
    s_nop 0
    buffer_load_dwordx4 v2, s[8:11], s24 offen offset:3072 sc1 lds
    v_mfma_f32_16x16x32_bf16 v[80:83], a[100:103], v[24:27], v[80:83]
    v_mfma_f32_16x16x32_bf16 v[84:87], a[100:103], v[28:31], v[84:87]
    s_add_u32 m0, s25, 73216
    s_nop 0
    buffer_load_dwordx4 v2, s[8:11], s24 offen offset:3584 sc1 lds
    v_mfma_f32_16x16x32_bf16 v[88:91], a[100:103], v[32:35], v[88:91]
    v_mfma_f32_16x16x32_bf16 v[92:95], v[16:19], a[104:107], v[92:95]
    buffer_load_dwordx4 a[56:59], v253, s[8:11], s28 offen offset:2048 sc1
    v_mfma_f32_16x16x32_bf16 v[96:99], v[20:23], a[104:107], v[96:99]
    v_mfma_f32_16x16x32_bf16 v[100:103], v[24:27], a[104:107], v[100:103]
    buffer_load_dwordx4 a[60:63], v229, s[8:11], s28 offen offset:3072 sc1
    s_add_u32 s28, s28, 4096
    v_mfma_f32_16x16x32_bf16 v[104:107], v[28:31], a[104:107], v[104:107]
    v_mfma_f32_16x16x32_bf16 v[108:111], v[32:35], a[104:107], v[108:111]
    buffer_load_dwordx4 a[64:67], v253, s[8:11], s28 offen offset:0 sc1
    v_mfma_f32_16x16x32_bf16 v[112:115], a[108:111], v[16:19], v[112:115]
    v_mfma_f32_16x16x32_bf16 v[116:119], a[108:111], v[20:23], v[116:119]
    buffer_load_dwordx2 v[226:227], v228, s[8:11], s39 offen sc1
    v_mfma_f32_16x16x32_bf16 v[120:123], a[108:111], v[24:27], v[120:123]
    v_mfma_f32_16x16x32_bf16 v[124:127], a[108:111], v[28:31], v[124:127]
    v_mfma_f32_16x16x32_bf16 v[128:131], a[108:111], v[32:35], v[128:131]
    s_waitcnt lgkmcnt(0)
    v_mfma_f32_16x16x32_bf16 v[56:59], a[112:115], v[40:43], v[56:59]
    ds_read_b128 v[16:19], v253 offset:40960
    v_mfma_f32_16x16x32_bf16 v[60:63], a[112:115], v[44:47], v[60:63]
    ds_read_b128 v[20:23], v253 offset:41984
    v_mfma_f32_16x16x32_bf16 v[64:67], a[112:115], v[48:51], v[64:67]
    ds_read_b128 v[24:27], v253 offset:43008
    v_mfma_f32_16x16x32_bf16 v[68:71], a[112:115], v[52:55], v[68:71]
    ds_read_b128 v[28:31], v253 offset:44032
    v_mfma_f32_16x16x32_bf16 v[72:75], a[116:119], v[36:39], v[72:75]
    ds_read_b128 v[32:35], v253 offset:45056
    v_mfma_f32_16x16x32_bf16 v[76:79], a[116:119], v[40:43], v[76:79]
    s_add_u32 m0, s25, 81920
    s_add_u32 s24, s24, 4096
    buffer_load_dwordx4 v2, s[8:11], s24 offen offset:0 sc1 lds
    v_mfma_f32_16x16x32_bf16 v[80:83], a[116:119], v[44:47], v[80:83]
    v_mfma_f32_16x16x32_bf16 v[84:87], a[116:119], v[48:51], v[84:87]
    s_add_u32 m0, s25, 86528
    s_nop 0
    buffer_load_dwordx4 v2, s[8:11], s24 offen offset:512 sc1 lds
    v_mfma_f32_16x16x32_bf16 v[88:91], a[116:119], v[52:55], v[88:91]
    v_mfma_f32_16x16x32_bf16 v[92:95], v[36:39], a[120:123], v[92:95]
    buffer_load_dwordx4 a[68:71], v253, s[8:11], s28 offen offset:1024 sc1
    v_mfma_f32_16x16x32_bf16 v[96:99], v[40:43], a[120:123], v[96:99]
    v_mfma_f32_16x16x32_bf16 v[100:103], v[44:47], a[120:123], v[100:103]
    buffer_load_dwordx4 a[72:75], v253, s[8:11], s28 offen offset:2048 sc1
    v_mfma_f32_16x16x32_bf16 v[104:107], v[48:51], a[120:123], v[104:107]
    v_mfma_f32_16x16x32_bf16 v[108:111], v[52:55], a[120:123], v[108:111]
    buffer_load_dwordx4 a[76:79], v229, s[8:11], s28 offen offset:3072 sc1
    s_add_u32 s28, s28, 4096
    v_mfma_f32_16x16x32_bf16 v[112:115], a[124:127], v[36:39], v[112:115]
    v_mfma_f32_16x16x32_bf16 v[116:119], a[124:127], v[40:43], v[116:119]
    v_mfma_f32_16x16x32_bf16 v[120:123], a[124:127], v[44:47], v[120:123]
    v_mfma_f32_16x16x32_bf16 v[124:127], a[124:127], v[48:51], v[124:127]
    v_mfma_f32_16x16x32_bf16 v[128:131], a[124:127], v[52:55], v[128:131]
    s_waitcnt lgkmcnt(0)
    v_mfma_f32_16x16x32_bf16 v[56:59], a[128:131], v[20:23], v[56:59]
    ds_read_b128 v[36:39], v6 offset:0
    v_mfma_f32_16x16x32_bf16 v[60:63], a[128:131], v[24:27], v[60:63]
    ds_read_b128 v[40:43], v6 offset:1024
    v_mfma_f32_16x16x32_bf16 v[64:67], a[128:131], v[28:31], v[64:67]
    ds_read_b128 v[44:47], v6 offset:2048
    v_mfma_f32_16x16x32_bf16 v[68:71], a[128:131], v[32:35], v[68:71]
    ds_read_b128 v[48:51], v6 offset:3072
    v_mfma_f32_16x16x32_bf16 v[72:75], a[132:135], v[16:19], v[72:75]
    ds_read_b128 v[52:55], v6 offset:4096
    v_mfma_f32_16x16x32_bf16 v[76:79], a[132:135], v[20:23], v[76:79]
    s_add_u32 m0, s26, 61440
    s_add_u32 s7, s27, 6144
    buffer_load_dwordx4 v2, s[8:11], s7 offen sc1 lds
    v_mfma_f32_16x16x32_bf16 v[80:83], a[132:135], v[24:27], v[80:83]
    v_mfma_f32_16x16x32_bf16 v[84:87], a[132:135], v[28:31], v[84:87]
    s_add_u32 m0, s29, 61440
    s_add_u32 s7, s23, 6144
    buffer_load_dwordx4 v2, s[8:11], s7 offen sc1 lds
    v_mfma_f32_16x16x32_bf16 v[88:91], a[132:135], v[32:35], v[88:91]
    v_mfma_f32_16x16x32_bf16 v[92:95], v[16:19], a[136:139], v[92:95]
    buffer_load_dwordx4 a[80:83], v253, s[8:11], s28 offen offset:0 sc1
    v_mfma_f32_16x16x32_bf16 v[96:99], v[20:23], a[136:139], v[96:99]
    v_mfma_f32_16x16x32_bf16 v[100:103], v[24:27], a[136:139], v[100:103]
    buffer_load_dwordx4 a[84:87], v253, s[8:11], s28 offen offset:1024 sc1
    v_mfma_f32_16x16x32_bf16 v[104:107], v[28:31], a[136:139], v[104:107]
    v_mfma_f32_16x16x32_bf16 v[108:111], v[32:35], a[136:139], v[108:111]
    buffer_load_dwordx4 a[88:91], v253, s[8:11], s28 offen offset:2048 sc1
    v_mfma_f32_16x16x32_bf16 v[112:115], a[140:143], v[16:19], v[112:115]
    v_mfma_f32_16x16x32_bf16 v[116:119], a[140:143], v[20:23], v[116:119]
    v_mfma_f32_16x16x32_bf16 v[120:123], a[140:143], v[24:27], v[120:123]
    v_mfma_f32_16x16x32_bf16 v[124:127], a[140:143], v[28:31], v[124:127]
    v_mfma_f32_16x16x32_bf16 v[128:131], a[140:143], v[32:35], v[128:131]
    s_waitcnt vmcnt(10) lgkmcnt(0)
    s_mov_b32 s6, 0
L_wo_poll_21:
    v_cmp_eq_u32 vcc, s76, v226
    v_cmp_eq_u32 s[20:21], s76, v227
    s_and_b64 vcc, vcc, s[20:21]
    s_cmp_eq_u64 vcc, exec
    s_cbranch_scc1 L_wo_ready_22
    buffer_load_dwordx2 v[226:227], v228, s[8:11], s39 offen sc1
    s_add_u32 s6, s6, 1
    s_cmp_lt_u32 s6, 1048576
    s_waitcnt vmcnt(0)
    s_cbranch_scc1 L_wo_poll_21
    s_branch L_main_end
L_wo_ready_22:
    v_mfma_f32_16x16x32_bf16 v[56:59], a[144:147], v[40:43], v[56:59]
    ds_read_b128 v[16:19], v6 offset:5120
    v_mfma_f32_16x16x32_bf16 v[60:63], a[144:147], v[44:47], v[60:63]
    ds_read_b128 v[20:23], v6 offset:6144
    v_mfma_f32_16x16x32_bf16 v[64:67], a[144:147], v[48:51], v[64:67]
    ds_read_b128 v[24:27], v6 offset:7168
    v_mfma_f32_16x16x32_bf16 v[68:71], a[144:147], v[52:55], v[68:71]
    ds_read_b128 v[28:31], v6 offset:8192
    v_mfma_f32_16x16x32_bf16 v[72:75], a[148:151], v[36:39], v[72:75]
    ds_read_b128 v[32:35], v6 offset:9216
    v_mfma_f32_16x16x32_bf16 v[76:79], a[148:151], v[40:43], v[76:79]
    buffer_load_dwordx4 a[92:95], v229, s[8:11], s28 offen offset:3072 sc1
    s_add_u32 s28, s28, 4096
    v_mfma_f32_16x16x32_bf16 v[80:83], a[148:151], v[44:47], v[80:83]
    v_mfma_f32_16x16x32_bf16 v[84:87], a[148:151], v[48:51], v[84:87]
    buffer_load_dwordx4 a[96:99], v253, s[8:11], s28 offen offset:0 sc1
    v_mfma_f32_16x16x32_bf16 v[88:91], a[148:151], v[52:55], v[88:91]
    v_mfma_f32_16x16x32_bf16 v[92:95], v[36:39], a[152:155], v[92:95]
    buffer_load_dwordx4 a[100:103], v253, s[8:11], s28 offen offset:1024 sc1
    v_mfma_f32_16x16x32_bf16 v[96:99], v[40:43], a[152:155], v[96:99]
    v_mfma_f32_16x16x32_bf16 v[100:103], v[44:47], a[152:155], v[100:103]
    buffer_load_dwordx4 a[160:163], v253, s[8:11], s32 offen offset:0 sc1
    v_mfma_f32_16x16x32_bf16 v[104:107], v[48:51], a[152:155], v[104:107]
    v_mfma_f32_16x16x32_bf16 v[108:111], v[52:55], a[152:155], v[108:111]
    v_mfma_f32_16x16x32_bf16 v[112:115], a[156:159], v[36:39], v[112:115]
    v_mfma_f32_16x16x32_bf16 v[116:119], a[156:159], v[40:43], v[116:119]
    v_mfma_f32_16x16x32_bf16 v[120:123], a[156:159], v[44:47], v[120:123]
    v_mfma_f32_16x16x32_bf16 v[124:127], a[156:159], v[48:51], v[124:127]
    v_mfma_f32_16x16x32_bf16 v[128:131], a[156:159], v[52:55], v[128:131]
    s_waitcnt vmcnt(34) lgkmcnt(0)
    v_mfma_f32_16x16x32_bf16 v[56:59], a[0:3], v[20:23], v[56:59]
    ds_read_b128 v[36:39], v6 offset:10240
    v_mfma_f32_16x16x32_bf16 v[60:63], a[0:3], v[24:27], v[60:63]
    ds_read_b128 v[40:43], v6 offset:11264
    v_mfma_f32_16x16x32_bf16 v[64:67], a[0:3], v[28:31], v[64:67]
    ds_read_b128 v[44:47], v6 offset:12288
    v_mfma_f32_16x16x32_bf16 v[68:71], a[0:3], v[32:35], v[68:71]
    ds_read_b128 v[48:51], v6 offset:13312
    v_mfma_f32_16x16x32_bf16 v[72:75], a[4:7], v[16:19], v[72:75]
    ds_read_b128 v[52:55], v6 offset:14336
    v_mfma_f32_16x16x32_bf16 v[76:79], a[4:7], v[20:23], v[76:79]
    buffer_load_dwordx4 a[104:107], v253, s[8:11], s28 offen offset:2048 sc1
    v_mfma_f32_16x16x32_bf16 v[80:83], a[4:7], v[24:27], v[80:83]
    v_mfma_f32_16x16x32_bf16 v[84:87], a[4:7], v[28:31], v[84:87]
    buffer_load_dwordx4 a[108:111], v229, s[8:11], s28 offen offset:3072 sc1
    s_add_u32 s28, s28, 4096
    v_mfma_f32_16x16x32_bf16 v[88:91], a[4:7], v[32:35], v[88:91]
    v_mfma_f32_16x16x32_bf16 v[92:95], v[16:19], a[8:11], v[92:95]
    buffer_load_dwordx4 a[112:115], v253, s[8:11], s28 offen offset:0 sc1
    v_mfma_f32_16x16x32_bf16 v[96:99], v[20:23], a[8:11], v[96:99]
    v_mfma_f32_16x16x32_bf16 v[100:103], v[24:27], a[8:11], v[100:103]
    buffer_load_dwordx4 a[164:167], v253, s[8:11], s33 offen offset:0 sc1
    v_mfma_f32_16x16x32_bf16 v[104:107], v[28:31], a[8:11], v[104:107]
    v_mfma_f32_16x16x32_bf16 v[108:111], v[32:35], a[8:11], v[108:111]
    v_mfma_f32_16x16x32_bf16 v[112:115], a[12:15], v[16:19], v[112:115]
    v_mfma_f32_16x16x32_bf16 v[116:119], a[12:15], v[20:23], v[116:119]
    v_mfma_f32_16x16x32_bf16 v[120:123], a[12:15], v[24:27], v[120:123]
    v_mfma_f32_16x16x32_bf16 v[124:127], a[12:15], v[28:31], v[124:127]
    v_mfma_f32_16x16x32_bf16 v[128:131], a[12:15], v[32:35], v[128:131]
    s_waitcnt vmcnt(11) lgkmcnt(0)
    s_barrier
    v_mfma_f32_16x16x32_bf16 v[56:59], a[16:19], v[40:43], v[56:59]
    ds_read_b128 v[16:19], v6 offset:15360
    v_mfma_f32_16x16x32_bf16 v[60:63], a[16:19], v[44:47], v[60:63]
    ds_read_b128 v[20:23], v6 offset:16384
    v_mfma_f32_16x16x32_bf16 v[64:67], a[16:19], v[48:51], v[64:67]
    ds_read_b128 v[24:27], v6 offset:17408
    v_mfma_f32_16x16x32_bf16 v[68:71], a[16:19], v[52:55], v[68:71]
    ds_read_b128 v[28:31], v6 offset:18432
    v_mfma_f32_16x16x32_bf16 v[72:75], a[20:23], v[36:39], v[72:75]
    ds_read_b128 v[32:35], v6 offset:19456
    v_mfma_f32_16x16x32_bf16 v[76:79], a[20:23], v[40:43], v[76:79]
    buffer_load_dwordx4 a[116:119], v253, s[8:11], s28 offen offset:1024 sc1
    v_mfma_f32_16x16x32_bf16 v[80:83], a[20:23], v[44:47], v[80:83]
    v_mfma_f32_16x16x32_bf16 v[84:87], a[20:23], v[48:51], v[84:87]
    buffer_load_dwordx4 a[120:123], v253, s[8:11], s28 offen offset:2048 sc1
    v_mfma_f32_16x16x32_bf16 v[88:91], a[20:23], v[52:55], v[88:91]
    v_mfma_f32_16x16x32_bf16 v[92:95], v[36:39], a[24:27], v[92:95]
    buffer_load_dwordx4 a[124:127], v229, s[8:11], s28 offen offset:3072 sc1
    s_add_u32 s28, s28, 4096
    v_mfma_f32_16x16x32_bf16 v[96:99], v[40:43], a[24:27], v[96:99]
    v_mfma_f32_16x16x32_bf16 v[100:103], v[44:47], a[24:27], v[100:103]
    buffer_load_dwordx4 a[168:171], v5, s[8:11], s34 offen offset:0 sc1
    v_mfma_f32_16x16x32_bf16 v[104:107], v[48:51], a[24:27], v[104:107]
    v_mfma_f32_16x16x32_bf16 v[108:111], v[52:55], a[24:27], v[108:111]
    v_mfma_f32_16x16x32_bf16 v[112:115], a[28:31], v[36:39], v[112:115]
    v_mfma_f32_16x16x32_bf16 v[116:119], a[28:31], v[40:43], v[116:119]
    v_mfma_f32_16x16x32_bf16 v[120:123], a[28:31], v[44:47], v[120:123]
    v_mfma_f32_16x16x32_bf16 v[124:127], a[28:31], v[48:51], v[124:127]
    v_mfma_f32_16x16x32_bf16 v[128:131], a[28:31], v[52:55], v[128:131]
    s_waitcnt vmcnt(30) lgkmcnt(0)
    v_mfma_f32_16x16x32_bf16 v[56:59], a[32:35], v[20:23], v[56:59]
    ds_read_b128 v[36:39], v6 offset:20480
    v_mfma_f32_16x16x32_bf16 v[60:63], a[32:35], v[24:27], v[60:63]
    ds_read_b128 v[40:43], v6 offset:21504
    v_mfma_f32_16x16x32_bf16 v[64:67], a[32:35], v[28:31], v[64:67]
    ds_read_b128 v[44:47], v6 offset:22528
    v_mfma_f32_16x16x32_bf16 v[68:71], a[32:35], v[32:35], v[68:71]
    ds_read_b128 v[48:51], v6 offset:23552
    v_mfma_f32_16x16x32_bf16 v[72:75], a[36:39], v[16:19], v[72:75]
    ds_read_b128 v[52:55], v6 offset:24576
    v_mfma_f32_16x16x32_bf16 v[76:79], a[36:39], v[20:23], v[76:79]
    buffer_load_dwordx4 a[172:175], v253, s[8:11], s32 offen offset:1024 sc1
    v_mfma_f32_16x16x32_bf16 v[80:83], a[36:39], v[24:27], v[80:83]
    v_mfma_f32_16x16x32_bf16 v[84:87], a[36:39], v[28:31], v[84:87]
    buffer_load_dwordx4 a[176:179], v253, s[8:11], s33 offen offset:1024 sc1
    v_mfma_f32_16x16x32_bf16 v[88:91], a[36:39], v[32:35], v[88:91]
    v_mfma_f32_16x16x32_bf16 v[92:95], v[16:19], a[40:43], v[92:95]
    buffer_load_dwordx4 a[180:183], v5, s[8:11], s34 offen offset:1024 sc1
    v_mfma_f32_16x16x32_bf16 v[96:99], v[20:23], a[40:43], v[96:99]
    v_mfma_f32_16x16x32_bf16 v[100:103], v[24:27], a[40:43], v[100:103]
    buffer_load_dwordx4 a[184:187], v253, s[8:11], s32 offen offset:2048 sc1
    v_mfma_f32_16x16x32_bf16 v[104:107], v[28:31], a[40:43], v[104:107]
    v_mfma_f32_16x16x32_bf16 v[108:111], v[32:35], a[40:43], v[108:111]
    v_mfma_f32_16x16x32_bf16 v[112:115], a[44:47], v[16:19], v[112:115]
    v_mfma_f32_16x16x32_bf16 v[116:119], a[44:47], v[20:23], v[116:119]
    v_mfma_f32_16x16x32_bf16 v[120:123], a[44:47], v[24:27], v[120:123]
    v_mfma_f32_16x16x32_bf16 v[124:127], a[44:47], v[28:31], v[124:127]
    v_mfma_f32_16x16x32_bf16 v[128:131], a[44:47], v[32:35], v[128:131]
    s_waitcnt vmcnt(28) lgkmcnt(0)
    v_mfma_f32_16x16x32_bf16 v[56:59], a[48:51], v[40:43], v[56:59]
    ds_read_b128 v[16:19], v6 offset:25600
    v_mfma_f32_16x16x32_bf16 v[60:63], a[48:51], v[44:47], v[60:63]
    ds_read_b128 v[20:23], v6 offset:26624
    v_mfma_f32_16x16x32_bf16 v[64:67], a[48:51], v[48:51], v[64:67]
    ds_read_b128 v[24:27], v6 offset:27648
    v_mfma_f32_16x16x32_bf16 v[68:71], a[48:51], v[52:55], v[68:71]
    ds_read_b128 v[28:31], v6 offset:28672
    v_mfma_f32_16x16x32_bf16 v[72:75], a[52:55], v[36:39], v[72:75]
    ds_read_b128 v[32:35], v6 offset:29696
    v_mfma_f32_16x16x32_bf16 v[76:79], a[52:55], v[40:43], v[76:79]
    buffer_load_dwordx4 a[188:191], v253, s[8:11], s33 offen offset:2048 sc1
    v_mfma_f32_16x16x32_bf16 v[80:83], a[52:55], v[44:47], v[80:83]
    v_mfma_f32_16x16x32_bf16 v[84:87], a[52:55], v[48:51], v[84:87]
    buffer_load_dwordx4 a[192:195], v5, s[8:11], s34 offen offset:2048 sc1
    v_mfma_f32_16x16x32_bf16 v[88:91], a[52:55], v[52:55], v[88:91]
    v_mfma_f32_16x16x32_bf16 v[92:95], v[36:39], a[56:59], v[92:95]
    buffer_load_dwordx4 a[196:199], v253, s[8:11], s32 offen offset:3072 sc1
    s_add_u32 s32, s32, 4096
    v_mfma_f32_16x16x32_bf16 v[96:99], v[40:43], a[56:59], v[96:99]
    v_mfma_f32_16x16x32_bf16 v[100:103], v[44:47], a[56:59], v[100:103]
    buffer_load_dwordx4 a[200:203], v253, s[8:11], s33 offen offset:3072 sc1
    s_add_u32 s33, s33, 4096
    v_mfma_f32_16x16x32_bf16 v[104:107], v[48:51], a[56:59], v[104:107]
    v_mfma_f32_16x16x32_bf16 v[108:111], v[52:55], a[56:59], v[108:111]
    v_mfma_f32_16x16x32_bf16 v[112:115], a[60:63], v[36:39], v[112:115]
    v_mfma_f32_16x16x32_bf16 v[116:119], a[60:63], v[40:43], v[116:119]
    v_mfma_f32_16x16x32_bf16 v[120:123], a[60:63], v[44:47], v[120:123]
    v_mfma_f32_16x16x32_bf16 v[124:127], a[60:63], v[48:51], v[124:127]
    v_mfma_f32_16x16x32_bf16 v[128:131], a[60:63], v[52:55], v[128:131]
    s_waitcnt vmcnt(25) lgkmcnt(0)
    v_mfma_f32_16x16x32_bf16 v[56:59], a[64:67], v[20:23], v[56:59]
    ds_read_b128 v[36:39], v6 offset:30720
    v_mfma_f32_16x16x32_bf16 v[60:63], a[64:67], v[24:27], v[60:63]
    ds_read_b128 v[40:43], v6 offset:31744
    v_mfma_f32_16x16x32_bf16 v[64:67], a[64:67], v[28:31], v[64:67]
    ds_read_b128 v[44:47], v6 offset:32768
    v_mfma_f32_16x16x32_bf16 v[68:71], a[64:67], v[32:35], v[68:71]
    ds_read_b128 v[48:51], v6 offset:33792
    v_mfma_f32_16x16x32_bf16 v[72:75], a[68:71], v[16:19], v[72:75]
    ds_read_b128 v[52:55], v6 offset:34816
    v_mfma_f32_16x16x32_bf16 v[76:79], a[68:71], v[20:23], v[76:79]
    buffer_load_dwordx4 a[204:207], v5, s[8:11], s34 offen offset:3072 sc1
    s_add_u32 s34, s34, 4096
    v_mfma_f32_16x16x32_bf16 v[80:83], a[68:71], v[24:27], v[80:83]
    v_mfma_f32_16x16x32_bf16 v[84:87], a[68:71], v[28:31], v[84:87]
    buffer_load_dwordx4 a[208:211], v253, s[8:11], s32 offen offset:0 sc1
    v_mfma_f32_16x16x32_bf16 v[88:91], a[68:71], v[32:35], v[88:91]
    v_mfma_f32_16x16x32_bf16 v[92:95], v[16:19], a[72:75], v[92:95]
    buffer_load_dwordx4 a[212:215], v253, s[8:11], s33 offen offset:0 sc1
    v_mfma_f32_16x16x32_bf16 v[96:99], v[20:23], a[72:75], v[96:99]
    v_mfma_f32_16x16x32_bf16 v[100:103], v[24:27], a[72:75], v[100:103]
    buffer_load_dwordx4 a[216:219], v5, s[8:11], s34 offen offset:0 sc1
    v_mfma_f32_16x16x32_bf16 v[104:107], v[28:31], a[72:75], v[104:107]
    v_mfma_f32_16x16x32_bf16 v[108:111], v[32:35], a[72:75], v[108:111]
    v_mfma_f32_16x16x32_bf16 v[112:115], a[76:79], v[16:19], v[112:115]
    v_mfma_f32_16x16x32_bf16 v[116:119], a[76:79], v[20:23], v[116:119]
    v_mfma_f32_16x16x32_bf16 v[120:123], a[76:79], v[24:27], v[120:123]
    v_mfma_f32_16x16x32_bf16 v[124:127], a[76:79], v[28:31], v[124:127]
    v_mfma_f32_16x16x32_bf16 v[128:131], a[76:79], v[32:35], v[128:131]
    s_waitcnt vmcnt(23) lgkmcnt(0)
    v_mfma_f32_16x16x32_bf16 v[56:59], a[80:83], v[40:43], v[56:59]
    ds_read_b128 v[16:19], v6 offset:35840
    v_mfma_f32_16x16x32_bf16 v[60:63], a[80:83], v[44:47], v[60:63]
    ds_read_b128 v[20:23], v6 offset:36864
    v_mfma_f32_16x16x32_bf16 v[64:67], a[80:83], v[48:51], v[64:67]
    ds_read_b128 v[24:27], v6 offset:37888
    v_mfma_f32_16x16x32_bf16 v[68:71], a[80:83], v[52:55], v[68:71]
    ds_read_b128 v[28:31], v6 offset:38912
    v_mfma_f32_16x16x32_bf16 v[72:75], a[84:87], v[36:39], v[72:75]
    ds_read_b128 v[32:35], v6 offset:39936
    v_mfma_f32_16x16x32_bf16 v[76:79], a[84:87], v[40:43], v[76:79]
    buffer_load_dwordx4 a[220:223], v253, s[8:11], s32 offen offset:1024 sc1
    v_mfma_f32_16x16x32_bf16 v[80:83], a[84:87], v[44:47], v[80:83]
    v_mfma_f32_16x16x32_bf16 v[84:87], a[84:87], v[48:51], v[84:87]
    buffer_load_dwordx4 a[224:227], v253, s[8:11], s33 offen offset:1024 sc1
    v_mfma_f32_16x16x32_bf16 v[88:91], a[84:87], v[52:55], v[88:91]
    v_mfma_f32_16x16x32_bf16 v[92:95], v[36:39], a[88:91], v[92:95]
    buffer_load_dwordx4 a[228:231], v5, s[8:11], s34 offen offset:1024 sc1
    v_mfma_f32_16x16x32_bf16 v[96:99], v[40:43], a[88:91], v[96:99]
    v_mfma_f32_16x16x32_bf16 v[100:103], v[44:47], a[88:91], v[100:103]
    buffer_load_dwordx4 a[232:235], v253, s[8:11], s32 offen offset:2048 sc1
    v_mfma_f32_16x16x32_bf16 v[104:107], v[48:51], a[88:91], v[104:107]
    v_mfma_f32_16x16x32_bf16 v[108:111], v[52:55], a[88:91], v[108:111]
    v_mfma_f32_16x16x32_bf16 v[112:115], a[92:95], v[36:39], v[112:115]
    v_mfma_f32_16x16x32_bf16 v[116:119], a[92:95], v[40:43], v[116:119]
    v_mfma_f32_16x16x32_bf16 v[120:123], a[92:95], v[44:47], v[120:123]
    v_mfma_f32_16x16x32_bf16 v[124:127], a[92:95], v[48:51], v[124:127]
    v_mfma_f32_16x16x32_bf16 v[128:131], a[92:95], v[52:55], v[128:131]
    s_waitcnt vmcnt(22) lgkmcnt(0)
    v_mfma_f32_16x16x32_bf16 v[56:59], a[96:99], v[20:23], v[56:59]
    ds_read_b128 v[36:39], v6 offset:40960
    v_mfma_f32_16x16x32_bf16 v[60:63], a[96:99], v[24:27], v[60:63]
    ds_read_b128 v[40:43], v6 offset:41984
    v_mfma_f32_16x16x32_bf16 v[64:67], a[96:99], v[28:31], v[64:67]
    ds_read_b128 v[44:47], v6 offset:43008
    v_mfma_f32_16x16x32_bf16 v[68:71], a[96:99], v[32:35], v[68:71]
    ds_read_b128 v[48:51], v6 offset:44032
    v_mfma_f32_16x16x32_bf16 v[72:75], a[100:103], v[16:19], v[72:75]
    ds_read_b128 v[52:55], v6 offset:45056
    v_mfma_f32_16x16x32_bf16 v[76:79], a[100:103], v[20:23], v[76:79]
    buffer_load_dwordx4 a[236:239], v253, s[8:11], s33 offen offset:2048 sc1
    v_mfma_f32_16x16x32_bf16 v[80:83], a[100:103], v[24:27], v[80:83]
    v_mfma_f32_16x16x32_bf16 v[84:87], a[100:103], v[28:31], v[84:87]
    buffer_load_dwordx4 a[240:243], v5, s[8:11], s34 offen offset:2048 sc1
    v_mfma_f32_16x16x32_bf16 v[88:91], a[100:103], v[32:35], v[88:91]
    v_mfma_f32_16x16x32_bf16 v[92:95], v[16:19], a[104:107], v[92:95]
    buffer_load_dwordx4 a[244:247], v253, s[8:11], s32 offen offset:3072 sc1
    s_add_u32 s32, s32, 4096
    v_mfma_f32_16x16x32_bf16 v[96:99], v[20:23], a[104:107], v[96:99]
    v_mfma_f32_16x16x32_bf16 v[100:103], v[24:27], a[104:107], v[100:103]
    buffer_load_dwordx4 a[248:251], v253, s[8:11], s33 offen offset:3072 sc1
    s_add_u32 s33, s33, 4096
    v_mfma_f32_16x16x32_bf16 v[104:107], v[28:31], a[104:107], v[104:107]
    v_mfma_f32_16x16x32_bf16 v[108:111], v[32:35], a[104:107], v[108:111]
    v_mfma_f32_16x16x32_bf16 v[112:115], a[108:111], v[16:19], v[112:115]
    v_mfma_f32_16x16x32_bf16 v[116:119], a[108:111], v[20:23], v[116:119]
    v_mfma_f32_16x16x32_bf16 v[120:123], a[108:111], v[24:27], v[120:123]
    v_mfma_f32_16x16x32_bf16 v[124:127], a[108:111], v[28:31], v[124:127]
    v_mfma_f32_16x16x32_bf16 v[128:131], a[108:111], v[32:35], v[128:131]
    s_waitcnt vmcnt(21) lgkmcnt(0)
    v_mfma_f32_16x16x32_bf16 v[56:59], a[112:115], v[40:43], v[56:59]
    v_mfma_f32_16x16x32_bf16 v[60:63], a[112:115], v[44:47], v[60:63]
    v_mfma_f32_16x16x32_bf16 v[64:67], a[112:115], v[48:51], v[64:67]
    v_mfma_f32_16x16x32_bf16 v[68:71], a[112:115], v[52:55], v[68:71]
    v_mfma_f32_16x16x32_bf16 v[72:75], a[116:119], v[36:39], v[72:75]
    v_mfma_f32_16x16x32_bf16 v[76:79], a[116:119], v[40:43], v[76:79]
    buffer_load_dwordx4 a[252:255], v5, s[8:11], s34 offen offset:3072 sc1
    s_add_u32 s34, s34, 4096
    v_mfma_f32_16x16x32_bf16 v[80:83], a[116:119], v[44:47], v[80:83]
    v_mfma_f32_16x16x32_bf16 v[84:87], a[116:119], v[48:51], v[84:87]
    buffer_load_dwordx4 a[128:131], v253, s[8:11], s32 offen offset:0 sc1
    v_mfma_f32_16x16x32_bf16 v[88:91], a[116:119], v[52:55], v[88:91]
    v_mfma_f32_16x16x32_bf16 v[92:95], v[36:39], a[120:123], v[92:95]
    buffer_load_dwordx4 a[132:135], v253, s[8:11], s33 offen offset:0 sc1
    v_mfma_f32_16x16x32_bf16 v[96:99], v[40:43], a[120:123], v[96:99]
    v_mfma_f32_16x16x32_bf16 v[100:103], v[44:47], a[120:123], v[100:103]
    buffer_load_dwordx4 a[136:139], v5, s[8:11], s34 offen offset:0 sc1
    v_mfma_f32_16x16x32_bf16 v[104:107], v[48:51], a[120:123], v[104:107]
    v_mfma_f32_16x16x32_bf16 v[108:111], v[52:55], a[120:123], v[108:111]
    v_mfma_f32_16x16x32_bf16 v[112:115], a[124:127], v[36:39], v[112:115]
    v_mfma_f32_16x16x32_bf16 v[116:119], a[124:127], v[40:43], v[116:119]
    v_mfma_f32_16x16x32_bf16 v[120:123], a[124:127], v[44:47], v[120:123]
    v_mfma_f32_16x16x32_bf16 v[124:127], a[124:127], v[48:51], v[124:127]
    v_mfma_f32_16x16x32_bf16 v[128:131], a[124:127], v[52:55], v[128:131]
    v_cvt_pk_bf16_f32 v136, v56, v57
    v_cvt_pk_bf16_f32 v137, v58, v59
    v_cvt_pk_bf16_f32 v140, v60, v61
    v_cvt_pk_bf16_f32 v141, v62, v63
    v_cvt_pk_bf16_f32 v144, v64, v65
    v_cvt_pk_bf16_f32 v145, v66, v67
    v_cvt_pk_bf16_f32 v148, v68, v69
    v_cvt_pk_bf16_f32 v149, v70, v71
    v_cvt_pk_bf16_f32 v152, v72, v73
    buffer_load_dwordx4 a[140:143], v253, s[8:11], s32 offen offset:1024 sc1
    v_cvt_pk_bf16_f32 v153, v74, v75
    v_cvt_pk_bf16_f32 v156, v76, v77
    v_cvt_pk_bf16_f32 v157, v78, v79
    v_cvt_pk_bf16_f32 v160, v80, v81
    v_cvt_pk_bf16_f32 v161, v82, v83
    v_cvt_pk_bf16_f32 v164, v84, v85
    v_cvt_pk_bf16_f32 v165, v86, v87
    v_cvt_pk_bf16_f32 v168, v88, v89
    v_cvt_pk_bf16_f32 v169, v90, v91
    buffer_load_dwordx4 a[144:147], v253, s[8:11], s33 offen offset:1024 sc1
    v_cvt_pk_bf16_f32 v134, v112, v113
    v_cvt_pk_bf16_f32 v154, v114, v115
    v_cvt_pk_bf16_f32 v138, v116, v117
    v_cvt_pk_bf16_f32 v158, v118, v119
    v_cvt_pk_bf16_f32 v142, v120, v121
    v_cvt_pk_bf16_f32 v162, v122, v123
    v_cvt_pk_bf16_f32 v146, v124, v125
    v_cvt_pk_bf16_f32 v166, v126, v127
    v_cvt_pk_bf16_f32 v150, v128, v129
    buffer_load_dwordx4 a[148:151], v5, s[8:11], s34 offen offset:1024 sc1
    v_cvt_pk_bf16_f32 v170, v130, v131
    v_cvt_pk_bf16_f32 v172, v92, v93
    v_cvt_pk_bf16_f32 v173, v94, v95
    v_cvt_pk_bf16_f32 v174, v96, v97
    v_cvt_pk_bf16_f32 v175, v98, v99
    v_cvt_pk_bf16_f32 v176, v100, v101
    v_cvt_pk_bf16_f32 v177, v102, v103
    v_cvt_pk_bf16_f32 v178, v104, v105
    v_cvt_pk_bf16_f32 v179, v106, v107
    buffer_load_dwordx4 a[152:155], v253, s[8:11], s32 offen offset:2048 sc1
    v_cvt_pk_bf16_f32 v180, v108, v109
    v_cvt_pk_bf16_f32 v181, v110, v111
    v_mfma_f32_16x16x32_bf16 v[16:19], v[152:155], v[136:139], v[208:211]
    v_mfma_f32_16x16x32_bf16 v[20:23], v[156:159], v[136:139], v[204:207]
    v_mfma_f32_16x16x32_bf16 v[24:27], v[156:159], v[140:143], v[200:203]
    v_mfma_f32_16x16x32_bf16 v[28:31], v[160:163], v[140:143], v[204:207]
    v_mfma_f32_16x16x32_bf16 v[32:35], v[160:163], v[144:147], v[200:203]
    v_mfma_f32_16x16x32_bf16 v[36:39], v[164:167], v[144:147], v[204:207]
    v_mfma_f32_16x16x32_bf16 v[40:43], v[164:167], v[148:151], v[200:203]
    buffer_load_dwordx4 a[156:159], v253, s[8:11], s33 offen offset:2048 sc1
    v_mfma_f32_16x16x32_bf16 v[44:47], v[168:171], v[148:151], v[204:207]
    v_mfma_f32_16x16x32_bf16 v[56:59], v[132:135], v[192:195], v[196:199]
    v_mfma_f32_16x16x32_bf16 v[60:63], v[136:139], v[192:195], v[196:199]
    v_mfma_f32_16x16x32_bf16 v[64:67], v[140:143], v[192:195], v[196:199]
    v_mfma_f32_16x16x32_bf16 v[68:71], v[144:147], v[192:195], v[196:199]
    v_mfma_f32_16x16x32_bf16 v[72:75], v[148:151], v[192:195], v[196:199]
    v_max3_f32 v92, v16, v17, v18
    v_max3_f32 v96, v19, v20, v21
    v_max3_f32 v93, v24, v25, v26
    buffer_load_dwordx4 a[0:3], v5, s[8:11], s34 offen offset:2048 sc1
    v_max3_f32 v97, v27, v28, v29
    v_max3_f32 v94, v32, v33, v34
    v_max3_f32 v98, v35, v36, v37
    v_max3_f32 v95, v40, v41, v42
    v_max3_f32 v99, v43, v44, v45
    v_max3_f32 v92, v92, v22, v23
    v_max3_f32 v93, v93, v30, v31
    v_max3_f32 v94, v94, v38, v39
    v_max3_f32 v95, v95, v46, v47
    buffer_load_dwordx4 a[4:7], v253, s[8:11], s32 offen offset:3072 sc1
    s_add_u32 s32, s32, 4096
    v_max_f32 v92, v92, v96
    v_max_f32 v93, v93, v97
    v_max_f32 v94, v94, v98
    v_max_f32 v95, v95, v99
    s_mov_b32 s18, 0x3eae1a93
    v_cvt_pk_bf16_f32 v182, v56, v57
    v_permlane32_swap_b32 v92, v93
    v_permlane32_swap_b32 v94, v95
    v_max_f32 v92, v92, v93
    buffer_load_dwordx4 a[8:11], v253, s[8:11], s33 offen offset:3072 sc1
    s_add_u32 s33, s33, 4096
    v_max_f32 v94, v94, v95
    v_cvt_pk_bf16_f32 v183, v58, v59
    v_cvt_pk_bf16_f32 v184, v60, v61
    v_permlane16_swap_b32 v92, v94
    v_max_f32 v92, v92, v94
    v_mul_f32 v92, 0xbeae1a93, v92
    v_mov_b32 v94, v92
    v_cvt_pk_bf16_f32 v185, v62, v63
    v_cvt_pk_bf16_f32 v186, v64, v65
    buffer_load_dwordx4 a[12:15], v5, s[8:11], s34 offen offset:3072 sc1
    s_add_u32 s34, s34, 4096
    v_permlane16_swap_b32 v92, v94
    v_mov_b32 v93, v92
    v_mov_b32 v95, v94
    v_cvt_pk_bf16_f32 v187, v66, v67
    v_cvt_pk_bf16_f32 v188, v68, v69
    v_permlane32_swap_b32 v92, v93
    v_permlane32_swap_b32 v94, v95
    v_cvt_pk_bf16_f32 v189, v70, v71
    v_cvt_pk_bf16_f32 v190, v72, v73
    buffer_load_dwordx4 a[16:19], v253, s[8:11], s32 offen offset:0 sc1
    v_cvt_pk_bf16_f32 v191, v74, v75
    v_fma_f32 v16, v16, s18, v92
    v_fma_f32 v17, v17, s18, v92
    v_fma_f32 v18, v18, s18, v92
    v_fma_f32 v19, v19, s18, v92
    v_fma_f32 v20, v20, s18, v92
    v_fma_f32 v21, v21, s18, v92
    v_fma_f32 v22, v22, s18, v92
    v_fma_f32 v23, v23, s18, v92
    buffer_load_dwordx4 a[20:23], v253, s[8:11], s33 offen offset:0 sc1
    v_exp_f32 v16, v16
    v_exp_f32 v17, v17
    v_exp_f32 v18, v18
    v_exp_f32 v19, v19
    v_exp_f32 v20, v20
    v_exp_f32 v21, v21
    v_exp_f32 v22, v22
    v_exp_f32 v23, v23
    s_nop 0
    buffer_load_dwordx4 a[24:27], v5, s[8:11], s34 offen offset:0 sc1
    v_cvt_pk_bf16_f32 v76, v16, v17
    v_cvt_pk_bf16_f32 v77, v18, v19
    v_cvt_pk_bf16_f32 v78, v20, v21
    v_cvt_pk_bf16_f32 v79, v22, v23
    v_fma_f32 v24, v24, s18, v93
    v_fma_f32 v25, v25, s18, v93
    v_fma_f32 v26, v26, s18, v93
    v_fma_f32 v27, v27, s18, v93
    v_fma_f32 v28, v28, s18, v93
    buffer_load_dwordx4 a[28:31], v253, s[8:11], s32 offen offset:1024 sc1
    v_fma_f32 v29, v29, s18, v93
    v_fma_f32 v30, v30, s18, v93
    v_fma_f32 v31, v31, s18, v93
    v_exp_f32 v24, v24
    v_exp_f32 v25, v25
    v_exp_f32 v26, v26
    v_exp_f32 v27, v27
    v_exp_f32 v28, v28
    v_exp_f32 v29, v29
    buffer_load_dwordx4 a[32:35], v253, s[8:11], s33 offen offset:1024 sc1
    v_exp_f32 v30, v30
    v_exp_f32 v31, v31
    v_mfma_f32_16x16x32_bf16 v[100:103], v[172:175], v[76:79], 0
    v_mfma_f32_16x16x32_bf16 v[116:119], v[182:185], v[76:79], 0
    v_cvt_pk_bf16_f32 v80, v24, v25
    v_cvt_pk_bf16_f32 v81, v26, v27
    v_cvt_pk_bf16_f32 v82, v28, v29
    v_cvt_pk_bf16_f32 v83, v30, v31
    v_fma_f32 v32, v32, s18, v94
    buffer_load_dwordx4 a[36:39], v5, s[8:11], s34 offen offset:1024 sc1
    v_fma_f32 v33, v33, s18, v94
    v_fma_f32 v34, v34, s18, v94
    v_fma_f32 v35, v35, s18, v94
    v_fma_f32 v36, v36, s18, v94
    v_fma_f32 v37, v37, s18, v94
    v_fma_f32 v38, v38, s18, v94
    v_fma_f32 v39, v39, s18, v94
    v_exp_f32 v32, v32
    v_exp_f32 v33, v33
    buffer_load_dwordx4 a[40:43], v253, s[8:11], s32 offen offset:2048 sc1
    v_exp_f32 v34, v34
    v_exp_f32 v35, v35
    v_exp_f32 v36, v36
    v_exp_f32 v37, v37
    v_exp_f32 v38, v38
    v_exp_f32 v39, v39
    v_mfma_f32_16x16x32_bf16 v[104:107], v[174:177], v[80:83], 0
    v_mfma_f32_16x16x32_bf16 v[120:123], v[184:187], v[80:83], 0
    v_cvt_pk_bf16_f32 v84, v32, v33
    buffer_load_dwordx4 a[44:47], v253, s[8:11], s33 offen offset:2048 sc1
    v_cvt_pk_bf16_f32 v85, v34, v35
    v_cvt_pk_bf16_f32 v86, v36, v37
    v_cvt_pk_bf16_f32 v87, v38, v39
    v_fma_f32 v40, v40, s18, v95
    v_fma_f32 v41, v41, s18, v95
    v_fma_f32 v42, v42, s18, v95
    v_fma_f32 v43, v43, s18, v95
    v_fma_f32 v44, v44, s18, v95
    v_fma_f32 v45, v45, s18, v95
    buffer_load_dwordx4 a[48:51], v5, s[8:11], s34 offen offset:2048 sc1
    v_fma_f32 v46, v46, s18, v95
    v_fma_f32 v47, v47, s18, v95
    v_exp_f32 v40, v40
    v_exp_f32 v41, v41
    v_exp_f32 v42, v42
    v_exp_f32 v43, v43
    v_exp_f32 v44, v44
    v_exp_f32 v45, v45
    v_exp_f32 v46, v46
    buffer_load_dwordx4 a[52:55], v253, s[8:11], s32 offen offset:3072 sc1
    s_add_u32 s32, s32, 4096
    v_exp_f32 v47, v47
    v_mfma_f32_16x16x32_bf16 v[108:111], v[176:179], v[84:87], 0
    v_mfma_f32_16x16x32_bf16 v[124:127], v[186:189], v[84:87], 0
    v_cvt_pk_bf16_f32 v88, v40, v41
    v_cvt_pk_bf16_f32 v89, v42, v43
    v_cvt_pk_bf16_f32 v90, v44, v45
    v_cvt_pk_bf16_f32 v91, v46, v47
    v_rcp_f32 v96, v118
    v_rcp_f32 v97, v122
    buffer_load_dwordx4 v[240:243], v9, s[8:11], s37 offen offset:0 sc1
    v_mfma_f32_16x16x32_bf16 v[112:115], v[178:181], v[88:91], 0
    v_mfma_f32_16x16x32_bf16 v[128:131], v[188:191], v[88:91], 0
    v_pk_mul_f32 v[100:101], v[96:97], v[100:101] op_sel:[0,0] op_sel_hi:[0,1]
    v_pk_mul_f32 v[102:103], v[96:97], v[102:103] op_sel:[0,0] op_sel_hi:[0,1]
    v_pk_mul_f32 v[116:117], v[96:97], v[116:117] op_sel:[0,0] op_sel_hi:[0,1]
    v_cvt_pk_bf16_f32 v212, v100, v101
    v_cvt_pk_bf16_f32 v213, v102, v103
    v_cvt_pk_bf16_f32 v220, v116, v117
    v_rcp_f32 v98, v126
    buffer_load_dwordx4 v[244:247], v9, s[8:11], s37 offen offset:1024 sc1
    v_pk_mul_f32 v[104:105], v[96:97], v[104:105] op_sel:[1,0] op_sel_hi:[1,1]
    v_pk_mul_f32 v[106:107], v[96:97], v[106:107] op_sel:[1,0] op_sel_hi:[1,1]
    v_pk_mul_f32 v[120:121], v[96:97], v[120:121] op_sel:[1,0] op_sel_hi:[1,1]
    v_cvt_pk_bf16_f32 v214, v104, v105
    v_cvt_pk_bf16_f32 v215, v106, v107
    v_cvt_pk_bf16_f32 v221, v120, v121
    v_rcp_f32 v99, v130
    v_permlane16_swap_b32 v212, v214
    v_permlane16_swap_b32 v213, v215
    buffer_load_dwordx4 v[248:251], v7, s[8:11], s37 offen offset:2048 sc1
    v_pk_mul_f32 v[108:109], v[98:99], v[108:109] op_sel:[0,0] op_sel_hi:[0,1]
    v_pk_mul_f32 v[110:111], v[98:99], v[110:111] op_sel:[0,0] op_sel_hi:[0,1]
    v_pk_mul_f32 v[124:125], v[98:99], v[124:125] op_sel:[0,0] op_sel_hi:[0,1]
    v_cvt_pk_bf16_f32 v216, v108, v109
    v_cvt_pk_bf16_f32 v217, v110, v111
    v_cvt_pk_bf16_f32 v222, v124, v125
    v_pk_mul_f32 v[112:113], v[98:99], v[112:113] op_sel:[1,0] op_sel_hi:[1,1]
    v_pk_mul_f32 v[114:115], v[98:99], v[114:115] op_sel:[1,0] op_sel_hi:[1,1]
    v_pk_mul_f32 v[128:129], v[98:99], v[128:129] op_sel:[1,0] op_sel_hi:[1,1]
    buffer_load_dword v252, v8, s[8:11], s47 offen sc1
    v_cvt_pk_bf16_f32 v218, v112, v113
    v_cvt_pk_bf16_f32 v219, v114, v115
    v_cvt_pk_bf16_f32 v223, v128, v129
    s_lshl_b32 s7, s3, 2
    s_add_u32 s7, s7, 94208
    v_permlane16_swap_b32 v220, v221
    v_permlane16_swap_b32 v222, v223
    v_add_u32 v11, s7, v253
    v_lshrrev_b32 v10, 3, v0
    v_permlane32_swap_b32 v220, v222
    v_mul_u32_u24 v10, 9216, v10
    ds_write_b32 v11, v220
    v_permlane16_swap_b32 v216, v218
    v_permlane16_swap_b32 v217, v219
    s_mul_i32 s7, s40, 1152
    s_add_u32 s22, s22, s7
    s_add_u32 s22, s22, 41156608
    s_lshl_b32 s7, s3, 8
    s_add_u32 s23, s22, s7
    s_add_u32 s24, s23, 36864
    buffer_store_dwordx4 v[212:215], v9, s[8:11], s23 offen sc1
    buffer_store_dwordx4 v[216:219], v9, s[8:11], s24 offen sc1
    v_and_b32 v11, 7, v0
    v_lshl_add_u32 v10, v11, 4, v10
    s_cmp_eq_u32 s3, 3
    s_cselect_b32 s7, 0, 1073741824
    v_add_u32 v10, s7, v10
    v_add_u32 v11, 94208, v253
    s_waitcnt lgkmcnt(0)
    s_barrier
    ds_read_b128 v[220:223], v11
    s_waitcnt lgkmcnt(0)
    buffer_store_dwordx4 v[220:223], v10, s[8:11], s22 offen offset:1024 sc1
    v_lshlrev_b32 v15, 7, v0
    s_lshl_b32 s6, s40, 2
    s_add_u32 s6, s6, s44
    v_mov_b32 v1, s76
    s_mov_b64 vcc, 0xff
    s_waitcnt vmcnt(0)
    s_barrier
    s_cmp_lg_u32 s3, 0
    s_cbranch_scc1 L_pub_23
    s_mov_b64 exec, vcc
    buffer_store_dword v1, v15, s[8:11], s6 offen sc1
L_pub_23:
    s_mov_b64 exec, -1
    buffer_load_dwordx4 a[56:59], v253, s[8:11], s33 offen offset:3072 sc1
    s_add_u32 s33, s33, 4096
    buffer_load_dwordx4 a[60:63], v5, s[8:11], s34 offen offset:3072 sc1
    s_add_u32 s34, s34, 4096
    buffer_load_dwordx4 a[64:67], v253, s[8:11], s32 offen offset:0 sc1
    buffer_load_dwordx4 a[68:71], v253, s[8:11], s33 offen offset:0 sc1
    buffer_load_dwordx4 a[72:75], v5, s[8:11], s34 offen offset:0 sc1
    buffer_load_dwordx4 a[76:79], v253, s[8:11], s32 offen offset:1024 sc1
    buffer_load_dwordx4 a[80:83], v253, s[8:11], s33 offen offset:1024 sc1
    buffer_load_dwordx4 a[84:87], v5, s[8:11], s34 offen offset:1024 sc1
    s_cmp_lg_u32 s42, 0
    s_cbranch_scc1 L_swz_24
    s_cmp_eq_u32 s93, 2
    s_cselect_b32 s6, 2, 3
    s_mov_b32 s7, 512
    s_cmov_b32 s7, 2048
    v_lshrrev_b32 v14, 4, v0
    v_lshlrev_b32 v14, s6, v14
    v_bfe_u32 v15, v0, 2, 2
    v_add_u32 v14, v14, v15
    v_mul_u32_u24 v14, 128, v14
    v_and_b32 v15, 3, v0
    v_lshl_add_u32 v14, v15, 3, v14
    v_add_u32 v14, s79, v14
    v_add_u32 v15, s7, v14
    ds_read_b64_tr_b16 v[76:77], v14 offset:8192
    ds_read_b64_tr_b16 v[78:79], v15 offset:8192
    ds_read_b64_tr_b16 v[80:81], v14 offset:8224
    ds_read_b64_tr_b16 v[82:83], v15 offset:8224
    ds_read_b64_tr_b16 v[84:85], v14 offset:8256
    ds_read_b64_tr_b16 v[86:87], v15 offset:8256
    ds_read_b64_tr_b16 v[88:89], v14 offset:8288
    ds_read_b64_tr_b16 v[90:91], v15 offset:8288
    ds_read_b64_tr_b16 v[92:93], v14 offset:12288
    ds_read_b64_tr_b16 v[94:95], v15 offset:12288
    ds_read_b64_tr_b16 v[96:97], v14 offset:12320
    ds_read_b64_tr_b16 v[98:99], v15 offset:12320
    ds_read_b64_tr_b16 v[176:177], v14 offset:12352
    ds_read_b64_tr_b16 v[178:179], v15 offset:12352
    ds_read_b64_tr_b16 v[180:181], v14 offset:12384
    ds_read_b64_tr_b16 v[182:183], v15 offset:12384
    s_waitcnt lgkmcnt(0)
    s_add_u32 s7, s78, 0
    buffer_store_dwordx4 v[76:79], v253, s[8:11], s7 offen sc1
    s_add_u32 s7, s78, 497664
    buffer_store_dwordx4 v[80:83], v253, s[8:11], s7 offen sc1
    s_add_u32 s7, s78, 995328
    buffer_store_dwordx4 v[84:87], v253, s[8:11], s7 offen sc1
    s_add_u32 s7, s78, 1492992
    buffer_store_dwordx4 v[88:91], v253, s[8:11], s7 offen sc1
    s_add_u32 s7, s70, 0
    buffer_store_dwordx4 v[92:95], v253, s[8:11], s7 offen sc1
    s_add_u32 s7, s70, 497664
    buffer_store_dwordx4 v[96:99], v253, s[8:11], s7 offen sc1
    s_add_u32 s7, s70, 995328
    buffer_store_dwordx4 v[176:179], v253, s[8:11], s7 offen sc1
    s_add_u32 s7, s70, 1492992
    buffer_store_dwordx4 v[180:183], v253, s[8:11], s7 offen sc1
    s_lshr_b32 s7, s2, 3
    s_lshl_b32 s7, s7, 2
    s_add_u32 s7, s7, s3
    s_lshl_b32 s7, s7, 9
    v_lshrrev_b32 v1, 1, v253
    v_add_u32 v1, s7, v1
    buffer_load_dwordx2 v[14:15], v1, s[96:99], 0 offen
L_swz_24:
    s_and_b32 s7, s3, 1
    s_mul_i32 s7, s7, 18432
    s_add_u32 s24, s30, s7
    s_lshr_b32 s7, s3, 1
    s_lshl_b32 s7, s7, 9
    s_add_u32 s24, s24, s7
    s_add_u32 s24, s24, 41156608
    s_mov_b32 s16, 0xffff0000
    v_lshlrev_b32 v124, 16, v240
    v_and_b32 v125, s16, v240
    v_lshlrev_b32 v126, 16, v241
    v_and_b32 v127, s16, v241
    v_lshlrev_b32 v128, 16, v242
    v_and_b32 v129, s16, v242
    v_lshlrev_b32 v130, 16, v243
    v_and_b32 v131, s16, v243
    v_lshlrev_b32 v132, 16, v244
    v_and_b32 v133, s16, v244
    v_lshlrev_b32 v134, 16, v245
    v_and_b32 v135, s16, v245
    v_lshlrev_b32 v136, 16, v246
    v_and_b32 v137, s16, v246
    v_lshlrev_b32 v138, 16, v247
    v_and_b32 v139, s16, v247
    v_lshlrev_b32 v140, 16, v248
    v_and_b32 v141, s16, v248
    v_lshlrev_b32 v142, 16, v249
    v_and_b32 v143, s16, v249
    v_lshlrev_b32 v144, 16, v250
    v_and_b32 v145, s16, v250
    v_lshlrev_b32 v146, 16, v251
    v_and_b32 v147, s16, v251
    s_cmp_eq_u32 s3, 1
    s_cselect_b32 s7, 16, 0
    v_lshlrev_b32 v12, 2, v0
    v_cmp_gt_u32 vcc, s7, v0
    v_add_u32 v10, 40960, v12
    v_add_u32 v11, 41472, v12
    v_cndmask_b32 v10, v11, v10, vcc
    v_and_b32 v11, 0x7c, v12
    v_cmp_gt_u32 vcc, 32, v0
    v_mov_b32 v13, 1073741824
    s_and_b32 s7, s40, 3
    s_lshl_b32 s45, s45, 2
    v_cndmask_b32 v8, v13, v12, vcc
    s_add_u32 s6, s7, s3
    s_cmp_eq_u32 s6, 0
    s_cselect_b32 s6, 0, 1073741824
    v_add_u32 v6, s6, v8
    s_add_u32 s45, s45, s7
    s_lshl_b32 s45, s45, 2
    s_add_u32 s45, s45, s3
    s_lshl_b32 s45, s45, 7
    s_add_u32 s45, s45, s43
    s_add_u32 s45, s45, 48300032
    s_cmp_eq_u32 s3, 0
    s_cselect_b32 s35, 1.0, 0
    s_lshl_b32 s7, s40, 2
    s_add_u32 s7, s7, s3
    s_mul_i32 s23, s7, 497664
    s_add_u32 s23, s23, 3145728
    s_add_u32 s50, s23, 497664
    s_mul_i32 s50, s50, s42
    v_mov_b32 v184, v253
    v_add_u32 v185, 4096, v253
    v_add_u32 v186, 8192, v253
    v_add_u32 v187, 12288, v253
    v_add_u32 v188, 16384, v253
    v_add_u32 v189, 20480, v253
    v_add_u32 v190, 24576, v253
    v_add_u32 v191, 28672, v253
    v_add_u32 v192, 32768, v253
    s_cmp_lg_u32 s3, 3
    s_cbranch_scc1 L_pollout_27
    s_lshl_b32 s7, s40, 7
    s_add_u32 s7, s7, s44
    s_add_u32 s52, s4, s7
    s_addc_u32 s53, s5, 0
    s_mov_b32 s6, 0
L_poll_25:
    s_load_dwordx8 s[56:63], s[52:53], 0 glc
    s_add_u32 s6, s6, 1
    s_waitcnt lgkmcnt(0)
    s_xor_b64 s[56:57], s[56:57], s[76:77]
    s_xor_b64 s[58:59], s[58:59], s[76:77]
    s_xor_b64 s[60:61], s[60:61], s[76:77]
    s_xor_b64 s[62:63], s[62:63], s[76:77]
    s_or_b64 s[56:57], s[56:57], s[58:59]
    s_or_b64 s[60:61], s[60:61], s[62:63]
    s_or_b64 s[56:57], s[56:57], s[60:61]
    s_cbranch_scc0 L_polled_26
    s_cmp_lt_u32 s6, 1048576
    s_cbranch_scc1 L_poll_25
    s_branch L_main_end
L_polled_26:
L_pollout_27:
    s_barrier
    s_lshl_b32 m0, s3, 10
    s_nop 0
    buffer_load_dwordx4 v2, s[8:11], s24 offen sc1 lds
    s_add_u32 m0, m0, 4096
    s_add_u32 s24, s24, 1024
    buffer_load_dwordx4 v2, s[8:11], s24 offen sc1 lds
    s_add_u32 m0, m0, 4096
    s_add_u32 s24, s24, 1024
    buffer_load_dwordx4 v2, s[8:11], s24 offen sc1 lds
    s_add_u32 m0, m0, 4096
    s_add_u32 s24, s24, 1024
    buffer_load_dwordx4 v2, s[8:11], s24 offen sc1 lds
    s_add_u32 m0, m0, 4096
    s_add_u32 s24, s24, 1024
    buffer_load_dwordx4 v2, s[8:11], s24 offen sc1 lds
    s_add_u32 m0, m0, 4096
    s_add_u32 s24, s24, 1024
    buffer_load_dwordx4 v2, s[8:11], s24 offen sc1 lds
    s_add_u32 m0, m0, 4096
    s_add_u32 s24, s24, 1024
    buffer_load_dwordx4 v2, s[8:11], s24 offen sc1 lds
    s_add_u32 m0, m0, 4096
    s_add_u32 s24, s24, 1024
    buffer_load_dwordx4 v2, s[8:11], s24 offen sc1 lds
    s_add_u32 m0, m0, 4096
    s_add_u32 s24, s24, 1024
    buffer_load_dwordx4 v2, s[8:11], s24 offen sc1 lds
    s_waitcnt vmcnt(4)
    s_barrier
    s_xor_b32 s7, s3, 0
    s_or_b32 s7, s7, s42
    s_cbranch_scc1 L_swz_28
    s_lshl_b32 s6, s40, 7
    s_lshl_b32 s7, s41, 2
    s_add_u32 s6, s6, s7
    s_add_u32 s6, s6, 19464192
    s_mov_b64 exec, 0xffffffff
    v_lshlrev_b32 v15, 10, v0
    v_mov_b32 v1, s76
    buffer_store_dword v1, v15, s[8:11], s6 offen sc1
    s_mov_b64 exec, -1
L_swz_28:
    ds_read_b128 v[160:163], v253 offset:0
    ds_read_b128 v[164:167], v253 offset:1024
    s_waitcnt lgkmcnt(0)
    v_mfma_f32_16x16x32_bf16 v[100:103], a[160:163], v[160:163], 0
    ds_read_b128 v[168:171], v253 offset:2048
    v_mfma_f32_16x16x32_bf16 v[104:107], a[160:163], v[164:167], 0
    ds_read_b128 v[172:175], v253 offset:3072
    v_mfma_f32_16x16x32_bf16 v[108:111], a[164:167], v[160:163], 0
    v_mfma_f32_16x16x32_bf16 v[112:115], a[164:167], v[164:167], 0
    buffer_load_dwordx4 v[16:19], v184, s[48:51], s23 offen offset:0 sc1
    v_mfma_f32_16x16x32_bf16 v[116:119], a[168:171], v[160:163], 0
    v_mfma_f32_16x16x32_bf16 v[120:123], a[168:171], v[164:167], 0
    s_waitcnt lgkmcnt(0)
    v_mfma_f32_16x16x32_bf16 v[100:103], a[172:175], v[168:171], v[100:103]
    ds_read_b128 v[160:163], v253 offset:4096
    v_mfma_f32_16x16x32_bf16 v[104:107], a[172:175], v[172:175], v[104:107]
    ds_read_b128 v[164:167], v253 offset:5120
    v_mfma_f32_16x16x32_bf16 v[108:111], a[176:179], v[168:171], v[108:111]
    v_mfma_f32_16x16x32_bf16 v[112:115], a[176:179], v[172:175], v[112:115]
    buffer_load_dwordx4 v[20:23], v184, s[48:51], s23 offen offset:1024 sc1
    v_mfma_f32_16x16x32_bf16 v[116:119], a[180:183], v[168:171], v[116:119]
    v_mfma_f32_16x16x32_bf16 v[120:123], a[180:183], v[172:175], v[120:123]
    s_waitcnt lgkmcnt(0)
    v_mfma_f32_16x16x32_bf16 v[100:103], a[184:187], v[160:163], v[100:103]
    ds_read_b128 v[168:171], v253 offset:6144
    v_mfma_f32_16x16x32_bf16 v[104:107], a[184:187], v[164:167], v[104:107]
    ds_read_b128 v[172:175], v253 offset:7168
    v_mfma_f32_16x16x32_bf16 v[108:111], a[188:191], v[160:163], v[108:111]
    v_mfma_f32_16x16x32_bf16 v[112:115], a[188:191], v[164:167], v[112:115]
    buffer_load_dwordx4 v[24:27], v184, s[48:51], s23 offen offset:2048 sc1
    v_mfma_f32_16x16x32_bf16 v[116:119], a[192:195], v[160:163], v[116:119]
    v_mfma_f32_16x16x32_bf16 v[120:123], a[192:195], v[164:167], v[120:123]
    s_waitcnt lgkmcnt(0)
    v_mfma_f32_16x16x32_bf16 v[100:103], a[196:199], v[168:171], v[100:103]
    ds_read_b128 v[160:163], v253 offset:8192
    v_mfma_f32_16x16x32_bf16 v[104:107], a[196:199], v[172:175], v[104:107]
    ds_read_b128 v[164:167], v253 offset:9216
    v_mfma_f32_16x16x32_bf16 v[108:111], a[200:203], v[168:171], v[108:111]
    v_mfma_f32_16x16x32_bf16 v[112:115], a[200:203], v[172:175], v[112:115]
    buffer_load_dwordx4 v[28:31], v184, s[48:51], s23 offen offset:3072 sc1
    v_mfma_f32_16x16x32_bf16 v[116:119], a[204:207], v[168:171], v[116:119]
    v_mfma_f32_16x16x32_bf16 v[120:123], a[204:207], v[172:175], v[120:123]
    s_waitcnt lgkmcnt(0)
    v_mfma_f32_16x16x32_bf16 v[100:103], a[208:211], v[160:163], v[100:103]
    ds_read_b128 v[168:171], v253 offset:10240
    v_mfma_f32_16x16x32_bf16 v[104:107], a[208:211], v[164:167], v[104:107]
    ds_read_b128 v[172:175], v253 offset:11264
    v_mfma_f32_16x16x32_bf16 v[108:111], a[212:215], v[160:163], v[108:111]
    v_mfma_f32_16x16x32_bf16 v[112:115], a[212:215], v[164:167], v[112:115]
    buffer_load_dwordx4 v[32:35], v185, s[48:51], s23 offen offset:0 sc1
    v_mfma_f32_16x16x32_bf16 v[116:119], a[216:219], v[160:163], v[116:119]
    v_mfma_f32_16x16x32_bf16 v[120:123], a[216:219], v[164:167], v[120:123]
    s_waitcnt lgkmcnt(0)
    v_mfma_f32_16x16x32_bf16 v[100:103], a[220:223], v[168:171], v[100:103]
    ds_read_b128 v[160:163], v253 offset:12288
    v_mfma_f32_16x16x32_bf16 v[104:107], a[220:223], v[172:175], v[104:107]
    ds_read_b128 v[164:167], v253 offset:13312
    v_mfma_f32_16x16x32_bf16 v[108:111], a[224:227], v[168:171], v[108:111]
    v_mfma_f32_16x16x32_bf16 v[112:115], a[224:227], v[172:175], v[112:115]
    buffer_load_dwordx4 v[36:39], v185, s[48:51], s23 offen offset:1024 sc1
    v_mfma_f32_16x16x32_bf16 v[116:119], a[228:231], v[168:171], v[116:119]
    v_mfma_f32_16x16x32_bf16 v[120:123], a[228:231], v[172:175], v[120:123]
    s_waitcnt lgkmcnt(0)
    v_mfma_f32_16x16x32_bf16 v[100:103], a[232:235], v[160:163], v[100:103]
    ds_read_b128 v[168:171], v253 offset:14336
    v_mfma_f32_16x16x32_bf16 v[104:107], a[232:235], v[164:167], v[104:107]
    ds_read_b128 v[172:175], v253 offset:15360
    v_mfma_f32_16x16x32_bf16 v[108:111], a[236:239], v[160:163], v[108:111]
    v_mfma_f32_16x16x32_bf16 v[112:115], a[236:239], v[164:167], v[112:115]
    buffer_load_dwordx4 v[40:43], v185, s[48:51], s23 offen offset:2048 sc1
    v_mfma_f32_16x16x32_bf16 v[116:119], a[240:243], v[160:163], v[116:119]
    v_mfma_f32_16x16x32_bf16 v[120:123], a[240:243], v[164:167], v[120:123]
    s_waitcnt lgkmcnt(0)
    v_mfma_f32_16x16x32_bf16 v[100:103], a[244:247], v[168:171], v[100:103]
    ds_read_b128 v[160:163], v253 offset:16384
    v_mfma_f32_16x16x32_bf16 v[104:107], a[244:247], v[172:175], v[104:107]
    ds_read_b128 v[164:167], v253 offset:17408
    v_mfma_f32_16x16x32_bf16 v[108:111], a[248:251], v[168:171], v[108:111]
    v_mfma_f32_16x16x32_bf16 v[112:115], a[248:251], v[172:175], v[112:115]
    buffer_load_dwordx4 v[44:47], v185, s[48:51], s23 offen offset:3072 sc1
    v_mfma_f32_16x16x32_bf16 v[116:119], a[252:255], v[168:171], v[116:119]
    v_mfma_f32_16x16x32_bf16 v[120:123], a[252:255], v[172:175], v[120:123]
    s_waitcnt lgkmcnt(0)
    v_mfma_f32_16x16x32_bf16 v[100:103], a[128:131], v[160:163], v[100:103]
    ds_read_b128 v[168:171], v253 offset:18432
    v_mfma_f32_16x16x32_bf16 v[104:107], a[128:131], v[164:167], v[104:107]
    ds_read_b128 v[172:175], v253 offset:19456
    v_mfma_f32_16x16x32_bf16 v[108:111], a[132:135], v[160:163], v[108:111]
    v_mfma_f32_16x16x32_bf16 v[112:115], a[132:135], v[164:167], v[112:115]
    buffer_load_dwordx4 v[48:51], v186, s[48:51], s23 offen offset:0 sc1
    v_mfma_f32_16x16x32_bf16 v[116:119], a[136:139], v[160:163], v[116:119]
    v_mfma_f32_16x16x32_bf16 v[120:123], a[136:139], v[164:167], v[120:123]
    s_xor_b32 s7, s3, 0
    s_or_b32 s7, s7, s42
    s_cbranch_scc1 L_wo_x_29
    s_waitcnt vmcnt(10) lgkmcnt(0)
    s_branch L_wo_x_30
L_wo_x_29:
    s_waitcnt vmcnt(9) lgkmcnt(0)
L_wo_x_30:
    s_barrier
    v_mfma_f32_16x16x32_bf16 v[100:103], a[140:143], v[168:171], v[100:103]
    ds_read_b128 v[160:163], v253 offset:20480
    v_mfma_f32_16x16x32_bf16 v[104:107], a[140:143], v[172:175], v[104:107]
    ds_read_b128 v[164:167], v253 offset:21504
    v_mfma_f32_16x16x32_bf16 v[108:111], a[144:147], v[168:171], v[108:111]
    v_mfma_f32_16x16x32_bf16 v[112:115], a[144:147], v[172:175], v[112:115]
    buffer_load_dwordx4 v[52:55], v186, s[48:51], s23 offen offset:1024 sc1
    v_mfma_f32_16x16x32_bf16 v[116:119], a[148:151], v[168:171], v[116:119]
    v_mfma_f32_16x16x32_bf16 v[120:123], a[148:151], v[172:175], v[120:123]
    s_waitcnt lgkmcnt(0)
    v_mfma_f32_16x16x32_bf16 v[100:103], a[152:155], v[160:163], v[100:103]
    ds_read_b128 v[168:171], v253 offset:22528
    v_mfma_f32_16x16x32_bf16 v[104:107], a[152:155], v[164:167], v[104:107]
    ds_read_b128 v[172:175], v253 offset:23552
    v_mfma_f32_16x16x32_bf16 v[108:111], a[156:159], v[160:163], v[108:111]
    v_mfma_f32_16x16x32_bf16 v[112:115], a[156:159], v[164:167], v[112:115]
    buffer_load_dwordx4 v[56:59], v186, s[48:51], s23 offen offset:2048 sc1
    v_mfma_f32_16x16x32_bf16 v[116:119], a[0:3], v[160:163], v[116:119]
    v_mfma_f32_16x16x32_bf16 v[120:123], a[0:3], v[164:167], v[120:123]
    s_waitcnt lgkmcnt(0)
    v_mfma_f32_16x16x32_bf16 v[100:103], a[4:7], v[168:171], v[100:103]
    ds_read_b128 v[160:163], v253 offset:24576
    v_mfma_f32_16x16x32_bf16 v[104:107], a[4:7], v[172:175], v[104:107]
    ds_read_b128 v[164:167], v253 offset:25600
    v_mfma_f32_16x16x32_bf16 v[108:111], a[8:11], v[168:171], v[108:111]
    v_mfma_f32_16x16x32_bf16 v[112:115], a[8:11], v[172:175], v[112:115]
    buffer_load_dwordx4 v[60:63], v186, s[48:51], s23 offen offset:3072 sc1
    v_mfma_f32_16x16x32_bf16 v[116:119], a[12:15], v[168:171], v[116:119]
    v_mfma_f32_16x16x32_bf16 v[120:123], a[12:15], v[172:175], v[120:123]
    s_waitcnt lgkmcnt(0)
    v_mfma_f32_16x16x32_bf16 v[100:103], a[16:19], v[160:163], v[100:103]
    ds_read_b128 v[168:171], v253 offset:26624
    v_mfma_f32_16x16x32_bf16 v[104:107], a[16:19], v[164:167], v[104:107]
    ds_read_b128 v[172:175], v253 offset:27648
    v_mfma_f32_16x16x32_bf16 v[108:111], a[20:23], v[160:163], v[108:111]
    v_mfma_f32_16x16x32_bf16 v[112:115], a[20:23], v[164:167], v[112:115]
    buffer_load_dwordx4 v[64:67], v187, s[48:51], s23 offen offset:0 sc1
    v_mfma_f32_16x16x32_bf16 v[116:119], a[24:27], v[160:163], v[116:119]
    v_mfma_f32_16x16x32_bf16 v[120:123], a[24:27], v[164:167], v[120:123]
    s_waitcnt lgkmcnt(0)
    v_mfma_f32_16x16x32_bf16 v[100:103], a[28:31], v[168:171], v[100:103]
    ds_read_b128 v[160:163], v253 offset:28672
    v_mfma_f32_16x16x32_bf16 v[104:107], a[28:31], v[172:175], v[104:107]
    ds_read_b128 v[164:167], v253 offset:29696
    v_mfma_f32_16x16x32_bf16 v[108:111], a[32:35], v[168:171], v[108:111]
    v_mfma_f32_16x16x32_bf16 v[112:115], a[32:35], v[172:175], v[112:115]
    buffer_load_dwordx4 v[68:71], v187, s[48:51], s23 offen offset:1024 sc1
    v_mfma_f32_16x16x32_bf16 v[116:119], a[36:39], v[168:171], v[116:119]
    v_mfma_f32_16x16x32_bf16 v[120:123], a[36:39], v[172:175], v[120:123]
    s_waitcnt lgkmcnt(0)
    v_mfma_f32_16x16x32_bf16 v[100:103], a[40:43], v[160:163], v[100:103]
    ds_read_b128 v[168:171], v253 offset:30720
    v_mfma_f32_16x16x32_bf16 v[104:107], a[40:43], v[164:167], v[104:107]
    ds_read_b128 v[172:175], v253 offset:31744
    v_mfma_f32_16x16x32_bf16 v[108:111], a[44:47], v[160:163], v[108:111]
    v_mfma_f32_16x16x32_bf16 v[112:115], a[44:47], v[164:167], v[112:115]
    buffer_load_dwordx4 v[72:75], v187, s[48:51], s23 offen offset:2048 sc1
    v_mfma_f32_16x16x32_bf16 v[116:119], a[48:51], v[160:163], v[116:119]
    v_mfma_f32_16x16x32_bf16 v[120:123], a[48:51], v[164:167], v[120:123]
    s_waitcnt lgkmcnt(0)
    v_mfma_f32_16x16x32_bf16 v[100:103], a[52:55], v[168:171], v[100:103]
    ds_read_b128 v[160:163], v253 offset:32768
    v_mfma_f32_16x16x32_bf16 v[104:107], a[52:55], v[172:175], v[104:107]
    ds_read_b128 v[164:167], v253 offset:33792
    v_mfma_f32_16x16x32_bf16 v[108:111], a[56:59], v[168:171], v[108:111]
    v_mfma_f32_16x16x32_bf16 v[112:115], a[56:59], v[172:175], v[112:115]
    v_mfma_f32_16x16x32_bf16 v[116:119], a[60:63], v[168:171], v[116:119]
    v_mfma_f32_16x16x32_bf16 v[120:123], a[60:63], v[172:175], v[120:123]
    s_waitcnt lgkmcnt(0)
    v_mfma_f32_16x16x32_bf16 v[100:103], a[64:67], v[160:163], v[100:103]
    ds_read_b128 v[168:171], v253 offset:34816
    v_mfma_f32_16x16x32_bf16 v[104:107], a[64:67], v[164:167], v[104:107]
    ds_read_b128 v[172:175], v253 offset:35840
    v_mfma_f32_16x16x32_bf16 v[108:111], a[68:71], v[160:163], v[108:111]
    v_mfma_f32_16x16x32_bf16 v[112:115], a[68:71], v[164:167], v[112:115]
    v_mfma_f32_16x16x32_bf16 v[116:119], a[72:75], v[160:163], v[116:119]
    v_mfma_f32_16x16x32_bf16 v[120:123], a[72:75], v[164:167], v[120:123]
    s_waitcnt lgkmcnt(0)
    v_mfma_f32_16x16x32_bf16 v[100:103], a[76:79], v[168:171], v[100:103]
    v_mfma_f32_16x16x32_bf16 v[104:107], a[76:79], v[172:175], v[104:107]
    v_mfma_f32_16x16x32_bf16 v[108:111], a[80:83], v[168:171], v[108:111]
    v_mfma_f32_16x16x32_bf16 v[112:115], a[80:83], v[172:175], v[112:115]
    v_mfma_f32_16x16x32_bf16 v[116:119], a[84:87], v[168:171], v[116:119]
    v_mfma_f32_16x16x32_bf16 v[120:123], a[84:87], v[172:175], v[120:123]
    s_nop 3
    v_permlane16_swap_b32 v100, v104
    v_permlane16_swap_b32 v101, v105
    v_permlane16_swap_b32 v102, v106
    v_permlane16_swap_b32 v103, v107
    v_add_f32 v12, v116, v117
    v_add_f32 v13, v120, v121
    ds_write_b32 v10, v12
    ds_write_b32 v10, v13 offset:64
    v_permlane16_swap_b32 v108, v112
    v_permlane16_swap_b32 v109, v113
    v_permlane16_swap_b32 v110, v114
    v_permlane16_swap_b32 v111, v115
    v_permlane16_swap_b32 v116, v120
    v_permlane16_swap_b32 v117, v121
    v_permlane16_swap_b32 v118, v122
    v_permlane16_swap_b32 v119, v123
    s_waitcnt lgkmcnt(0)
    s_barrier
    ds_read_b32 v12, v11 offset:40960
    v_pk_add_f32 v[124:125], v[124:125], v[100:101]
    v_pk_add_f32 v[126:127], v[126:127], v[102:103]
    v_pk_add_f32 v[128:129], v[128:129], v[104:105]
    v_pk_add_f32 v[130:131], v[130:131], v[106:107]
    v_pk_add_f32 v[132:133], v[132:133], v[108:109]
    v_pk_add_f32 v[134:135], v[134:135], v[110:111]
    v_pk_add_f32 v[136:137], v[136:137], v[112:113]
    v_pk_add_f32 v[138:139], v[138:139], v[114:115]
    v_pk_add_f32 v[140:141], v[140:141], v[116:117]
    v_pk_add_f32 v[142:143], v[142:143], v[118:119]
    v_pk_add_f32 v[144:145], v[144:145], v[120:121]
    v_pk_add_f32 v[146:147], v[146:147], v[122:123]
    v_mov_b32 v14, 0
    v_mov_b32 v15, 0
    s_waitcnt lgkmcnt(0)
    v_add_f32 v12, v12, v252
    v_pk_add_f32 v[100:101], v[124:125], v[12:13] op_sel_hi:[1,0] neg_lo:[0,1] neg_hi:[0,1]
    v_pk_add_f32 v[102:103], v[126:127], v[12:13] op_sel_hi:[1,0] neg_lo:[0,1] neg_hi:[0,1]
    v_pk_add_f32 v[104:105], v[128:129], v[12:13] op_sel_hi:[1,0] neg_lo:[0,1] neg_hi:[0,1]
    v_pk_add_f32 v[106:107], v[130:131], v[12:13] op_sel_hi:[1,0] neg_lo:[0,1] neg_hi:[0,1]
    v_cvt_pk_bf16_f32 v148, v100, v101
    v_cvt_pk_bf16_f32 v149, v102, v103
    v_cvt_pk_bf16_f32 v150, v104, v105
    v_cvt_pk_bf16_f32 v151, v106, v107
    buffer_store_dwordx4 v[148:151], v9, s[8:11], s46 offen offset:0 sc1
    v_pk_add_f32 v[108:109], v[132:133], v[12:13] op_sel_hi:[1,0] neg_lo:[0,1] neg_hi:[0,1]
    v_pk_add_f32 v[110:111], v[134:135], v[12:13] op_sel_hi:[1,0] neg_lo:[0,1] neg_hi:[0,1]
    v_pk_add_f32 v[112:113], v[136:137], v[12:13] op_sel_hi:[1,0] neg_lo:[0,1] neg_hi:[0,1]
    v_pk_add_f32 v[114:115], v[138:139], v[12:13] op_sel_hi:[1,0] neg_lo:[0,1] neg_hi:[0,1]
    v_cvt_pk_bf16_f32 v152, v108, v109
    v_cvt_pk_bf16_f32 v153, v110, v111
    v_cvt_pk_bf16_f32 v154, v112, v113
    v_cvt_pk_bf16_f32 v155, v114, v115
    buffer_store_dwordx4 v[152:155], v9, s[8:11], s46 offen offset:1024 sc1
    v_pk_add_f32 v[116:117], v[140:141], v[12:13] op_sel_hi:[1,0] neg_lo:[0,1] neg_hi:[0,1]
    v_pk_add_f32 v[118:119], v[142:143], v[12:13] op_sel_hi:[1,0] neg_lo:[0,1] neg_hi:[0,1]
    v_pk_add_f32 v[120:121], v[144:145], v[12:13] op_sel_hi:[1,0] neg_lo:[0,1] neg_hi:[0,1]
    v_pk_add_f32 v[122:123], v[146:147], v[12:13] op_sel_hi:[1,0] neg_lo:[0,1] neg_hi:[0,1]
    v_cvt_pk_bf16_f32 v156, v116, v117
    v_cvt_pk_bf16_f32 v157, v118, v119
    v_cvt_pk_bf16_f32 v158, v120, v121
    v_cvt_pk_bf16_f32 v159, v122, v123
    buffer_store_dwordx4 v[156:159], v7, s[8:11], s46 offen offset:2048 sc1
    v_dot2c_f32_bf16 v14, v148, v148
    v_dot2c_f32_bf16 v14, v149, v149
    v_dot2c_f32_bf16 v14, v150, v150
    v_dot2c_f32_bf16 v14, v151, v151
    v_dot2c_f32_bf16 v14, v152, v152
    v_dot2c_f32_bf16 v14, v153, v153
    v_dot2c_f32_bf16 v14, v154, v154
    v_dot2c_f32_bf16 v14, v155, v155
    v_dot2c_f32_bf16 v15, v156, v156
    v_dot2c_f32_bf16 v15, v157, v157
    v_dot2c_f32_bf16 v15, v158, v158
    v_dot2c_f32_bf16 v15, v159, v159
    buffer_store_dword v12, v6, s[8:11], s36 offen sc1
    s_nop 1
    v_fma_f32 v14, v15, s35, v14
    v_mov_b32 v15, v14
    s_nop 1
    v_permlane32_swap_b32 v14, v15
    v_add_f32 v14, v14, v15
    buffer_store_dword v14, v8, s[8:11], s45 offen sc1
    v_lshlrev_b32 v15, 7, v0
    s_lshl_b32 s6, s40, 2
    s_add_u32 s6, s6, s44
    s_add_u32 s6, s6, 32768
    v_mov_b32 v1, s76
    s_mov_b64 vcc, 0xff
    s_waitcnt vmcnt(0)
    s_barrier
    s_cmp_lg_u32 s3, 0
    s_cbranch_scc1 L_pub_31
    s_mov_b64 exec, vcc
    buffer_store_dword v1, v15, s[8:11], s6 offen sc1
L_pub_31:
    s_mov_b64 exec, -1
    s_lshl_b32 s7, s41, 2
    s_add_u32 s7, s7, s3
    s_mul_i32 s22, s7, 18432
    s_add_u32 s22, s22, s43
    s_add_u32 s22, s22, 45875200
    s_mul_i32 s24, s3, 18432
    s_lshl_b32 s25, s41, 12
    s_add_u32 s25, s25, s43
    s_add_u32 s25, s25, 48300032
    v_lshrrev_b32 v3, 5, v0
    v_and_b32 v10, 31, v0
    v_lshlrev_b32 v10, 2, v10
    v_lshl_add_u32 v3, v3, 11, v10
    v_add_u32 v11, 36864, v184
    s_mov_b32 s16, 0xffff0000
    s_lshl_b32 s7, s3, 10
    v_add_u32 v172, s7, v253
    v_add_u32 v174, 5120, v172
    v_and_b32 v178, 7, v0
    v_mul_u32_u24 v178, 1152, v178
    v_lshrrev_b32 v179, 3, v0
    v_lshl_add_u32 v178, v179, 4, v178
    s_lshl_b32 s7, s3, 7
    v_add_u32 v175, s7, v178
    v_add_u32 v177, 640, v175
    s_cmp_eq_u32 s3, 0
    s_mov_b32 s17, 1073741824
    s_cmov_b32 s17, 4096
    v_add_u32 v173, s17, v172
    s_mov_b32 s17, 1073741824
    s_cmov_b32 s17, 512
    v_add_u32 v176, s17, v175
    s_lshl_b32 s21, s41, 3
    s_add_u32 s21, s21, s40
    s_mul_i32 s18, s21, 9216
    s_mul_i32 s20, s21, 73728
    s_add_u32 s20, s20, 19922944
    v_bfe_u32 v1, v0, 3, 2
    s_mov_b32 s7, 73728
    v_mul_lo_u32 v178, v1, s7
    v_lshrrev_b32 v1, 5, v0
    v_lshl_add_u32 v178, v1, 7, v178
    v_and_b32 v1, 7, v0
    v_lshl_add_u32 v178, v1, 4, v178
    v_add_u32 v179, 294912, v178
    v_lshrrev_b32 v1, 5, v0
    v_and_b32 v15, 7, v0
    v_lshlrev_b32 v15, 4, v15
    v_lshl_add_u32 v15, v1, 7, v15
    s_lshl_b32 s7, s3, 8
    s_add_u32 s7, s7, 3072
    v_add_u32 v15, s7, v15
    v_bfe_u32 v1, v0, 3, 2
    v_mov_b32 v182, 1073741824
    v_add_u32 v183, 14336, v253
    s_sub_u32 s7, s40, 0
    v_cmp_eq_u32 vcc, s7, v1
    s_nop 1
    v_cndmask_b32 v178, v178, v182, vcc
    v_cndmask_b32 v216, v183, v15, vcc
    v_cndmask_b32 v218, 0, 1, vcc
    v_lshlrev_b32 v218, 10, v218
    s_sub_u32 s7, s40, 4
    v_cmp_eq_u32 vcc, s7, v1
    s_nop 1
    v_cndmask_b32 v179, v179, v182, vcc
    v_cndmask_b32 v217, v183, v15, vcc
    v_cndmask_b32 v219, 0, 1, vcc
    v_lshlrev_b32 v219, 10, v219
    s_mul_i32 s26, s41, 589824
    s_mul_i32 s7, s40, 9216
    s_add_u32 s26, s26, s7
    s_lshl_b32 s7, s3, 8
    s_add_u32 s27, s26, s7
    s_add_u32 s27, s27, 19921920
    s_mov_b32 s72, s8
    s_mov_b32 s73, s9
    s_mov_b32 s74, 0
    s_mul_i32 s7, s42, 98304
    s_sub_u32 s29, s44, s7
    s_add_u32 s29, s29, 360448
    s_lshl_b32 s7, s40, 7
    s_add_u32 s7, s7, s29
    s_add_u32 s38, s4, s7
    s_addc_u32 s39, s5, 0
    s_lshl_b32 s7, s40, 2
    s_add_u32 s29, s29, s7
    s_add_u32 s50, s23, 497664
    s_cmp_lg_u32 s42, 0
    s_cbranch_scc1 L_ring_32
    s_cmp_lg_u32 s3, 0
    s_cbranch_scc1 L_ring_33
    s_lshl_b32 s7, s41, 3
    s_add_u32 s7, s7, s40
    s_lshl_b32 s7, s7, 7
    s_add_u32 s7, s7, 19464192
    s_add_u32 s68, s4, s7
    s_addc_u32 s69, s5, 0
    s_mov_b32 s6, 0
    s_mov_b32 s7, 0
L_cpoll_34:
    s_load_dwordx16 s[52:67], s[68:69], s7 glc
    s_add_u32 s6, s6, 1
    s_waitcnt lgkmcnt(0)
    s_xor_b64 s[52:53], s[52:53], s[76:77]
    s_xor_b64 s[54:55], s[54:55], s[76:77]
    s_xor_b64 s[56:57], s[56:57], s[76:77]
    s_xor_b64 s[58:59], s[58:59], s[76:77]
    s_xor_b64 s[60:61], s[60:61], s[76:77]
    s_xor_b64 s[62:63], s[62:63], s[76:77]
    s_xor_b64 s[64:65], s[64:65], s[76:77]
    s_xor_b64 s[66:67], s[66:67], s[76:77]
    s_or_b64 s[52:53], s[52:53], s[60:61]
    s_or_b64 s[54:55], s[54:55], s[62:63]
    s_or_b64 s[56:57], s[56:57], s[64:65]
    s_or_b64 s[58:59], s[58:59], s[66:67]
    s_or_b64 s[52:53], s[52:53], s[56:57]
    s_or_b64 s[54:55], s[54:55], s[58:59]
    s_or_b64 s[52:53], s[52:53], s[54:55]
    s_cbranch_scc1 L_cpoll_35
    s_add_u32 s7, s7, 64
    s_cmp_eq_u32 s7, 128
    s_cbranch_scc1 L_cpolled_36
L_cpoll_35:
    s_cmp_lt_u32 s6, 1048576
    s_cbranch_scc1 L_cpoll_34
    s_branch L_main_end
L_cpolled_36:
L_ring_33:
    s_barrier
    buffer_load_dwordx4 v[16:19], v184, s[48:51], s23 offen offset:0 sc1
    buffer_load_dwordx4 v[20:23], v184, s[48:51], s23 offen offset:1024 sc1
    buffer_load_dwordx4 v[24:27], v184, s[48:51], s23 offen offset:2048 sc1
    buffer_load_dwordx4 v[28:31], v184, s[48:51], s23 offen offset:3072 sc1
    buffer_load_dwordx4 v[32:35], v185, s[48:51], s23 offen offset:0 sc1
    buffer_load_dwordx4 v[36:39], v185, s[48:51], s23 offen offset:1024 sc1
    buffer_load_dwordx4 v[40:43], v185, s[48:51], s23 offen offset:2048 sc1
    buffer_load_dwordx4 v[44:47], v185, s[48:51], s23 offen offset:3072 sc1
    buffer_load_dwordx4 v[48:51], v186, s[48:51], s23 offen offset:0 sc1
    buffer_load_dwordx4 v[52:55], v186, s[48:51], s23 offen offset:1024 sc1
    buffer_load_dwordx4 v[56:59], v186, s[48:51], s23 offen offset:2048 sc1
    buffer_load_dwordx4 v[60:63], v186, s[48:51], s23 offen offset:3072 sc1
    buffer_load_dwordx4 v[64:67], v187, s[48:51], s23 offen offset:0 sc1
    buffer_load_dwordx4 v[68:71], v187, s[48:51], s23 offen offset:1024 sc1
    buffer_load_dwordx4 v[72:75], v187, s[48:51], s23 offen offset:2048 sc1
L_ring_32:
    s_cmp_lg_u32 s3, 3
    s_cbranch_scc1 L_pollout_39
    s_lshl_b32 s7, s40, 7
    s_add_u32 s7, s7, s44
    s_add_u32 s7, s7, 32768
    s_add_u32 s52, s4, s7
    s_addc_u32 s53, s5, 0
    s_mov_b32 s6, 0
L_poll_37:
    s_load_dwordx8 s[56:63], s[52:53], 0 glc
    s_add_u32 s6, s6, 1
    s_waitcnt lgkmcnt(0)
    s_xor_b64 s[56:57], s[56:57], s[76:77]
    s_xor_b64 s[58:59], s[58:59], s[76:77]
    s_xor_b64 s[60:61], s[60:61], s[76:77]
    s_xor_b64 s[62:63], s[62:63], s[76:77]
    s_or_b64 s[56:57], s[56:57], s[58:59]
    s_or_b64 s[60:61], s[60:61], s[62:63]
    s_or_b64 s[56:57], s[56:57], s[60:61]
    s_cbranch_scc0 L_polled_38
    s_cmp_lt_u32 s6, 1048576
    s_cbranch_scc1 L_poll_37
    s_branch L_main_end
L_polled_38:
L_pollout_39:
    s_barrier
    s_add_u32 m0, s24, 0
    s_nop 0
    buffer_load_dwordx4 v2, s[8:11], s22 offen offset:0 sc1 lds
    s_add_u32 m0, s24, 512
    s_nop 0
    buffer_load_dwordx4 v2, s[8:11], s22 offen offset:512 sc1 lds
    s_add_u32 m0, s24, 1024
    s_nop 0
    buffer_load_dwordx4 v2, s[8:11], s22 offen offset:1024 sc1 lds
    s_add_u32 m0, s24, 1536
    s_nop 0
    buffer_load_dwordx4 v2, s[8:11], s22 offen offset:1536 sc1 lds
    s_add_u32 m0, s24, 2048
    s_nop 0
    buffer_load_dwordx4 v2, s[8:11], s22 offen offset:2048 sc1 lds
    s_add_u32 m0, s24, 2560
    s_nop 0
    buffer_load_dwordx4 v2, s[8:11], s22 offen offset:2560 sc1 lds
    s_add_u32 m0, s24, 3072
    s_nop 0
    buffer_load_dwordx4 v2, s[8:11], s22 offen offset:3072 sc1 lds
    s_add_u32 m0, s24, 3584
    s_nop 0
    buffer_load_dwordx4 v2, s[8:11], s22 offen offset:3584 sc1 lds
    s_add_u32 m0, s24, 8192
    s_add_u32 s22, s22, 4096
    buffer_load_dwordx4 v2, s[8:11], s22 offen offset:0 sc1 lds
    s_add_u32 m0, s24, 8704
    s_nop 0
    buffer_load_dwordx4 v2, s[8:11], s22 offen offset:512 sc1 lds
    s_add_u32 m0, s24, 9216
    s_nop 0
    buffer_load_dwordx4 v2, s[8:11], s22 offen offset:1024 sc1 lds
    s_add_u32 m0, s24, 9728
    s_nop 0
    buffer_load_dwordx4 v2, s[8:11], s22 offen offset:1536 sc1 lds
    s_add_u32 s23, s23, 15360
    s_lshr_b32 s7, s3, 1
    s_lshl_b32 s7, s7, 10
    s_and_b32 s6, s3, 1
    s_lshl_b32 s6, s6, 3
    s_add_u32 s28, s7, s6
    s_add_u32 s28, s28, 73728
    s_waitcnt vmcnt(6)
    s_barrier
    ds_read_b128 a[0:3], v184 offset:0
    ds_read_b128 a[72:75], v184 offset:18432
    ds_read_b128 a[144:147], v11 offset:0
    ds_read_b128 a[216:219], v11 offset:18432
    ds_read_b128 a[4:7], v184 offset:1024
    ds_read_b128 a[76:79], v184 offset:19456
    ds_read_b128 a[148:151], v11 offset:1024
    ds_read_b128 a[220:223], v11 offset:19456
    ds_read_b128 a[8:11], v184 offset:2048
    ds_read_b128 a[80:83], v184 offset:20480
    ds_read_b128 a[152:155], v11 offset:2048
    ds_read_b128 a[224:227], v11 offset:20480
    s_waitcnt vmcnt(24) lgkmcnt(0)
    v_mfma_f32_16x16x32_bf16 v[88:91], v[16:19], a[0:3], 0
    ds_read_b128 a[12:15], v184 offset:3072
    v_mfma_f32_16x16x32_bf16 v[88:91], v[20:23], a[4:7], v[88:91]
    buffer_load_dwordx4 v[76:79], v184, s[48:51], s23 offen offset:0 sc1
    v_mfma_f32_16x16x32_bf16 v[88:91], v[24:27], a[8:11], v[88:91]
    ds_read_b128 a[84:87], v184 offset:21504
    v_mfma_f32_16x16x32_bf16 v[92:95], v[16:19], a[72:75], 0
    s_add_u32 m0, s24, 10240
    s_nop 0
    buffer_load_dwordx4 v2, s[8:11], s22 offen offset:2048 sc1 lds
    v_mfma_f32_16x16x32_bf16 v[92:95], v[20:23], a[76:79], v[92:95]
    ds_read_b128 a[156:159], v11 offset:3072
    ds_read_b128 a[228:231], v11 offset:21504
    v_mfma_f32_16x16x32_bf16 v[92:95], v[24:27], a[80:83], v[92:95]
    buffer_load_dwordx4 v[80:83], v184, s[48:51], s23 offen offset:1024 sc1
    v_mfma_f32_16x16x32_bf16 v[96:99], v[16:19], a[144:147], 0
    ds_read_b128 a[16:19], v184 offset:4096
    v_mfma_f32_16x16x32_bf16 v[96:99], v[20:23], a[148:151], v[96:99]
    s_add_u32 m0, s24, 10752
    s_nop 0
    buffer_load_dwordx4 v2, s[8:11], s22 offen offset:2560 sc1 lds
    v_mfma_f32_16x16x32_bf16 v[96:99], v[24:27], a[152:155], v[96:99]
    ds_read_b128 a[88:91], v184 offset:22528
    v_mfma_f32_16x16x32_bf16 v[100:103], v[16:19], a[216:219], 0
    buffer_load_dwordx4 v[84:87], v184, s[48:51], s23 offen offset:2048 sc1
    v_mfma_f32_16x16x32_bf16 v[100:103], v[20:23], a[220:223], v[100:103]
    ds_read_b128 a[160:163], v11 offset:4096
    ds_read_b128 a[232:235], v11 offset:22528
    v_mfma_f32_16x16x32_bf16 v[100:103], v[24:27], a[224:227], v[100:103]
    s_add_u32 m0, s24, 11264
    s_nop 0
    buffer_load_dwordx4 v2, s[8:11], s22 offen offset:3072 sc1 lds
    s_waitcnt vmcnt(27) lgkmcnt(8)
    v_mfma_f32_16x16x32_bf16 v[104:107], v[28:31], a[0:3], 0
    ds_read_b128 a[20:23], v184 offset:5120
    v_mfma_f32_16x16x32_bf16 v[104:107], v[32:35], a[4:7], v[104:107]
    buffer_load_dwordx4 v[16:19], v184, s[48:51], s23 offen offset:3072 sc1
    v_mfma_f32_16x16x32_bf16 v[104:107], v[36:39], a[8:11], v[104:107]
    ds_read_b128 a[92:95], v184 offset:23552
    v_mfma_f32_16x16x32_bf16 v[108:111], v[28:31], a[72:75], 0
    s_add_u32 m0, s24, 11776
    s_nop 0
    buffer_load_dwordx4 v2, s[8:11], s22 offen offset:3584 sc1 lds
    v_mfma_f32_16x16x32_bf16 v[108:111], v[32:35], a[76:79], v[108:111]
    ds_read_b128 a[164:167], v11 offset:5120
    ds_read_b128 a[236:239], v11 offset:23552
    v_mfma_f32_16x16x32_bf16 v[108:111], v[36:39], a[80:83], v[108:111]
    buffer_load_dwordx4 v[20:23], v185, s[48:51], s23 offen offset:0 sc1
    v_mfma_f32_16x16x32_bf16 v[112:115], v[28:31], a[144:147], 0
    v_mfma_f32_16x16x32_bf16 v[112:115], v[32:35], a[148:151], v[112:115]
    s_add_u32 m0, s24, 16384
    s_add_u32 s22, s22, 4096
    buffer_load_dwordx4 v2, s[8:11], s22 offen offset:0 sc1 lds
    v_mfma_f32_16x16x32_bf16 v[112:115], v[36:39], a[152:155], v[112:115]
    v_mfma_f32_16x16x32_bf16 v[116:119], v[28:31], a[216:219], 0
    buffer_load_dwordx4 v[24:27], v185, s[48:51], s23 offen offset:1024 sc1
    v_mfma_f32_16x16x32_bf16 v[116:119], v[32:35], a[220:223], v[116:119]
    v_mfma_f32_16x16x32_bf16 v[116:119], v[36:39], a[224:227], v[116:119]
    s_add_u32 m0, s24, 16896
    s_nop 0
    buffer_load_dwordx4 v2, s[8:11], s22 offen offset:512 sc1 lds
    s_waitcnt vmcnt(12) lgkmcnt(0)
    s_barrier
    v_mfma_f32_16x16x32_bf16 v[88:91], v[40:43], a[12:15], v[88:91]
    ds_read_b128 a[24:27], v184 offset:6144
    v_mfma_f32_16x16x32_bf16 v[88:91], v[44:47], a[16:19], v[88:91]
    buffer_load_dwordx4 v[28:31], v185, s[48:51], s23 offen offset:2048 sc1
    v_mfma_f32_16x16x32_bf16 v[88:91], v[48:51], a[20:23], v[88:91]
    ds_read_b128 a[96:99], v184 offset:24576
    v_mfma_f32_16x16x32_bf16 v[92:95], v[40:43], a[84:87], v[92:95]
    buffer_load_dword v136, v3, s[8:11], s25 offen offset:0 sc1
    v_mfma_f32_16x16x32_bf16 v[92:95], v[44:47], a[88:91], v[92:95]
    ds_read_b128 a[168:171], v11 offset:6144
    ds_read_b128 a[240:243], v11 offset:24576
    v_mfma_f32_16x16x32_bf16 v[92:95], v[48:51], a[92:95], v[92:95]
    buffer_load_dwordx4 v[32:35], v185, s[48:51], s23 offen offset:3072 sc1
    v_mfma_f32_16x16x32_bf16 v[96:99], v[40:43], a[156:159], v[96:99]
    buffer_load_dword v137, v3, s[8:11], s25 offen offset:128 sc1
    v_mfma_f32_16x16x32_bf16 v[96:99], v[44:47], a[160:163], v[96:99]
    buffer_load_dword v138, v3, s[8:11], s25 offen offset:256 sc1
    v_mfma_f32_16x16x32_bf16 v[96:99], v[48:51], a[164:167], v[96:99]
    ds_read_b128 a[28:31], v184 offset:7168
    ds_read_b128 a[100:103], v184 offset:25600
    v_mfma_f32_16x16x32_bf16 v[100:103], v[40:43], a[228:231], v[100:103]
    buffer_load_dwordx4 v[36:39], v186, s[48:51], s23 offen offset:0 sc1
    v_mfma_f32_16x16x32_bf16 v[100:103], v[44:47], a[232:235], v[100:103]
    buffer_load_dword v139, v3, s[8:11], s25 offen offset:384 sc1
    v_mfma_f32_16x16x32_bf16 v[100:103], v[48:51], a[236:239], v[100:103]
    buffer_load_dword v140, v3, s[8:11], s25 offen offset:512 sc1
    s_waitcnt vmcnt(35) lgkmcnt(6)
    v_mfma_f32_16x16x32_bf16 v[104:107], v[52:55], a[12:15], v[104:107]
    ds_read_b128 a[172:175], v11 offset:7168
    ds_read_b128 a[244:247], v11 offset:25600
    v_mfma_f32_16x16x32_bf16 v[104:107], v[56:59], a[16:19], v[104:107]
    buffer_load_dwordx4 v[40:43], v186, s[48:51], s23 offen offset:1024 sc1
    v_mfma_f32_16x16x32_bf16 v[104:107], v[60:63], a[20:23], v[104:107]
    ds_read_b128 a[32:35], v184 offset:8192
    ds_read_b128 a[104:107], v184 offset:26624
    v_mfma_f32_16x16x32_bf16 v[108:111], v[52:55], a[84:87], v[108:111]
    buffer_load_dword v141, v3, s[8:11], s25 offen offset:640 sc1
    v_mfma_f32_16x16x32_bf16 v[108:111], v[56:59], a[88:91], v[108:111]
    ds_read_b128 a[176:179], v11 offset:8192
    ds_read_b128 a[248:251], v11 offset:26624
    v_mfma_f32_16x16x32_bf16 v[108:111], v[60:63], a[92:95], v[108:111]
    buffer_load_dwordx4 v[44:47], v186, s[48:51], s23 offen offset:2048 sc1
    v_mfma_f32_16x16x32_bf16 v[112:115], v[52:55], a[156:159], v[112:115]
    buffer_load_dword v142, v3, s[8:11], s25 offen offset:768 sc1
    v_mfma_f32_16x16x32_bf16 v[112:115], v[56:59], a[160:163], v[112:115]
    buffer_load_dword v143, v3, s[8:11], s25 offen offset:896 sc1
    v_mfma_f32_16x16x32_bf16 v[112:115], v[60:63], a[164:167], v[112:115]
    v_mfma_f32_16x16x32_bf16 v[116:119], v[52:55], a[228:231], v[116:119]
    buffer_load_dwordx4 v[48:51], v186, s[48:51], s23 offen offset:3072 sc1
    v_mfma_f32_16x16x32_bf16 v[116:119], v[56:59], a[232:235], v[116:119]
    buffer_load_dword v144, v3, s[8:11], s25 offen offset:1024 sc1
    v_mfma_f32_16x16x32_bf16 v[116:119], v[60:63], a[236:239], v[116:119]
    buffer_load_dword v145, v3, s[8:11], s25 offen offset:1152 sc1
    s_waitcnt vmcnt(40) lgkmcnt(0)
    v_mfma_f32_16x16x32_bf16 v[88:91], v[64:67], a[24:27], v[88:91]
    ds_read_b128 a[36:39], v184 offset:9216
    v_mfma_f32_16x16x32_bf16 v[88:91], v[68:71], a[28:31], v[88:91]
    buffer_load_dwordx4 v[52:55], v187, s[48:51], s23 offen offset:0 sc1
    v_mfma_f32_16x16x32_bf16 v[88:91], v[72:75], a[32:35], v[88:91]
    ds_read_b128 a[108:111], v184 offset:27648
    v_mfma_f32_16x16x32_bf16 v[92:95], v[64:67], a[96:99], v[92:95]
    buffer_load_dword v146, v3, s[8:11], s25 offen offset:1280 sc1
    v_mfma_f32_16x16x32_bf16 v[92:95], v[68:71], a[100:103], v[92:95]
    ds_read_b128 a[180:183], v11 offset:9216
    ds_read_b128 a[252:255], v11 offset:27648
    v_mfma_f32_16x16x32_bf16 v[92:95], v[72:75], a[104:107], v[92:95]
    buffer_load_dwordx4 v[56:59], v187, s[48:51], s23 offen offset:1024 sc1
    v_mfma_f32_16x16x32_bf16 v[96:99], v[64:67], a[168:171], v[96:99]
    buffer_load_dword v147, v3, s[8:11], s25 offen offset:1408 sc1
    v_mfma_f32_16x16x32_bf16 v[96:99], v[68:71], a[172:175], v[96:99]
    buffer_load_dword v148, v3, s[8:11], s25 offen offset:1536 sc1
    v_mfma_f32_16x16x32_bf16 v[96:99], v[72:75], a[176:179], v[96:99]
    ds_read_b128 a[40:43], v184 offset:10240
    ds_read_b128 a[112:115], v184 offset:28672
    v_mfma_f32_16x16x32_bf16 v[100:103], v[64:67], a[240:243], v[100:103]
    buffer_load_dwordx4 v[60:63], v187, s[48:51], s23 offen offset:2048 sc1
    v_mfma_f32_16x16x32_bf16 v[100:103], v[68:71], a[244:247], v[100:103]
    buffer_load_dword v149, v3, s[8:11], s25 offen offset:1664 sc1
    v_mfma_f32_16x16x32_bf16 v[100:103], v[72:75], a[248:251], v[100:103]
    buffer_load_dword v150, v3, s[8:11], s25 offen offset:1792 sc1
    s_waitcnt vmcnt(31) lgkmcnt(6)
    v_mfma_f32_16x16x32_bf16 v[104:107], v[76:79], a[24:27], v[104:107]
    ds_read_b128 a[184:187], v11 offset:10240
    ds_read_b128 v[220:223], v11 offset:28672
    v_mfma_f32_16x16x32_bf16 v[104:107], v[80:83], a[28:31], v[104:107]
    buffer_load_dwordx4 v[64:67], v187, s[48:51], s23 offen offset:3072 sc1
    v_mfma_f32_16x16x32_bf16 v[104:107], v[84:87], a[32:35], v[104:107]
    ds_read_b128 a[44:47], v184 offset:11264
    ds_read_b128 a[116:119], v184 offset:29696
    v_mfma_f32_16x16x32_bf16 v[108:111], v[76:79], a[96:99], v[108:111]
    buffer_load_dword v151, v3, s[8:11], s25 offen offset:1920 sc1
    v_mfma_f32_16x16x32_bf16 v[108:111], v[80:83], a[100:103], v[108:111]
    ds_read_b128 a[188:191], v11 offset:11264
    ds_read_b128 v[224:227], v11 offset:29696
    v_mfma_f32_16x16x32_bf16 v[108:111], v[84:87], a[104:107], v[108:111]
    buffer_load_dwordx4 v[68:71], v188, s[48:51], s23 offen offset:0 sc1
    v_mfma_f32_16x16x32_bf16 v[112:115], v[76:79], a[168:171], v[112:115]
    v_mfma_f32_16x16x32_bf16 v[112:115], v[80:83], a[172:175], v[112:115]
    v_mfma_f32_16x16x32_bf16 v[112:115], v[84:87], a[176:179], v[112:115]
    v_mfma_f32_16x16x32_bf16 v[116:119], v[76:79], a[240:243], v[116:119]
    buffer_load_dwordx4 v[72:75], v188, s[48:51], s23 offen offset:1024 sc1
    v_mfma_f32_16x16x32_bf16 v[116:119], v[80:83], a[244:247], v[116:119]
    v_mfma_f32_16x16x32_bf16 v[116:119], v[84:87], a[248:251], v[116:119]
    s_waitcnt vmcnt(28) lgkmcnt(0)
    s_barrier
    v_mfma_f32_16x16x32_bf16 v[88:91], v[16:19], a[36:39], v[88:91]
    ds_read_b128 a[48:51], v184 offset:12288
    v_mfma_f32_16x16x32_bf16 v[88:91], v[20:23], a[40:43], v[88:91]
    buffer_load_dwordx4 v[76:79], v188, s[48:51], s23 offen offset:2048 sc1
    v_mfma_f32_16x16x32_bf16 v[88:91], v[24:27], a[44:47], v[88:91]
    ds_read_b128 a[120:123], v184 offset:30720
    v_mfma_f32_16x16x32_bf16 v[92:95], v[16:19], a[108:111], v[92:95]
    ds_read_b128 a[192:195], v11 offset:12288
    v_mfma_f32_16x16x32_bf16 v[92:95], v[20:23], a[112:115], v[92:95]
    ds_read_b128 v[228:231], v11 offset:30720
    v_mfma_f32_16x16x32_bf16 v[92:95], v[24:27], a[116:119], v[92:95]
    buffer_load_dwordx4 v[80:83], v188, s[48:51], s23 offen offset:3072 sc1
    v_mfma_f32_16x16x32_bf16 v[96:99], v[16:19], a[180:183], v[96:99]
    ds_read_b128 a[52:55], v184 offset:13312
    v_mfma_f32_16x16x32_bf16 v[96:99], v[20:23], a[184:187], v[96:99]
    ds_read_b128 a[124:127], v184 offset:31744
    v_mfma_f32_16x16x32_bf16 v[96:99], v[24:27], a[188:191], v[96:99]
    v_mfma_f32_16x16x32_bf16 v[100:103], v[16:19], a[252:255], v[100:103]
    buffer_load_dwordx4 v[84:87], v189, s[48:51], s23 offen offset:0 sc1
    v_mfma_f32_16x16x32_bf16 v[100:103], v[20:23], v[220:223], v[100:103]
    ds_read_b128 a[196:199], v11 offset:13312
    ds_read_b128 v[232:235], v11 offset:31744
    v_mfma_f32_16x16x32_bf16 v[100:103], v[24:27], v[224:227], v[100:103]
    s_waitcnt vmcnt(25) lgkmcnt(8)
    v_mfma_f32_16x16x32_bf16 v[104:107], v[28:31], a[36:39], v[104:107]
    ds_read_b128 a[56:59], v184 offset:14336
    v_mfma_f32_16x16x32_bf16 v[104:107], v[32:35], a[40:43], v[104:107]
    buffer_load_dwordx4 v[16:19], v189, s[48:51], s23 offen offset:1024 sc1
    v_mfma_f32_16x16x32_bf16 v[104:107], v[36:39], a[44:47], v[104:107]
    ds_read_b128 a[128:131], v184 offset:32768
    v_mfma_f32_16x16x32_bf16 v[108:111], v[28:31], a[108:111], v[108:111]
    ds_read_b128 a[200:203], v11 offset:14336
    v_mfma_f32_16x16x32_bf16 v[108:111], v[32:35], a[112:115], v[108:111]
    ds_read_b128 v[236:239], v11 offset:32768
    v_mfma_f32_16x16x32_bf16 v[108:111], v[36:39], a[116:119], v[108:111]
    buffer_load_dwordx4 v[20:23], v189, s[48:51], s23 offen offset:2048 sc1
    v_mfma_f32_16x16x32_bf16 v[112:115], v[28:31], a[180:183], v[112:115]
    v_mfma_f32_16x16x32_bf16 v[112:115], v[32:35], a[184:187], v[112:115]
    v_mfma_f32_16x16x32_bf16 v[112:115], v[36:39], a[188:191], v[112:115]
    v_mfma_f32_16x16x32_bf16 v[116:119], v[28:31], a[252:255], v[116:119]
    buffer_load_dwordx4 v[24:27], v189, s[48:51], s23 offen offset:3072 sc1
    v_mfma_f32_16x16x32_bf16 v[116:119], v[32:35], v[220:223], v[116:119]
    v_mfma_f32_16x16x32_bf16 v[116:119], v[36:39], v[224:227], v[116:119]
    s_waitcnt vmcnt(8) lgkmcnt(0)
    v_mfma_f32_16x16x32_bf16 v[88:91], v[40:43], a[48:51], v[88:91]
    ds_read_b128 a[60:63], v184 offset:15360
    v_add_f32 v136, v136, v144
    v_mfma_f32_16x16x32_bf16 v[88:91], v[44:47], a[52:55], v[88:91]
    buffer_load_dwordx4 v[28:31], v190, s[48:51], s23 offen offset:0 sc1
    v_mfma_f32_16x16x32_bf16 v[88:91], v[48:51], a[56:59], v[88:91]
    ds_read_b128 a[132:135], v184 offset:33792
    v_add_f32 v137, v137, v145
    v_mfma_f32_16x16x32_bf16 v[92:95], v[40:43], a[120:123], v[92:95]
    ds_read_b128 a[204:207], v11 offset:15360
    v_add_f32 v138, v138, v146
    v_mfma_f32_16x16x32_bf16 v[92:95], v[44:47], a[124:127], v[92:95]
    ds_read_b128 v[240:243], v11 offset:33792
    v_add_f32 v139, v139, v147
    v_mfma_f32_16x16x32_bf16 v[92:95], v[48:51], a[128:131], v[92:95]
    buffer_load_dwordx4 v[32:35], v190, s[48:51], s23 offen offset:1024 sc1
    v_mfma_f32_16x16x32_bf16 v[96:99], v[40:43], a[192:195], v[96:99]
    ds_read_b128 a[64:67], v184 offset:16384
    v_add_f32 v140, v140, v148
    v_mfma_f32_16x16x32_bf16 v[96:99], v[44:47], a[196:199], v[96:99]
    ds_read_b128 a[136:139], v184 offset:34816
    v_add_f32 v141, v141, v149
    v_mfma_f32_16x16x32_bf16 v[96:99], v[48:51], a[200:203], v[96:99]
    v_add_f32 v142, v142, v150
    v_add_f32 v143, v143, v151
    v_mfma_f32_16x16x32_bf16 v[100:103], v[40:43], v[228:231], v[100:103]
    buffer_load_dwordx4 v[36:39], v190, s[48:51], s23 offen offset:2048 sc1
    v_mfma_f32_16x16x32_bf16 v[100:103], v[44:47], v[232:235], v[100:103]
    ds_read_b128 a[208:211], v11 offset:16384
    ds_read_b128 v[244:247], v11 offset:34816
    v_mfma_f32_16x16x32_bf16 v[100:103], v[48:51], v[236:239], v[100:103]
    v_add_f32 v136, v136, v140
    v_add_f32 v137, v137, v141
    s_waitcnt vmcnt(15) lgkmcnt(8)
    v_mfma_f32_16x16x32_bf16 v[104:107], v[52:55], a[48:51], v[104:107]
    ds_read_b128 a[68:71], v184 offset:17408
    v_add_f32 v138, v138, v142
    v_mfma_f32_16x16x32_bf16 v[104:107], v[56:59], a[52:55], v[104:107]
    buffer_load_dwordx4 v[40:43], v190, s[48:51], s23 offen offset:3072 sc1
    v_mfma_f32_16x16x32_bf16 v[104:107], v[60:63], a[56:59], v[104:107]
    ds_read_b128 a[140:143], v184 offset:35840
    v_add_f32 v139, v139, v143
    v_mfma_f32_16x16x32_bf16 v[108:111], v[52:55], a[120:123], v[108:111]
    ds_read_b128 a[212:215], v11 offset:17408
    v_add_f32 v136, v136, v138
    v_mfma_f32_16x16x32_bf16 v[108:111], v[56:59], a[124:127], v[108:111]
    ds_read_b128 v[248:251], v11 offset:35840
    v_add_f32 v137, v137, v139
    v_mfma_f32_16x16x32_bf16 v[108:111], v[60:63], a[128:131], v[108:111]
    buffer_load_dwordx4 v[44:47], v191, s[48:51], s23 offen offset:0 sc1
    v_mfma_f32_16x16x32_bf16 v[112:115], v[52:55], a[192:195], v[112:115]
    v_add_f32 v136, v136, v137
    v_mov_b32 v137, 0x3727c5ac
    v_mfma_f32_16x16x32_bf16 v[112:115], v[56:59], a[196:199], v[112:115]
    v_fmac_f32 v137, 0x3ae38e39, v136
    v_mov_b32 v193, v137
    v_mfma_f32_16x16x32_bf16 v[112:115], v[60:63], a[200:203], v[112:115]
    s_nop 0
    v_permlane16_swap_b32 v193, v137
    v_mfma_f32_16x16x32_bf16 v[116:119], v[52:55], v[228:231], v[116:119]
    buffer_load_dwordx4 v[48:51], v191, s[48:51], s23 offen offset:1024 sc1
    v_mfma_f32_16x16x32_bf16 v[116:119], v[56:59], v[232:235], v[116:119]
    v_mov_b32 v195, v193
    v_mov_b32 v194, v137
    v_mfma_f32_16x16x32_bf16 v[116:119], v[60:63], v[236:239], v[116:119]
    v_mov_b32 v252, v137
    s_waitcnt vmcnt(12) lgkmcnt(0)
    v_mfma_f32_16x16x32_bf16 v[88:91], v[64:67], a[60:63], v[88:91]
    s_nop 0
    v_permlane32_swap_b32 v193, v195
    v_mfma_f32_16x16x32_bf16 v[88:91], v[68:71], a[64:67], v[88:91]
    buffer_load_dwordx4 v[52:55], v191, s[48:51], s23 offen offset:2048 sc1
    v_mfma_f32_16x16x32_bf16 v[120:123], v[72:75], a[68:71], v[88:91]
    v_permlane32_swap_b32 v194, v252
    v_mfma_f32_16x16x32_bf16 v[92:95], v[64:67], a[132:135], v[92:95]
    v_rsq_f32 v4, v193
    v_mfma_f32_16x16x32_bf16 v[92:95], v[68:71], a[136:139], v[92:95]
    v_rsq_f32 v5, v194
    v_mfma_f32_16x16x32_bf16 v[124:127], v[72:75], a[140:143], v[92:95]
    buffer_load_dwordx4 v[56:59], v191, s[48:51], s23 offen offset:3072 sc1
    v_mfma_f32_16x16x32_bf16 v[96:99], v[64:67], a[204:207], v[96:99]
    v_rsq_f32 v6, v195
    v_mfma_f32_16x16x32_bf16 v[96:99], v[68:71], a[208:211], v[96:99]
    v_rsq_f32 v7, v252
    v_mfma_f32_16x16x32_bf16 v[128:131], v[72:75], a[212:215], v[96:99]
    v_mul_f32 v8, v4, v4
    v_mul_f32 v9, v5, v5
    v_mfma_f32_16x16x32_bf16 v[100:103], v[64:67], v[240:243], v[100:103]
    buffer_load_dwordx4 v[60:63], v192, s[48:51], s23 offen offset:0 sc1
    v_mfma_f32_16x16x32_bf16 v[100:103], v[68:71], v[244:247], v[100:103]
    v_mul_f32 v13, v6, v6
    v_mul_f32 v14, v7, v7
    v_mfma_f32_16x16x32_bf16 v[132:135], v[72:75], v[248:251], v[100:103]
    v_mul_f32 v4, 0xc0135761, v4
    v_mul_f32 v5, 0xc0135761, v5
    s_waitcnt vmcnt(12) lgkmcnt(0)
    v_mfma_f32_16x16x32_bf16 v[104:107], v[76:79], a[60:63], v[104:107]
    v_mul_f32 v6, 0xc0135761, v6
    v_mul_f32 v7, 0xc0135761, v7
    v_mfma_f32_16x16x32_bf16 v[104:107], v[80:83], a[64:67], v[104:107]
    buffer_load_dwordx4 v[64:67], v192, s[48:51], s23 offen offset:1024 sc1
    v_mfma_f32_16x16x32_bf16 v[136:139], v[84:87], a[68:71], v[104:107]
    v_mul_f32 v8, 0x3d372713, v8
    v_mul_f32 v9, 0x3d372713, v9
    v_mfma_f32_16x16x32_bf16 v[108:111], v[76:79], a[132:135], v[108:111]
    v_mul_f32 v13, 0x3d372713, v13
    v_mul_f32 v14, 0x3d372713, v14
    v_mfma_f32_16x16x32_bf16 v[108:111], v[80:83], a[136:139], v[108:111]
    v_mul_f32 v8, v8, v4
    v_mul_f32 v9, v9, v5
    v_mfma_f32_16x16x32_bf16 v[140:143], v[84:87], a[140:143], v[108:111]
    buffer_load_dwordx4 v[68:71], v192, s[48:51], s23 offen offset:2048 sc1
    v_mfma_f32_16x16x32_bf16 v[112:115], v[76:79], a[204:207], v[112:115]
    v_mul_f32 v13, v13, v6
    v_mul_f32 v14, v14, v7
    v_mfma_f32_16x16x32_bf16 v[112:115], v[80:83], a[208:211], v[112:115]
    s_mov_b32 s25, 0
    v_mfma_f32_16x16x32_bf16 v[144:147], v[84:87], a[212:215], v[112:115]
    s_mov_b32 s7, s28
    v_mfma_f32_16x16x32_bf16 v[116:119], v[76:79], v[240:243], v[116:119]
    buffer_load_dwordx4 v[72:75], v192, s[48:51], s23 offen offset:3072 sc1
    v_mfma_f32_16x16x32_bf16 v[116:119], v[80:83], v[244:247], v[116:119]
    s_add_u32 s23, s23, 36864
    v_mfma_f32_16x16x32_bf16 v[148:151], v[84:87], v[248:251], v[116:119]
    v_add_u32 v12, s7, v184
    s_add_u32 s25, s25, 1
L_ffn_gu_40:
    s_waitcnt vmcnt(12)
    v_mfma_f32_16x16x32_bf16 v[88:91], v[16:19], a[0:3], 0
    v_mfma_f32_16x16x32_bf16 v[88:91], v[20:23], a[4:7], v[88:91]
    buffer_load_dwordx4 v[76:79], v184, s[48:51], s23 offen offset:0 sc1
    v_mfma_f32_16x16x32_bf16 v[88:91], v[24:27], a[8:11], v[88:91]
    v_mul_f32 v152, v120, v120
    v_mul_f32 v153, v121, v121
    v_mfma_f32_16x16x32_bf16 v[92:95], v[16:19], a[72:75], 0
    v_mul_f32 v154, v122, v122
    v_mul_f32 v155, v123, v123
    v_mfma_f32_16x16x32_bf16 v[92:95], v[20:23], a[76:79], v[92:95]
    v_fma_f32 v152, v152, v8, v4
    v_fma_f32 v153, v153, v8, v4
    v_mfma_f32_16x16x32_bf16 v[92:95], v[24:27], a[80:83], v[92:95]
    buffer_load_dwordx4 v[80:83], v184, s[48:51], s23 offen offset:1024 sc1
    v_mfma_f32_16x16x32_bf16 v[96:99], v[16:19], a[144:147], 0
    v_fma_f32 v154, v154, v8, v4
    v_fma_f32 v155, v155, v8, v4
    v_mfma_f32_16x16x32_bf16 v[96:99], v[20:23], a[148:151], v[96:99]
    v_mul_f32 v152, v120, v152
    v_mul_f32 v153, v121, v153
    v_mfma_f32_16x16x32_bf16 v[96:99], v[24:27], a[152:155], v[96:99]
    v_mul_f32 v154, v122, v154
    v_mul_f32 v155, v123, v155
    v_mfma_f32_16x16x32_bf16 v[100:103], v[16:19], a[216:219], 0
    buffer_load_dwordx4 v[84:87], v184, s[48:51], s23 offen offset:2048 sc1
    v_mfma_f32_16x16x32_bf16 v[100:103], v[20:23], a[220:223], v[100:103]
    v_exp_f32 v152, v152
    v_mfma_f32_16x16x32_bf16 v[100:103], v[24:27], a[224:227], v[100:103]
    v_exp_f32 v153, v153
    s_waitcnt vmcnt(12)
    v_mfma_f32_16x16x32_bf16 v[104:107], v[28:31], a[0:3], 0
    v_exp_f32 v154, v154
    v_mfma_f32_16x16x32_bf16 v[104:107], v[32:35], a[4:7], v[104:107]
    buffer_load_dwordx4 v[16:19], v184, s[48:51], s23 offen offset:3072 sc1
    v_mfma_f32_16x16x32_bf16 v[104:107], v[36:39], a[8:11], v[104:107]
    v_exp_f32 v155, v155
    v_mfma_f32_16x16x32_bf16 v[108:111], v[28:31], a[72:75], 0
    v_mul_f32 v156, v120, v136
    v_mul_f32 v157, v121, v137
    v_mfma_f32_16x16x32_bf16 v[108:111], v[32:35], a[76:79], v[108:111]
    v_mul_f32 v158, v122, v138
    v_mul_f32 v159, v123, v139
    v_mfma_f32_16x16x32_bf16 v[108:111], v[36:39], a[80:83], v[108:111]
    buffer_load_dwordx4 v[20:23], v185, s[48:51], s23 offen offset:0 sc1
    v_mfma_f32_16x16x32_bf16 v[112:115], v[28:31], a[144:147], 0
    v_fma_f32 v152, v152, v193, v193
    v_fma_f32 v153, v153, v193, v193
    v_mfma_f32_16x16x32_bf16 v[112:115], v[32:35], a[148:151], v[112:115]
    v_fma_f32 v154, v154, v193, v193
    v_fma_f32 v155, v155, v193, v193
    v_mfma_f32_16x16x32_bf16 v[112:115], v[36:39], a[152:155], v[112:115]
    v_rcp_f32 v152, v152
    v_mfma_f32_16x16x32_bf16 v[116:119], v[28:31], a[216:219], 0
    buffer_load_dwordx4 v[24:27], v185, s[48:51], s23 offen offset:1024 sc1
    v_mfma_f32_16x16x32_bf16 v[116:119], v[32:35], a[220:223], v[116:119]
    v_rcp_f32 v153, v153
    v_mfma_f32_16x16x32_bf16 v[116:119], v[36:39], a[224:227], v[116:119]
    v_rcp_f32 v154, v154
    s_waitcnt vmcnt(12)
    v_mfma_f32_16x16x32_bf16 v[88:91], v[40:43], a[12:15], v[88:91]
    v_rcp_f32 v155, v155
    v_mfma_f32_16x16x32_bf16 v[88:91], v[44:47], a[16:19], v[88:91]
    buffer_load_dwordx4 v[28:31], v185, s[48:51], s23 offen offset:2048 sc1
    v_mfma_f32_16x16x32_bf16 v[88:91], v[48:51], a[20:23], v[88:91]
    v_mul_f32 v156, v156, v152
    v_mul_f32 v157, v157, v153
    v_mfma_f32_16x16x32_bf16 v[92:95], v[40:43], a[84:87], v[92:95]
    v_mul_f32 v158, v158, v154
    v_mul_f32 v159, v159, v155
    v_mfma_f32_16x16x32_bf16 v[92:95], v[44:47], a[88:91], v[92:95]
    v_cvt_pk_bf16_f32 v160, v156, v157
    v_cvt_pk_bf16_f32 v161, v158, v159
    v_mfma_f32_16x16x32_bf16 v[92:95], v[48:51], a[92:95], v[92:95]
    buffer_load_dwordx4 v[32:35], v185, s[48:51], s23 offen offset:3072 sc1
    v_mfma_f32_16x16x32_bf16 v[96:99], v[40:43], a[156:159], v[96:99]
    ds_write_b64 v12, v[160:161] offset:0
    v_mfma_f32_16x16x32_bf16 v[96:99], v[44:47], a[160:163], v[96:99]
    v_mul_f32 v162, v124, v124
    v_mul_f32 v163, v125, v125
    v_mfma_f32_16x16x32_bf16 v[96:99], v[48:51], a[164:167], v[96:99]
    v_mul_f32 v164, v126, v126
    v_mul_f32 v165, v127, v127
    v_mfma_f32_16x16x32_bf16 v[100:103], v[40:43], a[228:231], v[100:103]
    buffer_load_dwordx4 v[36:39], v186, s[48:51], s23 offen offset:0 sc1
    v_mfma_f32_16x16x32_bf16 v[100:103], v[44:47], a[232:235], v[100:103]
    v_fma_f32 v162, v162, v9, v5
    v_fma_f32 v163, v163, v9, v5
    v_mfma_f32_16x16x32_bf16 v[100:103], v[48:51], a[236:239], v[100:103]
    v_fma_f32 v164, v164, v9, v5
    v_fma_f32 v165, v165, v9, v5
    s_waitcnt vmcnt(12)
    v_mfma_f32_16x16x32_bf16 v[104:107], v[52:55], a[12:15], v[104:107]
    v_mul_f32 v162, v124, v162
    v_mul_f32 v163, v125, v163
    v_mfma_f32_16x16x32_bf16 v[104:107], v[56:59], a[16:19], v[104:107]
    buffer_load_dwordx4 v[40:43], v186, s[48:51], s23 offen offset:1024 sc1
    v_mfma_f32_16x16x32_bf16 v[104:107], v[60:63], a[20:23], v[104:107]
    v_mul_f32 v164, v126, v164
    v_mul_f32 v165, v127, v165
    v_mfma_f32_16x16x32_bf16 v[108:111], v[52:55], a[84:87], v[108:111]
    v_exp_f32 v162, v162
    v_mfma_f32_16x16x32_bf16 v[108:111], v[56:59], a[88:91], v[108:111]
    v_exp_f32 v163, v163
    v_mfma_f32_16x16x32_bf16 v[108:111], v[60:63], a[92:95], v[108:111]
    buffer_load_dwordx4 v[44:47], v186, s[48:51], s23 offen offset:2048 sc1
    v_mfma_f32_16x16x32_bf16 v[112:115], v[52:55], a[156:159], v[112:115]
    v_exp_f32 v164, v164
    v_mfma_f32_16x16x32_bf16 v[112:115], v[56:59], a[160:163], v[112:115]
    v_exp_f32 v165, v165
    v_mfma_f32_16x16x32_bf16 v[112:115], v[60:63], a[164:167], v[112:115]
    v_mul_f32 v166, v124, v140
    v_mul_f32 v167, v125, v141
    v_mfma_f32_16x16x32_bf16 v[116:119], v[52:55], a[228:231], v[116:119]
    buffer_load_dwordx4 v[48:51], v186, s[48:51], s23 offen offset:3072 sc1
    v_mfma_f32_16x16x32_bf16 v[116:119], v[56:59], a[232:235], v[116:119]
    v_mul_f32 v168, v126, v142
    v_mul_f32 v169, v127, v143
    v_mfma_f32_16x16x32_bf16 v[116:119], v[60:63], a[236:239], v[116:119]
    v_fma_f32 v162, v162, v194, v194
    v_fma_f32 v163, v163, v194, v194
    s_waitcnt vmcnt(12)
    v_mfma_f32_16x16x32_bf16 v[88:91], v[64:67], a[24:27], v[88:91]
    v_fma_f32 v164, v164, v194, v194
    v_fma_f32 v165, v165, v194, v194
    v_mfma_f32_16x16x32_bf16 v[88:91], v[68:71], a[28:31], v[88:91]
    buffer_load_dwordx4 v[52:55], v187, s[48:51], s23 offen offset:0 sc1
    v_mfma_f32_16x16x32_bf16 v[88:91], v[72:75], a[32:35], v[88:91]
    v_rcp_f32 v162, v162
    v_mfma_f32_16x16x32_bf16 v[92:95], v[64:67], a[96:99], v[92:95]
    v_rcp_f32 v163, v163
    v_mfma_f32_16x16x32_bf16 v[92:95], v[68:71], a[100:103], v[92:95]
    v_rcp_f32 v164, v164
    v_mfma_f32_16x16x32_bf16 v[92:95], v[72:75], a[104:107], v[92:95]
    buffer_load_dwordx4 v[56:59], v187, s[48:51], s23 offen offset:1024 sc1
    v_mfma_f32_16x16x32_bf16 v[96:99], v[64:67], a[168:171], v[96:99]
    v_rcp_f32 v165, v165
    v_mfma_f32_16x16x32_bf16 v[96:99], v[68:71], a[172:175], v[96:99]
    v_mul_f32 v166, v166, v162
    v_mul_f32 v167, v167, v163
    v_mfma_f32_16x16x32_bf16 v[96:99], v[72:75], a[176:179], v[96:99]
    v_mul_f32 v168, v168, v164
    v_mul_f32 v169, v169, v165
    v_mfma_f32_16x16x32_bf16 v[100:103], v[64:67], a[240:243], v[100:103]
    buffer_load_dwordx4 v[60:63], v187, s[48:51], s23 offen offset:2048 sc1
    v_mfma_f32_16x16x32_bf16 v[100:103], v[68:71], a[244:247], v[100:103]
    v_cvt_pk_bf16_f32 v170, v166, v167
    v_cvt_pk_bf16_f32 v171, v168, v169
    v_mfma_f32_16x16x32_bf16 v[100:103], v[72:75], a[248:251], v[100:103]
    ds_write_b64 v12, v[170:171] offset:18432
    s_waitcnt vmcnt(12)
    v_mfma_f32_16x16x32_bf16 v[104:107], v[76:79], a[24:27], v[104:107]
    v_mul_f32 v152, v128, v128
    v_mul_f32 v153, v129, v129
    v_mfma_f32_16x16x32_bf16 v[104:107], v[80:83], a[28:31], v[104:107]
    buffer_load_dwordx4 v[64:67], v187, s[48:51], s23 offen offset:3072 sc1
    v_mfma_f32_16x16x32_bf16 v[104:107], v[84:87], a[32:35], v[104:107]
    v_mul_f32 v154, v130, v130
    v_mul_f32 v155, v131, v131
    v_mfma_f32_16x16x32_bf16 v[108:111], v[76:79], a[96:99], v[108:111]
    v_fma_f32 v152, v152, v13, v6
    v_fma_f32 v153, v153, v13, v6
    v_mfma_f32_16x16x32_bf16 v[108:111], v[80:83], a[100:103], v[108:111]
    v_fma_f32 v154, v154, v13, v6
    v_fma_f32 v155, v155, v13, v6
    v_mfma_f32_16x16x32_bf16 v[108:111], v[84:87], a[104:107], v[108:111]
    buffer_load_dwordx4 v[68:71], v188, s[48:51], s23 offen offset:0 sc1
    v_mfma_f32_16x16x32_bf16 v[112:115], v[76:79], a[168:171], v[112:115]
    v_mul_f32 v152, v128, v152
    v_mul_f32 v153, v129, v153
    v_mfma_f32_16x16x32_bf16 v[112:115], v[80:83], a[172:175], v[112:115]
    v_mul_f32 v154, v130, v154
    v_mul_f32 v155, v131, v155
    v_mfma_f32_16x16x32_bf16 v[112:115], v[84:87], a[176:179], v[112:115]
    v_exp_f32 v152, v152
    v_mfma_f32_16x16x32_bf16 v[116:119], v[76:79], a[240:243], v[116:119]
    buffer_load_dwordx4 v[72:75], v188, s[48:51], s23 offen offset:1024 sc1
    v_mfma_f32_16x16x32_bf16 v[116:119], v[80:83], a[244:247], v[116:119]
    v_exp_f32 v153, v153
    v_mfma_f32_16x16x32_bf16 v[116:119], v[84:87], a[248:251], v[116:119]
    v_exp_f32 v154, v154
    s_waitcnt vmcnt(12)
    v_mfma_f32_16x16x32_bf16 v[88:91], v[16:19], a[36:39], v[88:91]
    v_exp_f32 v155, v155
    v_mfma_f32_16x16x32_bf16 v[88:91], v[20:23], a[40:43], v[88:91]
    buffer_load_dwordx4 v[76:79], v188, s[48:51], s23 offen offset:2048 sc1
    v_mfma_f32_16x16x32_bf16 v[88:91], v[24:27], a[44:47], v[88:91]
    v_mul_f32 v156, v128, v144
    v_mul_f32 v157, v129, v145
    v_mfma_f32_16x16x32_bf16 v[92:95], v[16:19], a[108:111], v[92:95]
    v_mul_f32 v158, v130, v146
    v_mul_f32 v159, v131, v147
    v_mfma_f32_16x16x32_bf16 v[92:95], v[20:23], a[112:115], v[92:95]
    v_fma_f32 v152, v152, v195, v195
    v_fma_f32 v153, v153, v195, v195
    v_mfma_f32_16x16x32_bf16 v[92:95], v[24:27], a[116:119], v[92:95]
    buffer_load_dwordx4 v[80:83], v188, s[48:51], s23 offen offset:3072 sc1
    v_mfma_f32_16x16x32_bf16 v[96:99], v[16:19], a[180:183], v[96:99]
    v_fma_f32 v154, v154, v195, v195
    v_fma_f32 v155, v155, v195, v195
    v_mfma_f32_16x16x32_bf16 v[96:99], v[20:23], a[184:187], v[96:99]
    v_rcp_f32 v152, v152
    v_mfma_f32_16x16x32_bf16 v[96:99], v[24:27], a[188:191], v[96:99]
    v_rcp_f32 v153, v153
    v_mfma_f32_16x16x32_bf16 v[100:103], v[16:19], a[252:255], v[100:103]
    buffer_load_dwordx4 v[84:87], v189, s[48:51], s23 offen offset:0 sc1
    v_mfma_f32_16x16x32_bf16 v[100:103], v[20:23], v[220:223], v[100:103]
    v_rcp_f32 v154, v154
    v_mfma_f32_16x16x32_bf16 v[100:103], v[24:27], v[224:227], v[100:103]
    v_rcp_f32 v155, v155
    s_waitcnt vmcnt(12)
    v_mfma_f32_16x16x32_bf16 v[104:107], v[28:31], a[36:39], v[104:107]
    v_mul_f32 v156, v156, v152
    v_mul_f32 v157, v157, v153
    v_mfma_f32_16x16x32_bf16 v[104:107], v[32:35], a[40:43], v[104:107]
    buffer_load_dwordx4 v[16:19], v189, s[48:51], s23 offen offset:1024 sc1
    v_mfma_f32_16x16x32_bf16 v[104:107], v[36:39], a[44:47], v[104:107]
    v_mul_f32 v158, v158, v154
    v_mul_f32 v159, v159, v155
    v_mfma_f32_16x16x32_bf16 v[108:111], v[28:31], a[108:111], v[108:111]
    v_cvt_pk_bf16_f32 v160, v156, v157
    v_cvt_pk_bf16_f32 v161, v158, v159
    v_mfma_f32_16x16x32_bf16 v[108:111], v[32:35], a[112:115], v[108:111]
    ds_write_b64 v12, v[160:161] offset:36864
    v_mfma_f32_16x16x32_bf16 v[108:111], v[36:39], a[116:119], v[108:111]
    buffer_load_dwordx4 v[20:23], v189, s[48:51], s23 offen offset:2048 sc1
    v_mfma_f32_16x16x32_bf16 v[112:115], v[28:31], a[180:183], v[112:115]
    v_mul_f32 v162, v132, v132
    v_mul_f32 v163, v133, v133
    v_mfma_f32_16x16x32_bf16 v[112:115], v[32:35], a[184:187], v[112:115]
    v_mul_f32 v164, v134, v134
    v_mul_f32 v165, v135, v135
    v_mfma_f32_16x16x32_bf16 v[112:115], v[36:39], a[188:191], v[112:115]
    v_fma_f32 v162, v162, v14, v7
    v_fma_f32 v163, v163, v14, v7
    v_mfma_f32_16x16x32_bf16 v[116:119], v[28:31], a[252:255], v[116:119]
    buffer_load_dwordx4 v[24:27], v189, s[48:51], s23 offen offset:3072 sc1
    v_mfma_f32_16x16x32_bf16 v[116:119], v[32:35], v[220:223], v[116:119]
    v_fma_f32 v164, v164, v14, v7
    v_fma_f32 v165, v165, v14, v7
    v_mfma_f32_16x16x32_bf16 v[116:119], v[36:39], v[224:227], v[116:119]
    v_mul_f32 v162, v132, v162
    v_mul_f32 v163, v133, v163
    s_waitcnt vmcnt(12)
    v_mfma_f32_16x16x32_bf16 v[88:91], v[40:43], a[48:51], v[88:91]
    v_mul_f32 v164, v134, v164
    v_mul_f32 v165, v135, v165
    v_mfma_f32_16x16x32_bf16 v[88:91], v[44:47], a[52:55], v[88:91]
    buffer_load_dwordx4 v[28:31], v190, s[48:51], s23 offen offset:0 sc1
    v_mfma_f32_16x16x32_bf16 v[88:91], v[48:51], a[56:59], v[88:91]
    v_exp_f32 v162, v162
    v_mfma_f32_16x16x32_bf16 v[92:95], v[40:43], a[120:123], v[92:95]
    v_exp_f32 v163, v163
    v_mfma_f32_16x16x32_bf16 v[92:95], v[44:47], a[124:127], v[92:95]
    v_exp_f32 v164, v164
    v_mfma_f32_16x16x32_bf16 v[92:95], v[48:51], a[128:131], v[92:95]
    buffer_load_dwordx4 v[32:35], v190, s[48:51], s23 offen offset:1024 sc1
    v_mfma_f32_16x16x32_bf16 v[96:99], v[40:43], a[192:195], v[96:99]
    v_exp_f32 v165, v165
    v_mfma_f32_16x16x32_bf16 v[96:99], v[44:47], a[196:199], v[96:99]
    v_mul_f32 v166, v132, v148
    v_mul_f32 v167, v133, v149
    v_mfma_f32_16x16x32_bf16 v[96:99], v[48:51], a[200:203], v[96:99]
    v_mul_f32 v168, v134, v150
    v_mul_f32 v169, v135, v151
    v_mfma_f32_16x16x32_bf16 v[100:103], v[40:43], v[228:231], v[100:103]
    buffer_load_dwordx4 v[36:39], v190, s[48:51], s23 offen offset:2048 sc1
    v_mfma_f32_16x16x32_bf16 v[100:103], v[44:47], v[232:235], v[100:103]
    v_fma_f32 v162, v162, v252, v252
    v_fma_f32 v163, v163, v252, v252
    v_mfma_f32_16x16x32_bf16 v[100:103], v[48:51], v[236:239], v[100:103]
    v_fma_f32 v164, v164, v252, v252
    v_fma_f32 v165, v165, v252, v252
    s_waitcnt vmcnt(12)
    v_mfma_f32_16x16x32_bf16 v[104:107], v[52:55], a[48:51], v[104:107]
    v_rcp_f32 v162, v162
    v_mfma_f32_16x16x32_bf16 v[104:107], v[56:59], a[52:55], v[104:107]
    buffer_load_dwordx4 v[40:43], v190, s[48:51], s23 offen offset:3072 sc1
    v_mfma_f32_16x16x32_bf16 v[104:107], v[60:63], a[56:59], v[104:107]
    v_rcp_f32 v163, v163
    v_mfma_f32_16x16x32_bf16 v[108:111], v[52:55], a[120:123], v[108:111]
    v_rcp_f32 v164, v164
    v_mfma_f32_16x16x32_bf16 v[108:111], v[56:59], a[124:127], v[108:111]
    v_rcp_f32 v165, v165
    v_mfma_f32_16x16x32_bf16 v[108:111], v[60:63], a[128:131], v[108:111]
    buffer_load_dwordx4 v[44:47], v191, s[48:51], s23 offen offset:0 sc1
    v_mfma_f32_16x16x32_bf16 v[112:115], v[52:55], a[192:195], v[112:115]
    v_mul_f32 v166, v166, v162
    v_mul_f32 v167, v167, v163
    v_mfma_f32_16x16x32_bf16 v[112:115], v[56:59], a[196:199], v[112:115]
    v_mul_f32 v168, v168, v164
    v_mul_f32 v169, v169, v165
    v_mfma_f32_16x16x32_bf16 v[112:115], v[60:63], a[200:203], v[112:115]
    v_cvt_pk_bf16_f32 v170, v166, v167
    v_cvt_pk_bf16_f32 v171, v168, v169
    v_mfma_f32_16x16x32_bf16 v[116:119], v[52:55], v[228:231], v[116:119]
    buffer_load_dwordx4 v[48:51], v191, s[48:51], s23 offen offset:1024 sc1
    v_mfma_f32_16x16x32_bf16 v[116:119], v[56:59], v[232:235], v[116:119]
    ds_write_b64 v12, v[170:171] offset:55296
    v_mfma_f32_16x16x32_bf16 v[116:119], v[60:63], v[236:239], v[116:119]
    s_waitcnt vmcnt(12)
    v_mfma_f32_16x16x32_bf16 v[88:91], v[64:67], a[60:63], v[88:91]
    v_mfma_f32_16x16x32_bf16 v[88:91], v[68:71], a[64:67], v[88:91]
    buffer_load_dwordx4 v[52:55], v191, s[48:51], s23 offen offset:2048 sc1
    v_mfma_f32_16x16x32_bf16 v[120:123], v[72:75], a[68:71], v[88:91]
    v_mfma_f32_16x16x32_bf16 v[92:95], v[64:67], a[132:135], v[92:95]
    v_mfma_f32_16x16x32_bf16 v[92:95], v[68:71], a[136:139], v[92:95]
    v_mfma_f32_16x16x32_bf16 v[124:127], v[72:75], a[140:143], v[92:95]
    buffer_load_dwordx4 v[56:59], v191, s[48:51], s23 offen offset:3072 sc1
    v_mfma_f32_16x16x32_bf16 v[96:99], v[64:67], a[204:207], v[96:99]
    v_mfma_f32_16x16x32_bf16 v[96:99], v[68:71], a[208:211], v[96:99]
    v_mfma_f32_16x16x32_bf16 v[128:131], v[72:75], a[212:215], v[96:99]
    v_mfma_f32_16x16x32_bf16 v[100:103], v[64:67], v[240:243], v[100:103]
    buffer_load_dwordx4 v[60:63], v192, s[48:51], s23 offen offset:0 sc1
    v_mfma_f32_16x16x32_bf16 v[100:103], v[68:71], v[244:247], v[100:103]
    v_mfma_f32_16x16x32_bf16 v[132:135], v[72:75], v[248:251], v[100:103]
    s_waitcnt vmcnt(12)
    v_mfma_f32_16x16x32_bf16 v[104:107], v[76:79], a[60:63], v[104:107]
    v_mfma_f32_16x16x32_bf16 v[104:107], v[80:83], a[64:67], v[104:107]
    buffer_load_dwordx4 v[64:67], v192, s[48:51], s23 offen offset:1024 sc1
    v_mfma_f32_16x16x32_bf16 v[136:139], v[84:87], a[68:71], v[104:107]
    v_mfma_f32_16x16x32_bf16 v[108:111], v[76:79], a[132:135], v[108:111]
    v_mfma_f32_16x16x32_bf16 v[108:111], v[80:83], a[136:139], v[108:111]
    v_mfma_f32_16x16x32_bf16 v[140:143], v[84:87], a[140:143], v[108:111]
    buffer_load_dwordx4 v[68:71], v192, s[48:51], s23 offen offset:2048 sc1
    v_mfma_f32_16x16x32_bf16 v[112:115], v[76:79], a[204:207], v[112:115]
    v_mfma_f32_16x16x32_bf16 v[112:115], v[80:83], a[208:211], v[112:115]
    s_lshl_b32 s7, s25, 11
    v_mfma_f32_16x16x32_bf16 v[144:147], v[84:87], a[212:215], v[112:115]
    s_add_u32 s7, s7, s28
    v_mfma_f32_16x16x32_bf16 v[116:119], v[76:79], v[240:243], v[116:119]
    buffer_load_dwordx4 v[72:75], v192, s[48:51], s23 offen offset:3072 sc1
    v_mfma_f32_16x16x32_bf16 v[116:119], v[80:83], v[244:247], v[116:119]
    s_add_u32 s23, s23, 36864
    v_mfma_f32_16x16x32_bf16 v[148:151], v[84:87], v[248:251], v[116:119]
    v_add_u32 v12, s7, v184
    s_add_u32 s25, s25, 1
    s_cmp_lt_u32 s25, 8
    s_cbranch_scc1 L_ffn_gu_40
    v_add_u32 v10, 73728, v184
    v_add_u32 v11, 110592, v184
    s_lshr_b32 s7, s2, 3
    s_lshl_b32 s7, s7, 2
    s_add_u32 s7, s7, s3
    s_lshl_b32 s7, s7, 9
    v_lshrrev_b32 v1, 1, v253
    v_add_u32 v1, s7, v1
    buffer_load_dwordx2 v[2:3], v1, s[96:99], 0 offen
    s_waitcnt lgkmcnt(0)
    s_barrier
    s_waitcnt vmcnt(12)
    v_mfma_f32_16x16x32_bf16 v[88:91], v[16:19], a[0:3], 0
    v_mfma_f32_16x16x32_bf16 v[88:91], v[20:23], a[4:7], v[88:91]
    buffer_load_dwordx4 v[76:79], v184, s[48:51], s23 offen offset:0 sc1
    v_mfma_f32_16x16x32_bf16 v[88:91], v[24:27], a[8:11], v[88:91]
    v_mul_f32 v152, v120, v120
    v_mul_f32 v153, v121, v121
    v_mfma_f32_16x16x32_bf16 v[92:95], v[16:19], a[72:75], 0
    v_mul_f32 v154, v122, v122
    v_mul_f32 v155, v123, v123
    v_mfma_f32_16x16x32_bf16 v[92:95], v[20:23], a[76:79], v[92:95]
    v_fma_f32 v152, v152, v8, v4
    v_fma_f32 v153, v153, v8, v4
    v_mfma_f32_16x16x32_bf16 v[92:95], v[24:27], a[80:83], v[92:95]
    buffer_load_dwordx4 v[80:83], v184, s[48:51], s23 offen offset:1024 sc1
    v_mfma_f32_16x16x32_bf16 v[96:99], v[16:19], a[144:147], 0
    v_fma_f32 v154, v154, v8, v4
    v_fma_f32 v155, v155, v8, v4
    v_mfma_f32_16x16x32_bf16 v[96:99], v[20:23], a[148:151], v[96:99]
    v_mul_f32 v152, v120, v152
    v_mul_f32 v153, v121, v153
    v_mfma_f32_16x16x32_bf16 v[96:99], v[24:27], a[152:155], v[96:99]
    v_mul_f32 v154, v122, v154
    v_mul_f32 v155, v123, v155
    v_mfma_f32_16x16x32_bf16 v[100:103], v[16:19], a[216:219], 0
    buffer_load_dwordx4 v[84:87], v184, s[48:51], s23 offen offset:2048 sc1
    v_mfma_f32_16x16x32_bf16 v[100:103], v[20:23], a[220:223], v[100:103]
    v_exp_f32 v152, v152
    v_mfma_f32_16x16x32_bf16 v[100:103], v[24:27], a[224:227], v[100:103]
    v_exp_f32 v153, v153
    s_waitcnt vmcnt(12)
    v_mfma_f32_16x16x32_bf16 v[104:107], v[28:31], a[0:3], 0
    v_exp_f32 v154, v154
    ds_read_b128 a[0:3], v10 offset:0
    v_mfma_f32_16x16x32_bf16 v[104:107], v[32:35], a[4:7], v[104:107]
    buffer_load_dwordx4 v[16:19], v184, s[48:51], s23 offen offset:3072 sc1
    v_mfma_f32_16x16x32_bf16 v[104:107], v[36:39], a[8:11], v[104:107]
    v_exp_f32 v155, v155
    v_mfma_f32_16x16x32_bf16 v[108:111], v[28:31], a[72:75], 0
    v_mul_f32 v156, v120, v136
    v_mul_f32 v157, v121, v137
    ds_read_b128 a[72:75], v10 offset:18432
    v_mfma_f32_16x16x32_bf16 v[108:111], v[32:35], a[76:79], v[108:111]
    v_mul_f32 v158, v122, v138
    v_mul_f32 v159, v123, v139
    v_mfma_f32_16x16x32_bf16 v[108:111], v[36:39], a[80:83], v[108:111]
    buffer_load_dwordx4 v[20:23], v185, s[48:51], s23 offen offset:0 sc1
    v_mfma_f32_16x16x32_bf16 v[112:115], v[28:31], a[144:147], 0
    v_fma_f32 v152, v152, v193, v193
    v_fma_f32 v153, v153, v193, v193
    ds_read_b128 a[144:147], v11 offset:0
    v_mfma_f32_16x16x32_bf16 v[112:115], v[32:35], a[148:151], v[112:115]
    v_fma_f32 v154, v154, v193, v193
    v_fma_f32 v155, v155, v193, v193
    v_mfma_f32_16x16x32_bf16 v[112:115], v[36:39], a[152:155], v[112:115]
    v_rcp_f32 v152, v152
    v_mfma_f32_16x16x32_bf16 v[116:119], v[28:31], a[216:219], 0
    buffer_load_dwordx4 v[24:27], v185, s[48:51], s23 offen offset:1024 sc1
    v_mfma_f32_16x16x32_bf16 v[116:119], v[32:35], a[220:223], v[116:119]
    v_rcp_f32 v153, v153
    ds_read_b128 a[216:219], v11 offset:18432
    v_mfma_f32_16x16x32_bf16 v[116:119], v[36:39], a[224:227], v[116:119]
    v_rcp_f32 v154, v154
    ds_read_b128 a[4:7], v10 offset:1024
    s_waitcnt vmcnt(12)
    v_mfma_f32_16x16x32_bf16 v[88:91], v[40:43], a[12:15], v[88:91]
    v_rcp_f32 v155, v155
    ds_read_b128 a[76:79], v10 offset:19456
    v_mfma_f32_16x16x32_bf16 v[88:91], v[44:47], a[16:19], v[88:91]
    buffer_load_dwordx4 v[28:31], v185, s[48:51], s23 offen offset:2048 sc1
    v_mfma_f32_16x16x32_bf16 v[88:91], v[48:51], a[20:23], v[88:91]
    v_mul_f32 v156, v156, v152
    v_mul_f32 v157, v157, v153
    ds_read_b128 a[148:151], v11 offset:1024
    v_mfma_f32_16x16x32_bf16 v[92:95], v[40:43], a[84:87], v[92:95]
    v_mul_f32 v158, v158, v154
    v_mul_f32 v159, v159, v155
    ds_read_b128 a[220:223], v11 offset:19456
    v_mfma_f32_16x16x32_bf16 v[92:95], v[44:47], a[88:91], v[92:95]
    v_cvt_pk_bf16_f32 v160, v156, v157
    v_cvt_pk_bf16_f32 v161, v158, v159
    ds_read_b128 a[8:11], v10 offset:2048
    v_mfma_f32_16x16x32_bf16 v[92:95], v[48:51], a[92:95], v[92:95]
    buffer_load_dwordx4 v[32:35], v185, s[48:51], s23 offen offset:3072 sc1
    v_mfma_f32_16x16x32_bf16 v[96:99], v[40:43], a[156:159], v[96:99]
    ds_write_b64 v12, v[160:161] offset:0
    v_mfma_f32_16x16x32_bf16 v[96:99], v[44:47], a[160:163], v[96:99]
    v_mul_f32 v162, v124, v124
    v_mul_f32 v163, v125, v125
    ds_read_b128 a[80:83], v10 offset:20480
    v_mfma_f32_16x16x32_bf16 v[96:99], v[48:51], a[164:167], v[96:99]
    v_mul_f32 v164, v126, v126
    v_mul_f32 v165, v127, v127
    ds_read_b128 a[152:155], v11 offset:2048
    v_mfma_f32_16x16x32_bf16 v[100:103], v[40:43], a[228:231], v[100:103]
    buffer_load_dwordx4 v[36:39], v186, s[48:51], s23 offen offset:0 sc1
    v_mfma_f32_16x16x32_bf16 v[100:103], v[44:47], a[232:235], v[100:103]
    v_fma_f32 v162, v162, v9, v5
    v_fma_f32 v163, v163, v9, v5
    ds_read_b128 a[224:227], v11 offset:20480
    v_mfma_f32_16x16x32_bf16 v[100:103], v[48:51], a[236:239], v[100:103]
    v_fma_f32 v164, v164, v9, v5
    v_fma_f32 v165, v165, v9, v5
    s_waitcnt vmcnt(12)
    v_mfma_f32_16x16x32_bf16 v[104:107], v[52:55], a[12:15], v[104:107]
    v_mul_f32 v162, v124, v162
    v_mul_f32 v163, v125, v163
    ds_read_b128 a[12:15], v10 offset:3072
    v_mfma_f32_16x16x32_bf16 v[104:107], v[56:59], a[16:19], v[104:107]
    buffer_load_dwordx4 v[40:43], v186, s[48:51], s23 offen offset:1024 sc1
    v_mfma_f32_16x16x32_bf16 v[104:107], v[60:63], a[20:23], v[104:107]
    v_mul_f32 v164, v126, v164
    v_mul_f32 v165, v127, v165
    v_mfma_f32_16x16x32_bf16 v[108:111], v[52:55], a[84:87], v[108:111]
    v_exp_f32 v162, v162
    ds_read_b128 a[84:87], v10 offset:21504
    v_mfma_f32_16x16x32_bf16 v[108:111], v[56:59], a[88:91], v[108:111]
    v_exp_f32 v163, v163
    v_mfma_f32_16x16x32_bf16 v[108:111], v[60:63], a[92:95], v[108:111]
    buffer_load_dwordx4 v[44:47], v186, s[48:51], s23 offen offset:2048 sc1
    v_mfma_f32_16x16x32_bf16 v[112:115], v[52:55], a[156:159], v[112:115]
    v_exp_f32 v164, v164
    ds_read_b128 a[156:159], v11 offset:3072
    v_mfma_f32_16x16x32_bf16 v[112:115], v[56:59], a[160:163], v[112:115]
    v_exp_f32 v165, v165
    v_mfma_f32_16x16x32_bf16 v[112:115], v[60:63], a[164:167], v[112:115]
    v_mul_f32 v166, v124, v140
    v_mul_f32 v167, v125, v141
    v_mfma_f32_16x16x32_bf16 v[116:119], v[52:55], a[228:231], v[116:119]
    buffer_load_dwordx4 v[48:51], v186, s[48:51], s23 offen offset:3072 sc1
    v_mfma_f32_16x16x32_bf16 v[116:119], v[56:59], a[232:235], v[116:119]
    v_mul_f32 v168, v126, v142
    v_mul_f32 v169, v127, v143
    ds_read_b128 a[228:231], v11 offset:21504
    v_mfma_f32_16x16x32_bf16 v[116:119], v[60:63], a[236:239], v[116:119]
    v_fma_f32 v162, v162, v194, v194
    v_fma_f32 v163, v163, v194, v194
    ds_read_b128 a[16:19], v10 offset:4096
    s_waitcnt vmcnt(12)
    v_mfma_f32_16x16x32_bf16 v[88:91], v[64:67], a[24:27], v[88:91]
    v_fma_f32 v164, v164, v194, v194
    v_fma_f32 v165, v165, v194, v194
    ds_read_b128 a[88:91], v10 offset:22528
    v_mfma_f32_16x16x32_bf16 v[88:91], v[68:71], a[28:31], v[88:91]
    buffer_load_dwordx4 v[52:55], v187, s[48:51], s23 offen offset:0 sc1
    v_mfma_f32_16x16x32_bf16 v[88:91], v[72:75], a[32:35], v[88:91]
    v_rcp_f32 v162, v162
    ds_read_b128 a[160:163], v11 offset:4096
    v_mfma_f32_16x16x32_bf16 v[92:95], v[64:67], a[96:99], v[92:95]
    v_rcp_f32 v163, v163
    ds_read_b128 a[232:235], v11 offset:22528
    v_mfma_f32_16x16x32_bf16 v[92:95], v[68:71], a[100:103], v[92:95]
    v_rcp_f32 v164, v164
    ds_read_b128 a[20:23], v10 offset:5120
    v_mfma_f32_16x16x32_bf16 v[92:95], v[72:75], a[104:107], v[92:95]
    buffer_load_dwordx4 v[56:59], v187, s[48:51], s23 offen offset:1024 sc1
    v_mfma_f32_16x16x32_bf16 v[96:99], v[64:67], a[168:171], v[96:99]
    v_rcp_f32 v165, v165
    ds_read_b128 a[92:95], v10 offset:23552
    v_mfma_f32_16x16x32_bf16 v[96:99], v[68:71], a[172:175], v[96:99]
    v_mul_f32 v166, v166, v162
    v_mul_f32 v167, v167, v163
    ds_read_b128 a[164:167], v11 offset:5120
    v_mfma_f32_16x16x32_bf16 v[96:99], v[72:75], a[176:179], v[96:99]
    v_mul_f32 v168, v168, v164
    v_mul_f32 v169, v169, v165
    ds_read_b128 a[236:239], v11 offset:23552
    v_mfma_f32_16x16x32_bf16 v[100:103], v[64:67], a[240:243], v[100:103]
    buffer_load_dwordx4 v[60:63], v187, s[48:51], s23 offen offset:2048 sc1
    v_mfma_f32_16x16x32_bf16 v[100:103], v[68:71], a[244:247], v[100:103]
    v_cvt_pk_bf16_f32 v170, v166, v167
    v_cvt_pk_bf16_f32 v171, v168, v169
    v_mfma_f32_16x16x32_bf16 v[100:103], v[72:75], a[248:251], v[100:103]
    ds_write_b64 v12, v[170:171] offset:18432
    s_waitcnt vmcnt(12)
    v_mfma_f32_16x16x32_bf16 v[104:107], v[76:79], a[24:27], v[104:107]
    v_mul_f32 v152, v128, v128
    v_mul_f32 v153, v129, v129
    ds_read_b128 a[24:27], v10 offset:6144
    v_mfma_f32_16x16x32_bf16 v[104:107], v[80:83], a[28:31], v[104:107]
    buffer_load_dwordx4 v[64:67], v187, s[48:51], s23 offen offset:3072 sc1
    v_mfma_f32_16x16x32_bf16 v[104:107], v[84:87], a[32:35], v[104:107]
    v_mul_f32 v154, v130, v130
    v_mul_f32 v155, v131, v131
    v_mfma_f32_16x16x32_bf16 v[108:111], v[76:79], a[96:99], v[108:111]
    v_fma_f32 v152, v152, v13, v6
    v_fma_f32 v153, v153, v13, v6
    ds_read_b128 a[96:99], v10 offset:24576
    v_mfma_f32_16x16x32_bf16 v[108:111], v[80:83], a[100:103], v[108:111]
    v_fma_f32 v154, v154, v13, v6
    v_fma_f32 v155, v155, v13, v6
    v_mfma_f32_16x16x32_bf16 v[108:111], v[84:87], a[104:107], v[108:111]
    buffer_load_dwordx4 v[68:71], v188, s[48:51], s23 offen offset:0 sc1
    v_mfma_f32_16x16x32_bf16 v[112:115], v[76:79], a[168:171], v[112:115]
    v_mul_f32 v152, v128, v152
    v_mul_f32 v153, v129, v153
    ds_read_b128 a[168:171], v11 offset:6144
    v_mfma_f32_16x16x32_bf16 v[112:115], v[80:83], a[172:175], v[112:115]
    v_mul_f32 v154, v130, v154
    v_mul_f32 v155, v131, v155
    v_mfma_f32_16x16x32_bf16 v[112:115], v[84:87], a[176:179], v[112:115]
    v_exp_f32 v152, v152
    v_mfma_f32_16x16x32_bf16 v[116:119], v[76:79], a[240:243], v[116:119]
    buffer_load_dwordx4 v[72:75], v188, s[48:51], s23 offen offset:1024 sc1
    v_mfma_f32_16x16x32_bf16 v[116:119], v[80:83], a[244:247], v[116:119]
    v_exp_f32 v153, v153
    ds_read_b128 a[240:243], v11 offset:24576
    v_mfma_f32_16x16x32_bf16 v[116:119], v[84:87], a[248:251], v[116:119]
    v_exp_f32 v154, v154
    ds_read_b128 a[28:31], v10 offset:7168
    s_waitcnt vmcnt(12)
    v_mfma_f32_16x16x32_bf16 v[88:91], v[16:19], a[36:39], v[88:91]
    v_exp_f32 v155, v155
    ds_read_b128 a[100:103], v10 offset:25600
    v_mfma_f32_16x16x32_bf16 v[88:91], v[20:23], a[40:43], v[88:91]
    buffer_load_dwordx4 v[76:79], v188, s[48:51], s23 offen offset:2048 sc1
    v_mfma_f32_16x16x32_bf16 v[88:91], v[24:27], a[44:47], v[88:91]
    v_mul_f32 v156, v128, v144
    v_mul_f32 v157, v129, v145
    ds_read_b128 a[172:175], v11 offset:7168
    v_mfma_f32_16x16x32_bf16 v[92:95], v[16:19], a[108:111], v[92:95]
    v_mul_f32 v158, v130, v146
    v_mul_f32 v159, v131, v147
    ds_read_b128 a[244:247], v11 offset:25600
    v_mfma_f32_16x16x32_bf16 v[92:95], v[20:23], a[112:115], v[92:95]
    v_fma_f32 v152, v152, v195, v195
    v_fma_f32 v153, v153, v195, v195
    ds_read_b128 a[32:35], v10 offset:8192
    v_mfma_f32_16x16x32_bf16 v[92:95], v[24:27], a[116:119], v[92:95]
    buffer_load_dwordx4 v[80:83], v188, s[48:51], s23 offen offset:3072 sc1
    v_mfma_f32_16x16x32_bf16 v[96:99], v[16:19], a[180:183], v[96:99]
    v_fma_f32 v154, v154, v195, v195
    v_fma_f32 v155, v155, v195, v195
    ds_read_b128 a[104:107], v10 offset:26624
    v_mfma_f32_16x16x32_bf16 v[96:99], v[20:23], a[184:187], v[96:99]
    v_rcp_f32 v152, v152
    ds_read_b128 a[176:179], v11 offset:8192
    v_mfma_f32_16x16x32_bf16 v[96:99], v[24:27], a[188:191], v[96:99]
    v_rcp_f32 v153, v153
    ds_read_b128 a[248:251], v11 offset:26624
    v_mfma_f32_16x16x32_bf16 v[100:103], v[16:19], a[252:255], v[100:103]
    buffer_load_dwordx4 v[84:87], v189, s[48:51], s23 offen offset:0 sc1
    v_mfma_f32_16x16x32_bf16 v[100:103], v[20:23], v[220:223], v[100:103]
    v_rcp_f32 v154, v154
    v_mfma_f32_16x16x32_bf16 v[100:103], v[24:27], v[224:227], v[100:103]
    v_rcp_f32 v155, v155
    s_waitcnt vmcnt(12)
    v_mfma_f32_16x16x32_bf16 v[104:107], v[28:31], a[36:39], v[104:107]
    v_mul_f32 v156, v156, v152
    v_mul_f32 v157, v157, v153
    ds_read_b128 a[36:39], v10 offset:9216
    v_mfma_f32_16x16x32_bf16 v[104:107], v[32:35], a[40:43], v[104:107]
    buffer_load_dwordx4 v[16:19], v189, s[48:51], s23 offen offset:1024 sc1
    v_mfma_f32_16x16x32_bf16 v[104:107], v[36:39], a[44:47], v[104:107]
    v_mul_f32 v158, v158, v154
    v_mul_f32 v159, v159, v155
    v_mfma_f32_16x16x32_bf16 v[108:111], v[28:31], a[108:111], v[108:111]
    v_cvt_pk_bf16_f32 v160, v156, v157
    v_cvt_pk_bf16_f32 v161, v158, v159
    ds_read_b128 a[108:111], v10 offset:27648
    v_mfma_f32_16x16x32_bf16 v[108:111], v[32:35], a[112:115], v[108:111]
    ds_write_b64 v12, v[160:161] offset:36864
    v_mfma_f32_16x16x32_bf16 v[108:111], v[36:39], a[116:119], v[108:111]
    buffer_load_dwordx4 v[20:23], v189, s[48:51], s23 offen offset:2048 sc1
    v_mfma_f32_16x16x32_bf16 v[112:115], v[28:31], a[180:183], v[112:115]
    v_mul_f32 v162, v132, v132
    v_mul_f32 v163, v133, v133
    ds_read_b128 a[180:183], v11 offset:9216
    v_mfma_f32_16x16x32_bf16 v[112:115], v[32:35], a[184:187], v[112:115]
    v_mul_f32 v164, v134, v134
    v_mul_f32 v165, v135, v135
    v_mfma_f32_16x16x32_bf16 v[112:115], v[36:39], a[188:191], v[112:115]
    v_fma_f32 v162, v162, v14, v7
    v_fma_f32 v163, v163, v14, v7
    v_mfma_f32_16x16x32_bf16 v[116:119], v[28:31], a[252:255], v[116:119]
    buffer_load_dwordx4 v[24:27], v189, s[48:51], s23 offen offset:3072 sc1
    v_mfma_f32_16x16x32_bf16 v[116:119], v[32:35], v[220:223], v[116:119]
    v_fma_f32 v164, v164, v14, v7
    v_fma_f32 v165, v165, v14, v7
    ds_read_b128 a[252:255], v11 offset:27648
    v_mfma_f32_16x16x32_bf16 v[116:119], v[36:39], v[224:227], v[116:119]
    v_mul_f32 v162, v132, v162
    v_mul_f32 v163, v133, v163
    ds_read_b128 a[40:43], v10 offset:10240
    s_waitcnt vmcnt(12)
    v_mfma_f32_16x16x32_bf16 v[88:91], v[40:43], a[48:51], v[88:91]
    v_mul_f32 v164, v134, v164
    v_mul_f32 v165, v135, v165
    ds_read_b128 a[112:115], v10 offset:28672
    v_mfma_f32_16x16x32_bf16 v[88:91], v[44:47], a[52:55], v[88:91]
    buffer_load_dwordx4 v[28:31], v190, s[48:51], s23 offen offset:0 sc1
    v_mfma_f32_16x16x32_bf16 v[88:91], v[48:51], a[56:59], v[88:91]
    v_exp_f32 v162, v162
    ds_read_b128 a[184:187], v11 offset:10240
    v_mfma_f32_16x16x32_bf16 v[92:95], v[40:43], a[120:123], v[92:95]
    v_exp_f32 v163, v163
    ds_read_b128 v[220:223], v11 offset:28672
    v_mfma_f32_16x16x32_bf16 v[92:95], v[44:47], a[124:127], v[92:95]
    v_exp_f32 v164, v164
    ds_read_b128 a[44:47], v10 offset:11264
    v_mfma_f32_16x16x32_bf16 v[92:95], v[48:51], a[128:131], v[92:95]
    buffer_load_dwordx4 v[32:35], v190, s[48:51], s23 offen offset:1024 sc1
    v_mfma_f32_16x16x32_bf16 v[96:99], v[40:43], a[192:195], v[96:99]
    v_exp_f32 v165, v165
    ds_read_b128 a[116:119], v10 offset:29696
    v_mfma_f32_16x16x32_bf16 v[96:99], v[44:47], a[196:199], v[96:99]
    v_mul_f32 v166, v132, v148
    v_mul_f32 v167, v133, v149
    ds_read_b128 a[188:191], v11 offset:11264
    v_mfma_f32_16x16x32_bf16 v[96:99], v[48:51], a[200:203], v[96:99]
    v_mul_f32 v168, v134, v150
    v_mul_f32 v169, v135, v151
    ds_read_b128 v[224:227], v11 offset:29696
    v_mfma_f32_16x16x32_bf16 v[100:103], v[40:43], v[228:231], v[100:103]
    buffer_load_dwordx4 v[36:39], v190, s[48:51], s23 offen offset:2048 sc1
    v_mfma_f32_16x16x32_bf16 v[100:103], v[44:47], v[232:235], v[100:103]
    v_fma_f32 v162, v162, v252, v252
    v_fma_f32 v163, v163, v252, v252
    v_mfma_f32_16x16x32_bf16 v[100:103], v[48:51], v[236:239], v[100:103]
    v_fma_f32 v164, v164, v252, v252
    v_fma_f32 v165, v165, v252, v252
    s_waitcnt vmcnt(12)
    v_mfma_f32_16x16x32_bf16 v[104:107], v[52:55], a[48:51], v[104:107]
    v_rcp_f32 v162, v162
    ds_read_b128 a[48:51], v10 offset:12288
    v_mfma_f32_16x16x32_bf16 v[104:107], v[56:59], a[52:55], v[104:107]
    buffer_load_dwordx4 v[40:43], v190, s[48:51], s23 offen offset:3072 sc1
    v_mfma_f32_16x16x32_bf16 v[104:107], v[60:63], a[56:59], v[104:107]
    v_rcp_f32 v163, v163
    v_mfma_f32_16x16x32_bf16 v[108:111], v[52:55], a[120:123], v[108:111]
    v_rcp_f32 v164, v164
    ds_read_b128 a[120:123], v10 offset:30720
    v_mfma_f32_16x16x32_bf16 v[108:111], v[56:59], a[124:127], v[108:111]
    v_rcp_f32 v165, v165
    v_mfma_f32_16x16x32_bf16 v[108:111], v[60:63], a[128:131], v[108:111]
    buffer_load_dwordx4 v[44:47], v191, s[48:51], s23 offen offset:0 sc1
    v_mfma_f32_16x16x32_bf16 v[112:115], v[52:55], a[192:195], v[112:115]
    v_mul_f32 v166, v166, v162
    v_mul_f32 v167, v167, v163
    ds_read_b128 a[192:195], v11 offset:12288
    v_mfma_f32_16x16x32_bf16 v[112:115], v[56:59], a[196:199], v[112:115]
    v_mul_f32 v168, v168, v164
    v_mul_f32 v169, v169, v165
    v_mfma_f32_16x16x32_bf16 v[112:115], v[60:63], a[200:203], v[112:115]
    v_cvt_pk_bf16_f32 v170, v166, v167
    v_cvt_pk_bf16_f32 v171, v168, v169
    v_mfma_f32_16x16x32_bf16 v[116:119], v[52:55], v[228:231], v[116:119]
    buffer_load_dwordx4 v[48:51], v191, s[48:51], s23 offen offset:1024 sc1
    v_mfma_f32_16x16x32_bf16 v[116:119], v[56:59], v[232:235], v[116:119]
    ds_write_b64 v12, v[170:171] offset:55296
    v_mfma_f32_16x16x32_bf16 v[116:119], v[60:63], v[236:239], v[116:119]
    ds_read_b128 v[228:231], v11 offset:30720
    s_waitcnt vmcnt(12)
    v_mfma_f32_16x16x32_bf16 v[88:91], v[64:67], a[60:63], v[88:91]
    ds_read_b128 a[52:55], v10 offset:13312
    v_mfma_f32_16x16x32_bf16 v[88:91], v[68:71], a[64:67], v[88:91]
    buffer_load_dwordx4 v[52:55], v191, s[48:51], s23 offen offset:2048 sc1
    v_mfma_f32_16x16x32_bf16 v[120:123], v[72:75], a[68:71], v[88:91]
    ds_read_b128 a[124:127], v10 offset:31744
    v_mfma_f32_16x16x32_bf16 v[92:95], v[64:67], a[132:135], v[92:95]
    ds_read_b128 a[196:199], v11 offset:13312
    v_mfma_f32_16x16x32_bf16 v[92:95], v[68:71], a[136:139], v[92:95]
    ds_read_b128 v[232:235], v11 offset:31744
    v_mfma_f32_16x16x32_bf16 v[124:127], v[72:75], a[140:143], v[92:95]
    buffer_load_dwordx4 v[56:59], v191, s[48:51], s23 offen offset:3072 sc1
    v_mfma_f32_16x16x32_bf16 v[96:99], v[64:67], a[204:207], v[96:99]
    v_mfma_f32_16x16x32_bf16 v[96:99], v[68:71], a[208:211], v[96:99]
    v_mfma_f32_16x16x32_bf16 v[128:131], v[72:75], a[212:215], v[96:99]
    v_mfma_f32_16x16x32_bf16 v[100:103], v[64:67], v[240:243], v[100:103]
    buffer_load_dwordx4 v[60:63], v192, s[48:51], s23 offen offset:0 sc1
    v_mfma_f32_16x16x32_bf16 v[100:103], v[68:71], v[244:247], v[100:103]
    v_mfma_f32_16x16x32_bf16 v[132:135], v[72:75], v[248:251], v[100:103]
    s_waitcnt vmcnt(12)
    v_mfma_f32_16x16x32_bf16 v[104:107], v[76:79], a[60:63], v[104:107]
    v_mfma_f32_16x16x32_bf16 v[104:107], v[80:83], a[64:67], v[104:107]
    buffer_load_dwordx4 v[64:67], v192, s[48:51], s23 offen offset:1024 sc1
    v_mfma_f32_16x16x32_bf16 v[136:139], v[84:87], a[68:71], v[104:107]
    v_mfma_f32_16x16x32_bf16 v[108:111], v[76:79], a[132:135], v[108:111]
    v_mfma_f32_16x16x32_bf16 v[108:111], v[80:83], a[136:139], v[108:111]
    v_mfma_f32_16x16x32_bf16 v[140:143], v[84:87], a[140:143], v[108:111]
    buffer_load_dwordx4 v[68:71], v192, s[48:51], s23 offen offset:2048 sc1
    v_mfma_f32_16x16x32_bf16 v[112:115], v[76:79], a[204:207], v[112:115]
    v_mfma_f32_16x16x32_bf16 v[112:115], v[80:83], a[208:211], v[112:115]
    s_lshl_b32 s7, s25, 11
    v_mfma_f32_16x16x32_bf16 v[144:147], v[84:87], a[212:215], v[112:115]
    s_add_u32 s7, s7, s28
    v_mfma_f32_16x16x32_bf16 v[116:119], v[76:79], v[240:243], v[116:119]
    buffer_load_dwordx4 v[72:75], v192, s[48:51], s23 offen offset:3072 sc1
    v_mfma_f32_16x16x32_bf16 v[116:119], v[80:83], v[244:247], v[116:119]
    s_add_u32 s23, s23, 36864
    v_mfma_f32_16x16x32_bf16 v[148:151], v[84:87], v[248:251], v[116:119]
    v_add_u32 v12, s7, v184
    s_add_u32 s25, s25, 1
    s_waitcnt lgkmcnt(0)
    s_barrier
    v_pk_mul_f32 v[152:153], v[120:121], v[120:121]
    ds_read_b128 a[56:59], v10 offset:14336
    v_pk_mul_f32 v[154:155], v[122:123], v[122:123]
    ds_read_b128 a[128:131], v10 offset:32768
    v_pk_fma_f32 v[152:153], v[152:153], v[8:9], v[4:5] op_sel:[0,0,0] op_sel_hi:[1,0,0]
    ds_read_b128 a[200:203], v11 offset:14336
    v_pk_fma_f32 v[154:155], v[154:155], v[8:9], v[4:5] op_sel:[0,0,0] op_sel_hi:[1,0,0]
    v_pk_mul_f32 v[152:153], v[120:121], v[152:153]
    ds_read_b128 v[236:239], v11 offset:32768
    v_pk_mul_f32 v[154:155], v[122:123], v[154:155]
    ds_read_b128 a[60:63], v10 offset:15360
    buffer_load_dwordx4 v[76:79], v184, s[48:51], s23 offen offset:0 sc1
    v_exp_f32 v152, v152
    ds_read_b128 a[132:135], v10 offset:33792
    v_exp_f32 v153, v153
    v_exp_f32 v154, v154
    ds_read_b128 a[204:207], v11 offset:15360
    v_exp_f32 v155, v155
    ds_read_b128 v[240:243], v11 offset:33792
    v_pk_mul_f32 v[156:157], v[120:121], v[136:137]
    v_pk_mul_f32 v[158:159], v[122:123], v[138:139]
    buffer_load_dwordx4 v[80:83], v184, s[48:51], s23 offen offset:1024 sc1
    v_pk_fma_f32 v[152:153], v[152:153], v[192:193], v[192:193] op_sel:[0,1,1] op_sel_hi:[1,1,1]
    v_pk_fma_f32 v[154:155], v[154:155], v[192:193], v[192:193] op_sel:[0,1,1] op_sel_hi:[1,1,1]
    v_rcp_f32 v152, v152
    v_rcp_f32 v153, v153
    v_rcp_f32 v154, v154
    v_rcp_f32 v155, v155
    buffer_load_dwordx4 v[84:87], v184, s[48:51], s23 offen offset:2048 sc1
    s_nop 0
    v_pk_mul_f32 v[156:157], v[156:157], v[152:153]
    v_pk_mul_f32 v[158:159], v[158:159], v[154:155]
    v_cvt_pk_bf16_f32 v160, v156, v157
    v_cvt_pk_bf16_f32 v161, v158, v159
    ds_write_b64 v12, v[160:161] offset:0
    buffer_load_dwordx4 v[104:107], v184, s[48:51], s23 offen offset:3072 sc1
    v_pk_mul_f32 v[162:163], v[124:125], v[124:125]
    v_pk_mul_f32 v[164:165], v[126:127], v[126:127]
    v_pk_fma_f32 v[162:163], v[162:163], v[8:9], v[4:5] op_sel:[0,1,1] op_sel_hi:[1,1,1]
    v_pk_fma_f32 v[164:165], v[164:165], v[8:9], v[4:5] op_sel:[0,1,1] op_sel_hi:[1,1,1]
    v_pk_mul_f32 v[162:163], v[124:125], v[162:163]
    v_pk_mul_f32 v[164:165], v[126:127], v[164:165]
    buffer_load_dwordx4 v[108:111], v185, s[48:51], s23 offen offset:0 sc1
    v_exp_f32 v162, v162
    v_exp_f32 v163, v163
    v_exp_f32 v164, v164
    v_exp_f32 v165, v165
    v_pk_mul_f32 v[166:167], v[124:125], v[140:141]
    v_pk_mul_f32 v[168:169], v[126:127], v[142:143]
    buffer_load_dwordx4 v[112:115], v185, s[48:51], s23 offen offset:1024 sc1
    v_pk_fma_f32 v[162:163], v[162:163], v[194:195], v[194:195] op_sel:[0,0,0] op_sel_hi:[1,0,0]
    v_pk_fma_f32 v[164:165], v[164:165], v[194:195], v[194:195] op_sel:[0,0,0] op_sel_hi:[1,0,0]
    v_rcp_f32 v162, v162
    v_rcp_f32 v163, v163
    v_rcp_f32 v164, v164
    v_rcp_f32 v165, v165
    buffer_load_dwordx4 v[116:119], v185, s[48:51], s23 offen offset:2048 sc1
    s_nop 0
    v_pk_mul_f32 v[166:167], v[166:167], v[162:163]
    v_pk_mul_f32 v[168:169], v[168:169], v[164:165]
    v_cvt_pk_bf16_f32 v170, v166, v167
    v_cvt_pk_bf16_f32 v171, v168, v169
    ds_write_b64 v12, v[170:171] offset:18432
    buffer_load_dwordx4 v[180:183], v185, s[48:51], s23 offen offset:3072 sc1
    v_pk_mul_f32 v[152:153], v[128:129], v[128:129]
    v_pk_mul_f32 v[154:155], v[130:131], v[130:131]
    v_pk_fma_f32 v[152:153], v[152:153], v[12:13], v[6:7] op_sel:[0,1,0] op_sel_hi:[1,1,0]
    v_pk_fma_f32 v[154:155], v[154:155], v[12:13], v[6:7] op_sel:[0,1,0] op_sel_hi:[1,1,0]
    v_pk_mul_f32 v[152:153], v[128:129], v[152:153]
    v_pk_mul_f32 v[154:155], v[130:131], v[154:155]
    buffer_load_dwordx4 v[196:199], v186, s[48:51], s23 offen offset:0 sc1
    v_exp_f32 v152, v152
    v_exp_f32 v153, v153
    v_exp_f32 v154, v154
    v_exp_f32 v155, v155
    v_pk_mul_f32 v[156:157], v[128:129], v[144:145]
    v_pk_mul_f32 v[158:159], v[130:131], v[146:147]
    buffer_load_dwordx4 v[200:203], v186, s[48:51], s23 offen offset:1024 sc1
    v_pk_fma_f32 v[152:153], v[152:153], v[194:195], v[194:195] op_sel:[0,1,1] op_sel_hi:[1,1,1]
    v_pk_fma_f32 v[154:155], v[154:155], v[194:195], v[194:195] op_sel:[0,1,1] op_sel_hi:[1,1,1]
    v_rcp_f32 v152, v152
    v_rcp_f32 v153, v153
    v_rcp_f32 v154, v154
    v_rcp_f32 v155, v155
    buffer_load_dwordx4 v[204:207], v186, s[48:51], s23 offen offset:2048 sc1
    s_nop 0
    v_pk_mul_f32 v[156:157], v[156:157], v[152:153]
    v_pk_mul_f32 v[158:159], v[158:159], v[154:155]
    v_cvt_pk_bf16_f32 v160, v156, v157
    v_cvt_pk_bf16_f32 v161, v158, v159
    ds_write_b64 v12, v[160:161] offset:36864
    buffer_load_dwordx4 v[208:211], v186, s[48:51], s23 offen offset:3072 sc1
    v_pk_mul_f32 v[162:163], v[132:133], v[132:133]
    v_pk_mul_f32 v[164:165], v[134:135], v[134:135]
    v_pk_fma_f32 v[162:163], v[162:163], v[14:15], v[6:7] op_sel:[0,0,1] op_sel_hi:[1,0,1]
    v_pk_fma_f32 v[164:165], v[164:165], v[14:15], v[6:7] op_sel:[0,0,1] op_sel_hi:[1,0,1]
    v_pk_mul_f32 v[162:163], v[132:133], v[162:163]
    v_pk_mul_f32 v[164:165], v[134:135], v[164:165]
    buffer_load_dwordx4 v[212:215], v187, s[48:51], s23 offen offset:0 sc1
    v_exp_f32 v162, v162
    v_exp_f32 v163, v163
    v_exp_f32 v164, v164
    v_exp_f32 v165, v165
    v_pk_mul_f32 v[166:167], v[132:133], v[148:149]
    v_pk_mul_f32 v[168:169], v[134:135], v[150:151]
    v_pk_fma_f32 v[162:163], v[162:163], v[252:253], v[252:253] op_sel:[0,0,0] op_sel_hi:[1,0,0]
    v_pk_fma_f32 v[164:165], v[164:165], v[252:253], v[252:253] op_sel:[0,0,0] op_sel_hi:[1,0,0]
    v_rcp_f32 v162, v162
    v_rcp_f32 v163, v163
    v_rcp_f32 v164, v164
    v_rcp_f32 v165, v165
    s_nop 0
    v_pk_mul_f32 v[166:167], v[166:167], v[162:163]
    v_pk_mul_f32 v[168:169], v[168:169], v[164:165]
    v_cvt_pk_bf16_f32 v170, v166, v167
    v_cvt_pk_bf16_f32 v171, v168, v169
    ds_write_b64 v12, v[170:171] offset:55296
    buffer_load_dwordx4 v[136:139], v187, s[48:51], s23 offen offset:1024 sc1
    buffer_load_dwordx4 v[140:143], v187, s[48:51], s23 offen offset:2048 sc1
    buffer_load_dwordx4 v[144:147], v187, s[48:51], s23 offen offset:3072 sc1
    buffer_load_dwordx4 v[160:163], v188, s[48:51], s23 offen offset:0 sc1
    buffer_load_dwordx4 v[164:167], v188, s[48:51], s23 offen offset:1024 sc1
    s_add_u32 s23, s23, 18432
    s_waitcnt lgkmcnt(0)
    s_barrier
    ds_read_b128 a[64:67], v10 offset:16384
    ds_read_b128 a[136:139], v10 offset:34816
    ds_read_b128 a[208:211], v11 offset:16384
    ds_read_b128 v[244:247], v11 offset:34816
    ds_read_b128 a[68:71], v10 offset:17408
    ds_read_b128 a[140:143], v10 offset:35840
    ds_read_b128 a[212:215], v11 offset:17408
    ds_read_b128 v[248:251], v11 offset:35840
    s_mov_b32 s25, 0
    s_waitcnt lgkmcnt(0)
    s_branch L_ffn_dn_mid_42
L_ffn_dn_41:
    s_waitcnt vmcnt(32)
    v_mfma_f32_16x16x32_bf16 v[88:91], v[104:107], a[0:3], 0
    v_mfma_f32_16x16x32_bf16 v[88:91], v[108:111], a[4:7], v[88:91]
    buffer_load_dwordx4 v[76:79], v184, s[48:51], s23 offen offset:0 sc1
    v_mfma_f32_16x16x32_bf16 v[88:91], v[112:115], a[8:11], v[88:91]
    v_mfma_f32_16x16x32_bf16 v[92:95], v[104:107], a[72:75], 0
    v_mfma_f32_16x16x32_bf16 v[92:95], v[108:111], a[76:79], v[92:95]
    v_mfma_f32_16x16x32_bf16 v[92:95], v[112:115], a[80:83], v[92:95]
    buffer_load_dwordx4 v[80:83], v184, s[48:51], s23 offen offset:1024 sc1
    v_mfma_f32_16x16x32_bf16 v[96:99], v[104:107], a[144:147], 0
    v_cvt_pk_bf16_f32 v152, v120, v121
    v_cvt_pk_bf16_f32 v153, v122, v123
    v_mfma_f32_16x16x32_bf16 v[96:99], v[108:111], a[148:151], v[96:99]
    v_cvt_pk_bf16_f32 v154, v124, v125
    v_cvt_pk_bf16_f32 v155, v126, v127
    v_mfma_f32_16x16x32_bf16 v[96:99], v[112:115], a[152:155], v[96:99]
    s_nop 0
    v_permlane16_swap_b32 v152, v154
    v_mfma_f32_16x16x32_bf16 v[100:103], v[104:107], a[216:219], 0
    buffer_load_dwordx4 v[84:87], v184, s[48:51], s23 offen offset:2048 sc1
    v_mfma_f32_16x16x32_bf16 v[100:103], v[108:111], a[220:223], v[100:103]
    v_permlane16_swap_b32 v153, v155
    v_mfma_f32_16x16x32_bf16 v[100:103], v[112:115], a[224:227], v[100:103]
    buffer_store_dwordx4 v[152:155], v178, s[72:75], s27 offen sc1
    s_waitcnt vmcnt(33)
    v_mfma_f32_16x16x32_bf16 v[88:91], v[116:119], a[12:15], v[88:91]
    ds_write_b128 v216, v[152:155]
    v_mfma_f32_16x16x32_bf16 v[88:91], v[180:183], a[16:19], v[88:91]
    buffer_load_dwordx4 v[104:107], v184, s[48:51], s23 offen offset:3072 sc1
    v_mfma_f32_16x16x32_bf16 v[88:91], v[196:199], a[20:23], v[88:91]
    v_add_u32 v216, v216, v218
    v_mfma_f32_16x16x32_bf16 v[92:95], v[116:119], a[84:87], v[92:95]
    v_mfma_f32_16x16x32_bf16 v[92:95], v[180:183], a[88:91], v[92:95]
    v_mfma_f32_16x16x32_bf16 v[92:95], v[196:199], a[92:95], v[92:95]
    buffer_load_dwordx4 v[108:111], v185, s[48:51], s23 offen offset:0 sc1
    v_mfma_f32_16x16x32_bf16 v[96:99], v[116:119], a[156:159], v[96:99]
    v_mfma_f32_16x16x32_bf16 v[96:99], v[180:183], a[160:163], v[96:99]
    v_mfma_f32_16x16x32_bf16 v[96:99], v[196:199], a[164:167], v[96:99]
    v_mfma_f32_16x16x32_bf16 v[100:103], v[116:119], a[228:231], v[100:103]
    buffer_load_dwordx4 v[112:115], v185, s[48:51], s23 offen offset:1024 sc1
    v_mfma_f32_16x16x32_bf16 v[100:103], v[180:183], a[232:235], v[100:103]
    v_mfma_f32_16x16x32_bf16 v[100:103], v[196:199], a[236:239], v[100:103]
    s_waitcnt vmcnt(33)
    v_mfma_f32_16x16x32_bf16 v[88:91], v[200:203], a[24:27], v[88:91]
    v_mfma_f32_16x16x32_bf16 v[88:91], v[204:207], a[28:31], v[88:91]
    buffer_load_dwordx4 v[116:119], v185, s[48:51], s23 offen offset:2048 sc1
    v_mfma_f32_16x16x32_bf16 v[88:91], v[208:211], a[32:35], v[88:91]
    v_mfma_f32_16x16x32_bf16 v[92:95], v[200:203], a[96:99], v[92:95]
    v_mfma_f32_16x16x32_bf16 v[92:95], v[204:207], a[100:103], v[92:95]
    v_mfma_f32_16x16x32_bf16 v[92:95], v[208:211], a[104:107], v[92:95]
    buffer_load_dwordx4 v[180:183], v185, s[48:51], s23 offen offset:3072 sc1
    v_mfma_f32_16x16x32_bf16 v[96:99], v[200:203], a[168:171], v[96:99]
    v_mfma_f32_16x16x32_bf16 v[96:99], v[204:207], a[172:175], v[96:99]
    v_mfma_f32_16x16x32_bf16 v[96:99], v[208:211], a[176:179], v[96:99]
    v_mfma_f32_16x16x32_bf16 v[100:103], v[200:203], a[240:243], v[100:103]
    buffer_load_dwordx4 v[196:199], v186, s[48:51], s23 offen offset:0 sc1
    v_mfma_f32_16x16x32_bf16 v[100:103], v[204:207], a[244:247], v[100:103]
    v_mfma_f32_16x16x32_bf16 v[100:103], v[208:211], a[248:251], v[100:103]
    s_waitcnt vmcnt(33)
    v_mfma_f32_16x16x32_bf16 v[88:91], v[212:215], a[36:39], v[88:91]
    v_mfma_f32_16x16x32_bf16 v[88:91], v[136:139], a[40:43], v[88:91]
    buffer_load_dwordx4 v[200:203], v186, s[48:51], s23 offen offset:1024 sc1
    v_mfma_f32_16x16x32_bf16 v[88:91], v[140:143], a[44:47], v[88:91]
    v_mfma_f32_16x16x32_bf16 v[92:95], v[212:215], a[108:111], v[92:95]
    v_mfma_f32_16x16x32_bf16 v[92:95], v[136:139], a[112:115], v[92:95]
    v_cvt_pk_bf16_f32 v156, v128, v129
    v_cvt_pk_bf16_f32 v157, v130, v131
    v_mfma_f32_16x16x32_bf16 v[92:95], v[140:143], a[116:119], v[92:95]
    buffer_load_dwordx4 v[204:207], v186, s[48:51], s23 offen offset:2048 sc1
    v_mfma_f32_16x16x32_bf16 v[96:99], v[212:215], a[180:183], v[96:99]
    v_cvt_pk_bf16_f32 v158, v132, v133
    v_cvt_pk_bf16_f32 v159, v134, v135
    v_mfma_f32_16x16x32_bf16 v[96:99], v[136:139], a[184:187], v[96:99]
    s_nop 0
    v_permlane16_swap_b32 v156, v158
    v_mfma_f32_16x16x32_bf16 v[96:99], v[140:143], a[188:191], v[96:99]
    v_permlane16_swap_b32 v157, v159
    v_mfma_f32_16x16x32_bf16 v[100:103], v[212:215], a[252:255], v[100:103]
    buffer_load_dwordx4 v[208:211], v186, s[48:51], s23 offen offset:3072 sc1
    v_mfma_f32_16x16x32_bf16 v[100:103], v[136:139], v[220:223], v[100:103]
    buffer_store_dwordx4 v[156:159], v179, s[72:75], s27 offen sc1
    v_mfma_f32_16x16x32_bf16 v[100:103], v[140:143], v[224:227], v[100:103]
    ds_write_b128 v217, v[156:159]
    s_waitcnt vmcnt(34)
    v_mfma_f32_16x16x32_bf16 v[88:91], v[144:147], a[48:51], v[88:91]
    v_add_u32 v217, v217, v219
    v_mfma_f32_16x16x32_bf16 v[88:91], v[160:163], a[52:55], v[88:91]
    buffer_load_dwordx4 v[212:215], v187, s[48:51], s23 offen offset:0 sc1
    v_mfma_f32_16x16x32_bf16 v[88:91], v[164:167], a[56:59], v[88:91]
    v_mfma_f32_16x16x32_bf16 v[92:95], v[144:147], a[120:123], v[92:95]
    v_mfma_f32_16x16x32_bf16 v[92:95], v[160:163], a[124:127], v[92:95]
    v_mfma_f32_16x16x32_bf16 v[92:95], v[164:167], a[128:131], v[92:95]
    buffer_load_dwordx4 v[136:139], v187, s[48:51], s23 offen offset:1024 sc1
    v_mfma_f32_16x16x32_bf16 v[96:99], v[144:147], a[192:195], v[96:99]
    v_mfma_f32_16x16x32_bf16 v[96:99], v[160:163], a[196:199], v[96:99]
    v_mfma_f32_16x16x32_bf16 v[96:99], v[164:167], a[200:203], v[96:99]
    v_mfma_f32_16x16x32_bf16 v[100:103], v[144:147], v[228:231], v[100:103]
    buffer_load_dwordx4 v[140:143], v187, s[48:51], s23 offen offset:2048 sc1
    v_mfma_f32_16x16x32_bf16 v[100:103], v[160:163], v[232:235], v[100:103]
    v_mfma_f32_16x16x32_bf16 v[100:103], v[164:167], v[236:239], v[100:103]
    s_waitcnt vmcnt(34)
    v_mfma_f32_16x16x32_bf16 v[88:91], v[168:171], a[60:63], v[88:91]
    v_mfma_f32_16x16x32_bf16 v[88:91], v[148:151], a[64:67], v[88:91]
    buffer_load_dwordx4 v[144:147], v187, s[48:51], s23 offen offset:3072 sc1
    v_mfma_f32_16x16x32_bf16 v[120:123], v[4:7], a[68:71], v[88:91]
    v_mfma_f32_16x16x32_bf16 v[92:95], v[168:171], a[132:135], v[92:95]
    v_mfma_f32_16x16x32_bf16 v[92:95], v[148:151], a[136:139], v[92:95]
    v_mfma_f32_16x16x32_bf16 v[124:127], v[4:7], a[140:143], v[92:95]
    buffer_load_dwordx4 v[160:163], v188, s[48:51], s23 offen offset:0 sc1
    v_mfma_f32_16x16x32_bf16 v[96:99], v[168:171], a[204:207], v[96:99]
    s_mov_b32 s74, 268435456
    v_mfma_f32_16x16x32_bf16 v[96:99], v[148:151], a[208:211], v[96:99]
    s_add_u32 s27, s27, 1024
    v_mfma_f32_16x16x32_bf16 v[128:131], v[4:7], a[212:215], v[96:99]
    s_add_u32 s25, s25, 1
    v_mfma_f32_16x16x32_bf16 v[100:103], v[168:171], v[240:243], v[100:103]
    buffer_load_dwordx4 v[164:167], v188, s[48:51], s23 offen offset:1024 sc1
    v_mfma_f32_16x16x32_bf16 v[100:103], v[148:151], v[244:247], v[100:103]
    s_add_u32 s23, s23, 18432
    v_mfma_f32_16x16x32_bf16 v[132:135], v[4:7], v[248:251], v[100:103]
L_ffn_dn_mid_42:
    s_waitcnt vmcnt(30)
    v_mfma_f32_16x16x32_bf16 v[88:91], v[16:19], a[0:3], 0
    v_mfma_f32_16x16x32_bf16 v[88:91], v[20:23], a[4:7], v[88:91]
    buffer_load_dwordx4 v[168:171], v184, s[48:51], s23 offen offset:0 sc1
    v_mfma_f32_16x16x32_bf16 v[88:91], v[24:27], a[8:11], v[88:91]
    v_mfma_f32_16x16x32_bf16 v[92:95], v[16:19], a[72:75], 0
    v_mfma_f32_16x16x32_bf16 v[92:95], v[20:23], a[76:79], v[92:95]
    v_mfma_f32_16x16x32_bf16 v[92:95], v[24:27], a[80:83], v[92:95]
    buffer_load_dwordx4 v[148:151], v184, s[48:51], s23 offen offset:1024 sc1
    v_mfma_f32_16x16x32_bf16 v[96:99], v[16:19], a[144:147], 0
    v_cvt_pk_bf16_f32 v152, v120, v121
    v_cvt_pk_bf16_f32 v153, v122, v123
    v_mfma_f32_16x16x32_bf16 v[96:99], v[20:23], a[148:151], v[96:99]
    v_cvt_pk_bf16_f32 v154, v124, v125
    v_cvt_pk_bf16_f32 v155, v126, v127
    v_mfma_f32_16x16x32_bf16 v[96:99], v[24:27], a[152:155], v[96:99]
    s_nop 0
    v_permlane16_swap_b32 v152, v154
    v_mfma_f32_16x16x32_bf16 v[100:103], v[16:19], a[216:219], 0
    buffer_load_dwordx4 v[4:7], v184, s[48:51], s23 offen offset:2048 sc1
    v_mfma_f32_16x16x32_bf16 v[100:103], v[20:23], a[220:223], v[100:103]
    v_permlane16_swap_b32 v153, v155
    v_mfma_f32_16x16x32_bf16 v[100:103], v[24:27], a[224:227], v[100:103]
    buffer_store_dwordx4 v[152:155], v178, s[72:75], s27 offen sc1
    s_waitcnt vmcnt(31)
    v_mfma_f32_16x16x32_bf16 v[88:91], v[28:31], a[12:15], v[88:91]
    ds_write_b128 v216, v[152:155]
    v_mfma_f32_16x16x32_bf16 v[88:91], v[32:35], a[16:19], v[88:91]
    buffer_load_dwordx4 v[16:19], v184, s[48:51], s23 offen offset:3072 sc1
    v_mfma_f32_16x16x32_bf16 v[88:91], v[36:39], a[20:23], v[88:91]
    v_add_u32 v216, v216, v218
    v_mfma_f32_16x16x32_bf16 v[92:95], v[28:31], a[84:87], v[92:95]
    v_mfma_f32_16x16x32_bf16 v[92:95], v[32:35], a[88:91], v[92:95]
    v_mfma_f32_16x16x32_bf16 v[92:95], v[36:39], a[92:95], v[92:95]
    buffer_load_dwordx4 v[20:23], v185, s[48:51], s23 offen offset:0 sc1
    v_mfma_f32_16x16x32_bf16 v[96:99], v[28:31], a[156:159], v[96:99]
    v_mfma_f32_16x16x32_bf16 v[96:99], v[32:35], a[160:163], v[96:99]
    v_mfma_f32_16x16x32_bf16 v[96:99], v[36:39], a[164:167], v[96:99]
    v_mfma_f32_16x16x32_bf16 v[100:103], v[28:31], a[228:231], v[100:103]
    buffer_load_dwordx4 v[24:27], v185, s[48:51], s23 offen offset:1024 sc1
    v_mfma_f32_16x16x32_bf16 v[100:103], v[32:35], a[232:235], v[100:103]
    v_mfma_f32_16x16x32_bf16 v[100:103], v[36:39], a[236:239], v[100:103]
    s_waitcnt vmcnt(31)
    v_mfma_f32_16x16x32_bf16 v[88:91], v[40:43], a[24:27], v[88:91]
    v_mfma_f32_16x16x32_bf16 v[88:91], v[44:47], a[28:31], v[88:91]
    buffer_load_dwordx4 v[28:31], v185, s[48:51], s23 offen offset:2048 sc1
    v_mfma_f32_16x16x32_bf16 v[88:91], v[48:51], a[32:35], v[88:91]
    v_mfma_f32_16x16x32_bf16 v[92:95], v[40:43], a[96:99], v[92:95]
    v_mfma_f32_16x16x32_bf16 v[92:95], v[44:47], a[100:103], v[92:95]
    v_mfma_f32_16x16x32_bf16 v[92:95], v[48:51], a[104:107], v[92:95]
    buffer_load_dwordx4 v[32:35], v185, s[48:51], s23 offen offset:3072 sc1
    v_mfma_f32_16x16x32_bf16 v[96:99], v[40:43], a[168:171], v[96:99]
    v_mfma_f32_16x16x32_bf16 v[96:99], v[44:47], a[172:175], v[96:99]
    v_mfma_f32_16x16x32_bf16 v[96:99], v[48:51], a[176:179], v[96:99]
    v_mfma_f32_16x16x32_bf16 v[100:103], v[40:43], a[240:243], v[100:103]
    buffer_load_dwordx4 v[36:39], v186, s[48:51], s23 offen offset:0 sc1
    v_mfma_f32_16x16x32_bf16 v[100:103], v[44:47], a[244:247], v[100:103]
    v_mfma_f32_16x16x32_bf16 v[100:103], v[48:51], a[248:251], v[100:103]
    s_waitcnt vmcnt(31)
    s_cmp_lg_u32 s25, 6
    s_cbranch_scc1 L_early_43
    s_waitcnt vmcnt(16)
    s_barrier
    s_cmp_lg_u32 s3, 0
    s_cbranch_scc1 L_early_43
    v_lshlrev_b32 v15, 7, v0
    v_mov_b32 v1, s76
    s_mov_b64 exec, 0xff
    buffer_store_dword v1, v15, s[8:11], s29 offen sc1
    s_mov_b64 exec, -1
L_early_43:
    v_mfma_f32_16x16x32_bf16 v[88:91], v[52:55], a[36:39], v[88:91]
    v_mfma_f32_16x16x32_bf16 v[88:91], v[56:59], a[40:43], v[88:91]
    buffer_load_dwordx4 v[40:43], v186, s[48:51], s23 offen offset:1024 sc1
    v_mfma_f32_16x16x32_bf16 v[88:91], v[60:63], a[44:47], v[88:91]
    v_mfma_f32_16x16x32_bf16 v[92:95], v[52:55], a[108:111], v[92:95]
    v_mfma_f32_16x16x32_bf16 v[92:95], v[56:59], a[112:115], v[92:95]
    v_cvt_pk_bf16_f32 v156, v128, v129
    v_cvt_pk_bf16_f32 v157, v130, v131
    v_mfma_f32_16x16x32_bf16 v[92:95], v[60:63], a[116:119], v[92:95]
    buffer_load_dwordx4 v[44:47], v186, s[48:51], s23 offen offset:2048 sc1
    v_mfma_f32_16x16x32_bf16 v[96:99], v[52:55], a[180:183], v[96:99]
    v_cvt_pk_bf16_f32 v158, v132, v133
    v_cvt_pk_bf16_f32 v159, v134, v135
    v_mfma_f32_16x16x32_bf16 v[96:99], v[56:59], a[184:187], v[96:99]
    s_nop 0
    v_permlane16_swap_b32 v156, v158
    v_mfma_f32_16x16x32_bf16 v[96:99], v[60:63], a[188:191], v[96:99]
    v_permlane16_swap_b32 v157, v159
    v_mfma_f32_16x16x32_bf16 v[100:103], v[52:55], a[252:255], v[100:103]
    buffer_load_dwordx4 v[48:51], v186, s[48:51], s23 offen offset:3072 sc1
    v_mfma_f32_16x16x32_bf16 v[100:103], v[56:59], v[220:223], v[100:103]
    buffer_store_dwordx4 v[156:159], v179, s[72:75], s27 offen sc1
    v_mfma_f32_16x16x32_bf16 v[100:103], v[60:63], v[224:227], v[100:103]
    ds_write_b128 v217, v[156:159]
    s_waitcnt vmcnt(32)
    v_mfma_f32_16x16x32_bf16 v[88:91], v[64:67], a[48:51], v[88:91]
    v_add_u32 v217, v217, v219
    v_mfma_f32_16x16x32_bf16 v[88:91], v[68:71], a[52:55], v[88:91]
    buffer_load_dwordx4 v[52:55], v187, s[48:51], s23 offen offset:0 sc1
    v_mfma_f32_16x16x32_bf16 v[88:91], v[72:75], a[56:59], v[88:91]
    v_mfma_f32_16x16x32_bf16 v[92:95], v[64:67], a[120:123], v[92:95]
    v_mfma_f32_16x16x32_bf16 v[92:95], v[68:71], a[124:127], v[92:95]
    v_mfma_f32_16x16x32_bf16 v[92:95], v[72:75], a[128:131], v[92:95]
    buffer_load_dwordx4 v[56:59], v187, s[48:51], s23 offen offset:1024 sc1
    v_mfma_f32_16x16x32_bf16 v[96:99], v[64:67], a[192:195], v[96:99]
    v_mfma_f32_16x16x32_bf16 v[96:99], v[68:71], a[196:199], v[96:99]
    v_mfma_f32_16x16x32_bf16 v[96:99], v[72:75], a[200:203], v[96:99]
    v_mfma_f32_16x16x32_bf16 v[100:103], v[64:67], v[228:231], v[100:103]
    buffer_load_dwordx4 v[60:63], v187, s[48:51], s23 offen offset:2048 sc1
    v_mfma_f32_16x16x32_bf16 v[100:103], v[68:71], v[232:235], v[100:103]
    v_mfma_f32_16x16x32_bf16 v[100:103], v[72:75], v[236:239], v[100:103]
    s_waitcnt vmcnt(32)
    v_mfma_f32_16x16x32_bf16 v[88:91], v[76:79], a[60:63], v[88:91]
    v_mfma_f32_16x16x32_bf16 v[88:91], v[80:83], a[64:67], v[88:91]
    buffer_load_dwordx4 v[64:67], v187, s[48:51], s23 offen offset:3072 sc1
    v_mfma_f32_16x16x32_bf16 v[120:123], v[84:87], a[68:71], v[88:91]
    v_mfma_f32_16x16x32_bf16 v[92:95], v[76:79], a[132:135], v[92:95]
    v_mfma_f32_16x16x32_bf16 v[92:95], v[80:83], a[136:139], v[92:95]
    v_mfma_f32_16x16x32_bf16 v[124:127], v[84:87], a[140:143], v[92:95]
    buffer_load_dwordx4 v[68:71], v188, s[48:51], s23 offen offset:0 sc1
    v_mfma_f32_16x16x32_bf16 v[96:99], v[76:79], a[204:207], v[96:99]
    s_mov_b32 s74, 268435456
    v_mfma_f32_16x16x32_bf16 v[96:99], v[80:83], a[208:211], v[96:99]
    s_add_u32 s27, s27, 1024
    v_mfma_f32_16x16x32_bf16 v[128:131], v[84:87], a[212:215], v[96:99]
    s_add_u32 s25, s25, 1
    v_mfma_f32_16x16x32_bf16 v[100:103], v[76:79], v[240:243], v[100:103]
    buffer_load_dwordx4 v[72:75], v188, s[48:51], s23 offen offset:1024 sc1
    v_mfma_f32_16x16x32_bf16 v[100:103], v[80:83], v[244:247], v[100:103]
    s_add_u32 s23, s23, 18432
    v_mfma_f32_16x16x32_bf16 v[132:135], v[84:87], v[248:251], v[100:103]
    s_cmp_lt_u32 s25, 7
    s_cbranch_scc1 L_ffn_dn_41
    s_waitcnt vmcnt(33)
    v_mfma_f32_16x16x32_bf16 v[88:91], v[104:107], a[0:3], 0
    v_mfma_f32_16x16x32_bf16 v[88:91], v[108:111], a[4:7], v[88:91]
    buffer_load_dwordx4 v[76:79], v184, s[48:51], s23 offen offset:0 sc1
    v_mfma_f32_16x16x32_bf16 v[88:91], v[112:115], a[8:11], v[88:91]
    v_mfma_f32_16x16x32_bf16 v[92:95], v[104:107], a[72:75], 0
    v_mfma_f32_16x16x32_bf16 v[92:95], v[108:111], a[76:79], v[92:95]
    v_mfma_f32_16x16x32_bf16 v[92:95], v[112:115], a[80:83], v[92:95]
    buffer_load_dwordx4 v[80:83], v184, s[48:51], s23 offen offset:1024 sc1
    v_mfma_f32_16x16x32_bf16 v[96:99], v[104:107], a[144:147], 0
    v_cvt_pk_bf16_f32 v152, v120, v121
    v_cvt_pk_bf16_f32 v153, v122, v123
    v_mfma_f32_16x16x32_bf16 v[96:99], v[108:111], a[148:151], v[96:99]
    v_cvt_pk_bf16_f32 v154, v124, v125
    v_cvt_pk_bf16_f32 v155, v126, v127
    v_mfma_f32_16x16x32_bf16 v[96:99], v[112:115], a[152:155], v[96:99]
    s_nop 0
    v_permlane16_swap_b32 v152, v154
    v_mfma_f32_16x16x32_bf16 v[100:103], v[104:107], a[216:219], 0
    buffer_load_dwordx4 v[84:87], v184, s[48:51], s23 offen offset:2048 sc1
    v_mfma_f32_16x16x32_bf16 v[100:103], v[108:111], a[220:223], v[100:103]
    v_permlane16_swap_b32 v153, v155
    v_mfma_f32_16x16x32_bf16 v[100:103], v[112:115], a[224:227], v[100:103]
    buffer_store_dwordx4 v[152:155], v178, s[72:75], s27 offen sc1
    s_waitcnt vmcnt(34)
    v_mfma_f32_16x16x32_bf16 v[88:91], v[116:119], a[12:15], v[88:91]
    ds_write_b128 v216, v[152:155]
    v_mfma_f32_16x16x32_bf16 v[88:91], v[180:183], a[16:19], v[88:91]
    v_add_u32 v216, v216, v218
    v_cvt_pk_bf16_f32 v156, v128, v129
    v_mfma_f32_16x16x32_bf16 v[88:91], v[196:199], a[20:23], v[88:91]
    v_cvt_pk_bf16_f32 v157, v130, v131
    v_cvt_pk_bf16_f32 v158, v132, v133
    s_load_dwordx8 s[56:63], s[38:39], 0 glc
    v_mfma_f32_16x16x32_bf16 v[92:95], v[116:119], a[84:87], v[92:95]
    v_cvt_pk_bf16_f32 v159, v134, v135
    v_mfma_f32_16x16x32_bf16 v[92:95], v[180:183], a[88:91], v[92:95]
    s_nop 0
    v_permlane16_swap_b32 v156, v158
    v_mfma_f32_16x16x32_bf16 v[92:95], v[196:199], a[92:95], v[92:95]
    v_permlane16_swap_b32 v157, v159
    v_mfma_f32_16x16x32_bf16 v[96:99], v[116:119], a[156:159], v[96:99]
    buffer_store_dwordx4 v[156:159], v179, s[72:75], s27 offen sc1
    v_mfma_f32_16x16x32_bf16 v[96:99], v[180:183], a[160:163], v[96:99]
    ds_write_b128 v217, v[156:159]
    v_mfma_f32_16x16x32_bf16 v[96:99], v[196:199], a[164:167], v[96:99]
    v_add_u32 v217, v217, v219
    v_mfma_f32_16x16x32_bf16 v[100:103], v[116:119], a[228:231], v[100:103]
    v_mfma_f32_16x16x32_bf16 v[100:103], v[180:183], a[232:235], v[100:103]
    v_mfma_f32_16x16x32_bf16 v[100:103], v[196:199], a[236:239], v[100:103]
    s_waitcnt vmcnt(32)
    s_mov_b32 s6, 0
L_epoll_44:
    s_waitcnt lgkmcnt(0)
    s_xor_b64 s[56:57], s[56:57], s[76:77]
    s_xor_b64 s[58:59], s[58:59], s[76:77]
    s_xor_b64 s[60:61], s[60:61], s[76:77]
    s_xor_b64 s[62:63], s[62:63], s[76:77]
    s_or_b64 s[56:57], s[56:57], s[58:59]
    s_or_b64 s[60:61], s[60:61], s[62:63]
    s_or_b64 s[56:57], s[56:57], s[60:61]
    s_cbranch_scc0 L_epolled_45
    s_load_dwordx8 s[56:63], s[38:39], 0 glc
    s_add_u32 s6, s6, 1
    s_cmp_lt_u32 s6, 1048576
    s_cbranch_scc1 L_epoll_44
    s_branch L_main_end
L_epolled_45:
    v_mfma_f32_16x16x32_bf16 v[88:91], v[200:203], a[24:27], v[88:91]
    v_mfma_f32_16x16x32_bf16 v[88:91], v[204:207], a[28:31], v[88:91]
    s_add_u32 s7, s40, 1
    s_and_b32 s7, s7, 7
    s_mul_i32 s7, s7, 9216
    s_add_u32 s19, s7, s20
    buffer_load_dwordx4 v[104:107], v172, s[8:11], s19 offen sc1
    v_mfma_f32_16x16x32_bf16 v[88:91], v[208:211], a[32:35], v[88:91]
    v_mfma_f32_16x16x32_bf16 v[92:95], v[200:203], a[96:99], v[92:95]
    v_mfma_f32_16x16x32_bf16 v[92:95], v[204:207], a[100:103], v[92:95]
    v_mfma_f32_16x16x32_bf16 v[92:95], v[208:211], a[104:107], v[92:95]
    buffer_load_dwordx4 v[108:111], v173, s[8:11], s19 offen sc1
    v_mfma_f32_16x16x32_bf16 v[96:99], v[200:203], a[168:171], v[96:99]
    v_mfma_f32_16x16x32_bf16 v[96:99], v[204:207], a[172:175], v[96:99]
    v_mfma_f32_16x16x32_bf16 v[96:99], v[208:211], a[176:179], v[96:99]
    v_mfma_f32_16x16x32_bf16 v[100:103], v[200:203], a[240:243], v[100:103]
    s_add_u32 s7, s40, 2
    s_and_b32 s7, s7, 7
    s_mul_i32 s7, s7, 9216
    s_add_u32 s19, s7, s20
    buffer_load_dwordx4 v[112:115], v172, s[8:11], s19 offen sc1
    v_mfma_f32_16x16x32_bf16 v[100:103], v[204:207], a[244:247], v[100:103]
    v_mfma_f32_16x16x32_bf16 v[100:103], v[208:211], a[248:251], v[100:103]
    s_waitcnt vmcnt(31)
    v_mfma_f32_16x16x32_bf16 v[88:91], v[212:215], a[36:39], v[88:91]
    v_mfma_f32_16x16x32_bf16 v[88:91], v[136:139], a[40:43], v[88:91]
    buffer_load_dwordx4 v[116:119], v173, s[8:11], s19 offen sc1
    v_mfma_f32_16x16x32_bf16 v[88:91], v[140:143], a[44:47], v[88:91]
    v_mfma_f32_16x16x32_bf16 v[92:95], v[212:215], a[108:111], v[92:95]
    v_mfma_f32_16x16x32_bf16 v[92:95], v[136:139], a[112:115], v[92:95]
    v_mfma_f32_16x16x32_bf16 v[92:95], v[140:143], a[116:119], v[92:95]
    s_add_u32 s7, s40, 3
    s_and_b32 s7, s7, 7
    s_mul_i32 s7, s7, 9216
    s_add_u32 s19, s7, s20
    buffer_load_dwordx4 v[180:183], v172, s[8:11], s19 offen sc1
    v_mfma_f32_16x16x32_bf16 v[96:99], v[212:215], a[180:183], v[96:99]
    v_mfma_f32_16x16x32_bf16 v[96:99], v[136:139], a[184:187], v[96:99]
    v_mfma_f32_16x16x32_bf16 v[96:99], v[140:143], a[188:191], v[96:99]
    v_mfma_f32_16x16x32_bf16 v[100:103], v[212:215], a[252:255], v[100:103]
    buffer_load_dwordx4 v[196:199], v173, s[8:11], s19 offen sc1
    v_mfma_f32_16x16x32_bf16 v[100:103], v[136:139], v[220:223], v[100:103]
    v_mfma_f32_16x16x32_bf16 v[100:103], v[140:143], v[224:227], v[100:103]
    s_waitcnt vmcnt(31)
    v_mfma_f32_16x16x32_bf16 v[88:91], v[144:147], a[48:51], v[88:91]
    v_mfma_f32_16x16x32_bf16 v[88:91], v[160:163], a[52:55], v[88:91]
    s_add_u32 s7, s40, 4
    s_and_b32 s7, s7, 7
    s_mul_i32 s7, s7, 9216
    s_add_u32 s19, s7, s20
    buffer_load_dwordx4 v[200:203], v172, s[8:11], s19 offen sc1
    v_mfma_f32_16x16x32_bf16 v[88:91], v[164:167], a[56:59], v[88:91]
    v_mfma_f32_16x16x32_bf16 v[92:95], v[144:147], a[120:123], v[92:95]
    v_mfma_f32_16x16x32_bf16 v[92:95], v[160:163], a[124:127], v[92:95]
    v_mfma_f32_16x16x32_bf16 v[92:95], v[164:167], a[128:131], v[92:95]
    buffer_load_dwordx4 v[204:207], v173, s[8:11], s19 offen sc1
    v_mfma_f32_16x16x32_bf16 v[96:99], v[144:147], a[192:195], v[96:99]
    v_mfma_f32_16x16x32_bf16 v[96:99], v[160:163], a[196:199], v[96:99]
    v_mfma_f32_16x16x32_bf16 v[96:99], v[164:167], a[200:203], v[96:99]
    v_mfma_f32_16x16x32_bf16 v[100:103], v[144:147], v[228:231], v[100:103]
    s_add_u32 s7, s40, 5
    s_and_b32 s7, s7, 7
    s_mul_i32 s7, s7, 9216
    s_add_u32 s19, s7, s20
    buffer_load_dwordx4 v[208:211], v172, s[8:11], s19 offen sc1
    v_mfma_f32_16x16x32_bf16 v[100:103], v[160:163], v[232:235], v[100:103]
    v_mfma_f32_16x16x32_bf16 v[100:103], v[164:167], v[236:239], v[100:103]
    s_waitcnt vmcnt(31)
    v_mfma_f32_16x16x32_bf16 v[88:91], v[168:171], a[60:63], v[88:91]
    v_mfma_f32_16x16x32_bf16 v[88:91], v[148:151], a[64:67], v[88:91]
    buffer_load_dwordx4 v[212:215], v173, s[8:11], s19 offen sc1
    v_mfma_f32_16x16x32_bf16 v[120:123], v[4:7], a[68:71], v[88:91]
    v_mfma_f32_16x16x32_bf16 v[92:95], v[168:171], a[132:135], v[92:95]
    v_mfma_f32_16x16x32_bf16 v[92:95], v[148:151], a[136:139], v[92:95]
    v_mfma_f32_16x16x32_bf16 v[124:127], v[4:7], a[140:143], v[92:95]
    s_add_u32 s7, s40, 6
    s_and_b32 s7, s7, 7
    s_mul_i32 s7, s7, 9216
    s_add_u32 s19, s7, s20
    buffer_load_dwordx4 v[136:139], v172, s[8:11], s19 offen sc1
    v_mfma_f32_16x16x32_bf16 v[96:99], v[168:171], a[204:207], v[96:99]
    s_mov_b32 s74, 268435456
    v_mfma_f32_16x16x32_bf16 v[96:99], v[148:151], a[208:211], v[96:99]
    s_add_u32 s27, s27, 1024
    v_mfma_f32_16x16x32_bf16 v[128:131], v[4:7], a[212:215], v[96:99]
    s_add_u32 s25, s25, 1
    v_mfma_f32_16x16x32_bf16 v[100:103], v[168:171], v[240:243], v[100:103]
    buffer_load_dwordx4 v[140:143], v173, s[8:11], s19 offen sc1
    v_mfma_f32_16x16x32_bf16 v[100:103], v[148:151], v[244:247], v[100:103]
    s_add_u32 s23, s23, 18432
    v_mfma_f32_16x16x32_bf16 v[132:135], v[4:7], v[248:251], v[100:103]
    s_waitcnt vmcnt(30)
    v_mfma_f32_16x16x32_bf16 v[88:91], v[16:19], a[0:3], 0
    v_mfma_f32_16x16x32_bf16 v[88:91], v[20:23], a[4:7], v[88:91]
    s_add_u32 s7, s40, 7
    s_and_b32 s7, s7, 7
    s_mul_i32 s7, s7, 9216
    s_add_u32 s19, s7, s20
    buffer_load_dwordx4 v[144:147], v172, s[8:11], s19 offen sc1
    v_mfma_f32_16x16x32_bf16 v[88:91], v[24:27], a[8:11], v[88:91]
    v_mfma_f32_16x16x32_bf16 v[92:95], v[16:19], a[72:75], 0
    v_mfma_f32_16x16x32_bf16 v[92:95], v[20:23], a[76:79], v[92:95]
    v_mfma_f32_16x16x32_bf16 v[92:95], v[24:27], a[80:83], v[92:95]
    buffer_load_dwordx4 v[160:163], v173, s[8:11], s19 offen sc1
    v_mfma_f32_16x16x32_bf16 v[96:99], v[16:19], a[144:147], 0
    v_cvt_pk_bf16_f32 v152, v120, v121
    v_cvt_pk_bf16_f32 v153, v122, v123
    v_mfma_f32_16x16x32_bf16 v[96:99], v[20:23], a[148:151], v[96:99]
    v_cvt_pk_bf16_f32 v154, v124, v125
    v_cvt_pk_bf16_f32 v155, v126, v127
    v_mfma_f32_16x16x32_bf16 v[96:99], v[24:27], a[152:155], v[96:99]
    s_nop 0
    v_permlane16_swap_b32 v152, v154
    v_mfma_f32_16x16x32_bf16 v[100:103], v[16:19], a[216:219], 0
    v_permlane16_swap_b32 v153, v155
    v_mfma_f32_16x16x32_bf16 v[100:103], v[20:23], a[220:223], v[100:103]
    buffer_store_dwordx4 v[152:155], v178, s[72:75], s27 offen sc1
    v_mfma_f32_16x16x32_bf16 v[100:103], v[24:27], a[224:227], v[100:103]
    ds_write_b128 v216, v[152:155]
    s_waitcnt vmcnt(30)
    v_mfma_f32_16x16x32_bf16 v[88:91], v[28:31], a[12:15], v[88:91]
    v_add_u32 v216, v216, v218
    v_cvt_pk_bf16_f32 v156, v128, v129
    v_mfma_f32_16x16x32_bf16 v[88:91], v[32:35], a[16:19], v[88:91]
    v_cvt_pk_bf16_f32 v157, v130, v131
    v_cvt_pk_bf16_f32 v158, v132, v133
    v_mfma_f32_16x16x32_bf16 v[88:91], v[36:39], a[20:23], v[88:91]
    v_cvt_pk_bf16_f32 v159, v134, v135
    v_mfma_f32_16x16x32_bf16 v[92:95], v[28:31], a[84:87], v[92:95]
    s_nop 0
    v_permlane16_swap_b32 v156, v158
    v_mfma_f32_16x16x32_bf16 v[92:95], v[32:35], a[88:91], v[92:95]
    v_permlane16_swap_b32 v157, v159
    v_mfma_f32_16x16x32_bf16 v[92:95], v[36:39], a[92:95], v[92:95]
    buffer_store_dwordx4 v[156:159], v179, s[72:75], s27 offen sc1
    v_mfma_f32_16x16x32_bf16 v[96:99], v[28:31], a[156:159], v[96:99]
    ds_write_b128 v217, v[156:159]
    v_mfma_f32_16x16x32_bf16 v[96:99], v[32:35], a[160:163], v[96:99]
    v_add_u32 v217, v217, v219
    v_mfma_f32_16x16x32_bf16 v[96:99], v[36:39], a[164:167], v[96:99]
    v_mfma_f32_16x16x32_bf16 v[100:103], v[28:31], a[228:231], v[100:103]
    v_mfma_f32_16x16x32_bf16 v[100:103], v[32:35], a[232:235], v[100:103]
    v_mfma_f32_16x16x32_bf16 v[100:103], v[36:39], a[236:239], v[100:103]
    s_waitcnt vmcnt(28)
    s_waitcnt vmcnt(16)
    s_barrier
    s_cmp_lg_u32 s3, 0
    s_cbranch_scc1 L_early_46
    s_mov_b64 exec, 0xff
    buffer_store_dword v1, v15, s[8:11], s29 offen offset:32 sc1
    s_mov_b64 exec, -1
L_early_46:
    v_mfma_f32_16x16x32_bf16 v[88:91], v[40:43], a[24:27], v[88:91]
    v_mfma_f32_16x16x32_bf16 v[88:91], v[44:47], a[28:31], v[88:91]
    v_mfma_f32_16x16x32_bf16 v[88:91], v[48:51], a[32:35], v[88:91]
    v_mfma_f32_16x16x32_bf16 v[92:95], v[40:43], a[96:99], v[92:95]
    v_mfma_f32_16x16x32_bf16 v[92:95], v[44:47], a[100:103], v[92:95]
    v_mfma_f32_16x16x32_bf16 v[92:95], v[48:51], a[104:107], v[92:95]
    v_mfma_f32_16x16x32_bf16 v[96:99], v[40:43], a[168:171], v[96:99]
    v_mfma_f32_16x16x32_bf16 v[96:99], v[44:47], a[172:175], v[96:99]
    v_mfma_f32_16x16x32_bf16 v[96:99], v[48:51], a[176:179], v[96:99]
    v_mfma_f32_16x16x32_bf16 v[100:103], v[40:43], a[240:243], v[100:103]
    v_mfma_f32_16x16x32_bf16 v[100:103], v[44:47], a[244:247], v[100:103]
    v_mfma_f32_16x16x32_bf16 v[100:103], v[48:51], a[248:251], v[100:103]
    s_waitcnt vmcnt(24)
    v_mfma_f32_16x16x32_bf16 v[88:91], v[52:55], a[36:39], v[88:91]
    v_mfma_f32_16x16x32_bf16 v[88:91], v[56:59], a[40:43], v[88:91]
    v_mfma_f32_16x16x32_bf16 v[88:91], v[60:63], a[44:47], v[88:91]
    v_mfma_f32_16x16x32_bf16 v[92:95], v[52:55], a[108:111], v[92:95]
    v_mfma_f32_16x16x32_bf16 v[92:95], v[56:59], a[112:115], v[92:95]
    v_mfma_f32_16x16x32_bf16 v[92:95], v[60:63], a[116:119], v[92:95]
    v_mfma_f32_16x16x32_bf16 v[96:99], v[52:55], a[180:183], v[96:99]
    v_mfma_f32_16x16x32_bf16 v[96:99], v[56:59], a[184:187], v[96:99]
    v_mfma_f32_16x16x32_bf16 v[96:99], v[60:63], a[188:191], v[96:99]
    v_mfma_f32_16x16x32_bf16 v[100:103], v[52:55], a[252:255], v[100:103]
    v_mfma_f32_16x16x32_bf16 v[100:103], v[56:59], v[220:223], v[100:103]
    v_mfma_f32_16x16x32_bf16 v[100:103], v[60:63], v[224:227], v[100:103]
    s_waitcnt vmcnt(21)
    v_mfma_f32_16x16x32_bf16 v[88:91], v[64:67], a[48:51], v[88:91]
    v_mfma_f32_16x16x32_bf16 v[88:91], v[68:71], a[52:55], v[88:91]
    v_mfma_f32_16x16x32_bf16 v[88:91], v[72:75], a[56:59], v[88:91]
    v_mfma_f32_16x16x32_bf16 v[92:95], v[64:67], a[120:123], v[92:95]
    v_mfma_f32_16x16x32_bf16 v[92:95], v[68:71], a[124:127], v[92:95]
    v_mfma_f32_16x16x32_bf16 v[92:95], v[72:75], a[128:131], v[92:95]
    v_mfma_f32_16x16x32_bf16 v[96:99], v[64:67], a[192:195], v[96:99]
    v_mfma_f32_16x16x32_bf16 v[96:99], v[68:71], a[196:199], v[96:99]
    v_mfma_f32_16x16x32_bf16 v[96:99], v[72:75], a[200:203], v[96:99]
    v_mfma_f32_16x16x32_bf16 v[100:103], v[64:67], v[228:231], v[100:103]
    v_mfma_f32_16x16x32_bf16 v[100:103], v[68:71], v[232:235], v[100:103]
    v_mfma_f32_16x16x32_bf16 v[100:103], v[72:75], v[236:239], v[100:103]
    s_waitcnt vmcnt(18)
    v_mfma_f32_16x16x32_bf16 v[88:91], v[76:79], a[60:63], v[88:91]
    v_mfma_f32_16x16x32_bf16 v[88:91], v[80:83], a[64:67], v[88:91]
    v_mfma_f32_16x16x32_bf16 v[120:123], v[84:87], a[68:71], v[88:91]
    v_mfma_f32_16x16x32_bf16 v[92:95], v[76:79], a[132:135], v[92:95]
    v_mfma_f32_16x16x32_bf16 v[92:95], v[80:83], a[136:139], v[92:95]
    v_mfma_f32_16x16x32_bf16 v[124:127], v[84:87], a[140:143], v[92:95]
    v_mfma_f32_16x16x32_bf16 v[96:99], v[76:79], a[204:207], v[96:99]
    s_mov_b32 s74, 268435456
    v_mfma_f32_16x16x32_bf16 v[96:99], v[80:83], a[208:211], v[96:99]
    s_add_u32 s27, s27, 1024
    v_mfma_f32_16x16x32_bf16 v[128:131], v[84:87], a[212:215], v[96:99]
    s_add_u32 s25, s25, 1
    v_mfma_f32_16x16x32_bf16 v[100:103], v[76:79], v[240:243], v[100:103]
    v_mfma_f32_16x16x32_bf16 v[100:103], v[80:83], v[244:247], v[100:103]
    s_add_u32 s23, s23, 18432
    v_mfma_f32_16x16x32_bf16 v[132:135], v[84:87], v[248:251], v[100:103]
    s_nop 7
    v_cvt_pk_bf16_f32 v152, v120, v121
    v_cvt_pk_bf16_f32 v153, v122, v123
    v_cvt_pk_bf16_f32 v154, v124, v125
    v_cvt_pk_bf16_f32 v155, v126, v127
    v_cvt_pk_bf16_f32 v156, v128, v129
    v_cvt_pk_bf16_f32 v157, v130, v131
    v_cvt_pk_bf16_f32 v158, v132, v133
    v_cvt_pk_bf16_f32 v159, v134, v135
    s_nop 0
    v_permlane16_swap_b32 v152, v154
    v_permlane16_swap_b32 v153, v155
    buffer_store_dwordx4 v[152:155], v178, s[72:75], s27 offen sc1
    s_nop 0
    v_permlane16_swap_b32 v156, v158
    v_permlane16_swap_b32 v157, v159
    buffer_store_dwordx4 v[156:159], v179, s[72:75], s27 offen sc1
    ds_write_b128 v216, v[152:155]
    ds_write_b128 v217, v[156:159]
    s_waitcnt lgkmcnt(0)
    v_lshlrev_b32 v15, 7, v0
    s_lshl_b32 s6, s40, 2
    s_add_u32 s6, s6, s44
    s_add_u32 s6, s6, 65536
    v_mov_b32 v1, s76
    s_mov_b64 vcc, 0xff
    s_waitcnt vmcnt(0)
    s_barrier
    s_cmp_lg_u32 s3, 0
    s_cbranch_scc1 L_pub_47
    s_mov_b64 exec, vcc
    buffer_store_dword v1, v15, s[8:11], s6 offen sc1
L_pub_47:
    s_mov_b64 exec, -1
    s_add_u32 s19, s18, s43
    s_add_u32 s22, s19, 45875200
    s_lshl_b32 s23, s21, 5
    s_add_u32 s23, s23, s43
    s_add_u32 s23, s23, 48431104
    s_cmp_ge_u32 s3, 2
    s_cbranch_scc1 L_late_48
    s_load_dwordx8 s[56:63], s[38:39], 32 glc
L_late_48:
    v_and_b32 v12, 7, v0
    v_lshlrev_b32 v12, 2, v12
    buffer_load_dword v10, v12, s[8:11], s23 offen sc1
    buffer_load_dwordx4 v[92:95], v172, s[8:11], s22 offen sc1
    buffer_load_dwordx4 v[96:99], v173, s[8:11], s22 offen sc1
    buffer_load_dwordx4 v[100:103], v174, s[8:11], s22 offen sc1
    v_min_u32 v13, 9216, v173
    ds_read_b128 v[148:151], v172 offset:4096
    ds_read_b128 v[152:155], v13 offset:4096
    ds_read_b128 v[156:159], v174 offset:4096
    s_lshl_b32 s28, s40, 2
    s_add_u32 s28, s28, s3
    s_mul_i32 s28, s28, 73728
    v_and_b32 v229, 8, v0
    v_lshl_add_u32 v229, v229, 27, v253
    s_mul_i32 s7, s42, 1073741824
    v_add_u32 v3, s7, v253
    v_or_b32 v229, s7, v229
    v_lshlrev_b32 v16, 16, v104
    v_and_b32 v17, s16, v104
    v_lshlrev_b32 v18, 16, v105
    v_and_b32 v19, s16, v105
    v_lshlrev_b32 v20, 16, v106
    v_and_b32 v21, s16, v106
    v_lshlrev_b32 v22, 16, v107
    v_and_b32 v23, s16, v107
    v_lshlrev_b32 v24, 16, v108
    v_and_b32 v25, s16, v108
    v_lshlrev_b32 v26, 16, v109
    v_and_b32 v27, s16, v109
    v_lshlrev_b32 v28, 16, v110
    v_and_b32 v29, s16, v110
    v_lshlrev_b32 v30, 16, v111
    v_and_b32 v31, s16, v111
    s_cmp_ge_u32 s3, 2
    s_cbranch_scc1 L_late_49
    s_mov_b32 s6, 0
L_epoll_51:
    s_waitcnt lgkmcnt(0)
    s_xor_b64 s[56:57], s[56:57], s[76:77]
    s_xor_b64 s[58:59], s[58:59], s[76:77]
    s_xor_b64 s[60:61], s[60:61], s[76:77]
    s_xor_b64 s[62:63], s[62:63], s[76:77]
    s_or_b64 s[56:57], s[56:57], s[58:59]
    s_or_b64 s[60:61], s[60:61], s[62:63]
    s_or_b64 s[56:57], s[56:57], s[60:61]
    s_cbranch_scc0 L_epolled_52
    s_load_dwordx8 s[56:63], s[38:39], 32 glc
    s_add_u32 s6, s6, 1
    s_cmp_lt_u32 s6, 1048576
    s_cbranch_scc1 L_epoll_51
    s_branch L_main_end
L_epolled_52:
    s_add_u32 s7, s40, 1
    s_and_b32 s7, s7, 7
    s_mul_i32 s7, s7, 9216
    s_add_u32 s19, s7, s20
    buffer_load_dwordx4 v[60:63], v174, s[8:11], s19 offen sc1
    s_add_u32 s7, s40, 2
    s_and_b32 s7, s7, 7
    s_mul_i32 s7, s7, 9216
    s_add_u32 s19, s7, s20
    buffer_load_dwordx4 v[64:67], v174, s[8:11], s19 offen sc1
    s_add_u32 s7, s40, 3
    s_and_b32 s7, s7, 7
    s_mul_i32 s7, s7, 9216
    s_add_u32 s19, s7, s20
    buffer_load_dwordx4 v[68:71], v174, s[8:11], s19 offen sc1
    s_add_u32 s7, s40, 4
    s_and_b32 s7, s7, 7
    s_mul_i32 s7, s7, 9216
    s_add_u32 s19, s7, s20
    buffer_load_dwordx4 v[72:75], v174, s[8:11], s19 offen sc1
    s_add_u32 s7, s40, 5
    s_and_b32 s7, s7, 7
    s_mul_i32 s7, s7, 9216
    s_add_u32 s19, s7, s20
    buffer_load_dwordx4 v[76:79], v174, s[8:11], s19 offen sc1
    s_add_u32 s7, s40, 6
    s_and_b32 s7, s7, 7
    s_mul_i32 s7, s7, 9216
    s_add_u32 s19, s7, s20
    buffer_load_dwordx4 v[80:83], v174, s[8:11], s19 offen sc1
    s_add_u32 s7, s40, 7
    s_and_b32 s7, s7, 7
    s_mul_i32 s7, s7, 9216
    s_add_u32 s19, s7, s20
    buffer_load_dwordx4 v[84:87], v174, s[8:11], s19 offen sc1
L_late_49:
    s_cmp_lg_u32 s42, 0
    s_cbranch_scc1 L_nopf_53
    buffer_load_dwordx4 a[0:3], v3, s[8:11], s28 offen offset:0 sc1
    buffer_load_dwordx4 a[4:7], v3, s[8:11], s28 offen offset:1024 sc1
    buffer_load_dwordx4 a[8:11], v3, s[8:11], s28 offen offset:2048 sc1
    buffer_load_dwordx4 a[12:15], v229, s[8:11], s28 offen offset:3072 sc1
    s_add_u32 s28, s28, 4096
    buffer_load_dwordx4 a[16:19], v3, s[8:11], s28 offen offset:0 sc1
    buffer_load_dwordx4 a[20:23], v3, s[8:11], s28 offen offset:1024 sc1
    buffer_load_dwordx4 a[24:27], v3, s[8:11], s28 offen offset:2048 sc1
    buffer_load_dwordx4 a[28:31], v229, s[8:11], s28 offen offset:3072 sc1
L_nopf_53:
    v_lshlrev_b32 v40, 16, v112
    v_and_b32 v41, s16, v112
    v_lshlrev_b32 v42, 16, v113
    v_and_b32 v43, s16, v113
    v_lshlrev_b32 v44, 16, v114
    v_and_b32 v45, s16, v114
    v_lshlrev_b32 v46, 16, v115
    v_and_b32 v47, s16, v115
    v_pk_add_f32 v[16:17], v[16:17], v[40:41]
    v_pk_add_f32 v[18:19], v[18:19], v[42:43]
    v_pk_add_f32 v[20:21], v[20:21], v[44:45]
    v_pk_add_f32 v[22:23], v[22:23], v[46:47]
    v_lshlrev_b32 v40, 16, v116
    v_and_b32 v41, s16, v116
    v_lshlrev_b32 v42, 16, v117
    v_and_b32 v43, s16, v117
    v_lshlrev_b32 v44, 16, v118
    v_and_b32 v45, s16, v118
    v_lshlrev_b32 v46, 16, v119
    v_and_b32 v47, s16, v119
    v_pk_add_f32 v[24:25], v[24:25], v[40:41]
    v_pk_add_f32 v[26:27], v[26:27], v[42:43]
    v_pk_add_f32 v[28:29], v[28:29], v[44:45]
    v_pk_add_f32 v[30:31], v[30:31], v[46:47]
    s_cmp_lg_u32 s42, 0
    s_cbranch_scc1 L_nopf_54
    s_add_u32 s28, s28, 4096
    buffer_load_dwordx4 a[32:35], v3, s[8:11], s28 offen offset:0 sc1
    buffer_load_dwordx4 a[36:39], v3, s[8:11], s28 offen offset:1024 sc1
    buffer_load_dwordx4 a[40:43], v3, s[8:11], s28 offen offset:2048 sc1
    buffer_load_dwordx4 a[44:47], v229, s[8:11], s28 offen offset:3072 sc1
    s_add_u32 s28, s28, 4096
    buffer_load_dwordx4 a[48:51], v3, s[8:11], s28 offen offset:0 sc1
    buffer_load_dwordx4 a[52:55], v3, s[8:11], s28 offen offset:1024 sc1
    buffer_load_dwordx4 a[56:59], v3, s[8:11], s28 offen offset:2048 sc1
    buffer_load_dwordx4 a[60:63], v229, s[8:11], s28 offen offset:3072 sc1
L_nopf_54:
    v_lshlrev_b32 v40, 16, v180
    v_and_b32 v41, s16, v180
    v_lshlrev_b32 v42, 16, v181
    v_and_b32 v43, s16, v181
    v_lshlrev_b32 v44, 16, v182
    v_and_b32 v45, s16, v182
    v_lshlrev_b32 v46, 16, v183
    v_and_b32 v47, s16, v183
    v_pk_add_f32 v[16:17], v[16:17], v[40:41]
    v_pk_add_f32 v[18:19], v[18:19], v[42:43]
    v_pk_add_f32 v[20:21], v[20:21], v[44:45]
    v_pk_add_f32 v[22:23], v[22:23], v[46:47]
    v_lshlrev_b32 v40, 16, v196
    v_and_b32 v41, s16, v196
    v_lshlrev_b32 v42, 16, v197
    v_and_b32 v43, s16, v197
    v_lshlrev_b32 v44, 16, v198
    v_and_b32 v45, s16, v198
    v_lshlrev_b32 v46, 16, v199
    v_and_b32 v47, s16, v199
    v_pk_add_f32 v[24:25], v[24:25], v[40:41]
    v_pk_add_f32 v[26:27], v[26:27], v[42:43]
    v_pk_add_f32 v[28:29], v[28:29], v[44:45]
    v_pk_add_f32 v[30:31], v[30:31], v[46:47]
    v_lshlrev_b32 v40, 16, v200
    v_and_b32 v41, s16, v200
    v_lshlrev_b32 v42, 16, v201
    v_and_b32 v43, s16, v201
    v_lshlrev_b32 v44, 16, v202
    v_and_b32 v45, s16, v202
    v_lshlrev_b32 v46, 16, v203
    v_and_b32 v47, s16, v203
    v_pk_add_f32 v[16:17], v[16:17], v[40:41]
    v_pk_add_f32 v[18:19], v[18:19], v[42:43]
    v_pk_add_f32 v[20:21], v[20:21], v[44:45]
    v_pk_add_f32 v[22:23], v[22:23], v[46:47]
    v_lshlrev_b32 v40, 16, v204
    v_and_b32 v41, s16, v204
    v_lshlrev_b32 v42, 16, v205
    v_and_b32 v43, s16, v205
    v_lshlrev_b32 v44, 16, v206
    v_and_b32 v45, s16, v206
    v_lshlrev_b32 v46, 16, v207
    v_and_b32 v47, s16, v207
    v_pk_add_f32 v[24:25], v[24:25], v[40:41]
    v_pk_add_f32 v[26:27], v[26:27], v[42:43]
    v_pk_add_f32 v[28:29], v[28:29], v[44:45]
    v_pk_add_f32 v[30:31], v[30:31], v[46:47]
    v_lshlrev_b32 v40, 16, v208
    v_and_b32 v41, s16, v208
    v_lshlrev_b32 v42, 16, v209
    v_and_b32 v43, s16, v209
    v_lshlrev_b32 v44, 16, v210
    v_and_b32 v45, s16, v210
    v_lshlrev_b32 v46, 16, v211
    v_and_b32 v47, s16, v211
    v_pk_add_f32 v[16:17], v[16:17], v[40:41]
    v_pk_add_f32 v[18:19], v[18:19], v[42:43]
    v_pk_add_f32 v[20:21], v[20:21], v[44:45]
    v_pk_add_f32 v[22:23], v[22:23], v[46:47]
    v_lshlrev_b32 v40, 16, v212
    v_and_b32 v41, s16, v212
    v_lshlrev_b32 v42, 16, v213
    v_and_b32 v43, s16, v213
    v_lshlrev_b32 v44, 16, v214
    v_and_b32 v45, s16, v214
    v_lshlrev_b32 v46, 16, v215
    v_and_b32 v47, s16, v215
    v_pk_add_f32 v[24:25], v[24:25], v[40:41]
    v_pk_add_f32 v[26:27], v[26:27], v[42:43]
    v_pk_add_f32 v[28:29], v[28:29], v[44:45]
    v_pk_add_f32 v[30:31], v[30:31], v[46:47]
    v_lshlrev_b32 v40, 16, v136
    v_and_b32 v41, s16, v136
    v_lshlrev_b32 v42, 16, v137
    v_and_b32 v43, s16, v137
    v_lshlrev_b32 v44, 16, v138
    v_and_b32 v45, s16, v138
    v_lshlrev_b32 v46, 16, v139
    v_and_b32 v47, s16, v139
    v_pk_add_f32 v[16:17], v[16:17], v[40:41]
    v_pk_add_f32 v[18:19], v[18:19], v[42:43]
    v_pk_add_f32 v[20:21], v[20:21], v[44:45]
    v_pk_add_f32 v[22:23], v[22:23], v[46:47]
    v_lshlrev_b32 v40, 16, v140
    v_and_b32 v41, s16, v140
    v_lshlrev_b32 v42, 16, v141
    v_and_b32 v43, s16, v141
    v_lshlrev_b32 v44, 16, v142
    v_and_b32 v45, s16, v142
    v_lshlrev_b32 v46, 16, v143
    v_and_b32 v47, s16, v143
    v_pk_add_f32 v[24:25], v[24:25], v[40:41]
    v_pk_add_f32 v[26:27], v[26:27], v[42:43]
    v_pk_add_f32 v[28:29], v[28:29], v[44:45]
    v_pk_add_f32 v[30:31], v[30:31], v[46:47]
    v_lshlrev_b32 v40, 16, v144
    v_and_b32 v41, s16, v144
    v_lshlrev_b32 v42, 16, v145
    v_and_b32 v43, s16, v145
    v_lshlrev_b32 v44, 16, v146
    v_and_b32 v45, s16, v146
    v_lshlrev_b32 v46, 16, v147
    v_and_b32 v47, s16, v147
    v_pk_add_f32 v[16:17], v[16:17], v[40:41]
    v_pk_add_f32 v[18:19], v[18:19], v[42:43]
    v_pk_add_f32 v[20:21], v[20:21], v[44:45]
    v_pk_add_f32 v[22:23], v[22:23], v[46:47]
    v_lshlrev_b32 v40, 16, v160
    v_and_b32 v41, s16, v160
    v_lshlrev_b32 v42, 16, v161
    v_and_b32 v43, s16, v161
    v_lshlrev_b32 v44, 16, v162
    v_and_b32 v45, s16, v162
    v_lshlrev_b32 v46, 16, v163
    v_and_b32 v47, s16, v163
    v_pk_add_f32 v[24:25], v[24:25], v[40:41]
    v_pk_add_f32 v[26:27], v[26:27], v[42:43]
    v_pk_add_f32 v[28:29], v[28:29], v[44:45]
    v_pk_add_f32 v[30:31], v[30:31], v[46:47]
    s_cmp_lg_u32 s3, 3
    s_cbranch_scc1 L_pollout_57
    s_lshl_b32 s7, s40, 7
    s_add_u32 s7, s7, s44
    s_add_u32 s7, s7, 65536
    s_add_u32 s52, s4, s7
    s_addc_u32 s53, s5, 0
    s_mov_b32 s6, 0
L_poll_55:
    s_load_dwordx8 s[56:63], s[52:53], 0 glc
    s_add_u32 s6, s6, 1
    s_waitcnt lgkmcnt(0)
    s_xor_b64 s[56:57], s[56:57], s[76:77]
    s_xor_b64 s[58:59], s[58:59], s[76:77]
    s_xor_b64 s[60:61], s[60:61], s[76:77]
    s_xor_b64 s[62:63], s[62:63], s[76:77]
    s_or_b64 s[56:57], s[56:57], s[58:59]
    s_or_b64 s[60:61], s[60:61], s[62:63]
    s_or_b64 s[56:57], s[56:57], s[60:61]
    s_cbranch_scc0 L_polled_56
    s_cmp_lt_u32 s6, 1048576
    s_cbranch_scc1 L_poll_55
    s_branch L_main_end
L_polled_56:
L_pollout_57:
    s_barrier
    s_cmp_lt_u32 s3, 2
    s_cbranch_scc1 L_late_50
    s_add_u32 s7, s40, 1
    s_and_b32 s7, s7, 7
    s_mul_i32 s7, s7, 9216
    s_add_u32 s19, s7, s20
    buffer_load_dwordx4 v[60:63], v174, s[8:11], s19 offen sc1
    s_add_u32 s7, s40, 2
    s_and_b32 s7, s7, 7
    s_mul_i32 s7, s7, 9216
    s_add_u32 s19, s7, s20
    buffer_load_dwordx4 v[64:67], v174, s[8:11], s19 offen sc1
    s_add_u32 s7, s40, 3
    s_and_b32 s7, s7, 7
    s_mul_i32 s7, s7, 9216
    s_add_u32 s19, s7, s20
    buffer_load_dwordx4 v[68:71], v174, s[8:11], s19 offen sc1
    s_add_u32 s7, s40, 4
    s_and_b32 s7, s7, 7
    s_mul_i32 s7, s7, 9216
    s_add_u32 s19, s7, s20
    buffer_load_dwordx4 v[72:75], v174, s[8:11], s19 offen sc1
    s_add_u32 s7, s40, 5
    s_and_b32 s7, s7, 7
    s_mul_i32 s7, s7, 9216
    s_add_u32 s19, s7, s20
    buffer_load_dwordx4 v[76:79], v174, s[8:11], s19 offen sc1
    s_add_u32 s7, s40, 6
    s_and_b32 s7, s7, 7
    s_mul_i32 s7, s7, 9216
    s_add_u32 s19, s7, s20
    buffer_load_dwordx4 v[80:83], v174, s[8:11], s19 offen sc1
    s_add_u32 s7, s40, 7
    s_and_b32 s7, s7, 7
    s_mul_i32 s7, s7, 9216
    s_add_u32 s19, s7, s20
    buffer_load_dwordx4 v[84:87], v174, s[8:11], s19 offen sc1
L_late_50:
    s_cmp_eq_u32 s3, 0
    s_cselect_b32 s7, 1.0, 0
    s_cselect_b32 s6, -1, 0
    s_waitcnt vmcnt(7) lgkmcnt(0)
    v_and_b32 v152, s6, v152
    v_and_b32 v153, s6, v153
    v_and_b32 v154, s6, v154
    v_and_b32 v155, s6, v155
    v_mul_f32 v11, s7, v10
    v_lshlrev_b32 v40, 16, v92
    v_and_b32 v41, s16, v92
    v_lshlrev_b32 v42, 16, v93
    v_and_b32 v43, s16, v93
    v_lshlrev_b32 v44, 16, v94
    v_and_b32 v45, s16, v94
    v_lshlrev_b32 v46, 16, v95
    v_and_b32 v47, s16, v95
    v_pk_add_f32 v[16:17], v[16:17], v[40:41]
    v_pk_add_f32 v[18:19], v[18:19], v[42:43]
    v_pk_add_f32 v[20:21], v[20:21], v[44:45]
    v_pk_add_f32 v[22:23], v[22:23], v[46:47]
    v_lshlrev_b32 v40, 16, v96
    v_and_b32 v41, s16, v96
    v_lshlrev_b32 v42, 16, v97
    v_and_b32 v43, s16, v97
    v_lshlrev_b32 v44, 16, v98
    v_and_b32 v45, s16, v98
    v_lshlrev_b32 v46, 16, v99
    v_and_b32 v47, s16, v99
    v_pk_add_f32 v[24:25], v[24:25], v[40:41]
    v_pk_add_f32 v[26:27], v[26:27], v[42:43]
    v_pk_add_f32 v[28:29], v[28:29], v[44:45]
    v_pk_add_f32 v[30:31], v[30:31], v[46:47]
    v_lshlrev_b32 v32, 16, v100
    v_and_b32 v33, s16, v100
    v_lshlrev_b32 v34, 16, v101
    v_and_b32 v35, s16, v101
    v_lshlrev_b32 v36, 16, v102
    v_and_b32 v37, s16, v102
    v_lshlrev_b32 v38, 16, v103
    v_and_b32 v39, s16, v103
    v_lshlrev_b32 v40, 16, v148
    v_and_b32 v41, s16, v148
    v_lshlrev_b32 v42, 16, v149
    v_and_b32 v43, s16, v149
    v_lshlrev_b32 v44, 16, v150
    v_and_b32 v45, s16, v150
    v_lshlrev_b32 v46, 16, v151
    v_and_b32 v47, s16, v151
    v_pk_add_f32 v[16:17], v[16:17], v[40:41]
    v_pk_add_f32 v[18:19], v[18:19], v[42:43]
    v_pk_add_f32 v[20:21], v[20:21], v[44:45]
    v_pk_add_f32 v[22:23], v[22:23], v[46:47]
    v_lshlrev_b32 v40, 16, v152
    v_and_b32 v41, s16, v152
    v_lshlrev_b32 v42, 16, v153
    v_and_b32 v43, s16, v153
    v_lshlrev_b32 v44, 16, v154
    v_and_b32 v45, s16, v154
    v_lshlrev_b32 v46, 16, v155
    v_and_b32 v47, s16, v155
    v_pk_add_f32 v[24:25], v[24:25], v[40:41]
    v_pk_add_f32 v[26:27], v[26:27], v[42:43]
    v_pk_add_f32 v[28:29], v[28:29], v[44:45]
    v_pk_add_f32 v[30:31], v[30:31], v[46:47]
    v_lshlrev_b32 v40, 16, v156
    v_and_b32 v41, s16, v156
    v_lshlrev_b32 v42, 16, v157
    v_and_b32 v43, s16, v157
    v_lshlrev_b32 v44, 16, v158
    v_and_b32 v45, s16, v158
    v_lshlrev_b32 v46, 16, v159
    v_and_b32 v47, s16, v159
    v_pk_add_f32 v[32:33], v[32:33], v[40:41]
    v_pk_add_f32 v[34:35], v[34:35], v[42:43]
    v_pk_add_f32 v[36:37], v[36:37], v[44:45]
    v_pk_add_f32 v[38:39], v[38:39], v[46:47]
    v_pk_add_f32 v[16:17], v[16:17], v[10:11] op_sel_hi:[1,0]
    v_pk_add_f32 v[18:19], v[18:19], v[10:11] op_sel_hi:[1,0]
    v_pk_add_f32 v[20:21], v[20:21], v[10:11] op_sel_hi:[1,0]
    v_pk_add_f32 v[22:23], v[22:23], v[10:11] op_sel_hi:[1,0]
    v_pk_add_f32 v[24:25], v[24:25], v[10:11] op_sel:[0,1] op_sel_hi:[1,1]
    v_pk_add_f32 v[26:27], v[26:27], v[10:11] op_sel:[0,1] op_sel_hi:[1,1]
    v_pk_add_f32 v[28:29], v[28:29], v[10:11] op_sel:[0,1] op_sel_hi:[1,1]
    v_pk_add_f32 v[30:31], v[30:31], v[10:11] op_sel:[0,1] op_sel_hi:[1,1]
    v_pk_add_f32 v[32:33], v[32:33], v[10:11] op_sel_hi:[1,0]
    v_pk_add_f32 v[34:35], v[34:35], v[10:11] op_sel_hi:[1,0]
    v_pk_add_f32 v[36:37], v[36:37], v[10:11] op_sel_hi:[1,0]
    v_pk_add_f32 v[38:39], v[38:39], v[10:11] op_sel_hi:[1,0]
    s_waitcnt vmcnt(6)
    s_add_u32 s28, s28, 4096
    buffer_load_dwordx4 a[64:67], v3, s[8:11], s28 offen offset:0 sc1
    v_lshlrev_b32 v40, 16, v60
    v_and_b32 v41, s16, v60
    v_lshlrev_b32 v42, 16, v61
    v_and_b32 v43, s16, v61
    v_lshlrev_b32 v44, 16, v62
    v_and_b32 v45, s16, v62
    v_lshlrev_b32 v46, 16, v63
    v_and_b32 v47, s16, v63
    v_pk_add_f32 v[32:33], v[32:33], v[40:41]
    v_pk_add_f32 v[34:35], v[34:35], v[42:43]
    v_pk_add_f32 v[36:37], v[36:37], v[44:45]
    v_pk_add_f32 v[38:39], v[38:39], v[46:47]
    s_waitcnt vmcnt(6)
    buffer_load_dwordx4 a[68:71], v3, s[8:11], s28 offen offset:1024 sc1
    v_lshlrev_b32 v40, 16, v64
    v_and_b32 v41, s16, v64
    v_lshlrev_b32 v42, 16, v65
    v_and_b32 v43, s16, v65
    v_lshlrev_b32 v44, 16, v66
    v_and_b32 v45, s16, v66
    v_lshlrev_b32 v46, 16, v67
    v_and_b32 v47, s16, v67
    v_pk_add_f32 v[32:33], v[32:33], v[40:41]
    v_pk_add_f32 v[34:35], v[34:35], v[42:43]
    v_pk_add_f32 v[36:37], v[36:37], v[44:45]
    v_pk_add_f32 v[38:39], v[38:39], v[46:47]
    s_waitcnt vmcnt(6)
    buffer_load_dwordx4 a[72:75], v3, s[8:11], s28 offen offset:2048 sc1
    v_lshlrev_b32 v40, 16, v68
    v_and_b32 v41, s16, v68
    v_lshlrev_b32 v42, 16, v69
    v_and_b32 v43, s16, v69
    v_lshlrev_b32 v44, 16, v70
    v_and_b32 v45, s16, v70
    v_lshlrev_b32 v46, 16, v71
    v_and_b32 v47, s16, v71
    v_pk_add_f32 v[32:33], v[32:33], v[40:41]
    v_pk_add_f32 v[34:35], v[34:35], v[42:43]
    v_pk_add_f32 v[36:37], v[36:37], v[44:45]
    v_pk_add_f32 v[38:39], v[38:39], v[46:47]
    s_waitcnt vmcnt(6)
    buffer_load_dwordx4 a[76:79], v229, s[8:11], s28 offen offset:3072 sc1
    v_lshlrev_b32 v40, 16, v72
    v_and_b32 v41, s16, v72
    v_lshlrev_b32 v42, 16, v73
    v_and_b32 v43, s16, v73
    v_lshlrev_b32 v44, 16, v74
    v_and_b32 v45, s16, v74
    v_lshlrev_b32 v46, 16, v75
    v_and_b32 v47, s16, v75
    v_pk_add_f32 v[32:33], v[32:33], v[40:41]
    v_pk_add_f32 v[34:35], v[34:35], v[42:43]
    v_pk_add_f32 v[36:37], v[36:37], v[44:45]
    v_pk_add_f32 v[38:39], v[38:39], v[46:47]
    s_waitcnt vmcnt(6)
    s_add_u32 s28, s28, 4096
    buffer_load_dwordx4 a[80:83], v3, s[8:11], s28 offen offset:0 sc1
    v_lshlrev_b32 v40, 16, v76
    v_and_b32 v41, s16, v76
    v_lshlrev_b32 v42, 16, v77
    v_and_b32 v43, s16, v77
    v_lshlrev_b32 v44, 16, v78
    v_and_b32 v45, s16, v78
    v_lshlrev_b32 v46, 16, v79
    v_and_b32 v47, s16, v79
    v_pk_add_f32 v[32:33], v[32:33], v[40:41]
    v_pk_add_f32 v[34:35], v[34:35], v[42:43]
    v_pk_add_f32 v[36:37], v[36:37], v[44:45]
    v_pk_add_f32 v[38:39], v[38:39], v[46:47]
    s_waitcnt vmcnt(6)
    buffer_load_dwordx4 a[84:87], v3, s[8:11], s28 offen offset:1024 sc1
    v_lshlrev_b32 v40, 16, v80
    v_and_b32 v41, s16, v80
    v_lshlrev_b32 v42, 16, v81
    v_and_b32 v43, s16, v81
    v_lshlrev_b32 v44, 16, v82
    v_and_b32 v45, s16, v82
    v_lshlrev_b32 v46, 16, v83
    v_and_b32 v47, s16, v83
    v_pk_add_f32 v[32:33], v[32:33], v[40:41]
    v_pk_add_f32 v[34:35], v[34:35], v[42:43]
    v_pk_add_f32 v[36:37], v[36:37], v[44:45]
    v_pk_add_f32 v[38:39], v[38:39], v[46:47]
    s_waitcnt vmcnt(6)
    buffer_load_dwordx4 a[88:91], v3, s[8:11], s28 offen offset:2048 sc1
    v_lshlrev_b32 v40, 16, v84
    v_and_b32 v41, s16, v84
    v_lshlrev_b32 v42, 16, v85
    v_and_b32 v43, s16, v85
    v_lshlrev_b32 v44, 16, v86
    v_and_b32 v45, s16, v86
    v_lshlrev_b32 v46, 16, v87
    v_and_b32 v47, s16, v87
    v_pk_add_f32 v[32:33], v[32:33], v[40:41]
    v_pk_add_f32 v[34:35], v[34:35], v[42:43]
    v_pk_add_f32 v[36:37], v[36:37], v[44:45]
    v_pk_add_f32 v[38:39], v[38:39], v[46:47]
    buffer_load_dwordx4 a[92:95], v229, s[8:11], s28 offen offset:3072 sc1
    v_cvt_pk_bf16_f32 v120, v16, v17
    v_cvt_pk_bf16_f32 v121, v18, v19
    v_cvt_pk_bf16_f32 v122, v20, v21
    v_cvt_pk_bf16_f32 v123, v22, v23
    v_cvt_pk_bf16_f32 v124, v24, v25
    v_cvt_pk_bf16_f32 v125, v26, v27
    v_cvt_pk_bf16_f32 v126, v28, v29
    v_cvt_pk_bf16_f32 v127, v30, v31
    v_cvt_pk_bf16_f32 v128, v32, v33
    v_cvt_pk_bf16_f32 v129, v34, v35
    v_cvt_pk_bf16_f32 v130, v36, v37
    v_cvt_pk_bf16_f32 v131, v38, v39
    s_cmp_lg_u32 s42, 0
    s_cbranch_scc1 L_main_last
    s_add_u32 s19, s18, 53215232
    s_add_u32 s20, s18, 48496640
    s_lshl_b32 s22, s21, 7
    s_add_u32 s22, s22, 57933824
    buffer_store_dwordx4 v[120:123], v172, s[8:11], s19 offen sc1
    buffer_store_dwordx4 v[124:127], v173, s[8:11], s19 offen sc1
    buffer_store_dwordx4 v[128:131], v174, s[8:11], s19 offen sc1
    s_mov_b32 s17, 0x3f803f80
    v_mov_b32 v8, 0
    v_mov_b32 v9, 0
    v_mov_b32 v10, 0
    v_mov_b32 v11, 0
    v_dot2c_f32_bf16 v8, s17, v120
    v_dot2c_f32_bf16 v9, v120, v120
    v_dot2c_f32_bf16 v10, s17, v121
    v_dot2c_f32_bf16 v11, v121, v121
    v_dot2c_f32_bf16 v8, s17, v122
    v_dot2c_f32_bf16 v9, v122, v122
    v_dot2c_f32_bf16 v10, s17, v123
    v_dot2c_f32_bf16 v11, v123, v123
    v_dot2c_f32_bf16 v8, s17, v124
    v_dot2c_f32_bf16 v9, v124, v124
    v_dot2c_f32_bf16 v10, s17, v125
    v_dot2c_f32_bf16 v11, v125, v125
    v_dot2c_f32_bf16 v8, s17, v126
    v_dot2c_f32_bf16 v9, v126, v126
    v_dot2c_f32_bf16 v10, s17, v127
    v_dot2c_f32_bf16 v11, v127, v127
    v_dot2c_f32_bf16 v8, s17, v128
    v_dot2c_f32_bf16 v9, v128, v128
    v_dot2c_f32_bf16 v10, s17, v129
    v_dot2c_f32_bf16 v11, v129, v129
    v_dot2c_f32_bf16 v8, s17, v130
    v_dot2c_f32_bf16 v9, v130, v130
    v_dot2c_f32_bf16 v10, s17, v131
    v_dot2c_f32_bf16 v11, v131, v131
    v_and_b32 v12, 7, v0
    v_lshlrev_b32 v12, 3, v12
    s_lshl_b32 s7, s3, 6
    v_add_u32 v13, s7, v12
    v_pk_add_f32 v[8:9], v[8:9], v[10:11]
    s_nop 1
    v_add_f32_dpp v8, v8, v8 row_ror:8 row_mask:0xf bank_mask:0xf
    v_add_f32_dpp v9, v9, v9 row_ror:8 row_mask:0xf bank_mask:0xf
    v_mov_b32 v10, v8
    v_mov_b32 v11, v9
    s_nop 1
    v_permlane32_swap_b32 v10, v8
    v_permlane32_swap_b32 v11, v9
    v_add_f32 v8, v8, v10
    v_add_f32 v9, v9, v11
    v_mov_b32 v10, v8
    v_mov_b32 v11, v9
    s_nop 1
    v_permlane16_swap_b32 v10, v8
    v_permlane16_swap_b32 v11, v9
    v_add_f32 v8, v8, v10
    v_add_f32 v9, v9, v11
    ds_write_b64 v13, v[8:9]
    s_waitcnt lgkmcnt(0)
    s_barrier
    ds_read_b64 v[40:41], v12 offset:0
    ds_read_b64 v[42:43], v12 offset:64
    ds_read_b64 v[44:45], v12 offset:128
    ds_read_b64 v[46:47], v12 offset:192
    s_waitcnt lgkmcnt(0)
    v_pk_add_f32 v[40:41], v[40:41], v[42:43]
    v_pk_add_f32 v[44:45], v[44:45], v[46:47]
    v_pk_add_f32 v[8:9], v[40:41], v[44:45]
    v_mul_f32 v8, 0x3ae38e39, v8
    v_mul_f32 v9, 0x3ae38e39, v9
    v_fma_f32 v9, -v8, v8, v9
    v_max_f32 v9, 0, v9
    v_add_f32 v9, 0x3727c5ac, v9
    v_rsq_f32 v10, v9
    s_nop 0
    v_mul_f32 v12, v8, v10
    v_mov_b32 v11, v10
    v_sub_f32 v12, 0, v12
    v_mov_b32 v13, v12
    s_cmp_eq_u32 s3, 0
    s_cselect_b32 s7, 32, 0
    v_lshlrev_b32 v14, 2, v0
    v_cmp_gt_u32 vcc, s7, v0
    v_mov_b32 v9, 1073741824
    s_nop 0
    v_cndmask_b32 v14, v9, v14, vcc
    buffer_store_dword v8, v14, s[8:11], s22 offen sc1
    v_lshlrev_b32 v40, 16, v120
    v_and_b32 v41, s16, v120
    v_lshlrev_b32 v42, 16, v121
    v_and_b32 v43, s16, v121
    v_lshlrev_b32 v44, 16, v122
    v_and_b32 v45, s16, v122
    v_lshlrev_b32 v46, 16, v123
    v_and_b32 v47, s16, v123
    v_pk_fma_f32 v[40:41], v[40:41], v[10:11], v[12:13]
    v_pk_fma_f32 v[42:43], v[42:43], v[10:11], v[12:13]
    v_pk_fma_f32 v[44:45], v[44:45], v[10:11], v[12:13]
    v_pk_fma_f32 v[46:47], v[46:47], v[10:11], v[12:13]
    v_cvt_pk_bf16_f32 v48, v40, v41
    v_cvt_pk_bf16_f32 v49, v42, v43
    v_cvt_pk_bf16_f32 v50, v44, v45
    v_cvt_pk_bf16_f32 v51, v46, v47
    v_lshlrev_b32 v40, 16, v124
    v_and_b32 v41, s16, v124
    v_lshlrev_b32 v42, 16, v125
    v_and_b32 v43, s16, v125
    v_lshlrev_b32 v44, 16, v126
    v_and_b32 v45, s16, v126
    v_lshlrev_b32 v46, 16, v127
    v_and_b32 v47, s16, v127
    v_pk_fma_f32 v[40:41], v[40:41], v[10:11], v[12:13]
    v_pk_fma_f32 v[42:43], v[42:43], v[10:11], v[12:13]
    v_pk_fma_f32 v[44:45], v[44:45], v[10:11], v[12:13]
    v_pk_fma_f32 v[46:47], v[46:47], v[10:11], v[12:13]
    v_cvt_pk_bf16_f32 v52, v40, v41
    v_cvt_pk_bf16_f32 v53, v42, v43
    v_cvt_pk_bf16_f32 v54, v44, v45
    v_cvt_pk_bf16_f32 v55, v46, v47
    v_lshlrev_b32 v40, 16, v128
    v_and_b32 v41, s16, v128
    v_lshlrev_b32 v42, 16, v129
    v_and_b32 v43, s16, v129
    v_lshlrev_b32 v44, 16, v130
    v_and_b32 v45, s16, v130
    v_lshlrev_b32 v46, 16, v131
    v_and_b32 v47, s16, v131
    v_pk_fma_f32 v[40:41], v[40:41], v[10:11], v[12:13]
    v_pk_fma_f32 v[42:43], v[42:43], v[10:11], v[12:13]
    v_pk_fma_f32 v[44:45], v[44:45], v[10:11], v[12:13]
    v_pk_fma_f32 v[46:47], v[46:47], v[10:11], v[12:13]
    v_cvt_pk_bf16_f32 v56, v40, v41
    v_cvt_pk_bf16_f32 v57, v42, v43
    v_cvt_pk_bf16_f32 v58, v44, v45
    v_cvt_pk_bf16_f32 v59, v46, v47
    buffer_store_dwordx4 v[48:51], v172, s[8:11], s20 offen sc1
    buffer_store_dwordx4 v[52:55], v173, s[8:11], s20 offen sc1
    buffer_store_dwordx4 v[56:59], v174, s[8:11], s20 offen sc1
    v_lshlrev_b32 v15, 7, v0
    s_lshl_b32 s6, s40, 2
    s_add_u32 s6, s6, s44
    s_add_u32 s6, s6, 98304
    v_mov_b32 v1, s76
    s_mov_b64 vcc, 0xff
    v_lshrrev_b32 v14, 3, v0
    v_lshl_add_u32 v15, v14, 3, v15
    s_cmp_ge_u32 s40, 6
    s_cselect_b32 s7, s41, 31
    s_cmp_lt_u32 s7, 31
    s_cmov_b64 vcc, 0xffff
    s_waitcnt vmcnt(0)
    s_barrier
    s_cmp_lg_u32 s3, 0
    s_cbranch_scc1 L_pub_58
    s_mov_b64 exec, vcc
    buffer_store_dword v1, v15, s[8:11], s6 offen sc1
L_pub_58:
    s_mov_b64 exec, -1
    s_add_u32 s28, s28, 4096
    buffer_load_dwordx4 a[96:99], v3, s[8:11], s28 offen offset:0 sc1
    buffer_load_dwordx4 a[100:103], v3, s[8:11], s28 offen offset:1024 sc1
    buffer_load_dwordx4 a[104:107], v3, s[8:11], s28 offen offset:2048 sc1
    buffer_load_dwordx4 a[108:111], v229, s[8:11], s28 offen offset:3072 sc1
    s_add_u32 s28, s28, 4096
    buffer_load_dwordx4 a[112:115], v3, s[8:11], s28 offen offset:0 sc1
    buffer_load_dwordx4 a[116:119], v3, s[8:11], s28 offen offset:1024 sc1
    buffer_load_dwordx4 a[120:123], v3, s[8:11], s28 offen offset:2048 sc1
    buffer_load_dwordx4 a[124:127], v229, s[8:11], s28 offen offset:3072 sc1
    s_add_u32 s28, s28, 4096
    buffer_load_dwordx4 a[128:131], v3, s[8:11], s28 offen offset:0 sc1
    buffer_load_dwordx4 a[132:135], v3, s[8:11], s28 offen offset:1024 sc1
    buffer_load_dwordx4 a[136:139], v3, s[8:11], s28 offen offset:2048 sc1
    buffer_load_dwordx4 a[140:143], v229, s[8:11], s28 offen offset:3072 sc1
    s_add_u32 s28, s28, 4096
    s_mov_b32 s42, 1
    s_mov_b32 s43, 9699328
    s_add_u32 s44, s44, 131072
    s_branch L_main_layer
L_main_last:
    buffer_store_dwordx4 v[120:123], v175, s[12:15], s18 offen sc0 sc1
    buffer_store_dwordx4 v[124:127], v176, s[12:15], s18 offen sc0 sc1
    buffer_store_dwordx4 v[128:131], v177, s[12:15], s18 offen sc0 sc1
    s_or_b32 s7, s40, s41
    s_or_b32 s7, s7, s3
    s_cbranch_scc1 L_done_59
    v_mov_b32 v1, s76
    s_mov_b32 s7, 19660800
    s_mov_b64 exec, 1
    buffer_store_dword v1, off, s[8:11], s7 sc1
    s_mov_b64 exec, -1
L_done_59:
L_main_end:
    s_endpgm
L_main_code_end:
.section .rodata,"a"
.p2align 6
.amdhsa_kernel interleave_layers__sliding_local_dilated__glu_gated_geglu__prompt_kernel
.amdhsa_next_free_vgpr 512
.amdhsa_next_free_sgpr 102
.amdhsa_accum_offset 256
.amdhsa_group_segment_fixed_size 0
.amdhsa_kernarg_size 80
.amdhsa_user_sgpr_count 2
.amdhsa_user_sgpr_kernarg_segment_ptr 1
.amdhsa_system_sgpr_workgroup_id_x 1
.amdhsa_float_denorm_mode_32 3
.amdhsa_float_denorm_mode_16_64 3
.end_amdhsa_kernel
```

```asm
; @launch grid=(256,1,1) block=(256,1,1) lds=163840
.amdgcn_target "amdgcn-amd-amdhsa--gfx950"
.text
.globl interleave_layers__sliding_local_dilated__glu_gated_geglu__prompt_kernel
.p2align 8
.type interleave_layers__sliding_local_dilated__glu_gated_geglu__prompt_kernel,@function
interleave_layers__sliding_local_dilated__glu_gated_geglu__prompt_kernel:
    s_cmp_ge_u32 s2, 256
    s_cbranch_scc1 L_main_end
    s_load_dwordx2 s[4:5], s[0:1], 72
    s_load_dwordx4 s[16:19], s[0:1], 0
    s_load_dwordx2 s[22:23], s[0:1], 16
    s_load_dwordx8 s[24:31], s[0:1], 32
    s_getpc_b64 s[96:97]
L_main_pc:
    s_sub_u32 s96, s96, L_main_pc-interleave_layers__sliding_local_dilated__glu_gated_geglu__prompt_kernel
    s_subb_u32 s97, s97, 0
    s_and_b32 s97, s97, 0xffff
    s_mov_b32 s98, L_main_code_end-interleave_layers__sliding_local_dilated__glu_gated_geglu__prompt_kernel
    s_mov_b32 s99, 0x20000
    s_lshr_b32 s7, s2, 3
    s_lshl_b32 s7, s7, 11
    v_lshl_add_u32 v253, v0, 3, s7
    buffer_load_dwordx2 v[2:3], v253, s[96:99], 0 offen
    v_lshrrev_b32 v1, 6, v0
    v_and_b32 v0, 63, v0
    v_readfirstlane_b32 s3, v1
    s_waitcnt lgkmcnt(0)
    s_mov_b32 s8, s4
    s_and_b32 s9, s5, 0xffff
    s_mov_b32 s10, 268435456
    s_mov_b32 s11, 0x20000
    s_mov_b32 s7, 19660800
    s_load_dword s76, s[4:5], s7
    s_mov_b64 s[20:21], s[18:19]
    s_mov_b64 s[18:19], s[16:17]
    s_mov_b32 s48, s4
    s_and_b32 s49, s5, 0xffff
    s_mov_b32 s50, 268435456
    s_mov_b32 s51, 0x20000
    s_and_b32 s40, s2, 3
    s_lshl_b32 s40, s40, 1
    s_bfe_u32 s7, s2, 65539
    s_add_u32 s40, s40, s7
    s_bfe_u32 s41, s2, 65538
    s_lshl_b32 s41, s41, 4
    s_lshr_b32 s7, s2, 4
    s_add_u32 s41, s41, s7
    s_mov_b32 s42, 0
    s_mov_b32 s43, 0
    s_lshl_b32 s44, s41, 10
    s_add_u32 s44, s44, 19169280
    v_lshlrev_b32 v253, 4, v0
    s_mov_b32 s12, s18
    s_and_b32 s13, s19, 0xffff
    s_mov_b32 s14, 2359296
    s_mov_b32 s15, 0x20000
    s_mov_b32 s64, s20
    s_and_b32 s65, s21, 0xffff
    s_mov_b32 s66, 1990656
    s_mov_b32 s67, 0x20000
    s_mov_b32 s68, s22
    s_and_b32 s69, s23, 0xffff
    s_mov_b32 s70, 663552
    s_mov_b32 s71, 0x20000
    s_mov_b32 s16, 0xffff0000
    s_lshl_b32 s7, s3, 10
    v_add_u32 v172, s7, v253
    v_add_u32 v174, 5120, v172
    v_and_b32 v178, 7, v0
    v_mul_u32_u24 v178, 1152, v178
    v_lshrrev_b32 v179, 3, v0
    v_lshl_add_u32 v178, v179, 4, v178
    s_lshl_b32 s7, s3, 7
    v_add_u32 v175, s7, v178
    v_add_u32 v177, 640, v175
    s_cmp_eq_u32 s3, 0
    s_mov_b32 s17, 1073741824
    s_cmov_b32 s17, 4096
    v_add_u32 v173, s17, v172
    s_mov_b32 s17, 1073741824
    s_cmov_b32 s17, 512
    v_add_u32 v176, s17, v175
    s_lshl_b32 s21, s41, 3
    s_add_u32 s21, s21, s40
    s_mul_i32 s18, s21, 9216
    buffer_load_dwordx4 v[16:19], v175, s[12:15], s18 offen nt
    buffer_load_dwordx4 v[20:23], v176, s[12:15], s18 offen nt
    buffer_load_dwordx4 v[24:27], v177, s[12:15], s18 offen nt
    s_mov_b32 s12, s30
    s_and_b32 s13, s31, 0xffff
    s_mov_b32 s14, 2359296
    s_mov_b32 s15, 0x20000
    s_lshl_b32 s79, s3, 14
    s_add_u32 s79, s79, 98304
    s_and_b32 s32, s41, 15
    s_lshl_b32 s32, s32, 1
    s_lshr_b32 s7, s41, 4
    s_add_u32 s32, s32, s7
    s_lshl_b32 s36, s32, 3
    s_add_u32 s36, s36, s40
    s_sub_u32 s36, s36, 144
    s_cmp_ge_u32 s32, 18
    s_cbranch_scc1 L_prep_o_1
    s_mul_i32 s35, s32, 110592
    s_mul_i32 s7, s40, 144
    s_and_b32 s46, s7, 127
    s_sub_u32 s7, s7, s46
    s_add_u32 s35, s35, s7
    s_mul_i32 s7, s3, 13824
    s_add_u32 s35, s35, s7
    v_lshrrev_b32 v8, 4, v0
    v_mul_u32_u24 v8, 3456, v8
    v_and_b32 v9, 15, v0
    v_lshl_add_u32 v8, v9, 4, v8
    s_lshl_b32 s34, s3, 10
    s_add_u32 m0, s34, 8192
    s_add_u32 s7, s35, 0
    buffer_load_dwordx4 v8, s[64:67], s7 offen nt lds
    s_add_u32 m0, s34, 12288
    s_add_u32 s7, s35, 55296
    buffer_load_dwordx4 v8, s[64:67], s7 offen nt lds
    s_add_u32 m0, s34, 16384
    s_add_u32 s7, s35, 1152
    buffer_load_dwordx4 v8, s[64:67], s7 offen nt lds
    s_add_u32 m0, s34, 20480
    s_add_u32 s7, s35, 56448
    buffer_load_dwordx4 v8, s[64:67], s7 offen nt lds
    s_add_u32 m0, s34, 24576
    s_add_u32 s7, s35, 2304
    buffer_load_dwordx4 v8, s[64:67], s7 offen nt lds
    s_add_u32 m0, s34, 28672
    s_add_u32 s7, s35, 57600
    buffer_load_dwordx4 v8, s[64:67], s7 offen nt lds
    s_branch L_prep_go_3
L_prep_o_1:
    s_cmp_ge_u32 s36, 54
    s_cbranch_scc1 L_prep_m_2
    s_mul_i32 s33, s36, 349526
    s_lshr_b32 s33, s33, 20
    s_mul_i32 s34, s33, 3
    s_sub_u32 s34, s36, s34
    s_lshl_b32 s7, s33, 2
    s_add_u32 s7, s7, s3
    v_mov_b32 v8, s7
    v_lshrrev_b32 v9, 3, v0
    v_mul_u32_u24 v11, 7282, v8
    v_lshrrev_b32 v11, 16, v11
    v_mul_u32_u24 v12, 9, v11
    v_sub_u32 v12, v8, v12
    v_mul_u32_u24 v11, 72, v11
    v_cmp_eq_u32 vcc, 8, v12
    v_lshrrev_b32 v10, 1, v12
    v_mad_u32_u24 v10, v10, 18, v11
    v_and_b32 v12, 1, v12
    v_lshl_add_u32 v10, v12, 3, v10
    v_add_u32 v10, v10, v9
    v_lshrrev_b32 v12, 1, v9
    v_mad_u32_u24 v11, v12, 18, v11
    v_and_b32 v12, 1, v9
    v_add3_u32 v11, v11, v12, 16
    v_cndmask_b32 v10, v10, v11, vcc
    v_mul_u32_u24 v10, 1152, v10
    v_and_b32 v9, 7, v0
    v_lshl_add_u32 v10, v9, 4, v10
    s_mul_i32 s35, s34, 384
    s_lshl_b32 s6, s3, 10
    s_add_u32 m0, s6, 8192
    s_add_u32 s7, s35, 0
    buffer_load_dwordx4 v10, s[68:71], s7 offen nt lds
    s_add_u32 m0, s6, 12288
    s_add_u32 s7, s35, 128
    buffer_load_dwordx4 v10, s[68:71], s7 offen nt lds
    s_add_u32 m0, s6, 16384
    s_add_u32 s7, s35, 256
    buffer_load_dwordx4 v10, s[68:71], s7 offen nt lds
    s_branch L_prep_go_3
L_prep_m_2:
    s_sub_u32 s37, s36, 54
    s_lshl_b32 s7, s3, 6
    s_add_u32 s37, s37, s7
    s_cmp_ge_u32 s37, 36
    s_cbranch_scc1 L_prep_go_3
    s_lshl_b32 s7, s37, 1
    v_bfe_u32 v8, v0, 3, 1
    v_add_u32 v8, s7, v8
    v_and_b32 v9, 7, v0
    v_mul_u32_u24 v11, 7282, v8
    v_lshrrev_b32 v11, 16, v11
    v_mul_u32_u24 v12, 9, v11
    v_sub_u32 v12, v8, v12
    v_mul_u32_u24 v11, 72, v11
    v_cmp_eq_u32 vcc, 8, v12
    v_lshrrev_b32 v10, 1, v12
    v_mad_u32_u24 v10, v10, 18, v11
    v_and_b32 v12, 1, v12
    v_lshl_add_u32 v10, v12, 3, v10
    v_add_u32 v10, v10, v9
    v_lshrrev_b32 v12, 1, v9
    v_mad_u32_u24 v11, v12, 18, v11
    v_and_b32 v12, 1, v9
    v_add3_u32 v11, v11, v12, 16
    v_cndmask_b32 v10, v10, v11, vcc
    v_mul_u32_u24 v10, 1152, v10
    v_lshrrev_b32 v9, 4, v0
    v_lshl_add_u32 v10, v9, 4, v10
    buffer_load_dwordx4 v[64:67], v10, s[68:71], 0 offen offset:0
    buffer_load_dwordx4 v[68:71], v10, s[68:71], 0 offen offset:64
    buffer_load_dwordx4 v[72:75], v10, s[68:71], 0 offen offset:128
    buffer_load_dwordx4 v[76:79], v10, s[68:71], 0 offen offset:192
    buffer_load_dwordx4 v[80:83], v10, s[68:71], 0 offen offset:256
    buffer_load_dwordx4 v[84:87], v10, s[68:71], 0 offen offset:320
    buffer_load_dwordx4 v[88:91], v10, s[68:71], 0 offen offset:384
    buffer_load_dwordx4 v[92:95], v10, s[68:71], 0 offen offset:448
    buffer_load_dwordx4 v[96:99], v10, s[68:71], 0 offen offset:512
    buffer_load_dwordx4 v[100:103], v10, s[68:71], 0 offen offset:576
    buffer_load_dwordx4 v[104:107], v10, s[68:71], 0 offen offset:640
    buffer_load_dwordx4 v[108:111], v10, s[68:71], 0 offen offset:704
    buffer_load_dwordx4 v[112:115], v10, s[68:71], 0 offen offset:768
    buffer_load_dwordx4 v[116:119], v10, s[68:71], 0 offen offset:832
    buffer_load_dwordx4 v[120:123], v10, s[68:71], 0 offen offset:896
    buffer_load_dwordx4 v[124:127], v10, s[68:71], 0 offen offset:960
    buffer_load_dwordx4 v[128:131], v10, s[68:71], 0 offen offset:1024
    buffer_load_dwordx4 v[132:135], v10, s[68:71], 0 offen offset:1088
L_prep_go_3:
    s_lshl_b32 s7, s32, 2
    s_add_u32 s7, s7, s3
    s_cmp_ge_u32 s7, 72
    s_cbranch_scc1 L_blocks_7
    s_cmp_ge_u32 s7, 54
    s_cselect_b32 s93, 1, 0
    s_cselect_b32 s6, 54, 0
    s_sub_u32 s7, s7, s6
    s_mul_i32 s17, s7, 3
    s_mov_b32 s45, 1
    s_branch L_blocks_8
L_blocks_7:
    s_sub_u32 s7, s7, 72
    s_cmp_ge_u32 s7, 22
    s_cselect_b32 s93, 2, 1
    s_cselect_b32 s6, 22, 0
    s_cselect_b32 s17, 0, 54
    s_sub_u32 s7, s7, s6
    s_mul_i32 s7, s7, 5
    s_add_u32 s17, s17, s7
    s_mov_b32 s45, 3
L_blocks_8:
    s_cmp_eq_u32 s93, 1
    s_cselect_b32 s72, s26, s24
    s_cselect_b32 s73, s27, s25
    s_cmp_eq_u32 s93, 2
    s_cselect_b32 s72, s28, s72
    s_cselect_b32 s73, s29, s73
    s_mov_b32 s92, 73728
    s_cmov_b32 s92, 9216
    s_mov_b32 s47, 1152
    s_cmov_b32 s47, 663552
    s_and_b32 s73, s73, 0xffff
    s_mov_b32 s74, 5308416
    s_mov_b32 s75, 0x20000
    s_mul_i32 s47, s47, s40
    s_add_u32 s7, s17, 0
    s_min_u32 s7, s7, 161
    s_mul_i32 s52, s7, 116509
    s_lshr_b32 s52, s52, 20
    s_mul_i32 s53, s52, 9
    s_sub_u32 s53, s7, s53
    s_mul_i32 s7, s52, s92
    s_lshl_b32 s7, s7, 2
    s_add_u32 s7, s7, s47
    s_lshl_b32 s6, s53, 7
    s_add_u32 s80, s7, s6
    s_add_u32 s7, s17, 1
    s_min_u32 s7, s7, 161
    s_mul_i32 s54, s7, 116509
    s_lshr_b32 s54, s54, 20
    s_mul_i32 s55, s54, 9
    s_sub_u32 s55, s7, s55
    s_mul_i32 s7, s54, s92
    s_lshl_b32 s7, s7, 2
    s_add_u32 s7, s7, s47
    s_lshl_b32 s6, s55, 7
    s_add_u32 s81, s7, s6
    s_add_u32 s7, s17, 2
    s_min_u32 s7, s7, 161
    s_mul_i32 s56, s7, 116509
    s_lshr_b32 s56, s56, 20
    s_mul_i32 s57, s56, 9
    s_sub_u32 s57, s7, s57
    s_mul_i32 s7, s56, s92
    s_lshl_b32 s7, s7, 2
    s_add_u32 s7, s7, s47
    s_lshl_b32 s6, s57, 7
    s_add_u32 s82, s7, s6
    s_add_u32 s7, s17, 0
    s_add_u32 s7, s7, s45
    s_min_u32 s7, s7, 161
    s_mul_i32 s58, s7, 116509
    s_lshr_b32 s58, s58, 20
    s_mul_i32 s59, s58, 9
    s_sub_u32 s59, s7, s59
    s_mul_i32 s7, s58, s92
    s_lshl_b32 s7, s7, 2
    s_add_u32 s7, s7, s47
    s_lshl_b32 s6, s59, 7
    s_add_u32 s83, s7, s6
    s_add_u32 s7, s17, 1
    s_add_u32 s7, s7, s45
    s_min_u32 s7, s7, 161
    s_mul_i32 s60, s7, 116509
    s_lshr_b32 s60, s60, 20
    s_mul_i32 s61, s60, 9
    s_sub_u32 s61, s7, s61
    s_mul_i32 s7, s60, s92
    s_lshl_b32 s7, s7, 2
    s_add_u32 s7, s7, s47
    s_lshl_b32 s6, s61, 7
    s_add_u32 s84, s7, s6
    s_lshr_b32 s7, s92, 3
    v_lshrrev_b32 v224, 3, v0
    v_mul_lo_u32 v224, v224, s7
    v_and_b32 v8, 7, v0
    v_lshl_add_u32 v224, v8, 4, v224
    s_waitcnt lgkmcnt(0)
    s_mul_i32 s76, s76, 0x9e3779b1
    s_add_u32 s76, s76, 0x7f4a7c15
    s_mov_b32 s77, s76
    s_add_u32 m0, s79, 0
    s_mov_b32 s71, s80
    buffer_load_dwordx4 v224, s[72:75], s71 offen nt lds
    s_add_u32 m0, s79, 1024
    s_add_u32 s71, s71, s92
    buffer_load_dwordx4 v224, s[72:75], s71 offen nt lds
    s_add_u32 m0, s79, 2048
    s_add_u32 s71, s71, s92
    buffer_load_dwordx4 v224, s[72:75], s71 offen nt lds
    s_add_u32 m0, s79, 3072
    s_add_u32 s71, s71, s92
    buffer_load_dwordx4 v224, s[72:75], s71 offen nt lds
    s_cmp_lt_u32 s32, 18
    s_cbranch_scc1 L_raw_9
    s_add_u32 m0, s79, 4096
    s_mov_b32 s71, s81
    buffer_load_dwordx4 v224, s[72:75], s71 offen nt lds
    s_add_u32 m0, s79, 5120
    s_add_u32 s71, s71, s92
    buffer_load_dwordx4 v224, s[72:75], s71 offen nt lds
    s_add_u32 m0, s79, 6144
    s_add_u32 s71, s71, s92
    buffer_load_dwordx4 v224, s[72:75], s71 offen nt lds
    s_add_u32 m0, s79, 7168
    s_add_u32 s71, s71, s92
    buffer_load_dwordx4 v224, s[72:75], s71 offen nt lds
    s_add_u32 m0, s79, 8192
    s_mov_b32 s71, s82
    buffer_load_dwordx4 v224, s[72:75], s71 offen nt lds
    s_add_u32 m0, s79, 9216
    s_add_u32 s71, s71, s92
    buffer_load_dwordx4 v224, s[72:75], s71 offen nt lds
    s_add_u32 m0, s79, 10240
    s_add_u32 s71, s71, s92
    buffer_load_dwordx4 v224, s[72:75], s71 offen nt lds
    s_add_u32 m0, s79, 11264
    s_add_u32 s71, s71, s92
    buffer_load_dwordx4 v224, s[72:75], s71 offen nt lds
    s_mul_i32 s68, s40, 1990656
    s_add_u32 s68, s68, 3145728
    s_mul_i32 s6, s52, 524288
    s_lshr_b32 s6, s6, 20
    s_mul_i32 s7, s6, 2
    s_sub_u32 s7, s52, s7
    s_mul_i32 s6, s6, 4
    s_add_u32 s7, s7, s6
    s_mul_i32 s6, s53, 36
    s_add_u32 s7, s7, s6
    s_mul_i32 s6, s93, 2
    s_add_u32 s7, s7, s6
    s_mul_i32 s6, s53, 18
    s_add_u32 s6, s6, s52
    s_add_u32 s6, s6, 324
    s_cmp_eq_u32 s93, 2
    s_cselect_b32 s7, s6, s7
    s_lshl_b32 s7, s7, 10
    s_add_u32 s94, s7, s68
    s_mul_i32 s6, s54, 524288
    s_lshr_b32 s6, s6, 20
    s_mul_i32 s7, s6, 2
    s_sub_u32 s7, s54, s7
    s_mul_i32 s6, s6, 4
    s_add_u32 s7, s7, s6
    s_mul_i32 s6, s55, 36
    s_add_u32 s7, s7, s6
    s_mul_i32 s6, s93, 2
    s_add_u32 s7, s7, s6
    s_mul_i32 s6, s55, 18
    s_add_u32 s6, s6, s54
    s_add_u32 s6, s6, 324
    s_cmp_eq_u32 s93, 2
    s_cselect_b32 s7, s6, s7
    s_lshl_b32 s7, s7, 10
    s_add_u32 s95, s7, s68
    s_mul_i32 s6, s56, 524288
    s_lshr_b32 s6, s6, 20
    s_mul_i32 s7, s6, 2
    s_sub_u32 s7, s56, s7
    s_mul_i32 s6, s6, 4
    s_add_u32 s7, s7, s6
    s_mul_i32 s6, s57, 36
    s_add_u32 s7, s7, s6
    s_mul_i32 s6, s93, 2
    s_add_u32 s7, s7, s6
    s_mul_i32 s6, s57, 18
    s_add_u32 s6, s6, s56
    s_add_u32 s6, s6, 324
    s_cmp_eq_u32 s93, 2
    s_cselect_b32 s7, s6, s7
    s_lshl_b32 s7, s7, 10
    s_add_u32 s85, s7, s68
    s_mul_i32 s6, s58, 524288
    s_lshr_b32 s6, s6, 20
    s_mul_i32 s7, s6, 2
    s_sub_u32 s7, s58, s7
    s_mul_i32 s6, s6, 4
    s_add_u32 s7, s7, s6
    s_mul_i32 s6, s59, 36
    s_add_u32 s7, s7, s6
    s_mul_i32 s6, s93, 2
    s_add_u32 s7, s7, s6
    s_mul_i32 s6, s59, 18
    s_add_u32 s6, s6, s58
    s_add_u32 s6, s6, 324
    s_cmp_eq_u32 s93, 2
    s_cselect_b32 s7, s6, s7
    s_lshl_b32 s7, s7, 10
    s_add_u32 s78, s7, s68
    s_mul_i32 s6, s60, 524288
    s_lshr_b32 s6, s6, 20
    s_mul_i32 s7, s6, 2
    s_sub_u32 s7, s60, s7
    s_mul_i32 s6, s6, 4
    s_add_u32 s7, s7, s6
    s_mul_i32 s6, s61, 36
    s_add_u32 s7, s7, s6
    s_mul_i32 s6, s93, 2
    s_add_u32 s7, s7, s6
    s_mul_i32 s6, s61, 18
    s_add_u32 s6, s6, s60
    s_add_u32 s6, s6, 324
    s_cmp_eq_u32 s93, 2
    s_cselect_b32 s7, s6, s7
    s_lshl_b32 s7, s7, 10
    s_add_u32 s70, s7, s68
    s_waitcnt vmcnt(12)
    s_branch L_raw_10
L_raw_9:
    s_mul_i32 s68, s40, 1990656
    s_add_u32 s68, s68, 3145728
    s_mul_i32 s6, s52, 524288
    s_lshr_b32 s6, s6, 20
    s_mul_i32 s7, s6, 2
    s_sub_u32 s7, s52, s7
    s_mul_i32 s6, s6, 4
    s_add_u32 s7, s7, s6
    s_mul_i32 s6, s53, 36
    s_add_u32 s7, s7, s6
    s_mul_i32 s6, s93, 2
    s_add_u32 s7, s7, s6
    s_mul_i32 s6, s53, 18
    s_add_u32 s6, s6, s52
    s_add_u32 s6, s6, 324
    s_cmp_eq_u32 s93, 2
    s_cselect_b32 s7, s6, s7
    s_lshl_b32 s7, s7, 10
    s_add_u32 s94, s7, s68
    s_mul_i32 s6, s54, 524288
    s_lshr_b32 s6, s6, 20
    s_mul_i32 s7, s6, 2
    s_sub_u32 s7, s54, s7
    s_mul_i32 s6, s6, 4
    s_add_u32 s7, s7, s6
    s_mul_i32 s6, s55, 36
    s_add_u32 s7, s7, s6
    s_mul_i32 s6, s93, 2
    s_add_u32 s7, s7, s6
    s_mul_i32 s6, s55, 18
    s_add_u32 s6, s6, s54
    s_add_u32 s6, s6, 324
    s_cmp_eq_u32 s93, 2
    s_cselect_b32 s7, s6, s7
    s_lshl_b32 s7, s7, 10
    s_add_u32 s95, s7, s68
    s_mul_i32 s6, s56, 524288
    s_lshr_b32 s6, s6, 20
    s_mul_i32 s7, s6, 2
    s_sub_u32 s7, s56, s7
    s_mul_i32 s6, s6, 4
    s_add_u32 s7, s7, s6
    s_mul_i32 s6, s57, 36
    s_add_u32 s7, s7, s6
    s_mul_i32 s6, s93, 2
    s_add_u32 s7, s7, s6
    s_mul_i32 s6, s57, 18
    s_add_u32 s6, s6, s56
    s_add_u32 s6, s6, 324
    s_cmp_eq_u32 s93, 2
    s_cselect_b32 s7, s6, s7
    s_lshl_b32 s7, s7, 10
    s_add_u32 s85, s7, s68
    s_mul_i32 s6, s58, 524288
    s_lshr_b32 s6, s6, 20
    s_mul_i32 s7, s6, 2
    s_sub_u32 s7, s58, s7
    s_mul_i32 s6, s6, 4
    s_add_u32 s7, s7, s6
    s_mul_i32 s6, s59, 36
    s_add_u32 s7, s7, s6
    s_mul_i32 s6, s93, 2
    s_add_u32 s7, s7, s6
    s_mul_i32 s6, s59, 18
    s_add_u32 s6, s6, s58
    s_add_u32 s6, s6, 324
    s_cmp_eq_u32 s93, 2
    s_cselect_b32 s7, s6, s7
    s_lshl_b32 s7, s7, 10
    s_add_u32 s78, s7, s68
    s_mul_i32 s6, s60, 524288
    s_lshr_b32 s6, s6, 20
    s_mul_i32 s7, s6, 2
    s_sub_u32 s7, s60, s7
    s_mul_i32 s6, s6, 4
    s_add_u32 s7, s7, s6
    s_mul_i32 s6, s61, 36
    s_add_u32 s7, s7, s6
    s_mul_i32 s6, s93, 2
    s_add_u32 s7, s7, s6
    s_mul_i32 s6, s61, 18
    s_add_u32 s6, s6, s60
    s_add_u32 s6, s6, 324
    s_cmp_eq_u32 s93, 2
    s_cselect_b32 s7, s6, s7
    s_lshl_b32 s7, s7, 10
    s_add_u32 s70, s7, s68
    s_waitcnt vmcnt(4)
L_raw_10:
    s_barrier
    s_cmp_ge_u32 s32, 18
    s_cbranch_scc1 L_prep_o_4
    s_mul_i32 s7, s3, 36
    s_add_u32 s7, s7, s46
    v_lshrrev_b32 v8, 4, v0
    v_lshlrev_b32 v8, 11, v8
    v_add_u32 v8, s7, v8
    v_and_b32 v9, 15, v0
    v_cmp_gt_u32 s[22:23], 6, v9
    v_lshrrev_b32 v10, 1, v9
    v_min_u32 v10, 2, v10
    v_lshl_add_u32 v10, v10, 13, v8
    v_and_b32 v11, 1, v0
    v_lshl_add_u32 v10, v11, 1, v10
    v_lshl_add_u32 v8, v9, 1, v8
    ds_read_u16 v136, v8 offset:8192
    ds_read_u16 v137, v8 offset:8448
    ds_read_u16 v138, v8 offset:8704
    ds_read_u16 v139, v8 offset:8960
    ds_read_u16 v140, v8 offset:9216
    ds_read_u16 v141, v8 offset:9472
    ds_read_u16 v142, v8 offset:9728
    ds_read_u16 v143, v8 offset:9984
    s_lshl_b32 s33, s40, 2
    s_add_u32 s33, s33, s3
    s_mul_i32 s33, s33, 18
    s_add_u32 s33, s33, s32
    s_lshl_b32 s33, s33, 12
    ds_read_u16 v144, v8 offset:16384
    ds_read_u16 v145, v8 offset:16640
    ds_read_u16 v146, v8 offset:16896
    ds_read_u16 v147, v8 offset:17152
    ds_read_u16 v148, v8 offset:17408
    ds_read_u16 v149, v8 offset:17664
    ds_read_u16 v150, v8 offset:17920
    ds_read_u16 v151, v8 offset:18176
    s_waitcnt lgkmcnt(8)
    v_lshl_or_b32 v32, v137, 16, v136
    v_lshl_or_b32 v33, v139, 16, v138
    v_lshl_or_b32 v34, v141, 16, v140
    v_lshl_or_b32 v35, v143, 16, v142
    buffer_store_dwordx4 v[32:35], v253, s[8:11], s33 offen offset:0 sc1
    ds_read_u16 v152, v8 offset:24576
    ds_read_u16 v153, v8 offset:24832
    ds_read_u16 v154, v8 offset:25088
    ds_read_u16 v155, v8 offset:25344
    ds_read_u16 v156, v8 offset:25600
    ds_read_u16 v157, v8 offset:25856
    ds_read_u16 v158, v8 offset:26112
    ds_read_u16 v159, v8 offset:26368
    s_waitcnt lgkmcnt(8)
    v_lshl_or_b32 v36, v145, 16, v144
    v_lshl_or_b32 v37, v147, 16, v146
    v_lshl_or_b32 v38, v149, 16, v148
    v_lshl_or_b32 v39, v151, 16, v150
    buffer_store_dwordx4 v[36:39], v253, s[8:11], s33 offen offset:1024 sc1
    ds_read_u16 v160, v10 offset:8224
    ds_read_u16 v161, v10 offset:8480
    ds_read_u16 v162, v10 offset:8736
    ds_read_u16 v163, v10 offset:8992
    ds_read_u16 v164, v10 offset:9248
    ds_read_u16 v165, v10 offset:9504
    ds_read_u16 v166, v10 offset:9760
    ds_read_u16 v167, v10 offset:10016
    s_waitcnt lgkmcnt(8)
    v_lshl_or_b32 v40, v153, 16, v152
    v_lshl_or_b32 v41, v155, 16, v154
    v_lshl_or_b32 v42, v157, 16, v156
    v_lshl_or_b32 v43, v159, 16, v158
    buffer_store_dwordx4 v[40:43], v253, s[8:11], s33 offen offset:2048 sc1
    s_waitcnt lgkmcnt(0)
    v_lshl_or_b32 v44, v161, 16, v160
    v_cndmask_b32 v44, 0, v44, s[22:23]
    v_lshl_or_b32 v45, v163, 16, v162
    v_cndmask_b32 v45, 0, v45, s[22:23]
    v_lshl_or_b32 v46, v165, 16, v164
    v_cndmask_b32 v46, 0, v46, s[22:23]
    v_lshl_or_b32 v47, v167, 16, v166
    v_cndmask_b32 v47, 0, v47, s[22:23]
    buffer_store_dwordx4 v[44:47], v253, s[8:11], s33 offen offset:3072 sc1
    s_branch L_prep_done_6
L_prep_o_4:
    s_cmp_ge_u32 s36, 54
    s_cbranch_scc1 L_prep_m_5
    v_lshrrev_b32 v8, 4, v0
    v_lshlrev_b32 v8, 3, v8
    v_bfe_u32 v9, v0, 2, 2
    v_add_u32 v8, v8, v9
    v_mul_u32_u24 v8, 128, v8
    v_and_b32 v9, 3, v0
    v_lshl_add_u32 v8, v9, 3, v8
    s_lshl_b32 s7, s3, 5
    v_add_u32 v8, s7, v8
    ds_read_b64_tr_b16 v[32:33], v8 offset:8192
    ds_read_b64_tr_b16 v[34:35], v8 offset:8704
    ds_read_b64_tr_b16 v[36:37], v8 offset:12288
    ds_read_b64_tr_b16 v[38:39], v8 offset:12800
    ds_read_b64_tr_b16 v[40:41], v8 offset:16384
    ds_read_b64_tr_b16 v[42:43], v8 offset:16896
    s_mul_i32 s34, s34, 12
    s_add_u32 s34, s34, s3
    s_mul_i32 s34, s34, 18
    s_add_u32 s34, s34, s33
    s_lshl_b32 s34, s34, 10
    s_add_u32 s7, s34, 2359296
    s_waitcnt lgkmcnt(4)
    buffer_store_dwordx4 v[32:35], v253, s[8:11], s7 offen sc1
    s_add_u32 s7, s34, 2433024
    s_waitcnt lgkmcnt(2)
    buffer_store_dwordx4 v[36:39], v253, s[8:11], s7 offen sc1
    s_add_u32 s7, s34, 2506752
    s_waitcnt lgkmcnt(0)
    buffer_store_dwordx4 v[40:43], v253, s[8:11], s7 offen sc1
    s_branch L_prep_done_6
L_prep_m_5:
    s_cmp_ge_u32 s37, 36
    s_cbranch_scc1 L_prep_done_6
    v_mov_b32 v28, 0x3f803f80
    v_mov_b32 v29, 0x3f803f80
    v_mov_b32 v30, 0x3f803f80
    v_mov_b32 v31, 0x3f803f80
    v_and_b32 v9, 15, v0
    v_cmp_eq_u32 vcc, 0, v9
    v_cmp_eq_u32 s[22:23], 1, v9
    v_mfma_f32_16x16x32_bf16 v[32:35], v[64:67], v[28:31], 0
    v_mfma_f32_16x16x32_bf16 v[32:35], v[68:71], v[28:31], v[32:35]
    v_mfma_f32_16x16x32_bf16 v[32:35], v[72:75], v[28:31], v[32:35]
    v_mfma_f32_16x16x32_bf16 v[32:35], v[76:79], v[28:31], v[32:35]
    v_mfma_f32_16x16x32_bf16 v[32:35], v[80:83], v[28:31], v[32:35]
    v_mfma_f32_16x16x32_bf16 v[32:35], v[84:87], v[28:31], v[32:35]
    v_mfma_f32_16x16x32_bf16 v[32:35], v[88:91], v[28:31], v[32:35]
    v_mfma_f32_16x16x32_bf16 v[32:35], v[92:95], v[28:31], v[32:35]
    v_mfma_f32_16x16x32_bf16 v[32:35], v[96:99], v[28:31], v[32:35]
    v_mfma_f32_16x16x32_bf16 v[32:35], v[100:103], v[28:31], v[32:35]
    v_mfma_f32_16x16x32_bf16 v[32:35], v[104:107], v[28:31], v[32:35]
    v_mfma_f32_16x16x32_bf16 v[32:35], v[108:111], v[28:31], v[32:35]
    v_mfma_f32_16x16x32_bf16 v[32:35], v[112:115], v[28:31], v[32:35]
    v_mfma_f32_16x16x32_bf16 v[32:35], v[116:119], v[28:31], v[32:35]
    v_mfma_f32_16x16x32_bf16 v[32:35], v[120:123], v[28:31], v[32:35]
    v_mfma_f32_16x16x32_bf16 v[32:35], v[124:127], v[28:31], v[32:35]
    v_mfma_f32_16x16x32_bf16 v[32:35], v[128:131], v[28:31], v[32:35]
    v_mfma_f32_16x16x32_bf16 v[32:35], v[132:135], v[28:31], v[32:35]
    v_lshrrev_b32 v10, 5, v0
    v_lshlrev_b32 v10, 8, v10
    v_lshl_add_u32 v10, v9, 4, v10
    v_bfe_u32 v9, v0, 4, 1
    v_lshl_add_u32 v10, v9, 3, v10
    s_lshl_b32 s7, s37, 9
    s_add_u32 s7, s7, 3022848
    s_nop 0
    v_mul_f32 v32, 0x3ae38e39, v32
    v_mul_f32 v33, 0x3ae38e39, v33
    v_mul_f32 v34, 0x3ae38e39, v34
    v_mul_f32 v35, 0x3ae38e39, v35
    v_cvt_pk_bf16_f32 v36, v32, v33
    v_cvt_pk_bf16_f32 v37, v34, v35
    v_lshlrev_b32 v38, 16, v36
    v_and_b32 v39, s16, v36
    v_sub_f32 v38, v32, v38
    v_sub_f32 v39, v33, v39
    v_cvt_pk_bf16_f32 v28, v38, v39
    v_cndmask_b32 v28, 0, v28, s[22:23]
    v_cndmask_b32 v28, v28, v36, vcc
    v_lshlrev_b32 v38, 16, v37
    v_and_b32 v39, s16, v37
    v_sub_f32 v38, v34, v38
    v_sub_f32 v39, v35, v39
    v_cvt_pk_bf16_f32 v29, v38, v39
    v_cndmask_b32 v29, 0, v29, s[22:23]
    v_cndmask_b32 v29, v29, v37, vcc
    buffer_store_dwordx2 v[28:29], v10, s[8:11], s7 offen sc1
L_prep_done_6:
    s_add_u32 s19, s18, 43515904
    s_add_u32 s20, s18, 38797312
    s_lshl_b32 s22, s21, 7
    s_add_u32 s22, s22, 48234496
    buffer_store_dwordx4 v[16:19], v172, s[8:11], s19 offen sc1
    buffer_store_dwordx4 v[20:23], v173, s[8:11], s19 offen sc1
    buffer_store_dwordx4 v[24:27], v174, s[8:11], s19 offen sc1
    s_mov_b32 s17, 0x3f803f80
    v_mov_b32 v8, 0
    v_mov_b32 v9, 0
    v_mov_b32 v10, 0
    v_mov_b32 v11, 0
    v_dot2c_f32_bf16 v8, s17, v16
    v_dot2c_f32_bf16 v9, v16, v16
    v_dot2c_f32_bf16 v10, s17, v17
    v_dot2c_f32_bf16 v11, v17, v17
    v_dot2c_f32_bf16 v8, s17, v18
    v_dot2c_f32_bf16 v9, v18, v18
    v_dot2c_f32_bf16 v10, s17, v19
    v_dot2c_f32_bf16 v11, v19, v19
    v_dot2c_f32_bf16 v8, s17, v20
    v_dot2c_f32_bf16 v9, v20, v20
    v_dot2c_f32_bf16 v10, s17, v21
    v_dot2c_f32_bf16 v11, v21, v21
    v_dot2c_f32_bf16 v8, s17, v22
    v_dot2c_f32_bf16 v9, v22, v22
    v_dot2c_f32_bf16 v10, s17, v23
    v_dot2c_f32_bf16 v11, v23, v23
    v_dot2c_f32_bf16 v8, s17, v24
    v_dot2c_f32_bf16 v9, v24, v24
    v_dot2c_f32_bf16 v10, s17, v25
    v_dot2c_f32_bf16 v11, v25, v25
    v_dot2c_f32_bf16 v8, s17, v26
    v_dot2c_f32_bf16 v9, v26, v26
    v_dot2c_f32_bf16 v10, s17, v27
    v_dot2c_f32_bf16 v11, v27, v27
    v_and_b32 v12, 7, v0
    v_lshlrev_b32 v12, 3, v12
    s_lshl_b32 s7, s3, 6
    v_add_u32 v13, s7, v12
    v_pk_add_f32 v[8:9], v[8:9], v[10:11]
    s_nop 1
    v_add_f32_dpp v8, v8, v8 row_ror:8 row_mask:0xf bank_mask:0xf
    v_add_f32_dpp v9, v9, v9 row_ror:8 row_mask:0xf bank_mask:0xf
    v_mov_b32 v10, v8
    v_mov_b32 v11, v9
    s_nop 1
    v_permlane32_swap_b32 v10, v8
    v_permlane32_swap_b32 v11, v9
    v_add_f32 v8, v8, v10
    v_add_f32 v9, v9, v11
    v_mov_b32 v10, v8
    v_mov_b32 v11, v9
    s_nop 1
    v_permlane16_swap_b32 v10, v8
    v_permlane16_swap_b32 v11, v9
    v_add_f32 v8, v8, v10
    v_add_f32 v9, v9, v11
    ds_write_b64 v13, v[8:9]
    s_waitcnt lgkmcnt(0)
    s_barrier
    ds_read_b64 v[40:41], v12 offset:0
    ds_read_b64 v[42:43], v12 offset:64
    ds_read_b64 v[44:45], v12 offset:128
    ds_read_b64 v[46:47], v12 offset:192
    s_waitcnt lgkmcnt(0)
    v_pk_add_f32 v[40:41], v[40:41], v[42:43]
    v_pk_add_f32 v[44:45], v[44:45], v[46:47]
    v_pk_add_f32 v[8:9], v[40:41], v[44:45]
    v_mul_f32 v8, 0x3ae38e39, v8
    v_mul_f32 v9, 0x3ae38e39, v9
    v_fma_f32 v9, -v8, v8, v9
    v_max_f32 v9, 0, v9
    v_add_f32 v9, 0x3727c5ac, v9
    v_rsq_f32 v10, v9
    s_nop 0
    v_mul_f32 v12, v8, v10
    v_mov_b32 v11, v10
    v_sub_f32 v12, 0, v12
    v_mov_b32 v13, v12
    s_cmp_eq_u32 s3, 0
    s_cselect_b32 s7, 32, 0
    v_lshlrev_b32 v14, 2, v0
    v_cmp_gt_u32 vcc, s7, v0
    v_mov_b32 v9, 1073741824
    s_nop 0
    v_cndmask_b32 v14, v9, v14, vcc
    buffer_store_dword v8, v14, s[8:11], s22 offen sc1
    v_lshlrev_b32 v40, 16, v16
    v_and_b32 v41, s16, v16
    v_lshlrev_b32 v42, 16, v17
    v_and_b32 v43, s16, v17
    v_lshlrev_b32 v44, 16, v18
    v_and_b32 v45, s16, v18
    v_lshlrev_b32 v46, 16, v19
    v_and_b32 v47, s16, v19
    v_pk_fma_f32 v[40:41], v[40:41], v[10:11], v[12:13]
    v_pk_fma_f32 v[42:43], v[42:43], v[10:11], v[12:13]
    v_pk_fma_f32 v[44:45], v[44:45], v[10:11], v[12:13]
    v_pk_fma_f32 v[46:47], v[46:47], v[10:11], v[12:13]
    v_cvt_pk_bf16_f32 v48, v40, v41
    v_cvt_pk_bf16_f32 v49, v42, v43
    v_cvt_pk_bf16_f32 v50, v44, v45
    v_cvt_pk_bf16_f32 v51, v46, v47
    v_lshlrev_b32 v40, 16, v20
    v_and_b32 v41, s16, v20
    v_lshlrev_b32 v42, 16, v21
    v_and_b32 v43, s16, v21
    v_lshlrev_b32 v44, 16, v22
    v_and_b32 v45, s16, v22
    v_lshlrev_b32 v46, 16, v23
    v_and_b32 v47, s16, v23
    v_pk_fma_f32 v[40:41], v[40:41], v[10:11], v[12:13]
    v_pk_fma_f32 v[42:43], v[42:43], v[10:11], v[12:13]
    v_pk_fma_f32 v[44:45], v[44:45], v[10:11], v[12:13]
    v_pk_fma_f32 v[46:47], v[46:47], v[10:11], v[12:13]
    v_cvt_pk_bf16_f32 v52, v40, v41
    v_cvt_pk_bf16_f32 v53, v42, v43
    v_cvt_pk_bf16_f32 v54, v44, v45
    v_cvt_pk_bf16_f32 v55, v46, v47
    v_lshlrev_b32 v40, 16, v24
    v_and_b32 v41, s16, v24
    v_lshlrev_b32 v42, 16, v25
    v_and_b32 v43, s16, v25
    v_lshlrev_b32 v44, 16, v26
    v_and_b32 v45, s16, v26
    v_lshlrev_b32 v46, 16, v27
    v_and_b32 v47, s16, v27
    v_pk_fma_f32 v[40:41], v[40:41], v[10:11], v[12:13]
    v_pk_fma_f32 v[42:43], v[42:43], v[10:11], v[12:13]
    v_pk_fma_f32 v[44:45], v[44:45], v[10:11], v[12:13]
    v_pk_fma_f32 v[46:47], v[46:47], v[10:11], v[12:13]
    v_cvt_pk_bf16_f32 v56, v40, v41
    v_cvt_pk_bf16_f32 v57, v42, v43
    v_cvt_pk_bf16_f32 v58, v44, v45
    v_cvt_pk_bf16_f32 v59, v46, v47
    buffer_store_dwordx4 v[48:51], v172, s[8:11], s20 offen sc1
    buffer_store_dwordx4 v[52:55], v173, s[8:11], s20 offen sc1
    buffer_store_dwordx4 v[56:59], v174, s[8:11], s20 offen sc1
    v_lshlrev_b32 v15, 7, v0
    s_lshl_b32 s6, s40, 2
    s_add_u32 s6, s6, s44
    s_sub_u32 s6, s6, 32768
    v_mov_b32 v1, s76
    s_mov_b64 vcc, 0xff
    v_lshrrev_b32 v14, 3, v0
    v_lshl_add_u32 v15, v14, 3, v15
    s_cmp_ge_u32 s40, 6
    s_cselect_b32 s7, s41, 31
    s_cmp_lt_u32 s7, 31
    s_cmov_b64 vcc, 0xffff
    s_waitcnt vmcnt(0)
    s_barrier
    s_cmp_lg_u32 s3, 0
    s_cbranch_scc1 L_pub_11
    s_mov_b64 exec, vcc
    buffer_store_dword v1, v15, s[8:11], s6 offen sc1
    s_lshl_b32 s6, s40, 7
    s_lshl_b32 s7, s32, 2
    s_add_u32 s6, s6, s7
    s_add_u32 s6, s6, 19431424
    s_mov_b64 exec, 0xffffffff
    v_lshlrev_b32 v15, 10, v0
    v_mov_b32 v1, s76
    buffer_store_dword v1, v15, s[8:11], s6 offen sc1
    s_cmp_lt_u32 s32, 18
    s_cbranch_scc1 L_pub_11
    s_lshl_b32 s6, s36, 2
    s_add_u32 s6, s6, 19496960
    s_mov_b64 exec, 1
    buffer_store_dword v1, off, s[8:11], s6 sc1
L_pub_11:
    s_mov_b64 exec, -1
    s_cmp_lt_u32 s32, 18
    s_cbranch_scc1 L_raw_12
    s_cmp_eq_u32 s93, 2
    s_cselect_b32 s6, 2, 3
    s_mov_b32 s7, 512
    s_cmov_b32 s7, 2048
    v_lshrrev_b32 v14, 4, v0
    v_lshlrev_b32 v14, s6, v14
    v_bfe_u32 v15, v0, 2, 2
    v_add_u32 v14, v14, v15
    v_mul_u32_u24 v14, 128, v14
    v_and_b32 v15, 3, v0
    v_lshl_add_u32 v14, v15, 3, v14
    v_add_u32 v14, s79, v14
    v_add_u32 v15, s7, v14
    ds_read_b64_tr_b16 v[64:65], v14 offset:0
    ds_read_b64_tr_b16 v[66:67], v15 offset:0
    ds_read_b64_tr_b16 v[68:69], v14 offset:32
    ds_read_b64_tr_b16 v[70:71], v15 offset:32
    ds_read_b64_tr_b16 v[72:73], v14 offset:64
    ds_read_b64_tr_b16 v[74:75], v15 offset:64
    ds_read_b64_tr_b16 v[76:77], v14 offset:96
    ds_read_b64_tr_b16 v[78:79], v15 offset:96
    ds_read_b64_tr_b16 v[80:81], v14 offset:4096
    ds_read_b64_tr_b16 v[82:83], v15 offset:4096
    ds_read_b64_tr_b16 v[84:85], v14 offset:4128
    ds_read_b64_tr_b16 v[86:87], v15 offset:4128
    ds_read_b64_tr_b16 v[88:89], v14 offset:4160
    ds_read_b64_tr_b16 v[90:91], v15 offset:4160
    ds_read_b64_tr_b16 v[92:93], v14 offset:4192
    ds_read_b64_tr_b16 v[94:95], v15 offset:4192
    ds_read_b64_tr_b16 v[96:97], v14 offset:8192
    ds_read_b64_tr_b16 v[98:99], v15 offset:8192
    ds_read_b64_tr_b16 v[100:101], v14 offset:8224
    ds_read_b64_tr_b16 v[102:103], v15 offset:8224
    ds_read_b64_tr_b16 v[104:105], v14 offset:8256
    ds_read_b64_tr_b16 v[106:107], v15 offset:8256
    ds_read_b64_tr_b16 v[108:109], v14 offset:8288
    ds_read_b64_tr_b16 v[110:111], v15 offset:8288
    s_waitcnt lgkmcnt(0)
    s_add_u32 m0, s79, 8192
    s_mov_b32 s71, s83
    buffer_load_dwordx4 v224, s[72:75], s71 offen nt lds
    s_add_u32 m0, s79, 9216
    s_add_u32 s71, s71, s92
    buffer_load_dwordx4 v224, s[72:75], s71 offen nt lds
    s_add_u32 m0, s79, 10240
    s_add_u32 s71, s71, s92
    buffer_load_dwordx4 v224, s[72:75], s71 offen nt lds
    s_add_u32 m0, s79, 11264
    s_add_u32 s71, s71, s92
    buffer_load_dwordx4 v224, s[72:75], s71 offen nt lds
    s_add_u32 m0, s79, 12288
    s_mov_b32 s71, s84
    buffer_load_dwordx4 v224, s[72:75], s71 offen nt lds
    s_add_u32 m0, s79, 13312
    s_add_u32 s71, s71, s92
    buffer_load_dwordx4 v224, s[72:75], s71 offen nt lds
    s_add_u32 m0, s79, 14336
    s_add_u32 s71, s71, s92
    buffer_load_dwordx4 v224, s[72:75], s71 offen nt lds
    s_add_u32 m0, s79, 15360
    s_add_u32 s71, s71, s92
    buffer_load_dwordx4 v224, s[72:75], s71 offen nt lds
    s_add_u32 s7, s94, 0
    buffer_store_dwordx4 v[64:67], v253, s[8:11], s7 offen sc1
    s_add_u32 s7, s94, 497664
    buffer_store_dwordx4 v[68:71], v253, s[8:11], s7 offen sc1
    s_add_u32 s7, s94, 995328
    buffer_store_dwordx4 v[72:75], v253, s[8:11], s7 offen sc1
    s_add_u32 s7, s94, 1492992
    buffer_store_dwordx4 v[76:79], v253, s[8:11], s7 offen sc1
    s_add_u32 s7, s95, 0
    buffer_store_dwordx4 v[80:83], v253, s[8:11], s7 offen sc1
    s_add_u32 s7, s95, 497664
    buffer_store_dwordx4 v[84:87], v253, s[8:11], s7 offen sc1
    s_add_u32 s7, s95, 995328
    buffer_store_dwordx4 v[88:91], v253, s[8:11], s7 offen sc1
    s_add_u32 s7, s95, 1492992
    buffer_store_dwordx4 v[92:95], v253, s[8:11], s7 offen sc1
    s_add_u32 s7, s85, 0
    buffer_store_dwordx4 v[96:99], v253, s[8:11], s7 offen sc1
    s_add_u32 s7, s85, 497664
    buffer_store_dwordx4 v[100:103], v253, s[8:11], s7 offen sc1
    s_add_u32 s7, s85, 995328
    buffer_store_dwordx4 v[104:107], v253, s[8:11], s7 offen sc1
    s_add_u32 s7, s85, 1492992
    buffer_store_dwordx4 v[108:111], v253, s[8:11], s7 offen sc1
    s_branch L_raw_13
L_raw_12:
    s_cmp_eq_u32 s93, 2
    s_cselect_b32 s6, 2, 3
    s_mov_b32 s7, 512
    s_cmov_b32 s7, 2048
    v_lshrrev_b32 v14, 4, v0
    v_lshlrev_b32 v14, s6, v14
    v_bfe_u32 v15, v0, 2, 2
    v_add_u32 v14, v14, v15
    v_mul_u32_u24 v14, 128, v14
    v_and_b32 v15, 3, v0
    v_lshl_add_u32 v14, v15, 3, v14
    v_add_u32 v14, s79, v14
    v_add_u32 v15, s7, v14
    ds_read_b64_tr_b16 v[64:65], v14 offset:0
    ds_read_b64_tr_b16 v[66:67], v15 offset:0
    ds_read_b64_tr_b16 v[68:69], v14 offset:32
    ds_read_b64_tr_b16 v[70:71], v15 offset:32
    ds_read_b64_tr_b16 v[72:73], v14 offset:64
    ds_read_b64_tr_b16 v[74:75], v15 offset:64
    ds_read_b64_tr_b16 v[76:77], v14 offset:96
    ds_read_b64_tr_b16 v[78:79], v15 offset:96
    s_waitcnt lgkmcnt(0)
    s_add_u32 m0, s79, 8192
    s_mov_b32 s71, s83
    buffer_load_dwordx4 v224, s[72:75], s71 offen nt lds
    s_add_u32 m0, s79, 9216
    s_add_u32 s71, s71, s92
    buffer_load_dwordx4 v224, s[72:75], s71 offen nt lds
    s_add_u32 m0, s79, 10240
    s_add_u32 s71, s71, s92
    buffer_load_dwordx4 v224, s[72:75], s71 offen nt lds
    s_add_u32 m0, s79, 11264
    s_add_u32 s71, s71, s92
    buffer_load_dwordx4 v224, s[72:75], s71 offen nt lds
    s_add_u32 m0, s79, 12288
    s_mov_b32 s71, s84
    buffer_load_dwordx4 v224, s[72:75], s71 offen nt lds
    s_add_u32 m0, s79, 13312
    s_add_u32 s71, s71, s92
    buffer_load_dwordx4 v224, s[72:75], s71 offen nt lds
    s_add_u32 m0, s79, 14336
    s_add_u32 s71, s71, s92
    buffer_load_dwordx4 v224, s[72:75], s71 offen nt lds
    s_add_u32 m0, s79, 15360
    s_add_u32 s71, s71, s92
    buffer_load_dwordx4 v224, s[72:75], s71 offen nt lds
    s_add_u32 s7, s94, 0
    buffer_store_dwordx4 v[64:67], v253, s[8:11], s7 offen sc1
    s_add_u32 s7, s94, 497664
    buffer_store_dwordx4 v[68:71], v253, s[8:11], s7 offen sc1
    s_add_u32 s7, s94, 995328
    buffer_store_dwordx4 v[72:75], v253, s[8:11], s7 offen sc1
    s_add_u32 s7, s94, 1492992
    buffer_store_dwordx4 v[76:79], v253, s[8:11], s7 offen sc1
L_raw_13:
    s_cmp_lg_u32 s3, 0
    s_cbranch_scc1 L_wq_ready_14
    s_lshl_b32 s7, s41, 3
    s_add_u32 s7, s7, s40
    s_lshl_b32 s7, s7, 7
    s_add_u32 s7, s7, 19431424
    s_add_u32 s68, s4, s7
    s_addc_u32 s69, s5, 0
    s_mov_b32 s6, 0
    s_mov_b32 s7, 0
L_cpoll_15:
    s_load_dwordx16 s[52:67], s[68:69], s7 glc
    s_add_u32 s6, s6, 1
    s_waitcnt lgkmcnt(0)
    s_xor_b64 s[52:53], s[52:53], s[76:77]
    s_xor_b64 s[54:55], s[54:55], s[76:77]
    s_xor_b64 s[56:57], s[56:57], s[76:77]
    s_xor_b64 s[58:59], s[58:59], s[76:77]
    s_xor_b64 s[60:61], s[60:61], s[76:77]
    s_xor_b64 s[62:63], s[62:63], s[76:77]
    s_xor_b64 s[64:65], s[64:65], s[76:77]
    s_xor_b64 s[66:67], s[66:67], s[76:77]
    s_or_b64 s[52:53], s[52:53], s[60:61]
    s_or_b64 s[54:55], s[54:55], s[62:63]
    s_or_b64 s[56:57], s[56:57], s[64:65]
    s_or_b64 s[58:59], s[58:59], s[66:67]
    s_or_b64 s[52:53], s[52:53], s[56:57]
    s_or_b64 s[54:55], s[54:55], s[58:59]
    s_or_b64 s[52:53], s[52:53], s[54:55]
    s_cbranch_scc1 L_cpoll_16
    s_add_u32 s7, s7, 8
    s_cmp_eq_u32 s7, 16
    s_cbranch_scc1 L_cpolled_17
L_cpoll_16:
    s_cmp_lt_u32 s6, 1048576
    s_cbranch_scc1 L_cpoll_15
    s_branch L_main_end
L_cpolled_17:
L_wq_ready_14:
    s_barrier
    s_lshl_b32 s28, s40, 2
    s_add_u32 s28, s28, s3
    s_mul_i32 s28, s28, 73728
    v_and_b32 v229, 8, v0
    v_lshl_add_u32 v229, v229, 27, v253
    buffer_load_dwordx4 a[0:3], v253, s[8:11], s28 offen offset:0 sc1
    buffer_load_dwordx4 a[4:7], v253, s[8:11], s28 offen offset:1024 sc1
    buffer_load_dwordx4 a[8:11], v253, s[8:11], s28 offen offset:2048 sc1
    buffer_load_dwordx4 a[12:15], v229, s[8:11], s28 offen offset:3072 sc1
    s_add_u32 s28, s28, 4096
    buffer_load_dwordx4 a[16:19], v253, s[8:11], s28 offen offset:0 sc1
    buffer_load_dwordx4 a[20:23], v253, s[8:11], s28 offen offset:1024 sc1
    buffer_load_dwordx4 a[24:27], v253, s[8:11], s28 offen offset:2048 sc1
    buffer_load_dwordx4 a[28:31], v229, s[8:11], s28 offen offset:3072 sc1
    s_add_u32 s28, s28, 4096
    buffer_load_dwordx4 a[32:35], v253, s[8:11], s28 offen offset:0 sc1
    buffer_load_dwordx4 a[36:39], v253, s[8:11], s28 offen offset:1024 sc1
    buffer_load_dwordx4 a[40:43], v253, s[8:11], s28 offen offset:2048 sc1
    buffer_load_dwordx4 a[44:47], v229, s[8:11], s28 offen offset:3072 sc1
    s_add_u32 s28, s28, 4096
    buffer_load_dwordx4 a[48:51], v253, s[8:11], s28 offen offset:0 sc1
    buffer_load_dwordx4 a[52:55], v253, s[8:11], s28 offen offset:1024 sc1
    buffer_load_dwordx4 a[56:59], v253, s[8:11], s28 offen offset:2048 sc1
    buffer_load_dwordx4 a[60:63], v229, s[8:11], s28 offen offset:3072 sc1
    s_add_u32 s28, s28, 4096
    buffer_load_dwordx4 a[64:67], v253, s[8:11], s28 offen offset:0 sc1
    buffer_load_dwordx4 a[68:71], v253, s[8:11], s28 offen offset:1024 sc1
    buffer_load_dwordx4 a[72:75], v253, s[8:11], s28 offen offset:2048 sc1
    buffer_load_dwordx4 a[76:79], v229, s[8:11], s28 offen offset:3072 sc1
    s_add_u32 s28, s28, 4096
    buffer_load_dwordx4 a[80:83], v253, s[8:11], s28 offen offset:0 sc1
    buffer_load_dwordx4 a[84:87], v253, s[8:11], s28 offen offset:1024 sc1
    buffer_load_dwordx4 a[88:91], v253, s[8:11], s28 offen offset:2048 sc1
    buffer_load_dwordx4 a[92:95], v229, s[8:11], s28 offen offset:3072 sc1
    s_add_u32 s28, s28, 4096
    buffer_load_dwordx4 a[96:99], v253, s[8:11], s28 offen offset:0 sc1
    buffer_load_dwordx4 a[100:103], v253, s[8:11], s28 offen offset:1024 sc1
    buffer_load_dwordx4 a[104:107], v253, s[8:11], s28 offen offset:2048 sc1
    buffer_load_dwordx4 a[108:111], v229, s[8:11], s28 offen offset:3072 sc1
    s_add_u32 s28, s28, 4096
    buffer_load_dwordx4 a[112:115], v253, s[8:11], s28 offen offset:0 sc1
    buffer_load_dwordx4 a[116:119], v253, s[8:11], s28 offen offset:1024 sc1
    buffer_load_dwordx4 a[120:123], v253, s[8:11], s28 offen offset:2048 sc1
    buffer_load_dwordx4 a[124:127], v229, s[8:11], s28 offen offset:3072 sc1
    s_add_u32 s28, s28, 4096
    buffer_load_dwordx4 a[128:131], v253, s[8:11], s28 offen offset:0 sc1
    buffer_load_dwordx4 a[132:135], v253, s[8:11], s28 offen offset:1024 sc1
    buffer_load_dwordx4 a[136:139], v253, s[8:11], s28 offen offset:2048 sc1
    buffer_load_dwordx4 a[140:143], v229, s[8:11], s28 offen offset:3072 sc1
    s_add_u32 s28, s28, 4096
L_main_layer:
    v_bfe_u32 v3, v0, 3, 1
    v_mul_u32_u24 v2, 9216, v3
    v_lshrrev_b32 v3, 4, v0
    v_lshl_add_u32 v2, v3, 7, v2
    v_and_b32 v3, 7, v0
    v_lshl_add_u32 v2, v3, 4, v2
    v_bfe_u32 v3, v0, 3, 2
    s_mov_b32 s7, 9216
    v_mul_lo_u32 v9, v3, s7
    v_lshrrev_b32 v3, 5, v0
    v_lshl_add_u32 v9, v3, 7, v9
    v_and_b32 v3, 7, v0
    v_lshl_add_u32 v9, v3, 4, v9
    s_mul_i32 s22, s41, 73728
    s_add_u32 s22, s22, s43
    s_add_u32 s23, s22, 38797312
    s_mul_i32 s7, s3, 18432
    s_add_u32 s24, s23, s7
    s_cmp_eq_u32 s41, 0
    s_cselect_b32 s7, 0, 18432
    s_sub_u32 s23, s23, s7
    s_lshl_b32 s25, s3, 10
    s_add_u32 s25, s25, 1024
    s_mul_i32 s26, s3, 5120
    s_lshl_b32 s7, s3, 9
    s_add_u32 s27, s23, s7
    s_and_b32 s7, s3, 1
    s_add_u32 s7, s7, 4
    s_mul_i32 s29, s7, 5120
    s_lshl_b32 s7, s7, 9
    s_add_u32 s23, s23, s7
    s_cmp_lg_u32 s3, 3
    s_cbranch_scc1 L_pollout_20
    s_lshl_b32 s7, s40, 7
    s_add_u32 s7, s7, s44
    s_sub_u32 s7, s7, 32768
    s_add_u32 s52, s4, s7
    s_addc_u32 s53, s5, 0
    s_cmp_eq_u32 s41, 0
    s_cselect_b32 s7, 0, 32
    s_mov_b32 s6, 0
L_poll_18:
    s_load_dwordx8 s[56:63], s[52:53], 0 glc
    s_load_dwordx2 s[54:55], s[52:53], s7 glc
    s_add_u32 s6, s6, 1
    s_waitcnt lgkmcnt(0)
    s_xor_b64 s[54:55], s[54:55], s[76:77]
    s_xor_b64 s[56:57], s[56:57], s[76:77]
    s_xor_b64 s[58:59], s[58:59], s[76:77]
    s_xor_b64 s[60:61], s[60:61], s[76:77]
    s_xor_b64 s[62:63], s[62:63], s[76:77]
    s_or_b64 s[56:57], s[56:57], s[58:59]
    s_or_b64 s[60:61], s[60:61], s[62:63]
    s_or_b64 s[56:57], s[56:57], s[54:55]
    s_or_b64 s[56:57], s[56:57], s[60:61]
    s_cbranch_scc0 L_polled_19
    s_cmp_lt_u32 s6, 1048576
    s_cbranch_scc1 L_poll_18
    s_branch L_main_end
L_polled_19:
L_pollout_20:
    s_barrier
    s_add_u32 m0, s25, 0
    s_nop 0
    buffer_load_dwordx4 v2, s[8:11], s24 offen offset:0 sc1 lds
    s_add_u32 m0, s25, 4608
    s_nop 0
    buffer_load_dwordx4 v2, s[8:11], s24 offen offset:512 sc1 lds
    s_add_u32 m0, s25, 9216
    s_nop 0
    buffer_load_dwordx4 v2, s[8:11], s24 offen offset:1024 sc1 lds
    s_add_u32 m0, s25, 13824
    s_nop 0
    buffer_load_dwordx4 v2, s[8:11], s24 offen offset:1536 sc1 lds
    s_add_u32 m0, s25, 18432
    s_nop 0
    buffer_load_dwordx4 v2, s[8:11], s24 offen offset:2048 sc1 lds
    s_add_u32 m0, s25, 23040
    s_nop 0
    buffer_load_dwordx4 v2, s[8:11], s24 offen offset:2560 sc1 lds
    s_add_u32 m0, s26, 0
    s_add_u32 s7, s27, 0
    buffer_load_dwordx4 v2, s[8:11], s7 offen sc1 lds
    s_add_u32 m0, s29, 0
    s_add_u32 s7, s23, 0
    buffer_load_dwordx4 v2, s[8:11], s7 offen sc1 lds
    v_add_u32 v6, 46080, v253
    s_waitcnt vmcnt(0)
    s_barrier
    ds_read_b128 v[16:19], v253 offset:0
    ds_read_b128 v[20:23], v253 offset:1024
    ds_read_b128 v[24:27], v253 offset:2048
    ds_read_b128 v[28:31], v253 offset:3072
    ds_read_b128 v[32:35], v253 offset:4096
    s_waitcnt lgkmcnt(0)
    v_mfma_f32_16x16x32_bf16 v[56:59], a[0:3], v[20:23], 0
    ds_read_b128 v[36:39], v253 offset:5120
    v_mfma_f32_16x16x32_bf16 v[60:63], a[0:3], v[24:27], 0
    ds_read_b128 v[40:43], v253 offset:6144
    v_mfma_f32_16x16x32_bf16 v[64:67], a[0:3], v[28:31], 0
    ds_read_b128 v[44:47], v253 offset:7168
    v_mfma_f32_16x16x32_bf16 v[68:71], a[0:3], v[32:35], 0
    ds_read_b128 v[48:51], v253 offset:8192
    v_mfma_f32_16x16x32_bf16 v[72:75], a[4:7], v[16:19], 0
    ds_read_b128 v[52:55], v253 offset:9216
    v_mfma_f32_16x16x32_bf16 v[76:79], a[4:7], v[20:23], 0
    s_add_u32 m0, s25, 27648
    s_nop 0
    buffer_load_dwordx4 v2, s[8:11], s24 offen offset:3072 sc1 lds
    v_mfma_f32_16x16x32_bf16 v[80:83], a[4:7], v[24:27], 0
    v_mov_b32 v132, 0
    v_mov_b32 v133, 0
    v_mfma_f32_16x16x32_bf16 v[84:87], a[4:7], v[28:31], 0
    s_add_u32 m0, s25, 32256
    s_nop 0
    buffer_load_dwordx4 v2, s[8:11], s24 offen offset:3584 sc1 lds
    v_mfma_f32_16x16x32_bf16 v[88:91], a[4:7], v[32:35], 0
    v_mov_b32 v192, 0
    v_mov_b32 v193, 0
    v_mfma_f32_16x16x32_bf16 v[92:95], v[16:19], a[8:11], 0
    buffer_load_dwordx4 a[144:147], v253, s[8:11], s28 offen offset:0 sc1
    v_mfma_f32_16x16x32_bf16 v[96:99], v[20:23], a[8:11], 0
    v_mov_b32 v195, 0
    v_mov_b32 v135, 0
    v_mfma_f32_16x16x32_bf16 v[100:103], v[24:27], a[8:11], 0
    buffer_load_dwordx4 a[148:151], v253, s[8:11], s28 offen offset:1024 sc1
    v_mfma_f32_16x16x32_bf16 v[104:107], v[28:31], a[8:11], 0
    v_mov_b32 v139, 0
    v_mov_b32 v143, 0
    v_mfma_f32_16x16x32_bf16 v[108:111], v[32:35], a[8:11], 0
    buffer_load_dwordx4 a[152:155], v253, s[8:11], s28 offen offset:2048 sc1
    v_mfma_f32_16x16x32_bf16 v[112:115], a[12:15], v[16:19], 0
    v_mov_b32 v147, 0
    v_mov_b32 v151, 0
    v_mfma_f32_16x16x32_bf16 v[116:119], a[12:15], v[20:23], 0
    v_mov_b32 v155, 0
    v_mov_b32 v159, 0
    v_mfma_f32_16x16x32_bf16 v[120:123], a[12:15], v[24:27], 0
    v_mov_b32 v163, 0
    v_mov_b32 v167, 0
    v_mfma_f32_16x16x32_bf16 v[124:127], a[12:15], v[28:31], 0
    v_mov_b32 v171, 0
    v_cmp_eq_u32 vcc, 16, v0
    v_mov_b32 v10, 0x3f80
    v_mfma_f32_16x16x32_bf16 v[128:131], a[12:15], v[32:35], 0
    v_cmp_eq_u32 s[20:21], 17, v0
    v_cndmask_b32 v194, 0, v10, vcc
    v_and_b32 v11, 3, v0
    s_waitcnt lgkmcnt(0)
    v_mfma_f32_16x16x32_bf16 v[56:59], a[16:19], v[40:43], v[56:59]
    ds_read_b128 v[16:19], v253 offset:10240
    v_mfma_f32_16x16x32_bf16 v[60:63], a[16:19], v[44:47], v[60:63]
    ds_read_b128 v[20:23], v253 offset:11264
    v_mfma_f32_16x16x32_bf16 v[64:67], a[16:19], v[48:51], v[64:67]
    ds_read_b128 v[24:27], v253 offset:12288
    v_mfma_f32_16x16x32_bf16 v[68:71], a[16:19], v[52:55], v[68:71]
    ds_read_b128 v[28:31], v253 offset:13312
    v_mfma_f32_16x16x32_bf16 v[72:75], a[20:23], v[36:39], v[72:75]
    ds_read_b128 v[32:35], v253 offset:14336
    v_mfma_f32_16x16x32_bf16 v[76:79], a[20:23], v[40:43], v[76:79]
    s_add_u32 m0, s25, 40960
    s_add_u32 s24, s24, 4096
    buffer_load_dwordx4 v2, s[8:11], s24 offen offset:0 sc1 lds
    v_mfma_f32_16x16x32_bf16 v[80:83], a[20:23], v[44:47], v[80:83]
    v_cndmask_b32 v194, v194, 1.0, s[20:21]
    v_cmp_eq_u32 vcc, 2, v11
    v_and_b32 v10, 15, v0
    v_mfma_f32_16x16x32_bf16 v[84:87], a[20:23], v[48:51], v[84:87]
    s_add_u32 m0, s25, 45568
    s_nop 0
    buffer_load_dwordx4 v2, s[8:11], s24 offen offset:512 sc1 lds
    v_mfma_f32_16x16x32_bf16 v[88:91], a[20:23], v[52:55], v[88:91]
    v_lshrrev_b32 v11, 4, v0
    v_cndmask_b32 v196, 0, 1.0, vcc
    v_mfma_f32_16x16x32_bf16 v[92:95], v[36:39], a[24:27], v[92:95]
    buffer_load_dwordx4 a[156:159], v229, s[8:11], s28 offen offset:3072 sc1
    s_add_u32 s28, s28, 4096
    v_mfma_f32_16x16x32_bf16 v[96:99], v[40:43], a[24:27], v[96:99]
    v_cndmask_b32 v197, 0, 1.0, vcc
    v_cndmask_b32 v198, 0, 1.0, vcc
    v_mfma_f32_16x16x32_bf16 v[100:103], v[44:47], a[24:27], v[100:103]
    buffer_load_dwordx4 a[0:3], v253, s[8:11], s28 offen offset:0 sc1
    v_mfma_f32_16x16x32_bf16 v[104:107], v[48:51], a[24:27], v[104:107]
    v_cndmask_b32 v199, 0, 1.0, vcc
    v_lshlrev_b32 v11, 2, v11
    v_mfma_f32_16x16x32_bf16 v[108:111], v[52:55], a[24:27], v[108:111]
    buffer_load_dwordx4 a[4:7], v253, s[8:11], s28 offen offset:1024 sc1
    v_mfma_f32_16x16x32_bf16 v[112:115], a[28:31], v[36:39], v[112:115]
    v_sub_u32 v10, v11, v10
    v_mov_b32 v12, 0xf149f2ca
    v_mfma_f32_16x16x32_bf16 v[116:119], a[28:31], v[40:43], v[116:119]
    s_cmp_eq_u32 s41, 0
    s_cselect_b64 s[38:39], 0, -1
    v_add_u32 v11, 0, v10
    v_and_b32 v13, 1, v11
    v_mfma_f32_16x16x32_bf16 v[120:123], a[28:31], v[44:47], v[120:123]
    v_cmp_eq_u32 s[20:21], 0, v13
    v_cmp_lt_i32 vcc, 1, v11
    v_cmp_gt_i32 s[18:19], 1, v11
    s_and_b64 vcc, vcc, s[20:21]
    s_and_b64 s[18:19], s[18:19], s[20:21]
    s_and_b64 s[20:21], vcc, s[38:39]
    v_cndmask_b32 v200, v12, 0, vcc
    v_cndmask_b32 v204, v12, 0, s[18:19]
    v_mfma_f32_16x16x32_bf16 v[124:127], a[28:31], v[48:51], v[124:127]
    v_cndmask_b32 v208, v12, 0, s[20:21]
    v_add_u32 v11, 1, v10
    v_mfma_f32_16x16x32_bf16 v[128:131], a[28:31], v[52:55], v[128:131]
    v_and_b32 v13, 1, v11
    v_cmp_eq_u32 s[20:21], 0, v13
    v_cmp_lt_i32 vcc, 1, v11
    v_cmp_gt_i32 s[18:19], 1, v11
    s_and_b64 vcc, vcc, s[20:21]
    s_and_b64 s[18:19], s[18:19], s[20:21]
    s_and_b64 s[20:21], vcc, s[38:39]
    v_cndmask_b32 v201, v12, 0, vcc
    s_waitcnt lgkmcnt(0)
    v_mfma_f32_16x16x32_bf16 v[56:59], a[32:35], v[20:23], v[56:59]
    ds_read_b128 v[36:39], v253 offset:15360
    v_mfma_f32_16x16x32_bf16 v[60:63], a[32:35], v[24:27], v[60:63]
    ds_read_b128 v[40:43], v253 offset:16384
    v_mfma_f32_16x16x32_bf16 v[64:67], a[32:35], v[28:31], v[64:67]
    ds_read_b128 v[44:47], v253 offset:17408
    v_mfma_f32_16x16x32_bf16 v[68:71], a[32:35], v[32:35], v[68:71]
    ds_read_b128 v[48:51], v253 offset:18432
    v_mfma_f32_16x16x32_bf16 v[72:75], a[36:39], v[16:19], v[72:75]
    ds_read_b128 v[52:55], v253 offset:19456
    v_mfma_f32_16x16x32_bf16 v[76:79], a[36:39], v[20:23], v[76:79]
    s_add_u32 m0, s25, 50176
    s_nop 0
    buffer_load_dwordx4 v2, s[8:11], s24 offen offset:1024 sc1 lds
    v_mfma_f32_16x16x32_bf16 v[80:83], a[36:39], v[24:27], v[80:83]
    v_cndmask_b32 v205, v12, 0, s[18:19]
    v_cndmask_b32 v209, v12, 0, s[20:21]
    v_mfma_f32_16x16x32_bf16 v[84:87], a[36:39], v[28:31], v[84:87]
    s_add_u32 m0, s25, 54784
    s_nop 0
    buffer_load_dwordx4 v2, s[8:11], s24 offen offset:1536 sc1 lds
    v_mfma_f32_16x16x32_bf16 v[88:91], a[36:39], v[32:35], v[88:91]
    v_add_u32 v11, 2, v10
    v_and_b32 v13, 1, v11
    v_mfma_f32_16x16x32_bf16 v[92:95], v[16:19], a[40:43], v[92:95]
    buffer_load_dwordx4 a[8:11], v253, s[8:11], s28 offen offset:2048 sc1
    v_mfma_f32_16x16x32_bf16 v[96:99], v[20:23], a[40:43], v[96:99]
    v_cmp_eq_u32 s[20:21], 0, v13
    v_cmp_lt_i32 vcc, 1, v11
    v_cmp_gt_i32 s[18:19], 1, v11
    s_and_b64 vcc, vcc, s[20:21]
    s_and_b64 s[18:19], s[18:19], s[20:21]
    s_and_b64 s[20:21], vcc, s[38:39]
    v_cndmask_b32 v202, v12, 0, vcc
    v_cndmask_b32 v206, v12, 0, s[18:19]
    v_mfma_f32_16x16x32_bf16 v[100:103], v[24:27], a[40:43], v[100:103]
    buffer_load_dwordx4 a[12:15], v229, s[8:11], s28 offen offset:3072 sc1
    s_add_u32 s28, s28, 4096
    v_mfma_f32_16x16x32_bf16 v[104:107], v[28:31], a[40:43], v[104:107]
    v_cndmask_b32 v210, v12, 0, s[20:21]
    v_add_u32 v11, 3, v10
    v_mfma_f32_16x16x32_bf16 v[108:111], v[32:35], a[40:43], v[108:111]
    buffer_load_dwordx4 a[16:19], v253, s[8:11], s28 offen offset:0 sc1
    v_mfma_f32_16x16x32_bf16 v[112:115], a[44:47], v[16:19], v[112:115]
    v_and_b32 v13, 1, v11
    v_cmp_eq_u32 s[20:21], 0, v13
    v_cmp_lt_i32 vcc, 1, v11
    v_cmp_gt_i32 s[18:19], 1, v11
    s_and_b64 vcc, vcc, s[20:21]
    s_and_b64 s[18:19], s[18:19], s[20:21]
    s_and_b64 s[20:21], vcc, s[38:39]
    v_cndmask_b32 v203, v12, 0, vcc
    v_mfma_f32_16x16x32_bf16 v[116:119], a[44:47], v[20:23], v[116:119]
    v_cndmask_b32 v207, v12, 0, s[18:19]
    v_cndmask_b32 v211, v12, 0, s[20:21]
    v_mfma_f32_16x16x32_bf16 v[120:123], a[44:47], v[24:27], v[120:123]
    s_lshl_b32 s45, s41, 1
    s_lshr_b32 s7, s40, 2
    s_add_u32 s45, s45, s7
    s_mul_i32 s30, s45, 36864
    s_add_u32 s30, s30, s43
    s_and_b32 s31, s40, 3
    s_mul_i32 s31, s31, 9
    s_add_u32 s31, s31, s3
    s_mul_i32 s32, s31, 18432
    s_add_u32 s32, s32, 2359296
    s_add_u32 s33, s32, 73728
    s_add_u32 s34, s32, 147456
    s_mov_b32 s39, 19496960
    v_min_u32 v228, 44, v0
    v_lshlrev_b32 v228, 3, v228
    v_mfma_f32_16x16x32_bf16 v[124:127], a[44:47], v[28:31], v[124:127]
    s_cmp_eq_u32 s3, 1
    s_cmov_b32 s34, 3022848
    s_cmp_lt_u32 s3, 2
    s_cselect_b32 s35, 0, 1073741824
    v_add_u32 v5, s35, v253
    s_cmp_eq_u32 s3, 1
    s_cselect_b32 s7, 8, 0
    v_and_b32 v10, s7, v0
    v_mfma_f32_16x16x32_bf16 v[128:131], a[44:47], v[32:35], v[128:131]
    v_lshl_add_u32 v5, v10, 27, v5
    s_cmp_eq_u32 s3, 0
    s_cselect_b32 s35, 0, 1073741824
    v_add_u32 v7, s35, v9
    s_waitcnt lgkmcnt(0)
    v_mfma_f32_16x16x32_bf16 v[56:59], a[48:51], v[40:43], v[56:59]
    ds_read_b128 v[16:19], v253 offset:20480
    v_mfma_f32_16x16x32_bf16 v[60:63], a[48:51], v[44:47], v[60:63]
    ds_read_b128 v[20:23], v253 offset:21504
    v_mfma_f32_16x16x32_bf16 v[64:67], a[48:51], v[48:51], v[64:67]
    ds_read_b128 v[24:27], v253 offset:22528
    v_mfma_f32_16x16x32_bf16 v[68:71], a[48:51], v[52:55], v[68:71]
    ds_read_b128 v[28:31], v253 offset:23552
    v_mfma_f32_16x16x32_bf16 v[72:75], a[52:55], v[36:39], v[72:75]
    ds_read_b128 v[32:35], v253 offset:24576
    v_mfma_f32_16x16x32_bf16 v[76:79], a[52:55], v[40:43], v[76:79]
    s_add_u32 m0, s26, 30720
    s_add_u32 s7, s27, 3072
    buffer_load_dwordx4 v2, s[8:11], s7 offen sc1 lds
    v_mfma_f32_16x16x32_bf16 v[80:83], a[52:55], v[44:47], v[80:83]
    s_lshl_b32 s7, s31, 8
    s_add_u32 s36, s30, s7
    s_add_u32 s37, s36, 43515904
    s_add_u32 s46, s36, 45875200
    s_lshl_b32 s36, s45, 7
    s_add_u32 s36, s36, s43
    s_add_u32 s36, s36, 48431104
    s_lshl_b32 s47, s45, 9
    s_add_u32 s47, s47, s43
    s_add_u32 s47, s47, 48234496
    v_bfe_u32 v10, v0, 3, 2
    v_and_b32 v8, 7, v0
    v_mfma_f32_16x16x32_bf16 v[84:87], a[52:55], v[48:51], v[84:87]
    s_add_u32 m0, s29, 30720
    s_add_u32 s7, s23, 3072
    buffer_load_dwordx4 v2, s[8:11], s7 offen sc1 lds
    v_mfma_f32_16x16x32_bf16 v[88:91], a[52:55], v[52:55], v[88:91]
    v_lshlrev_b32 v8, 2, v8
    v_lshl_add_u32 v8, v10, 7, v8
    v_mfma_f32_16x16x32_bf16 v[92:95], v[36:39], a[56:59], v[92:95]
    buffer_load_dwordx4 a[20:23], v253, s[8:11], s28 offen offset:1024 sc1
    v_mfma_f32_16x16x32_bf16 v[96:99], v[40:43], a[56:59], v[96:99]
    v_mfma_f32_16x16x32_bf16 v[100:103], v[44:47], a[56:59], v[100:103]
    buffer_load_dwordx4 a[24:27], v253, s[8:11], s28 offen offset:2048 sc1
    v_mfma_f32_16x16x32_bf16 v[104:107], v[48:51], a[56:59], v[104:107]
    v_mfma_f32_16x16x32_bf16 v[108:111], v[52:55], a[56:59], v[108:111]
    buffer_load_dwordx4 a[28:31], v229, s[8:11], s28 offen offset:3072 sc1
    s_add_u32 s28, s28, 4096
    v_mfma_f32_16x16x32_bf16 v[112:115], a[60:63], v[36:39], v[112:115]
    v_mfma_f32_16x16x32_bf16 v[116:119], a[60:63], v[40:43], v[116:119]
    v_mfma_f32_16x16x32_bf16 v[120:123], a[60:63], v[44:47], v[120:123]
    v_mfma_f32_16x16x32_bf16 v[124:127], a[60:63], v[48:51], v[124:127]
    v_mfma_f32_16x16x32_bf16 v[128:131], a[60:63], v[52:55], v[128:131]
    s_waitcnt lgkmcnt(0)
    v_mfma_f32_16x16x32_bf16 v[56:59], a[64:67], v[20:23], v[56:59]
    ds_read_b128 v[36:39], v253 offset:25600
    v_mfma_f32_16x16x32_bf16 v[60:63], a[64:67], v[24:27], v[60:63]
    ds_read_b128 v[40:43], v253 offset:26624
    v_mfma_f32_16x16x32_bf16 v[64:67], a[64:67], v[28:31], v[64:67]
    ds_read_b128 v[44:47], v253 offset:27648
    v_mfma_f32_16x16x32_bf16 v[68:71], a[64:67], v[32:35], v[68:71]
    ds_read_b128 v[48:51], v253 offset:28672
    v_mfma_f32_16x16x32_bf16 v[72:75], a[68:71], v[16:19], v[72:75]
    ds_read_b128 v[52:55], v253 offset:29696
    v_mfma_f32_16x16x32_bf16 v[76:79], a[68:71], v[20:23], v[76:79]
    buffer_load_dwordx4 a[32:35], v253, s[8:11], s28 offen offset:0 sc1
    v_mfma_f32_16x16x32_bf16 v[80:83], a[68:71], v[24:27], v[80:83]
    v_mfma_f32_16x16x32_bf16 v[84:87], a[68:71], v[28:31], v[84:87]
    buffer_load_dwordx4 a[36:39], v253, s[8:11], s28 offen offset:1024 sc1
    v_mfma_f32_16x16x32_bf16 v[88:91], a[68:71], v[32:35], v[88:91]
    v_mfma_f32_16x16x32_bf16 v[92:95], v[16:19], a[72:75], v[92:95]
    buffer_load_dwordx4 a[40:43], v253, s[8:11], s28 offen offset:2048 sc1
    v_mfma_f32_16x16x32_bf16 v[96:99], v[20:23], a[72:75], v[96:99]
    v_mfma_f32_16x16x32_bf16 v[100:103], v[24:27], a[72:75], v[100:103]
    v_mfma_f32_16x16x32_bf16 v[104:107], v[28:31], a[72:75], v[104:107]
    v_mfma_f32_16x16x32_bf16 v[108:111], v[32:35], a[72:75], v[108:111]
    v_mfma_f32_16x16x32_bf16 v[112:115], a[76:79], v[16:19], v[112:115]
    v_mfma_f32_16x16x32_bf16 v[116:119], a[76:79], v[20:23], v[116:119]
    v_mfma_f32_16x16x32_bf16 v[120:123], a[76:79], v[24:27], v[120:123]
    v_mfma_f32_16x16x32_bf16 v[124:127], a[76:79], v[28:31], v[124:127]
    v_mfma_f32_16x16x32_bf16 v[128:131], a[76:79], v[32:35], v[128:131]
    s_waitcnt vmcnt(6) lgkmcnt(0)
    s_barrier
    v_mfma_f32_16x16x32_bf16 v[56:59], a[80:83], v[40:43], v[56:59]
    ds_read_b128 v[16:19], v253 offset:30720
    v_mfma_f32_16x16x32_bf16 v[60:63], a[80:83], v[44:47], v[60:63]
    ds_read_b128 v[20:23], v253 offset:31744
    v_mfma_f32_16x16x32_bf16 v[64:67], a[80:83], v[48:51], v[64:67]
    ds_read_b128 v[24:27], v253 offset:32768
    v_mfma_f32_16x16x32_bf16 v[68:71], a[80:83], v[52:55], v[68:71]
    ds_read_b128 v[28:31], v253 offset:33792
    v_mfma_f32_16x16x32_bf16 v[72:75], a[84:87], v[36:39], v[72:75]
    ds_read_b128 v[32:35], v253 offset:34816
    v_mfma_f32_16x16x32_bf16 v[76:79], a[84:87], v[40:43], v[76:79]
    s_add_u32 m0, s25, 59392
    s_nop 0
    buffer_load_dwordx4 v2, s[8:11], s24 offen offset:2048 sc1 lds
    v_mfma_f32_16x16x32_bf16 v[80:83], a[84:87], v[44:47], v[80:83]
    v_mfma_f32_16x16x32_bf16 v[84:87], a[84:87], v[48:51], v[84:87]
    s_add_u32 m0, s25, 64000
    s_nop 0
    buffer_load_dwordx4 v2, s[8:11], s24 offen offset:2560 sc1 lds
    v_mfma_f32_16x16x32_bf16 v[88:91], a[84:87], v[52:55], v[88:91]
    v_mfma_f32_16x16x32_bf16 v[92:95], v[36:39], a[88:91], v[92:95]
    buffer_load_dwordx4 a[44:47], v229, s[8:11], s28 offen offset:3072 sc1
    s_add_u32 s28, s28, 4096
    v_mfma_f32_16x16x32_bf16 v[96:99], v[40:43], a[88:91], v[96:99]
    v_mfma_f32_16x16x32_bf16 v[100:103], v[44:47], a[88:91], v[100:103]
    buffer_load_dwordx4 a[48:51], v253, s[8:11], s28 offen offset:0 sc1
    v_mfma_f32_16x16x32_bf16 v[104:107], v[48:51], a[88:91], v[104:107]
    v_mfma_f32_16x16x32_bf16 v[108:111], v[52:55], a[88:91], v[108:111]
    buffer_load_dwordx4 a[52:55], v253, s[8:11], s28 offen offset:1024 sc1
    v_mfma_f32_16x16x32_bf16 v[112:115], a[92:95], v[36:39], v[112:115]
    v_mfma_f32_16x16x32_bf16 v[116:119], a[92:95], v[40:43], v[116:119]
    v_mfma_f32_16x16x32_bf16 v[120:123], a[92:95], v[44:47], v[120:123]
    v_mfma_f32_16x16x32_bf16 v[124:127], a[92:95], v[48:51], v[124:127]
    v_mfma_f32_16x16x32_bf16 v[128:131], a[92:95], v[52:55], v[128:131]
    s_waitcnt lgkmcnt(0)
    v_mfma_f32_16x16x32_bf16 v[56:59], a[96:99], v[20:23], v[56:59]
    ds_read_b128 v[36:39], v253 offset:35840
    v_mfma_f32_16x16x32_bf16 v[60:63], a[96:99], v[24:27], v[60:63]
    ds_read_b128 v[40:43], v253 offset:36864
    v_mfma_f32_16x16x32_bf16 v[64:67], a[96:99], v[28:31], v[64:67]
    ds_read_b128 v[44:47], v253 offset:37888
    v_mfma_f32_16x16x32_bf16 v[68:71], a[96:99], v[32:35], v[68:71]
    ds_read_b128 v[48:51], v253 offset:38912
    v_mfma_f32_16x16x32_bf16 v[72:75], a[100:103], v[16:19], v[72:75]
    ds_read_b128 v[52:55], v253 offset:39936
    v_mfma_f32_16x16x32_bf16 v[76:79], a[100:103], v[20:23], v[76:79]
    s_add_u32 m0, s25, 68608
    s_nop 0
    buffer_load_dwordx4 v2, s[8:11], s24 offen offset:3072 sc1 lds
    v_mfma_f32_16x16x32_bf16 v[80:83], a[100:103], v[24:27], v[80:83]
    v_mfma_f32_16x16x32_bf16 v[84:87], a[100:103], v[28:31], v[84:87]
    s_add_u32 m0, s25, 73216
    s_nop 0
    buffer_load_dwordx4 v2, s[8:11], s24 offen offset:3584 sc1 lds
    v_mfma_f32_16x16x32_bf16 v[88:91], a[100:103], v[32:35], v[88:91]
    v_mfma_f32_16x16x32_bf16 v[92:95], v[16:19], a[104:107], v[92:95]
    buffer_load_dwordx4 a[56:59], v253, s[8:11], s28 offen offset:2048 sc1
    v_mfma_f32_16x16x32_bf16 v[96:99], v[20:23], a[104:107], v[96:99]
    v_mfma_f32_16x16x32_bf16 v[100:103], v[24:27], a[104:107], v[100:103]
    buffer_load_dwordx4 a[60:63], v229, s[8:11], s28 offen offset:3072 sc1
    s_add_u32 s28, s28, 4096
    v_mfma_f32_16x16x32_bf16 v[104:107], v[28:31], a[104:107], v[104:107]
    v_mfma_f32_16x16x32_bf16 v[108:111], v[32:35], a[104:107], v[108:111]
    buffer_load_dwordx4 a[64:67], v253, s[8:11], s28 offen offset:0 sc1
    v_mfma_f32_16x16x32_bf16 v[112:115], a[108:111], v[16:19], v[112:115]
    v_mfma_f32_16x16x32_bf16 v[116:119], a[108:111], v[20:23], v[116:119]
    buffer_load_dwordx2 v[226:227], v228, s[8:11], s39 offen sc1
    v_mfma_f32_16x16x32_bf16 v[120:123], a[108:111], v[24:27], v[120:123]
    v_mfma_f32_16x16x32_bf16 v[124:127], a[108:111], v[28:31], v[124:127]
    v_mfma_f32_16x16x32_bf16 v[128:131], a[108:111], v[32:35], v[128:131]
    s_waitcnt lgkmcnt(0)
    v_mfma_f32_16x16x32_bf16 v[56:59], a[112:115], v[40:43], v[56:59]
    ds_read_b128 v[16:19], v253 offset:40960
    v_mfma_f32_16x16x32_bf16 v[60:63], a[112:115], v[44:47], v[60:63]
    ds_read_b128 v[20:23], v253 offset:41984
    v_mfma_f32_16x16x32_bf16 v[64:67], a[112:115], v[48:51], v[64:67]
    ds_read_b128 v[24:27], v253 offset:43008
    v_mfma_f32_16x16x32_bf16 v[68:71], a[112:115], v[52:55], v[68:71]
    ds_read_b128 v[28:31], v253 offset:44032
    v_mfma_f32_16x16x32_bf16 v[72:75], a[116:119], v[36:39], v[72:75]
    ds_read_b128 v[32:35], v253 offset:45056
    v_mfma_f32_16x16x32_bf16 v[76:79], a[116:119], v[40:43], v[76:79]
    s_add_u32 m0, s25, 81920
    s_add_u32 s24, s24, 4096
    buffer_load_dwordx4 v2, s[8:11], s24 offen offset:0 sc1 lds
    v_mfma_f32_16x16x32_bf16 v[80:83], a[116:119], v[44:47], v[80:83]
    v_mfma_f32_16x16x32_bf16 v[84:87], a[116:119], v[48:51], v[84:87]
    s_add_u32 m0, s25, 86528
    s_nop 0
    buffer_load_dwordx4 v2, s[8:11], s24 offen offset:512 sc1 lds
    v_mfma_f32_16x16x32_bf16 v[88:91], a[116:119], v[52:55], v[88:91]
    v_mfma_f32_16x16x32_bf16 v[92:95], v[36:39], a[120:123], v[92:95]
    buffer_load_dwordx4 a[68:71], v253, s[8:11], s28 offen offset:1024 sc1
    v_mfma_f32_16x16x32_bf16 v[96:99], v[40:43], a[120:123], v[96:99]
    v_mfma_f32_16x16x32_bf16 v[100:103], v[44:47], a[120:123], v[100:103]
    buffer_load_dwordx4 a[72:75], v253, s[8:11], s28 offen offset:2048 sc1
    v_mfma_f32_16x16x32_bf16 v[104:107], v[48:51], a[120:123], v[104:107]
    v_mfma_f32_16x16x32_bf16 v[108:111], v[52:55], a[120:123], v[108:111]
    buffer_load_dwordx4 a[76:79], v229, s[8:11], s28 offen offset:3072 sc1
    s_add_u32 s28, s28, 4096
    v_mfma_f32_16x16x32_bf16 v[112:115], a[124:127], v[36:39], v[112:115]
    v_mfma_f32_16x16x32_bf16 v[116:119], a[124:127], v[40:43], v[116:119]
    v_mfma_f32_16x16x32_bf16 v[120:123], a[124:127], v[44:47], v[120:123]
    v_mfma_f32_16x16x32_bf16 v[124:127], a[124:127], v[48:51], v[124:127]
    v_mfma_f32_16x16x32_bf16 v[128:131], a[124:127], v[52:55], v[128:131]
    s_waitcnt lgkmcnt(0)
    v_mfma_f32_16x16x32_bf16 v[56:59], a[128:131], v[20:23], v[56:59]
    ds_read_b128 v[36:39], v6 offset:0
    v_mfma_f32_16x16x32_bf16 v[60:63], a[128:131], v[24:27], v[60:63]
    ds_read_b128 v[40:43], v6 offset:1024
    v_mfma_f32_16x16x32_bf16 v[64:67], a[128:131], v[28:31], v[64:67]
    ds_read_b128 v[44:47], v6 offset:2048
    v_mfma_f32_16x16x32_bf16 v[68:71], a[128:131], v[32:35], v[68:71]
    ds_read_b128 v[48:51], v6 offset:3072
    v_mfma_f32_16x16x32_bf16 v[72:75], a[132:135], v[16:19], v[72:75]
    ds_read_b128 v[52:55], v6 offset:4096
    v_mfma_f32_16x16x32_bf16 v[76:79], a[132:135], v[20:23], v[76:79]
    s_add_u32 m0, s26, 61440
    s_add_u32 s7, s27, 6144
    buffer_load_dwordx4 v2, s[8:11], s7 offen sc1 lds
    v_mfma_f32_16x16x32_bf16 v[80:83], a[132:135], v[24:27], v[80:83]
    v_mfma_f32_16x16x32_bf16 v[84:87], a[132:135], v[28:31], v[84:87]
    s_add_u32 m0, s29, 61440
    s_add_u32 s7, s23, 6144
    buffer_load_dwordx4 v2, s[8:11], s7 offen sc1 lds
    v_mfma_f32_16x16x32_bf16 v[88:91], a[132:135], v[32:35], v[88:91]
    v_mfma_f32_16x16x32_bf16 v[92:95], v[16:19], a[136:139], v[92:95]
    buffer_load_dwordx4 a[80:83], v253, s[8:11], s28 offen offset:0 sc1
    v_mfma_f32_16x16x32_bf16 v[96:99], v[20:23], a[136:139], v[96:99]
    v_mfma_f32_16x16x32_bf16 v[100:103], v[24:27], a[136:139], v[100:103]
    buffer_load_dwordx4 a[84:87], v253, s[8:11], s28 offen offset:1024 sc1
    v_mfma_f32_16x16x32_bf16 v[104:107], v[28:31], a[136:139], v[104:107]
    v_mfma_f32_16x16x32_bf16 v[108:111], v[32:35], a[136:139], v[108:111]
    buffer_load_dwordx4 a[88:91], v253, s[8:11], s28 offen offset:2048 sc1
    v_mfma_f32_16x16x32_bf16 v[112:115], a[140:143], v[16:19], v[112:115]
    v_mfma_f32_16x16x32_bf16 v[116:119], a[140:143], v[20:23], v[116:119]
    v_mfma_f32_16x16x32_bf16 v[120:123], a[140:143], v[24:27], v[120:123]
    v_mfma_f32_16x16x32_bf16 v[124:127], a[140:143], v[28:31], v[124:127]
    v_mfma_f32_16x16x32_bf16 v[128:131], a[140:143], v[32:35], v[128:131]
    s_waitcnt vmcnt(10) lgkmcnt(0)
    s_mov_b32 s6, 0
L_wo_poll_21:
    v_cmp_eq_u32 vcc, s76, v226
    v_cmp_eq_u32 s[20:21], s76, v227
    s_and_b64 vcc, vcc, s[20:21]
    s_cmp_eq_u64 vcc, exec
    s_cbranch_scc1 L_wo_ready_22
    buffer_load_dwordx2 v[226:227], v228, s[8:11], s39 offen sc1
    s_add_u32 s6, s6, 1
    s_cmp_lt_u32 s6, 1048576
    s_waitcnt vmcnt(0)
    s_cbranch_scc1 L_wo_poll_21
    s_branch L_main_end
L_wo_ready_22:
    v_mfma_f32_16x16x32_bf16 v[56:59], a[144:147], v[40:43], v[56:59]
    ds_read_b128 v[16:19], v6 offset:5120
    v_mfma_f32_16x16x32_bf16 v[60:63], a[144:147], v[44:47], v[60:63]
    ds_read_b128 v[20:23], v6 offset:6144
    v_mfma_f32_16x16x32_bf16 v[64:67], a[144:147], v[48:51], v[64:67]
    ds_read_b128 v[24:27], v6 offset:7168
    v_mfma_f32_16x16x32_bf16 v[68:71], a[144:147], v[52:55], v[68:71]
    ds_read_b128 v[28:31], v6 offset:8192
    v_mfma_f32_16x16x32_bf16 v[72:75], a[148:151], v[36:39], v[72:75]
    ds_read_b128 v[32:35], v6 offset:9216
    v_mfma_f32_16x16x32_bf16 v[76:79], a[148:151], v[40:43], v[76:79]
    buffer_load_dwordx4 a[92:95], v229, s[8:11], s28 offen offset:3072 sc1
    s_add_u32 s28, s28, 4096
    v_mfma_f32_16x16x32_bf16 v[80:83], a[148:151], v[44:47], v[80:83]
    v_mfma_f32_16x16x32_bf16 v[84:87], a[148:151], v[48:51], v[84:87]
    buffer_load_dwordx4 a[96:99], v253, s[8:11], s28 offen offset:0 sc1
    v_mfma_f32_16x16x32_bf16 v[88:91], a[148:151], v[52:55], v[88:91]
    v_mfma_f32_16x16x32_bf16 v[92:95], v[36:39], a[152:155], v[92:95]
    buffer_load_dwordx4 a[100:103], v253, s[8:11], s28 offen offset:1024 sc1
    v_mfma_f32_16x16x32_bf16 v[96:99], v[40:43], a[152:155], v[96:99]
    v_mfma_f32_16x16x32_bf16 v[100:103], v[44:47], a[152:155], v[100:103]
    buffer_load_dwordx4 a[160:163], v253, s[8:11], s32 offen offset:0 sc1
    v_mfma_f32_16x16x32_bf16 v[104:107], v[48:51], a[152:155], v[104:107]
    v_mfma_f32_16x16x32_bf16 v[108:111], v[52:55], a[152:155], v[108:111]
    v_mfma_f32_16x16x32_bf16 v[112:115], a[156:159], v[36:39], v[112:115]
    v_mfma_f32_16x16x32_bf16 v[116:119], a[156:159], v[40:43], v[116:119]
    v_mfma_f32_16x16x32_bf16 v[120:123], a[156:159], v[44:47], v[120:123]
    v_mfma_f32_16x16x32_bf16 v[124:127], a[156:159], v[48:51], v[124:127]
    v_mfma_f32_16x16x32_bf16 v[128:131], a[156:159], v[52:55], v[128:131]
    s_waitcnt vmcnt(34) lgkmcnt(0)
    v_mfma_f32_16x16x32_bf16 v[56:59], a[0:3], v[20:23], v[56:59]
    ds_read_b128 v[36:39], v6 offset:10240
    v_mfma_f32_16x16x32_bf16 v[60:63], a[0:3], v[24:27], v[60:63]
    ds_read_b128 v[40:43], v6 offset:11264
    v_mfma_f32_16x16x32_bf16 v[64:67], a[0:3], v[28:31], v[64:67]
    ds_read_b128 v[44:47], v6 offset:12288
    v_mfma_f32_16x16x32_bf16 v[68:71], a[0:3], v[32:35], v[68:71]
    ds_read_b128 v[48:51], v6 offset:13312
    v_mfma_f32_16x16x32_bf16 v[72:75], a[4:7], v[16:19], v[72:75]
    ds_read_b128 v[52:55], v6 offset:14336
    v_mfma_f32_16x16x32_bf16 v[76:79], a[4:7], v[20:23], v[76:79]
    buffer_load_dwordx4 a[104:107], v253, s[8:11], s28 offen offset:2048 sc1
    v_mfma_f32_16x16x32_bf16 v[80:83], a[4:7], v[24:27], v[80:83]
    v_mfma_f32_16x16x32_bf16 v[84:87], a[4:7], v[28:31], v[84:87]
    buffer_load_dwordx4 a[108:111], v229, s[8:11], s28 offen offset:3072 sc1
    s_add_u32 s28, s28, 4096
    v_mfma_f32_16x16x32_bf16 v[88:91], a[4:7], v[32:35], v[88:91]
    v_mfma_f32_16x16x32_bf16 v[92:95], v[16:19], a[8:11], v[92:95]
    buffer_load_dwordx4 a[112:115], v253, s[8:11], s28 offen offset:0 sc1
    v_mfma_f32_16x16x32_bf16 v[96:99], v[20:23], a[8:11], v[96:99]
    v_mfma_f32_16x16x32_bf16 v[100:103], v[24:27], a[8:11], v[100:103]
    buffer_load_dwordx4 a[164:167], v253, s[8:11], s33 offen offset:0 sc1
    v_mfma_f32_16x16x32_bf16 v[104:107], v[28:31], a[8:11], v[104:107]
    v_mfma_f32_16x16x32_bf16 v[108:111], v[32:35], a[8:11], v[108:111]
    v_mfma_f32_16x16x32_bf16 v[112:115], a[12:15], v[16:19], v[112:115]
    v_mfma_f32_16x16x32_bf16 v[116:119], a[12:15], v[20:23], v[116:119]
    v_mfma_f32_16x16x32_bf16 v[120:123], a[12:15], v[24:27], v[120:123]
    v_mfma_f32_16x16x32_bf16 v[124:127], a[12:15], v[28:31], v[124:127]
    v_mfma_f32_16x16x32_bf16 v[128:131], a[12:15], v[32:35], v[128:131]
    s_waitcnt vmcnt(11) lgkmcnt(0)
    s_barrier
    v_mfma_f32_16x16x32_bf16 v[56:59], a[16:19], v[40:43], v[56:59]
    ds_read_b128 v[16:19], v6 offset:15360
    v_mfma_f32_16x16x32_bf16 v[60:63], a[16:19], v[44:47], v[60:63]
    ds_read_b128 v[20:23], v6 offset:16384
    v_mfma_f32_16x16x32_bf16 v[64:67], a[16:19], v[48:51], v[64:67]
    ds_read_b128 v[24:27], v6 offset:17408
    v_mfma_f32_16x16x32_bf16 v[68:71], a[16:19], v[52:55], v[68:71]
    ds_read_b128 v[28:31], v6 offset:18432
    v_mfma_f32_16x16x32_bf16 v[72:75], a[20:23], v[36:39], v[72:75]
    ds_read_b128 v[32:35], v6 offset:19456
    v_mfma_f32_16x16x32_bf16 v[76:79], a[20:23], v[40:43], v[76:79]
    buffer_load_dwordx4 a[116:119], v253, s[8:11], s28 offen offset:1024 sc1
    v_mfma_f32_16x16x32_bf16 v[80:83], a[20:23], v[44:47], v[80:83]
    v_mfma_f32_16x16x32_bf16 v[84:87], a[20:23], v[48:51], v[84:87]
    buffer_load_dwordx4 a[120:123], v253, s[8:11], s28 offen offset:2048 sc1
    v_mfma_f32_16x16x32_bf16 v[88:91], a[20:23], v[52:55], v[88:91]
    v_mfma_f32_16x16x32_bf16 v[92:95], v[36:39], a[24:27], v[92:95]
    buffer_load_dwordx4 a[124:127], v229, s[8:11], s28 offen offset:3072 sc1
    s_add_u32 s28, s28, 4096
    v_mfma_f32_16x16x32_bf16 v[96:99], v[40:43], a[24:27], v[96:99]
    v_mfma_f32_16x16x32_bf16 v[100:103], v[44:47], a[24:27], v[100:103]
    buffer_load_dwordx4 a[168:171], v5, s[8:11], s34 offen offset:0 sc1
    v_mfma_f32_16x16x32_bf16 v[104:107], v[48:51], a[24:27], v[104:107]
    v_mfma_f32_16x16x32_bf16 v[108:111], v[52:55], a[24:27], v[108:111]
    v_mfma_f32_16x16x32_bf16 v[112:115], a[28:31], v[36:39], v[112:115]
    v_mfma_f32_16x16x32_bf16 v[116:119], a[28:31], v[40:43], v[116:119]
    v_mfma_f32_16x16x32_bf16 v[120:123], a[28:31], v[44:47], v[120:123]
    v_mfma_f32_16x16x32_bf16 v[124:127], a[28:31], v[48:51], v[124:127]
    v_mfma_f32_16x16x32_bf16 v[128:131], a[28:31], v[52:55], v[128:131]
    s_waitcnt vmcnt(30) lgkmcnt(0)
    v_mfma_f32_16x16x32_bf16 v[56:59], a[32:35], v[20:23], v[56:59]
    ds_read_b128 v[36:39], v6 offset:20480
    v_mfma_f32_16x16x32_bf16 v[60:63], a[32:35], v[24:27], v[60:63]
    ds_read_b128 v[40:43], v6 offset:21504
    v_mfma_f32_16x16x32_bf16 v[64:67], a[32:35], v[28:31], v[64:67]
    ds_read_b128 v[44:47], v6 offset:22528
    v_mfma_f32_16x16x32_bf16 v[68:71], a[32:35], v[32:35], v[68:71]
    ds_read_b128 v[48:51], v6 offset:23552
    v_mfma_f32_16x16x32_bf16 v[72:75], a[36:39], v[16:19], v[72:75]
    ds_read_b128 v[52:55], v6 offset:24576
    v_mfma_f32_16x16x32_bf16 v[76:79], a[36:39], v[20:23], v[76:79]
    buffer_load_dwordx4 a[172:175], v253, s[8:11], s32 offen offset:1024 sc1
    v_mfma_f32_16x16x32_bf16 v[80:83], a[36:39], v[24:27], v[80:83]
    v_mfma_f32_16x16x32_bf16 v[84:87], a[36:39], v[28:31], v[84:87]
    buffer_load_dwordx4 a[176:179], v253, s[8:11], s33 offen offset:1024 sc1
    v_mfma_f32_16x16x32_bf16 v[88:91], a[36:39], v[32:35], v[88:91]
    v_mfma_f32_16x16x32_bf16 v[92:95], v[16:19], a[40:43], v[92:95]
    buffer_load_dwordx4 a[180:183], v5, s[8:11], s34 offen offset:1024 sc1
    v_mfma_f32_16x16x32_bf16 v[96:99], v[20:23], a[40:43], v[96:99]
    v_mfma_f32_16x16x32_bf16 v[100:103], v[24:27], a[40:43], v[100:103]
    buffer_load_dwordx4 a[184:187], v253, s[8:11], s32 offen offset:2048 sc1
    v_mfma_f32_16x16x32_bf16 v[104:107], v[28:31], a[40:43], v[104:107]
    v_mfma_f32_16x16x32_bf16 v[108:111], v[32:35], a[40:43], v[108:111]
    v_mfma_f32_16x16x32_bf16 v[112:115], a[44:47], v[16:19], v[112:115]
    v_mfma_f32_16x16x32_bf16 v[116:119], a[44:47], v[20:23], v[116:119]
    v_mfma_f32_16x16x32_bf16 v[120:123], a[44:47], v[24:27], v[120:123]
    v_mfma_f32_16x16x32_bf16 v[124:127], a[44:47], v[28:31], v[124:127]
    v_mfma_f32_16x16x32_bf16 v[128:131], a[44:47], v[32:35], v[128:131]
    s_waitcnt vmcnt(28) lgkmcnt(0)
    v_mfma_f32_16x16x32_bf16 v[56:59], a[48:51], v[40:43], v[56:59]
    ds_read_b128 v[16:19], v6 offset:25600
    v_mfma_f32_16x16x32_bf16 v[60:63], a[48:51], v[44:47], v[60:63]
    ds_read_b128 v[20:23], v6 offset:26624
    v_mfma_f32_16x16x32_bf16 v[64:67], a[48:51], v[48:51], v[64:67]
    ds_read_b128 v[24:27], v6 offset:27648
    v_mfma_f32_16x16x32_bf16 v[68:71], a[48:51], v[52:55], v[68:71]
    ds_read_b128 v[28:31], v6 offset:28672
    v_mfma_f32_16x16x32_bf16 v[72:75], a[52:55], v[36:39], v[72:75]
    ds_read_b128 v[32:35], v6 offset:29696
    v_mfma_f32_16x16x32_bf16 v[76:79], a[52:55], v[40:43], v[76:79]
    buffer_load_dwordx4 a[188:191], v253, s[8:11], s33 offen offset:2048 sc1
    v_mfma_f32_16x16x32_bf16 v[80:83], a[52:55], v[44:47], v[80:83]
    v_mfma_f32_16x16x32_bf16 v[84:87], a[52:55], v[48:51], v[84:87]
    buffer_load_dwordx4 a[192:195], v5, s[8:11], s34 offen offset:2048 sc1
    v_mfma_f32_16x16x32_bf16 v[88:91], a[52:55], v[52:55], v[88:91]
    v_mfma_f32_16x16x32_bf16 v[92:95], v[36:39], a[56:59], v[92:95]
    buffer_load_dwordx4 a[196:199], v253, s[8:11], s32 offen offset:3072 sc1
    s_add_u32 s32, s32, 4096
    v_mfma_f32_16x16x32_bf16 v[96:99], v[40:43], a[56:59], v[96:99]
    v_mfma_f32_16x16x32_bf16 v[100:103], v[44:47], a[56:59], v[100:103]
    buffer_load_dwordx4 a[200:203], v253, s[8:11], s33 offen offset:3072 sc1
    s_add_u32 s33, s33, 4096
    v_mfma_f32_16x16x32_bf16 v[104:107], v[48:51], a[56:59], v[104:107]
    v_mfma_f32_16x16x32_bf16 v[108:111], v[52:55], a[56:59], v[108:111]
    v_mfma_f32_16x16x32_bf16 v[112:115], a[60:63], v[36:39], v[112:115]
    v_mfma_f32_16x16x32_bf16 v[116:119], a[60:63], v[40:43], v[116:119]
    v_mfma_f32_16x16x32_bf16 v[120:123], a[60:63], v[44:47], v[120:123]
    v_mfma_f32_16x16x32_bf16 v[124:127], a[60:63], v[48:51], v[124:127]
    v_mfma_f32_16x16x32_bf16 v[128:131], a[60:63], v[52:55], v[128:131]
    s_waitcnt vmcnt(25) lgkmcnt(0)
    v_mfma_f32_16x16x32_bf16 v[56:59], a[64:67], v[20:23], v[56:59]
    ds_read_b128 v[36:39], v6 offset:30720
    v_mfma_f32_16x16x32_bf16 v[60:63], a[64:67], v[24:27], v[60:63]
    ds_read_b128 v[40:43], v6 offset:31744
    v_mfma_f32_16x16x32_bf16 v[64:67], a[64:67], v[28:31], v[64:67]
    ds_read_b128 v[44:47], v6 offset:32768
    v_mfma_f32_16x16x32_bf16 v[68:71], a[64:67], v[32:35], v[68:71]
    ds_read_b128 v[48:51], v6 offset:33792
    v_mfma_f32_16x16x32_bf16 v[72:75], a[68:71], v[16:19], v[72:75]
    ds_read_b128 v[52:55], v6 offset:34816
    v_mfma_f32_16x16x32_bf16 v[76:79], a[68:71], v[20:23], v[76:79]
    buffer_load_dwordx4 a[204:207], v5, s[8:11], s34 offen offset:3072 sc1
    s_add_u32 s34, s34, 4096
    v_mfma_f32_16x16x32_bf16 v[80:83], a[68:71], v[24:27], v[80:83]
    v_mfma_f32_16x16x32_bf16 v[84:87], a[68:71], v[28:31], v[84:87]
    buffer_load_dwordx4 a[208:211], v253, s[8:11], s32 offen offset:0 sc1
    v_mfma_f32_16x16x32_bf16 v[88:91], a[68:71], v[32:35], v[88:91]
    v_mfma_f32_16x16x32_bf16 v[92:95], v[16:19], a[72:75], v[92:95]
    buffer_load_dwordx4 a[212:215], v253, s[8:11], s33 offen offset:0 sc1
    v_mfma_f32_16x16x32_bf16 v[96:99], v[20:23], a[72:75], v[96:99]
    v_mfma_f32_16x16x32_bf16 v[100:103], v[24:27], a[72:75], v[100:103]
    buffer_load_dwordx4 a[216:219], v5, s[8:11], s34 offen offset:0 sc1
    v_mfma_f32_16x16x32_bf16 v[104:107], v[28:31], a[72:75], v[104:107]
    v_mfma_f32_16x16x32_bf16 v[108:111], v[32:35], a[72:75], v[108:111]
    v_mfma_f32_16x16x32_bf16 v[112:115], a[76:79], v[16:19], v[112:115]
    v_mfma_f32_16x16x32_bf16 v[116:119], a[76:79], v[20:23], v[116:119]
    v_mfma_f32_16x16x32_bf16 v[120:123], a[76:79], v[24:27], v[120:123]
    v_mfma_f32_16x16x32_bf16 v[124:127], a[76:79], v[28:31], v[124:127]
    v_mfma_f32_16x16x32_bf16 v[128:131], a[76:79], v[32:35], v[128:131]
    s_waitcnt vmcnt(23) lgkmcnt(0)
    v_mfma_f32_16x16x32_bf16 v[56:59], a[80:83], v[40:43], v[56:59]
    ds_read_b128 v[16:19], v6 offset:35840
    v_mfma_f32_16x16x32_bf16 v[60:63], a[80:83], v[44:47], v[60:63]
    ds_read_b128 v[20:23], v6 offset:36864
    v_mfma_f32_16x16x32_bf16 v[64:67], a[80:83], v[48:51], v[64:67]
    ds_read_b128 v[24:27], v6 offset:37888
    v_mfma_f32_16x16x32_bf16 v[68:71], a[80:83], v[52:55], v[68:71]
    ds_read_b128 v[28:31], v6 offset:38912
    v_mfma_f32_16x16x32_bf16 v[72:75], a[84:87], v[36:39], v[72:75]
    ds_read_b128 v[32:35], v6 offset:39936
    v_mfma_f32_16x16x32_bf16 v[76:79], a[84:87], v[40:43], v[76:79]
    buffer_load_dwordx4 a[220:223], v253, s[8:11], s32 offen offset:1024 sc1
    v_mfma_f32_16x16x32_bf16 v[80:83], a[84:87], v[44:47], v[80:83]
    v_mfma_f32_16x16x32_bf16 v[84:87], a[84:87], v[48:51], v[84:87]
    buffer_load_dwordx4 a[224:227], v253, s[8:11], s33 offen offset:1024 sc1
    v_mfma_f32_16x16x32_bf16 v[88:91], a[84:87], v[52:55], v[88:91]
    v_mfma_f32_16x16x32_bf16 v[92:95], v[36:39], a[88:91], v[92:95]
    buffer_load_dwordx4 a[228:231], v5, s[8:11], s34 offen offset:1024 sc1
    v_mfma_f32_16x16x32_bf16 v[96:99], v[40:43], a[88:91], v[96:99]
    v_mfma_f32_16x16x32_bf16 v[100:103], v[44:47], a[88:91], v[100:103]
    buffer_load_dwordx4 a[232:235], v253, s[8:11], s32 offen offset:2048 sc1
    v_mfma_f32_16x16x32_bf16 v[104:107], v[48:51], a[88:91], v[104:107]
    v_mfma_f32_16x16x32_bf16 v[108:111], v[52:55], a[88:91], v[108:111]
    v_mfma_f32_16x16x32_bf16 v[112:115], a[92:95], v[36:39], v[112:115]
    v_mfma_f32_16x16x32_bf16 v[116:119], a[92:95], v[40:43], v[116:119]
    v_mfma_f32_16x16x32_bf16 v[120:123], a[92:95], v[44:47], v[120:123]
    v_mfma_f32_16x16x32_bf16 v[124:127], a[92:95], v[48:51], v[124:127]
    v_mfma_f32_16x16x32_bf16 v[128:131], a[92:95], v[52:55], v[128:131]
    s_waitcnt vmcnt(22) lgkmcnt(0)
    v_mfma_f32_16x16x32_bf16 v[56:59], a[96:99], v[20:23], v[56:59]
    ds_read_b128 v[36:39], v6 offset:40960
    v_mfma_f32_16x16x32_bf16 v[60:63], a[96:99], v[24:27], v[60:63]
    ds_read_b128 v[40:43], v6 offset:41984
    v_mfma_f32_16x16x32_bf16 v[64:67], a[96:99], v[28:31], v[64:67]
    ds_read_b128 v[44:47], v6 offset:43008
    v_mfma_f32_16x16x32_bf16 v[68:71], a[96:99], v[32:35], v[68:71]
    ds_read_b128 v[48:51], v6 offset:44032
    v_mfma_f32_16x16x32_bf16 v[72:75], a[100:103], v[16:19], v[72:75]
    ds_read_b128 v[52:55], v6 offset:45056
    v_mfma_f32_16x16x32_bf16 v[76:79], a[100:103], v[20:23], v[76:79]
    buffer_load_dwordx4 a[236:239], v253, s[8:11], s33 offen offset:2048 sc1
    v_mfma_f32_16x16x32_bf16 v[80:83], a[100:103], v[24:27], v[80:83]
    v_mfma_f32_16x16x32_bf16 v[84:87], a[100:103], v[28:31], v[84:87]
    buffer_load_dwordx4 a[240:243], v5, s[8:11], s34 offen offset:2048 sc1
    v_mfma_f32_16x16x32_bf16 v[88:91], a[100:103], v[32:35], v[88:91]
    v_mfma_f32_16x16x32_bf16 v[92:95], v[16:19], a[104:107], v[92:95]
    buffer_load_dwordx4 a[244:247], v253, s[8:11], s32 offen offset:3072 sc1
    s_add_u32 s32, s32, 4096
    v_mfma_f32_16x16x32_bf16 v[96:99], v[20:23], a[104:107], v[96:99]
    v_mfma_f32_16x16x32_bf16 v[100:103], v[24:27], a[104:107], v[100:103]
    buffer_load_dwordx4 a[248:251], v253, s[8:11], s33 offen offset:3072 sc1
    s_add_u32 s33, s33, 4096
    v_mfma_f32_16x16x32_bf16 v[104:107], v[28:31], a[104:107], v[104:107]
    v_mfma_f32_16x16x32_bf16 v[108:111], v[32:35], a[104:107], v[108:111]
    v_mfma_f32_16x16x32_bf16 v[112:115], a[108:111], v[16:19], v[112:115]
    v_mfma_f32_16x16x32_bf16 v[116:119], a[108:111], v[20:23], v[116:119]
    v_mfma_f32_16x16x32_bf16 v[120:123], a[108:111], v[24:27], v[120:123]
    v_mfma_f32_16x16x32_bf16 v[124:127], a[108:111], v[28:31], v[124:127]
    v_mfma_f32_16x16x32_bf16 v[128:131], a[108:111], v[32:35], v[128:131]
    s_waitcnt vmcnt(21) lgkmcnt(0)
    v_mfma_f32_16x16x32_bf16 v[56:59], a[112:115], v[40:43], v[56:59]
    v_mfma_f32_16x16x32_bf16 v[60:63], a[112:115], v[44:47], v[60:63]
    v_mfma_f32_16x16x32_bf16 v[64:67], a[112:115], v[48:51], v[64:67]
    v_mfma_f32_16x16x32_bf16 v[68:71], a[112:115], v[52:55], v[68:71]
    v_mfma_f32_16x16x32_bf16 v[72:75], a[116:119], v[36:39], v[72:75]
    v_mfma_f32_16x16x32_bf16 v[76:79], a[116:119], v[40:43], v[76:79]
    buffer_load_dwordx4 a[252:255], v5, s[8:11], s34 offen offset:3072 sc1
    s_add_u32 s34, s34, 4096
    v_mfma_f32_16x16x32_bf16 v[80:83], a[116:119], v[44:47], v[80:83]
    v_mfma_f32_16x16x32_bf16 v[84:87], a[116:119], v[48:51], v[84:87]
    buffer_load_dwordx4 a[128:131], v253, s[8:11], s32 offen offset:0 sc1
    v_mfma_f32_16x16x32_bf16 v[88:91], a[116:119], v[52:55], v[88:91]
    v_mfma_f32_16x16x32_bf16 v[92:95], v[36:39], a[120:123], v[92:95]
    buffer_load_dwordx4 a[132:135], v253, s[8:11], s33 offen offset:0 sc1
    v_mfma_f32_16x16x32_bf16 v[96:99], v[40:43], a[120:123], v[96:99]
    v_mfma_f32_16x16x32_bf16 v[100:103], v[44:47], a[120:123], v[100:103]
    buffer_load_dwordx4 a[136:139], v5, s[8:11], s34 offen offset:0 sc1
    v_mfma_f32_16x16x32_bf16 v[104:107], v[48:51], a[120:123], v[104:107]
    v_mfma_f32_16x16x32_bf16 v[108:111], v[52:55], a[120:123], v[108:111]
    v_mfma_f32_16x16x32_bf16 v[112:115], a[124:127], v[36:39], v[112:115]
    v_mfma_f32_16x16x32_bf16 v[116:119], a[124:127], v[40:43], v[116:119]
    v_mfma_f32_16x16x32_bf16 v[120:123], a[124:127], v[44:47], v[120:123]
    v_mfma_f32_16x16x32_bf16 v[124:127], a[124:127], v[48:51], v[124:127]
    v_mfma_f32_16x16x32_bf16 v[128:131], a[124:127], v[52:55], v[128:131]
    v_cvt_pk_bf16_f32 v136, v56, v57
    v_cvt_pk_bf16_f32 v137, v58, v59
    v_cvt_pk_bf16_f32 v140, v60, v61
    v_cvt_pk_bf16_f32 v141, v62, v63
    v_cvt_pk_bf16_f32 v144, v64, v65
    v_cvt_pk_bf16_f32 v145, v66, v67
    v_cvt_pk_bf16_f32 v148, v68, v69
    v_cvt_pk_bf16_f32 v149, v70, v71
    v_cvt_pk_bf16_f32 v152, v72, v73
    buffer_load_dwordx4 a[140:143], v253, s[8:11], s32 offen offset:1024 sc1
    v_cvt_pk_bf16_f32 v153, v74, v75
    v_cvt_pk_bf16_f32 v156, v76, v77
    v_cvt_pk_bf16_f32 v157, v78, v79
    v_cvt_pk_bf16_f32 v160, v80, v81
    v_cvt_pk_bf16_f32 v161, v82, v83
    v_cvt_pk_bf16_f32 v164, v84, v85
    v_cvt_pk_bf16_f32 v165, v86, v87
    v_cvt_pk_bf16_f32 v168, v88, v89
    v_cvt_pk_bf16_f32 v169, v90, v91
    buffer_load_dwordx4 a[144:147], v253, s[8:11], s33 offen offset:1024 sc1
    v_cvt_pk_bf16_f32 v134, v112, v113
    v_cvt_pk_bf16_f32 v154, v114, v115
    v_cvt_pk_bf16_f32 v138, v116, v117
    v_cvt_pk_bf16_f32 v158, v118, v119
    v_cvt_pk_bf16_f32 v142, v120, v121
    v_cvt_pk_bf16_f32 v162, v122, v123
    v_cvt_pk_bf16_f32 v146, v124, v125
    v_cvt_pk_bf16_f32 v166, v126, v127
    v_cvt_pk_bf16_f32 v150, v128, v129
    buffer_load_dwordx4 a[148:151], v5, s[8:11], s34 offen offset:1024 sc1
    v_cvt_pk_bf16_f32 v170, v130, v131
    v_cvt_pk_bf16_f32 v172, v92, v93
    v_cvt_pk_bf16_f32 v173, v94, v95
    v_cvt_pk_bf16_f32 v174, v96, v97
    v_cvt_pk_bf16_f32 v175, v98, v99
    v_cvt_pk_bf16_f32 v176, v100, v101
    v_cvt_pk_bf16_f32 v177, v102, v103
    v_cvt_pk_bf16_f32 v178, v104, v105
    v_cvt_pk_bf16_f32 v179, v106, v107
    buffer_load_dwordx4 a[152:155], v253, s[8:11], s32 offen offset:2048 sc1
    v_cvt_pk_bf16_f32 v180, v108, v109
    v_cvt_pk_bf16_f32 v181, v110, v111
    v_mfma_f32_16x16x32_bf16 v[16:19], v[152:155], v[136:139], v[208:211]
    v_mfma_f32_16x16x32_bf16 v[20:23], v[156:159], v[136:139], v[204:207]
    v_mfma_f32_16x16x32_bf16 v[24:27], v[156:159], v[140:143], v[200:203]
    v_mfma_f32_16x16x32_bf16 v[28:31], v[160:163], v[140:143], v[204:207]
    v_mfma_f32_16x16x32_bf16 v[32:35], v[160:163], v[144:147], v[200:203]
    v_mfma_f32_16x16x32_bf16 v[36:39], v[164:167], v[144:147], v[204:207]
    v_mfma_f32_16x16x32_bf16 v[40:43], v[164:167], v[148:151], v[200:203]
    buffer_load_dwordx4 a[156:159], v253, s[8:11], s33 offen offset:2048 sc1
    v_mfma_f32_16x16x32_bf16 v[44:47], v[168:171], v[148:151], v[204:207]
    v_mfma_f32_16x16x32_bf16 v[56:59], v[132:135], v[192:195], v[196:199]
    v_mfma_f32_16x16x32_bf16 v[60:63], v[136:139], v[192:195], v[196:199]
    v_mfma_f32_16x16x32_bf16 v[64:67], v[140:143], v[192:195], v[196:199]
    v_mfma_f32_16x16x32_bf16 v[68:71], v[144:147], v[192:195], v[196:199]
    v_mfma_f32_16x16x32_bf16 v[72:75], v[148:151], v[192:195], v[196:199]
    v_max3_f32 v92, v16, v17, v18
    v_max3_f32 v96, v19, v20, v21
    v_max3_f32 v93, v24, v25, v26
    buffer_load_dwordx4 a[0:3], v5, s[8:11], s34 offen offset:2048 sc1
    v_max3_f32 v97, v27, v28, v29
    v_max3_f32 v94, v32, v33, v34
    v_max3_f32 v98, v35, v36, v37
    v_max3_f32 v95, v40, v41, v42
    v_max3_f32 v99, v43, v44, v45
    v_max3_f32 v92, v92, v22, v23
    v_max3_f32 v93, v93, v30, v31
    v_max3_f32 v94, v94, v38, v39
    v_max3_f32 v95, v95, v46, v47
    buffer_load_dwordx4 a[4:7], v253, s[8:11], s32 offen offset:3072 sc1
    s_add_u32 s32, s32, 4096
    v_max_f32 v92, v92, v96
    v_max_f32 v93, v93, v97
    v_max_f32 v94, v94, v98
    v_max_f32 v95, v95, v99
    s_mov_b32 s18, 0x3eae1a93
    v_cvt_pk_bf16_f32 v182, v56, v57
    v_permlane32_swap_b32 v92, v93
    v_permlane32_swap_b32 v94, v95
    v_max_f32 v92, v92, v93
    buffer_load_dwordx4 a[8:11], v253, s[8:11], s33 offen offset:3072 sc1
    s_add_u32 s33, s33, 4096
    v_max_f32 v94, v94, v95
    v_cvt_pk_bf16_f32 v183, v58, v59
    v_cvt_pk_bf16_f32 v184, v60, v61
    v_permlane16_swap_b32 v92, v94
    v_max_f32 v92, v92, v94
    v_mul_f32 v92, 0xbeae1a93, v92
    v_mov_b32 v94, v92
    v_cvt_pk_bf16_f32 v185, v62, v63
    v_cvt_pk_bf16_f32 v186, v64, v65
    buffer_load_dwordx4 a[12:15], v5, s[8:11], s34 offen offset:3072 sc1
    s_add_u32 s34, s34, 4096
    v_permlane16_swap_b32 v92, v94
    v_mov_b32 v93, v92
    v_mov_b32 v95, v94
    v_cvt_pk_bf16_f32 v187, v66, v67
    v_cvt_pk_bf16_f32 v188, v68, v69
    v_permlane32_swap_b32 v92, v93
    v_permlane32_swap_b32 v94, v95
    v_cvt_pk_bf16_f32 v189, v70, v71
    v_cvt_pk_bf16_f32 v190, v72, v73
    buffer_load_dwordx4 a[16:19], v253, s[8:11], s32 offen offset:0 sc1
    v_cvt_pk_bf16_f32 v191, v74, v75
    v_fma_f32 v16, v16, s18, v92
    v_fma_f32 v17, v17, s18, v92
    v_fma_f32 v18, v18, s18, v92
    v_fma_f32 v19, v19, s18, v92
    v_fma_f32 v20, v20, s18, v92
    v_fma_f32 v21, v21, s18, v92
    v_fma_f32 v22, v22, s18, v92
    v_fma_f32 v23, v23, s18, v92
    buffer_load_dwordx4 a[20:23], v253, s[8:11], s33 offen offset:0 sc1
    v_exp_f32 v16, v16
    v_exp_f32 v17, v17
    v_exp_f32 v18, v18
    v_exp_f32 v19, v19
    v_exp_f32 v20, v20
    v_exp_f32 v21, v21
    v_exp_f32 v22, v22
    v_exp_f32 v23, v23
    s_nop 0
    buffer_load_dwordx4 a[24:27], v5, s[8:11], s34 offen offset:0 sc1
    v_cvt_pk_bf16_f32 v76, v16, v17
    v_cvt_pk_bf16_f32 v77, v18, v19
    v_cvt_pk_bf16_f32 v78, v20, v21
    v_cvt_pk_bf16_f32 v79, v22, v23
    v_fma_f32 v24, v24, s18, v93
    v_fma_f32 v25, v25, s18, v93
    v_fma_f32 v26, v26, s18, v93
    v_fma_f32 v27, v27, s18, v93
    v_fma_f32 v28, v28, s18, v93
    buffer_load_dwordx4 a[28:31], v253, s[8:11], s32 offen offset:1024 sc1
    v_fma_f32 v29, v29, s18, v93
    v_fma_f32 v30, v30, s18, v93
    v_fma_f32 v31, v31, s18, v93
    v_exp_f32 v24, v24
    v_exp_f32 v25, v25
    v_exp_f32 v26, v26
    v_exp_f32 v27, v27
    v_exp_f32 v28, v28
    v_exp_f32 v29, v29
    buffer_load_dwordx4 a[32:35], v253, s[8:11], s33 offen offset:1024 sc1
    v_exp_f32 v30, v30
    v_exp_f32 v31, v31
    v_mfma_f32_16x16x32_bf16 v[100:103], v[172:175], v[76:79], 0
    v_mfma_f32_16x16x32_bf16 v[116:119], v[182:185], v[76:79], 0
    v_cvt_pk_bf16_f32 v80, v24, v25
    v_cvt_pk_bf16_f32 v81, v26, v27
    v_cvt_pk_bf16_f32 v82, v28, v29
    v_cvt_pk_bf16_f32 v83, v30, v31
    v_fma_f32 v32, v32, s18, v94
    buffer_load_dwordx4 a[36:39], v5, s[8:11], s34 offen offset:1024 sc1
    v_fma_f32 v33, v33, s18, v94
    v_fma_f32 v34, v34, s18, v94
    v_fma_f32 v35, v35, s18, v94
    v_fma_f32 v36, v36, s18, v94
    v_fma_f32 v37, v37, s18, v94
    v_fma_f32 v38, v38, s18, v94
    v_fma_f32 v39, v39, s18, v94
    v_exp_f32 v32, v32
    v_exp_f32 v33, v33
    buffer_load_dwordx4 a[40:43], v253, s[8:11], s32 offen offset:2048 sc1
    v_exp_f32 v34, v34
    v_exp_f32 v35, v35
    v_exp_f32 v36, v36
    v_exp_f32 v37, v37
    v_exp_f32 v38, v38
    v_exp_f32 v39, v39
    v_mfma_f32_16x16x32_bf16 v[104:107], v[174:177], v[80:83], 0
    v_mfma_f32_16x16x32_bf16 v[120:123], v[184:187], v[80:83], 0
    v_cvt_pk_bf16_f32 v84, v32, v33
    buffer_load_dwordx4 a[44:47], v253, s[8:11], s33 offen offset:2048 sc1
    v_cvt_pk_bf16_f32 v85, v34, v35
    v_cvt_pk_bf16_f32 v86, v36, v37
    v_cvt_pk_bf16_f32 v87, v38, v39
    v_fma_f32 v40, v40, s18, v95
    v_fma_f32 v41, v41, s18, v95
    v_fma_f32 v42, v42, s18, v95
    v_fma_f32 v43, v43, s18, v95
    v_fma_f32 v44, v44, s18, v95
    v_fma_f32 v45, v45, s18, v95
    buffer_load_dwordx4 a[48:51], v5, s[8:11], s34 offen offset:2048 sc1
    v_fma_f32 v46, v46, s18, v95
    v_fma_f32 v47, v47, s18, v95
    v_exp_f32 v40, v40
    v_exp_f32 v41, v41
    v_exp_f32 v42, v42
    v_exp_f32 v43, v43
    v_exp_f32 v44, v44
    v_exp_f32 v45, v45
    v_exp_f32 v46, v46
    buffer_load_dwordx4 a[52:55], v253, s[8:11], s32 offen offset:3072 sc1
    s_add_u32 s32, s32, 4096
    v_exp_f32 v47, v47
    v_mfma_f32_16x16x32_bf16 v[108:111], v[176:179], v[84:87], 0
    v_mfma_f32_16x16x32_bf16 v[124:127], v[186:189], v[84:87], 0
    v_cvt_pk_bf16_f32 v88, v40, v41
    v_cvt_pk_bf16_f32 v89, v42, v43
    v_cvt_pk_bf16_f32 v90, v44, v45
    v_cvt_pk_bf16_f32 v91, v46, v47
    v_rcp_f32 v96, v118
    v_rcp_f32 v97, v122
    buffer_load_dwordx4 v[240:243], v9, s[8:11], s37 offen offset:0 sc1
    v_mfma_f32_16x16x32_bf16 v[112:115], v[178:181], v[88:91], 0
    v_mfma_f32_16x16x32_bf16 v[128:131], v[188:191], v[88:91], 0
    v_pk_mul_f32 v[100:101], v[96:97], v[100:101] op_sel:[0,0] op_sel_hi:[0,1]
    v_pk_mul_f32 v[102:103], v[96:97], v[102:103] op_sel:[0,0] op_sel_hi:[0,1]
    v_pk_mul_f32 v[116:117], v[96:97], v[116:117] op_sel:[0,0] op_sel_hi:[0,1]
    v_cvt_pk_bf16_f32 v212, v100, v101
    v_cvt_pk_bf16_f32 v213, v102, v103
    v_cvt_pk_bf16_f32 v220, v116, v117
    v_rcp_f32 v98, v126
    buffer_load_dwordx4 v[244:247], v9, s[8:11], s37 offen offset:1024 sc1
    v_pk_mul_f32 v[104:105], v[96:97], v[104:105] op_sel:[1,0] op_sel_hi:[1,1]
    v_pk_mul_f32 v[106:107], v[96:97], v[106:107] op_sel:[1,0] op_sel_hi:[1,1]
    v_pk_mul_f32 v[120:121], v[96:97], v[120:121] op_sel:[1,0] op_sel_hi:[1,1]
    v_cvt_pk_bf16_f32 v214, v104, v105
    v_cvt_pk_bf16_f32 v215, v106, v107
    v_cvt_pk_bf16_f32 v221, v120, v121
    v_rcp_f32 v99, v130
    v_permlane16_swap_b32 v212, v214
    v_permlane16_swap_b32 v213, v215
    buffer_load_dwordx4 v[248:251], v7, s[8:11], s37 offen offset:2048 sc1
    v_pk_mul_f32 v[108:109], v[98:99], v[108:109] op_sel:[0,0] op_sel_hi:[0,1]
    v_pk_mul_f32 v[110:111], v[98:99], v[110:111] op_sel:[0,0] op_sel_hi:[0,1]
    v_pk_mul_f32 v[124:125], v[98:99], v[124:125] op_sel:[0,0] op_sel_hi:[0,1]
    v_cvt_pk_bf16_f32 v216, v108, v109
    v_cvt_pk_bf16_f32 v217, v110, v111
    v_cvt_pk_bf16_f32 v222, v124, v125
    v_pk_mul_f32 v[112:113], v[98:99], v[112:113] op_sel:[1,0] op_sel_hi:[1,1]
    v_pk_mul_f32 v[114:115], v[98:99], v[114:115] op_sel:[1,0] op_sel_hi:[1,1]
    v_pk_mul_f32 v[128:129], v[98:99], v[128:129] op_sel:[1,0] op_sel_hi:[1,1]
    buffer_load_dword v252, v8, s[8:11], s47 offen sc1
    v_cvt_pk_bf16_f32 v218, v112, v113
    v_cvt_pk_bf16_f32 v219, v114, v115
    v_cvt_pk_bf16_f32 v223, v128, v129
    s_lshl_b32 s7, s3, 2
    s_add_u32 s7, s7, 94208
    v_permlane16_swap_b32 v220, v221
    v_permlane16_swap_b32 v222, v223
    v_add_u32 v11, s7, v253
    v_lshrrev_b32 v10, 3, v0
    v_permlane32_swap_b32 v220, v222
    v_mul_u32_u24 v10, 9216, v10
    ds_write_b32 v11, v220
    v_permlane16_swap_b32 v216, v218
    v_permlane16_swap_b32 v217, v219
    s_mul_i32 s7, s40, 1152
    s_add_u32 s22, s22, s7
    s_add_u32 s22, s22, 41156608
    s_lshl_b32 s7, s3, 8
    s_add_u32 s23, s22, s7
    s_add_u32 s24, s23, 36864
    buffer_store_dwordx4 v[212:215], v9, s[8:11], s23 offen sc1
    buffer_store_dwordx4 v[216:219], v9, s[8:11], s24 offen sc1
    v_and_b32 v11, 7, v0
    v_lshl_add_u32 v10, v11, 4, v10
    s_cmp_eq_u32 s3, 3
    s_cselect_b32 s7, 0, 1073741824
    v_add_u32 v10, s7, v10
    v_add_u32 v11, 94208, v253
    s_waitcnt lgkmcnt(0)
    s_barrier
    ds_read_b128 v[220:223], v11
    s_waitcnt lgkmcnt(0)
    buffer_store_dwordx4 v[220:223], v10, s[8:11], s22 offen offset:1024 sc1
    v_lshlrev_b32 v15, 7, v0
    s_lshl_b32 s6, s40, 2
    s_add_u32 s6, s6, s44
    v_mov_b32 v1, s76
    s_mov_b64 vcc, 0xff
    s_waitcnt vmcnt(0)
    s_barrier
    s_cmp_lg_u32 s3, 0
    s_cbranch_scc1 L_pub_23
    s_mov_b64 exec, vcc
    buffer_store_dword v1, v15, s[8:11], s6 offen sc1
L_pub_23:
    s_mov_b64 exec, -1
    buffer_load_dwordx4 a[56:59], v253, s[8:11], s33 offen offset:3072 sc1
    s_add_u32 s33, s33, 4096
    buffer_load_dwordx4 a[60:63], v5, s[8:11], s34 offen offset:3072 sc1
    s_add_u32 s34, s34, 4096
    buffer_load_dwordx4 a[64:67], v253, s[8:11], s32 offen offset:0 sc1
    buffer_load_dwordx4 a[68:71], v253, s[8:11], s33 offen offset:0 sc1
    buffer_load_dwordx4 a[72:75], v5, s[8:11], s34 offen offset:0 sc1
    buffer_load_dwordx4 a[76:79], v253, s[8:11], s32 offen offset:1024 sc1
    buffer_load_dwordx4 a[80:83], v253, s[8:11], s33 offen offset:1024 sc1
    buffer_load_dwordx4 a[84:87], v5, s[8:11], s34 offen offset:1024 sc1
    s_cmp_lg_u32 s42, 0
    s_cbranch_scc1 L_swz_24
    s_cmp_eq_u32 s93, 2
    s_cselect_b32 s6, 2, 3
    s_mov_b32 s7, 512
    s_cmov_b32 s7, 2048
    v_lshrrev_b32 v14, 4, v0
    v_lshlrev_b32 v14, s6, v14
    v_bfe_u32 v15, v0, 2, 2
    v_add_u32 v14, v14, v15
    v_mul_u32_u24 v14, 128, v14
    v_and_b32 v15, 3, v0
    v_lshl_add_u32 v14, v15, 3, v14
    v_add_u32 v14, s79, v14
    v_add_u32 v15, s7, v14
    ds_read_b64_tr_b16 v[76:77], v14 offset:8192
    ds_read_b64_tr_b16 v[78:79], v15 offset:8192
    ds_read_b64_tr_b16 v[80:81], v14 offset:8224
    ds_read_b64_tr_b16 v[82:83], v15 offset:8224
    ds_read_b64_tr_b16 v[84:85], v14 offset:8256
    ds_read_b64_tr_b16 v[86:87], v15 offset:8256
    ds_read_b64_tr_b16 v[88:89], v14 offset:8288
    ds_read_b64_tr_b16 v[90:91], v15 offset:8288
    ds_read_b64_tr_b16 v[92:93], v14 offset:12288
    ds_read_b64_tr_b16 v[94:95], v15 offset:12288
    ds_read_b64_tr_b16 v[96:97], v14 offset:12320
    ds_read_b64_tr_b16 v[98:99], v15 offset:12320
    ds_read_b64_tr_b16 v[176:177], v14 offset:12352
    ds_read_b64_tr_b16 v[178:179], v15 offset:12352
    ds_read_b64_tr_b16 v[180:181], v14 offset:12384
    ds_read_b64_tr_b16 v[182:183], v15 offset:12384
    s_waitcnt lgkmcnt(0)
    s_add_u32 s7, s78, 0
    buffer_store_dwordx4 v[76:79], v253, s[8:11], s7 offen sc1
    s_add_u32 s7, s78, 497664
    buffer_store_dwordx4 v[80:83], v253, s[8:11], s7 offen sc1
    s_add_u32 s7, s78, 995328
    buffer_store_dwordx4 v[84:87], v253, s[8:11], s7 offen sc1
    s_add_u32 s7, s78, 1492992
    buffer_store_dwordx4 v[88:91], v253, s[8:11], s7 offen sc1
    s_add_u32 s7, s70, 0
    buffer_store_dwordx4 v[92:95], v253, s[8:11], s7 offen sc1
    s_add_u32 s7, s70, 497664
    buffer_store_dwordx4 v[96:99], v253, s[8:11], s7 offen sc1
    s_add_u32 s7, s70, 995328
    buffer_store_dwordx4 v[176:179], v253, s[8:11], s7 offen sc1
    s_add_u32 s7, s70, 1492992
    buffer_store_dwordx4 v[180:183], v253, s[8:11], s7 offen sc1
    s_lshr_b32 s7, s2, 3
    s_lshl_b32 s7, s7, 2
    s_add_u32 s7, s7, s3
    s_lshl_b32 s7, s7, 9
    v_lshrrev_b32 v1, 1, v253
    v_add_u32 v1, s7, v1
    buffer_load_dwordx2 v[14:15], v1, s[96:99], 0 offen
L_swz_24:
    s_and_b32 s7, s3, 1
    s_mul_i32 s7, s7, 18432
    s_add_u32 s24, s30, s7
    s_lshr_b32 s7, s3, 1
    s_lshl_b32 s7, s7, 9
    s_add_u32 s24, s24, s7
    s_add_u32 s24, s24, 41156608
    s_mov_b32 s16, 0xffff0000
    v_lshlrev_b32 v124, 16, v240
    v_and_b32 v125, s16, v240
    v_lshlrev_b32 v126, 16, v241
    v_and_b32 v127, s16, v241
    v_lshlrev_b32 v128, 16, v242
    v_and_b32 v129, s16, v242
    v_lshlrev_b32 v130, 16, v243
    v_and_b32 v131, s16, v243
    v_lshlrev_b32 v132, 16, v244
    v_and_b32 v133, s16, v244
    v_lshlrev_b32 v134, 16, v245
    v_and_b32 v135, s16, v245
    v_lshlrev_b32 v136, 16, v246
    v_and_b32 v137, s16, v246
    v_lshlrev_b32 v138, 16, v247
    v_and_b32 v139, s16, v247
    v_lshlrev_b32 v140, 16, v248
    v_and_b32 v141, s16, v248
    v_lshlrev_b32 v142, 16, v249
    v_and_b32 v143, s16, v249
    v_lshlrev_b32 v144, 16, v250
    v_and_b32 v145, s16, v250
    v_lshlrev_b32 v146, 16, v251
    v_and_b32 v147, s16, v251
    s_cmp_eq_u32 s3, 1
    s_cselect_b32 s7, 16, 0
    v_lshlrev_b32 v12, 2, v0
    v_cmp_gt_u32 vcc, s7, v0
    v_add_u32 v10, 40960, v12
    v_add_u32 v11, 41472, v12
    v_cndmask_b32 v10, v11, v10, vcc
    v_and_b32 v11, 0x7c, v12
    v_cmp_gt_u32 vcc, 32, v0
    v_mov_b32 v13, 1073741824
    s_and_b32 s7, s40, 3
    s_lshl_b32 s45, s45, 2
    v_cndmask_b32 v8, v13, v12, vcc
    s_add_u32 s6, s7, s3
    s_cmp_eq_u32 s6, 0
    s_cselect_b32 s6, 0, 1073741824
    v_add_u32 v6, s6, v8
    s_add_u32 s45, s45, s7
    s_lshl_b32 s45, s45, 2
    s_add_u32 s45, s45, s3
    s_lshl_b32 s45, s45, 7
    s_add_u32 s45, s45, s43
    s_add_u32 s45, s45, 48300032
    s_cmp_eq_u32 s3, 0
    s_cselect_b32 s35, 1.0, 0
    s_lshl_b32 s7, s40, 2
    s_add_u32 s7, s7, s3
    s_mul_i32 s23, s7, 497664
    s_add_u32 s23, s23, 3145728
    s_add_u32 s50, s23, 497664
    s_mul_i32 s50, s50, s42
    v_mov_b32 v184, v253
    v_add_u32 v185, 4096, v253
    v_add_u32 v186, 8192, v253
    v_add_u32 v187, 12288, v253
    v_add_u32 v188, 16384, v253
    v_add_u32 v189, 20480, v253
    v_add_u32 v190, 24576, v253
    v_add_u32 v191, 28672, v253
    v_add_u32 v192, 32768, v253
    s_cmp_lg_u32 s3, 3
    s_cbranch_scc1 L_pollout_27
    s_lshl_b32 s7, s40, 7
    s_add_u32 s7, s7, s44
    s_add_u32 s52, s4, s7
    s_addc_u32 s53, s5, 0
    s_mov_b32 s6, 0
L_poll_25:
    s_load_dwordx8 s[56:63], s[52:53], 0 glc
    s_add_u32 s6, s6, 1
    s_waitcnt lgkmcnt(0)
    s_xor_b64 s[56:57], s[56:57], s[76:77]
    s_xor_b64 s[58:59], s[58:59], s[76:77]
    s_xor_b64 s[60:61], s[60:61], s[76:77]
    s_xor_b64 s[62:63], s[62:63], s[76:77]
    s_or_b64 s[56:57], s[56:57], s[58:59]
    s_or_b64 s[60:61], s[60:61], s[62:63]
    s_or_b64 s[56:57], s[56:57], s[60:61]
    s_cbranch_scc0 L_polled_26
    s_cmp_lt_u32 s6, 1048576
    s_cbranch_scc1 L_poll_25
    s_branch L_main_end
L_polled_26:
L_pollout_27:
    s_barrier
    s_lshl_b32 m0, s3, 10
    s_nop 0
    buffer_load_dwordx4 v2, s[8:11], s24 offen sc1 lds
    s_add_u32 m0, m0, 4096
    s_add_u32 s24, s24, 1024
    buffer_load_dwordx4 v2, s[8:11], s24 offen sc1 lds
    s_add_u32 m0, m0, 4096
    s_add_u32 s24, s24, 1024
    buffer_load_dwordx4 v2, s[8:11], s24 offen sc1 lds
    s_add_u32 m0, m0, 4096
    s_add_u32 s24, s24, 1024
    buffer_load_dwordx4 v2, s[8:11], s24 offen sc1 lds
    s_add_u32 m0, m0, 4096
    s_add_u32 s24, s24, 1024
    buffer_load_dwordx4 v2, s[8:11], s24 offen sc1 lds
    s_add_u32 m0, m0, 4096
    s_add_u32 s24, s24, 1024
    buffer_load_dwordx4 v2, s[8:11], s24 offen sc1 lds
    s_add_u32 m0, m0, 4096
    s_add_u32 s24, s24, 1024
    buffer_load_dwordx4 v2, s[8:11], s24 offen sc1 lds
    s_add_u32 m0, m0, 4096
    s_add_u32 s24, s24, 1024
    buffer_load_dwordx4 v2, s[8:11], s24 offen sc1 lds
    s_add_u32 m0, m0, 4096
    s_add_u32 s24, s24, 1024
    buffer_load_dwordx4 v2, s[8:11], s24 offen sc1 lds
    s_waitcnt vmcnt(4)
    s_barrier
    s_xor_b32 s7, s3, 0
    s_or_b32 s7, s7, s42
    s_cbranch_scc1 L_swz_28
    s_lshl_b32 s6, s40, 7
    s_lshl_b32 s7, s41, 2
    s_add_u32 s6, s6, s7
    s_add_u32 s6, s6, 19464192
    s_mov_b64 exec, 0xffffffff
    v_lshlrev_b32 v15, 10, v0
    v_mov_b32 v1, s76
    buffer_store_dword v1, v15, s[8:11], s6 offen sc1
    s_mov_b64 exec, -1
L_swz_28:
    ds_read_b128 v[160:163], v253 offset:0
    ds_read_b128 v[164:167], v253 offset:1024
    s_waitcnt lgkmcnt(0)
    v_mfma_f32_16x16x32_bf16 v[100:103], a[160:163], v[160:163], 0
    ds_read_b128 v[168:171], v253 offset:2048
    v_mfma_f32_16x16x32_bf16 v[104:107], a[160:163], v[164:167], 0
    ds_read_b128 v[172:175], v253 offset:3072
    v_mfma_f32_16x16x32_bf16 v[108:111], a[164:167], v[160:163], 0
    v_mfma_f32_16x16x32_bf16 v[112:115], a[164:167], v[164:167], 0
    buffer_load_dwordx4 v[16:19], v184, s[48:51], s23 offen offset:0 sc1
    v_mfma_f32_16x16x32_bf16 v[116:119], a[168:171], v[160:163], 0
    v_mfma_f32_16x16x32_bf16 v[120:123], a[168:171], v[164:167], 0
    s_waitcnt lgkmcnt(0)
    v_mfma_f32_16x16x32_bf16 v[100:103], a[172:175], v[168:171], v[100:103]
    ds_read_b128 v[160:163], v253 offset:4096
    v_mfma_f32_16x16x32_bf16 v[104:107], a[172:175], v[172:175], v[104:107]
    ds_read_b128 v[164:167], v253 offset:5120
    v_mfma_f32_16x16x32_bf16 v[108:111], a[176:179], v[168:171], v[108:111]
    v_mfma_f32_16x16x32_bf16 v[112:115], a[176:179], v[172:175], v[112:115]
    buffer_load_dwordx4 v[20:23], v184, s[48:51], s23 offen offset:1024 sc1
    v_mfma_f32_16x16x32_bf16 v[116:119], a[180:183], v[168:171], v[116:119]
    v_mfma_f32_16x16x32_bf16 v[120:123], a[180:183], v[172:175], v[120:123]
    s_waitcnt lgkmcnt(0)
    v_mfma_f32_16x16x32_bf16 v[100:103], a[184:187], v[160:163], v[100:103]
    ds_read_b128 v[168:171], v253 offset:6144
    v_mfma_f32_16x16x32_bf16 v[104:107], a[184:187], v[164:167], v[104:107]
    ds_read_b128 v[172:175], v253 offset:7168
    v_mfma_f32_16x16x32_bf16 v[108:111], a[188:191], v[160:163], v[108:111]
    v_mfma_f32_16x16x32_bf16 v[112:115], a[188:191], v[164:167], v[112:115]
    buffer_load_dwordx4 v[24:27], v184, s[48:51], s23 offen offset:2048 sc1
    v_mfma_f32_16x16x32_bf16 v[116:119], a[192:195], v[160:163], v[116:119]
    v_mfma_f32_16x16x32_bf16 v[120:123], a[192:195], v[164:167], v[120:123]
    s_waitcnt lgkmcnt(0)
    v_mfma_f32_16x16x32_bf16 v[100:103], a[196:199], v[168:171], v[100:103]
    ds_read_b128 v[160:163], v253 offset:8192
    v_mfma_f32_16x16x32_bf16 v[104:107], a[196:199], v[172:175], v[104:107]
    ds_read_b128 v[164:167], v253 offset:9216
    v_mfma_f32_16x16x32_bf16 v[108:111], a[200:203], v[168:171], v[108:111]
    v_mfma_f32_16x16x32_bf16 v[112:115], a[200:203], v[172:175], v[112:115]
    buffer_load_dwordx4 v[28:31], v184, s[48:51], s23 offen offset:3072 sc1
    v_mfma_f32_16x16x32_bf16 v[116:119], a[204:207], v[168:171], v[116:119]
    v_mfma_f32_16x16x32_bf16 v[120:123], a[204:207], v[172:175], v[120:123]
    s_waitcnt lgkmcnt(0)
    v_mfma_f32_16x16x32_bf16 v[100:103], a[208:211], v[160:163], v[100:103]
    ds_read_b128 v[168:171], v253 offset:10240
    v_mfma_f32_16x16x32_bf16 v[104:107], a[208:211], v[164:167], v[104:107]
    ds_read_b128 v[172:175], v253 offset:11264
    v_mfma_f32_16x16x32_bf16 v[108:111], a[212:215], v[160:163], v[108:111]
    v_mfma_f32_16x16x32_bf16 v[112:115], a[212:215], v[164:167], v[112:115]
    buffer_load_dwordx4 v[32:35], v185, s[48:51], s23 offen offset:0 sc1
    v_mfma_f32_16x16x32_bf16 v[116:119], a[216:219], v[160:163], v[116:119]
    v_mfma_f32_16x16x32_bf16 v[120:123], a[216:219], v[164:167], v[120:123]
    s_waitcnt lgkmcnt(0)
    v_mfma_f32_16x16x32_bf16 v[100:103], a[220:223], v[168:171], v[100:103]
    ds_read_b128 v[160:163], v253 offset:12288
    v_mfma_f32_16x16x32_bf16 v[104:107], a[220:223], v[172:175], v[104:107]
    ds_read_b128 v[164:167], v253 offset:13312
    v_mfma_f32_16x16x32_bf16 v[108:111], a[224:227], v[168:171], v[108:111]
    v_mfma_f32_16x16x32_bf16 v[112:115], a[224:227], v[172:175], v[112:115]
    buffer_load_dwordx4 v[36:39], v185, s[48:51], s23 offen offset:1024 sc1
    v_mfma_f32_16x16x32_bf16 v[116:119], a[228:231], v[168:171], v[116:119]
    v_mfma_f32_16x16x32_bf16 v[120:123], a[228:231], v[172:175], v[120:123]
    s_waitcnt lgkmcnt(0)
    v_mfma_f32_16x16x32_bf16 v[100:103], a[232:235], v[160:163], v[100:103]
    ds_read_b128 v[168:171], v253 offset:14336
    v_mfma_f32_16x16x32_bf16 v[104:107], a[232:235], v[164:167], v[104:107]
    ds_read_b128 v[172:175], v253 offset:15360
    v_mfma_f32_16x16x32_bf16 v[108:111], a[236:239], v[160:163], v[108:111]
    v_mfma_f32_16x16x32_bf16 v[112:115], a[236:239], v[164:167], v[112:115]
    buffer_load_dwordx4 v[40:43], v185, s[48:51], s23 offen offset:2048 sc1
    v_mfma_f32_16x16x32_bf16 v[116:119], a[240:243], v[160:163], v[116:119]
    v_mfma_f32_16x16x32_bf16 v[120:123], a[240:243], v[164:167], v[120:123]
    s_waitcnt lgkmcnt(0)
    v_mfma_f32_16x16x32_bf16 v[100:103], a[244:247], v[168:171], v[100:103]
    ds_read_b128 v[160:163], v253 offset:16384
    v_mfma_f32_16x16x32_bf16 v[104:107], a[244:247], v[172:175], v[104:107]
    ds_read_b128 v[164:167], v253 offset:17408
    v_mfma_f32_16x16x32_bf16 v[108:111], a[248:251], v[168:171], v[108:111]
    v_mfma_f32_16x16x32_bf16 v[112:115], a[248:251], v[172:175], v[112:115]
    buffer_load_dwordx4 v[44:47], v185, s[48:51], s23 offen offset:3072 sc1
    v_mfma_f32_16x16x32_bf16 v[116:119], a[252:255], v[168:171], v[116:119]
    v_mfma_f32_16x16x32_bf16 v[120:123], a[252:255], v[172:175], v[120:123]
    s_waitcnt lgkmcnt(0)
    v_mfma_f32_16x16x32_bf16 v[100:103], a[128:131], v[160:163], v[100:103]
    ds_read_b128 v[168:171], v253 offset:18432
    v_mfma_f32_16x16x32_bf16 v[104:107], a[128:131], v[164:167], v[104:107]
    ds_read_b128 v[172:175], v253 offset:19456
    v_mfma_f32_16x16x32_bf16 v[108:111], a[132:135], v[160:163], v[108:111]
    v_mfma_f32_16x16x32_bf16 v[112:115], a[132:135], v[164:167], v[112:115]
    buffer_load_dwordx4 v[48:51], v186, s[48:51], s23 offen offset:0 sc1
    v_mfma_f32_16x16x32_bf16 v[116:119], a[136:139], v[160:163], v[116:119]
    v_mfma_f32_16x16x32_bf16 v[120:123], a[136:139], v[164:167], v[120:123]
    s_xor_b32 s7, s3, 0
    s_or_b32 s7, s7, s42
    s_cbranch_scc1 L_wo_x_29
    s_waitcnt vmcnt(10) lgkmcnt(0)
    s_branch L_wo_x_30
L_wo_x_29:
    s_waitcnt vmcnt(9) lgkmcnt(0)
L_wo_x_30:
    s_barrier
    v_mfma_f32_16x16x32_bf16 v[100:103], a[140:143], v[168:171], v[100:103]
    ds_read_b128 v[160:163], v253 offset:20480
    v_mfma_f32_16x16x32_bf16 v[104:107], a[140:143], v[172:175], v[104:107]
    ds_read_b128 v[164:167], v253 offset:21504
    v_mfma_f32_16x16x32_bf16 v[108:111], a[144:147], v[168:171], v[108:111]
    v_mfma_f32_16x16x32_bf16 v[112:115], a[144:147], v[172:175], v[112:115]
    buffer_load_dwordx4 v[52:55], v186, s[48:51], s23 offen offset:1024 sc1
    v_mfma_f32_16x16x32_bf16 v[116:119], a[148:151], v[168:171], v[116:119]
    v_mfma_f32_16x16x32_bf16 v[120:123], a[148:151], v[172:175], v[120:123]
    s_waitcnt lgkmcnt(0)
    v_mfma_f32_16x16x32_bf16 v[100:103], a[152:155], v[160:163], v[100:103]
    ds_read_b128 v[168:171], v253 offset:22528
    v_mfma_f32_16x16x32_bf16 v[104:107], a[152:155], v[164:167], v[104:107]
    ds_read_b128 v[172:175], v253 offset:23552
    v_mfma_f32_16x16x32_bf16 v[108:111], a[156:159], v[160:163], v[108:111]
    v_mfma_f32_16x16x32_bf16 v[112:115], a[156:159], v[164:167], v[112:115]
    buffer_load_dwordx4 v[56:59], v186, s[48:51], s23 offen offset:2048 sc1
    v_mfma_f32_16x16x32_bf16 v[116:119], a[0:3], v[160:163], v[116:119]
    v_mfma_f32_16x16x32_bf16 v[120:123], a[0:3], v[164:167], v[120:123]
    s_waitcnt lgkmcnt(0)
    v_mfma_f32_16x16x32_bf16 v[100:103], a[4:7], v[168:171], v[100:103]
    ds_read_b128 v[160:163], v253 offset:24576
    v_mfma_f32_16x16x32_bf16 v[104:107], a[4:7], v[172:175], v[104:107]
    ds_read_b128 v[164:167], v253 offset:25600
    v_mfma_f32_16x16x32_bf16 v[108:111], a[8:11], v[168:171], v[108:111]
    v_mfma_f32_16x16x32_bf16 v[112:115], a[8:11], v[172:175], v[112:115]
    buffer_load_dwordx4 v[60:63], v186, s[48:51], s23 offen offset:3072 sc1
    v_mfma_f32_16x16x32_bf16 v[116:119], a[12:15], v[168:171], v[116:119]
    v_mfma_f32_16x16x32_bf16 v[120:123], a[12:15], v[172:175], v[120:123]
    s_waitcnt lgkmcnt(0)
    v_mfma_f32_16x16x32_bf16 v[100:103], a[16:19], v[160:163], v[100:103]
    ds_read_b128 v[168:171], v253 offset:26624
    v_mfma_f32_16x16x32_bf16 v[104:107], a[16:19], v[164:167], v[104:107]
    ds_read_b128 v[172:175], v253 offset:27648
    v_mfma_f32_16x16x32_bf16 v[108:111], a[20:23], v[160:163], v[108:111]
    v_mfma_f32_16x16x32_bf16 v[112:115], a[20:23], v[164:167], v[112:115]
    buffer_load_dwordx4 v[64:67], v187, s[48:51], s23 offen offset:0 sc1
    v_mfma_f32_16x16x32_bf16 v[116:119], a[24:27], v[160:163], v[116:119]
    v_mfma_f32_16x16x32_bf16 v[120:123], a[24:27], v[164:167], v[120:123]
    s_waitcnt lgkmcnt(0)
    v_mfma_f32_16x16x32_bf16 v[100:103], a[28:31], v[168:171], v[100:103]
    ds_read_b128 v[160:163], v253 offset:28672
    v_mfma_f32_16x16x32_bf16 v[104:107], a[28:31], v[172:175], v[104:107]
    ds_read_b128 v[164:167], v253 offset:29696
    v_mfma_f32_16x16x32_bf16 v[108:111], a[32:35], v[168:171], v[108:111]
    v_mfma_f32_16x16x32_bf16 v[112:115], a[32:35], v[172:175], v[112:115]
    buffer_load_dwordx4 v[68:71], v187, s[48:51], s23 offen offset:1024 sc1
    v_mfma_f32_16x16x32_bf16 v[116:119], a[36:39], v[168:171], v[116:119]
    v_mfma_f32_16x16x32_bf16 v[120:123], a[36:39], v[172:175], v[120:123]
    s_waitcnt lgkmcnt(0)
    v_mfma_f32_16x16x32_bf16 v[100:103], a[40:43], v[160:163], v[100:103]
    ds_read_b128 v[168:171], v253 offset:30720
    v_mfma_f32_16x16x32_bf16 v[104:107], a[40:43], v[164:167], v[104:107]
    ds_read_b128 v[172:175], v253 offset:31744
    v_mfma_f32_16x16x32_bf16 v[108:111], a[44:47], v[160:163], v[108:111]
    v_mfma_f32_16x16x32_bf16 v[112:115], a[44:47], v[164:167], v[112:115]
    buffer_load_dwordx4 v[72:75], v187, s[48:51], s23 offen offset:2048 sc1
    v_mfma_f32_16x16x32_bf16 v[116:119], a[48:51], v[160:163], v[116:119]
    v_mfma_f32_16x16x32_bf16 v[120:123], a[48:51], v[164:167], v[120:123]
    s_waitcnt lgkmcnt(0)
    v_mfma_f32_16x16x32_bf16 v[100:103], a[52:55], v[168:171], v[100:103]
    ds_read_b128 v[160:163], v253 offset:32768
    v_mfma_f32_16x16x32_bf16 v[104:107], a[52:55], v[172:175], v[104:107]
    ds_read_b128 v[164:167], v253 offset:33792
    v_mfma_f32_16x16x32_bf16 v[108:111], a[56:59], v[168:171], v[108:111]
    v_mfma_f32_16x16x32_bf16 v[112:115], a[56:59], v[172:175], v[112:115]
    buffer_load_dwordx4 v[76:79], v187, s[48:51], s23 offen offset:3072 sc1
    v_mfma_f32_16x16x32_bf16 v[116:119], a[60:63], v[168:171], v[116:119]
    v_mfma_f32_16x16x32_bf16 v[120:123], a[60:63], v[172:175], v[120:123]
    s_waitcnt lgkmcnt(0)
    v_mfma_f32_16x16x32_bf16 v[100:103], a[64:67], v[160:163], v[100:103]
    ds_read_b128 v[168:171], v253 offset:34816
    v_mfma_f32_16x16x32_bf16 v[104:107], a[64:67], v[164:167], v[104:107]
    ds_read_b128 v[172:175], v253 offset:35840
    v_mfma_f32_16x16x32_bf16 v[108:111], a[68:71], v[160:163], v[108:111]
    v_mfma_f32_16x16x32_bf16 v[112:115], a[68:71], v[164:167], v[112:115]
    v_mfma_f32_16x16x32_bf16 v[116:119], a[72:75], v[160:163], v[116:119]
    v_mfma_f32_16x16x32_bf16 v[120:123], a[72:75], v[164:167], v[120:123]
    s_waitcnt lgkmcnt(0)
    v_mfma_f32_16x16x32_bf16 v[100:103], a[76:79], v[168:171], v[100:103]
    v_mfma_f32_16x16x32_bf16 v[104:107], a[76:79], v[172:175], v[104:107]
    v_mfma_f32_16x16x32_bf16 v[108:111], a[80:83], v[168:171], v[108:111]
    v_mfma_f32_16x16x32_bf16 v[112:115], a[80:83], v[172:175], v[112:115]
    v_mfma_f32_16x16x32_bf16 v[116:119], a[84:87], v[168:171], v[116:119]
    v_mfma_f32_16x16x32_bf16 v[120:123], a[84:87], v[172:175], v[120:123]
    s_nop 3
    v_permlane16_swap_b32 v100, v104
    v_permlane16_swap_b32 v101, v105
    v_permlane16_swap_b32 v102, v106
    v_permlane16_swap_b32 v103, v107
    v_add_f32 v12, v116, v117
    v_add_f32 v13, v120, v121
    ds_write_b32 v10, v12
    ds_write_b32 v10, v13 offset:64
    v_permlane16_swap_b32 v108, v112
    v_permlane16_swap_b32 v109, v113
    v_permlane16_swap_b32 v110, v114
    v_permlane16_swap_b32 v111, v115
    v_permlane16_swap_b32 v116, v120
    v_permlane16_swap_b32 v117, v121
    v_permlane16_swap_b32 v118, v122
    v_permlane16_swap_b32 v119, v123
    s_waitcnt lgkmcnt(0)
    s_barrier
    ds_read_b32 v12, v11 offset:40960
    v_pk_add_f32 v[124:125], v[124:125], v[100:101]
    v_pk_add_f32 v[126:127], v[126:127], v[102:103]
    v_pk_add_f32 v[128:129], v[128:129], v[104:105]
    v_pk_add_f32 v[130:131], v[130:131], v[106:107]
    v_pk_add_f32 v[132:133], v[132:133], v[108:109]
    v_pk_add_f32 v[134:135], v[134:135], v[110:111]
    v_pk_add_f32 v[136:137], v[136:137], v[112:113]
    v_pk_add_f32 v[138:139], v[138:139], v[114:115]
    v_pk_add_f32 v[140:141], v[140:141], v[116:117]
    v_pk_add_f32 v[142:143], v[142:143], v[118:119]
    v_pk_add_f32 v[144:145], v[144:145], v[120:121]
    v_pk_add_f32 v[146:147], v[146:147], v[122:123]
    v_mov_b32 v14, 0
    v_mov_b32 v15, 0
    s_waitcnt lgkmcnt(0)
    v_add_f32 v12, v12, v252
    v_pk_add_f32 v[100:101], v[124:125], v[12:13] op_sel_hi:[1,0] neg_lo:[0,1] neg_hi:[0,1]
    v_pk_add_f32 v[102:103], v[126:127], v[12:13] op_sel_hi:[1,0] neg_lo:[0,1] neg_hi:[0,1]
    v_pk_add_f32 v[104:105], v[128:129], v[12:13] op_sel_hi:[1,0] neg_lo:[0,1] neg_hi:[0,1]
    v_pk_add_f32 v[106:107], v[130:131], v[12:13] op_sel_hi:[1,0] neg_lo:[0,1] neg_hi:[0,1]
    v_cvt_pk_bf16_f32 v148, v100, v101
    v_cvt_pk_bf16_f32 v149, v102, v103
    v_cvt_pk_bf16_f32 v150, v104, v105
    v_cvt_pk_bf16_f32 v151, v106, v107
    buffer_store_dwordx4 v[148:151], v9, s[8:11], s46 offen offset:0 sc1
    v_pk_add_f32 v[108:109], v[132:133], v[12:13] op_sel_hi:[1,0] neg_lo:[0,1] neg_hi:[0,1]
    v_pk_add_f32 v[110:111], v[134:135], v[12:13] op_sel_hi:[1,0] neg_lo:[0,1] neg_hi:[0,1]
    v_pk_add_f32 v[112:113], v[136:137], v[12:13] op_sel_hi:[1,0] neg_lo:[0,1] neg_hi:[0,1]
    v_pk_add_f32 v[114:115], v[138:139], v[12:13] op_sel_hi:[1,0] neg_lo:[0,1] neg_hi:[0,1]
    v_cvt_pk_bf16_f32 v152, v108, v109
    v_cvt_pk_bf16_f32 v153, v110, v111
    v_cvt_pk_bf16_f32 v154, v112, v113
    v_cvt_pk_bf16_f32 v155, v114, v115
    buffer_store_dwordx4 v[152:155], v9, s[8:11], s46 offen offset:1024 sc1
    v_pk_add_f32 v[116:117], v[140:141], v[12:13] op_sel_hi:[1,0] neg_lo:[0,1] neg_hi:[0,1]
    v_pk_add_f32 v[118:119], v[142:143], v[12:13] op_sel_hi:[1,0] neg_lo:[0,1] neg_hi:[0,1]
    v_pk_add_f32 v[120:121], v[144:145], v[12:13] op_sel_hi:[1,0] neg_lo:[0,1] neg_hi:[0,1]
    v_pk_add_f32 v[122:123], v[146:147], v[12:13] op_sel_hi:[1,0] neg_lo:[0,1] neg_hi:[0,1]
    v_cvt_pk_bf16_f32 v156, v116, v117
    v_cvt_pk_bf16_f32 v157, v118, v119
    v_cvt_pk_bf16_f32 v158, v120, v121
    v_cvt_pk_bf16_f32 v159, v122, v123
    buffer_store_dwordx4 v[156:159], v7, s[8:11], s46 offen offset:2048 sc1
    v_dot2c_f32_bf16 v14, v148, v148
    v_dot2c_f32_bf16 v14, v149, v149
    v_dot2c_f32_bf16 v14, v150, v150
    v_dot2c_f32_bf16 v14, v151, v151
    v_dot2c_f32_bf16 v14, v152, v152
    v_dot2c_f32_bf16 v14, v153, v153
    v_dot2c_f32_bf16 v14, v154, v154
    v_dot2c_f32_bf16 v14, v155, v155
    v_dot2c_f32_bf16 v15, v156, v156
    v_dot2c_f32_bf16 v15, v157, v157
    v_dot2c_f32_bf16 v15, v158, v158
    v_dot2c_f32_bf16 v15, v159, v159
    buffer_store_dword v12, v6, s[8:11], s36 offen sc1
    s_nop 1
    v_fma_f32 v14, v15, s35, v14
    v_mov_b32 v15, v14
    s_nop 1
    v_permlane32_swap_b32 v14, v15
    v_add_f32 v14, v14, v15
    buffer_store_dword v14, v8, s[8:11], s45 offen sc1
    v_lshlrev_b32 v15, 7, v0
    s_lshl_b32 s6, s40, 2
    s_add_u32 s6, s6, s44
    s_add_u32 s6, s6, 32768
    v_mov_b32 v1, s76
    s_mov_b64 vcc, 0xff
    s_waitcnt vmcnt(0)
    s_barrier
    s_cmp_lg_u32 s3, 0
    s_cbranch_scc1 L_pub_31
    s_mov_b64 exec, vcc
    buffer_store_dword v1, v15, s[8:11], s6 offen sc1
L_pub_31:
    s_mov_b64 exec, -1
    s_lshl_b32 s7, s41, 2
    s_add_u32 s7, s7, s3
    s_mul_i32 s22, s7, 18432
    s_add_u32 s22, s22, s43
    s_add_u32 s22, s22, 45875200
    s_mul_i32 s24, s3, 18432
    s_lshl_b32 s25, s41, 12
    s_add_u32 s25, s25, s43
    s_add_u32 s25, s25, 48300032
    v_lshrrev_b32 v3, 5, v0
    v_and_b32 v10, 31, v0
    v_lshlrev_b32 v10, 2, v10
    v_lshl_add_u32 v3, v3, 11, v10
    v_add_u32 v11, 36864, v184
    s_mov_b32 s16, 0xffff0000
    s_lshl_b32 s7, s3, 10
    v_add_u32 v172, s7, v253
    v_add_u32 v174, 5120, v172
    v_and_b32 v178, 7, v0
    v_mul_u32_u24 v178, 1152, v178
    v_lshrrev_b32 v179, 3, v0
    v_lshl_add_u32 v178, v179, 4, v178
    s_lshl_b32 s7, s3, 7
    v_add_u32 v175, s7, v178
    v_add_u32 v177, 640, v175
    s_cmp_eq_u32 s3, 0
    s_mov_b32 s17, 1073741824
    s_cmov_b32 s17, 4096
    v_add_u32 v173, s17, v172
    s_mov_b32 s17, 1073741824
    s_cmov_b32 s17, 512
    v_add_u32 v176, s17, v175
    s_lshl_b32 s21, s41, 3
    s_add_u32 s21, s21, s40
    s_mul_i32 s18, s21, 9216
    s_mul_i32 s20, s21, 73728
    s_add_u32 s20, s20, 19922944
    v_bfe_u32 v1, v0, 3, 2
    s_mov_b32 s7, 73728
    v_mul_lo_u32 v178, v1, s7
    v_lshrrev_b32 v1, 5, v0
    v_lshl_add_u32 v178, v1, 7, v178
    v_and_b32 v1, 7, v0
    v_lshl_add_u32 v178, v1, 4, v178
    v_add_u32 v179, 294912, v178
    v_lshrrev_b32 v1, 5, v0
    v_and_b32 v15, 7, v0
    v_lshlrev_b32 v15, 4, v15
    v_lshl_add_u32 v15, v1, 7, v15
    s_lshl_b32 s7, s3, 8
    s_add_u32 s7, s7, 3072
    v_add_u32 v15, s7, v15
    v_bfe_u32 v1, v0, 3, 2
    v_mov_b32 v182, 1073741824
    v_add_u32 v183, 14336, v253
    s_sub_u32 s7, s40, 0
    v_cmp_eq_u32 vcc, s7, v1
    s_nop 1
    v_cndmask_b32 v178, v178, v182, vcc
    v_cndmask_b32 v216, v183, v15, vcc
    v_cndmask_b32 v218, 0, 1, vcc
    v_lshlrev_b32 v218, 10, v218
    s_sub_u32 s7, s40, 4
    v_cmp_eq_u32 vcc, s7, v1
    s_nop 1
    v_cndmask_b32 v179, v179, v182, vcc
    v_cndmask_b32 v217, v183, v15, vcc
    v_cndmask_b32 v219, 0, 1, vcc
    v_lshlrev_b32 v219, 10, v219
    s_mul_i32 s26, s41, 589824
    s_mul_i32 s7, s40, 9216
    s_add_u32 s26, s26, s7
    s_lshl_b32 s7, s3, 8
    s_add_u32 s27, s26, s7
    s_add_u32 s27, s27, 19921920
    s_mov_b32 s72, s8
    s_mov_b32 s73, s9
    s_mov_b32 s74, 0
    s_mul_i32 s7, s42, 98304
    s_sub_u32 s29, s44, s7
    s_add_u32 s29, s29, 360448
    s_lshl_b32 s7, s40, 7
    s_add_u32 s7, s7, s29
    s_add_u32 s38, s4, s7
    s_addc_u32 s39, s5, 0
    s_lshl_b32 s7, s40, 2
    s_add_u32 s29, s29, s7
    s_add_u32 s50, s23, 497664
    s_cmp_lg_u32 s42, 0
    s_cbranch_scc1 L_ring_32
    s_cmp_lg_u32 s3, 0
    s_cbranch_scc1 L_ring_33
    s_lshl_b32 s7, s41, 3
    s_add_u32 s7, s7, s40
    s_lshl_b32 s7, s7, 7
    s_add_u32 s7, s7, 19464192
    s_add_u32 s68, s4, s7
    s_addc_u32 s69, s5, 0
    s_mov_b32 s6, 0
    s_mov_b32 s7, 0
L_cpoll_34:
    s_load_dwordx16 s[52:67], s[68:69], s7 glc
    s_add_u32 s6, s6, 1
    s_waitcnt lgkmcnt(0)
    s_xor_b64 s[52:53], s[52:53], s[76:77]
    s_xor_b64 s[54:55], s[54:55], s[76:77]
    s_xor_b64 s[56:57], s[56:57], s[76:77]
    s_xor_b64 s[58:59], s[58:59], s[76:77]
    s_xor_b64 s[60:61], s[60:61], s[76:77]
    s_xor_b64 s[62:63], s[62:63], s[76:77]
    s_xor_b64 s[64:65], s[64:65], s[76:77]
    s_xor_b64 s[66:67], s[66:67], s[76:77]
    s_or_b64 s[52:53], s[52:53], s[60:61]
    s_or_b64 s[54:55], s[54:55], s[62:63]
    s_or_b64 s[56:57], s[56:57], s[64:65]
    s_or_b64 s[58:59], s[58:59], s[66:67]
    s_or_b64 s[52:53], s[52:53], s[56:57]
    s_or_b64 s[54:55], s[54:55], s[58:59]
    s_or_b64 s[52:53], s[52:53], s[54:55]
    s_cbranch_scc1 L_cpoll_35
    s_add_u32 s7, s7, 64
    s_cmp_eq_u32 s7, 128
    s_cbranch_scc1 L_cpolled_36
L_cpoll_35:
    s_cmp_lt_u32 s6, 1048576
    s_cbranch_scc1 L_cpoll_34
    s_branch L_main_end
L_cpolled_36:
L_ring_33:
    s_barrier
    buffer_load_dwordx4 v[16:19], v184, s[48:51], s23 offen offset:0 sc1
    buffer_load_dwordx4 v[20:23], v184, s[48:51], s23 offen offset:1024 sc1
    buffer_load_dwordx4 v[24:27], v184, s[48:51], s23 offen offset:2048 sc1
    buffer_load_dwordx4 v[28:31], v184, s[48:51], s23 offen offset:3072 sc1
    buffer_load_dwordx4 v[32:35], v185, s[48:51], s23 offen offset:0 sc1
    buffer_load_dwordx4 v[36:39], v185, s[48:51], s23 offen offset:1024 sc1
    buffer_load_dwordx4 v[40:43], v185, s[48:51], s23 offen offset:2048 sc1
    buffer_load_dwordx4 v[44:47], v185, s[48:51], s23 offen offset:3072 sc1
    buffer_load_dwordx4 v[48:51], v186, s[48:51], s23 offen offset:0 sc1
    buffer_load_dwordx4 v[52:55], v186, s[48:51], s23 offen offset:1024 sc1
    buffer_load_dwordx4 v[56:59], v186, s[48:51], s23 offen offset:2048 sc1
    buffer_load_dwordx4 v[60:63], v186, s[48:51], s23 offen offset:3072 sc1
    buffer_load_dwordx4 v[64:67], v187, s[48:51], s23 offen offset:0 sc1
    buffer_load_dwordx4 v[68:71], v187, s[48:51], s23 offen offset:1024 sc1
    buffer_load_dwordx4 v[72:75], v187, s[48:51], s23 offen offset:2048 sc1
    buffer_load_dwordx4 v[76:79], v187, s[48:51], s23 offen offset:3072 sc1
L_ring_32:
    s_cmp_lg_u32 s3, 3
    s_cbranch_scc1 L_pollout_39
    s_lshl_b32 s7, s40, 7
    s_add_u32 s7, s7, s44
    s_add_u32 s7, s7, 32768
    s_add_u32 s52, s4, s7
    s_addc_u32 s53, s5, 0
    s_mov_b32 s6, 0
L_poll_37:
    s_load_dwordx8 s[56:63], s[52:53], 0 glc
    s_add_u32 s6, s6, 1
    s_waitcnt lgkmcnt(0)
    s_xor_b64 s[56:57], s[56:57], s[76:77]
    s_xor_b64 s[58:59], s[58:59], s[76:77]
    s_xor_b64 s[60:61], s[60:61], s[76:77]
    s_xor_b64 s[62:63], s[62:63], s[76:77]
    s_or_b64 s[56:57], s[56:57], s[58:59]
    s_or_b64 s[60:61], s[60:61], s[62:63]
    s_or_b64 s[56:57], s[56:57], s[60:61]
    s_cbranch_scc0 L_polled_38
    s_cmp_lt_u32 s6, 1048576
    s_cbranch_scc1 L_poll_37
    s_branch L_main_end
L_polled_38:
L_pollout_39:
    s_barrier
    s_add_u32 m0, s24, 0
    s_nop 0
    buffer_load_dwordx4 v2, s[8:11], s22 offen offset:0 sc1 lds
    s_add_u32 m0, s24, 512
    s_nop 0
    buffer_load_dwordx4 v2, s[8:11], s22 offen offset:512 sc1 lds
    s_add_u32 m0, s24, 1024
    s_nop 0
    buffer_load_dwordx4 v2, s[8:11], s22 offen offset:1024 sc1 lds
    s_add_u32 m0, s24, 1536
    s_nop 0
    buffer_load_dwordx4 v2, s[8:11], s22 offen offset:1536 sc1 lds
    s_add_u32 m0, s24, 2048
    s_nop 0
    buffer_load_dwordx4 v2, s[8:11], s22 offen offset:2048 sc1 lds
    s_add_u32 m0, s24, 2560
    s_nop 0
    buffer_load_dwordx4 v2, s[8:11], s22 offen offset:2560 sc1 lds
    s_add_u32 m0, s24, 3072
    s_nop 0
    buffer_load_dwordx4 v2, s[8:11], s22 offen offset:3072 sc1 lds
    s_add_u32 m0, s24, 3584
    s_nop 0
    buffer_load_dwordx4 v2, s[8:11], s22 offen offset:3584 sc1 lds
    s_add_u32 m0, s24, 8192
    s_add_u32 s22, s22, 4096
    buffer_load_dwordx4 v2, s[8:11], s22 offen offset:0 sc1 lds
    s_add_u32 m0, s24, 8704
    s_nop 0
    buffer_load_dwordx4 v2, s[8:11], s22 offen offset:512 sc1 lds
    s_add_u32 m0, s24, 9216
    s_nop 0
    buffer_load_dwordx4 v2, s[8:11], s22 offen offset:1024 sc1 lds
    s_add_u32 m0, s24, 9728
    s_nop 0
    buffer_load_dwordx4 v2, s[8:11], s22 offen offset:1536 sc1 lds
    s_add_u32 s23, s23, 16384
    s_lshr_b32 s7, s3, 1
    s_lshl_b32 s7, s7, 10
    s_and_b32 s6, s3, 1
    s_lshl_b32 s6, s6, 3
    s_add_u32 s28, s7, s6
    s_add_u32 s28, s28, 73728
    s_waitcnt vmcnt(6)
    s_barrier
    ds_read_b128 a[0:3], v184 offset:0
    ds_read_b128 a[72:75], v184 offset:18432
    ds_read_b128 a[144:147], v11 offset:0
    ds_read_b128 a[216:219], v11 offset:18432
    ds_read_b128 a[4:7], v184 offset:1024
    ds_read_b128 a[76:79], v184 offset:19456
    ds_read_b128 a[148:151], v11 offset:1024
    ds_read_b128 a[220:223], v11 offset:19456
    s_waitcnt vmcnt(26) lgkmcnt(0)
    v_mfma_f32_16x16x32_bf16 v[88:91], v[16:19], a[0:3], 0
    ds_read_b128 a[8:11], v184 offset:2048
    v_mfma_f32_16x16x32_bf16 v[88:91], v[20:23], a[4:7], v[88:91]
    buffer_load_dwordx4 v[80:83], v184, s[48:51], s23 offen offset:0 sc1
    v_mfma_f32_16x16x32_bf16 v[92:95], v[16:19], a[72:75], 0
    ds_read_b128 a[80:83], v184 offset:20480
    v_mfma_f32_16x16x32_bf16 v[92:95], v[20:23], a[76:79], v[92:95]
    s_add_u32 m0, s24, 10240
    s_nop 0
    buffer_load_dwordx4 v2, s[8:11], s22 offen offset:2048 sc1 lds
    v_mfma_f32_16x16x32_bf16 v[96:99], v[16:19], a[144:147], 0
    ds_read_b128 a[152:155], v11 offset:2048
    ds_read_b128 a[224:227], v11 offset:20480
    v_mfma_f32_16x16x32_bf16 v[96:99], v[20:23], a[148:151], v[96:99]
    buffer_load_dwordx4 v[84:87], v184, s[48:51], s23 offen offset:1024 sc1
    v_mfma_f32_16x16x32_bf16 v[100:103], v[16:19], a[216:219], 0
    ds_read_b128 a[12:15], v184 offset:3072
    v_mfma_f32_16x16x32_bf16 v[100:103], v[20:23], a[220:223], v[100:103]
    s_add_u32 m0, s24, 10752
    s_nop 0
    buffer_load_dwordx4 v2, s[8:11], s22 offen offset:2560 sc1 lds
    s_waitcnt vmcnt(28) lgkmcnt(5)
    v_mfma_f32_16x16x32_bf16 v[104:107], v[24:27], a[0:3], 0
    ds_read_b128 a[84:87], v184 offset:21504
    v_mfma_f32_16x16x32_bf16 v[104:107], v[28:31], a[4:7], v[104:107]
    buffer_load_dwordx4 v[16:19], v184, s[48:51], s23 offen offset:2048 sc1
    v_mfma_f32_16x16x32_bf16 v[108:111], v[24:27], a[72:75], 0
    ds_read_b128 a[156:159], v11 offset:3072
    ds_read_b128 a[228:231], v11 offset:21504
    v_mfma_f32_16x16x32_bf16 v[108:111], v[28:31], a[76:79], v[108:111]
    s_add_u32 m0, s24, 11264
    s_nop 0
    buffer_load_dwordx4 v2, s[8:11], s22 offen offset:3072 sc1 lds
    v_mfma_f32_16x16x32_bf16 v[112:115], v[24:27], a[144:147], 0
    v_mfma_f32_16x16x32_bf16 v[112:115], v[28:31], a[148:151], v[112:115]
    buffer_load_dwordx4 v[20:23], v184, s[48:51], s23 offen offset:3072 sc1
    v_mfma_f32_16x16x32_bf16 v[116:119], v[24:27], a[216:219], 0
    v_mfma_f32_16x16x32_bf16 v[116:119], v[28:31], a[220:223], v[116:119]
    s_add_u32 m0, s24, 11776
    s_nop 0
    buffer_load_dwordx4 v2, s[8:11], s22 offen offset:3584 sc1 lds
    s_waitcnt vmcnt(30) lgkmcnt(0)
    v_mfma_f32_16x16x32_bf16 v[88:91], v[32:35], a[8:11], v[88:91]
    ds_read_b128 a[16:19], v184 offset:4096
    v_mfma_f32_16x16x32_bf16 v[88:91], v[36:39], a[12:15], v[88:91]
    buffer_load_dwordx4 v[24:27], v185, s[48:51], s23 offen offset:0 sc1
    v_mfma_f32_16x16x32_bf16 v[92:95], v[32:35], a[80:83], v[92:95]
    ds_read_b128 a[88:91], v184 offset:22528
    v_mfma_f32_16x16x32_bf16 v[92:95], v[36:39], a[84:87], v[92:95]
    s_add_u32 m0, s24, 16384
    s_add_u32 s22, s22, 4096
    buffer_load_dwordx4 v2, s[8:11], s22 offen offset:0 sc1 lds
    v_mfma_f32_16x16x32_bf16 v[96:99], v[32:35], a[152:155], v[96:99]
    ds_read_b128 a[160:163], v11 offset:4096
    ds_read_b128 a[232:235], v11 offset:22528
    v_mfma_f32_16x16x32_bf16 v[96:99], v[36:39], a[156:159], v[96:99]
    buffer_load_dwordx4 v[28:31], v185, s[48:51], s23 offen offset:1024 sc1
    v_mfma_f32_16x16x32_bf16 v[100:103], v[32:35], a[224:227], v[100:103]
    ds_read_b128 a[20:23], v184 offset:5120
    v_mfma_f32_16x16x32_bf16 v[100:103], v[36:39], a[228:231], v[100:103]
    s_add_u32 m0, s24, 16896
    s_nop 0
    buffer_load_dwordx4 v2, s[8:11], s22 offen offset:512 sc1 lds
    s_waitcnt vmcnt(32) lgkmcnt(5)
    v_mfma_f32_16x16x32_bf16 v[104:107], v[40:43], a[8:11], v[104:107]
    ds_read_b128 a[92:95], v184 offset:23552
    v_mfma_f32_16x16x32_bf16 v[104:107], v[44:47], a[12:15], v[104:107]
    buffer_load_dwordx4 v[32:35], v185, s[48:51], s23 offen offset:2048 sc1
    v_mfma_f32_16x16x32_bf16 v[108:111], v[40:43], a[80:83], v[108:111]
    ds_read_b128 a[164:167], v11 offset:5120
    ds_read_b128 a[236:239], v11 offset:23552
    v_mfma_f32_16x16x32_bf16 v[108:111], v[44:47], a[84:87], v[108:111]
    buffer_load_dword v136, v3, s[8:11], s25 offen offset:0 sc1
    v_mfma_f32_16x16x32_bf16 v[112:115], v[40:43], a[152:155], v[112:115]
    v_mfma_f32_16x16x32_bf16 v[112:115], v[44:47], a[156:159], v[112:115]
    buffer_load_dwordx4 v[36:39], v185, s[48:51], s23 offen offset:3072 sc1
    v_mfma_f32_16x16x32_bf16 v[116:119], v[40:43], a[224:227], v[116:119]
    buffer_load_dword v137, v3, s[8:11], s25 offen offset:128 sc1
    v_mfma_f32_16x16x32_bf16 v[116:119], v[44:47], a[228:231], v[116:119]
    buffer_load_dword v138, v3, s[8:11], s25 offen offset:256 sc1
    s_waitcnt vmcnt(17) lgkmcnt(0)
    s_barrier
    v_mfma_f32_16x16x32_bf16 v[88:91], v[48:51], a[16:19], v[88:91]
    ds_read_b128 a[24:27], v184 offset:6144
    v_mfma_f32_16x16x32_bf16 v[88:91], v[52:55], a[20:23], v[88:91]
    buffer_load_dwordx4 v[40:43], v186, s[48:51], s23 offen offset:0 sc1
    v_mfma_f32_16x16x32_bf16 v[92:95], v[48:51], a[88:91], v[92:95]
    buffer_load_dword v139, v3, s[8:11], s25 offen offset:384 sc1
    v_mfma_f32_16x16x32_bf16 v[92:95], v[52:55], a[92:95], v[92:95]
    buffer_load_dword v140, v3, s[8:11], s25 offen offset:512 sc1
    v_mfma_f32_16x16x32_bf16 v[96:99], v[48:51], a[160:163], v[96:99]
    ds_read_b128 a[96:99], v184 offset:24576
    ds_read_b128 a[168:171], v11 offset:6144
    v_mfma_f32_16x16x32_bf16 v[96:99], v[52:55], a[164:167], v[96:99]
    buffer_load_dwordx4 v[44:47], v186, s[48:51], s23 offen offset:1024 sc1
    v_mfma_f32_16x16x32_bf16 v[100:103], v[48:51], a[232:235], v[100:103]
    ds_read_b128 a[240:243], v11 offset:24576
    ds_read_b128 a[28:31], v184 offset:7168
    v_mfma_f32_16x16x32_bf16 v[100:103], v[52:55], a[236:239], v[100:103]
    buffer_load_dword v141, v3, s[8:11], s25 offen offset:640 sc1
    s_waitcnt vmcnt(38) lgkmcnt(5)
    v_mfma_f32_16x16x32_bf16 v[104:107], v[56:59], a[16:19], v[104:107]
    ds_read_b128 a[100:103], v184 offset:25600
    v_mfma_f32_16x16x32_bf16 v[104:107], v[60:63], a[20:23], v[104:107]
    buffer_load_dwordx4 v[48:51], v186, s[48:51], s23 offen offset:2048 sc1
    v_mfma_f32_16x16x32_bf16 v[108:111], v[56:59], a[88:91], v[108:111]
    buffer_load_dword v142, v3, s[8:11], s25 offen offset:768 sc1
    v_mfma_f32_16x16x32_bf16 v[108:111], v[60:63], a[92:95], v[108:111]
    buffer_load_dword v143, v3, s[8:11], s25 offen offset:896 sc1
    v_mfma_f32_16x16x32_bf16 v[112:115], v[56:59], a[160:163], v[112:115]
    ds_read_b128 a[172:175], v11 offset:7168
    ds_read_b128 a[244:247], v11 offset:25600
    v_mfma_f32_16x16x32_bf16 v[112:115], v[60:63], a[164:167], v[112:115]
    buffer_load_dwordx4 v[52:55], v186, s[48:51], s23 offen offset:3072 sc1
    v_mfma_f32_16x16x32_bf16 v[116:119], v[56:59], a[232:235], v[116:119]
    buffer_load_dword v144, v3, s[8:11], s25 offen offset:1024 sc1
    v_mfma_f32_16x16x32_bf16 v[116:119], v[60:63], a[236:239], v[116:119]
    buffer_load_dword v145, v3, s[8:11], s25 offen offset:1152 sc1
    s_waitcnt vmcnt(42) lgkmcnt(0)
    v_mfma_f32_16x16x32_bf16 v[88:91], v[64:67], a[24:27], v[88:91]
    ds_read_b128 a[32:35], v184 offset:8192
    v_mfma_f32_16x16x32_bf16 v[88:91], v[68:71], a[28:31], v[88:91]
    buffer_load_dwordx4 v[56:59], v187, s[48:51], s23 offen offset:0 sc1
    v_mfma_f32_16x16x32_bf16 v[92:95], v[64:67], a[96:99], v[92:95]
    ds_read_b128 a[104:107], v184 offset:26624
    v_mfma_f32_16x16x32_bf16 v[92:95], v[68:71], a[100:103], v[92:95]
    buffer_load_dword v146, v3, s[8:11], s25 offen offset:1280 sc1
    v_mfma_f32_16x16x32_bf16 v[96:99], v[64:67], a[168:171], v[96:99]
    ds_read_b128 a[176:179], v11 offset:8192
    ds_read_b128 a[248:251], v11 offset:26624
    v_mfma_f32_16x16x32_bf16 v[96:99], v[68:71], a[172:175], v[96:99]
    buffer_load_dwordx4 v[60:63], v187, s[48:51], s23 offen offset:1024 sc1
    v_mfma_f32_16x16x32_bf16 v[100:103], v[64:67], a[240:243], v[100:103]
    buffer_load_dword v147, v3, s[8:11], s25 offen offset:1408 sc1
    v_mfma_f32_16x16x32_bf16 v[100:103], v[68:71], a[244:247], v[100:103]
    buffer_load_dword v148, v3, s[8:11], s25 offen offset:1536 sc1
    s_waitcnt vmcnt(45) lgkmcnt(4)
    v_mfma_f32_16x16x32_bf16 v[104:107], v[72:75], a[24:27], v[104:107]
    ds_read_b128 a[36:39], v184 offset:9216
    ds_read_b128 a[108:111], v184 offset:27648
    v_mfma_f32_16x16x32_bf16 v[104:107], v[76:79], a[28:31], v[104:107]
    buffer_load_dwordx4 v[64:67], v187, s[48:51], s23 offen offset:2048 sc1
    v_mfma_f32_16x16x32_bf16 v[108:111], v[72:75], a[96:99], v[108:111]
    buffer_load_dword v149, v3, s[8:11], s25 offen offset:1664 sc1
    v_mfma_f32_16x16x32_bf16 v[108:111], v[76:79], a[100:103], v[108:111]
    buffer_load_dword v150, v3, s[8:11], s25 offen offset:1792 sc1
    v_mfma_f32_16x16x32_bf16 v[112:115], v[72:75], a[168:171], v[112:115]
    ds_read_b128 a[180:183], v11 offset:9216
    ds_read_b128 a[252:255], v11 offset:27648
    v_mfma_f32_16x16x32_bf16 v[112:115], v[76:79], a[172:175], v[112:115]
    buffer_load_dwordx4 v[68:71], v187, s[48:51], s23 offen offset:3072 sc1
    v_mfma_f32_16x16x32_bf16 v[116:119], v[72:75], a[240:243], v[116:119]
    v_mfma_f32_16x16x32_bf16 v[116:119], v[76:79], a[244:247], v[116:119]
    buffer_load_dword v151, v3, s[8:11], s25 offen offset:1920 sc1
    s_waitcnt vmcnt(35) lgkmcnt(0)
    v_mfma_f32_16x16x32_bf16 v[88:91], v[80:83], a[32:35], v[88:91]
    ds_read_b128 a[40:43], v184 offset:10240
    v_mfma_f32_16x16x32_bf16 v[88:91], v[84:87], a[36:39], v[88:91]
    buffer_load_dwordx4 v[72:75], v188, s[48:51], s23 offen offset:0 sc1
    v_mfma_f32_16x16x32_bf16 v[92:95], v[80:83], a[104:107], v[92:95]
    ds_read_b128 a[112:115], v184 offset:28672
    v_mfma_f32_16x16x32_bf16 v[92:95], v[84:87], a[108:111], v[92:95]
    ds_read_b128 a[184:187], v11 offset:10240
    v_mfma_f32_16x16x32_bf16 v[96:99], v[80:83], a[176:179], v[96:99]
    ds_read_b128 v[220:223], v11 offset:28672
    v_mfma_f32_16x16x32_bf16 v[96:99], v[84:87], a[180:183], v[96:99]
    buffer_load_dwordx4 v[76:79], v188, s[48:51], s23 offen offset:1024 sc1
    v_mfma_f32_16x16x32_bf16 v[100:103], v[80:83], a[248:251], v[100:103]
    ds_read_b128 a[44:47], v184 offset:11264
    v_mfma_f32_16x16x32_bf16 v[100:103], v[84:87], a[252:255], v[100:103]
    ds_read_b128 a[116:119], v184 offset:29696
    s_waitcnt vmcnt(33) lgkmcnt(6)
    v_mfma_f32_16x16x32_bf16 v[104:107], v[16:19], a[32:35], v[104:107]
    v_mfma_f32_16x16x32_bf16 v[104:107], v[20:23], a[36:39], v[104:107]
    buffer_load_dwordx4 v[80:83], v188, s[48:51], s23 offen offset:2048 sc1
    v_mfma_f32_16x16x32_bf16 v[108:111], v[16:19], a[104:107], v[108:111]
    ds_read_b128 a[188:191], v11 offset:11264
    ds_read_b128 v[224:227], v11 offset:29696
    v_mfma_f32_16x16x32_bf16 v[108:111], v[20:23], a[108:111], v[108:111]
    v_mfma_f32_16x16x32_bf16 v[112:115], v[16:19], a[176:179], v[112:115]
    v_mfma_f32_16x16x32_bf16 v[112:115], v[20:23], a[180:183], v[112:115]
    buffer_load_dwordx4 v[84:87], v188, s[48:51], s23 offen offset:3072 sc1
    v_mfma_f32_16x16x32_bf16 v[116:119], v[16:19], a[248:251], v[116:119]
    v_mfma_f32_16x16x32_bf16 v[116:119], v[20:23], a[252:255], v[116:119]
    s_waitcnt vmcnt(30) lgkmcnt(0)
    s_barrier
    v_mfma_f32_16x16x32_bf16 v[88:91], v[24:27], a[40:43], v[88:91]
    ds_read_b128 a[48:51], v184 offset:12288
    v_mfma_f32_16x16x32_bf16 v[88:91], v[28:31], a[44:47], v[88:91]
    buffer_load_dwordx4 v[16:19], v189, s[48:51], s23 offen offset:0 sc1
    v_mfma_f32_16x16x32_bf16 v[92:95], v[24:27], a[112:115], v[92:95]
    ds_read_b128 a[120:123], v184 offset:30720
    v_mfma_f32_16x16x32_bf16 v[92:95], v[28:31], a[116:119], v[92:95]
    ds_read_b128 a[192:195], v11 offset:12288
    v_mfma_f32_16x16x32_bf16 v[96:99], v[24:27], a[184:187], v[96:99]
    ds_read_b128 v[228:231], v11 offset:30720
    v_mfma_f32_16x16x32_bf16 v[96:99], v[28:31], a[188:191], v[96:99]
    buffer_load_dwordx4 v[20:23], v189, s[48:51], s23 offen offset:1024 sc1
    v_mfma_f32_16x16x32_bf16 v[100:103], v[24:27], v[220:223], v[100:103]
    ds_read_b128 a[52:55], v184 offset:13312
    v_mfma_f32_16x16x32_bf16 v[100:103], v[28:31], v[224:227], v[100:103]
    ds_read_b128 a[124:127], v184 offset:31744
    s_waitcnt vmcnt(29) lgkmcnt(6)
    v_mfma_f32_16x16x32_bf16 v[104:107], v[32:35], a[40:43], v[104:107]
    v_mfma_f32_16x16x32_bf16 v[104:107], v[36:39], a[44:47], v[104:107]
    buffer_load_dwordx4 v[24:27], v189, s[48:51], s23 offen offset:2048 sc1
    v_mfma_f32_16x16x32_bf16 v[108:111], v[32:35], a[112:115], v[108:111]
    ds_read_b128 a[196:199], v11 offset:13312
    ds_read_b128 v[232:235], v11 offset:31744
    v_mfma_f32_16x16x32_bf16 v[108:111], v[36:39], a[116:119], v[108:111]
    v_mfma_f32_16x16x32_bf16 v[112:115], v[32:35], a[184:187], v[112:115]
    v_mfma_f32_16x16x32_bf16 v[112:115], v[36:39], a[188:191], v[112:115]
    buffer_load_dwordx4 v[28:31], v189, s[48:51], s23 offen offset:3072 sc1
    v_mfma_f32_16x16x32_bf16 v[116:119], v[32:35], v[220:223], v[116:119]
    v_mfma_f32_16x16x32_bf16 v[116:119], v[36:39], v[224:227], v[116:119]
    s_waitcnt vmcnt(8) lgkmcnt(0)
    v_mfma_f32_16x16x32_bf16 v[88:91], v[40:43], a[48:51], v[88:91]
    ds_read_b128 a[56:59], v184 offset:14336
    v_add_f32 v136, v136, v144
    v_mfma_f32_16x16x32_bf16 v[88:91], v[44:47], a[52:55], v[88:91]
    buffer_load_dwordx4 v[32:35], v190, s[48:51], s23 offen offset:0 sc1
    v_mfma_f32_16x16x32_bf16 v[92:95], v[40:43], a[120:123], v[92:95]
    ds_read_b128 a[128:131], v184 offset:32768
    v_add_f32 v137, v137, v145
    v_mfma_f32_16x16x32_bf16 v[92:95], v[44:47], a[124:127], v[92:95]
    ds_read_b128 a[200:203], v11 offset:14336
    v_add_f32 v138, v138, v146
    v_mfma_f32_16x16x32_bf16 v[96:99], v[40:43], a[192:195], v[96:99]
    ds_read_b128 v[236:239], v11 offset:32768
    v_add_f32 v139, v139, v147
    v_mfma_f32_16x16x32_bf16 v[96:99], v[44:47], a[196:199], v[96:99]
    buffer_load_dwordx4 v[36:39], v190, s[48:51], s23 offen offset:1024 sc1
    v_mfma_f32_16x16x32_bf16 v[100:103], v[40:43], v[228:231], v[100:103]
    ds_read_b128 a[60:63], v184 offset:15360
    v_add_f32 v140, v140, v148
    v_mfma_f32_16x16x32_bf16 v[100:103], v[44:47], v[232:235], v[100:103]
    ds_read_b128 a[132:135], v184 offset:33792
    v_add_f32 v141, v141, v149
    s_waitcnt vmcnt(22) lgkmcnt(6)
    v_mfma_f32_16x16x32_bf16 v[104:107], v[48:51], a[48:51], v[104:107]
    v_add_f32 v142, v142, v150
    v_add_f32 v143, v143, v151
    v_mfma_f32_16x16x32_bf16 v[104:107], v[52:55], a[52:55], v[104:107]
    buffer_load_dwordx4 v[40:43], v190, s[48:51], s23 offen offset:2048 sc1
    v_mfma_f32_16x16x32_bf16 v[108:111], v[48:51], a[120:123], v[108:111]
    ds_read_b128 a[204:207], v11 offset:15360
    ds_read_b128 v[240:243], v11 offset:33792
    v_mfma_f32_16x16x32_bf16 v[108:111], v[52:55], a[124:127], v[108:111]
    v_add_f32 v136, v136, v140
    v_add_f32 v137, v137, v141
    v_mfma_f32_16x16x32_bf16 v[112:115], v[48:51], a[192:195], v[112:115]
    v_add_f32 v138, v138, v142
    v_add_f32 v139, v139, v143
    v_mfma_f32_16x16x32_bf16 v[112:115], v[52:55], a[196:199], v[112:115]
    buffer_load_dwordx4 v[44:47], v190, s[48:51], s23 offen offset:3072 sc1
    v_mfma_f32_16x16x32_bf16 v[116:119], v[48:51], v[228:231], v[116:119]
    v_add_f32 v136, v136, v138
    v_add_f32 v137, v137, v139
    v_mfma_f32_16x16x32_bf16 v[116:119], v[52:55], v[232:235], v[116:119]
    v_add_f32 v136, v136, v137
    v_mov_b32 v137, 0x3727c5ac
    s_waitcnt vmcnt(19) lgkmcnt(0)
    v_mfma_f32_16x16x32_bf16 v[88:91], v[56:59], a[56:59], v[88:91]
    ds_read_b128 a[64:67], v184 offset:16384
    v_fmac_f32 v137, 0x3ae38e39, v136
    v_mfma_f32_16x16x32_bf16 v[88:91], v[60:63], a[60:63], v[88:91]
    buffer_load_dwordx4 v[48:51], v191, s[48:51], s23 offen offset:0 sc1
    v_mfma_f32_16x16x32_bf16 v[92:95], v[56:59], a[128:131], v[92:95]
    ds_read_b128 a[136:139], v184 offset:34816
    v_mov_b32 v193, v137
    v_mfma_f32_16x16x32_bf16 v[92:95], v[60:63], a[132:135], v[92:95]
    ds_read_b128 a[208:211], v11 offset:16384
    v_mfma_f32_16x16x32_bf16 v[96:99], v[56:59], a[200:203], v[96:99]
    ds_read_b128 v[244:247], v11 offset:34816
    v_mfma_f32_16x16x32_bf16 v[96:99], v[60:63], a[204:207], v[96:99]
    buffer_load_dwordx4 v[52:55], v191, s[48:51], s23 offen offset:1024 sc1
    v_mfma_f32_16x16x32_bf16 v[100:103], v[56:59], v[236:239], v[100:103]
    ds_read_b128 a[68:71], v184 offset:17408
    v_mfma_f32_16x16x32_bf16 v[100:103], v[60:63], v[240:243], v[100:103]
    ds_read_b128 a[140:143], v184 offset:35840
    s_waitcnt vmcnt(15) lgkmcnt(6)
    v_mfma_f32_16x16x32_bf16 v[104:107], v[64:67], a[56:59], v[104:107]
    s_nop 0
    v_permlane16_swap_b32 v193, v137
    v_mfma_f32_16x16x32_bf16 v[104:107], v[68:71], a[60:63], v[104:107]
    buffer_load_dwordx4 v[56:59], v191, s[48:51], s23 offen offset:2048 sc1
    v_mfma_f32_16x16x32_bf16 v[108:111], v[64:67], a[128:131], v[108:111]
    ds_read_b128 a[212:215], v11 offset:17408
    ds_read_b128 v[248:251], v11 offset:35840
    v_mfma_f32_16x16x32_bf16 v[108:111], v[68:71], a[132:135], v[108:111]
    v_mov_b32 v195, v193
    v_mov_b32 v194, v137
    v_mfma_f32_16x16x32_bf16 v[112:115], v[64:67], a[200:203], v[112:115]
    v_mov_b32 v252, v137
    v_mfma_f32_16x16x32_bf16 v[112:115], v[68:71], a[204:207], v[112:115]
    buffer_load_dwordx4 v[60:63], v191, s[48:51], s23 offen offset:3072 sc1
    v_mfma_f32_16x16x32_bf16 v[116:119], v[64:67], v[236:239], v[116:119]
    s_nop 0
    v_permlane32_swap_b32 v193, v195
    v_mfma_f32_16x16x32_bf16 v[116:119], v[68:71], v[240:243], v[116:119]
    v_permlane32_swap_b32 v194, v252
    s_waitcnt vmcnt(14) lgkmcnt(0)
    v_mfma_f32_16x16x32_bf16 v[88:91], v[72:75], a[64:67], v[88:91]
    v_rsq_f32 v4, v193
    v_mfma_f32_16x16x32_bf16 v[120:123], v[76:79], a[68:71], v[88:91]
    buffer_load_dwordx4 v[64:67], v192, s[48:51], s23 offen offset:0 sc1
    v_mfma_f32_16x16x32_bf16 v[92:95], v[72:75], a[136:139], v[92:95]
    v_rsq_f32 v5, v194
    v_mfma_f32_16x16x32_bf16 v[124:127], v[76:79], a[140:143], v[92:95]
    v_rsq_f32 v6, v195
    v_mfma_f32_16x16x32_bf16 v[96:99], v[72:75], a[208:211], v[96:99]
    v_rsq_f32 v7, v252
    v_mfma_f32_16x16x32_bf16 v[128:131], v[76:79], a[212:215], v[96:99]
    buffer_load_dwordx4 v[68:71], v192, s[48:51], s23 offen offset:1024 sc1
    v_mfma_f32_16x16x32_bf16 v[100:103], v[72:75], v[244:247], v[100:103]
    v_mul_f32 v8, v4, v4
    v_mul_f32 v9, v5, v5
    v_mfma_f32_16x16x32_bf16 v[132:135], v[76:79], v[248:251], v[100:103]
    v_mul_f32 v13, v6, v6
    v_mul_f32 v14, v7, v7
    s_waitcnt vmcnt(14) lgkmcnt(0)
    v_mfma_f32_16x16x32_bf16 v[104:107], v[80:83], a[64:67], v[104:107]
    v_mul_f32 v4, 0xc0135761, v4
    v_mul_f32 v5, 0xc0135761, v5
    v_mfma_f32_16x16x32_bf16 v[136:139], v[84:87], a[68:71], v[104:107]
    buffer_load_dwordx4 v[72:75], v192, s[48:51], s23 offen offset:2048 sc1
    v_mfma_f32_16x16x32_bf16 v[108:111], v[80:83], a[136:139], v[108:111]
    v_mul_f32 v6, 0xc0135761, v6
    v_mul_f32 v7, 0xc0135761, v7
    v_mfma_f32_16x16x32_bf16 v[140:143], v[84:87], a[140:143], v[108:111]
    v_mul_f32 v8, 0x3d372713, v8
    v_mul_f32 v9, 0x3d372713, v9
    s_mov_b32 s25, 0
    v_mfma_f32_16x16x32_bf16 v[112:115], v[80:83], a[208:211], v[112:115]
    v_mul_f32 v13, 0x3d372713, v13
    v_mul_f32 v14, 0x3d372713, v14
    s_mov_b32 s7, s28
    v_mfma_f32_16x16x32_bf16 v[144:147], v[84:87], a[212:215], v[112:115]
    buffer_load_dwordx4 v[76:79], v192, s[48:51], s23 offen offset:3072 sc1
    v_mfma_f32_16x16x32_bf16 v[116:119], v[80:83], v[244:247], v[116:119]
    v_mul_f32 v8, v8, v4
    v_mul_f32 v9, v9, v5
    s_add_u32 s23, s23, 36864
    v_mfma_f32_16x16x32_bf16 v[148:151], v[84:87], v[248:251], v[116:119]
    v_mul_f32 v13, v13, v6
    v_mul_f32 v14, v14, v7
    v_add_u32 v12, s7, v184
    s_add_u32 s25, s25, 1
L_ffn_gu_40:
    s_waitcnt vmcnt(14)
    v_mfma_f32_16x16x32_bf16 v[88:91], v[16:19], a[0:3], 0
    v_mfma_f32_16x16x32_bf16 v[88:91], v[20:23], a[4:7], v[88:91]
    buffer_load_dwordx4 v[80:83], v184, s[48:51], s23 offen offset:0 sc1
    v_mfma_f32_16x16x32_bf16 v[92:95], v[16:19], a[72:75], 0
    v_mul_f32 v152, v120, v120
    v_mul_f32 v153, v121, v121
    v_mfma_f32_16x16x32_bf16 v[92:95], v[20:23], a[76:79], v[92:95]
    v_mul_f32 v154, v122, v122
    v_mul_f32 v155, v123, v123
    v_mfma_f32_16x16x32_bf16 v[96:99], v[16:19], a[144:147], 0
    v_fma_f32 v152, v152, v8, v4
    v_fma_f32 v153, v153, v8, v4
    v_mfma_f32_16x16x32_bf16 v[96:99], v[20:23], a[148:151], v[96:99]
    buffer_load_dwordx4 v[84:87], v184, s[48:51], s23 offen offset:1024 sc1
    v_mfma_f32_16x16x32_bf16 v[100:103], v[16:19], a[216:219], 0
    v_fma_f32 v154, v154, v8, v4
    v_fma_f32 v155, v155, v8, v4
    v_mfma_f32_16x16x32_bf16 v[100:103], v[20:23], a[220:223], v[100:103]
    v_mul_f32 v152, v120, v152
    v_mul_f32 v153, v121, v153
    s_waitcnt vmcnt(14)
    v_mfma_f32_16x16x32_bf16 v[104:107], v[24:27], a[0:3], 0
    v_mul_f32 v154, v122, v154
    v_mul_f32 v155, v123, v155
    v_mfma_f32_16x16x32_bf16 v[104:107], v[28:31], a[4:7], v[104:107]
    buffer_load_dwordx4 v[16:19], v184, s[48:51], s23 offen offset:2048 sc1
    v_mfma_f32_16x16x32_bf16 v[108:111], v[24:27], a[72:75], 0
    v_exp_f32 v152, v152
    v_mfma_f32_16x16x32_bf16 v[108:111], v[28:31], a[76:79], v[108:111]
    v_exp_f32 v153, v153
    v_mfma_f32_16x16x32_bf16 v[112:115], v[24:27], a[144:147], 0
    v_exp_f32 v154, v154
    v_mfma_f32_16x16x32_bf16 v[112:115], v[28:31], a[148:151], v[112:115]
    buffer_load_dwordx4 v[20:23], v184, s[48:51], s23 offen offset:3072 sc1
    v_mfma_f32_16x16x32_bf16 v[116:119], v[24:27], a[216:219], 0
    v_exp_f32 v155, v155
    v_mfma_f32_16x16x32_bf16 v[116:119], v[28:31], a[220:223], v[116:119]
    v_mul_f32 v156, v120, v136
    v_mul_f32 v157, v121, v137
    s_waitcnt vmcnt(14)
    v_mfma_f32_16x16x32_bf16 v[88:91], v[32:35], a[8:11], v[88:91]
    v_mul_f32 v158, v122, v138
    v_mul_f32 v159, v123, v139
    v_mfma_f32_16x16x32_bf16 v[88:91], v[36:39], a[12:15], v[88:91]
    buffer_load_dwordx4 v[24:27], v185, s[48:51], s23 offen offset:0 sc1
    v_mfma_f32_16x16x32_bf16 v[92:95], v[32:35], a[80:83], v[92:95]
    v_fma_f32 v152, v152, v193, v193
    v_fma_f32 v153, v153, v193, v193
    v_mfma_f32_16x16x32_bf16 v[92:95], v[36:39], a[84:87], v[92:95]
    v_fma_f32 v154, v154, v193, v193
    v_fma_f32 v155, v155, v193, v193
    v_mfma_f32_16x16x32_bf16 v[96:99], v[32:35], a[152:155], v[96:99]
    v_rcp_f32 v152, v152
    v_mfma_f32_16x16x32_bf16 v[96:99], v[36:39], a[156:159], v[96:99]
    buffer_load_dwordx4 v[28:31], v185, s[48:51], s23 offen offset:1024 sc1
    v_mfma_f32_16x16x32_bf16 v[100:103], v[32:35], a[224:227], v[100:103]
    v_rcp_f32 v153, v153
    v_mfma_f32_16x16x32_bf16 v[100:103], v[36:39], a[228:231], v[100:103]
    v_rcp_f32 v154, v154
    s_waitcnt vmcnt(14)
    v_mfma_f32_16x16x32_bf16 v[104:107], v[40:43], a[8:11], v[104:107]
    v_rcp_f32 v155, v155
    v_mfma_f32_16x16x32_bf16 v[104:107], v[44:47], a[12:15], v[104:107]
    buffer_load_dwordx4 v[32:35], v185, s[48:51], s23 offen offset:2048 sc1
    v_mfma_f32_16x16x32_bf16 v[108:111], v[40:43], a[80:83], v[108:111]
    v_mul_f32 v156, v156, v152
    v_mul_f32 v157, v157, v153
    v_mfma_f32_16x16x32_bf16 v[108:111], v[44:47], a[84:87], v[108:111]
    v_mul_f32 v158, v158, v154
    v_mul_f32 v159, v159, v155
    v_mfma_f32_16x16x32_bf16 v[112:115], v[40:43], a[152:155], v[112:115]
    v_cvt_pk_bf16_f32 v160, v156, v157
    v_cvt_pk_bf16_f32 v161, v158, v159
    v_mfma_f32_16x16x32_bf16 v[112:115], v[44:47], a[156:159], v[112:115]
    buffer_load_dwordx4 v[36:39], v185, s[48:51], s23 offen offset:3072 sc1
    v_mfma_f32_16x16x32_bf16 v[116:119], v[40:43], a[224:227], v[116:119]
    ds_write_b64 v12, v[160:161] offset:0
    v_mfma_f32_16x16x32_bf16 v[116:119], v[44:47], a[228:231], v[116:119]
    v_mul_f32 v162, v124, v124
    v_mul_f32 v163, v125, v125
    s_waitcnt vmcnt(14)
    v_mfma_f32_16x16x32_bf16 v[88:91], v[48:51], a[16:19], v[88:91]
    v_mul_f32 v164, v126, v126
    v_mul_f32 v165, v127, v127
    v_mfma_f32_16x16x32_bf16 v[88:91], v[52:55], a[20:23], v[88:91]
    buffer_load_dwordx4 v[40:43], v186, s[48:51], s23 offen offset:0 sc1
    v_mfma_f32_16x16x32_bf16 v[92:95], v[48:51], a[88:91], v[92:95]
    v_fma_f32 v162, v162, v9, v5
    v_fma_f32 v163, v163, v9, v5
    v_mfma_f32_16x16x32_bf16 v[92:95], v[52:55], a[92:95], v[92:95]
    v_fma_f32 v164, v164, v9, v5
    v_fma_f32 v165, v165, v9, v5
    v_mfma_f32_16x16x32_bf16 v[96:99], v[48:51], a[160:163], v[96:99]
    v_mul_f32 v162, v124, v162
    v_mul_f32 v163, v125, v163
    v_mfma_f32_16x16x32_bf16 v[96:99], v[52:55], a[164:167], v[96:99]
    buffer_load_dwordx4 v[44:47], v186, s[48:51], s23 offen offset:1024 sc1
    v_mfma_f32_16x16x32_bf16 v[100:103], v[48:51], a[232:235], v[100:103]
    v_mul_f32 v164, v126, v164
    v_mul_f32 v165, v127, v165
    v_mfma_f32_16x16x32_bf16 v[100:103], v[52:55], a[236:239], v[100:103]
    v_exp_f32 v162, v162
    s_waitcnt vmcnt(14)
    v_mfma_f32_16x16x32_bf16 v[104:107], v[56:59], a[16:19], v[104:107]
    v_exp_f32 v163, v163
    v_mfma_f32_16x16x32_bf16 v[104:107], v[60:63], a[20:23], v[104:107]
    buffer_load_dwordx4 v[48:51], v186, s[48:51], s23 offen offset:2048 sc1
    v_mfma_f32_16x16x32_bf16 v[108:111], v[56:59], a[88:91], v[108:111]
    v_exp_f32 v164, v164
    v_mfma_f32_16x16x32_bf16 v[108:111], v[60:63], a[92:95], v[108:111]
    v_exp_f32 v165, v165
    v_mfma_f32_16x16x32_bf16 v[112:115], v[56:59], a[160:163], v[112:115]
    v_mul_f32 v166, v124, v140
    v_mul_f32 v167, v125, v141
    v_mfma_f32_16x16x32_bf16 v[112:115], v[60:63], a[164:167], v[112:115]
    buffer_load_dwordx4 v[52:55], v186, s[48:51], s23 offen offset:3072 sc1
    v_mfma_f32_16x16x32_bf16 v[116:119], v[56:59], a[232:235], v[116:119]
    v_mul_f32 v168, v126, v142
    v_mul_f32 v169, v127, v143
    v_mfma_f32_16x16x32_bf16 v[116:119], v[60:63], a[236:239], v[116:119]
    v_fma_f32 v162, v162, v194, v194
    v_fma_f32 v163, v163, v194, v194
    s_waitcnt vmcnt(14)
    v_mfma_f32_16x16x32_bf16 v[88:91], v[64:67], a[24:27], v[88:91]
    v_fma_f32 v164, v164, v194, v194
    v_fma_f32 v165, v165, v194, v194
    v_mfma_f32_16x16x32_bf16 v[88:91], v[68:71], a[28:31], v[88:91]
    buffer_load_dwordx4 v[56:59], v187, s[48:51], s23 offen offset:0 sc1
    v_mfma_f32_16x16x32_bf16 v[92:95], v[64:67], a[96:99], v[92:95]
    v_rcp_f32 v162, v162
    v_mfma_f32_16x16x32_bf16 v[92:95], v[68:71], a[100:103], v[92:95]
    v_rcp_f32 v163, v163
    v_mfma_f32_16x16x32_bf16 v[96:99], v[64:67], a[168:171], v[96:99]
    v_rcp_f32 v164, v164
    v_mfma_f32_16x16x32_bf16 v[96:99], v[68:71], a[172:175], v[96:99]
    buffer_load_dwordx4 v[60:63], v187, s[48:51], s23 offen offset:1024 sc1
    v_mfma_f32_16x16x32_bf16 v[100:103], v[64:67], a[240:243], v[100:103]
    v_rcp_f32 v165, v165
    v_mfma_f32_16x16x32_bf16 v[100:103], v[68:71], a[244:247], v[100:103]
    v_mul_f32 v166, v166, v162
    v_mul_f32 v167, v167, v163
    s_waitcnt vmcnt(14)
    v_mfma_f32_16x16x32_bf16 v[104:107], v[72:75], a[24:27], v[104:107]
    v_mul_f32 v168, v168, v164
    v_mul_f32 v169, v169, v165
    v_mfma_f32_16x16x32_bf16 v[104:107], v[76:79], a[28:31], v[104:107]
    buffer_load_dwordx4 v[64:67], v187, s[48:51], s23 offen offset:2048 sc1
    v_mfma_f32_16x16x32_bf16 v[108:111], v[72:75], a[96:99], v[108:111]
    v_cvt_pk_bf16_f32 v170, v166, v167
    v_cvt_pk_bf16_f32 v171, v168, v169
    v_mfma_f32_16x16x32_bf16 v[108:111], v[76:79], a[100:103], v[108:111]
    ds_write_b64 v12, v[170:171] offset:18432
    v_mfma_f32_16x16x32_bf16 v[112:115], v[72:75], a[168:171], v[112:115]
    v_mul_f32 v152, v128, v128
    v_mul_f32 v153, v129, v129
    v_mfma_f32_16x16x32_bf16 v[112:115], v[76:79], a[172:175], v[112:115]
    buffer_load_dwordx4 v[68:71], v187, s[48:51], s23 offen offset:3072 sc1
    v_mfma_f32_16x16x32_bf16 v[116:119], v[72:75], a[240:243], v[116:119]
    v_mul_f32 v154, v130, v130
    v_mul_f32 v155, v131, v131
    v_mfma_f32_16x16x32_bf16 v[116:119], v[76:79], a[244:247], v[116:119]
    v_fma_f32 v152, v152, v13, v6
    v_fma_f32 v153, v153, v13, v6
    s_waitcnt vmcnt(14)
    v_mfma_f32_16x16x32_bf16 v[88:91], v[80:83], a[32:35], v[88:91]
    v_fma_f32 v154, v154, v13, v6
    v_fma_f32 v155, v155, v13, v6
    v_mfma_f32_16x16x32_bf16 v[88:91], v[84:87], a[36:39], v[88:91]
    buffer_load_dwordx4 v[72:75], v188, s[48:51], s23 offen offset:0 sc1
    v_mfma_f32_16x16x32_bf16 v[92:95], v[80:83], a[104:107], v[92:95]
    v_mul_f32 v152, v128, v152
    v_mul_f32 v153, v129, v153
    v_mfma_f32_16x16x32_bf16 v[92:95], v[84:87], a[108:111], v[92:95]
    v_mul_f32 v154, v130, v154
    v_mul_f32 v155, v131, v155
    v_mfma_f32_16x16x32_bf16 v[96:99], v[80:83], a[176:179], v[96:99]
    v_exp_f32 v152, v152
    v_mfma_f32_16x16x32_bf16 v[96:99], v[84:87], a[180:183], v[96:99]
    buffer_load_dwordx4 v[76:79], v188, s[48:51], s23 offen offset:1024 sc1
    v_mfma_f32_16x16x32_bf16 v[100:103], v[80:83], a[248:251], v[100:103]
    v_exp_f32 v153, v153
    v_mfma_f32_16x16x32_bf16 v[100:103], v[84:87], a[252:255], v[100:103]
    v_exp_f32 v154, v154
    s_waitcnt vmcnt(14)
    v_mfma_f32_16x16x32_bf16 v[104:107], v[16:19], a[32:35], v[104:107]
    v_exp_f32 v155, v155
    v_mfma_f32_16x16x32_bf16 v[104:107], v[20:23], a[36:39], v[104:107]
    buffer_load_dwordx4 v[80:83], v188, s[48:51], s23 offen offset:2048 sc1
    v_mfma_f32_16x16x32_bf16 v[108:111], v[16:19], a[104:107], v[108:111]
    v_mul_f32 v156, v128, v144
    v_mul_f32 v157, v129, v145
    v_mfma_f32_16x16x32_bf16 v[108:111], v[20:23], a[108:111], v[108:111]
    v_mul_f32 v158, v130, v146
    v_mul_f32 v159, v131, v147
    v_mfma_f32_16x16x32_bf16 v[112:115], v[16:19], a[176:179], v[112:115]
    v_fma_f32 v152, v152, v195, v195
    v_fma_f32 v153, v153, v195, v195
    v_mfma_f32_16x16x32_bf16 v[112:115], v[20:23], a[180:183], v[112:115]
    buffer_load_dwordx4 v[84:87], v188, s[48:51], s23 offen offset:3072 sc1
    v_mfma_f32_16x16x32_bf16 v[116:119], v[16:19], a[248:251], v[116:119]
    v_fma_f32 v154, v154, v195, v195
    v_fma_f32 v155, v155, v195, v195
    v_mfma_f32_16x16x32_bf16 v[116:119], v[20:23], a[252:255], v[116:119]
    v_rcp_f32 v152, v152
    s_waitcnt vmcnt(14)
    v_mfma_f32_16x16x32_bf16 v[88:91], v[24:27], a[40:43], v[88:91]
    v_rcp_f32 v153, v153
    v_mfma_f32_16x16x32_bf16 v[88:91], v[28:31], a[44:47], v[88:91]
    buffer_load_dwordx4 v[16:19], v189, s[48:51], s23 offen offset:0 sc1
    v_mfma_f32_16x16x32_bf16 v[92:95], v[24:27], a[112:115], v[92:95]
    v_rcp_f32 v154, v154
    v_mfma_f32_16x16x32_bf16 v[92:95], v[28:31], a[116:119], v[92:95]
    v_rcp_f32 v155, v155
    v_mfma_f32_16x16x32_bf16 v[96:99], v[24:27], a[184:187], v[96:99]
    v_mul_f32 v156, v156, v152
    v_mul_f32 v157, v157, v153
    v_mfma_f32_16x16x32_bf16 v[96:99], v[28:31], a[188:191], v[96:99]
    buffer_load_dwordx4 v[20:23], v189, s[48:51], s23 offen offset:1024 sc1
    v_mfma_f32_16x16x32_bf16 v[100:103], v[24:27], v[220:223], v[100:103]
    v_mul_f32 v158, v158, v154
    v_mul_f32 v159, v159, v155
    v_mfma_f32_16x16x32_bf16 v[100:103], v[28:31], v[224:227], v[100:103]
    v_cvt_pk_bf16_f32 v160, v156, v157
    v_cvt_pk_bf16_f32 v161, v158, v159
    s_waitcnt vmcnt(14)
    v_mfma_f32_16x16x32_bf16 v[104:107], v[32:35], a[40:43], v[104:107]
    ds_write_b64 v12, v[160:161] offset:36864
    v_mfma_f32_16x16x32_bf16 v[104:107], v[36:39], a[44:47], v[104:107]
    buffer_load_dwordx4 v[24:27], v189, s[48:51], s23 offen offset:2048 sc1
    v_mfma_f32_16x16x32_bf16 v[108:111], v[32:35], a[112:115], v[108:111]
    v_mul_f32 v162, v132, v132
    v_mul_f32 v163, v133, v133
    v_mfma_f32_16x16x32_bf16 v[108:111], v[36:39], a[116:119], v[108:111]
    v_mul_f32 v164, v134, v134
    v_mul_f32 v165, v135, v135
    v_mfma_f32_16x16x32_bf16 v[112:115], v[32:35], a[184:187], v[112:115]
    v_fma_f32 v162, v162, v14, v7
    v_fma_f32 v163, v163, v14, v7
    v_mfma_f32_16x16x32_bf16 v[112:115], v[36:39], a[188:191], v[112:115]
    buffer_load_dwordx4 v[28:31], v189, s[48:51], s23 offen offset:3072 sc1
    v_mfma_f32_16x16x32_bf16 v[116:119], v[32:35], v[220:223], v[116:119]
    v_fma_f32 v164, v164, v14, v7
    v_fma_f32 v165, v165, v14, v7
    v_mfma_f32_16x16x32_bf16 v[116:119], v[36:39], v[224:227], v[116:119]
    v_mul_f32 v162, v132, v162
    v_mul_f32 v163, v133, v163
    s_waitcnt vmcnt(14)
    v_mfma_f32_16x16x32_bf16 v[88:91], v[40:43], a[48:51], v[88:91]
    v_mul_f32 v164, v134, v164
    v_mul_f32 v165, v135, v165
    v_mfma_f32_16x16x32_bf16 v[88:91], v[44:47], a[52:55], v[88:91]
    buffer_load_dwordx4 v[32:35], v190, s[48:51], s23 offen offset:0 sc1
    v_mfma_f32_16x16x32_bf16 v[92:95], v[40:43], a[120:123], v[92:95]
    v_exp_f32 v162, v162
    v_mfma_f32_16x16x32_bf16 v[92:95], v[44:47], a[124:127], v[92:95]
    v_exp_f32 v163, v163
    v_mfma_f32_16x16x32_bf16 v[96:99], v[40:43], a[192:195], v[96:99]
    v_exp_f32 v164, v164
    v_mfma_f32_16x16x32_bf16 v[96:99], v[44:47], a[196:199], v[96:99]
    buffer_load_dwordx4 v[36:39], v190, s[48:51], s23 offen offset:1024 sc1
    v_mfma_f32_16x16x32_bf16 v[100:103], v[40:43], v[228:231], v[100:103]
    v_exp_f32 v165, v165
    v_mfma_f32_16x16x32_bf16 v[100:103], v[44:47], v[232:235], v[100:103]
    v_mul_f32 v166, v132, v148
    v_mul_f32 v167, v133, v149
    s_waitcnt vmcnt(14)
    v_mfma_f32_16x16x32_bf16 v[104:107], v[48:51], a[48:51], v[104:107]
    v_mul_f32 v168, v134, v150
    v_mul_f32 v169, v135, v151
    v_mfma_f32_16x16x32_bf16 v[104:107], v[52:55], a[52:55], v[104:107]
    buffer_load_dwordx4 v[40:43], v190, s[48:51], s23 offen offset:2048 sc1
    v_mfma_f32_16x16x32_bf16 v[108:111], v[48:51], a[120:123], v[108:111]
    v_fma_f32 v162, v162, v252, v252
    v_fma_f32 v163, v163, v252, v252
    v_mfma_f32_16x16x32_bf16 v[108:111], v[52:55], a[124:127], v[108:111]
    v_fma_f32 v164, v164, v252, v252
    v_fma_f32 v165, v165, v252, v252
    v_mfma_f32_16x16x32_bf16 v[112:115], v[48:51], a[192:195], v[112:115]
    v_rcp_f32 v162, v162
    v_mfma_f32_16x16x32_bf16 v[112:115], v[52:55], a[196:199], v[112:115]
    buffer_load_dwordx4 v[44:47], v190, s[48:51], s23 offen offset:3072 sc1
    v_mfma_f32_16x16x32_bf16 v[116:119], v[48:51], v[228:231], v[116:119]
    v_rcp_f32 v163, v163
    v_mfma_f32_16x16x32_bf16 v[116:119], v[52:55], v[232:235], v[116:119]
    v_rcp_f32 v164, v164
    s_waitcnt vmcnt(14)
    v_mfma_f32_16x16x32_bf16 v[88:91], v[56:59], a[56:59], v[88:91]
    v_rcp_f32 v165, v165
    v_mfma_f32_16x16x32_bf16 v[88:91], v[60:63], a[60:63], v[88:91]
    buffer_load_dwordx4 v[48:51], v191, s[48:51], s23 offen offset:0 sc1
    v_mfma_f32_16x16x32_bf16 v[92:95], v[56:59], a[128:131], v[92:95]
    v_mul_f32 v166, v166, v162
    v_mul_f32 v167, v167, v163
    v_mfma_f32_16x16x32_bf16 v[92:95], v[60:63], a[132:135], v[92:95]
    v_mul_f32 v168, v168, v164
    v_mul_f32 v169, v169, v165
    v_mfma_f32_16x16x32_bf16 v[96:99], v[56:59], a[200:203], v[96:99]
    v_cvt_pk_bf16_f32 v170, v166, v167
    v_cvt_pk_bf16_f32 v171, v168, v169
    v_mfma_f32_16x16x32_bf16 v[96:99], v[60:63], a[204:207], v[96:99]
    buffer_load_dwordx4 v[52:55], v191, s[48:51], s23 offen offset:1024 sc1
    v_mfma_f32_16x16x32_bf16 v[100:103], v[56:59], v[236:239], v[100:103]
    ds_write_b64 v12, v[170:171] offset:55296
    v_mfma_f32_16x16x32_bf16 v[100:103], v[60:63], v[240:243], v[100:103]
    s_waitcnt vmcnt(14)
    v_mfma_f32_16x16x32_bf16 v[104:107], v[64:67], a[56:59], v[104:107]
    v_mfma_f32_16x16x32_bf16 v[104:107], v[68:71], a[60:63], v[104:107]
    buffer_load_dwordx4 v[56:59], v191, s[48:51], s23 offen offset:2048 sc1
    v_mfma_f32_16x16x32_bf16 v[108:111], v[64:67], a[128:131], v[108:111]
    v_mfma_f32_16x16x32_bf16 v[108:111], v[68:71], a[132:135], v[108:111]
    v_mfma_f32_16x16x32_bf16 v[112:115], v[64:67], a[200:203], v[112:115]
    v_mfma_f32_16x16x32_bf16 v[112:115], v[68:71], a[204:207], v[112:115]
    buffer_load_dwordx4 v[60:63], v191, s[48:51], s23 offen offset:3072 sc1
    v_mfma_f32_16x16x32_bf16 v[116:119], v[64:67], v[236:239], v[116:119]
    v_mfma_f32_16x16x32_bf16 v[116:119], v[68:71], v[240:243], v[116:119]
    s_waitcnt vmcnt(14)
    v_mfma_f32_16x16x32_bf16 v[88:91], v[72:75], a[64:67], v[88:91]
    v_mfma_f32_16x16x32_bf16 v[120:123], v[76:79], a[68:71], v[88:91]
    buffer_load_dwordx4 v[64:67], v192, s[48:51], s23 offen offset:0 sc1
    v_mfma_f32_16x16x32_bf16 v[92:95], v[72:75], a[136:139], v[92:95]
    v_mfma_f32_16x16x32_bf16 v[124:127], v[76:79], a[140:143], v[92:95]
    v_mfma_f32_16x16x32_bf16 v[96:99], v[72:75], a[208:211], v[96:99]
    v_mfma_f32_16x16x32_bf16 v[128:131], v[76:79], a[212:215], v[96:99]
    buffer_load_dwordx4 v[68:71], v192, s[48:51], s23 offen offset:1024 sc1
    v_mfma_f32_16x16x32_bf16 v[100:103], v[72:75], v[244:247], v[100:103]
    v_mfma_f32_16x16x32_bf16 v[132:135], v[76:79], v[248:251], v[100:103]
    s_waitcnt vmcnt(14)
    v_mfma_f32_16x16x32_bf16 v[104:107], v[80:83], a[64:67], v[104:107]
    v_mfma_f32_16x16x32_bf16 v[136:139], v[84:87], a[68:71], v[104:107]
    buffer_load_dwordx4 v[72:75], v192, s[48:51], s23 offen offset:2048 sc1
    v_mfma_f32_16x16x32_bf16 v[108:111], v[80:83], a[136:139], v[108:111]
    v_mfma_f32_16x16x32_bf16 v[140:143], v[84:87], a[140:143], v[108:111]
    s_lshl_b32 s7, s25, 11
    v_mfma_f32_16x16x32_bf16 v[112:115], v[80:83], a[208:211], v[112:115]
    s_add_u32 s7, s7, s28
    v_mfma_f32_16x16x32_bf16 v[144:147], v[84:87], a[212:215], v[112:115]
    buffer_load_dwordx4 v[76:79], v192, s[48:51], s23 offen offset:3072 sc1
    v_mfma_f32_16x16x32_bf16 v[116:119], v[80:83], v[244:247], v[116:119]
    s_add_u32 s23, s23, 36864
    v_mfma_f32_16x16x32_bf16 v[148:151], v[84:87], v[248:251], v[116:119]
    v_add_u32 v12, s7, v184
    s_add_u32 s25, s25, 1
    s_cmp_lt_u32 s25, 8
    s_cbranch_scc1 L_ffn_gu_40
    v_add_u32 v10, 73728, v184
    v_add_u32 v11, 110592, v184
    s_lshr_b32 s7, s2, 3
    s_lshl_b32 s7, s7, 2
    s_add_u32 s7, s7, s3
    s_lshl_b32 s7, s7, 9
    v_lshrrev_b32 v1, 1, v253
    v_add_u32 v1, s7, v1
    buffer_load_dwordx2 v[2:3], v1, s[96:99], 0 offen
    s_waitcnt lgkmcnt(0)
    s_barrier
    s_waitcnt vmcnt(14)
    v_mfma_f32_16x16x32_bf16 v[88:91], v[16:19], a[0:3], 0
    v_mfma_f32_16x16x32_bf16 v[88:91], v[20:23], a[4:7], v[88:91]
    buffer_load_dwordx4 v[80:83], v184, s[48:51], s23 offen offset:0 sc1
    v_mfma_f32_16x16x32_bf16 v[92:95], v[16:19], a[72:75], 0
    v_mul_f32 v152, v120, v120
    v_mul_f32 v153, v121, v121
    v_mfma_f32_16x16x32_bf16 v[92:95], v[20:23], a[76:79], v[92:95]
    v_mul_f32 v154, v122, v122
    v_mul_f32 v155, v123, v123
    v_mfma_f32_16x16x32_bf16 v[96:99], v[16:19], a[144:147], 0
    v_fma_f32 v152, v152, v8, v4
    v_fma_f32 v153, v153, v8, v4
    v_mfma_f32_16x16x32_bf16 v[96:99], v[20:23], a[148:151], v[96:99]
    buffer_load_dwordx4 v[84:87], v184, s[48:51], s23 offen offset:1024 sc1
    v_mfma_f32_16x16x32_bf16 v[100:103], v[16:19], a[216:219], 0
    v_fma_f32 v154, v154, v8, v4
    v_fma_f32 v155, v155, v8, v4
    v_mfma_f32_16x16x32_bf16 v[100:103], v[20:23], a[220:223], v[100:103]
    v_mul_f32 v152, v120, v152
    v_mul_f32 v153, v121, v153
    s_waitcnt vmcnt(14)
    v_mfma_f32_16x16x32_bf16 v[104:107], v[24:27], a[0:3], 0
    v_mul_f32 v154, v122, v154
    v_mul_f32 v155, v123, v155
    ds_read_b128 a[0:3], v10 offset:0
    v_mfma_f32_16x16x32_bf16 v[104:107], v[28:31], a[4:7], v[104:107]
    buffer_load_dwordx4 v[16:19], v184, s[48:51], s23 offen offset:2048 sc1
    v_mfma_f32_16x16x32_bf16 v[108:111], v[24:27], a[72:75], 0
    v_exp_f32 v152, v152
    ds_read_b128 a[72:75], v10 offset:18432
    v_mfma_f32_16x16x32_bf16 v[108:111], v[28:31], a[76:79], v[108:111]
    v_exp_f32 v153, v153
    v_mfma_f32_16x16x32_bf16 v[112:115], v[24:27], a[144:147], 0
    v_exp_f32 v154, v154
    ds_read_b128 a[144:147], v11 offset:0
    v_mfma_f32_16x16x32_bf16 v[112:115], v[28:31], a[148:151], v[112:115]
    buffer_load_dwordx4 v[20:23], v184, s[48:51], s23 offen offset:3072 sc1
    v_mfma_f32_16x16x32_bf16 v[116:119], v[24:27], a[216:219], 0
    v_exp_f32 v155, v155
    ds_read_b128 a[216:219], v11 offset:18432
    v_mfma_f32_16x16x32_bf16 v[116:119], v[28:31], a[220:223], v[116:119]
    v_mul_f32 v156, v120, v136
    v_mul_f32 v157, v121, v137
    ds_read_b128 a[4:7], v10 offset:1024
    s_waitcnt vmcnt(14)
    v_mfma_f32_16x16x32_bf16 v[88:91], v[32:35], a[8:11], v[88:91]
    v_mul_f32 v158, v122, v138
    v_mul_f32 v159, v123, v139
    ds_read_b128 a[76:79], v10 offset:19456
    v_mfma_f32_16x16x32_bf16 v[88:91], v[36:39], a[12:15], v[88:91]
    buffer_load_dwordx4 v[24:27], v185, s[48:51], s23 offen offset:0 sc1
    v_mfma_f32_16x16x32_bf16 v[92:95], v[32:35], a[80:83], v[92:95]
    v_fma_f32 v152, v152, v193, v193
    v_fma_f32 v153, v153, v193, v193
    ds_read_b128 a[148:151], v11 offset:1024
    v_mfma_f32_16x16x32_bf16 v[92:95], v[36:39], a[84:87], v[92:95]
    v_fma_f32 v154, v154, v193, v193
    v_fma_f32 v155, v155, v193, v193
    ds_read_b128 a[220:223], v11 offset:19456
    v_mfma_f32_16x16x32_bf16 v[96:99], v[32:35], a[152:155], v[96:99]
    v_rcp_f32 v152, v152
    v_mfma_f32_16x16x32_bf16 v[96:99], v[36:39], a[156:159], v[96:99]
    buffer_load_dwordx4 v[28:31], v185, s[48:51], s23 offen offset:1024 sc1
    v_mfma_f32_16x16x32_bf16 v[100:103], v[32:35], a[224:227], v[100:103]
    v_rcp_f32 v153, v153
    v_mfma_f32_16x16x32_bf16 v[100:103], v[36:39], a[228:231], v[100:103]
    v_rcp_f32 v154, v154
    s_waitcnt vmcnt(14)
    v_mfma_f32_16x16x32_bf16 v[104:107], v[40:43], a[8:11], v[104:107]
    v_rcp_f32 v155, v155
    ds_read_b128 a[8:11], v10 offset:2048
    v_mfma_f32_16x16x32_bf16 v[104:107], v[44:47], a[12:15], v[104:107]
    buffer_load_dwordx4 v[32:35], v185, s[48:51], s23 offen offset:2048 sc1
    v_mfma_f32_16x16x32_bf16 v[108:111], v[40:43], a[80:83], v[108:111]
    v_mul_f32 v156, v156, v152
    v_mul_f32 v157, v157, v153
    ds_read_b128 a[80:83], v10 offset:20480
    v_mfma_f32_16x16x32_bf16 v[108:111], v[44:47], a[84:87], v[108:111]
    v_mul_f32 v158, v158, v154
    v_mul_f32 v159, v159, v155
    v_mfma_f32_16x16x32_bf16 v[112:115], v[40:43], a[152:155], v[112:115]
    v_cvt_pk_bf16_f32 v160, v156, v157
    v_cvt_pk_bf16_f32 v161, v158, v159
    ds_read_b128 a[152:155], v11 offset:2048
    v_mfma_f32_16x16x32_bf16 v[112:115], v[44:47], a[156:159], v[112:115]
    buffer_load_dwordx4 v[36:39], v185, s[48:51], s23 offen offset:3072 sc1
    v_mfma_f32_16x16x32_bf16 v[116:119], v[40:43], a[224:227], v[116:119]
    ds_write_b64 v12, v[160:161] offset:0
    v_mfma_f32_16x16x32_bf16 v[116:119], v[44:47], a[228:231], v[116:119]
    v_mul_f32 v162, v124, v124
    v_mul_f32 v163, v125, v125
    ds_read_b128 a[224:227], v11 offset:20480
    s_waitcnt vmcnt(14)
    v_mfma_f32_16x16x32_bf16 v[88:91], v[48:51], a[16:19], v[88:91]
    v_mul_f32 v164, v126, v126
    v_mul_f32 v165, v127, v127
    ds_read_b128 a[12:15], v10 offset:3072
    v_mfma_f32_16x16x32_bf16 v[88:91], v[52:55], a[20:23], v[88:91]
    buffer_load_dwordx4 v[40:43], v186, s[48:51], s23 offen offset:0 sc1
    v_mfma_f32_16x16x32_bf16 v[92:95], v[48:51], a[88:91], v[92:95]
    v_fma_f32 v162, v162, v9, v5
    v_fma_f32 v163, v163, v9, v5
    ds_read_b128 a[84:87], v10 offset:21504
    v_mfma_f32_16x16x32_bf16 v[92:95], v[52:55], a[92:95], v[92:95]
    v_fma_f32 v164, v164, v9, v5
    v_fma_f32 v165, v165, v9, v5
    ds_read_b128 a[156:159], v11 offset:3072
    v_mfma_f32_16x16x32_bf16 v[96:99], v[48:51], a[160:163], v[96:99]
    v_mul_f32 v162, v124, v162
    v_mul_f32 v163, v125, v163
    ds_read_b128 a[228:231], v11 offset:21504
    v_mfma_f32_16x16x32_bf16 v[96:99], v[52:55], a[164:167], v[96:99]
    buffer_load_dwordx4 v[44:47], v186, s[48:51], s23 offen offset:1024 sc1
    v_mfma_f32_16x16x32_bf16 v[100:103], v[48:51], a[232:235], v[100:103]
    v_mul_f32 v164, v126, v164
    v_mul_f32 v165, v127, v165
    v_mfma_f32_16x16x32_bf16 v[100:103], v[52:55], a[236:239], v[100:103]
    v_exp_f32 v162, v162
    s_waitcnt vmcnt(14)
    v_mfma_f32_16x16x32_bf16 v[104:107], v[56:59], a[16:19], v[104:107]
    v_exp_f32 v163, v163
    ds_read_b128 a[16:19], v10 offset:4096
    v_mfma_f32_16x16x32_bf16 v[104:107], v[60:63], a[20:23], v[104:107]
    buffer_load_dwordx4 v[48:51], v186, s[48:51], s23 offen offset:2048 sc1
    v_mfma_f32_16x16x32_bf16 v[108:111], v[56:59], a[88:91], v[108:111]
    v_exp_f32 v164, v164
    ds_read_b128 a[88:91], v10 offset:22528
    v_mfma_f32_16x16x32_bf16 v[108:111], v[60:63], a[92:95], v[108:111]
    v_exp_f32 v165, v165
    v_mfma_f32_16x16x32_bf16 v[112:115], v[56:59], a[160:163], v[112:115]
    v_mul_f32 v166, v124, v140
    v_mul_f32 v167, v125, v141
    ds_read_b128 a[160:163], v11 offset:4096
    v_mfma_f32_16x16x32_bf16 v[112:115], v[60:63], a[164:167], v[112:115]
    buffer_load_dwordx4 v[52:55], v186, s[48:51], s23 offen offset:3072 sc1
    v_mfma_f32_16x16x32_bf16 v[116:119], v[56:59], a[232:235], v[116:119]
    v_mul_f32 v168, v126, v142
    v_mul_f32 v169, v127, v143
    ds_read_b128 a[232:235], v11 offset:22528
    v_mfma_f32_16x16x32_bf16 v[116:119], v[60:63], a[236:239], v[116:119]
    v_fma_f32 v162, v162, v194, v194
    v_fma_f32 v163, v163, v194, v194
    ds_read_b128 a[20:23], v10 offset:5120
    s_waitcnt vmcnt(14)
    v_mfma_f32_16x16x32_bf16 v[88:91], v[64:67], a[24:27], v[88:91]
    v_fma_f32 v164, v164, v194, v194
    v_fma_f32 v165, v165, v194, v194
    ds_read_b128 a[92:95], v10 offset:23552
    v_mfma_f32_16x16x32_bf16 v[88:91], v[68:71], a[28:31], v[88:91]
    buffer_load_dwordx4 v[56:59], v187, s[48:51], s23 offen offset:0 sc1
    v_mfma_f32_16x16x32_bf16 v[92:95], v[64:67], a[96:99], v[92:95]
    v_rcp_f32 v162, v162
    ds_read_b128 a[164:167], v11 offset:5120
    v_mfma_f32_16x16x32_bf16 v[92:95], v[68:71], a[100:103], v[92:95]
    v_rcp_f32 v163, v163
    ds_read_b128 a[236:239], v11 offset:23552
    v_mfma_f32_16x16x32_bf16 v[96:99], v[64:67], a[168:171], v[96:99]
    v_rcp_f32 v164, v164
    v_mfma_f32_16x16x32_bf16 v[96:99], v[68:71], a[172:175], v[96:99]
    buffer_load_dwordx4 v[60:63], v187, s[48:51], s23 offen offset:1024 sc1
    v_mfma_f32_16x16x32_bf16 v[100:103], v[64:67], a[240:243], v[100:103]
    v_rcp_f32 v165, v165
    v_mfma_f32_16x16x32_bf16 v[100:103], v[68:71], a[244:247], v[100:103]
    v_mul_f32 v166, v166, v162
    v_mul_f32 v167, v167, v163
    s_waitcnt vmcnt(14)
    v_mfma_f32_16x16x32_bf16 v[104:107], v[72:75], a[24:27], v[104:107]
    v_mul_f32 v168, v168, v164
    v_mul_f32 v169, v169, v165
    ds_read_b128 a[24:27], v10 offset:6144
    v_mfma_f32_16x16x32_bf16 v[104:107], v[76:79], a[28:31], v[104:107]
    buffer_load_dwordx4 v[64:67], v187, s[48:51], s23 offen offset:2048 sc1
    v_mfma_f32_16x16x32_bf16 v[108:111], v[72:75], a[96:99], v[108:111]
    v_cvt_pk_bf16_f32 v170, v166, v167
    v_cvt_pk_bf16_f32 v171, v168, v169
    ds_read_b128 a[96:99], v10 offset:24576
    v_mfma_f32_16x16x32_bf16 v[108:111], v[76:79], a[100:103], v[108:111]
    ds_write_b64 v12, v[170:171] offset:18432
    v_mfma_f32_16x16x32_bf16 v[112:115], v[72:75], a[168:171], v[112:115]
    v_mul_f32 v152, v128, v128
    v_mul_f32 v153, v129, v129
    ds_read_b128 a[168:171], v11 offset:6144
    v_mfma_f32_16x16x32_bf16 v[112:115], v[76:79], a[172:175], v[112:115]
    buffer_load_dwordx4 v[68:71], v187, s[48:51], s23 offen offset:3072 sc1
    v_mfma_f32_16x16x32_bf16 v[116:119], v[72:75], a[240:243], v[116:119]
    v_mul_f32 v154, v130, v130
    v_mul_f32 v155, v131, v131
    ds_read_b128 a[240:243], v11 offset:24576
    v_mfma_f32_16x16x32_bf16 v[116:119], v[76:79], a[244:247], v[116:119]
    v_fma_f32 v152, v152, v13, v6
    v_fma_f32 v153, v153, v13, v6
    ds_read_b128 a[28:31], v10 offset:7168
    s_waitcnt vmcnt(14)
    v_mfma_f32_16x16x32_bf16 v[88:91], v[80:83], a[32:35], v[88:91]
    v_fma_f32 v154, v154, v13, v6
    v_fma_f32 v155, v155, v13, v6
    ds_read_b128 a[100:103], v10 offset:25600
    v_mfma_f32_16x16x32_bf16 v[88:91], v[84:87], a[36:39], v[88:91]
    buffer_load_dwordx4 v[72:75], v188, s[48:51], s23 offen offset:0 sc1
    v_mfma_f32_16x16x32_bf16 v[92:95], v[80:83], a[104:107], v[92:95]
    v_mul_f32 v152, v128, v152
    v_mul_f32 v153, v129, v153
    ds_read_b128 a[172:175], v11 offset:7168
    v_mfma_f32_16x16x32_bf16 v[92:95], v[84:87], a[108:111], v[92:95]
    v_mul_f32 v154, v130, v154
    v_mul_f32 v155, v131, v155
    ds_read_b128 a[244:247], v11 offset:25600
    v_mfma_f32_16x16x32_bf16 v[96:99], v[80:83], a[176:179], v[96:99]
    v_exp_f32 v152, v152
    v_mfma_f32_16x16x32_bf16 v[96:99], v[84:87], a[180:183], v[96:99]
    buffer_load_dwordx4 v[76:79], v188, s[48:51], s23 offen offset:1024 sc1
    v_mfma_f32_16x16x32_bf16 v[100:103], v[80:83], a[248:251], v[100:103]
    v_exp_f32 v153, v153
    v_mfma_f32_16x16x32_bf16 v[100:103], v[84:87], a[252:255], v[100:103]
    v_exp_f32 v154, v154
    s_waitcnt vmcnt(14)
    v_mfma_f32_16x16x32_bf16 v[104:107], v[16:19], a[32:35], v[104:107]
    v_exp_f32 v155, v155
    ds_read_b128 a[32:35], v10 offset:8192
    v_mfma_f32_16x16x32_bf16 v[104:107], v[20:23], a[36:39], v[104:107]
    buffer_load_dwordx4 v[80:83], v188, s[48:51], s23 offen offset:2048 sc1
    v_mfma_f32_16x16x32_bf16 v[108:111], v[16:19], a[104:107], v[108:111]
    v_mul_f32 v156, v128, v144
    v_mul_f32 v157, v129, v145
    ds_read_b128 a[104:107], v10 offset:26624
    v_mfma_f32_16x16x32_bf16 v[108:111], v[20:23], a[108:111], v[108:111]
    v_mul_f32 v158, v130, v146
    v_mul_f32 v159, v131, v147
    v_mfma_f32_16x16x32_bf16 v[112:115], v[16:19], a[176:179], v[112:115]
    v_fma_f32 v152, v152, v195, v195
    v_fma_f32 v153, v153, v195, v195
    ds_read_b128 a[176:179], v11 offset:8192
    v_mfma_f32_16x16x32_bf16 v[112:115], v[20:23], a[180:183], v[112:115]
    buffer_load_dwordx4 v[84:87], v188, s[48:51], s23 offen offset:3072 sc1
    v_mfma_f32_16x16x32_bf16 v[116:119], v[16:19], a[248:251], v[116:119]
    v_fma_f32 v154, v154, v195, v195
    v_fma_f32 v155, v155, v195, v195
    ds_read_b128 a[248:251], v11 offset:26624
    v_mfma_f32_16x16x32_bf16 v[116:119], v[20:23], a[252:255], v[116:119]
    v_rcp_f32 v152, v152
    ds_read_b128 a[36:39], v10 offset:9216
    s_waitcnt vmcnt(14)
    v_mfma_f32_16x16x32_bf16 v[88:91], v[24:27], a[40:43], v[88:91]
    v_rcp_f32 v153, v153
    ds_read_b128 a[108:111], v10 offset:27648
    v_mfma_f32_16x16x32_bf16 v[88:91], v[28:31], a[44:47], v[88:91]
    buffer_load_dwordx4 v[16:19], v189, s[48:51], s23 offen offset:0 sc1
    v_mfma_f32_16x16x32_bf16 v[92:95], v[24:27], a[112:115], v[92:95]
    v_rcp_f32 v154, v154
    ds_read_b128 a[180:183], v11 offset:9216
    v_mfma_f32_16x16x32_bf16 v[92:95], v[28:31], a[116:119], v[92:95]
    v_rcp_f32 v155, v155
    ds_read_b128 a[252:255], v11 offset:27648
    v_mfma_f32_16x16x32_bf16 v[96:99], v[24:27], a[184:187], v[96:99]
    v_mul_f32 v156, v156, v152
    v_mul_f32 v157, v157, v153
    v_mfma_f32_16x16x32_bf16 v[96:99], v[28:31], a[188:191], v[96:99]
    buffer_load_dwordx4 v[20:23], v189, s[48:51], s23 offen offset:1024 sc1
    v_mfma_f32_16x16x32_bf16 v[100:103], v[24:27], v[220:223], v[100:103]
    v_mul_f32 v158, v158, v154
    v_mul_f32 v159, v159, v155
    v_mfma_f32_16x16x32_bf16 v[100:103], v[28:31], v[224:227], v[100:103]
    v_cvt_pk_bf16_f32 v160, v156, v157
    v_cvt_pk_bf16_f32 v161, v158, v159
    s_waitcnt vmcnt(14)
    v_mfma_f32_16x16x32_bf16 v[104:107], v[32:35], a[40:43], v[104:107]
    ds_write_b64 v12, v[160:161] offset:36864
    v_mfma_f32_16x16x32_bf16 v[104:107], v[36:39], a[44:47], v[104:107]
    buffer_load_dwordx4 v[24:27], v189, s[48:51], s23 offen offset:2048 sc1
    v_mfma_f32_16x16x32_bf16 v[108:111], v[32:35], a[112:115], v[108:111]
    v_mul_f32 v162, v132, v132
    v_mul_f32 v163, v133, v133
    ds_read_b128 a[40:43], v10 offset:10240
    v_mfma_f32_16x16x32_bf16 v[108:111], v[36:39], a[116:119], v[108:111]
    v_mul_f32 v164, v134, v134
    v_mul_f32 v165, v135, v135
    ds_read_b128 a[112:115], v10 offset:28672
    v_mfma_f32_16x16x32_bf16 v[112:115], v[32:35], a[184:187], v[112:115]
    v_fma_f32 v162, v162, v14, v7
    v_fma_f32 v163, v163, v14, v7
    ds_read_b128 a[184:187], v11 offset:10240
    v_mfma_f32_16x16x32_bf16 v[112:115], v[36:39], a[188:191], v[112:115]
    buffer_load_dwordx4 v[28:31], v189, s[48:51], s23 offen offset:3072 sc1
    v_mfma_f32_16x16x32_bf16 v[116:119], v[32:35], v[220:223], v[116:119]
    v_fma_f32 v164, v164, v14, v7
    v_fma_f32 v165, v165, v14, v7
    ds_read_b128 v[220:223], v11 offset:28672
    v_mfma_f32_16x16x32_bf16 v[116:119], v[36:39], v[224:227], v[116:119]
    v_mul_f32 v162, v132, v162
    v_mul_f32 v163, v133, v163
    ds_read_b128 a[44:47], v10 offset:11264
    s_waitcnt vmcnt(14)
    v_mfma_f32_16x16x32_bf16 v[88:91], v[40:43], a[48:51], v[88:91]
    v_mul_f32 v164, v134, v164
    v_mul_f32 v165, v135, v165
    ds_read_b128 a[116:119], v10 offset:29696
    v_mfma_f32_16x16x32_bf16 v[88:91], v[44:47], a[52:55], v[88:91]
    buffer_load_dwordx4 v[32:35], v190, s[48:51], s23 offen offset:0 sc1
    v_mfma_f32_16x16x32_bf16 v[92:95], v[40:43], a[120:123], v[92:95]
    v_exp_f32 v162, v162
    ds_read_b128 a[188:191], v11 offset:11264
    v_mfma_f32_16x16x32_bf16 v[92:95], v[44:47], a[124:127], v[92:95]
    v_exp_f32 v163, v163
    ds_read_b128 v[224:227], v11 offset:29696
    v_mfma_f32_16x16x32_bf16 v[96:99], v[40:43], a[192:195], v[96:99]
    v_exp_f32 v164, v164
    v_mfma_f32_16x16x32_bf16 v[96:99], v[44:47], a[196:199], v[96:99]
    buffer_load_dwordx4 v[36:39], v190, s[48:51], s23 offen offset:1024 sc1
    v_mfma_f32_16x16x32_bf16 v[100:103], v[40:43], v[228:231], v[100:103]
    v_exp_f32 v165, v165
    v_mfma_f32_16x16x32_bf16 v[100:103], v[44:47], v[232:235], v[100:103]
    v_mul_f32 v166, v132, v148
    v_mul_f32 v167, v133, v149
    s_waitcnt vmcnt(14)
    v_mfma_f32_16x16x32_bf16 v[104:107], v[48:51], a[48:51], v[104:107]
    v_mul_f32 v168, v134, v150
    v_mul_f32 v169, v135, v151
    ds_read_b128 a[48:51], v10 offset:12288
    v_mfma_f32_16x16x32_bf16 v[104:107], v[52:55], a[52:55], v[104:107]
    buffer_load_dwordx4 v[40:43], v190, s[48:51], s23 offen offset:2048 sc1
    v_mfma_f32_16x16x32_bf16 v[108:111], v[48:51], a[120:123], v[108:111]
    v_fma_f32 v162, v162, v252, v252
    v_fma_f32 v163, v163, v252, v252
    ds_read_b128 a[120:123], v10 offset:30720
    v_mfma_f32_16x16x32_bf16 v[108:111], v[52:55], a[124:127], v[108:111]
    v_fma_f32 v164, v164, v252, v252
    v_fma_f32 v165, v165, v252, v252
    v_mfma_f32_16x16x32_bf16 v[112:115], v[48:51], a[192:195], v[112:115]
    v_rcp_f32 v162, v162
    ds_read_b128 a[192:195], v11 offset:12288
    v_mfma_f32_16x16x32_bf16 v[112:115], v[52:55], a[196:199], v[112:115]
    buffer_load_dwordx4 v[44:47], v190, s[48:51], s23 offen offset:3072 sc1
    v_mfma_f32_16x16x32_bf16 v[116:119], v[48:51], v[228:231], v[116:119]
    v_rcp_f32 v163, v163
    ds_read_b128 v[228:231], v11 offset:30720
    v_mfma_f32_16x16x32_bf16 v[116:119], v[52:55], v[232:235], v[116:119]
    v_rcp_f32 v164, v164
    ds_read_b128 a[52:55], v10 offset:13312
    s_waitcnt vmcnt(14)
    v_mfma_f32_16x16x32_bf16 v[88:91], v[56:59], a[56:59], v[88:91]
    v_rcp_f32 v165, v165
    ds_read_b128 a[124:127], v10 offset:31744
    v_mfma_f32_16x16x32_bf16 v[88:91], v[60:63], a[60:63], v[88:91]
    buffer_load_dwordx4 v[48:51], v191, s[48:51], s23 offen offset:0 sc1
    v_mfma_f32_16x16x32_bf16 v[92:95], v[56:59], a[128:131], v[92:95]
    v_mul_f32 v166, v166, v162
    v_mul_f32 v167, v167, v163
    ds_read_b128 a[196:199], v11 offset:13312
    v_mfma_f32_16x16x32_bf16 v[92:95], v[60:63], a[132:135], v[92:95]
    v_mul_f32 v168, v168, v164
    v_mul_f32 v169, v169, v165
    ds_read_b128 v[232:235], v11 offset:31744
    v_mfma_f32_16x16x32_bf16 v[96:99], v[56:59], a[200:203], v[96:99]
    v_cvt_pk_bf16_f32 v170, v166, v167
    v_cvt_pk_bf16_f32 v171, v168, v169
    v_mfma_f32_16x16x32_bf16 v[96:99], v[60:63], a[204:207], v[96:99]
    buffer_load_dwordx4 v[52:55], v191, s[48:51], s23 offen offset:1024 sc1
    v_mfma_f32_16x16x32_bf16 v[100:103], v[56:59], v[236:239], v[100:103]
    ds_write_b64 v12, v[170:171] offset:55296
    v_mfma_f32_16x16x32_bf16 v[100:103], v[60:63], v[240:243], v[100:103]
    s_waitcnt vmcnt(14)
    v_mfma_f32_16x16x32_bf16 v[104:107], v[64:67], a[56:59], v[104:107]
    v_mfma_f32_16x16x32_bf16 v[104:107], v[68:71], a[60:63], v[104:107]
    buffer_load_dwordx4 v[56:59], v191, s[48:51], s23 offen offset:2048 sc1
    v_mfma_f32_16x16x32_bf16 v[108:111], v[64:67], a[128:131], v[108:111]
    v_mfma_f32_16x16x32_bf16 v[108:111], v[68:71], a[132:135], v[108:111]
    v_mfma_f32_16x16x32_bf16 v[112:115], v[64:67], a[200:203], v[112:115]
    v_mfma_f32_16x16x32_bf16 v[112:115], v[68:71], a[204:207], v[112:115]
    buffer_load_dwordx4 v[60:63], v191, s[48:51], s23 offen offset:3072 sc1
    v_mfma_f32_16x16x32_bf16 v[116:119], v[64:67], v[236:239], v[116:119]
    v_mfma_f32_16x16x32_bf16 v[116:119], v[68:71], v[240:243], v[116:119]
    s_waitcnt vmcnt(14)
    v_mfma_f32_16x16x32_bf16 v[88:91], v[72:75], a[64:67], v[88:91]
    v_mfma_f32_16x16x32_bf16 v[120:123], v[76:79], a[68:71], v[88:91]
    buffer_load_dwordx4 v[64:67], v192, s[48:51], s23 offen offset:0 sc1
    v_mfma_f32_16x16x32_bf16 v[92:95], v[72:75], a[136:139], v[92:95]
    v_mfma_f32_16x16x32_bf16 v[124:127], v[76:79], a[140:143], v[92:95]
    v_mfma_f32_16x16x32_bf16 v[96:99], v[72:75], a[208:211], v[96:99]
    v_mfma_f32_16x16x32_bf16 v[128:131], v[76:79], a[212:215], v[96:99]
    buffer_load_dwordx4 v[68:71], v192, s[48:51], s23 offen offset:1024 sc1
    v_mfma_f32_16x16x32_bf16 v[100:103], v[72:75], v[244:247], v[100:103]
    v_mfma_f32_16x16x32_bf16 v[132:135], v[76:79], v[248:251], v[100:103]
    s_waitcnt vmcnt(14)
    v_mfma_f32_16x16x32_bf16 v[104:107], v[80:83], a[64:67], v[104:107]
    v_mfma_f32_16x16x32_bf16 v[136:139], v[84:87], a[68:71], v[104:107]
    buffer_load_dwordx4 v[72:75], v192, s[48:51], s23 offen offset:2048 sc1
    v_mfma_f32_16x16x32_bf16 v[108:111], v[80:83], a[136:139], v[108:111]
    v_mfma_f32_16x16x32_bf16 v[140:143], v[84:87], a[140:143], v[108:111]
    s_lshl_b32 s7, s25, 11
    v_mfma_f32_16x16x32_bf16 v[112:115], v[80:83], a[208:211], v[112:115]
    s_add_u32 s7, s7, s28
    v_mfma_f32_16x16x32_bf16 v[144:147], v[84:87], a[212:215], v[112:115]
    buffer_load_dwordx4 v[76:79], v192, s[48:51], s23 offen offset:3072 sc1
    v_mfma_f32_16x16x32_bf16 v[116:119], v[80:83], v[244:247], v[116:119]
    s_add_u32 s23, s23, 36864
    v_mfma_f32_16x16x32_bf16 v[148:151], v[84:87], v[248:251], v[116:119]
    v_add_u32 v12, s7, v184
    s_add_u32 s25, s25, 1
    s_waitcnt lgkmcnt(0)
    s_barrier
    v_pk_mul_f32 v[152:153], v[120:121], v[120:121]
    ds_read_b128 a[56:59], v10 offset:14336
    v_pk_mul_f32 v[154:155], v[122:123], v[122:123]
    ds_read_b128 a[128:131], v10 offset:32768
    v_pk_fma_f32 v[152:153], v[152:153], v[8:9], v[4:5] op_sel:[0,0,0] op_sel_hi:[1,0,0]
    ds_read_b128 a[200:203], v11 offset:14336
    v_pk_fma_f32 v[154:155], v[154:155], v[8:9], v[4:5] op_sel:[0,0,0] op_sel_hi:[1,0,0]
    v_pk_mul_f32 v[152:153], v[120:121], v[152:153]
    ds_read_b128 v[236:239], v11 offset:32768
    v_pk_mul_f32 v[154:155], v[122:123], v[154:155]
    ds_read_b128 a[60:63], v10 offset:15360
    buffer_load_dwordx4 v[80:83], v184, s[48:51], s23 offen offset:0 sc1
    v_exp_f32 v152, v152
    ds_read_b128 a[132:135], v10 offset:33792
    v_exp_f32 v153, v153
    v_exp_f32 v154, v154
    ds_read_b128 a[204:207], v11 offset:15360
    v_exp_f32 v155, v155
    ds_read_b128 v[240:243], v11 offset:33792
    v_pk_mul_f32 v[156:157], v[120:121], v[136:137]
    v_pk_mul_f32 v[158:159], v[122:123], v[138:139]
    buffer_load_dwordx4 v[84:87], v184, s[48:51], s23 offen offset:1024 sc1
    v_pk_fma_f32 v[152:153], v[152:153], v[192:193], v[192:193] op_sel:[0,1,1] op_sel_hi:[1,1,1]
    v_pk_fma_f32 v[154:155], v[154:155], v[192:193], v[192:193] op_sel:[0,1,1] op_sel_hi:[1,1,1]
    v_rcp_f32 v152, v152
    v_rcp_f32 v153, v153
    v_rcp_f32 v154, v154
    v_rcp_f32 v155, v155
    buffer_load_dwordx4 v[104:107], v184, s[48:51], s23 offen offset:2048 sc1
    s_nop 0
    v_pk_mul_f32 v[156:157], v[156:157], v[152:153]
    v_pk_mul_f32 v[158:159], v[158:159], v[154:155]
    v_cvt_pk_bf16_f32 v160, v156, v157
    v_cvt_pk_bf16_f32 v161, v158, v159
    ds_write_b64 v12, v[160:161] offset:0
    buffer_load_dwordx4 v[108:111], v184, s[48:51], s23 offen offset:3072 sc1
    v_pk_mul_f32 v[162:163], v[124:125], v[124:125]
    v_pk_mul_f32 v[164:165], v[126:127], v[126:127]
    v_pk_fma_f32 v[162:163], v[162:163], v[8:9], v[4:5] op_sel:[0,1,1] op_sel_hi:[1,1,1]
    v_pk_fma_f32 v[164:165], v[164:165], v[8:9], v[4:5] op_sel:[0,1,1] op_sel_hi:[1,1,1]
    v_pk_mul_f32 v[162:163], v[124:125], v[162:163]
    v_pk_mul_f32 v[164:165], v[126:127], v[164:165]
    buffer_load_dwordx4 v[112:115], v185, s[48:51], s23 offen offset:0 sc1
    v_exp_f32 v162, v162
    v_exp_f32 v163, v163
    v_exp_f32 v164, v164
    v_exp_f32 v165, v165
    v_pk_mul_f32 v[166:167], v[124:125], v[140:141]
    v_pk_mul_f32 v[168:169], v[126:127], v[142:143]
    buffer_load_dwordx4 v[116:119], v185, s[48:51], s23 offen offset:1024 sc1
    v_pk_fma_f32 v[162:163], v[162:163], v[194:195], v[194:195] op_sel:[0,0,0] op_sel_hi:[1,0,0]
    v_pk_fma_f32 v[164:165], v[164:165], v[194:195], v[194:195] op_sel:[0,0,0] op_sel_hi:[1,0,0]
    v_rcp_f32 v162, v162
    v_rcp_f32 v163, v163
    v_rcp_f32 v164, v164
    v_rcp_f32 v165, v165
    buffer_load_dwordx4 v[180:183], v185, s[48:51], s23 offen offset:2048 sc1
    s_nop 0
    v_pk_mul_f32 v[166:167], v[166:167], v[162:163]
    v_pk_mul_f32 v[168:169], v[168:169], v[164:165]
    v_cvt_pk_bf16_f32 v170, v166, v167
    v_cvt_pk_bf16_f32 v171, v168, v169
    ds_write_b64 v12, v[170:171] offset:18432
    buffer_load_dwordx4 v[196:199], v185, s[48:51], s23 offen offset:3072 sc1
    v_pk_mul_f32 v[152:153], v[128:129], v[128:129]
    v_pk_mul_f32 v[154:155], v[130:131], v[130:131]
    v_pk_fma_f32 v[152:153], v[152:153], v[12:13], v[6:7] op_sel:[0,1,0] op_sel_hi:[1,1,0]
    v_pk_fma_f32 v[154:155], v[154:155], v[12:13], v[6:7] op_sel:[0,1,0] op_sel_hi:[1,1,0]
    v_pk_mul_f32 v[152:153], v[128:129], v[152:153]
    v_pk_mul_f32 v[154:155], v[130:131], v[154:155]
    buffer_load_dwordx4 v[200:203], v186, s[48:51], s23 offen offset:0 sc1
    v_exp_f32 v152, v152
    v_exp_f32 v153, v153
    v_exp_f32 v154, v154
    v_exp_f32 v155, v155
    v_pk_mul_f32 v[156:157], v[128:129], v[144:145]
    v_pk_mul_f32 v[158:159], v[130:131], v[146:147]
    buffer_load_dwordx4 v[204:207], v186, s[48:51], s23 offen offset:1024 sc1
    v_pk_fma_f32 v[152:153], v[152:153], v[194:195], v[194:195] op_sel:[0,1,1] op_sel_hi:[1,1,1]
    v_pk_fma_f32 v[154:155], v[154:155], v[194:195], v[194:195] op_sel:[0,1,1] op_sel_hi:[1,1,1]
    v_rcp_f32 v152, v152
    v_rcp_f32 v153, v153
    v_rcp_f32 v154, v154
    v_rcp_f32 v155, v155
    buffer_load_dwordx4 v[208:211], v186, s[48:51], s23 offen offset:2048 sc1
    s_nop 0
    v_pk_mul_f32 v[156:157], v[156:157], v[152:153]
    v_pk_mul_f32 v[158:159], v[158:159], v[154:155]
    v_cvt_pk_bf16_f32 v160, v156, v157
    v_cvt_pk_bf16_f32 v161, v158, v159
    ds_write_b64 v12, v[160:161] offset:36864
    buffer_load_dwordx4 v[212:215], v186, s[48:51], s23 offen offset:3072 sc1
    v_pk_mul_f32 v[162:163], v[132:133], v[132:133]
    v_pk_mul_f32 v[164:165], v[134:135], v[134:135]
    v_pk_fma_f32 v[162:163], v[162:163], v[14:15], v[6:7] op_sel:[0,0,1] op_sel_hi:[1,0,1]
    v_pk_fma_f32 v[164:165], v[164:165], v[14:15], v[6:7] op_sel:[0,0,1] op_sel_hi:[1,0,1]
    v_pk_mul_f32 v[162:163], v[132:133], v[162:163]
    v_pk_mul_f32 v[164:165], v[134:135], v[164:165]
    v_exp_f32 v162, v162
    v_exp_f32 v163, v163
    v_exp_f32 v164, v164
    v_exp_f32 v165, v165
    v_pk_mul_f32 v[166:167], v[132:133], v[148:149]
    v_pk_mul_f32 v[168:169], v[134:135], v[150:151]
    v_pk_fma_f32 v[162:163], v[162:163], v[252:253], v[252:253] op_sel:[0,0,0] op_sel_hi:[1,0,0]
    v_pk_fma_f32 v[164:165], v[164:165], v[252:253], v[252:253] op_sel:[0,0,0] op_sel_hi:[1,0,0]
    v_rcp_f32 v162, v162
    v_rcp_f32 v163, v163
    v_rcp_f32 v164, v164
    v_rcp_f32 v165, v165
    s_nop 0
    v_pk_mul_f32 v[166:167], v[166:167], v[162:163]
    v_pk_mul_f32 v[168:169], v[168:169], v[164:165]
    v_cvt_pk_bf16_f32 v170, v166, v167
    v_cvt_pk_bf16_f32 v171, v168, v169
    ds_write_b64 v12, v[170:171] offset:55296
    buffer_load_dwordx4 v[136:139], v187, s[48:51], s23 offen offset:0 sc1
    buffer_load_dwordx4 v[140:143], v187, s[48:51], s23 offen offset:1024 sc1
    buffer_load_dwordx4 v[144:147], v187, s[48:51], s23 offen offset:2048 sc1
    buffer_load_dwordx4 v[160:163], v187, s[48:51], s23 offen offset:3072 sc1
    buffer_load_dwordx4 v[164:167], v188, s[48:51], s23 offen offset:0 sc1
    buffer_load_dwordx4 v[168:171], v188, s[48:51], s23 offen offset:1024 sc1
    s_add_u32 s23, s23, 18432
    s_waitcnt lgkmcnt(0)
    s_barrier
    ds_read_b128 a[64:67], v10 offset:16384
    ds_read_b128 a[136:139], v10 offset:34816
    ds_read_b128 a[208:211], v11 offset:16384
    ds_read_b128 v[244:247], v11 offset:34816
    ds_read_b128 a[68:71], v10 offset:17408
    ds_read_b128 a[140:143], v10 offset:35840
    ds_read_b128 a[212:215], v11 offset:17408
    ds_read_b128 v[248:251], v11 offset:35840
    s_mov_b32 s25, 0
    s_waitcnt lgkmcnt(0)
    s_branch L_ffn_dn_mid_42
L_ffn_dn_41:
    s_waitcnt vmcnt(34)
    v_mfma_f32_16x16x32_bf16 v[88:91], v[104:107], a[0:3], 0
    v_mfma_f32_16x16x32_bf16 v[88:91], v[108:111], a[4:7], v[88:91]
    buffer_load_dwordx4 v[80:83], v184, s[48:51], s23 offen offset:0 sc1
    v_mfma_f32_16x16x32_bf16 v[92:95], v[104:107], a[72:75], 0
    v_mfma_f32_16x16x32_bf16 v[92:95], v[108:111], a[76:79], v[92:95]
    v_mfma_f32_16x16x32_bf16 v[96:99], v[104:107], a[144:147], 0
    v_mfma_f32_16x16x32_bf16 v[96:99], v[108:111], a[148:151], v[96:99]
    buffer_load_dwordx4 v[84:87], v184, s[48:51], s23 offen offset:1024 sc1
    v_mfma_f32_16x16x32_bf16 v[100:103], v[104:107], a[216:219], 0
    v_cvt_pk_bf16_f32 v152, v120, v121
    v_cvt_pk_bf16_f32 v153, v122, v123
    v_mfma_f32_16x16x32_bf16 v[100:103], v[108:111], a[220:223], v[100:103]
    v_cvt_pk_bf16_f32 v154, v124, v125
    v_cvt_pk_bf16_f32 v155, v126, v127
    s_waitcnt vmcnt(34)
    v_mfma_f32_16x16x32_bf16 v[88:91], v[112:115], a[8:11], v[88:91]
    s_nop 0
    v_permlane16_swap_b32 v152, v154
    v_mfma_f32_16x16x32_bf16 v[88:91], v[116:119], a[12:15], v[88:91]
    buffer_load_dwordx4 v[104:107], v184, s[48:51], s23 offen offset:2048 sc1
    v_mfma_f32_16x16x32_bf16 v[92:95], v[112:115], a[80:83], v[92:95]
    v_permlane16_swap_b32 v153, v155
    v_mfma_f32_16x16x32_bf16 v[92:95], v[116:119], a[84:87], v[92:95]
    buffer_store_dwordx4 v[152:155], v178, s[72:75], s27 offen sc1
    v_mfma_f32_16x16x32_bf16 v[96:99], v[112:115], a[152:155], v[96:99]
    ds_write_b128 v216, v[152:155]
    v_mfma_f32_16x16x32_bf16 v[96:99], v[116:119], a[156:159], v[96:99]
    buffer_load_dwordx4 v[108:111], v184, s[48:51], s23 offen offset:3072 sc1
    v_mfma_f32_16x16x32_bf16 v[100:103], v[112:115], a[224:227], v[100:103]
    v_add_u32 v216, v216, v218
    v_mfma_f32_16x16x32_bf16 v[100:103], v[116:119], a[228:231], v[100:103]
    s_waitcnt vmcnt(35)
    v_mfma_f32_16x16x32_bf16 v[88:91], v[180:183], a[16:19], v[88:91]
    v_mfma_f32_16x16x32_bf16 v[88:91], v[196:199], a[20:23], v[88:91]
    buffer_load_dwordx4 v[112:115], v185, s[48:51], s23 offen offset:0 sc1
    v_mfma_f32_16x16x32_bf16 v[92:95], v[180:183], a[88:91], v[92:95]
    v_mfma_f32_16x16x32_bf16 v[92:95], v[196:199], a[92:95], v[92:95]
    v_mfma_f32_16x16x32_bf16 v[96:99], v[180:183], a[160:163], v[96:99]
    v_mfma_f32_16x16x32_bf16 v[96:99], v[196:199], a[164:167], v[96:99]
    buffer_load_dwordx4 v[116:119], v185, s[48:51], s23 offen offset:1024 sc1
    v_mfma_f32_16x16x32_bf16 v[100:103], v[180:183], a[232:235], v[100:103]
    v_mfma_f32_16x16x32_bf16 v[100:103], v[196:199], a[236:239], v[100:103]
    s_waitcnt vmcnt(35)
    v_mfma_f32_16x16x32_bf16 v[88:91], v[200:203], a[24:27], v[88:91]
    v_mfma_f32_16x16x32_bf16 v[88:91], v[204:207], a[28:31], v[88:91]
    buffer_load_dwordx4 v[180:183], v185, s[48:51], s23 offen offset:2048 sc1
    v_mfma_f32_16x16x32_bf16 v[92:95], v[200:203], a[96:99], v[92:95]
    v_mfma_f32_16x16x32_bf16 v[92:95], v[204:207], a[100:103], v[92:95]
    v_mfma_f32_16x16x32_bf16 v[96:99], v[200:203], a[168:171], v[96:99]
    v_mfma_f32_16x16x32_bf16 v[96:99], v[204:207], a[172:175], v[96:99]
    buffer_load_dwordx4 v[196:199], v185, s[48:51], s23 offen offset:3072 sc1
    v_mfma_f32_16x16x32_bf16 v[100:103], v[200:203], a[240:243], v[100:103]
    v_mfma_f32_16x16x32_bf16 v[100:103], v[204:207], a[244:247], v[100:103]
    s_waitcnt vmcnt(35)
    v_mfma_f32_16x16x32_bf16 v[88:91], v[208:211], a[32:35], v[88:91]
    v_mfma_f32_16x16x32_bf16 v[88:91], v[212:215], a[36:39], v[88:91]
    buffer_load_dwordx4 v[200:203], v186, s[48:51], s23 offen offset:0 sc1
    v_mfma_f32_16x16x32_bf16 v[92:95], v[208:211], a[104:107], v[92:95]
    v_mfma_f32_16x16x32_bf16 v[92:95], v[212:215], a[108:111], v[92:95]
    v_mfma_f32_16x16x32_bf16 v[96:99], v[208:211], a[176:179], v[96:99]
    v_mfma_f32_16x16x32_bf16 v[96:99], v[212:215], a[180:183], v[96:99]
    buffer_load_dwordx4 v[204:207], v186, s[48:51], s23 offen offset:1024 sc1
    v_mfma_f32_16x16x32_bf16 v[100:103], v[208:211], a[248:251], v[100:103]
    v_mfma_f32_16x16x32_bf16 v[100:103], v[212:215], a[252:255], v[100:103]
    s_waitcnt vmcnt(35)
    v_mfma_f32_16x16x32_bf16 v[88:91], v[136:139], a[40:43], v[88:91]
    v_cvt_pk_bf16_f32 v156, v128, v129
    v_cvt_pk_bf16_f32 v157, v130, v131
    v_mfma_f32_16x16x32_bf16 v[88:91], v[140:143], a[44:47], v[88:91]
    buffer_load_dwordx4 v[208:211], v186, s[48:51], s23 offen offset:2048 sc1
    v_mfma_f32_16x16x32_bf16 v[92:95], v[136:139], a[112:115], v[92:95]
    v_cvt_pk_bf16_f32 v158, v132, v133
    v_cvt_pk_bf16_f32 v159, v134, v135
    v_mfma_f32_16x16x32_bf16 v[92:95], v[140:143], a[116:119], v[92:95]
    s_nop 0
    v_permlane16_swap_b32 v156, v158
    v_mfma_f32_16x16x32_bf16 v[96:99], v[136:139], a[184:187], v[96:99]
    v_permlane16_swap_b32 v157, v159
    v_mfma_f32_16x16x32_bf16 v[96:99], v[140:143], a[188:191], v[96:99]
    buffer_load_dwordx4 v[212:215], v186, s[48:51], s23 offen offset:3072 sc1
    v_mfma_f32_16x16x32_bf16 v[100:103], v[136:139], v[220:223], v[100:103]
    buffer_store_dwordx4 v[156:159], v179, s[72:75], s27 offen sc1
    v_mfma_f32_16x16x32_bf16 v[100:103], v[140:143], v[224:227], v[100:103]
    ds_write_b128 v217, v[156:159]
    s_waitcnt vmcnt(36)
    v_mfma_f32_16x16x32_bf16 v[88:91], v[144:147], a[48:51], v[88:91]
    v_add_u32 v217, v217, v219
    v_mfma_f32_16x16x32_bf16 v[88:91], v[160:163], a[52:55], v[88:91]
    buffer_load_dwordx4 v[136:139], v187, s[48:51], s23 offen offset:0 sc1
    v_mfma_f32_16x16x32_bf16 v[92:95], v[144:147], a[120:123], v[92:95]
    v_mfma_f32_16x16x32_bf16 v[92:95], v[160:163], a[124:127], v[92:95]
    v_mfma_f32_16x16x32_bf16 v[96:99], v[144:147], a[192:195], v[96:99]
    v_mfma_f32_16x16x32_bf16 v[96:99], v[160:163], a[196:199], v[96:99]
    buffer_load_dwordx4 v[140:143], v187, s[48:51], s23 offen offset:1024 sc1
    v_mfma_f32_16x16x32_bf16 v[100:103], v[144:147], v[228:231], v[100:103]
    v_mfma_f32_16x16x32_bf16 v[100:103], v[160:163], v[232:235], v[100:103]
    s_waitcnt vmcnt(36)
    v_mfma_f32_16x16x32_bf16 v[88:91], v[164:167], a[56:59], v[88:91]
    v_mfma_f32_16x16x32_bf16 v[88:91], v[168:171], a[60:63], v[88:91]
    buffer_load_dwordx4 v[144:147], v187, s[48:51], s23 offen offset:2048 sc1
    v_mfma_f32_16x16x32_bf16 v[92:95], v[164:167], a[128:131], v[92:95]
    v_mfma_f32_16x16x32_bf16 v[92:95], v[168:171], a[132:135], v[92:95]
    v_mfma_f32_16x16x32_bf16 v[96:99], v[164:167], a[200:203], v[96:99]
    v_mfma_f32_16x16x32_bf16 v[96:99], v[168:171], a[204:207], v[96:99]
    buffer_load_dwordx4 v[160:163], v187, s[48:51], s23 offen offset:3072 sc1
    v_mfma_f32_16x16x32_bf16 v[100:103], v[164:167], v[236:239], v[100:103]
    v_mfma_f32_16x16x32_bf16 v[100:103], v[168:171], v[240:243], v[100:103]
    s_waitcnt vmcnt(36)
    v_mfma_f32_16x16x32_bf16 v[88:91], v[148:151], a[64:67], v[88:91]
    v_mfma_f32_16x16x32_bf16 v[120:123], v[4:7], a[68:71], v[88:91]
    buffer_load_dwordx4 v[164:167], v188, s[48:51], s23 offen offset:0 sc1
    v_mfma_f32_16x16x32_bf16 v[92:95], v[148:151], a[136:139], v[92:95]
    s_mov_b32 s74, 268435456
    v_mfma_f32_16x16x32_bf16 v[124:127], v[4:7], a[140:143], v[92:95]
    s_add_u32 s27, s27, 1024
    v_mfma_f32_16x16x32_bf16 v[96:99], v[148:151], a[208:211], v[96:99]
    s_add_u32 s25, s25, 1
    v_mfma_f32_16x16x32_bf16 v[128:131], v[4:7], a[212:215], v[96:99]
    buffer_load_dwordx4 v[168:171], v188, s[48:51], s23 offen offset:1024 sc1
    v_mfma_f32_16x16x32_bf16 v[100:103], v[148:151], v[244:247], v[100:103]
    s_add_u32 s23, s23, 18432
    v_mfma_f32_16x16x32_bf16 v[132:135], v[4:7], v[248:251], v[100:103]
L_ffn_dn_mid_42:
    s_waitcnt vmcnt(32)
    v_mfma_f32_16x16x32_bf16 v[88:91], v[16:19], a[0:3], 0
    v_mfma_f32_16x16x32_bf16 v[88:91], v[20:23], a[4:7], v[88:91]
    buffer_load_dwordx4 v[148:151], v184, s[48:51], s23 offen offset:0 sc1
    v_mfma_f32_16x16x32_bf16 v[92:95], v[16:19], a[72:75], 0
    v_mfma_f32_16x16x32_bf16 v[92:95], v[20:23], a[76:79], v[92:95]
    v_mfma_f32_16x16x32_bf16 v[96:99], v[16:19], a[144:147], 0
    v_mfma_f32_16x16x32_bf16 v[96:99], v[20:23], a[148:151], v[96:99]
    buffer_load_dwordx4 v[4:7], v184, s[48:51], s23 offen offset:1024 sc1
    v_mfma_f32_16x16x32_bf16 v[100:103], v[16:19], a[216:219], 0
    v_cvt_pk_bf16_f32 v152, v120, v121
    v_cvt_pk_bf16_f32 v153, v122, v123
    v_mfma_f32_16x16x32_bf16 v[100:103], v[20:23], a[220:223], v[100:103]
    v_cvt_pk_bf16_f32 v154, v124, v125
    v_cvt_pk_bf16_f32 v155, v126, v127
    s_waitcnt vmcnt(32)
    v_mfma_f32_16x16x32_bf16 v[88:91], v[24:27], a[8:11], v[88:91]
    s_nop 0
    v_permlane16_swap_b32 v152, v154
    v_mfma_f32_16x16x32_bf16 v[88:91], v[28:31], a[12:15], v[88:91]
    buffer_load_dwordx4 v[16:19], v184, s[48:51], s23 offen offset:2048 sc1
    v_mfma_f32_16x16x32_bf16 v[92:95], v[24:27], a[80:83], v[92:95]
    v_permlane16_swap_b32 v153, v155
    v_mfma_f32_16x16x32_bf16 v[92:95], v[28:31], a[84:87], v[92:95]
    buffer_store_dwordx4 v[152:155], v178, s[72:75], s27 offen sc1
    v_mfma_f32_16x16x32_bf16 v[96:99], v[24:27], a[152:155], v[96:99]
    ds_write_b128 v216, v[152:155]
    v_mfma_f32_16x16x32_bf16 v[96:99], v[28:31], a[156:159], v[96:99]
    buffer_load_dwordx4 v[20:23], v184, s[48:51], s23 offen offset:3072 sc1
    v_mfma_f32_16x16x32_bf16 v[100:103], v[24:27], a[224:227], v[100:103]
    v_add_u32 v216, v216, v218
    v_mfma_f32_16x16x32_bf16 v[100:103], v[28:31], a[228:231], v[100:103]
    s_waitcnt vmcnt(33)
    v_mfma_f32_16x16x32_bf16 v[88:91], v[32:35], a[16:19], v[88:91]
    v_mfma_f32_16x16x32_bf16 v[88:91], v[36:39], a[20:23], v[88:91]
    buffer_load_dwordx4 v[24:27], v185, s[48:51], s23 offen offset:0 sc1
    v_mfma_f32_16x16x32_bf16 v[92:95], v[32:35], a[88:91], v[92:95]
    v_mfma_f32_16x16x32_bf16 v[92:95], v[36:39], a[92:95], v[92:95]
    v_mfma_f32_16x16x32_bf16 v[96:99], v[32:35], a[160:163], v[96:99]
    v_mfma_f32_16x16x32_bf16 v[96:99], v[36:39], a[164:167], v[96:99]
    buffer_load_dwordx4 v[28:31], v185, s[48:51], s23 offen offset:1024 sc1
    v_mfma_f32_16x16x32_bf16 v[100:103], v[32:35], a[232:235], v[100:103]
    v_mfma_f32_16x16x32_bf16 v[100:103], v[36:39], a[236:239], v[100:103]
    s_waitcnt vmcnt(33)
    v_mfma_f32_16x16x32_bf16 v[88:91], v[40:43], a[24:27], v[88:91]
    v_mfma_f32_16x16x32_bf16 v[88:91], v[44:47], a[28:31], v[88:91]
    buffer_load_dwordx4 v[32:35], v185, s[48:51], s23 offen offset:2048 sc1
    v_mfma_f32_16x16x32_bf16 v[92:95], v[40:43], a[96:99], v[92:95]
    v_mfma_f32_16x16x32_bf16 v[92:95], v[44:47], a[100:103], v[92:95]
    v_mfma_f32_16x16x32_bf16 v[96:99], v[40:43], a[168:171], v[96:99]
    v_mfma_f32_16x16x32_bf16 v[96:99], v[44:47], a[172:175], v[96:99]
    buffer_load_dwordx4 v[36:39], v185, s[48:51], s23 offen offset:3072 sc1
    v_mfma_f32_16x16x32_bf16 v[100:103], v[40:43], a[240:243], v[100:103]
    v_mfma_f32_16x16x32_bf16 v[100:103], v[44:47], a[244:247], v[100:103]
    s_waitcnt vmcnt(33)
    v_mfma_f32_16x16x32_bf16 v[88:91], v[48:51], a[32:35], v[88:91]
    v_mfma_f32_16x16x32_bf16 v[88:91], v[52:55], a[36:39], v[88:91]
    buffer_load_dwordx4 v[40:43], v186, s[48:51], s23 offen offset:0 sc1
    v_mfma_f32_16x16x32_bf16 v[92:95], v[48:51], a[104:107], v[92:95]
    v_mfma_f32_16x16x32_bf16 v[92:95], v[52:55], a[108:111], v[92:95]
    v_mfma_f32_16x16x32_bf16 v[96:99], v[48:51], a[176:179], v[96:99]
    v_mfma_f32_16x16x32_bf16 v[96:99], v[52:55], a[180:183], v[96:99]
    buffer_load_dwordx4 v[44:47], v186, s[48:51], s23 offen offset:1024 sc1
    v_mfma_f32_16x16x32_bf16 v[100:103], v[48:51], a[248:251], v[100:103]
    v_mfma_f32_16x16x32_bf16 v[100:103], v[52:55], a[252:255], v[100:103]
    s_waitcnt vmcnt(33)
    s_cmp_lg_u32 s25, 6
    s_cbranch_scc1 L_early_43
    s_waitcnt vmcnt(17)
    s_barrier
    s_cmp_lg_u32 s3, 0
    s_cbranch_scc1 L_early_43
    v_lshlrev_b32 v15, 7, v0
    v_mov_b32 v1, s76
    s_mov_b64 exec, 0xff
    buffer_store_dword v1, v15, s[8:11], s29 offen sc1
    s_mov_b64 exec, -1
L_early_43:
    v_mfma_f32_16x16x32_bf16 v[88:91], v[56:59], a[40:43], v[88:91]
    v_cvt_pk_bf16_f32 v156, v128, v129
    v_cvt_pk_bf16_f32 v157, v130, v131
    v_mfma_f32_16x16x32_bf16 v[88:91], v[60:63], a[44:47], v[88:91]
    buffer_load_dwordx4 v[48:51], v186, s[48:51], s23 offen offset:2048 sc1
    v_mfma_f32_16x16x32_bf16 v[92:95], v[56:59], a[112:115], v[92:95]
    v_cvt_pk_bf16_f32 v158, v132, v133
    v_cvt_pk_bf16_f32 v159, v134, v135
    v_mfma_f32_16x16x32_bf16 v[92:95], v[60:63], a[116:119], v[92:95]
    s_nop 0
    v_permlane16_swap_b32 v156, v158
    v_mfma_f32_16x16x32_bf16 v[96:99], v[56:59], a[184:187], v[96:99]
    v_permlane16_swap_b32 v157, v159
    v_mfma_f32_16x16x32_bf16 v[96:99], v[60:63], a[188:191], v[96:99]
    buffer_load_dwordx4 v[52:55], v186, s[48:51], s23 offen offset:3072 sc1
    v_mfma_f32_16x16x32_bf16 v[100:103], v[56:59], v[220:223], v[100:103]
    buffer_store_dwordx4 v[156:159], v179, s[72:75], s27 offen sc1
    v_mfma_f32_16x16x32_bf16 v[100:103], v[60:63], v[224:227], v[100:103]
    ds_write_b128 v217, v[156:159]
    s_waitcnt vmcnt(34)
    v_mfma_f32_16x16x32_bf16 v[88:91], v[64:67], a[48:51], v[88:91]
    v_add_u32 v217, v217, v219
    v_mfma_f32_16x16x32_bf16 v[88:91], v[68:71], a[52:55], v[88:91]
    buffer_load_dwordx4 v[56:59], v187, s[48:51], s23 offen offset:0 sc1
    v_mfma_f32_16x16x32_bf16 v[92:95], v[64:67], a[120:123], v[92:95]
    v_mfma_f32_16x16x32_bf16 v[92:95], v[68:71], a[124:127], v[92:95]
    v_mfma_f32_16x16x32_bf16 v[96:99], v[64:67], a[192:195], v[96:99]
    v_mfma_f32_16x16x32_bf16 v[96:99], v[68:71], a[196:199], v[96:99]
    buffer_load_dwordx4 v[60:63], v187, s[48:51], s23 offen offset:1024 sc1
    v_mfma_f32_16x16x32_bf16 v[100:103], v[64:67], v[228:231], v[100:103]
    v_mfma_f32_16x16x32_bf16 v[100:103], v[68:71], v[232:235], v[100:103]
    s_waitcnt vmcnt(34)
    v_mfma_f32_16x16x32_bf16 v[88:91], v[72:75], a[56:59], v[88:91]
    v_mfma_f32_16x16x32_bf16 v[88:91], v[76:79], a[60:63], v[88:91]
    buffer_load_dwordx4 v[64:67], v187, s[48:51], s23 offen offset:2048 sc1
    v_mfma_f32_16x16x32_bf16 v[92:95], v[72:75], a[128:131], v[92:95]
    v_mfma_f32_16x16x32_bf16 v[92:95], v[76:79], a[132:135], v[92:95]
    v_mfma_f32_16x16x32_bf16 v[96:99], v[72:75], a[200:203], v[96:99]
    v_mfma_f32_16x16x32_bf16 v[96:99], v[76:79], a[204:207], v[96:99]
    buffer_load_dwordx4 v[68:71], v187, s[48:51], s23 offen offset:3072 sc1
    v_mfma_f32_16x16x32_bf16 v[100:103], v[72:75], v[236:239], v[100:103]
    v_mfma_f32_16x16x32_bf16 v[100:103], v[76:79], v[240:243], v[100:103]
    s_waitcnt vmcnt(34)
    v_mfma_f32_16x16x32_bf16 v[88:91], v[80:83], a[64:67], v[88:91]
    v_mfma_f32_16x16x32_bf16 v[120:123], v[84:87], a[68:71], v[88:91]
    buffer_load_dwordx4 v[72:75], v188, s[48:51], s23 offen offset:0 sc1
    v_mfma_f32_16x16x32_bf16 v[92:95], v[80:83], a[136:139], v[92:95]
    s_mov_b32 s74, 268435456
    v_mfma_f32_16x16x32_bf16 v[124:127], v[84:87], a[140:143], v[92:95]
    s_add_u32 s27, s27, 1024
    v_mfma_f32_16x16x32_bf16 v[96:99], v[80:83], a[208:211], v[96:99]
    s_add_u32 s25, s25, 1
    v_mfma_f32_16x16x32_bf16 v[128:131], v[84:87], a[212:215], v[96:99]
    buffer_load_dwordx4 v[76:79], v188, s[48:51], s23 offen offset:1024 sc1
    v_mfma_f32_16x16x32_bf16 v[100:103], v[80:83], v[244:247], v[100:103]
    s_add_u32 s23, s23, 18432
    v_mfma_f32_16x16x32_bf16 v[132:135], v[84:87], v[248:251], v[100:103]
    s_cmp_lt_u32 s25, 7
    s_cbranch_scc1 L_ffn_dn_41
    s_waitcnt vmcnt(35)
    v_mfma_f32_16x16x32_bf16 v[88:91], v[104:107], a[0:3], 0
    v_mfma_f32_16x16x32_bf16 v[88:91], v[108:111], a[4:7], v[88:91]
    buffer_load_dwordx4 v[80:83], v184, s[48:51], s23 offen offset:0 sc1
    v_mfma_f32_16x16x32_bf16 v[92:95], v[104:107], a[72:75], 0
    v_mfma_f32_16x16x32_bf16 v[92:95], v[108:111], a[76:79], v[92:95]
    v_mfma_f32_16x16x32_bf16 v[96:99], v[104:107], a[144:147], 0
    v_mfma_f32_16x16x32_bf16 v[96:99], v[108:111], a[148:151], v[96:99]
    buffer_load_dwordx4 v[84:87], v184, s[48:51], s23 offen offset:1024 sc1
    v_mfma_f32_16x16x32_bf16 v[100:103], v[104:107], a[216:219], 0
    v_cvt_pk_bf16_f32 v152, v120, v121
    v_cvt_pk_bf16_f32 v153, v122, v123
    v_mfma_f32_16x16x32_bf16 v[100:103], v[108:111], a[220:223], v[100:103]
    v_cvt_pk_bf16_f32 v154, v124, v125
    v_cvt_pk_bf16_f32 v155, v126, v127
    s_waitcnt vmcnt(35)
    v_mfma_f32_16x16x32_bf16 v[88:91], v[112:115], a[8:11], v[88:91]
    s_nop 0
    v_permlane16_swap_b32 v152, v154
    v_mfma_f32_16x16x32_bf16 v[88:91], v[116:119], a[12:15], v[88:91]
    v_permlane16_swap_b32 v153, v155
    v_mfma_f32_16x16x32_bf16 v[92:95], v[112:115], a[80:83], v[92:95]
    buffer_store_dwordx4 v[152:155], v178, s[72:75], s27 offen sc1
    v_mfma_f32_16x16x32_bf16 v[92:95], v[116:119], a[84:87], v[92:95]
    ds_write_b128 v216, v[152:155]
    v_mfma_f32_16x16x32_bf16 v[96:99], v[112:115], a[152:155], v[96:99]
    v_add_u32 v216, v216, v218
    v_cvt_pk_bf16_f32 v156, v128, v129
    v_mfma_f32_16x16x32_bf16 v[96:99], v[116:119], a[156:159], v[96:99]
    v_cvt_pk_bf16_f32 v157, v130, v131
    v_cvt_pk_bf16_f32 v158, v132, v133
    v_mfma_f32_16x16x32_bf16 v[100:103], v[112:115], a[224:227], v[100:103]
    v_cvt_pk_bf16_f32 v159, v134, v135
    s_load_dwordx8 s[56:63], s[38:39], 0 glc
    v_mfma_f32_16x16x32_bf16 v[100:103], v[116:119], a[228:231], v[100:103]
    s_nop 0
    v_permlane16_swap_b32 v156, v158
    s_waitcnt vmcnt(34)
    v_mfma_f32_16x16x32_bf16 v[88:91], v[180:183], a[16:19], v[88:91]
    v_permlane16_swap_b32 v157, v159
    v_mfma_f32_16x16x32_bf16 v[88:91], v[196:199], a[20:23], v[88:91]
    buffer_store_dwordx4 v[156:159], v179, s[72:75], s27 offen sc1
    v_mfma_f32_16x16x32_bf16 v[92:95], v[180:183], a[88:91], v[92:95]
    ds_write_b128 v217, v[156:159]
    v_mfma_f32_16x16x32_bf16 v[92:95], v[196:199], a[92:95], v[92:95]
    v_add_u32 v217, v217, v219
    v_mfma_f32_16x16x32_bf16 v[96:99], v[180:183], a[160:163], v[96:99]
    v_mfma_f32_16x16x32_bf16 v[96:99], v[196:199], a[164:167], v[96:99]
    v_mfma_f32_16x16x32_bf16 v[100:103], v[180:183], a[232:235], v[100:103]
    v_mfma_f32_16x16x32_bf16 v[100:103], v[196:199], a[236:239], v[100:103]
    s_waitcnt vmcnt(33)
    s_mov_b32 s6, 0
L_epoll_44:
    s_waitcnt lgkmcnt(0)
    s_xor_b64 s[56:57], s[56:57], s[76:77]
    s_xor_b64 s[58:59], s[58:59], s[76:77]
    s_xor_b64 s[60:61], s[60:61], s[76:77]
    s_xor_b64 s[62:63], s[62:63], s[76:77]
    s_or_b64 s[56:57], s[56:57], s[58:59]
    s_or_b64 s[60:61], s[60:61], s[62:63]
    s_or_b64 s[56:57], s[56:57], s[60:61]
    s_cbranch_scc0 L_epolled_45
    s_load_dwordx8 s[56:63], s[38:39], 0 glc
    s_add_u32 s6, s6, 1
    s_cmp_lt_u32 s6, 1048576
    s_cbranch_scc1 L_epoll_44
    s_branch L_main_end
L_epolled_45:
    v_mfma_f32_16x16x32_bf16 v[88:91], v[200:203], a[24:27], v[88:91]
    v_mfma_f32_16x16x32_bf16 v[88:91], v[204:207], a[28:31], v[88:91]
    s_add_u32 s7, s40, 1
    s_and_b32 s7, s7, 7
    s_mul_i32 s7, s7, 9216
    s_add_u32 s19, s7, s20
    buffer_load_dwordx4 v[104:107], v172, s[8:11], s19 offen sc1
    v_mfma_f32_16x16x32_bf16 v[92:95], v[200:203], a[96:99], v[92:95]
    v_mfma_f32_16x16x32_bf16 v[92:95], v[204:207], a[100:103], v[92:95]
    v_mfma_f32_16x16x32_bf16 v[96:99], v[200:203], a[168:171], v[96:99]
    v_mfma_f32_16x16x32_bf16 v[96:99], v[204:207], a[172:175], v[96:99]
    buffer_load_dwordx4 v[108:111], v173, s[8:11], s19 offen sc1
    v_mfma_f32_16x16x32_bf16 v[100:103], v[200:203], a[240:243], v[100:103]
    v_mfma_f32_16x16x32_bf16 v[100:103], v[204:207], a[244:247], v[100:103]
    s_waitcnt vmcnt(33)
    v_mfma_f32_16x16x32_bf16 v[88:91], v[208:211], a[32:35], v[88:91]
    v_mfma_f32_16x16x32_bf16 v[88:91], v[212:215], a[36:39], v[88:91]
    s_add_u32 s7, s40, 2
    s_and_b32 s7, s7, 7
    s_mul_i32 s7, s7, 9216
    s_add_u32 s19, s7, s20
    buffer_load_dwordx4 v[112:115], v172, s[8:11], s19 offen sc1
    v_mfma_f32_16x16x32_bf16 v[92:95], v[208:211], a[104:107], v[92:95]
    v_mfma_f32_16x16x32_bf16 v[92:95], v[212:215], a[108:111], v[92:95]
    v_mfma_f32_16x16x32_bf16 v[96:99], v[208:211], a[176:179], v[96:99]
    v_mfma_f32_16x16x32_bf16 v[96:99], v[212:215], a[180:183], v[96:99]
    buffer_load_dwordx4 v[116:119], v173, s[8:11], s19 offen sc1
    v_mfma_f32_16x16x32_bf16 v[100:103], v[208:211], a[248:251], v[100:103]
    v_mfma_f32_16x16x32_bf16 v[100:103], v[212:215], a[252:255], v[100:103]
    s_waitcnt vmcnt(32)
    v_mfma_f32_16x16x32_bf16 v[88:91], v[136:139], a[40:43], v[88:91]
    v_mfma_f32_16x16x32_bf16 v[88:91], v[140:143], a[44:47], v[88:91]
    s_add_u32 s7, s40, 3
    s_and_b32 s7, s7, 7
    s_mul_i32 s7, s7, 9216
    s_add_u32 s19, s7, s20
    buffer_load_dwordx4 v[180:183], v172, s[8:11], s19 offen sc1
    v_mfma_f32_16x16x32_bf16 v[92:95], v[136:139], a[112:115], v[92:95]
    v_mfma_f32_16x16x32_bf16 v[92:95], v[140:143], a[116:119], v[92:95]
    v_mfma_f32_16x16x32_bf16 v[96:99], v[136:139], a[184:187], v[96:99]
    v_mfma_f32_16x16x32_bf16 v[96:99], v[140:143], a[188:191], v[96:99]
    buffer_load_dwordx4 v[196:199], v173, s[8:11], s19 offen sc1
    v_mfma_f32_16x16x32_bf16 v[100:103], v[136:139], v[220:223], v[100:103]
    v_mfma_f32_16x16x32_bf16 v[100:103], v[140:143], v[224:227], v[100:103]
    s_waitcnt vmcnt(32)
    v_mfma_f32_16x16x32_bf16 v[88:91], v[144:147], a[48:51], v[88:91]
    v_mfma_f32_16x16x32_bf16 v[88:91], v[160:163], a[52:55], v[88:91]
    s_add_u32 s7, s40, 4
    s_and_b32 s7, s7, 7
    s_mul_i32 s7, s7, 9216
    s_add_u32 s19, s7, s20
    buffer_load_dwordx4 v[200:203], v172, s[8:11], s19 offen sc1
    v_mfma_f32_16x16x32_bf16 v[92:95], v[144:147], a[120:123], v[92:95]
    v_mfma_f32_16x16x32_bf16 v[92:95], v[160:163], a[124:127], v[92:95]
    v_mfma_f32_16x16x32_bf16 v[96:99], v[144:147], a[192:195], v[96:99]
    v_mfma_f32_16x16x32_bf16 v[96:99], v[160:163], a[196:199], v[96:99]
    buffer_load_dwordx4 v[204:207], v173, s[8:11], s19 offen sc1
    v_mfma_f32_16x16x32_bf16 v[100:103], v[144:147], v[228:231], v[100:103]
    v_mfma_f32_16x16x32_bf16 v[100:103], v[160:163], v[232:235], v[100:103]
    s_waitcnt vmcnt(32)
    v_mfma_f32_16x16x32_bf16 v[88:91], v[164:167], a[56:59], v[88:91]
    v_mfma_f32_16x16x32_bf16 v[88:91], v[168:171], a[60:63], v[88:91]
    s_add_u32 s7, s40, 5
    s_and_b32 s7, s7, 7
    s_mul_i32 s7, s7, 9216
    s_add_u32 s19, s7, s20
    buffer_load_dwordx4 v[208:211], v172, s[8:11], s19 offen sc1
    v_mfma_f32_16x16x32_bf16 v[92:95], v[164:167], a[128:131], v[92:95]
    v_mfma_f32_16x16x32_bf16 v[92:95], v[168:171], a[132:135], v[92:95]
    v_mfma_f32_16x16x32_bf16 v[96:99], v[164:167], a[200:203], v[96:99]
    v_mfma_f32_16x16x32_bf16 v[96:99], v[168:171], a[204:207], v[96:99]
    buffer_load_dwordx4 v[212:215], v173, s[8:11], s19 offen sc1
    v_mfma_f32_16x16x32_bf16 v[100:103], v[164:167], v[236:239], v[100:103]
    v_mfma_f32_16x16x32_bf16 v[100:103], v[168:171], v[240:243], v[100:103]
    s_waitcnt vmcnt(32)
    v_mfma_f32_16x16x32_bf16 v[88:91], v[148:151], a[64:67], v[88:91]
    v_mfma_f32_16x16x32_bf16 v[120:123], v[4:7], a[68:71], v[88:91]
    s_add_u32 s7, s40, 6
    s_and_b32 s7, s7, 7
    s_mul_i32 s7, s7, 9216
    s_add_u32 s19, s7, s20
    buffer_load_dwordx4 v[136:139], v172, s[8:11], s19 offen sc1
    v_mfma_f32_16x16x32_bf16 v[92:95], v[148:151], a[136:139], v[92:95]
    s_mov_b32 s74, 268435456
    v_mfma_f32_16x16x32_bf16 v[124:127], v[4:7], a[140:143], v[92:95]
    s_add_u32 s27, s27, 1024
    v_mfma_f32_16x16x32_bf16 v[96:99], v[148:151], a[208:211], v[96:99]
    s_add_u32 s25, s25, 1
    v_mfma_f32_16x16x32_bf16 v[128:131], v[4:7], a[212:215], v[96:99]
    buffer_load_dwordx4 v[140:143], v173, s[8:11], s19 offen sc1
    v_mfma_f32_16x16x32_bf16 v[100:103], v[148:151], v[244:247], v[100:103]
    s_add_u32 s23, s23, 18432
    v_mfma_f32_16x16x32_bf16 v[132:135], v[4:7], v[248:251], v[100:103]
    s_waitcnt vmcnt(31)
    v_mfma_f32_16x16x32_bf16 v[88:91], v[16:19], a[0:3], 0
    v_mfma_f32_16x16x32_bf16 v[88:91], v[20:23], a[4:7], v[88:91]
    s_add_u32 s7, s40, 7
    s_and_b32 s7, s7, 7
    s_mul_i32 s7, s7, 9216
    s_add_u32 s19, s7, s20
    buffer_load_dwordx4 v[144:147], v172, s[8:11], s19 offen sc1
    v_mfma_f32_16x16x32_bf16 v[92:95], v[16:19], a[72:75], 0
    v_mfma_f32_16x16x32_bf16 v[92:95], v[20:23], a[76:79], v[92:95]
    v_mfma_f32_16x16x32_bf16 v[96:99], v[16:19], a[144:147], 0
    v_mfma_f32_16x16x32_bf16 v[96:99], v[20:23], a[148:151], v[96:99]
    buffer_load_dwordx4 v[160:163], v173, s[8:11], s19 offen sc1
    v_mfma_f32_16x16x32_bf16 v[100:103], v[16:19], a[216:219], 0
    v_cvt_pk_bf16_f32 v152, v120, v121
    v_cvt_pk_bf16_f32 v153, v122, v123
    v_mfma_f32_16x16x32_bf16 v[100:103], v[20:23], a[220:223], v[100:103]
    v_cvt_pk_bf16_f32 v154, v124, v125
    v_cvt_pk_bf16_f32 v155, v126, v127
    s_waitcnt vmcnt(31)
    v_mfma_f32_16x16x32_bf16 v[88:91], v[24:27], a[8:11], v[88:91]
    s_nop 0
    v_permlane16_swap_b32 v152, v154
    v_mfma_f32_16x16x32_bf16 v[88:91], v[28:31], a[12:15], v[88:91]
    v_permlane16_swap_b32 v153, v155
    v_mfma_f32_16x16x32_bf16 v[92:95], v[24:27], a[80:83], v[92:95]
    buffer_store_dwordx4 v[152:155], v178, s[72:75], s27 offen sc1
    v_mfma_f32_16x16x32_bf16 v[92:95], v[28:31], a[84:87], v[92:95]
    ds_write_b128 v216, v[152:155]
    v_mfma_f32_16x16x32_bf16 v[96:99], v[24:27], a[152:155], v[96:99]
    v_add_u32 v216, v216, v218
    v_cvt_pk_bf16_f32 v156, v128, v129
    v_mfma_f32_16x16x32_bf16 v[96:99], v[28:31], a[156:159], v[96:99]
    v_cvt_pk_bf16_f32 v157, v130, v131
    v_cvt_pk_bf16_f32 v158, v132, v133
    v_mfma_f32_16x16x32_bf16 v[100:103], v[24:27], a[224:227], v[100:103]
    v_cvt_pk_bf16_f32 v159, v134, v135
    v_mfma_f32_16x16x32_bf16 v[100:103], v[28:31], a[228:231], v[100:103]
    s_nop 0
    v_permlane16_swap_b32 v156, v158
    s_waitcnt vmcnt(30)
    v_mfma_f32_16x16x32_bf16 v[88:91], v[32:35], a[16:19], v[88:91]
    v_permlane16_swap_b32 v157, v159
    v_mfma_f32_16x16x32_bf16 v[88:91], v[36:39], a[20:23], v[88:91]
    buffer_store_dwordx4 v[156:159], v179, s[72:75], s27 offen sc1
    v_mfma_f32_16x16x32_bf16 v[92:95], v[32:35], a[88:91], v[92:95]
    ds_write_b128 v217, v[156:159]
    v_mfma_f32_16x16x32_bf16 v[92:95], v[36:39], a[92:95], v[92:95]
    v_add_u32 v217, v217, v219
    v_mfma_f32_16x16x32_bf16 v[96:99], v[32:35], a[160:163], v[96:99]
    v_mfma_f32_16x16x32_bf16 v[96:99], v[36:39], a[164:167], v[96:99]
    v_mfma_f32_16x16x32_bf16 v[100:103], v[32:35], a[232:235], v[100:103]
    v_mfma_f32_16x16x32_bf16 v[100:103], v[36:39], a[236:239], v[100:103]
    s_waitcnt vmcnt(29)
    s_waitcnt vmcnt(16)
    s_barrier
    s_cmp_lg_u32 s3, 0
    s_cbranch_scc1 L_early_46
    s_mov_b64 exec, 0xff
    buffer_store_dword v1, v15, s[8:11], s29 offen offset:32 sc1
    s_mov_b64 exec, -1
L_early_46:
    v_mfma_f32_16x16x32_bf16 v[88:91], v[40:43], a[24:27], v[88:91]
    v_mfma_f32_16x16x32_bf16 v[88:91], v[44:47], a[28:31], v[88:91]
    v_mfma_f32_16x16x32_bf16 v[92:95], v[40:43], a[96:99], v[92:95]
    v_mfma_f32_16x16x32_bf16 v[92:95], v[44:47], a[100:103], v[92:95]
    v_mfma_f32_16x16x32_bf16 v[96:99], v[40:43], a[168:171], v[96:99]
    v_mfma_f32_16x16x32_bf16 v[96:99], v[44:47], a[172:175], v[96:99]
    v_mfma_f32_16x16x32_bf16 v[100:103], v[40:43], a[240:243], v[100:103]
    v_mfma_f32_16x16x32_bf16 v[100:103], v[44:47], a[244:247], v[100:103]
    s_waitcnt vmcnt(27)
    v_mfma_f32_16x16x32_bf16 v[88:91], v[48:51], a[32:35], v[88:91]
    v_mfma_f32_16x16x32_bf16 v[88:91], v[52:55], a[36:39], v[88:91]
    v_mfma_f32_16x16x32_bf16 v[92:95], v[48:51], a[104:107], v[92:95]
    v_mfma_f32_16x16x32_bf16 v[92:95], v[52:55], a[108:111], v[92:95]
    v_mfma_f32_16x16x32_bf16 v[96:99], v[48:51], a[176:179], v[96:99]
    v_mfma_f32_16x16x32_bf16 v[96:99], v[52:55], a[180:183], v[96:99]
    v_mfma_f32_16x16x32_bf16 v[100:103], v[48:51], a[248:251], v[100:103]
    v_mfma_f32_16x16x32_bf16 v[100:103], v[52:55], a[252:255], v[100:103]
    s_waitcnt vmcnt(24)
    v_mfma_f32_16x16x32_bf16 v[88:91], v[56:59], a[40:43], v[88:91]
    v_mfma_f32_16x16x32_bf16 v[88:91], v[60:63], a[44:47], v[88:91]
    v_mfma_f32_16x16x32_bf16 v[92:95], v[56:59], a[112:115], v[92:95]
    v_mfma_f32_16x16x32_bf16 v[92:95], v[60:63], a[116:119], v[92:95]
    v_mfma_f32_16x16x32_bf16 v[96:99], v[56:59], a[184:187], v[96:99]
    v_mfma_f32_16x16x32_bf16 v[96:99], v[60:63], a[188:191], v[96:99]
    v_mfma_f32_16x16x32_bf16 v[100:103], v[56:59], v[220:223], v[100:103]
    v_mfma_f32_16x16x32_bf16 v[100:103], v[60:63], v[224:227], v[100:103]
    s_waitcnt vmcnt(22)
    v_mfma_f32_16x16x32_bf16 v[88:91], v[64:67], a[48:51], v[88:91]
    v_mfma_f32_16x16x32_bf16 v[88:91], v[68:71], a[52:55], v[88:91]
    v_mfma_f32_16x16x32_bf16 v[92:95], v[64:67], a[120:123], v[92:95]
    v_mfma_f32_16x16x32_bf16 v[92:95], v[68:71], a[124:127], v[92:95]
    v_mfma_f32_16x16x32_bf16 v[96:99], v[64:67], a[192:195], v[96:99]
    v_mfma_f32_16x16x32_bf16 v[96:99], v[68:71], a[196:199], v[96:99]
    v_mfma_f32_16x16x32_bf16 v[100:103], v[64:67], v[228:231], v[100:103]
    v_mfma_f32_16x16x32_bf16 v[100:103], v[68:71], v[232:235], v[100:103]
    s_waitcnt vmcnt(20)
    v_mfma_f32_16x16x32_bf16 v[88:91], v[72:75], a[56:59], v[88:91]
    v_mfma_f32_16x16x32_bf16 v[88:91], v[76:79], a[60:63], v[88:91]
    v_mfma_f32_16x16x32_bf16 v[92:95], v[72:75], a[128:131], v[92:95]
    v_mfma_f32_16x16x32_bf16 v[92:95], v[76:79], a[132:135], v[92:95]
    v_mfma_f32_16x16x32_bf16 v[96:99], v[72:75], a[200:203], v[96:99]
    v_mfma_f32_16x16x32_bf16 v[96:99], v[76:79], a[204:207], v[96:99]
    v_mfma_f32_16x16x32_bf16 v[100:103], v[72:75], v[236:239], v[100:103]
    v_mfma_f32_16x16x32_bf16 v[100:103], v[76:79], v[240:243], v[100:103]
    s_waitcnt vmcnt(18)
    v_mfma_f32_16x16x32_bf16 v[88:91], v[80:83], a[64:67], v[88:91]
    v_mfma_f32_16x16x32_bf16 v[120:123], v[84:87], a[68:71], v[88:91]
    v_mfma_f32_16x16x32_bf16 v[92:95], v[80:83], a[136:139], v[92:95]
    s_mov_b32 s74, 268435456
    v_mfma_f32_16x16x32_bf16 v[124:127], v[84:87], a[140:143], v[92:95]
    s_add_u32 s27, s27, 1024
    v_mfma_f32_16x16x32_bf16 v[96:99], v[80:83], a[208:211], v[96:99]
    s_add_u32 s25, s25, 1
    v_mfma_f32_16x16x32_bf16 v[128:131], v[84:87], a[212:215], v[96:99]
    v_mfma_f32_16x16x32_bf16 v[100:103], v[80:83], v[244:247], v[100:103]
    s_add_u32 s23, s23, 18432
    v_mfma_f32_16x16x32_bf16 v[132:135], v[84:87], v[248:251], v[100:103]
    s_nop 7
    v_cvt_pk_bf16_f32 v152, v120, v121
    v_cvt_pk_bf16_f32 v153, v122, v123
    v_cvt_pk_bf16_f32 v154, v124, v125
    v_cvt_pk_bf16_f32 v155, v126, v127
    v_cvt_pk_bf16_f32 v156, v128, v129
    v_cvt_pk_bf16_f32 v157, v130, v131
    v_cvt_pk_bf16_f32 v158, v132, v133
    v_cvt_pk_bf16_f32 v159, v134, v135
    s_nop 0
    v_permlane16_swap_b32 v152, v154
    v_permlane16_swap_b32 v153, v155
    buffer_store_dwordx4 v[152:155], v178, s[72:75], s27 offen sc1
    s_nop 0
    v_permlane16_swap_b32 v156, v158
    v_permlane16_swap_b32 v157, v159
    buffer_store_dwordx4 v[156:159], v179, s[72:75], s27 offen sc1
    ds_write_b128 v216, v[152:155]
    ds_write_b128 v217, v[156:159]
    s_waitcnt lgkmcnt(0)
    v_lshlrev_b32 v15, 7, v0
    s_lshl_b32 s6, s40, 2
    s_add_u32 s6, s6, s44
    s_add_u32 s6, s6, 65536
    v_mov_b32 v1, s76
    s_mov_b64 vcc, 0xff
    s_waitcnt vmcnt(0)
    s_barrier
    s_cmp_lg_u32 s3, 0
    s_cbranch_scc1 L_pub_47
    s_mov_b64 exec, vcc
    buffer_store_dword v1, v15, s[8:11], s6 offen sc1
L_pub_47:
    s_mov_b64 exec, -1
    s_add_u32 s19, s18, s43
    s_add_u32 s22, s19, 45875200
    s_lshl_b32 s23, s21, 5
    s_add_u32 s23, s23, s43
    s_add_u32 s23, s23, 48431104
    s_cmp_ge_u32 s3, 2
    s_cbranch_scc1 L_late_48
    s_load_dwordx8 s[56:63], s[38:39], 32 glc
L_late_48:
    v_and_b32 v12, 7, v0
    v_lshlrev_b32 v12, 2, v12
    buffer_load_dword v10, v12, s[8:11], s23 offen sc1
    buffer_load_dwordx4 v[92:95], v172, s[8:11], s22 offen sc1
    buffer_load_dwordx4 v[96:99], v173, s[8:11], s22 offen sc1
    buffer_load_dwordx4 v[100:103], v174, s[8:11], s22 offen sc1
    v_min_u32 v13, 9216, v173
    ds_read_b128 v[148:151], v172 offset:4096
    ds_read_b128 v[152:155], v13 offset:4096
    ds_read_b128 v[156:159], v174 offset:4096
    s_lshl_b32 s28, s40, 2
    s_add_u32 s28, s28, s3
    s_mul_i32 s28, s28, 73728
    v_and_b32 v229, 8, v0
    v_lshl_add_u32 v229, v229, 27, v253
    s_mul_i32 s7, s42, 1073741824
    v_add_u32 v3, s7, v253
    v_or_b32 v229, s7, v229
    v_lshlrev_b32 v16, 16, v104
    v_and_b32 v17, s16, v104
    v_lshlrev_b32 v18, 16, v105
    v_and_b32 v19, s16, v105
    v_lshlrev_b32 v20, 16, v106
    v_and_b32 v21, s16, v106
    v_lshlrev_b32 v22, 16, v107
    v_and_b32 v23, s16, v107
    v_lshlrev_b32 v24, 16, v108
    v_and_b32 v25, s16, v108
    v_lshlrev_b32 v26, 16, v109
    v_and_b32 v27, s16, v109
    v_lshlrev_b32 v28, 16, v110
    v_and_b32 v29, s16, v110
    v_lshlrev_b32 v30, 16, v111
    v_and_b32 v31, s16, v111
    s_cmp_ge_u32 s3, 2
    s_cbranch_scc1 L_late_49
    s_mov_b32 s6, 0
L_epoll_51:
    s_waitcnt lgkmcnt(0)
    s_xor_b64 s[56:57], s[56:57], s[76:77]
    s_xor_b64 s[58:59], s[58:59], s[76:77]
    s_xor_b64 s[60:61], s[60:61], s[76:77]
    s_xor_b64 s[62:63], s[62:63], s[76:77]
    s_or_b64 s[56:57], s[56:57], s[58:59]
    s_or_b64 s[60:61], s[60:61], s[62:63]
    s_or_b64 s[56:57], s[56:57], s[60:61]
    s_cbranch_scc0 L_epolled_52
    s_load_dwordx8 s[56:63], s[38:39], 32 glc
    s_add_u32 s6, s6, 1
    s_cmp_lt_u32 s6, 1048576
    s_cbranch_scc1 L_epoll_51
    s_branch L_main_end
L_epolled_52:
    s_add_u32 s7, s40, 1
    s_and_b32 s7, s7, 7
    s_mul_i32 s7, s7, 9216
    s_add_u32 s19, s7, s20
    buffer_load_dwordx4 v[60:63], v174, s[8:11], s19 offen sc1
    s_add_u32 s7, s40, 2
    s_and_b32 s7, s7, 7
    s_mul_i32 s7, s7, 9216
    s_add_u32 s19, s7, s20
    buffer_load_dwordx4 v[64:67], v174, s[8:11], s19 offen sc1
    s_add_u32 s7, s40, 3
    s_and_b32 s7, s7, 7
    s_mul_i32 s7, s7, 9216
    s_add_u32 s19, s7, s20
    buffer_load_dwordx4 v[68:71], v174, s[8:11], s19 offen sc1
    s_add_u32 s7, s40, 4
    s_and_b32 s7, s7, 7
    s_mul_i32 s7, s7, 9216
    s_add_u32 s19, s7, s20
    buffer_load_dwordx4 v[72:75], v174, s[8:11], s19 offen sc1
    s_add_u32 s7, s40, 5
    s_and_b32 s7, s7, 7
    s_mul_i32 s7, s7, 9216
    s_add_u32 s19, s7, s20
    buffer_load_dwordx4 v[76:79], v174, s[8:11], s19 offen sc1
    s_add_u32 s7, s40, 6
    s_and_b32 s7, s7, 7
    s_mul_i32 s7, s7, 9216
    s_add_u32 s19, s7, s20
    buffer_load_dwordx4 v[80:83], v174, s[8:11], s19 offen sc1
    s_add_u32 s7, s40, 7
    s_and_b32 s7, s7, 7
    s_mul_i32 s7, s7, 9216
    s_add_u32 s19, s7, s20
    buffer_load_dwordx4 v[84:87], v174, s[8:11], s19 offen sc1
L_late_49:
    s_cmp_lg_u32 s42, 0
    s_cbranch_scc1 L_nopf_53
    buffer_load_dwordx4 a[0:3], v3, s[8:11], s28 offen offset:0 sc1
    buffer_load_dwordx4 a[4:7], v3, s[8:11], s28 offen offset:1024 sc1
    buffer_load_dwordx4 a[8:11], v3, s[8:11], s28 offen offset:2048 sc1
    buffer_load_dwordx4 a[12:15], v229, s[8:11], s28 offen offset:3072 sc1
    s_add_u32 s28, s28, 4096
    buffer_load_dwordx4 a[16:19], v3, s[8:11], s28 offen offset:0 sc1
    buffer_load_dwordx4 a[20:23], v3, s[8:11], s28 offen offset:1024 sc1
    buffer_load_dwordx4 a[24:27], v3, s[8:11], s28 offen offset:2048 sc1
    buffer_load_dwordx4 a[28:31], v229, s[8:11], s28 offen offset:3072 sc1
L_nopf_53:
    v_lshlrev_b32 v40, 16, v112
    v_and_b32 v41, s16, v112
    v_lshlrev_b32 v42, 16, v113
    v_and_b32 v43, s16, v113
    v_lshlrev_b32 v44, 16, v114
    v_and_b32 v45, s16, v114
    v_lshlrev_b32 v46, 16, v115
    v_and_b32 v47, s16, v115
    v_pk_add_f32 v[16:17], v[16:17], v[40:41]
    v_pk_add_f32 v[18:19], v[18:19], v[42:43]
    v_pk_add_f32 v[20:21], v[20:21], v[44:45]
    v_pk_add_f32 v[22:23], v[22:23], v[46:47]
    v_lshlrev_b32 v40, 16, v116
    v_and_b32 v41, s16, v116
    v_lshlrev_b32 v42, 16, v117
    v_and_b32 v43, s16, v117
    v_lshlrev_b32 v44, 16, v118
    v_and_b32 v45, s16, v118
    v_lshlrev_b32 v46, 16, v119
    v_and_b32 v47, s16, v119
    v_pk_add_f32 v[24:25], v[24:25], v[40:41]
    v_pk_add_f32 v[26:27], v[26:27], v[42:43]
    v_pk_add_f32 v[28:29], v[28:29], v[44:45]
    v_pk_add_f32 v[30:31], v[30:31], v[46:47]
    s_cmp_lg_u32 s42, 0
    s_cbranch_scc1 L_nopf_54
    s_add_u32 s28, s28, 4096
    buffer_load_dwordx4 a[32:35], v3, s[8:11], s28 offen offset:0 sc1
    buffer_load_dwordx4 a[36:39], v3, s[8:11], s28 offen offset:1024 sc1
    buffer_load_dwordx4 a[40:43], v3, s[8:11], s28 offen offset:2048 sc1
    buffer_load_dwordx4 a[44:47], v229, s[8:11], s28 offen offset:3072 sc1
    s_add_u32 s28, s28, 4096
    buffer_load_dwordx4 a[48:51], v3, s[8:11], s28 offen offset:0 sc1
    buffer_load_dwordx4 a[52:55], v3, s[8:11], s28 offen offset:1024 sc1
    buffer_load_dwordx4 a[56:59], v3, s[8:11], s28 offen offset:2048 sc1
    buffer_load_dwordx4 a[60:63], v229, s[8:11], s28 offen offset:3072 sc1
L_nopf_54:
    v_lshlrev_b32 v40, 16, v180
    v_and_b32 v41, s16, v180
    v_lshlrev_b32 v42, 16, v181
    v_and_b32 v43, s16, v181
    v_lshlrev_b32 v44, 16, v182
    v_and_b32 v45, s16, v182
    v_lshlrev_b32 v46, 16, v183
    v_and_b32 v47, s16, v183
    v_pk_add_f32 v[16:17], v[16:17], v[40:41]
    v_pk_add_f32 v[18:19], v[18:19], v[42:43]
    v_pk_add_f32 v[20:21], v[20:21], v[44:45]
    v_pk_add_f32 v[22:23], v[22:23], v[46:47]
    v_lshlrev_b32 v40, 16, v196
    v_and_b32 v41, s16, v196
    v_lshlrev_b32 v42, 16, v197
    v_and_b32 v43, s16, v197
    v_lshlrev_b32 v44, 16, v198
    v_and_b32 v45, s16, v198
    v_lshlrev_b32 v46, 16, v199
    v_and_b32 v47, s16, v199
    v_pk_add_f32 v[24:25], v[24:25], v[40:41]
    v_pk_add_f32 v[26:27], v[26:27], v[42:43]
    v_pk_add_f32 v[28:29], v[28:29], v[44:45]
    v_pk_add_f32 v[30:31], v[30:31], v[46:47]
    v_lshlrev_b32 v40, 16, v200
    v_and_b32 v41, s16, v200
    v_lshlrev_b32 v42, 16, v201
    v_and_b32 v43, s16, v201
    v_lshlrev_b32 v44, 16, v202
    v_and_b32 v45, s16, v202
    v_lshlrev_b32 v46, 16, v203
    v_and_b32 v47, s16, v203
    v_pk_add_f32 v[16:17], v[16:17], v[40:41]
    v_pk_add_f32 v[18:19], v[18:19], v[42:43]
    v_pk_add_f32 v[20:21], v[20:21], v[44:45]
    v_pk_add_f32 v[22:23], v[22:23], v[46:47]
    v_lshlrev_b32 v40, 16, v204
    v_and_b32 v41, s16, v204
    v_lshlrev_b32 v42, 16, v205
    v_and_b32 v43, s16, v205
    v_lshlrev_b32 v44, 16, v206
    v_and_b32 v45, s16, v206
    v_lshlrev_b32 v46, 16, v207
    v_and_b32 v47, s16, v207
    v_pk_add_f32 v[24:25], v[24:25], v[40:41]
    v_pk_add_f32 v[26:27], v[26:27], v[42:43]
    v_pk_add_f32 v[28:29], v[28:29], v[44:45]
    v_pk_add_f32 v[30:31], v[30:31], v[46:47]
    v_lshlrev_b32 v40, 16, v208
    v_and_b32 v41, s16, v208
    v_lshlrev_b32 v42, 16, v209
    v_and_b32 v43, s16, v209
    v_lshlrev_b32 v44, 16, v210
    v_and_b32 v45, s16, v210
    v_lshlrev_b32 v46, 16, v211
    v_and_b32 v47, s16, v211
    v_pk_add_f32 v[16:17], v[16:17], v[40:41]
    v_pk_add_f32 v[18:19], v[18:19], v[42:43]
    v_pk_add_f32 v[20:21], v[20:21], v[44:45]
    v_pk_add_f32 v[22:23], v[22:23], v[46:47]
    v_lshlrev_b32 v40, 16, v212
    v_and_b32 v41, s16, v212
    v_lshlrev_b32 v42, 16, v213
    v_and_b32 v43, s16, v213
    v_lshlrev_b32 v44, 16, v214
    v_and_b32 v45, s16, v214
    v_lshlrev_b32 v46, 16, v215
    v_and_b32 v47, s16, v215
    v_pk_add_f32 v[24:25], v[24:25], v[40:41]
    v_pk_add_f32 v[26:27], v[26:27], v[42:43]
    v_pk_add_f32 v[28:29], v[28:29], v[44:45]
    v_pk_add_f32 v[30:31], v[30:31], v[46:47]
    v_lshlrev_b32 v40, 16, v136
    v_and_b32 v41, s16, v136
    v_lshlrev_b32 v42, 16, v137
    v_and_b32 v43, s16, v137
    v_lshlrev_b32 v44, 16, v138
    v_and_b32 v45, s16, v138
    v_lshlrev_b32 v46, 16, v139
    v_and_b32 v47, s16, v139
    v_pk_add_f32 v[16:17], v[16:17], v[40:41]
    v_pk_add_f32 v[18:19], v[18:19], v[42:43]
    v_pk_add_f32 v[20:21], v[20:21], v[44:45]
    v_pk_add_f32 v[22:23], v[22:23], v[46:47]
    v_lshlrev_b32 v40, 16, v140
    v_and_b32 v41, s16, v140
    v_lshlrev_b32 v42, 16, v141
    v_and_b32 v43, s16, v141
    v_lshlrev_b32 v44, 16, v142
    v_and_b32 v45, s16, v142
    v_lshlrev_b32 v46, 16, v143
    v_and_b32 v47, s16, v143
    v_pk_add_f32 v[24:25], v[24:25], v[40:41]
    v_pk_add_f32 v[26:27], v[26:27], v[42:43]
    v_pk_add_f32 v[28:29], v[28:29], v[44:45]
    v_pk_add_f32 v[30:31], v[30:31], v[46:47]
    v_lshlrev_b32 v40, 16, v144
    v_and_b32 v41, s16, v144
    v_lshlrev_b32 v42, 16, v145
    v_and_b32 v43, s16, v145
    v_lshlrev_b32 v44, 16, v146
    v_and_b32 v45, s16, v146
    v_lshlrev_b32 v46, 16, v147
    v_and_b32 v47, s16, v147
    v_pk_add_f32 v[16:17], v[16:17], v[40:41]
    v_pk_add_f32 v[18:19], v[18:19], v[42:43]
    v_pk_add_f32 v[20:21], v[20:21], v[44:45]
    v_pk_add_f32 v[22:23], v[22:23], v[46:47]
    v_lshlrev_b32 v40, 16, v160
    v_and_b32 v41, s16, v160
    v_lshlrev_b32 v42, 16, v161
    v_and_b32 v43, s16, v161
    v_lshlrev_b32 v44, 16, v162
    v_and_b32 v45, s16, v162
    v_lshlrev_b32 v46, 16, v163
    v_and_b32 v47, s16, v163
    v_pk_add_f32 v[24:25], v[24:25], v[40:41]
    v_pk_add_f32 v[26:27], v[26:27], v[42:43]
    v_pk_add_f32 v[28:29], v[28:29], v[44:45]
    v_pk_add_f32 v[30:31], v[30:31], v[46:47]
    s_cmp_lg_u32 s3, 3
    s_cbranch_scc1 L_pollout_57
    s_lshl_b32 s7, s40, 7
    s_add_u32 s7, s7, s44
    s_add_u32 s7, s7, 65536
    s_add_u32 s52, s4, s7
    s_addc_u32 s53, s5, 0
    s_mov_b32 s6, 0
L_poll_55:
    s_load_dwordx8 s[56:63], s[52:53], 0 glc
    s_add_u32 s6, s6, 1
    s_waitcnt lgkmcnt(0)
    s_xor_b64 s[56:57], s[56:57], s[76:77]
    s_xor_b64 s[58:59], s[58:59], s[76:77]
    s_xor_b64 s[60:61], s[60:61], s[76:77]
    s_xor_b64 s[62:63], s[62:63], s[76:77]
    s_or_b64 s[56:57], s[56:57], s[58:59]
    s_or_b64 s[60:61], s[60:61], s[62:63]
    s_or_b64 s[56:57], s[56:57], s[60:61]
    s_cbranch_scc0 L_polled_56
    s_cmp_lt_u32 s6, 1048576
    s_cbranch_scc1 L_poll_55
    s_branch L_main_end
L_polled_56:
L_pollout_57:
    s_barrier
    s_cmp_lt_u32 s3, 2
    s_cbranch_scc1 L_late_50
    s_add_u32 s7, s40, 1
    s_and_b32 s7, s7, 7
    s_mul_i32 s7, s7, 9216
    s_add_u32 s19, s7, s20
    buffer_load_dwordx4 v[60:63], v174, s[8:11], s19 offen sc1
    s_add_u32 s7, s40, 2
    s_and_b32 s7, s7, 7
    s_mul_i32 s7, s7, 9216
    s_add_u32 s19, s7, s20
    buffer_load_dwordx4 v[64:67], v174, s[8:11], s19 offen sc1
    s_add_u32 s7, s40, 3
    s_and_b32 s7, s7, 7
    s_mul_i32 s7, s7, 9216
    s_add_u32 s19, s7, s20
    buffer_load_dwordx4 v[68:71], v174, s[8:11], s19 offen sc1
    s_add_u32 s7, s40, 4
    s_and_b32 s7, s7, 7
    s_mul_i32 s7, s7, 9216
    s_add_u32 s19, s7, s20
    buffer_load_dwordx4 v[72:75], v174, s[8:11], s19 offen sc1
    s_add_u32 s7, s40, 5
    s_and_b32 s7, s7, 7
    s_mul_i32 s7, s7, 9216
    s_add_u32 s19, s7, s20
    buffer_load_dwordx4 v[76:79], v174, s[8:11], s19 offen sc1
    s_add_u32 s7, s40, 6
    s_and_b32 s7, s7, 7
    s_mul_i32 s7, s7, 9216
    s_add_u32 s19, s7, s20
    buffer_load_dwordx4 v[80:83], v174, s[8:11], s19 offen sc1
    s_add_u32 s7, s40, 7
    s_and_b32 s7, s7, 7
    s_mul_i32 s7, s7, 9216
    s_add_u32 s19, s7, s20
    buffer_load_dwordx4 v[84:87], v174, s[8:11], s19 offen sc1
L_late_50:
    s_cmp_eq_u32 s3, 0
    s_cselect_b32 s7, 1.0, 0
    s_cselect_b32 s6, -1, 0
    s_waitcnt vmcnt(7) lgkmcnt(0)
    v_and_b32 v152, s6, v152
    v_and_b32 v153, s6, v153
    v_and_b32 v154, s6, v154
    v_and_b32 v155, s6, v155
    v_mul_f32 v11, s7, v10
    v_lshlrev_b32 v40, 16, v92
    v_and_b32 v41, s16, v92
    v_lshlrev_b32 v42, 16, v93
    v_and_b32 v43, s16, v93
    v_lshlrev_b32 v44, 16, v94
    v_and_b32 v45, s16, v94
    v_lshlrev_b32 v46, 16, v95
    v_and_b32 v47, s16, v95
    v_pk_add_f32 v[16:17], v[16:17], v[40:41]
    v_pk_add_f32 v[18:19], v[18:19], v[42:43]
    v_pk_add_f32 v[20:21], v[20:21], v[44:45]
    v_pk_add_f32 v[22:23], v[22:23], v[46:47]
    v_lshlrev_b32 v40, 16, v96
    v_and_b32 v41, s16, v96
    v_lshlrev_b32 v42, 16, v97
    v_and_b32 v43, s16, v97
    v_lshlrev_b32 v44, 16, v98
    v_and_b32 v45, s16, v98
    v_lshlrev_b32 v46, 16, v99
    v_and_b32 v47, s16, v99
    v_pk_add_f32 v[24:25], v[24:25], v[40:41]
    v_pk_add_f32 v[26:27], v[26:27], v[42:43]
    v_pk_add_f32 v[28:29], v[28:29], v[44:45]
    v_pk_add_f32 v[30:31], v[30:31], v[46:47]
    v_lshlrev_b32 v32, 16, v100
    v_and_b32 v33, s16, v100
    v_lshlrev_b32 v34, 16, v101
    v_and_b32 v35, s16, v101
    v_lshlrev_b32 v36, 16, v102
    v_and_b32 v37, s16, v102
    v_lshlrev_b32 v38, 16, v103
    v_and_b32 v39, s16, v103
    v_lshlrev_b32 v40, 16, v148
    v_and_b32 v41, s16, v148
    v_lshlrev_b32 v42, 16, v149
    v_and_b32 v43, s16, v149
    v_lshlrev_b32 v44, 16, v150
    v_and_b32 v45, s16, v150
    v_lshlrev_b32 v46, 16, v151
    v_and_b32 v47, s16, v151
    v_pk_add_f32 v[16:17], v[16:17], v[40:41]
    v_pk_add_f32 v[18:19], v[18:19], v[42:43]
    v_pk_add_f32 v[20:21], v[20:21], v[44:45]
    v_pk_add_f32 v[22:23], v[22:23], v[46:47]
    v_lshlrev_b32 v40, 16, v152
    v_and_b32 v41, s16, v152
    v_lshlrev_b32 v42, 16, v153
    v_and_b32 v43, s16, v153
    v_lshlrev_b32 v44, 16, v154
    v_and_b32 v45, s16, v154
    v_lshlrev_b32 v46, 16, v155
    v_and_b32 v47, s16, v155
    v_pk_add_f32 v[24:25], v[24:25], v[40:41]
    v_pk_add_f32 v[26:27], v[26:27], v[42:43]
    v_pk_add_f32 v[28:29], v[28:29], v[44:45]
    v_pk_add_f32 v[30:31], v[30:31], v[46:47]
    v_lshlrev_b32 v40, 16, v156
    v_and_b32 v41, s16, v156
    v_lshlrev_b32 v42, 16, v157
    v_and_b32 v43, s16, v157
    v_lshlrev_b32 v44, 16, v158
    v_and_b32 v45, s16, v158
    v_lshlrev_b32 v46, 16, v159
    v_and_b32 v47, s16, v159
    v_pk_add_f32 v[32:33], v[32:33], v[40:41]
    v_pk_add_f32 v[34:35], v[34:35], v[42:43]
    v_pk_add_f32 v[36:37], v[36:37], v[44:45]
    v_pk_add_f32 v[38:39], v[38:39], v[46:47]
    v_pk_add_f32 v[16:17], v[16:17], v[10:11] op_sel_hi:[1,0]
    v_pk_add_f32 v[18:19], v[18:19], v[10:11] op_sel_hi:[1,0]
    v_pk_add_f32 v[20:21], v[20:21], v[10:11] op_sel_hi:[1,0]
    v_pk_add_f32 v[22:23], v[22:23], v[10:11] op_sel_hi:[1,0]
    v_pk_add_f32 v[24:25], v[24:25], v[10:11] op_sel:[0,1] op_sel_hi:[1,1]
    v_pk_add_f32 v[26:27], v[26:27], v[10:11] op_sel:[0,1] op_sel_hi:[1,1]
    v_pk_add_f32 v[28:29], v[28:29], v[10:11] op_sel:[0,1] op_sel_hi:[1,1]
    v_pk_add_f32 v[30:31], v[30:31], v[10:11] op_sel:[0,1] op_sel_hi:[1,1]
    v_pk_add_f32 v[32:33], v[32:33], v[10:11] op_sel_hi:[1,0]
    v_pk_add_f32 v[34:35], v[34:35], v[10:11] op_sel_hi:[1,0]
    v_pk_add_f32 v[36:37], v[36:37], v[10:11] op_sel_hi:[1,0]
    v_pk_add_f32 v[38:39], v[38:39], v[10:11] op_sel_hi:[1,0]
    s_waitcnt vmcnt(6)
    s_add_u32 s28, s28, 4096
    buffer_load_dwordx4 a[64:67], v3, s[8:11], s28 offen offset:0 sc1
    v_lshlrev_b32 v40, 16, v60
    v_and_b32 v41, s16, v60
    v_lshlrev_b32 v42, 16, v61
    v_and_b32 v43, s16, v61
    v_lshlrev_b32 v44, 16, v62
    v_and_b32 v45, s16, v62
    v_lshlrev_b32 v46, 16, v63
    v_and_b32 v47, s16, v63
    v_pk_add_f32 v[32:33], v[32:33], v[40:41]
    v_pk_add_f32 v[34:35], v[34:35], v[42:43]
    v_pk_add_f32 v[36:37], v[36:37], v[44:45]
    v_pk_add_f32 v[38:39], v[38:39], v[46:47]
    s_waitcnt vmcnt(6)
    buffer_load_dwordx4 a[68:71], v3, s[8:11], s28 offen offset:1024 sc1
    v_lshlrev_b32 v40, 16, v64
    v_and_b32 v41, s16, v64
    v_lshlrev_b32 v42, 16, v65
    v_and_b32 v43, s16, v65
    v_lshlrev_b32 v44, 16, v66
    v_and_b32 v45, s16, v66
    v_lshlrev_b32 v46, 16, v67
    v_and_b32 v47, s16, v67
    v_pk_add_f32 v[32:33], v[32:33], v[40:41]
    v_pk_add_f32 v[34:35], v[34:35], v[42:43]
    v_pk_add_f32 v[36:37], v[36:37], v[44:45]
    v_pk_add_f32 v[38:39], v[38:39], v[46:47]
    s_waitcnt vmcnt(6)
    buffer_load_dwordx4 a[72:75], v3, s[8:11], s28 offen offset:2048 sc1
    v_lshlrev_b32 v40, 16, v68
    v_and_b32 v41, s16, v68
    v_lshlrev_b32 v42, 16, v69
    v_and_b32 v43, s16, v69
    v_lshlrev_b32 v44, 16, v70
    v_and_b32 v45, s16, v70
    v_lshlrev_b32 v46, 16, v71
    v_and_b32 v47, s16, v71
    v_pk_add_f32 v[32:33], v[32:33], v[40:41]
    v_pk_add_f32 v[34:35], v[34:35], v[42:43]
    v_pk_add_f32 v[36:37], v[36:37], v[44:45]
    v_pk_add_f32 v[38:39], v[38:39], v[46:47]
    s_waitcnt vmcnt(6)
    buffer_load_dwordx4 a[76:79], v229, s[8:11], s28 offen offset:3072 sc1
    v_lshlrev_b32 v40, 16, v72
    v_and_b32 v41, s16, v72
    v_lshlrev_b32 v42, 16, v73
    v_and_b32 v43, s16, v73
    v_lshlrev_b32 v44, 16, v74
    v_and_b32 v45, s16, v74
    v_lshlrev_b32 v46, 16, v75
    v_and_b32 v47, s16, v75
    v_pk_add_f32 v[32:33], v[32:33], v[40:41]
    v_pk_add_f32 v[34:35], v[34:35], v[42:43]
    v_pk_add_f32 v[36:37], v[36:37], v[44:45]
    v_pk_add_f32 v[38:39], v[38:39], v[46:47]
    s_waitcnt vmcnt(6)
    s_add_u32 s28, s28, 4096
    buffer_load_dwordx4 a[80:83], v3, s[8:11], s28 offen offset:0 sc1
    v_lshlrev_b32 v40, 16, v76
    v_and_b32 v41, s16, v76
    v_lshlrev_b32 v42, 16, v77
    v_and_b32 v43, s16, v77
    v_lshlrev_b32 v44, 16, v78
    v_and_b32 v45, s16, v78
    v_lshlrev_b32 v46, 16, v79
    v_and_b32 v47, s16, v79
    v_pk_add_f32 v[32:33], v[32:33], v[40:41]
    v_pk_add_f32 v[34:35], v[34:35], v[42:43]
    v_pk_add_f32 v[36:37], v[36:37], v[44:45]
    v_pk_add_f32 v[38:39], v[38:39], v[46:47]
    s_waitcnt vmcnt(6)
    buffer_load_dwordx4 a[84:87], v3, s[8:11], s28 offen offset:1024 sc1
    v_lshlrev_b32 v40, 16, v80
    v_and_b32 v41, s16, v80
    v_lshlrev_b32 v42, 16, v81
    v_and_b32 v43, s16, v81
    v_lshlrev_b32 v44, 16, v82
    v_and_b32 v45, s16, v82
    v_lshlrev_b32 v46, 16, v83
    v_and_b32 v47, s16, v83
    v_pk_add_f32 v[32:33], v[32:33], v[40:41]
    v_pk_add_f32 v[34:35], v[34:35], v[42:43]
    v_pk_add_f32 v[36:37], v[36:37], v[44:45]
    v_pk_add_f32 v[38:39], v[38:39], v[46:47]
    s_waitcnt vmcnt(6)
    buffer_load_dwordx4 a[88:91], v3, s[8:11], s28 offen offset:2048 sc1
    v_lshlrev_b32 v40, 16, v84
    v_and_b32 v41, s16, v84
    v_lshlrev_b32 v42, 16, v85
    v_and_b32 v43, s16, v85
    v_lshlrev_b32 v44, 16, v86
    v_and_b32 v45, s16, v86
    v_lshlrev_b32 v46, 16, v87
    v_and_b32 v47, s16, v87
    v_pk_add_f32 v[32:33], v[32:33], v[40:41]
    v_pk_add_f32 v[34:35], v[34:35], v[42:43]
    v_pk_add_f32 v[36:37], v[36:37], v[44:45]
    v_pk_add_f32 v[38:39], v[38:39], v[46:47]
    buffer_load_dwordx4 a[92:95], v229, s[8:11], s28 offen offset:3072 sc1
    v_cvt_pk_bf16_f32 v120, v16, v17
    v_cvt_pk_bf16_f32 v121, v18, v19
    v_cvt_pk_bf16_f32 v122, v20, v21
    v_cvt_pk_bf16_f32 v123, v22, v23
    v_cvt_pk_bf16_f32 v124, v24, v25
    v_cvt_pk_bf16_f32 v125, v26, v27
    v_cvt_pk_bf16_f32 v126, v28, v29
    v_cvt_pk_bf16_f32 v127, v30, v31
    v_cvt_pk_bf16_f32 v128, v32, v33
    v_cvt_pk_bf16_f32 v129, v34, v35
    v_cvt_pk_bf16_f32 v130, v36, v37
    v_cvt_pk_bf16_f32 v131, v38, v39
    s_cmp_lg_u32 s42, 0
    s_cbranch_scc1 L_main_last
    s_add_u32 s19, s18, 53215232
    s_add_u32 s20, s18, 48496640
    s_lshl_b32 s22, s21, 7
    s_add_u32 s22, s22, 57933824
    buffer_store_dwordx4 v[120:123], v172, s[8:11], s19 offen sc1
    buffer_store_dwordx4 v[124:127], v173, s[8:11], s19 offen sc1
    buffer_store_dwordx4 v[128:131], v174, s[8:11], s19 offen sc1
    s_mov_b32 s17, 0x3f803f80
    v_mov_b32 v8, 0
    v_mov_b32 v9, 0
    v_mov_b32 v10, 0
    v_mov_b32 v11, 0
    v_dot2c_f32_bf16 v8, s17, v120
    v_dot2c_f32_bf16 v9, v120, v120
    v_dot2c_f32_bf16 v10, s17, v121
    v_dot2c_f32_bf16 v11, v121, v121
    v_dot2c_f32_bf16 v8, s17, v122
    v_dot2c_f32_bf16 v9, v122, v122
    v_dot2c_f32_bf16 v10, s17, v123
    v_dot2c_f32_bf16 v11, v123, v123
    v_dot2c_f32_bf16 v8, s17, v124
    v_dot2c_f32_bf16 v9, v124, v124
    v_dot2c_f32_bf16 v10, s17, v125
    v_dot2c_f32_bf16 v11, v125, v125
    v_dot2c_f32_bf16 v8, s17, v126
    v_dot2c_f32_bf16 v9, v126, v126
    v_dot2c_f32_bf16 v10, s17, v127
    v_dot2c_f32_bf16 v11, v127, v127
    v_dot2c_f32_bf16 v8, s17, v128
    v_dot2c_f32_bf16 v9, v128, v128
    v_dot2c_f32_bf16 v10, s17, v129
    v_dot2c_f32_bf16 v11, v129, v129
    v_dot2c_f32_bf16 v8, s17, v130
    v_dot2c_f32_bf16 v9, v130, v130
    v_dot2c_f32_bf16 v10, s17, v131
    v_dot2c_f32_bf16 v11, v131, v131
    v_and_b32 v12, 7, v0
    v_lshlrev_b32 v12, 3, v12
    s_lshl_b32 s7, s3, 6
    v_add_u32 v13, s7, v12
    v_pk_add_f32 v[8:9], v[8:9], v[10:11]
    s_nop 1
    v_add_f32_dpp v8, v8, v8 row_ror:8 row_mask:0xf bank_mask:0xf
    v_add_f32_dpp v9, v9, v9 row_ror:8 row_mask:0xf bank_mask:0xf
    v_mov_b32 v10, v8
    v_mov_b32 v11, v9
    s_nop 1
    v_permlane32_swap_b32 v10, v8
    v_permlane32_swap_b32 v11, v9
    v_add_f32 v8, v8, v10
    v_add_f32 v9, v9, v11
    v_mov_b32 v10, v8
    v_mov_b32 v11, v9
    s_nop 1
    v_permlane16_swap_b32 v10, v8
    v_permlane16_swap_b32 v11, v9
    v_add_f32 v8, v8, v10
    v_add_f32 v9, v9, v11
    ds_write_b64 v13, v[8:9]
    s_waitcnt lgkmcnt(0)
    s_barrier
    ds_read_b64 v[40:41], v12 offset:0
    ds_read_b64 v[42:43], v12 offset:64
    ds_read_b64 v[44:45], v12 offset:128
    ds_read_b64 v[46:47], v12 offset:192
    s_waitcnt lgkmcnt(0)
    v_pk_add_f32 v[40:41], v[40:41], v[42:43]
    v_pk_add_f32 v[44:45], v[44:45], v[46:47]
    v_pk_add_f32 v[8:9], v[40:41], v[44:45]
    v_mul_f32 v8, 0x3ae38e39, v8
    v_mul_f32 v9, 0x3ae38e39, v9
    v_fma_f32 v9, -v8, v8, v9
    v_max_f32 v9, 0, v9
    v_add_f32 v9, 0x3727c5ac, v9
    v_rsq_f32 v10, v9
    s_nop 0
    v_mul_f32 v12, v8, v10
    v_mov_b32 v11, v10
    v_sub_f32 v12, 0, v12
    v_mov_b32 v13, v12
    s_cmp_eq_u32 s3, 0
    s_cselect_b32 s7, 32, 0
    v_lshlrev_b32 v14, 2, v0
    v_cmp_gt_u32 vcc, s7, v0
    v_mov_b32 v9, 1073741824
    s_nop 0
    v_cndmask_b32 v14, v9, v14, vcc
    buffer_store_dword v8, v14, s[8:11], s22 offen sc1
    v_lshlrev_b32 v40, 16, v120
    v_and_b32 v41, s16, v120
    v_lshlrev_b32 v42, 16, v121
    v_and_b32 v43, s16, v121
    v_lshlrev_b32 v44, 16, v122
    v_and_b32 v45, s16, v122
    v_lshlrev_b32 v46, 16, v123
    v_and_b32 v47, s16, v123
    v_pk_fma_f32 v[40:41], v[40:41], v[10:11], v[12:13]
    v_pk_fma_f32 v[42:43], v[42:43], v[10:11], v[12:13]
    v_pk_fma_f32 v[44:45], v[44:45], v[10:11], v[12:13]
    v_pk_fma_f32 v[46:47], v[46:47], v[10:11], v[12:13]
    v_cvt_pk_bf16_f32 v48, v40, v41
    v_cvt_pk_bf16_f32 v49, v42, v43
    v_cvt_pk_bf16_f32 v50, v44, v45
    v_cvt_pk_bf16_f32 v51, v46, v47
    v_lshlrev_b32 v40, 16, v124
    v_and_b32 v41, s16, v124
    v_lshlrev_b32 v42, 16, v125
    v_and_b32 v43, s16, v125
    v_lshlrev_b32 v44, 16, v126
    v_and_b32 v45, s16, v126
    v_lshlrev_b32 v46, 16, v127
    v_and_b32 v47, s16, v127
    v_pk_fma_f32 v[40:41], v[40:41], v[10:11], v[12:13]
    v_pk_fma_f32 v[42:43], v[42:43], v[10:11], v[12:13]
    v_pk_fma_f32 v[44:45], v[44:45], v[10:11], v[12:13]
    v_pk_fma_f32 v[46:47], v[46:47], v[10:11], v[12:13]
    v_cvt_pk_bf16_f32 v52, v40, v41
    v_cvt_pk_bf16_f32 v53, v42, v43
    v_cvt_pk_bf16_f32 v54, v44, v45
    v_cvt_pk_bf16_f32 v55, v46, v47
    v_lshlrev_b32 v40, 16, v128
    v_and_b32 v41, s16, v128
    v_lshlrev_b32 v42, 16, v129
    v_and_b32 v43, s16, v129
    v_lshlrev_b32 v44, 16, v130
    v_and_b32 v45, s16, v130
    v_lshlrev_b32 v46, 16, v131
    v_and_b32 v47, s16, v131
    v_pk_fma_f32 v[40:41], v[40:41], v[10:11], v[12:13]
    v_pk_fma_f32 v[42:43], v[42:43], v[10:11], v[12:13]
    v_pk_fma_f32 v[44:45], v[44:45], v[10:11], v[12:13]
    v_pk_fma_f32 v[46:47], v[46:47], v[10:11], v[12:13]
    v_cvt_pk_bf16_f32 v56, v40, v41
    v_cvt_pk_bf16_f32 v57, v42, v43
    v_cvt_pk_bf16_f32 v58, v44, v45
    v_cvt_pk_bf16_f32 v59, v46, v47
    buffer_store_dwordx4 v[48:51], v172, s[8:11], s20 offen sc1
    buffer_store_dwordx4 v[52:55], v173, s[8:11], s20 offen sc1
    buffer_store_dwordx4 v[56:59], v174, s[8:11], s20 offen sc1
    v_lshlrev_b32 v15, 7, v0
    s_lshl_b32 s6, s40, 2
    s_add_u32 s6, s6, s44
    s_add_u32 s6, s6, 98304
    v_mov_b32 v1, s76
    s_mov_b64 vcc, 0xff
    v_lshrrev_b32 v14, 3, v0
    v_lshl_add_u32 v15, v14, 3, v15
    s_cmp_ge_u32 s40, 6
    s_cselect_b32 s7, s41, 31
    s_cmp_lt_u32 s7, 31
    s_cmov_b64 vcc, 0xffff
    s_waitcnt vmcnt(0)
    s_barrier
    s_cmp_lg_u32 s3, 0
    s_cbranch_scc1 L_pub_58
    s_mov_b64 exec, vcc
    buffer_store_dword v1, v15, s[8:11], s6 offen sc1
L_pub_58:
    s_mov_b64 exec, -1
    s_add_u32 s28, s28, 4096
    buffer_load_dwordx4 a[96:99], v3, s[8:11], s28 offen offset:0 sc1
    buffer_load_dwordx4 a[100:103], v3, s[8:11], s28 offen offset:1024 sc1
    buffer_load_dwordx4 a[104:107], v3, s[8:11], s28 offen offset:2048 sc1
    buffer_load_dwordx4 a[108:111], v229, s[8:11], s28 offen offset:3072 sc1
    s_add_u32 s28, s28, 4096
    buffer_load_dwordx4 a[112:115], v3, s[8:11], s28 offen offset:0 sc1
    buffer_load_dwordx4 a[116:119], v3, s[8:11], s28 offen offset:1024 sc1
    buffer_load_dwordx4 a[120:123], v3, s[8:11], s28 offen offset:2048 sc1
    buffer_load_dwordx4 a[124:127], v229, s[8:11], s28 offen offset:3072 sc1
    s_add_u32 s28, s28, 4096
    buffer_load_dwordx4 a[128:131], v3, s[8:11], s28 offen offset:0 sc1
    buffer_load_dwordx4 a[132:135], v3, s[8:11], s28 offen offset:1024 sc1
    buffer_load_dwordx4 a[136:139], v3, s[8:11], s28 offen offset:2048 sc1
    buffer_load_dwordx4 a[140:143], v229, s[8:11], s28 offen offset:3072 sc1
    s_add_u32 s28, s28, 4096
    s_mov_b32 s42, 1
    s_mov_b32 s43, 9699328
    s_add_u32 s44, s44, 131072
    s_branch L_main_layer
L_main_last:
    buffer_store_dwordx4 v[120:123], v175, s[12:15], s18 offen sc0 sc1
    buffer_store_dwordx4 v[124:127], v176, s[12:15], s18 offen sc0 sc1
    buffer_store_dwordx4 v[128:131], v177, s[12:15], s18 offen sc0 sc1
    s_or_b32 s7, s40, s41
    s_or_b32 s7, s7, s3
    s_cbranch_scc1 L_done_59
    v_mov_b32 v1, s76
    s_mov_b32 s7, 19660800
    s_mov_b64 exec, 1
    buffer_store_dword v1, off, s[8:11], s7 sc1
    s_mov_b64 exec, -1
L_done_59:
L_main_end:
    s_endpgm
L_main_code_end:
.section .rodata,"a"
.p2align 6
.amdhsa_kernel interleave_layers__sliding_local_dilated__glu_gated_geglu__prompt_kernel
.amdhsa_next_free_vgpr 512
.amdhsa_next_free_sgpr 102
.amdhsa_accum_offset 256
.amdhsa_group_segment_fixed_size 0
.amdhsa_kernarg_size 80
.amdhsa_user_sgpr_count 2
.amdhsa_user_sgpr_kernarg_segment_ptr 1
.amdhsa_system_sgpr_workgroup_id_x 1
.amdhsa_float_denorm_mode_32 3
.amdhsa_float_denorm_mode_16_64 3
.end_amdhsa_kernel
```
